```python
import torch

def _softmax(x, axis=-1):
    return torch.softmax(x, dim=axis)
def _gelu(x):
    return torch.nn.functional.gelu(x, approximate="tanh")
def _silu(x):
    return torch.nn.functional.silu(x)
def _sigmoid(x):
    return torch.sigmoid(x)
def _layernorm(x, axis=-1, eps=1e-5):
    m = x.mean(dim=axis, keepdim=True)
    v = x.var(dim=axis, keepdim=True, unbiased=False)
    return (x - m) / torch.sqrt(v + eps)
def _scatter_add(tgt, idx, src, axis=0):
    return tgt.clone().index_add_(axis, idx, src)
def _segment_sum(src, seg, n):
    out = torch.zeros((n,) + src.shape[1:], dtype=src.dtype)
    return out.index_add_(0, seg, src)
def _pad(x, pw):
    flat = tuple(v for pair in reversed(pw) for v in pair)
    return torch.nn.functional.pad(x, flat)

kernel_name = 'gated_mix__spectral_gfnet__ssm_conv_s5__prompt'

def setup_inputs():

    _w = (lambda a: (lambda t: t.to(torch.bfloat16) if t.is_floating_point() else t)(torch.as_tensor(a)))
    def _A_setup():
        B, S, D = 1, 2048, 1024
        Df = D // 2 + 1
        return {
            "x": _w((lambda *s: torch.randn(*s, dtype=torch.bfloat16) * 0.05)(B, S, D)),
            "w_r": _w((lambda *s: torch.randn(*s, dtype=torch.bfloat16) * 0.8)(S, Df) * 0.02),
            "w_i": _w((lambda *s: torch.randn(*s, dtype=torch.bfloat16) * 0.8)(S, Df) * 0.02),
        }
    _A_in = _A_setup()

    def _B_setup():
        B, S, D = 1, 2048, 1024
        P = D
        Lambda_re = -0.5 * (lambda _x: torch.exp(torch.as_tensor(_x)))((lambda *s: torch.randn(*s, dtype=torch.bfloat16) * 0.2)(P))
        Lambda_im = (lambda *s: torch.randn(*s, dtype=torch.bfloat16) * 0.4)(P) * 1.0
        B_re = (lambda *s: torch.randn(*s, dtype=torch.bfloat16) * 0.2)(P, D) * (D ** -0.5)
        B_im = (lambda *s: torch.randn(*s, dtype=torch.bfloat16) * 0.2)(P, D) * (D ** -0.5)
        C_re = (lambda *s: torch.randn(*s, dtype=torch.bfloat16) * 0.2)(D, P) * (P ** -0.5)
        C_im = (lambda *s: torch.randn(*s, dtype=torch.bfloat16) * 0.2)(D, P) * (P ** -0.5)
        log_dt = (lambda *s: torch.randn(*s, dtype=torch.bfloat16) * 0.2)(P) * 0.3 - 2.0
        Dskip = (lambda *s: torch.randn(*s, dtype=torch.bfloat16) * 0.05)(D)
        return {
            "x": _w((lambda *s: torch.randn(*s, dtype=torch.bfloat16) * 0.05)(B, S, D)),
            "Lambda_re": _w(Lambda_re),
            "Lambda_im": _w(Lambda_im),
            "B_re": _w(B_re),
            "B_im": _w(B_im),
            "C_re": _w(C_re),
            "C_im": _w(C_im),
            "log_dt": _w(log_dt),
            "Dskip": _w(Dskip),
        }
    _B_in = _B_setup()

    return {
        "A_x": _A_in["x"],
        "A_w_r": _A_in["w_r"],
        "A_w_i": _A_in["w_i"],
        "B_x": _B_in["x"],
        "B_Lambda_re": _B_in["Lambda_re"],
        "B_Lambda_im": _B_in["Lambda_im"],
        "B_B_re": _B_in["B_re"],
        "B_B_im": _B_in["B_im"],
        "B_C_re": _B_in["C_re"],
        "B_C_im": _B_in["C_im"],
        "B_log_dt": _B_in["log_dt"],
        "B_Dskip": _B_in["Dskip"],
        "gate_w": _w((lambda *s: torch.randn(*s, dtype=torch.bfloat16) * 0.05)(1024) * 16.0),
    }

def reference(A_x, A_w_r, A_w_i, B_x, B_Lambda_re, B_Lambda_im, B_B_re, B_B_im, B_C_re, B_C_im, B_log_dt, B_Dskip, gate_w):
    def _A_ref(x, w_r, w_i):
        B, S, D = x.shape
        X = (lambda x, axes=(-2,-1): torch.fft.rfft2(x.float(), dim=axes))(x, axes=(-2, -1))
        W = w_r + 1j * w_i
        X = X * W
        y = (lambda x, s, axes=(-2,-1): torch.fft.irfft2(x, s=s, dim=axes).to(torch.bfloat16))(X, (S, D), axes=(-2, -1))
        return y

    def _B_ref(x, Lambda_re, Lambda_im, B_re, B_im, C_re, C_im, log_dt, Dskip):
        Bsz, L, H = x.shape
        Lam = Lambda_re + 1j * Lambda_im
        Bmat = B_re + 1j * B_im
        Cmat = C_re + 1j * C_im
        dt = torch.exp(log_dt)
        Lam_bar = torch.exp(dt * Lam)
        B_bar = ((Lam_bar - 1.0) / Lam)[:, None] * Bmat
        Bu = torch.einsum("bld,pd->blp", x + 0j, B_bar)
        h = torch.zeros_like(Bu[:, 0, :])
        hs = []
        for t in range(L):
            h = Lam_bar[None, :] * h + Bu[:, t, :]
            hs.append(h)
        hseq = torch.stack(hs, 1)
        y = 2.0 * torch.einsum("blp,dp->bld", hseq, Cmat).real + x * Dskip[None, None, :]
        return y

    x = A_x
    g = _sigmoid((x * gate_w).sum(-1, keepdims=True))
    a = _A_ref(x, A_w_r, A_w_i)
    b = _B_ref(x, B_Lambda_re, B_Lambda_im, B_B_re, B_B_im, B_C_re, B_C_im, B_log_dt, B_Dskip)
    return g * a + (1 - g) * b
```

```asm
; @launch kernel=ka_kernel grid=(256,1,1) block=(256,1,1) lds=16384
; @launch kernel=kb_kernel grid=(256,1,1) block=(256,1,1) lds=33792
; @launch kernel=kc_kernel grid=(256,1,1) block=(256,1,1) lds=131072
; @launch kernel=kd_kernel grid=(256,1,1) block=(256,1,1) lds=155648
.amdgcn_target "amdgcn-amd-amdhsa--gfx950"
.text
.p2align 8
.globl ka_kernel
.type ka_kernel,@function
ka_kernel:
  s_cmp_ge_u32 s2, 256
  s_cbranch_scc1 ka_kernel_end
  s_load_dwordx2 s[4:5], s[0:1], 0
  s_load_dwordx2 s[6:7], s[0:1], 96
  s_load_dwordx2 s[8:9], s[0:1], 120
  v_lshrrev_b32 v1, 6, v0
  s_nop 0
  v_readfirstlane_b32 s3, v1
  v_and_b32 v1, 63, v0
  v_and_b32 v2, 15, v0
  v_bfe_u32 v3, v0, 4, 2
  s_and_b32 s10, s2, 7
  s_lshr_b32 s11, s2, 3
  s_and_b32 s15, s11, 3
  s_lshr_b32 s11, s11, 2
  s_lshl_b32 s14, s10, 3
  s_add_u32 s14, s14, s11
  s_and_b32 s12, s10, 3
  s_lshl_b32 s12, s12, 2
  s_add_u32 s12, s12, s15
  s_lshr_b32 s13, s10, 2
  s_lshl_b32 s13, s13, 3
  s_add_u32 s13, s13, s11
  s_waitcnt lgkmcnt(0)
  s_mov_b32 s16, s4
  s_mov_b32 s17, s5
  s_mov_b32 s18, 4194304
  s_mov_b32 s19, 0x20000
  s_mov_b32 s20, s6
  s_mov_b32 s21, s7
  s_mov_b32 s22, 2048
  s_mov_b32 s23, 0x20000
  s_mov_b32 s24, s8
  s_mov_b32 s25, s9
  s_mov_b32 s26, 4194304
  s_mov_b32 s27, 0x20000
  s_add_u32 s28, s8, 19922944
  s_addc_u32 s29, s9, 0
  s_mov_b32 s30, 8192
  s_mov_b32 s31, 0x20000
  s_add_u32 s32, s8, 19988480
  s_addc_u32 s33, s9, 0
  s_mov_b32 s34, 262144
  s_mov_b32 s35, 0x20000
  v_bfe_u32 v5, v1, 1, 2
  v_xor_b32 v5, v5, v3
  v_lshlrev_b32 v4, 9, v5
  v_and_b32 v5, 1, v1
  v_lshl_or_b32 v4, v5, 4, v4
  v_lshrrev_b32 v5, 3, v1
  v_lshl_or_b32 v4, v5, 15, v4
  s_lshl_b32 s10, s12, 11
  s_lshl_b32 m0, s13, 5
  s_add_u32 s10, s10, m0
  s_lshl_b32 m0, s3, 20
  s_add_u32 s10, s10, m0
  s_lshl_b32 m0, s3, 12
  s_add_u32 m0, m0, 0
  s_nop 0
  buffer_load_dwordx4 v4, s[16:19], s10 offen offset:0 lds
  s_add_u32 s10, s10, 261120
  buffer_load_dwordx4 v4, s[16:19], s10 offen offset:1024 lds
  s_add_u32 s10, s10, 261120
  buffer_load_dwordx4 v4, s[16:19], s10 offen offset:2048 lds
  s_add_u32 s10, s10, 261120
  buffer_load_dwordx4 v4, s[16:19], s10 offen offset:3072 lds
  v_lshlrev_b32 v28, 4, v1
  s_lshl_b32 s10, s2, 14
  s_lshl_b32 s11, s3, 12
  s_add_u32 s10, s10, s11
  buffer_load_dwordx4 v[4:7], v28, s[16:19], s10 offen offset:0
  buffer_load_dwordx4 v[8:11], v28, s[16:19], s10 offen offset:1024
  buffer_load_dwordx4 v[12:15], v28, s[16:19], s10 offen offset:2048
  buffer_load_dwordx4 v[16:19], v28, s[16:19], s10 offen offset:3072
  buffer_load_dwordx4 v[20:23], v28, s[20:23], 0 offen offset:0
  buffer_load_dwordx4 v[24:27], v28, s[20:23], 0 offen offset:1024
  v_lshlrev_b32 v28, 2, v0
  v_mov_b32 v29, -1
  s_lshl_b32 s10, s2, 10
  buffer_store_dword v29, v28, s[32:35], s10 offen
  s_lshl_b32 s10, s3, 4
  v_add_u32 v64, s10, v2
  v_cvt_f32_u32 v60, v64
  v_mul_f32 v60, 0x3c000000, v60
  v_cmp_eq_u32 vcc, 0, v64
  s_nop 1
  v_cndmask_b32 v61, v60, 0.5, vcc
  v_mov_b32 v62, 0x3e800000
  v_cndmask_b32 v62, v62, 0, vcc
  v_lshrrev_b32 v64, 1, v3
  v_lshlrev_b32 v64, 4, v64
  v_and_b32 v65, 1, v3
  v_lshl_add_u32 v64, v65, 2, v64
  v_cvt_f32_u32 v63, v64
  v_fma_f32 v62, v63, v61, v62
  v_mul_f32 v63, v63, v60
  v_fmamk_f32 v64, v60, 0x0, v63
  v_fmamk_f32 v65, v60, 0x3f800000, v63
  v_cos_f32 v64, v64
  v_cos_f32 v65, v65
  s_nop 0
  v_cvt_pk_bf16_f32 v28, v64, v65
  v_fmamk_f32 v64, v60, 0x40000000, v63
  v_fmamk_f32 v65, v60, 0x40400000, v63
  v_cos_f32 v64, v64
  v_cos_f32 v65, v65
  s_nop 0
  v_cvt_pk_bf16_f32 v29, v64, v65
  v_fmamk_f32 v64, v60, 0x41000000, v63
  v_fmamk_f32 v65, v60, 0x41100000, v63
  v_cos_f32 v64, v64
  v_cos_f32 v65, v65
  s_nop 0
  v_cvt_pk_bf16_f32 v30, v64, v65
  v_fmamk_f32 v64, v60, 0x41200000, v63
  v_fmamk_f32 v65, v60, 0x41300000, v63
  v_cos_f32 v64, v64
  v_cos_f32 v65, v65
  s_nop 0
  v_cvt_pk_bf16_f32 v31, v64, v65
  v_fmamk_f32 v64, v60, 0x42000000, v63
  v_fmamk_f32 v65, v60, 0x42040000, v63
  v_cos_f32 v64, v64
  v_cos_f32 v65, v65
  s_nop 0
  v_cvt_pk_bf16_f32 v32, v64, v65
  v_fmamk_f32 v64, v60, 0x42080000, v63
  v_fmamk_f32 v65, v60, 0x420c0000, v63
  v_cos_f32 v64, v64
  v_cos_f32 v65, v65
  s_nop 0
  v_cvt_pk_bf16_f32 v33, v64, v65
  v_fmamk_f32 v64, v60, 0x42200000, v63
  v_fmamk_f32 v65, v60, 0x42240000, v63
  v_cos_f32 v64, v64
  v_cos_f32 v65, v65
  s_nop 0
  v_cvt_pk_bf16_f32 v34, v64, v65
  v_fmamk_f32 v64, v60, 0x42280000, v63
  v_fmamk_f32 v65, v60, 0x422c0000, v63
  v_cos_f32 v64, v64
  v_cos_f32 v65, v65
  s_nop 0
  v_cvt_pk_bf16_f32 v35, v64, v65
  v_fmamk_f32 v64, v60, 0x42800000, v63
  v_fmamk_f32 v65, v60, 0x42820000, v63
  v_cos_f32 v64, v64
  v_cos_f32 v65, v65
  s_nop 0
  v_cvt_pk_bf16_f32 v36, v64, v65
  v_fmamk_f32 v64, v60, 0x42840000, v63
  v_fmamk_f32 v65, v60, 0x42860000, v63
  v_cos_f32 v64, v64
  v_cos_f32 v65, v65
  s_nop 0
  v_cvt_pk_bf16_f32 v37, v64, v65
  v_fmamk_f32 v64, v60, 0x42900000, v63
  v_fmamk_f32 v65, v60, 0x42920000, v63
  v_cos_f32 v64, v64
  v_cos_f32 v65, v65
  s_nop 0
  v_cvt_pk_bf16_f32 v38, v64, v65
  v_fmamk_f32 v64, v60, 0x42940000, v63
  v_fmamk_f32 v65, v60, 0x42960000, v63
  v_cos_f32 v64, v64
  v_cos_f32 v65, v65
  s_nop 0
  v_cvt_pk_bf16_f32 v39, v64, v65
  v_fmamk_f32 v64, v60, 0x42c00000, v63
  v_fmamk_f32 v65, v60, 0x42c20000, v63
  v_cos_f32 v64, v64
  v_cos_f32 v65, v65
  s_nop 0
  v_cvt_pk_bf16_f32 v40, v64, v65
  v_fmamk_f32 v64, v60, 0x42c40000, v63
  v_fmamk_f32 v65, v60, 0x42c60000, v63
  v_cos_f32 v64, v64
  v_cos_f32 v65, v65
  s_nop 0
  v_cvt_pk_bf16_f32 v41, v64, v65
  v_fmamk_f32 v64, v60, 0x42d00000, v63
  v_fmamk_f32 v65, v60, 0x42d20000, v63
  v_cos_f32 v64, v64
  v_cos_f32 v65, v65
  s_nop 0
  v_cvt_pk_bf16_f32 v42, v64, v65
  v_fmamk_f32 v64, v60, 0x42d40000, v63
  v_fmamk_f32 v65, v60, 0x42d60000, v63
  v_cos_f32 v64, v64
  v_cos_f32 v65, v65
  s_nop 0
  v_cvt_pk_bf16_f32 v43, v64, v65
  v_fmamk_f32 v64, v61, 0x0, v62
  v_fmamk_f32 v65, v61, 0x3f800000, v62
  v_cos_f32 v64, v64
  v_cos_f32 v65, v65
  s_nop 0
  v_cvt_pk_bf16_f32 v44, v64, v65
  v_fmamk_f32 v64, v61, 0x40000000, v62
  v_fmamk_f32 v65, v61, 0x40400000, v62
  v_cos_f32 v64, v64
  v_cos_f32 v65, v65
  s_nop 0
  v_cvt_pk_bf16_f32 v45, v64, v65
  v_fmamk_f32 v64, v61, 0x41000000, v62
  v_fmamk_f32 v65, v61, 0x41100000, v62
  v_cos_f32 v64, v64
  v_cos_f32 v65, v65
  s_nop 0
  v_cvt_pk_bf16_f32 v46, v64, v65
  v_fmamk_f32 v64, v61, 0x41200000, v62
  v_fmamk_f32 v65, v61, 0x41300000, v62
  v_cos_f32 v64, v64
  v_cos_f32 v65, v65
  s_nop 0
  v_cvt_pk_bf16_f32 v47, v64, v65
  v_fmamk_f32 v64, v61, 0x42000000, v62
  v_fmamk_f32 v65, v61, 0x42040000, v62
  v_cos_f32 v64, v64
  v_cos_f32 v65, v65
  s_nop 0
  v_cvt_pk_bf16_f32 v48, v64, v65
  v_fmamk_f32 v64, v61, 0x42080000, v62
  v_fmamk_f32 v65, v61, 0x420c0000, v62
  v_cos_f32 v64, v64
  v_cos_f32 v65, v65
  s_nop 0
  v_cvt_pk_bf16_f32 v49, v64, v65
  v_fmamk_f32 v64, v61, 0x42200000, v62
  v_fmamk_f32 v65, v61, 0x42240000, v62
  v_cos_f32 v64, v64
  v_cos_f32 v65, v65
  s_nop 0
  v_cvt_pk_bf16_f32 v50, v64, v65
  v_fmamk_f32 v64, v61, 0x42280000, v62
  v_fmamk_f32 v65, v61, 0x422c0000, v62
  v_cos_f32 v64, v64
  v_cos_f32 v65, v65
  s_nop 0
  v_cvt_pk_bf16_f32 v51, v64, v65
  v_fmamk_f32 v64, v61, 0x42800000, v62
  v_fmamk_f32 v65, v61, 0x42820000, v62
  v_cos_f32 v64, v64
  v_cos_f32 v65, v65
  s_nop 0
  v_cvt_pk_bf16_f32 v52, v64, v65
  v_fmamk_f32 v64, v61, 0x42840000, v62
  v_fmamk_f32 v65, v61, 0x42860000, v62
  v_cos_f32 v64, v64
  v_cos_f32 v65, v65
  s_nop 0
  v_cvt_pk_bf16_f32 v53, v64, v65
  v_fmamk_f32 v64, v61, 0x42900000, v62
  v_fmamk_f32 v65, v61, 0x42920000, v62
  v_cos_f32 v64, v64
  v_cos_f32 v65, v65
  s_nop 0
  v_cvt_pk_bf16_f32 v54, v64, v65
  v_fmamk_f32 v64, v61, 0x42940000, v62
  v_fmamk_f32 v65, v61, 0x42960000, v62
  v_cos_f32 v64, v64
  v_cos_f32 v65, v65
  s_nop 0
  v_cvt_pk_bf16_f32 v55, v64, v65
  v_fmamk_f32 v64, v61, 0x42c00000, v62
  v_fmamk_f32 v65, v61, 0x42c20000, v62
  v_cos_f32 v64, v64
  v_cos_f32 v65, v65
  s_nop 0
  v_cvt_pk_bf16_f32 v56, v64, v65
  v_fmamk_f32 v64, v61, 0x42c40000, v62
  v_fmamk_f32 v65, v61, 0x42c60000, v62
  v_cos_f32 v64, v64
  v_cos_f32 v65, v65
  s_nop 0
  v_cvt_pk_bf16_f32 v57, v64, v65
  v_fmamk_f32 v64, v61, 0x42d00000, v62
  v_fmamk_f32 v65, v61, 0x42d20000, v62
  v_cos_f32 v64, v64
  v_cos_f32 v65, v65
  s_nop 0
  v_cvt_pk_bf16_f32 v58, v64, v65
  v_fmamk_f32 v64, v61, 0x42d40000, v62
  v_fmamk_f32 v65, v61, 0x42d60000, v62
  v_cos_f32 v64, v64
  v_cos_f32 v65, v65
  s_nop 0
  v_cvt_pk_bf16_f32 v59, v64, v65
  s_waitcnt vmcnt(7)
  s_barrier
  v_bfe_u32 v64, v1, 2, 3
  v_lshrrev_b32 v65, 5, v1
  v_lshl_or_b32 v64, v65, 4, v64
  v_lshlrev_b32 v64, 7, v64
  v_and_b32 v65, 3, v1
  v_lshl_or_b32 v64, v65, 3, v64
  v_add_u32 v64, 0, v64
  v_bfe_u32 v65, v1, 3, 2
  v_xor_b32 v60, 0, v65
  v_lshl_add_u32 v60, v60, 5, v64
  v_xor_b32 v61, 1, v65
  v_lshl_add_u32 v61, v61, 5, v64
  v_xor_b32 v62, 2, v65
  v_lshl_add_u32 v62, v62, 5, v64
  v_xor_b32 v63, 3, v65
  v_lshl_add_u32 v63, v63, 5, v64
  ds_read_b64_tr_b16 v[100:101], v60 offset:0
  ds_read_b64_tr_b16 v[102:103], v60 offset:1024
  ds_read_b64_tr_b16 v[104:105], v60 offset:4096
  ds_read_b64_tr_b16 v[106:107], v60 offset:5120
  ds_read_b64_tr_b16 v[108:109], v60 offset:8192
  ds_read_b64_tr_b16 v[110:111], v60 offset:9216
  ds_read_b64_tr_b16 v[112:113], v60 offset:12288
  ds_read_b64_tr_b16 v[114:115], v60 offset:13312
  ds_read_b64_tr_b16 v[116:117], v61 offset:0
  ds_read_b64_tr_b16 v[118:119], v61 offset:1024
  ds_read_b64_tr_b16 v[120:121], v61 offset:4096
  ds_read_b64_tr_b16 v[122:123], v61 offset:5120
  ds_read_b64_tr_b16 v[124:125], v61 offset:8192
  ds_read_b64_tr_b16 v[126:127], v61 offset:9216
  ds_read_b64_tr_b16 v[128:129], v61 offset:12288
  ds_read_b64_tr_b16 v[130:131], v61 offset:13312
  ds_read_b64_tr_b16 v[132:133], v62 offset:0
  ds_read_b64_tr_b16 v[134:135], v62 offset:1024
  ds_read_b64_tr_b16 v[136:137], v62 offset:4096
  ds_read_b64_tr_b16 v[138:139], v62 offset:5120
  ds_read_b64_tr_b16 v[140:141], v62 offset:8192
  ds_read_b64_tr_b16 v[142:143], v62 offset:9216
  ds_read_b64_tr_b16 v[144:145], v62 offset:12288
  ds_read_b64_tr_b16 v[146:147], v62 offset:13312
  ds_read_b64_tr_b16 v[148:149], v63 offset:0
  ds_read_b64_tr_b16 v[150:151], v63 offset:1024
  ds_read_b64_tr_b16 v[152:153], v63 offset:4096
  ds_read_b64_tr_b16 v[154:155], v63 offset:5120
  ds_read_b64_tr_b16 v[156:157], v63 offset:8192
  ds_read_b64_tr_b16 v[158:159], v63 offset:9216
  ds_read_b64_tr_b16 v[160:161], v63 offset:12288
  ds_read_b64_tr_b16 v[162:163], v63 offset:13312
  s_waitcnt lgkmcnt(15)
  v_mfma_f32_16x16x32_bf16 v[68:71], v[100:103], v[28:31], 0
  v_mfma_f32_16x16x32_bf16 v[72:75], v[100:103], v[44:47], 0
  s_waitcnt lgkmcnt(15)
  v_mfma_f32_16x16x32_bf16 v[68:71], v[104:107], v[32:35], v[68:71]
  v_mfma_f32_16x16x32_bf16 v[72:75], v[104:107], v[48:51], v[72:75]
  s_waitcnt lgkmcnt(15)
  v_mfma_f32_16x16x32_bf16 v[68:71], v[108:111], v[36:39], v[68:71]
  v_mfma_f32_16x16x32_bf16 v[72:75], v[108:111], v[52:55], v[72:75]
  s_waitcnt lgkmcnt(15)
  v_mfma_f32_16x16x32_bf16 v[68:71], v[112:115], v[40:43], v[68:71]
  v_mfma_f32_16x16x32_bf16 v[72:75], v[112:115], v[56:59], v[72:75]
  s_waitcnt lgkmcnt(15)
  v_mfma_f32_16x16x32_bf16 v[76:79], v[116:119], v[28:31], 0
  v_mfma_f32_16x16x32_bf16 v[80:83], v[116:119], v[44:47], 0
  s_waitcnt lgkmcnt(15)
  v_mfma_f32_16x16x32_bf16 v[76:79], v[120:123], v[32:35], v[76:79]
  v_mfma_f32_16x16x32_bf16 v[80:83], v[120:123], v[48:51], v[80:83]
  s_waitcnt lgkmcnt(15)
  v_mfma_f32_16x16x32_bf16 v[76:79], v[124:127], v[36:39], v[76:79]
  v_mfma_f32_16x16x32_bf16 v[80:83], v[124:127], v[52:55], v[80:83]
  s_waitcnt lgkmcnt(15)
  v_mfma_f32_16x16x32_bf16 v[76:79], v[128:131], v[40:43], v[76:79]
  v_mfma_f32_16x16x32_bf16 v[80:83], v[128:131], v[56:59], v[80:83]
  s_waitcnt lgkmcnt(14)
  v_mfma_f32_16x16x32_bf16 v[84:87], v[132:135], v[28:31], 0
  v_mfma_f32_16x16x32_bf16 v[88:91], v[132:135], v[44:47], 0
  s_waitcnt lgkmcnt(12)
  v_mfma_f32_16x16x32_bf16 v[84:87], v[136:139], v[32:35], v[84:87]
  v_mfma_f32_16x16x32_bf16 v[88:91], v[136:139], v[48:51], v[88:91]
  s_waitcnt lgkmcnt(10)
  v_mfma_f32_16x16x32_bf16 v[84:87], v[140:143], v[36:39], v[84:87]
  v_mfma_f32_16x16x32_bf16 v[88:91], v[140:143], v[52:55], v[88:91]
  s_waitcnt lgkmcnt(8)
  v_mfma_f32_16x16x32_bf16 v[84:87], v[144:147], v[40:43], v[84:87]
  v_mfma_f32_16x16x32_bf16 v[88:91], v[144:147], v[56:59], v[88:91]
  s_waitcnt lgkmcnt(6)
  v_mfma_f32_16x16x32_bf16 v[92:95], v[148:151], v[28:31], 0
  v_mfma_f32_16x16x32_bf16 v[96:99], v[148:151], v[44:47], 0
  s_waitcnt lgkmcnt(4)
  v_mfma_f32_16x16x32_bf16 v[92:95], v[152:155], v[32:35], v[92:95]
  v_mfma_f32_16x16x32_bf16 v[96:99], v[152:155], v[48:51], v[96:99]
  s_waitcnt lgkmcnt(2)
  v_mfma_f32_16x16x32_bf16 v[92:95], v[156:159], v[36:39], v[92:95]
  v_mfma_f32_16x16x32_bf16 v[96:99], v[156:159], v[52:55], v[96:99]
  s_waitcnt lgkmcnt(0)
  v_mfma_f32_16x16x32_bf16 v[92:95], v[160:163], v[40:43], v[92:95]
  v_mfma_f32_16x16x32_bf16 v[96:99], v[160:163], v[56:59], v[96:99]
  v_pk_add_f32 v[100:101], v[68:69], v[84:85]
  v_pk_add_f32 v[116:117], v[68:69], v[84:85] neg_lo:[0,1] neg_hi:[0,1]
  s_nop 4
  v_pk_add_f32 v[108:109], v[76:77], v[92:93]
  v_pk_add_f32 v[124:125], v[76:77], v[92:93] neg_lo:[0,1] neg_hi:[0,1]
  v_pk_add_f32 v[102:103], v[70:71], v[86:87]
  v_pk_add_f32 v[118:119], v[70:71], v[86:87] neg_lo:[0,1] neg_hi:[0,1]
  v_pk_add_f32 v[110:111], v[78:79], v[94:95]
  v_pk_add_f32 v[126:127], v[78:79], v[94:95] neg_lo:[0,1] neg_hi:[0,1]
  v_pk_add_f32 v[104:105], v[72:73], v[88:89]
  v_pk_add_f32 v[120:121], v[72:73], v[88:89] neg_lo:[0,1] neg_hi:[0,1]
  v_pk_add_f32 v[112:113], v[80:81], v[96:97]
  v_pk_add_f32 v[128:129], v[80:81], v[96:97] neg_lo:[0,1] neg_hi:[0,1]
  v_pk_add_f32 v[106:107], v[74:75], v[90:91]
  v_pk_add_f32 v[122:123], v[74:75], v[90:91] neg_lo:[0,1] neg_hi:[0,1]
  v_pk_add_f32 v[114:115], v[82:83], v[98:99]
  v_pk_add_f32 v[130:131], v[82:83], v[98:99] neg_lo:[0,1] neg_hi:[0,1]
  v_pk_add_f32 v[68:69], v[100:101], v[108:109]
  v_pk_add_f32 v[84:85], v[100:101], v[108:109] neg_lo:[0,1] neg_hi:[0,1]
  v_pk_add_f32 v[72:73], v[104:105], v[112:113]
  v_pk_add_f32 v[88:89], v[104:105], v[112:113] neg_lo:[0,1] neg_hi:[0,1]
  v_pk_add_f32 v[76:77], v[116:117], v[128:129]
  v_pk_add_f32 v[80:81], v[120:121], v[124:125] neg_lo:[0,1] neg_hi:[0,1]
  v_pk_add_f32 v[92:93], v[116:117], v[128:129] neg_lo:[0,1] neg_hi:[0,1]
  v_pk_add_f32 v[96:97], v[120:121], v[124:125]
  v_pk_add_f32 v[70:71], v[102:103], v[110:111]
  v_pk_add_f32 v[86:87], v[102:103], v[110:111] neg_lo:[0,1] neg_hi:[0,1]
  v_pk_add_f32 v[74:75], v[106:107], v[114:115]
  v_pk_add_f32 v[90:91], v[106:107], v[114:115] neg_lo:[0,1] neg_hi:[0,1]
  v_pk_add_f32 v[78:79], v[118:119], v[130:131]
  v_pk_add_f32 v[82:83], v[122:123], v[126:127] neg_lo:[0,1] neg_hi:[0,1]
  v_pk_add_f32 v[94:95], v[118:119], v[130:131] neg_lo:[0,1] neg_hi:[0,1]
  v_pk_add_f32 v[98:99], v[122:123], v[126:127]
  s_cmp_lg_u32 s3, 0
  s_cbranch_scc1 ka_kernel_skip1
  s_mov_b32 exec_lo, 0x00010001
  s_mov_b32 exec_hi, 0x00010001
  v_mov_b32 v76, v116
  v_sub_f32 v80, 0, v124
  v_mov_b32 v92, v120
  v_sub_f32 v96, 0, v128
  v_mov_b32 v77, v117
  v_sub_f32 v81, 0, v125
  v_mov_b32 v93, v121
  v_sub_f32 v97, 0, v129
  v_mov_b32 v78, v118
  v_sub_f32 v82, 0, v126
  v_mov_b32 v94, v122
  v_sub_f32 v98, 0, v130
  v_mov_b32 v79, v119
  v_sub_f32 v83, 0, v127
  v_mov_b32 v95, v123
  v_sub_f32 v99, 0, v131
  s_mov_b64 exec, -1
ka_kernel_skip1:
  s_mov_b32 s10, 65536
  v_mul_lo_u32 v64, v2, s10
  v_lshl_add_u32 v64, v3, 4, v64
  s_mul_i32 s10, s3, 1048576
  s_lshl_b32 s11, s12, 10
  s_add_u32 s10, s10, s11
  s_lshl_b32 s11, s13, 6
  s_add_u32 s10, s10, s11
  v_cvt_pk_bf16_f32 v132, v68, v72
  v_cvt_pk_bf16_f32 v133, v69, v73
  v_cvt_pk_bf16_f32 v134, v70, v74
  v_cvt_pk_bf16_f32 v135, v71, v75
  buffer_store_dwordx4 v[132:135], v64, s[24:27], s10 offen
  s_add_u32 s10, s10, 16384
  v_cvt_pk_bf16_f32 v136, v76, v80
  v_cvt_pk_bf16_f32 v137, v77, v81
  v_cvt_pk_bf16_f32 v138, v78, v82
  v_cvt_pk_bf16_f32 v139, v79, v83
  buffer_store_dwordx4 v[136:139], v64, s[24:27], s10 offen
  s_add_u32 s10, s10, 16384
  v_cvt_pk_bf16_f32 v140, v84, v88
  v_cvt_pk_bf16_f32 v141, v85, v89
  v_cvt_pk_bf16_f32 v142, v86, v90
  v_cvt_pk_bf16_f32 v143, v87, v91
  buffer_store_dwordx4 v[140:143], v64, s[24:27], s10 offen
  s_add_u32 s10, s10, 16384
  v_cvt_pk_bf16_f32 v144, v92, v96
  v_cvt_pk_bf16_f32 v145, v93, v97
  v_cvt_pk_bf16_f32 v146, v94, v98
  v_cvt_pk_bf16_f32 v147, v95, v99
  buffer_store_dwordx4 v[144:147], v64, s[24:27], s10 offen
  v_mov_b32 v60, 0
  v_mov_b32 v61, 0
  s_waitcnt vmcnt(6)
  v_dot2c_f32_bf16 v60, v4, v20
  v_dot2c_f32_bf16 v61, v12, v20
  v_dot2c_f32_bf16 v60, v5, v21
  v_dot2c_f32_bf16 v61, v13, v21
  v_dot2c_f32_bf16 v60, v6, v22
  v_dot2c_f32_bf16 v61, v14, v22
  v_dot2c_f32_bf16 v60, v7, v23
  v_dot2c_f32_bf16 v61, v15, v23
  s_waitcnt vmcnt(5)
  v_dot2c_f32_bf16 v60, v8, v24
  v_dot2c_f32_bf16 v61, v16, v24
  v_dot2c_f32_bf16 v60, v9, v25
  v_dot2c_f32_bf16 v61, v17, v25
  v_dot2c_f32_bf16 v60, v10, v26
  v_dot2c_f32_bf16 v61, v18, v26
  v_dot2c_f32_bf16 v60, v11, v27
  v_dot2c_f32_bf16 v61, v19, v27
  s_nop 2
  v_permlane32_swap_b32 v60, v61
  v_add_f32 v60, v60, v61
  v_mov_b32 v61, v60
  s_nop 1
  v_permlane16_swap_b32 v60, v61
  v_add_f32 v60, v60, v61
  s_nop 1
  v_add_f32 v60, v60, v60 row_ror:8 row_mask:0xf bank_mask:0xf
  s_nop 1
  v_add_f32 v60, v60, v60 row_ror:4 row_mask:0xf bank_mask:0xf
  s_nop 1
  v_add_f32 v60, v60, v60 row_ror:2 row_mask:0xf bank_mask:0xf
  s_nop 1
  v_add_f32 v60, v60, v60 row_ror:1 row_mask:0xf bank_mask:0xf
  v_cvt_pk_bf16_f32 v60, v60, v60
  v_and_b32 v60, 0xffff0000, v60
  v_mul_f32 v60, 0xbfb8aa3b, v60
  v_exp_f32 v60, v60
  s_nop 0
  v_add_f32 v60, 1.0, v60
  v_rcp_f32 v60, v60
  s_nop 0
  v_cvt_pk_bf16_f32 v60, v60, v60
  v_and_b32 v60, 0xffff0000, v60
  s_and_b32 s10, s2, 1
  s_lshl_b32 s10, s10, 2
  s_add_u32 s10, s10, s3
  s_lshl_b32 s10, s10, 10
  s_lshr_b32 s11, s2, 1
  s_lshl_b32 s11, s11, 2
  s_add_u32 s10, s10, s11
  v_lshrrev_b32 v62, 5, v1
  v_lshlrev_b32 v62, 9, v62
  s_mov_b32 exec_lo, 1
  s_mov_b32 exec_hi, 1
  buffer_store_dword v60, v62, s[28:31], s10 offen
  s_mov_b64 exec, -1
ka_kernel_end:
  s_endpgm
.p2align 8
.globl kb_kernel
.type kb_kernel,@function
kb_kernel:
  s_cmp_ge_u32 s2, 256
  s_cbranch_scc1 kb_kernel_end
  s_load_dwordx2 s[4:5], s[0:1], 8
  s_load_dwordx2 s[6:7], s[0:1], 16
  s_load_dwordx2 s[8:9], s[0:1], 120
  v_lshrrev_b32 v1, 6, v0
  s_nop 0
  v_readfirstlane_b32 s3, v1
  v_and_b32 v1, 63, v0
  v_and_b32 v2, 15, v0
  v_bfe_u32 v3, v0, 4, 2
  s_and_b32 s10, s2, 7
  s_lshr_b32 s11, s2, 3
  s_and_b32 s15, s11, 3
  s_lshr_b32 s11, s11, 2
  s_lshl_b32 s14, s10, 3
  s_add_u32 s14, s14, s11
  s_and_b32 s12, s10, 3
  s_lshl_b32 s12, s12, 2
  s_add_u32 s12, s12, s15
  s_lshr_b32 s13, s10, 2
  s_lshl_b32 s13, s13, 3
  s_add_u32 s13, s13, s11
  s_waitcnt lgkmcnt(0)
  s_mov_b32 s16, s4
  s_mov_b32 s17, s5
  s_mov_b32 s18, 2101248
  s_mov_b32 s19, 0x20000
  s_mov_b32 s20, s6
  s_mov_b32 s21, s7
  s_mov_b32 s22, 2101248
  s_mov_b32 s23, 0x20000
  s_mov_b32 s24, s8
  s_mov_b32 s25, s9
  s_mov_b32 s26, 4194304
  s_mov_b32 s27, 0x20000
  s_add_u32 s28, s8, 5242880
  s_addc_u32 s29, s9, 0
  s_mov_b32 s30, 4194304
  s_mov_b32 s31, 0x20000
  s_lshl_b32 s33, s14, 2
  s_add_u32 s33, s33, s15
  s_cmp_eq_u32 s33, 3
  s_cselect_b32 s10, 1, s15
  s_cselect_b32 s11, 64, s14
  s_and_b32 s32, s33, 0xfd
  s_cmp_eq_u32 s32, 0
  s_cselect_b32 s32, 1, 0
  v_and_b32 v21, 3, v2
  v_lshlrev_b32 v20, 6, v21
  v_lshrrev_b32 v21, 2, v2
  v_lshl_or_b32 v20, v21, 4, v20
  v_lshl_or_b32 v20, v3, 12, v20
  s_mul_i32 s34, s33, 16384
  s_lshl_b32 s35, s3, 8
  s_add_u32 s34, s34, s35
  buffer_load_dwordx4 v[4:7], v20, s[24:27], s34 offen offset:0
  buffer_load_dwordx4 v[8:11], v20, s[24:27], s34 offen offset:1024
  buffer_load_dwordx4 v[12:15], v20, s[24:27], s34 offen offset:2048
  buffer_load_dwordx4 v[16:19], v20, s[24:27], s34 offen offset:3072
  v_lshlrev_b32 v65, 8, v3
  v_lshl_add_u32 v65, v2, 2, v65
  v_add_u32 v65, s10, v65
  v_sub_u32 v66, 832, v65
  v_cmp_lt_u32 s[38:39], 1, v3
  s_nop 1
  v_cndmask_b32 v65, v65, v66, s[38:39]
  v_lshlrev_b32 v65, 1, v65
  v_mov_b32 v20, 0
  v_mov_b32 v40, 0
  v_mov_b32 v21, 0
  v_mov_b32 v41, 0
  v_mov_b32 v22, 0
  v_mov_b32 v42, 0
  v_mov_b32 v23, 0
  v_mov_b32 v43, 0
  v_mov_b32 v24, 0
  v_mov_b32 v44, 0
  v_mov_b32 v25, 0
  v_mov_b32 v45, 0
  v_mov_b32 v26, 0
  v_mov_b32 v46, 0
  v_mov_b32 v27, 0
  v_mov_b32 v47, 0
  v_mov_b32 v28, 0
  v_mov_b32 v48, 0
  v_mov_b32 v29, 0
  v_mov_b32 v49, 0
  v_mov_b32 v30, 0
  v_mov_b32 v50, 0
  v_mov_b32 v31, 0
  v_mov_b32 v51, 0
  v_mov_b32 v32, 0
  v_mov_b32 v52, 0
  v_mov_b32 v33, 0
  v_mov_b32 v53, 0
  v_mov_b32 v34, 0
  v_mov_b32 v54, 0
  v_mov_b32 v35, 0
  v_mov_b32 v55, 0
  v_mov_b32 v36, 0
  v_mov_b32 v56, 0
  v_mov_b32 v37, 0
  v_mov_b32 v57, 0
  v_mov_b32 v38, 0
  v_mov_b32 v58, 0
  v_mov_b32 v39, 0
  v_mov_b32 v59, 0
  v_mov_b32 v60, 0
  v_mov_b32 v68, 0
  v_mov_b32 v61, 0
  v_mov_b32 v69, 0
  v_mov_b32 v62, 0
  v_mov_b32 v70, 0
  v_mov_b32 v63, 0
  v_mov_b32 v71, 0
  v_mov_b32 v64, 0
  v_mov_b32 v72, 0
  s_lshl_b32 s34, s3, 9
  s_add_u32 s34, s34, s11
  s_add_u32 s34, s34, 0
  s_lshr_b32 s36, s3, 1
  s_and_b32 s36, s36, s32
  s_mul_i32 s36, s36, 960
  s_sub_u32 s34, s34, s36
  s_sub_u32 s35, 2048, s34
  s_and_b32 s35, s35, 2047
  s_mul_i32 s34, s34, 1026
  s_mul_i32 s35, s35, 1026
  v_mov_b32 v66, s34
  v_mov_b32 v67, s35
  v_cndmask_b32 v67, v66, v67, s[38:39]
  v_add_u32 v67, v67, v65
  buffer_load_short_d16_hi v20, v67, s[16:19], 0 offen offset:0
  buffer_load_short_d16_hi v40, v67, s[20:23], 0 offen offset:0
  buffer_load_short_d16_hi v21, v67, s[16:19], 0 offen offset:128
  buffer_load_short_d16_hi v41, v67, s[20:23], 0 offen offset:128
  buffer_load_short_d16_hi v22, v67, s[16:19], 0 offen offset:256
  buffer_load_short_d16_hi v42, v67, s[20:23], 0 offen offset:256
  buffer_load_short_d16_hi v23, v67, s[16:19], 0 offen offset:384
  buffer_load_short_d16_hi v43, v67, s[20:23], 0 offen offset:384
  s_lshl_b32 s34, s3, 9
  s_add_u32 s34, s34, s11
  s_add_u32 s34, s34, 128
  s_lshr_b32 s36, s3, 1
  s_and_b32 s36, s36, s32
  s_mul_i32 s36, s36, 960
  s_sub_u32 s34, s34, s36
  s_sub_u32 s35, 2048, s34
  s_and_b32 s35, s35, 2047
  s_mul_i32 s34, s34, 1026
  s_mul_i32 s35, s35, 1026
  v_mov_b32 v66, s34
  v_mov_b32 v67, s35
  v_cndmask_b32 v67, v66, v67, s[38:39]
  v_add_u32 v67, v67, v65
  buffer_load_short_d16_hi v24, v67, s[16:19], 0 offen offset:0
  buffer_load_short_d16_hi v44, v67, s[20:23], 0 offen offset:0
  buffer_load_short_d16_hi v25, v67, s[16:19], 0 offen offset:128
  buffer_load_short_d16_hi v45, v67, s[20:23], 0 offen offset:128
  buffer_load_short_d16_hi v26, v67, s[16:19], 0 offen offset:256
  buffer_load_short_d16_hi v46, v67, s[20:23], 0 offen offset:256
  buffer_load_short_d16_hi v27, v67, s[16:19], 0 offen offset:384
  buffer_load_short_d16_hi v47, v67, s[20:23], 0 offen offset:384
  s_lshl_b32 s34, s3, 9
  s_add_u32 s34, s34, s11
  s_add_u32 s34, s34, 256
  s_lshr_b32 s36, s3, 1
  s_and_b32 s36, s36, s32
  s_mul_i32 s36, s36, 960
  s_sub_u32 s34, s34, s36
  s_sub_u32 s35, 2048, s34
  s_and_b32 s35, s35, 2047
  s_mul_i32 s34, s34, 1026
  s_mul_i32 s35, s35, 1026
  v_mov_b32 v66, s34
  v_mov_b32 v67, s35
  v_cndmask_b32 v67, v66, v67, s[38:39]
  v_add_u32 v67, v67, v65
  buffer_load_short_d16_hi v28, v67, s[16:19], 0 offen offset:0
  buffer_load_short_d16_hi v48, v67, s[20:23], 0 offen offset:0
  buffer_load_short_d16_hi v29, v67, s[16:19], 0 offen offset:128
  buffer_load_short_d16_hi v49, v67, s[20:23], 0 offen offset:128
  buffer_load_short_d16_hi v30, v67, s[16:19], 0 offen offset:256
  buffer_load_short_d16_hi v50, v67, s[20:23], 0 offen offset:256
  buffer_load_short_d16_hi v31, v67, s[16:19], 0 offen offset:384
  buffer_load_short_d16_hi v51, v67, s[20:23], 0 offen offset:384
  s_lshl_b32 s34, s3, 9
  s_add_u32 s34, s34, s11
  s_add_u32 s34, s34, 384
  s_lshr_b32 s36, s3, 1
  s_and_b32 s36, s36, s32
  s_mul_i32 s36, s36, 960
  s_sub_u32 s34, s34, s36
  s_sub_u32 s35, 2048, s34
  s_and_b32 s35, s35, 2047
  s_mul_i32 s34, s34, 1026
  s_mul_i32 s35, s35, 1026
  v_mov_b32 v66, s34
  v_mov_b32 v67, s35
  v_cndmask_b32 v67, v66, v67, s[38:39]
  v_add_u32 v67, v67, v65
  buffer_load_short_d16_hi v32, v67, s[16:19], 0 offen offset:0
  buffer_load_short_d16_hi v52, v67, s[20:23], 0 offen offset:0
  buffer_load_short_d16_hi v33, v67, s[16:19], 0 offen offset:128
  buffer_load_short_d16_hi v53, v67, s[20:23], 0 offen offset:128
  buffer_load_short_d16_hi v34, v67, s[16:19], 0 offen offset:256
  buffer_load_short_d16_hi v54, v67, s[20:23], 0 offen offset:256
  buffer_load_short_d16_hi v35, v67, s[16:19], 0 offen offset:384
  buffer_load_short_d16_hi v55, v67, s[20:23], 0 offen offset:384
  s_cmp_lg_u32 s10, 0
  s_cbranch_scc1 kb_kernel_skip1
  s_lshl_b32 s34, s3, 9
  s_add_u32 s34, s34, s11
  s_add_u32 s34, s34, 0
  s_lshr_b32 s36, s3, 1
  s_and_b32 s36, s36, s32
  s_mul_i32 s36, s36, 960
  s_sub_u32 s34, s34, s36
  s_sub_u32 s35, 2048, s34
  s_and_b32 s35, s35, 2047
  s_mul_i32 s34, s34, 1026
  s_mul_i32 s35, s35, 1026
  v_mov_b32 v66, s35
  v_mov_b32 v67, s34
  v_add_u32 v67, 1024, v67
  v_cndmask_b32 v67, v66, v67, s[38:39]
  buffer_load_short_d16_hi v60, v67, s[16:19], 0 offen
  buffer_load_short_d16_hi v68, v67, s[20:23], 0 offen
  s_lshl_b32 s34, s3, 9
  s_add_u32 s34, s34, s11
  s_add_u32 s34, s34, 128
  s_lshr_b32 s36, s3, 1
  s_and_b32 s36, s36, s32
  s_mul_i32 s36, s36, 960
  s_sub_u32 s34, s34, s36
  s_sub_u32 s35, 2048, s34
  s_and_b32 s35, s35, 2047
  s_mul_i32 s34, s34, 1026
  s_mul_i32 s35, s35, 1026
  v_mov_b32 v66, s35
  v_mov_b32 v67, s34
  v_add_u32 v67, 1024, v67
  v_cndmask_b32 v67, v66, v67, s[38:39]
  buffer_load_short_d16_hi v61, v67, s[16:19], 0 offen
  buffer_load_short_d16_hi v69, v67, s[20:23], 0 offen
  s_lshl_b32 s34, s3, 9
  s_add_u32 s34, s34, s11
  s_add_u32 s34, s34, 256
  s_lshr_b32 s36, s3, 1
  s_and_b32 s36, s36, s32
  s_mul_i32 s36, s36, 960
  s_sub_u32 s34, s34, s36
  s_sub_u32 s35, 2048, s34
  s_and_b32 s35, s35, 2047
  s_mul_i32 s34, s34, 1026
  s_mul_i32 s35, s35, 1026
  v_mov_b32 v66, s35
  v_mov_b32 v67, s34
  v_add_u32 v67, 1024, v67
  v_cndmask_b32 v67, v66, v67, s[38:39]
  buffer_load_short_d16_hi v62, v67, s[16:19], 0 offen
  buffer_load_short_d16_hi v70, v67, s[20:23], 0 offen
  s_lshl_b32 s34, s3, 9
  s_add_u32 s34, s34, s11
  s_add_u32 s34, s34, 384
  s_lshr_b32 s36, s3, 1
  s_and_b32 s36, s36, s32
  s_mul_i32 s36, s36, 960
  s_sub_u32 s34, s34, s36
  s_sub_u32 s35, 2048, s34
  s_and_b32 s35, s35, 2047
  s_mul_i32 s34, s34, 1026
  s_mul_i32 s35, s35, 1026
  v_mov_b32 v66, s35
  v_mov_b32 v67, s34
  v_add_u32 v67, 1024, v67
  v_cndmask_b32 v67, v66, v67, s[38:39]
  buffer_load_short_d16_hi v63, v67, s[16:19], 0 offen
  buffer_load_short_d16_hi v71, v67, s[20:23], 0 offen
  s_mov_b32 s34, 1024
  s_sub_u32 s35, 2048, s34
  s_and_b32 s35, s35, 2047
  s_mul_i32 s34, s34, 1026
  s_mul_i32 s35, s35, 1026
  v_mov_b32 v66, s35
  v_mov_b32 v67, s34
  v_add_u32 v67, 1024, v67
  v_cndmask_b32 v67, v66, v67, s[38:39]
  buffer_load_short_d16_hi v64, v67, s[16:19], 0 offen
  buffer_load_short_d16_hi v72, v67, s[20:23], 0 offen
kb_kernel_skip1:
  s_cmp_eq_u32 s32, 0
  s_cbranch_scc1 kb_kernel_skip2
  s_mov_b32 s34, 1024
  s_sub_u32 s35, 2048, s34
  s_and_b32 s35, s35, 2047
  s_mul_i32 s34, s34, 1026
  s_mul_i32 s35, s35, 1026
  v_mov_b32 v66, s34
  v_mov_b32 v67, s35
  v_cndmask_b32 v67, v66, v67, s[38:39]
  v_add_u32 v67, v67, v65
  buffer_load_short_d16_hi v36, v67, s[16:19], 0 offen offset:0
  buffer_load_short_d16_hi v56, v67, s[20:23], 0 offen offset:0
  buffer_load_short_d16_hi v37, v67, s[16:19], 0 offen offset:128
  buffer_load_short_d16_hi v57, v67, s[20:23], 0 offen offset:128
  buffer_load_short_d16_hi v38, v67, s[16:19], 0 offen offset:256
  buffer_load_short_d16_hi v58, v67, s[20:23], 0 offen offset:256
  buffer_load_short_d16_hi v39, v67, s[16:19], 0 offen offset:384
  buffer_load_short_d16_hi v59, v67, s[20:23], 0 offen offset:384
kb_kernel_skip2:
  v_cvt_f32_u32 v73, v2
  v_cvt_f32_u32 v74, v3
  v_mul_f32 v74, 4.0, v74
  v_cvt_f32_u32 v78, s10
  v_cvt_f32_u32 v79, s11
  v_cvt_f32_u32 v80, s32
  v_mul_f32 v80, 0xc4700000, v80
  v_cmp_lt_u32 vcc, 7, v2
  s_nop 1
  v_cndmask_b32 v77, 0, v80, vcc
  v_add_f32 v77, v77, v79
  v_fmamk_f32 v75, v73, 0x43000000, v77
  v_mul_f32 v75, 0x3a000000, v75
  v_mul_f32 v76, v75, v74
  v_fmamk_f32 v65, v75, 0x0, v76
  v_cos_f32 v66, v65
  v_sin_f32 v67, v65
  s_nop 0
  v_cvt_pk_bf16_f32 v84, v66, v67
  v_cvt_pk_bf16_f32 v88, -v67, v66
  v_fmamk_f32 v65, v75, 0x3f800000, v76
  v_cos_f32 v66, v65
  v_sin_f32 v67, v65
  s_nop 0
  v_cvt_pk_bf16_f32 v85, v66, v67
  v_cvt_pk_bf16_f32 v89, -v67, v66
  v_fmamk_f32 v65, v75, 0x40000000, v76
  v_cos_f32 v66, v65
  v_sin_f32 v67, v65
  s_nop 0
  v_cvt_pk_bf16_f32 v86, v66, v67
  v_cvt_pk_bf16_f32 v90, -v67, v66
  v_fmamk_f32 v65, v75, 0x40400000, v76
  v_cos_f32 v66, v65
  v_sin_f32 v67, v65
  s_nop 0
  v_cvt_pk_bf16_f32 v87, v66, v67
  v_cvt_pk_bf16_f32 v91, -v67, v66
  v_cmp_lt_u32 vcc, 1, v3
  s_nop 1
  v_cndmask_b32 v77, 0, v80, vcc
  v_add_f32 v77, v77, v79
  v_fmamk_f32 v77, v74, 0x43000000, v77
  v_mul_f32 v76, v77, v73
  v_mul_f32 v76, 0x3a000000, v76
  v_mul_f32 v75, 0x3d800000, v73
  v_fmamk_f32 v65, v75, 0x0, v76
  v_cos_f32 v66, v65
  v_sin_f32 v67, v65
  s_nop 0
  v_cvt_pk_bf16_f32 v92, v66, -v67
  v_cvt_pk_bf16_f32 v96, v67, v66
  v_fmamk_f32 v65, v75, 0x3f800000, v76
  v_cos_f32 v66, v65
  v_sin_f32 v67, v65
  s_nop 0
  v_cvt_pk_bf16_f32 v93, v66, -v67
  v_cvt_pk_bf16_f32 v97, v67, v66
  v_fmamk_f32 v65, v75, 0x40000000, v76
  v_cos_f32 v66, v65
  v_sin_f32 v67, v65
  s_nop 0
  v_cvt_pk_bf16_f32 v94, v66, -v67
  v_cvt_pk_bf16_f32 v98, v67, v66
  v_fmamk_f32 v65, v75, 0x40400000, v76
  v_cos_f32 v66, v65
  v_sin_f32 v67, v65
  s_nop 0
  v_cvt_pk_bf16_f32 v95, v66, -v67
  v_cvt_pk_bf16_f32 v99, v67, v66
  s_cmp_eq_u32 s32, 0
  s_cbranch_scc1 kb_kernel_skip3
  v_cmp_lt_u32 vcc, 7, v2
  s_nop 1
  v_cndmask_b32 v65, 0, 16, vcc
  v_and_b32 v84, 0xffff, v84
  v_lshlrev_b32 v84, v65, v84
  v_and_b32 v85, 0xffff, v85
  v_lshlrev_b32 v85, v65, v85
  v_and_b32 v86, 0xffff, v86
  v_lshlrev_b32 v86, v65, v86
  v_and_b32 v87, 0xffff, v87
  v_lshlrev_b32 v87, v65, v87
  v_and_b32 v88, 0xffff, v88
  v_lshlrev_b32 v88, v65, v88
  v_and_b32 v89, 0xffff, v89
  v_lshlrev_b32 v89, v65, v89
  v_and_b32 v90, 0xffff, v90
  v_lshlrev_b32 v90, v65, v90
  v_and_b32 v91, 0xffff, v91
  v_lshlrev_b32 v91, v65, v91
  v_cmp_eq_u32 vcc, 0, v2
  v_mov_b32 v66, 0x3f80
  s_nop 0
  v_cndmask_b32 v88, v88, v66, vcc
  v_mov_b32 v66, 0xbf80
  v_cndmask_b32 v89, v89, v66, vcc
  v_mov_b32 v66, 0x3f80
  v_cndmask_b32 v90, v90, v66, vcc
  v_mov_b32 v66, 0xbf80
  v_cndmask_b32 v91, v91, v66, vcc
  v_cmp_lt_u32 vcc, 1, v3
  v_lshlrev_b32 v66, 16, v92
  v_and_b32 v67, 0xffff0000, v92
  v_add_f32 v66, v66, v66
  v_add_f32 v67, v67, v67
  v_cvt_pk_bf16_f32 v66, v66, v67
  v_cndmask_b32 v92, v66, 0, vcc
  v_cndmask_b32 v96, 0, v66, vcc
  v_lshlrev_b32 v66, 16, v93
  v_and_b32 v67, 0xffff0000, v93
  v_add_f32 v66, v66, v66
  v_add_f32 v67, v67, v67
  v_cvt_pk_bf16_f32 v66, v66, v67
  v_cndmask_b32 v93, v66, 0, vcc
  v_cndmask_b32 v97, 0, v66, vcc
  v_lshlrev_b32 v66, 16, v94
  v_and_b32 v67, 0xffff0000, v94
  v_add_f32 v66, v66, v66
  v_add_f32 v67, v67, v67
  v_cvt_pk_bf16_f32 v66, v66, v67
  v_cndmask_b32 v94, v66, 0, vcc
  v_cndmask_b32 v98, 0, v66, vcc
  v_lshlrev_b32 v66, 16, v95
  v_and_b32 v67, 0xffff0000, v95
  v_add_f32 v66, v66, v66
  v_add_f32 v67, v67, v67
  v_cvt_pk_bf16_f32 v66, v66, v67
  v_cndmask_b32 v95, v66, 0, vcc
  v_cndmask_b32 v99, 0, v66, vcc
  v_lshlrev_b32 v66, 31, v2
  v_or_b32 v66, 0x3f803f80, v66
  v_cmp_eq_u32 vcc, 0, v3
  s_nop 1
  v_cndmask_b32 v92, v92, v66, vcc
kb_kernel_skip3:
  v_fma_f32 v77, v73, 4.0, v78
  v_mul_f32 v75, 0x3c800000, v77
  v_mul_f32 v76, v75, v74
  v_fmamk_f32 v65, v75, 0x0, v76
  v_cos_f32 v66, v65
  v_sin_f32 v67, v65
  s_nop 0
  v_cvt_pk_bf16_f32 v100, v66, v67
  v_cvt_pk_bf16_f32 v104, -v67, v66
  v_fmamk_f32 v65, v75, 0x3f800000, v76
  v_cos_f32 v66, v65
  v_sin_f32 v67, v65
  s_nop 0
  v_cvt_pk_bf16_f32 v101, v66, v67
  v_cvt_pk_bf16_f32 v105, -v67, v66
  v_fmamk_f32 v65, v75, 0x40000000, v76
  v_cos_f32 v66, v65
  v_sin_f32 v67, v65
  s_nop 0
  v_cvt_pk_bf16_f32 v102, v66, v67
  v_cvt_pk_bf16_f32 v106, -v67, v66
  v_fmamk_f32 v65, v75, 0x40400000, v76
  v_cos_f32 v66, v65
  v_sin_f32 v67, v65
  s_nop 0
  v_cvt_pk_bf16_f32 v103, v66, v67
  v_cvt_pk_bf16_f32 v107, -v67, v66
  v_mul_f32 v75, 0x3d800000, v75
  v_mul_f32 v76, 0x3d800000, v76
  v_fmamk_f32 v65, v75, 0x0, v76
  v_cos_f32 v108, v65
  v_sin_f32 v112, v65
  v_fmamk_f32 v65, v75, 0x3f800000, v76
  v_cos_f32 v109, v65
  v_sin_f32 v113, v65
  v_fmamk_f32 v65, v75, 0x40000000, v76
  v_cos_f32 v110, v65
  v_sin_f32 v114, v65
  v_fmamk_f32 v65, v75, 0x40400000, v76
  v_cos_f32 v111, v65
  v_sin_f32 v115, v65
  v_fma_f32 v77, v74, 4.0, v78
  v_mul_f32 v76, v77, v73
  v_mul_f32 v76, 0x3c800000, v76
  v_mul_f32 v75, 0x3d800000, v73
  v_fmamk_f32 v65, v75, 0x0, v76
  v_cos_f32 v66, v65
  v_sin_f32 v67, v65
  s_nop 0
  v_cvt_pk_bf16_f32 v116, v66, -v67
  v_cvt_pk_bf16_f32 v120, v67, v66
  v_fmamk_f32 v65, v75, 0x3f800000, v76
  v_cos_f32 v66, v65
  v_sin_f32 v67, v65
  s_nop 0
  v_cvt_pk_bf16_f32 v117, v66, -v67
  v_cvt_pk_bf16_f32 v121, v67, v66
  v_fmamk_f32 v65, v75, 0x40000000, v76
  v_cos_f32 v66, v65
  v_sin_f32 v67, v65
  s_nop 0
  v_cvt_pk_bf16_f32 v118, v66, -v67
  v_cvt_pk_bf16_f32 v122, v67, v66
  v_fmamk_f32 v65, v75, 0x40400000, v76
  v_cos_f32 v66, v65
  v_sin_f32 v67, v65
  s_nop 0
  v_cvt_pk_bf16_f32 v119, v66, -v67
  v_cvt_pk_bf16_f32 v123, v67, v66
  v_mul_f32 v75, 0x3d800000, v75
  v_mul_f32 v76, 0x3d800000, v76
  v_fmamk_f32 v65, v75, 0x0, v76
  v_cos_f32 v124, v65
  v_sin_f32 v128, v65
  v_fmamk_f32 v65, v75, 0x3f800000, v76
  v_cos_f32 v125, v65
  v_sin_f32 v129, v65
  v_fmamk_f32 v65, v75, 0x40000000, v76
  v_cos_f32 v126, v65
  v_sin_f32 v130, v65
  v_fmamk_f32 v65, v75, 0x40400000, v76
  v_cos_f32 v127, v65
  v_sin_f32 v131, v65
  v_xor_b32 v77, 3, v2
  v_cmp_lt_u32 vcc, 7, v2
  s_nop 1
  v_cndmask_b32 v77, v2, v77, vcc
  v_cvt_f32_u32 v75, v77
  v_mul_f32 v75, 0x3d800000, v75
  v_mul_f32 v76, v75, v74
  v_fmamk_f32 v65, v75, 0x0, v76
  v_cos_f32 v66, v65
  v_sin_f32 v67, v65
  s_nop 0
  v_cvt_pk_bf16_f32 v132, v66, v67
  v_cvt_pk_bf16_f32 v136, -v67, v66
  v_fmamk_f32 v65, v75, 0x3f800000, v76
  v_cos_f32 v66, v65
  v_sin_f32 v67, v65
  s_nop 0
  v_cvt_pk_bf16_f32 v133, v66, v67
  v_cvt_pk_bf16_f32 v137, -v67, v66
  v_fmamk_f32 v65, v75, 0x40000000, v76
  v_cos_f32 v66, v65
  v_sin_f32 v67, v65
  s_nop 0
  v_cvt_pk_bf16_f32 v134, v66, v67
  v_cvt_pk_bf16_f32 v138, -v67, v66
  v_fmamk_f32 v65, v75, 0x40400000, v76
  v_cos_f32 v66, v65
  v_sin_f32 v67, v65
  s_nop 0
  v_cvt_pk_bf16_f32 v135, v66, v67
  v_cvt_pk_bf16_f32 v139, -v67, v66
  v_mul_f32 v75, 0x3d800000, v73
  v_add_f32 v77, 0x40400000, v74
  v_cmp_lt_u32 vcc, 1, v3
  s_nop 1
  v_cndmask_b32 v77, v74, v77, vcc
  v_mul_f32 v76, v75, v77
  v_cndmask_b32 v75, v75, -v75, vcc
  v_fmamk_f32 v65, v75, 0x0, v76
  v_cos_f32 v66, v65
  v_sin_f32 v67, v65
  s_nop 0
  v_cvt_pk_bf16_f32 v140, v66, -v67
  v_cvt_pk_bf16_f32 v144, v67, v66
  v_fmamk_f32 v65, v75, 0x3f800000, v76
  v_cos_f32 v66, v65
  v_sin_f32 v67, v65
  s_nop 0
  v_cvt_pk_bf16_f32 v141, v66, -v67
  v_cvt_pk_bf16_f32 v145, v67, v66
  v_fmamk_f32 v65, v75, 0x40000000, v76
  v_cos_f32 v66, v65
  v_sin_f32 v67, v65
  s_nop 0
  v_cvt_pk_bf16_f32 v142, v66, -v67
  v_cvt_pk_bf16_f32 v146, v67, v66
  v_fmamk_f32 v65, v75, 0x40400000, v76
  v_cos_f32 v66, v65
  v_sin_f32 v67, v65
  s_nop 0
  v_cvt_pk_bf16_f32 v143, v66, -v67
  v_cvt_pk_bf16_f32 v147, v67, v66
  s_waitcnt vmcnt(35)
  v_mov_b32 v148, v4
  s_waitcnt vmcnt(34)
  v_mov_b32 v149, v8
  s_waitcnt vmcnt(33)
  v_mov_b32 v150, v12
  s_waitcnt vmcnt(32)
  v_mov_b32 v151, v16
  v_mov_b32 v152, v5
  v_mov_b32 v153, v9
  v_mov_b32 v154, v13
  v_mov_b32 v155, v17
  v_mov_b32 v156, v6
  v_mov_b32 v157, v10
  v_mov_b32 v158, v14
  v_mov_b32 v159, v18
  v_mov_b32 v160, v7
  v_mov_b32 v161, v11
  v_mov_b32 v162, v15
  v_mov_b32 v163, v19
  v_mfma_f32_16x16x32_bf16 v[164:167], v[148:151], v[84:87], 0
  v_mfma_f32_16x16x32_bf16 v[168:171], v[148:151], v[88:91], 0
  v_mfma_f32_16x16x32_bf16 v[172:175], v[152:155], v[84:87], 0
  v_mfma_f32_16x16x32_bf16 v[176:179], v[152:155], v[88:91], 0
  v_mfma_f32_16x16x32_bf16 v[180:183], v[156:159], v[84:87], 0
  v_mfma_f32_16x16x32_bf16 v[184:187], v[156:159], v[88:91], 0
  v_mfma_f32_16x16x32_bf16 v[188:191], v[160:163], v[84:87], 0
  v_mfma_f32_16x16x32_bf16 v[192:195], v[160:163], v[88:91], 0
  s_mov_b32 s34, 1040
  v_mul_lo_u32 v65, v2, s34
  v_lshl_add_u32 v65, v3, 6, v65
  s_lshl_b32 s34, s3, 8
  s_add_u32 s34, s34, 0
  v_add_u32 v65, s34, v65
  v_cvt_pk_bf16_f32 v148, v164, v168
  v_cvt_pk_bf16_f32 v149, v165, v169
  v_cvt_pk_bf16_f32 v150, v166, v170
  v_cvt_pk_bf16_f32 v151, v167, v171
  ds_write_b128 v65, v[148:151] offset:0
  v_cvt_pk_bf16_f32 v152, v172, v176
  v_cvt_pk_bf16_f32 v153, v173, v177
  v_cvt_pk_bf16_f32 v154, v174, v178
  v_cvt_pk_bf16_f32 v155, v175, v179
  ds_write_b128 v65, v[152:155] offset:16
  v_cvt_pk_bf16_f32 v156, v180, v184
  v_cvt_pk_bf16_f32 v157, v181, v185
  v_cvt_pk_bf16_f32 v158, v182, v186
  v_cvt_pk_bf16_f32 v159, v183, v187
  ds_write_b128 v65, v[156:159] offset:32
  v_cvt_pk_bf16_f32 v160, v188, v192
  v_cvt_pk_bf16_f32 v161, v189, v193
  v_cvt_pk_bf16_f32 v162, v190, v194
  v_cvt_pk_bf16_f32 v163, v191, v195
  ds_write_b128 v65, v[160:163] offset:48
  s_mul_i32 s34, s3, 4160
  s_add_u32 s34, s34, 0
  v_lshl_add_u32 v65, v1, 4, s34
  s_waitcnt lgkmcnt(0)
  s_barrier
  ds_read_b128 v[148:151], v65 offset:0
  ds_read_b128 v[152:155], v65 offset:1040
  ds_read_b128 v[156:159], v65 offset:2080
  ds_read_b128 v[160:163], v65 offset:3120
  s_waitcnt lgkmcnt(3)
  v_mfma_f32_16x16x32_bf16 v[164:167], v[148:151], v[100:103], 0
  v_mfma_f32_16x16x32_bf16 v[168:171], v[148:151], v[104:107], 0
  s_waitcnt lgkmcnt(2)
  v_mfma_f32_16x16x32_bf16 v[172:175], v[152:155], v[100:103], 0
  v_mfma_f32_16x16x32_bf16 v[176:179], v[152:155], v[104:107], 0
  s_waitcnt lgkmcnt(1)
  v_mfma_f32_16x16x32_bf16 v[180:183], v[156:159], v[100:103], 0
  v_mfma_f32_16x16x32_bf16 v[184:187], v[156:159], v[104:107], 0
  s_waitcnt lgkmcnt(0)
  v_mfma_f32_16x16x32_bf16 v[188:191], v[160:163], v[100:103], 0
  v_mfma_f32_16x16x32_bf16 v[192:195], v[160:163], v[104:107], 0
  v_pk_mul_f32 v[76:77], v[164:165], v[108:109]
  v_pk_mul_f32 v[78:79], v[168:169], v[108:109]
  v_pk_fma_f32 v[76:77], v[168:169], v[112:113], v[76:77]
  v_pk_fma_f32 v[78:79], v[164:165], v[112:113], v[78:79] neg_lo:[0,1,0] neg_hi:[0,1,0]
  v_cvt_pk_bf16_f32 v148, v76, v78
  v_cvt_pk_bf16_f32 v149, v77, v79
  v_pk_mul_f32 v[76:77], v[166:167], v[110:111]
  v_pk_mul_f32 v[78:79], v[170:171], v[110:111]
  v_pk_fma_f32 v[76:77], v[170:171], v[114:115], v[76:77]
  v_pk_fma_f32 v[78:79], v[166:167], v[114:115], v[78:79] neg_lo:[0,1,0] neg_hi:[0,1,0]
  v_cvt_pk_bf16_f32 v150, v76, v78
  v_cvt_pk_bf16_f32 v151, v77, v79
  v_pk_mul_f32 v[76:77], v[172:173], v[108:109]
  v_pk_mul_f32 v[78:79], v[176:177], v[108:109]
  v_pk_fma_f32 v[76:77], v[176:177], v[112:113], v[76:77]
  v_pk_fma_f32 v[78:79], v[172:173], v[112:113], v[78:79] neg_lo:[0,1,0] neg_hi:[0,1,0]
  v_cvt_pk_bf16_f32 v152, v76, v78
  v_cvt_pk_bf16_f32 v153, v77, v79
  v_pk_mul_f32 v[76:77], v[174:175], v[110:111]
  v_pk_mul_f32 v[78:79], v[178:179], v[110:111]
  v_pk_fma_f32 v[76:77], v[178:179], v[114:115], v[76:77]
  v_pk_fma_f32 v[78:79], v[174:175], v[114:115], v[78:79] neg_lo:[0,1,0] neg_hi:[0,1,0]
  v_cvt_pk_bf16_f32 v154, v76, v78
  v_cvt_pk_bf16_f32 v155, v77, v79
  v_pk_mul_f32 v[76:77], v[180:181], v[108:109]
  v_pk_mul_f32 v[78:79], v[184:185], v[108:109]
  v_pk_fma_f32 v[76:77], v[184:185], v[112:113], v[76:77]
  v_pk_fma_f32 v[78:79], v[180:181], v[112:113], v[78:79] neg_lo:[0,1,0] neg_hi:[0,1,0]
  v_cvt_pk_bf16_f32 v156, v76, v78
  v_cvt_pk_bf16_f32 v157, v77, v79
  v_pk_mul_f32 v[76:77], v[182:183], v[110:111]
  v_pk_mul_f32 v[78:79], v[186:187], v[110:111]
  v_pk_fma_f32 v[76:77], v[186:187], v[114:115], v[76:77]
  v_pk_fma_f32 v[78:79], v[182:183], v[114:115], v[78:79] neg_lo:[0,1,0] neg_hi:[0,1,0]
  v_cvt_pk_bf16_f32 v158, v76, v78
  v_cvt_pk_bf16_f32 v159, v77, v79
  v_pk_mul_f32 v[76:77], v[188:189], v[108:109]
  v_pk_mul_f32 v[78:79], v[192:193], v[108:109]
  v_pk_fma_f32 v[76:77], v[192:193], v[112:113], v[76:77]
  v_pk_fma_f32 v[78:79], v[188:189], v[112:113], v[78:79] neg_lo:[0,1,0] neg_hi:[0,1,0]
  v_cvt_pk_bf16_f32 v160, v76, v78
  v_cvt_pk_bf16_f32 v161, v77, v79
  v_pk_mul_f32 v[76:77], v[190:191], v[110:111]
  v_pk_mul_f32 v[78:79], v[194:195], v[110:111]
  v_pk_fma_f32 v[76:77], v[194:195], v[114:115], v[76:77]
  v_pk_fma_f32 v[78:79], v[190:191], v[114:115], v[78:79] neg_lo:[0,1,0] neg_hi:[0,1,0]
  v_cvt_pk_bf16_f32 v162, v76, v78
  v_cvt_pk_bf16_f32 v163, v77, v79
  v_mfma_f32_16x16x32_bf16 v[164:167], v[132:135], v[148:151], 0
  v_mfma_f32_16x16x32_bf16 v[168:171], v[136:139], v[148:151], 0
  v_mfma_f32_16x16x32_bf16 v[172:175], v[132:135], v[152:155], 0
  v_mfma_f32_16x16x32_bf16 v[176:179], v[136:139], v[152:155], 0
  v_mfma_f32_16x16x32_bf16 v[180:183], v[132:135], v[156:159], 0
  v_mfma_f32_16x16x32_bf16 v[184:187], v[136:139], v[156:159], 0
  v_mfma_f32_16x16x32_bf16 v[188:191], v[132:135], v[160:163], 0
  v_mfma_f32_16x16x32_bf16 v[192:195], v[136:139], v[160:163], 0
  s_cmp_lg_u32 s10, 0
  s_cbranch_scc1 kb_kernel_skip4
  s_mov_b32 exec_lo, 1
  s_mov_b32 exec_hi, 0
  s_waitcnt vmcnt(0)
  v_add_f32 v20, v20, v60
  s_waitcnt vmcnt(31)
  v_mul_f32 v20, 0.5, v20
  s_waitcnt vmcnt(0)
  v_sub_f32 v40, v40, v68
  s_waitcnt vmcnt(30)
  v_mul_f32 v40, 0.5, v40
  s_waitcnt vmcnt(0)
  v_add_f32 v24, v24, v61
  s_waitcnt vmcnt(23)
  v_mul_f32 v24, 0.5, v24
  s_waitcnt vmcnt(0)
  v_sub_f32 v44, v44, v69
  s_waitcnt vmcnt(22)
  v_mul_f32 v44, 0.5, v44
  s_waitcnt vmcnt(0)
  v_add_f32 v28, v28, v62
  s_waitcnt vmcnt(15)
  v_mul_f32 v28, 0.5, v28
  s_waitcnt vmcnt(0)
  v_sub_f32 v48, v48, v70
  s_waitcnt vmcnt(14)
  v_mul_f32 v48, 0.5, v48
  s_waitcnt vmcnt(0)
  v_add_f32 v32, v32, v63
  s_waitcnt vmcnt(7)
  v_mul_f32 v32, 0.5, v32
  s_waitcnt vmcnt(0)
  v_sub_f32 v52, v52, v71
  s_waitcnt vmcnt(6)
  v_mul_f32 v52, 0.5, v52
  s_waitcnt vmcnt(0)
  v_add_f32 v36, v36, v64
  s_waitcnt vmcnt(0)
  v_mul_f32 v36, 0.5, v36
  s_waitcnt vmcnt(0)
  v_sub_f32 v56, v56, v72
  s_waitcnt vmcnt(0)
  v_mul_f32 v56, 0.5, v56
  s_mov_b32 exec_lo, 0
  s_mov_b32 exec_hi, 1
  s_waitcnt vmcnt(0)
  v_add_f32 v23, v23, v60
  s_waitcnt vmcnt(25)
  v_mul_f32 v23, 0.5, v23
  s_waitcnt vmcnt(0)
  v_sub_f32 v43, v43, v68
  s_waitcnt vmcnt(24)
  v_mul_f32 v43, 0.5, v43
  s_waitcnt vmcnt(0)
  v_add_f32 v27, v27, v61
  s_waitcnt vmcnt(17)
  v_mul_f32 v27, 0.5, v27
  s_waitcnt vmcnt(0)
  v_sub_f32 v47, v47, v69
  s_waitcnt vmcnt(16)
  v_mul_f32 v47, 0.5, v47
  s_waitcnt vmcnt(0)
  v_add_f32 v31, v31, v62
  s_waitcnt vmcnt(9)
  v_mul_f32 v31, 0.5, v31
  s_waitcnt vmcnt(0)
  v_sub_f32 v51, v51, v70
  s_waitcnt vmcnt(8)
  v_mul_f32 v51, 0.5, v51
  s_waitcnt vmcnt(0)
  v_add_f32 v35, v35, v63
  s_waitcnt vmcnt(1)
  v_mul_f32 v35, 0.5, v35
  s_waitcnt vmcnt(0)
  v_sub_f32 v55, v55, v71
  s_waitcnt vmcnt(0)
  v_mul_f32 v55, 0.5, v55
  s_waitcnt vmcnt(0)
  v_add_f32 v39, v39, v64
  s_waitcnt vmcnt(0)
  v_mul_f32 v39, 0.5, v39
  s_waitcnt vmcnt(0)
  v_sub_f32 v59, v59, v72
  s_waitcnt vmcnt(0)
  v_mul_f32 v59, 0.5, v59
  s_mov_b64 exec, -1
kb_kernel_skip4:
  s_mov_b32 exec_lo, 0
  s_waitcnt vmcnt(30)
  v_xor_b32 v40, 0x80000000, v40
  s_waitcnt vmcnt(28)
  v_xor_b32 v41, 0x80000000, v41
  s_waitcnt vmcnt(26)
  v_xor_b32 v42, 0x80000000, v42
  s_waitcnt vmcnt(24)
  v_xor_b32 v43, 0x80000000, v43
  s_waitcnt vmcnt(22)
  v_xor_b32 v44, 0x80000000, v44
  s_waitcnt vmcnt(20)
  v_xor_b32 v45, 0x80000000, v45
  s_waitcnt vmcnt(18)
  v_xor_b32 v46, 0x80000000, v46
  s_waitcnt vmcnt(16)
  v_xor_b32 v47, 0x80000000, v47
  s_waitcnt vmcnt(14)
  v_xor_b32 v48, 0x80000000, v48
  s_waitcnt vmcnt(12)
  v_xor_b32 v49, 0x80000000, v49
  s_waitcnt vmcnt(10)
  v_xor_b32 v50, 0x80000000, v50
  s_waitcnt vmcnt(8)
  v_xor_b32 v51, 0x80000000, v51
  s_waitcnt vmcnt(6)
  v_xor_b32 v52, 0x80000000, v52
  s_waitcnt vmcnt(4)
  v_xor_b32 v53, 0x80000000, v53
  s_waitcnt vmcnt(2)
  v_xor_b32 v54, 0x80000000, v54
  s_waitcnt vmcnt(0)
  v_xor_b32 v55, 0x80000000, v55
  s_waitcnt vmcnt(0)
  v_xor_b32 v56, 0x80000000, v56
  s_waitcnt vmcnt(0)
  v_xor_b32 v57, 0x80000000, v57
  s_waitcnt vmcnt(0)
  v_xor_b32 v58, 0x80000000, v58
  s_waitcnt vmcnt(0)
  v_xor_b32 v59, 0x80000000, v59
  s_mov_b64 exec, -1
  v_pk_mul_f32 v[76:77], v[164:165], v[20:21]
  v_pk_mul_f32 v[78:79], v[168:169], v[20:21]
  v_pk_fma_f32 v[76:77], v[168:169], v[40:41], v[76:77] neg_lo:[0,1,0] neg_hi:[0,1,0]
  v_pk_fma_f32 v[78:79], v[164:165], v[40:41], v[78:79]
  v_cvt_pk_bf16_f32 v148, v76, v78
  v_cvt_pk_bf16_f32 v149, v77, v79
  v_pk_mul_f32 v[76:77], v[166:167], v[22:23]
  v_pk_mul_f32 v[78:79], v[170:171], v[22:23]
  v_pk_fma_f32 v[76:77], v[170:171], v[42:43], v[76:77] neg_lo:[0,1,0] neg_hi:[0,1,0]
  v_pk_fma_f32 v[78:79], v[166:167], v[42:43], v[78:79]
  v_cvt_pk_bf16_f32 v150, v76, v78
  v_cvt_pk_bf16_f32 v151, v77, v79
  v_pk_mul_f32 v[76:77], v[172:173], v[24:25]
  v_pk_mul_f32 v[78:79], v[176:177], v[24:25]
  v_pk_fma_f32 v[76:77], v[176:177], v[44:45], v[76:77] neg_lo:[0,1,0] neg_hi:[0,1,0]
  v_pk_fma_f32 v[78:79], v[172:173], v[44:45], v[78:79]
  v_cvt_pk_bf16_f32 v152, v76, v78
  v_cvt_pk_bf16_f32 v153, v77, v79
  v_pk_mul_f32 v[76:77], v[174:175], v[26:27]
  v_pk_mul_f32 v[78:79], v[178:179], v[26:27]
  v_pk_fma_f32 v[76:77], v[178:179], v[46:47], v[76:77] neg_lo:[0,1,0] neg_hi:[0,1,0]
  v_pk_fma_f32 v[78:79], v[174:175], v[46:47], v[78:79]
  v_cvt_pk_bf16_f32 v154, v76, v78
  v_cvt_pk_bf16_f32 v155, v77, v79
  v_pk_mul_f32 v[76:77], v[180:181], v[28:29]
  v_pk_mul_f32 v[78:79], v[184:185], v[28:29]
  v_pk_fma_f32 v[76:77], v[184:185], v[48:49], v[76:77] neg_lo:[0,1,0] neg_hi:[0,1,0]
  v_pk_fma_f32 v[78:79], v[180:181], v[48:49], v[78:79]
  v_cvt_pk_bf16_f32 v156, v76, v78
  v_cvt_pk_bf16_f32 v157, v77, v79
  v_pk_mul_f32 v[76:77], v[182:183], v[30:31]
  v_pk_mul_f32 v[78:79], v[186:187], v[30:31]
  v_pk_fma_f32 v[76:77], v[186:187], v[50:51], v[76:77] neg_lo:[0,1,0] neg_hi:[0,1,0]
  v_pk_fma_f32 v[78:79], v[182:183], v[50:51], v[78:79]
  v_cvt_pk_bf16_f32 v158, v76, v78
  v_cvt_pk_bf16_f32 v159, v77, v79
  v_pk_mul_f32 v[76:77], v[188:189], v[32:33]
  v_pk_mul_f32 v[78:79], v[192:193], v[32:33]
  v_pk_fma_f32 v[76:77], v[192:193], v[52:53], v[76:77] neg_lo:[0,1,0] neg_hi:[0,1,0]
  v_pk_fma_f32 v[78:79], v[188:189], v[52:53], v[78:79]
  v_cvt_pk_bf16_f32 v160, v76, v78
  v_cvt_pk_bf16_f32 v161, v77, v79
  v_pk_mul_f32 v[76:77], v[190:191], v[34:35]
  v_pk_mul_f32 v[78:79], v[194:195], v[34:35]
  v_pk_fma_f32 v[76:77], v[194:195], v[54:55], v[76:77] neg_lo:[0,1,0] neg_hi:[0,1,0]
  v_pk_fma_f32 v[78:79], v[190:191], v[54:55], v[78:79]
  v_cvt_pk_bf16_f32 v162, v76, v78
  v_cvt_pk_bf16_f32 v163, v77, v79
  s_cmp_eq_u32 s32, 0
  s_cbranch_scc1 kb_kernel_skip5
  v_pk_mul_f32 v[76:77], v[164:165], v[36:37]
  v_pk_mul_f32 v[78:79], v[168:169], v[36:37]
  v_pk_fma_f32 v[76:77], v[168:169], v[56:57], v[76:77] neg_lo:[0,1,0] neg_hi:[0,1,0]
  v_pk_fma_f32 v[78:79], v[164:165], v[56:57], v[78:79]
  v_cvt_pk_bf16_f32 v40, v76, v78
  v_cvt_pk_bf16_f32 v41, v77, v79
  v_pk_mul_f32 v[76:77], v[166:167], v[38:39]
  v_pk_mul_f32 v[78:79], v[170:171], v[38:39]
  v_pk_fma_f32 v[76:77], v[170:171], v[58:59], v[76:77] neg_lo:[0,1,0] neg_hi:[0,1,0]
  v_pk_fma_f32 v[78:79], v[166:167], v[58:59], v[78:79]
  v_cvt_pk_bf16_f32 v42, v76, v78
  v_cvt_pk_bf16_f32 v43, v77, v79
  s_nop 1
  v_mfma_f32_16x16x32_bf16 v[20:23], v[40:43], v[140:143], 0
  v_mfma_f32_16x16x32_bf16 v[24:27], v[40:43], v[144:147], 0
  s_nop 6
  v_pk_mul_f32 v[76:77], v[20:21], v[124:125]
  v_pk_mul_f32 v[78:79], v[24:25], v[124:125]
  v_pk_fma_f32 v[76:77], v[24:25], v[128:129], v[76:77] neg_lo:[0,1,0] neg_hi:[0,1,0]
  v_pk_fma_f32 v[78:79], v[20:21], v[128:129], v[78:79]
  v_cvt_pk_bf16_f32 v40, v76, v78
  v_cvt_pk_bf16_f32 v41, v77, v79
  v_pk_mul_f32 v[76:77], v[22:23], v[126:127]
  v_pk_mul_f32 v[78:79], v[26:27], v[126:127]
  v_pk_fma_f32 v[76:77], v[26:27], v[130:131], v[76:77] neg_lo:[0,1,0] neg_hi:[0,1,0]
  v_pk_fma_f32 v[78:79], v[22:23], v[130:131], v[78:79]
  v_cvt_pk_bf16_f32 v42, v76, v78
  v_cvt_pk_bf16_f32 v43, v77, v79
  s_nop 1
  v_mfma_f32_16x16x32_bf16 v[20:23], v[116:119], v[40:43], 0
  v_mfma_f32_16x16x32_bf16 v[24:27], v[120:123], v[40:43], 0
kb_kernel_skip5:
  v_mfma_f32_16x16x32_bf16 v[164:167], v[148:151], v[140:143], 0
  v_mfma_f32_16x16x32_bf16 v[168:171], v[148:151], v[144:147], 0
  v_mfma_f32_16x16x32_bf16 v[172:175], v[152:155], v[140:143], 0
  v_mfma_f32_16x16x32_bf16 v[176:179], v[152:155], v[144:147], 0
  v_mfma_f32_16x16x32_bf16 v[180:183], v[156:159], v[140:143], 0
  v_mfma_f32_16x16x32_bf16 v[184:187], v[156:159], v[144:147], 0
  v_mfma_f32_16x16x32_bf16 v[188:191], v[160:163], v[140:143], 0
  v_mfma_f32_16x16x32_bf16 v[192:195], v[160:163], v[144:147], 0
  s_nop 0
  v_pk_mul_f32 v[76:77], v[164:165], v[124:125]
  v_pk_mul_f32 v[78:79], v[168:169], v[124:125]
  v_pk_fma_f32 v[76:77], v[168:169], v[128:129], v[76:77] neg_lo:[0,1,0] neg_hi:[0,1,0]
  v_pk_fma_f32 v[78:79], v[164:165], v[128:129], v[78:79]
  v_cvt_pk_bf16_f32 v148, v76, v78
  v_cvt_pk_bf16_f32 v149, v77, v79
  v_pk_mul_f32 v[76:77], v[166:167], v[126:127]
  v_pk_mul_f32 v[78:79], v[170:171], v[126:127]
  v_pk_fma_f32 v[76:77], v[170:171], v[130:131], v[76:77] neg_lo:[0,1,0] neg_hi:[0,1,0]
  v_pk_fma_f32 v[78:79], v[166:167], v[130:131], v[78:79]
  v_cvt_pk_bf16_f32 v150, v76, v78
  v_cvt_pk_bf16_f32 v151, v77, v79
  v_pk_mul_f32 v[76:77], v[172:173], v[124:125]
  v_pk_mul_f32 v[78:79], v[176:177], v[124:125]
  v_pk_fma_f32 v[76:77], v[176:177], v[128:129], v[76:77] neg_lo:[0,1,0] neg_hi:[0,1,0]
  v_pk_fma_f32 v[78:79], v[172:173], v[128:129], v[78:79]
  v_cvt_pk_bf16_f32 v152, v76, v78
  v_cvt_pk_bf16_f32 v153, v77, v79
  v_pk_mul_f32 v[76:77], v[174:175], v[126:127]
  v_pk_mul_f32 v[78:79], v[178:179], v[126:127]
  v_pk_fma_f32 v[76:77], v[178:179], v[130:131], v[76:77] neg_lo:[0,1,0] neg_hi:[0,1,0]
  v_pk_fma_f32 v[78:79], v[174:175], v[130:131], v[78:79]
  v_cvt_pk_bf16_f32 v154, v76, v78
  v_cvt_pk_bf16_f32 v155, v77, v79
  v_pk_mul_f32 v[76:77], v[180:181], v[124:125]
  v_pk_mul_f32 v[78:79], v[184:185], v[124:125]
  v_pk_fma_f32 v[76:77], v[184:185], v[128:129], v[76:77] neg_lo:[0,1,0] neg_hi:[0,1,0]
  v_pk_fma_f32 v[78:79], v[180:181], v[128:129], v[78:79]
  v_cvt_pk_bf16_f32 v156, v76, v78
  v_cvt_pk_bf16_f32 v157, v77, v79
  v_pk_mul_f32 v[76:77], v[182:183], v[126:127]
  v_pk_mul_f32 v[78:79], v[186:187], v[126:127]
  v_pk_fma_f32 v[76:77], v[186:187], v[130:131], v[76:77] neg_lo:[0,1,0] neg_hi:[0,1,0]
  v_pk_fma_f32 v[78:79], v[182:183], v[130:131], v[78:79]
  v_cvt_pk_bf16_f32 v158, v76, v78
  v_cvt_pk_bf16_f32 v159, v77, v79
  v_pk_mul_f32 v[76:77], v[188:189], v[124:125]
  v_pk_mul_f32 v[78:79], v[192:193], v[124:125]
  v_pk_fma_f32 v[76:77], v[192:193], v[128:129], v[76:77] neg_lo:[0,1,0] neg_hi:[0,1,0]
  v_pk_fma_f32 v[78:79], v[188:189], v[128:129], v[78:79]
  v_cvt_pk_bf16_f32 v160, v76, v78
  v_cvt_pk_bf16_f32 v161, v77, v79
  v_pk_mul_f32 v[76:77], v[190:191], v[126:127]
  v_pk_mul_f32 v[78:79], v[194:195], v[126:127]
  v_pk_fma_f32 v[76:77], v[194:195], v[130:131], v[76:77] neg_lo:[0,1,0] neg_hi:[0,1,0]
  v_pk_fma_f32 v[78:79], v[190:191], v[130:131], v[78:79]
  v_cvt_pk_bf16_f32 v162, v76, v78
  v_cvt_pk_bf16_f32 v163, v77, v79
  v_mfma_f32_16x16x32_bf16 v[164:167], v[116:119], v[148:151], 0
  v_mfma_f32_16x16x32_bf16 v[168:171], v[120:123], v[148:151], 0
  v_mfma_f32_16x16x32_bf16 v[172:175], v[116:119], v[152:155], 0
  v_mfma_f32_16x16x32_bf16 v[176:179], v[120:123], v[152:155], 0
  v_mfma_f32_16x16x32_bf16 v[180:183], v[116:119], v[156:159], 0
  v_mfma_f32_16x16x32_bf16 v[184:187], v[120:123], v[156:159], 0
  v_mfma_f32_16x16x32_bf16 v[188:191], v[116:119], v[160:163], 0
  v_mfma_f32_16x16x32_bf16 v[192:195], v[120:123], v[160:163], 0
  s_sub_u32 s34, s32, 1
  s_or_b32 s34, s34, s3
  s_cmp_lg_u32 s34, 0
  s_cbranch_scc1 kb_kernel_skip6
  v_mov_b32 v168, v24
  v_mov_b32 v169, v25
  v_mov_b32 v170, v26
  v_mov_b32 v171, v27
kb_kernel_skip6:
  v_lshlrev_b32 v65, 12, v3
  v_lshl_add_u32 v65, v2, 4, v65
  s_lshl_b32 s34, s3, 8
  s_add_u32 s34, s34, 17408
  v_add_u32 v65, s34, v65
  v_cvt_pk_bf16_f32 v148, v164, v168
  v_cvt_pk_bf16_f32 v149, v172, v176
  v_cvt_pk_bf16_f32 v150, v180, v184
  v_cvt_pk_bf16_f32 v151, v188, v192
  ds_write_b128 v65, v[148:151] offset:0
  v_cvt_pk_bf16_f32 v152, v165, v169
  v_cvt_pk_bf16_f32 v153, v173, v177
  v_cvt_pk_bf16_f32 v154, v181, v185
  v_cvt_pk_bf16_f32 v155, v189, v193
  ds_write_b128 v65, v[152:155] offset:1024
  v_cvt_pk_bf16_f32 v156, v166, v170
  v_cvt_pk_bf16_f32 v157, v174, v178
  v_cvt_pk_bf16_f32 v158, v182, v186
  v_cvt_pk_bf16_f32 v159, v190, v194
  ds_write_b128 v65, v[156:159] offset:2048
  v_cvt_pk_bf16_f32 v160, v167, v171
  v_cvt_pk_bf16_f32 v161, v175, v179
  v_cvt_pk_bf16_f32 v162, v183, v187
  v_cvt_pk_bf16_f32 v163, v191, v195
  ds_write_b128 v65, v[160:163] offset:3072
  s_lshl_b32 s34, s3, 12
  s_add_u32 s34, s34, 17408
  v_lshl_add_u32 v65, v1, 4, s34
  s_waitcnt lgkmcnt(0)
  s_barrier
  ds_read_b128 v[148:151], v65 offset:0
  ds_read_b128 v[152:155], v65 offset:1024
  ds_read_b128 v[156:159], v65 offset:2048
  ds_read_b128 v[160:163], v65 offset:3072
  s_waitcnt lgkmcnt(3)
  v_mfma_f32_16x16x32_bf16 v[164:167], v[148:151], v[92:95], 0
  v_mfma_f32_16x16x32_bf16 v[168:171], v[148:151], v[96:99], 0
  s_waitcnt lgkmcnt(2)
  v_mfma_f32_16x16x32_bf16 v[172:175], v[152:155], v[92:95], 0
  v_mfma_f32_16x16x32_bf16 v[176:179], v[152:155], v[96:99], 0
  s_waitcnt lgkmcnt(1)
  v_mfma_f32_16x16x32_bf16 v[180:183], v[156:159], v[92:95], 0
  v_mfma_f32_16x16x32_bf16 v[184:187], v[156:159], v[96:99], 0
  s_waitcnt lgkmcnt(0)
  v_mfma_f32_16x16x32_bf16 v[188:191], v[160:163], v[92:95], 0
  v_mfma_f32_16x16x32_bf16 v[192:195], v[160:163], v[96:99], 0
  s_mov_b32 s34, 262144
  v_mul_lo_u32 v65, v2, s34
  v_lshl_add_u32 v65, v3, 4, v65
  s_mul_i32 s35, s3, 65536
  s_lshl_b32 s34, s33, 6
  s_add_u32 s35, s35, s34
  v_cvt_pk_bf16_f32 v148, v164, v168
  v_cvt_pk_bf16_f32 v149, v165, v169
  v_cvt_pk_bf16_f32 v150, v166, v170
  v_cvt_pk_bf16_f32 v151, v167, v171
  buffer_store_dwordx4 v[148:151], v65, s[28:31], s35 offen
  s_add_u32 s35, s35, 16384
  v_cvt_pk_bf16_f32 v152, v172, v176
  v_cvt_pk_bf16_f32 v153, v173, v177
  v_cvt_pk_bf16_f32 v154, v174, v178
  v_cvt_pk_bf16_f32 v155, v175, v179
  buffer_store_dwordx4 v[152:155], v65, s[28:31], s35 offen
  s_add_u32 s35, s35, 16384
  v_cvt_pk_bf16_f32 v156, v180, v184
  v_cvt_pk_bf16_f32 v157, v181, v185
  v_cvt_pk_bf16_f32 v158, v182, v186
  v_cvt_pk_bf16_f32 v159, v183, v187
  buffer_store_dwordx4 v[156:159], v65, s[28:31], s35 offen
  s_add_u32 s35, s35, 16384
  v_cvt_pk_bf16_f32 v160, v188, v192
  v_cvt_pk_bf16_f32 v161, v189, v193
  v_cvt_pk_bf16_f32 v162, v190, v194
  v_cvt_pk_bf16_f32 v163, v191, v195
  buffer_store_dwordx4 v[160:163], v65, s[28:31], s35 offen
kb_kernel_end:
  s_endpgm
.p2align 8
.globl kc_kernel
.type kc_kernel,@function
kc_kernel:
  s_cmp_ge_u32 s2, 256
  s_cbranch_scc1 kc_kernel_end
  s_load_dwordx2 s[4:5], s[0:1], 0
  s_load_dwordx2 s[6:7], s[0:1], 48
  s_load_dwordx2 s[8:9], s[0:1], 56
  s_load_dwordx2 s[10:11], s[0:1], 32
  s_load_dwordx2 s[12:13], s[0:1], 40
  s_load_dwordx2 s[14:15], s[0:1], 80
  s_load_dwordx2 s[16:17], s[0:1], 120
  v_lshrrev_b32 v1, 6, v0
  s_nop 0
  v_readfirstlane_b32 s3, v1
  v_and_b32 v1, 63, v0
  v_and_b32 v2, 15, v0
  v_bfe_u32 v3, v0, 4, 2
  s_and_b32 s18, s2, 7
  s_lshr_b32 s19, s2, 3
  s_and_b32 s23, s19, 3
  s_lshr_b32 s19, s19, 2
  s_lshl_b32 s22, s18, 3
  s_add_u32 s22, s22, s19
  s_and_b32 s20, s18, 3
  s_lshl_b32 s20, s20, 2
  s_add_u32 s20, s20, s23
  s_lshr_b32 s21, s18, 2
  s_lshl_b32 s21, s21, 3
  s_add_u32 s21, s21, s19
  s_waitcnt lgkmcnt(0)
  s_mov_b32 s24, s4
  s_mov_b32 s25, s5
  s_mov_b32 s26, 4194304
  s_mov_b32 s27, 0x20000
  s_bitcmp1_b32 s3, 0
  s_cselect_b32 s28, s8, s6
  s_cselect_b32 s29, s9, s7
  s_mov_b32 s30, 2097152
  s_mov_b32 s31, 0x20000
  v_lshrrev_b32 v20, 5, v1
  v_lshlrev_b32 v20, 5, v20
  v_bfe_u32 v21, v1, 3, 1
  v_lshl_or_b32 v20, v21, 4, v20
  v_bfe_u32 v21, v1, 4, 1
  v_or_b32 v20, v20, v21
  v_lshlrev_b32 v20, 11, v20
  v_lshrrev_b32 v21, 3, v1
  v_lshlrev_b32 v21, 11, v21
  v_and_b32 v22, 7, v1
  v_xor_b32 v22, v22, v3
  v_lshlrev_b32 v22, 4, v22
  v_or_b32 v20, v20, v22
  v_or_b32 v21, v21, v22
  v_xor_b32 v4, 0, v20
  v_add_u32 v4, 0, v4
  v_xor_b32 v8, 0, v21
  v_add_u32 v8, 0, v8
  v_xor_b32 v5, 64, v20
  v_add_u32 v5, 3072, v5
  v_xor_b32 v9, 64, v21
  v_add_u32 v9, 15360, v9
  v_xor_b32 v6, 0, v20
  v_add_u32 v6, 6144, v6
  v_xor_b32 v10, 0, v21
  v_add_u32 v10, 30720, v10
  v_xor_b32 v7, 64, v20
  v_add_u32 v7, 9216, v7
  v_xor_b32 v11, 64, v21
  v_add_u32 v11, 46080, v11
  s_lshl_b32 s18, s20, 18
  s_lshr_b32 s34, s3, 1
  s_lshl_b32 s32, s34, 17
  s_add_u32 s18, s18, s32
  s_lshl_b32 s19, s21, 17
  s_lshl_b32 s32, s34, 16
  s_add_u32 s19, s19, s32
  s_and_b32 s34, s3, 1
  s_lshl_b32 s34, s34, 14
  s_add_u32 s18, s18, s34
  s_lshl_b32 s34, s3, 12
  s_add_u32 s32, s34, 0
  s_add_u32 s33, s34, 65536
  v_and_b32 v20, 31, v1
  v_lshlrev_b32 v20, 7, v20
  v_bfe_u32 v21, v1, 1, 3
  v_lshrrev_b32 v22, 5, v1
  v_xor_b32 v21, v21, v22
  v_lshl_or_b32 v20, v21, 4, v20
  s_lshr_b32 s34, s3, 1
  s_lshl_b32 s34, s34, 13
  s_add_u32 s34, s34, 0
  v_add_u32 v21, s34, v20
  s_and_b32 s34, s3, 1
  s_lshl_b32 s34, s34, 13
  s_add_u32 s34, s34, 65536
  v_add_u32 v22, s34, v20
  v_xor_b32 v12, 0, v21
  v_xor_b32 v16, 0, v22
  v_xor_b32 v13, 32, v21
  v_xor_b32 v17, 32, v22
  v_xor_b32 v14, 64, v21
  v_xor_b32 v18, 64, v22
  v_xor_b32 v15, 96, v21
  v_xor_b32 v19, 96, v22
  s_add_u32 m0, s32, 0
  s_nop 0
  buffer_load_dwordx4 v4, s[24:27], s18 offen offset:0 lds
  buffer_load_dwordx4 v5, s[24:27], s18 offen offset:1024 lds
  buffer_load_dwordx4 v6, s[24:27], s18 offen offset:2048 lds
  buffer_load_dwordx4 v7, s[24:27], s18 offen offset:3072 lds
  s_add_u32 s18, s18, 128
  s_add_u32 m0, s33, 0
  s_nop 0
  buffer_load_dwordx4 v8, s[28:31], s19 offen offset:0 lds
  buffer_load_dwordx4 v9, s[28:31], s19 offen offset:1024 lds
  buffer_load_dwordx4 v10, s[28:31], s19 offen offset:2048 lds
  buffer_load_dwordx4 v11, s[28:31], s19 offen offset:3072 lds
  s_add_u32 s19, s19, 128
  s_add_u32 m0, s32, 16384
  s_nop 0
  buffer_load_dwordx4 v4, s[24:27], s18 offen offset:0 lds
  buffer_load_dwordx4 v5, s[24:27], s18 offen offset:1024 lds
  buffer_load_dwordx4 v6, s[24:27], s18 offen offset:2048 lds
  buffer_load_dwordx4 v7, s[24:27], s18 offen offset:3072 lds
  s_add_u32 s18, s18, 128
  s_add_u32 m0, s33, 16384
  s_nop 0
  buffer_load_dwordx4 v8, s[28:31], s19 offen offset:0 lds
  buffer_load_dwordx4 v9, s[28:31], s19 offen offset:1024 lds
  buffer_load_dwordx4 v10, s[28:31], s19 offen offset:2048 lds
  buffer_load_dwordx4 v11, s[28:31], s19 offen offset:3072 lds
  s_add_u32 s19, s19, 128
  s_add_u32 m0, s32, 32768
  s_nop 0
  buffer_load_dwordx4 v4, s[24:27], s18 offen offset:0 lds
  buffer_load_dwordx4 v5, s[24:27], s18 offen offset:1024 lds
  buffer_load_dwordx4 v6, s[24:27], s18 offen offset:2048 lds
  buffer_load_dwordx4 v7, s[24:27], s18 offen offset:3072 lds
  s_add_u32 s18, s18, 128
  s_add_u32 m0, s33, 32768
  s_nop 0
  buffer_load_dwordx4 v8, s[28:31], s19 offen offset:0 lds
  buffer_load_dwordx4 v9, s[28:31], s19 offen offset:1024 lds
  buffer_load_dwordx4 v10, s[28:31], s19 offen offset:2048 lds
  buffer_load_dwordx4 v11, s[28:31], s19 offen offset:3072 lds
  s_add_u32 s19, s19, 128
  s_add_u32 m0, s32, 49152
  s_nop 0
  buffer_load_dwordx4 v4, s[24:27], s18 offen offset:0 lds
  buffer_load_dwordx4 v5, s[24:27], s18 offen offset:1024 lds
  buffer_load_dwordx4 v6, s[24:27], s18 offen offset:2048 lds
  buffer_load_dwordx4 v7, s[24:27], s18 offen offset:3072 lds
  s_add_u32 s18, s18, 128
  s_add_u32 m0, s33, 49152
  s_nop 0
  buffer_load_dwordx4 v8, s[28:31], s19 offen offset:0 lds
  buffer_load_dwordx4 v9, s[28:31], s19 offen offset:1024 lds
  buffer_load_dwordx4 v10, s[28:31], s19 offen offset:2048 lds
  buffer_load_dwordx4 v11, s[28:31], s19 offen offset:3072 lds
  s_add_u32 s19, s19, 128
  s_mov_b32 s36, s10
  s_mov_b32 s37, s11
  s_mov_b32 s38, 2048
  s_mov_b32 s39, 0x20000
  s_mov_b32 s40, s12
  s_mov_b32 s41, s13
  s_mov_b32 s42, 2048
  s_mov_b32 s43, 0x20000
  s_mov_b32 s44, s14
  s_mov_b32 s45, s15
  s_mov_b32 s46, 2048
  s_mov_b32 s47, 0x20000
  s_lshl_b32 s34, s21, 14
  s_add_u32 s50, s34, 19988480
  s_add_u32 s48, s16, s50
  s_addc_u32 s49, s17, 0
  s_mov_b32 s50, 16384
  s_mov_b32 s51, 0x20000
  s_add_u32 s52, s16, 10485760
  s_addc_u32 s53, s17, 0
  s_mov_b32 s54, 8388608
  s_mov_b32 s55, 0x20000
  v_and_b32 v23, 31, v1
  v_lshlrev_b32 v23, 1, v23
  s_lshl_b32 s35, s21, 7
  s_and_b32 s56, s3, 1
  s_lshl_b32 s56, s56, 6
  s_add_u32 s35, s35, s56
  buffer_load_ushort v20, v23, s[36:39], s35 offen
  buffer_load_ushort v21, v23, s[40:43], s35 offen
  buffer_load_ushort v22, v23, s[44:47], s35 offen
  s_waitcnt vmcnt(27)
  s_barrier
  ds_read_b128 v[88:91], v12 offset:0
  ds_read_b128 v[96:99], v16 offset:0
  ds_read_b128 v[92:95], v12 offset:4096
  ds_read_b128 v[100:103], v16 offset:4096
  s_waitcnt lgkmcnt(2)
  v_mfma_f32_32x32x16_bf16 v[24:39], v[88:91], v[96:99], 0
  ds_read_b128 v[104:107], v13 offset:0
  ds_read_b128 v[112:115], v17 offset:0
  s_waitcnt lgkmcnt(2)
  v_mfma_f32_32x32x16_bf16 v[40:55], v[88:91], v[100:103], 0
  ds_read_b128 v[108:111], v13 offset:4096
  ds_read_b128 v[116:119], v17 offset:4096
  v_mfma_f32_32x32x16_bf16 v[72:87], v[92:95], v[100:103], 0
  v_mfma_f32_32x32x16_bf16 v[56:71], v[92:95], v[96:99], 0
  s_waitcnt lgkmcnt(2)
  v_mfma_f32_32x32x16_bf16 v[24:39], v[104:107], v[112:115], v[24:39]
  ds_read_b128 v[88:91], v14 offset:0
  ds_read_b128 v[96:99], v18 offset:0
  s_waitcnt lgkmcnt(2)
  v_mfma_f32_32x32x16_bf16 v[40:55], v[104:107], v[116:119], v[40:55]
  ds_read_b128 v[92:95], v14 offset:4096
  ds_read_b128 v[100:103], v18 offset:4096
  v_mfma_f32_32x32x16_bf16 v[72:87], v[108:111], v[116:119], v[72:87]
  v_mfma_f32_32x32x16_bf16 v[56:71], v[108:111], v[112:115], v[56:71]
  s_waitcnt lgkmcnt(2)
  v_mfma_f32_32x32x16_bf16 v[24:39], v[88:91], v[96:99], v[24:39]
  ds_read_b128 v[104:107], v15 offset:0
  ds_read_b128 v[112:115], v19 offset:0
  s_waitcnt lgkmcnt(2)
  v_mfma_f32_32x32x16_bf16 v[40:55], v[88:91], v[100:103], v[40:55]
  ds_read_b128 v[108:111], v15 offset:4096
  ds_read_b128 v[116:119], v19 offset:4096
  v_mfma_f32_32x32x16_bf16 v[72:87], v[92:95], v[100:103], v[72:87]
  v_mfma_f32_32x32x16_bf16 v[56:71], v[92:95], v[96:99], v[56:71]
  s_waitcnt vmcnt(19) lgkmcnt(0)
  s_barrier
  v_mfma_f32_32x32x16_bf16 v[24:39], v[104:107], v[112:115], v[24:39]
  ds_read_b128 v[88:91], v12 offset:16384
  ds_read_b128 v[96:99], v16 offset:16384
  v_mfma_f32_32x32x16_bf16 v[40:55], v[104:107], v[116:119], v[40:55]
  ds_read_b128 v[92:95], v12 offset:20480
  ds_read_b128 v[100:103], v16 offset:20480
  v_mfma_f32_32x32x16_bf16 v[72:87], v[108:111], v[116:119], v[72:87]
  s_add_u32 m0, s32, 0
  s_nop 0
  buffer_load_dwordx4 v4, s[24:27], s18 offen offset:0 lds
  v_mfma_f32_32x32x16_bf16 v[56:71], v[108:111], v[112:115], v[56:71]
  buffer_load_dwordx4 v5, s[24:27], s18 offen offset:1024 lds
  s_waitcnt lgkmcnt(2)
  v_mfma_f32_32x32x16_bf16 v[24:39], v[88:91], v[96:99], v[24:39]
  ds_read_b128 v[104:107], v13 offset:16384
  ds_read_b128 v[112:115], v17 offset:16384
  s_waitcnt lgkmcnt(2)
  v_mfma_f32_32x32x16_bf16 v[40:55], v[88:91], v[100:103], v[40:55]
  ds_read_b128 v[108:111], v13 offset:20480
  ds_read_b128 v[116:119], v17 offset:20480
  v_mfma_f32_32x32x16_bf16 v[72:87], v[92:95], v[100:103], v[72:87]
  buffer_load_dwordx4 v6, s[24:27], s18 offen offset:2048 lds
  v_mfma_f32_32x32x16_bf16 v[56:71], v[92:95], v[96:99], v[56:71]
  buffer_load_dwordx4 v7, s[24:27], s18 offen offset:3072 lds
  s_add_u32 s18, s18, 128
  s_waitcnt lgkmcnt(2)
  v_mfma_f32_32x32x16_bf16 v[24:39], v[104:107], v[112:115], v[24:39]
  ds_read_b128 v[88:91], v14 offset:16384
  ds_read_b128 v[96:99], v18 offset:16384
  s_waitcnt lgkmcnt(2)
  v_mfma_f32_32x32x16_bf16 v[40:55], v[104:107], v[116:119], v[40:55]
  ds_read_b128 v[92:95], v14 offset:20480
  ds_read_b128 v[100:103], v18 offset:20480
  v_mfma_f32_32x32x16_bf16 v[72:87], v[108:111], v[116:119], v[72:87]
  s_add_u32 m0, s33, 0
  s_nop 0
  buffer_load_dwordx4 v8, s[28:31], s19 offen offset:0 lds
  v_mfma_f32_32x32x16_bf16 v[56:71], v[108:111], v[112:115], v[56:71]
  buffer_load_dwordx4 v9, s[28:31], s19 offen offset:1024 lds
  s_waitcnt lgkmcnt(2)
  v_mfma_f32_32x32x16_bf16 v[24:39], v[88:91], v[96:99], v[24:39]
  ds_read_b128 v[104:107], v15 offset:16384
  ds_read_b128 v[112:115], v19 offset:16384
  s_waitcnt lgkmcnt(2)
  v_mfma_f32_32x32x16_bf16 v[40:55], v[88:91], v[100:103], v[40:55]
  ds_read_b128 v[108:111], v15 offset:20480
  ds_read_b128 v[116:119], v19 offset:20480
  v_mfma_f32_32x32x16_bf16 v[72:87], v[92:95], v[100:103], v[72:87]
  buffer_load_dwordx4 v10, s[28:31], s19 offen offset:2048 lds
  v_mfma_f32_32x32x16_bf16 v[56:71], v[92:95], v[96:99], v[56:71]
  buffer_load_dwordx4 v11, s[28:31], s19 offen offset:3072 lds
  s_add_u32 s19, s19, 128
  s_waitcnt vmcnt(19) lgkmcnt(0)
  s_barrier
  v_mfma_f32_32x32x16_bf16 v[24:39], v[104:107], v[112:115], v[24:39]
  ds_read_b128 v[88:91], v12 offset:32768
  ds_read_b128 v[96:99], v16 offset:32768
  v_mfma_f32_32x32x16_bf16 v[40:55], v[104:107], v[116:119], v[40:55]
  ds_read_b128 v[92:95], v12 offset:36864
  ds_read_b128 v[100:103], v16 offset:36864
  v_mfma_f32_32x32x16_bf16 v[72:87], v[108:111], v[116:119], v[72:87]
  s_add_u32 m0, s32, 16384
  s_nop 0
  buffer_load_dwordx4 v4, s[24:27], s18 offen offset:0 lds
  v_mfma_f32_32x32x16_bf16 v[56:71], v[108:111], v[112:115], v[56:71]
  buffer_load_dwordx4 v5, s[24:27], s18 offen offset:1024 lds
  s_waitcnt lgkmcnt(2)
  v_mfma_f32_32x32x16_bf16 v[24:39], v[88:91], v[96:99], v[24:39]
  ds_read_b128 v[104:107], v13 offset:32768
  ds_read_b128 v[112:115], v17 offset:32768
  s_waitcnt lgkmcnt(2)
  v_mfma_f32_32x32x16_bf16 v[40:55], v[88:91], v[100:103], v[40:55]
  ds_read_b128 v[108:111], v13 offset:36864
  ds_read_b128 v[116:119], v17 offset:36864
  v_mfma_f32_32x32x16_bf16 v[72:87], v[92:95], v[100:103], v[72:87]
  buffer_load_dwordx4 v6, s[24:27], s18 offen offset:2048 lds
  v_mfma_f32_32x32x16_bf16 v[56:71], v[92:95], v[96:99], v[56:71]
  buffer_load_dwordx4 v7, s[24:27], s18 offen offset:3072 lds
  s_add_u32 s18, s18, 128
  s_waitcnt lgkmcnt(2)
  v_mfma_f32_32x32x16_bf16 v[24:39], v[104:107], v[112:115], v[24:39]
  ds_read_b128 v[88:91], v14 offset:32768
  ds_read_b128 v[96:99], v18 offset:32768
  s_waitcnt lgkmcnt(2)
  v_mfma_f32_32x32x16_bf16 v[40:55], v[104:107], v[116:119], v[40:55]
  ds_read_b128 v[92:95], v14 offset:36864
  ds_read_b128 v[100:103], v18 offset:36864
  v_mfma_f32_32x32x16_bf16 v[72:87], v[108:111], v[116:119], v[72:87]
  s_add_u32 m0, s33, 16384
  s_nop 0
  buffer_load_dwordx4 v8, s[28:31], s19 offen offset:0 lds
  v_mfma_f32_32x32x16_bf16 v[56:71], v[108:111], v[112:115], v[56:71]
  buffer_load_dwordx4 v9, s[28:31], s19 offen offset:1024 lds
  s_waitcnt lgkmcnt(2)
  v_mfma_f32_32x32x16_bf16 v[24:39], v[88:91], v[96:99], v[24:39]
  ds_read_b128 v[104:107], v15 offset:32768
  ds_read_b128 v[112:115], v19 offset:32768
  s_waitcnt lgkmcnt(2)
  v_mfma_f32_32x32x16_bf16 v[40:55], v[88:91], v[100:103], v[40:55]
  ds_read_b128 v[108:111], v15 offset:36864
  ds_read_b128 v[116:119], v19 offset:36864
  v_mfma_f32_32x32x16_bf16 v[72:87], v[92:95], v[100:103], v[72:87]
  buffer_load_dwordx4 v10, s[28:31], s19 offen offset:2048 lds
  v_mfma_f32_32x32x16_bf16 v[56:71], v[92:95], v[96:99], v[56:71]
  buffer_load_dwordx4 v11, s[28:31], s19 offen offset:3072 lds
  s_add_u32 s19, s19, 128
  s_waitcnt vmcnt(19) lgkmcnt(0)
  s_barrier
  v_mfma_f32_32x32x16_bf16 v[24:39], v[104:107], v[112:115], v[24:39]
  ds_read_b128 v[88:91], v12 offset:49152
  ds_read_b128 v[96:99], v16 offset:49152
  v_mfma_f32_32x32x16_bf16 v[40:55], v[104:107], v[116:119], v[40:55]
  ds_read_b128 v[92:95], v12 offset:53248
  ds_read_b128 v[100:103], v16 offset:53248
  v_mfma_f32_32x32x16_bf16 v[72:87], v[108:111], v[116:119], v[72:87]
  s_add_u32 m0, s32, 32768
  s_nop 0
  buffer_load_dwordx4 v4, s[24:27], s18 offen offset:0 lds
  v_mfma_f32_32x32x16_bf16 v[56:71], v[108:111], v[112:115], v[56:71]
  buffer_load_dwordx4 v5, s[24:27], s18 offen offset:1024 lds
  s_waitcnt lgkmcnt(2)
  v_mfma_f32_32x32x16_bf16 v[24:39], v[88:91], v[96:99], v[24:39]
  ds_read_b128 v[104:107], v13 offset:49152
  ds_read_b128 v[112:115], v17 offset:49152
  s_waitcnt lgkmcnt(2)
  v_mfma_f32_32x32x16_bf16 v[40:55], v[88:91], v[100:103], v[40:55]
  ds_read_b128 v[108:111], v13 offset:53248
  ds_read_b128 v[116:119], v17 offset:53248
  v_mfma_f32_32x32x16_bf16 v[72:87], v[92:95], v[100:103], v[72:87]
  buffer_load_dwordx4 v6, s[24:27], s18 offen offset:2048 lds
  v_mfma_f32_32x32x16_bf16 v[56:71], v[92:95], v[96:99], v[56:71]
  buffer_load_dwordx4 v7, s[24:27], s18 offen offset:3072 lds
  s_add_u32 s18, s18, 128
  s_waitcnt lgkmcnt(2)
  v_mfma_f32_32x32x16_bf16 v[24:39], v[104:107], v[112:115], v[24:39]
  ds_read_b128 v[88:91], v14 offset:49152
  ds_read_b128 v[96:99], v18 offset:49152
  s_waitcnt lgkmcnt(2)
  v_mfma_f32_32x32x16_bf16 v[40:55], v[104:107], v[116:119], v[40:55]
  ds_read_b128 v[92:95], v14 offset:53248
  ds_read_b128 v[100:103], v18 offset:53248
  v_mfma_f32_32x32x16_bf16 v[72:87], v[108:111], v[116:119], v[72:87]
  s_add_u32 m0, s33, 32768
  s_nop 0
  buffer_load_dwordx4 v8, s[28:31], s19 offen offset:0 lds
  v_mfma_f32_32x32x16_bf16 v[56:71], v[108:111], v[112:115], v[56:71]
  buffer_load_dwordx4 v9, s[28:31], s19 offen offset:1024 lds
  s_waitcnt lgkmcnt(2)
  v_mfma_f32_32x32x16_bf16 v[24:39], v[88:91], v[96:99], v[24:39]
  ds_read_b128 v[104:107], v15 offset:49152
  ds_read_b128 v[112:115], v19 offset:49152
  s_waitcnt lgkmcnt(2)
  v_mfma_f32_32x32x16_bf16 v[40:55], v[88:91], v[100:103], v[40:55]
  ds_read_b128 v[108:111], v15 offset:53248
  ds_read_b128 v[116:119], v19 offset:53248
  v_mfma_f32_32x32x16_bf16 v[72:87], v[92:95], v[100:103], v[72:87]
  buffer_load_dwordx4 v10, s[28:31], s19 offen offset:2048 lds
  v_mfma_f32_32x32x16_bf16 v[56:71], v[92:95], v[96:99], v[56:71]
  buffer_load_dwordx4 v11, s[28:31], s19 offen offset:3072 lds
  s_add_u32 s19, s19, 128
  s_waitcnt vmcnt(16) lgkmcnt(0)
  s_barrier
  v_mfma_f32_32x32x16_bf16 v[24:39], v[104:107], v[112:115], v[24:39]
  ds_read_b128 v[88:91], v12 offset:0
  ds_read_b128 v[96:99], v16 offset:0
  v_mfma_f32_32x32x16_bf16 v[40:55], v[104:107], v[116:119], v[40:55]
  ds_read_b128 v[92:95], v12 offset:4096
  ds_read_b128 v[100:103], v16 offset:4096
  v_mfma_f32_32x32x16_bf16 v[72:87], v[108:111], v[116:119], v[72:87]
  s_add_u32 m0, s32, 49152
  s_nop 0
  buffer_load_dwordx4 v4, s[24:27], s18 offen offset:0 lds
  v_mfma_f32_32x32x16_bf16 v[56:71], v[108:111], v[112:115], v[56:71]
  buffer_load_dwordx4 v5, s[24:27], s18 offen offset:1024 lds
  s_waitcnt lgkmcnt(2)
  v_mfma_f32_32x32x16_bf16 v[24:39], v[88:91], v[96:99], v[24:39]
  ds_read_b128 v[104:107], v13 offset:0
  ds_read_b128 v[112:115], v17 offset:0
  s_waitcnt lgkmcnt(2)
  v_mfma_f32_32x32x16_bf16 v[40:55], v[88:91], v[100:103], v[40:55]
  ds_read_b128 v[108:111], v13 offset:4096
  ds_read_b128 v[116:119], v17 offset:4096
  v_mfma_f32_32x32x16_bf16 v[72:87], v[92:95], v[100:103], v[72:87]
  buffer_load_dwordx4 v6, s[24:27], s18 offen offset:2048 lds
  v_mfma_f32_32x32x16_bf16 v[56:71], v[92:95], v[96:99], v[56:71]
  buffer_load_dwordx4 v7, s[24:27], s18 offen offset:3072 lds
  s_add_u32 s18, s18, 128
  s_waitcnt lgkmcnt(2)
  v_mfma_f32_32x32x16_bf16 v[24:39], v[104:107], v[112:115], v[24:39]
  ds_read_b128 v[88:91], v14 offset:0
  ds_read_b128 v[96:99], v18 offset:0
  s_waitcnt lgkmcnt(2)
  v_mfma_f32_32x32x16_bf16 v[40:55], v[104:107], v[116:119], v[40:55]
  ds_read_b128 v[92:95], v14 offset:4096
  ds_read_b128 v[100:103], v18 offset:4096
  v_mfma_f32_32x32x16_bf16 v[72:87], v[108:111], v[116:119], v[72:87]
  s_add_u32 m0, s33, 49152
  s_nop 0
  buffer_load_dwordx4 v8, s[28:31], s19 offen offset:0 lds
  v_mfma_f32_32x32x16_bf16 v[56:71], v[108:111], v[112:115], v[56:71]
  buffer_load_dwordx4 v9, s[28:31], s19 offen offset:1024 lds
  s_waitcnt lgkmcnt(2)
  v_mfma_f32_32x32x16_bf16 v[24:39], v[88:91], v[96:99], v[24:39]
  ds_read_b128 v[104:107], v15 offset:0
  ds_read_b128 v[112:115], v19 offset:0
  s_waitcnt lgkmcnt(2)
  v_mfma_f32_32x32x16_bf16 v[40:55], v[88:91], v[100:103], v[40:55]
  ds_read_b128 v[108:111], v15 offset:4096
  ds_read_b128 v[116:119], v19 offset:4096
  v_mfma_f32_32x32x16_bf16 v[72:87], v[92:95], v[100:103], v[72:87]
  buffer_load_dwordx4 v10, s[28:31], s19 offen offset:2048 lds
  v_mfma_f32_32x32x16_bf16 v[56:71], v[92:95], v[96:99], v[56:71]
  buffer_load_dwordx4 v11, s[28:31], s19 offen offset:3072 lds
  s_add_u32 s19, s19, 128
  s_waitcnt vmcnt(16) lgkmcnt(0)
  s_barrier
  v_mfma_f32_32x32x16_bf16 v[24:39], v[104:107], v[112:115], v[24:39]
  ds_read_b128 v[88:91], v12 offset:16384
  ds_read_b128 v[96:99], v16 offset:16384
  v_mfma_f32_32x32x16_bf16 v[40:55], v[104:107], v[116:119], v[40:55]
  ds_read_b128 v[92:95], v12 offset:20480
  ds_read_b128 v[100:103], v16 offset:20480
  v_mfma_f32_32x32x16_bf16 v[72:87], v[108:111], v[116:119], v[72:87]
  s_add_u32 m0, s32, 0
  s_nop 0
  buffer_load_dwordx4 v4, s[24:27], s18 offen offset:0 lds
  v_mfma_f32_32x32x16_bf16 v[56:71], v[108:111], v[112:115], v[56:71]
  buffer_load_dwordx4 v5, s[24:27], s18 offen offset:1024 lds
  s_waitcnt lgkmcnt(2)
  v_mfma_f32_32x32x16_bf16 v[24:39], v[88:91], v[96:99], v[24:39]
  ds_read_b128 v[104:107], v13 offset:16384
  ds_read_b128 v[112:115], v17 offset:16384
  s_waitcnt lgkmcnt(2)
  v_mfma_f32_32x32x16_bf16 v[40:55], v[88:91], v[100:103], v[40:55]
  ds_read_b128 v[108:111], v13 offset:20480
  ds_read_b128 v[116:119], v17 offset:20480
  v_mfma_f32_32x32x16_bf16 v[72:87], v[92:95], v[100:103], v[72:87]
  buffer_load_dwordx4 v6, s[24:27], s18 offen offset:2048 lds
  v_mfma_f32_32x32x16_bf16 v[56:71], v[92:95], v[96:99], v[56:71]
  buffer_load_dwordx4 v7, s[24:27], s18 offen offset:3072 lds
  s_add_u32 s18, s18, 128
  s_waitcnt lgkmcnt(2)
  v_mfma_f32_32x32x16_bf16 v[24:39], v[104:107], v[112:115], v[24:39]
  ds_read_b128 v[88:91], v14 offset:16384
  ds_read_b128 v[96:99], v18 offset:16384
  s_waitcnt lgkmcnt(2)
  v_mfma_f32_32x32x16_bf16 v[40:55], v[104:107], v[116:119], v[40:55]
  ds_read_b128 v[92:95], v14 offset:20480
  ds_read_b128 v[100:103], v18 offset:20480
  v_mfma_f32_32x32x16_bf16 v[72:87], v[108:111], v[116:119], v[72:87]
  s_add_u32 m0, s33, 0
  s_nop 0
  buffer_load_dwordx4 v8, s[28:31], s19 offen offset:0 lds
  v_mfma_f32_32x32x16_bf16 v[56:71], v[108:111], v[112:115], v[56:71]
  buffer_load_dwordx4 v9, s[28:31], s19 offen offset:1024 lds
  s_waitcnt lgkmcnt(2)
  v_mfma_f32_32x32x16_bf16 v[24:39], v[88:91], v[96:99], v[24:39]
  ds_read_b128 v[104:107], v15 offset:16384
  ds_read_b128 v[112:115], v19 offset:16384
  s_waitcnt lgkmcnt(2)
  v_mfma_f32_32x32x16_bf16 v[40:55], v[88:91], v[100:103], v[40:55]
  ds_read_b128 v[108:111], v15 offset:20480
  ds_read_b128 v[116:119], v19 offset:20480
  v_mfma_f32_32x32x16_bf16 v[72:87], v[92:95], v[100:103], v[72:87]
  buffer_load_dwordx4 v10, s[28:31], s19 offen offset:2048 lds
  v_mfma_f32_32x32x16_bf16 v[56:71], v[92:95], v[96:99], v[56:71]
  buffer_load_dwordx4 v11, s[28:31], s19 offen offset:3072 lds
  s_add_u32 s19, s19, 128
  s_waitcnt vmcnt(16) lgkmcnt(0)
  s_barrier
  v_mfma_f32_32x32x16_bf16 v[24:39], v[104:107], v[112:115], v[24:39]
  ds_read_b128 v[88:91], v12 offset:32768
  ds_read_b128 v[96:99], v16 offset:32768
  v_mfma_f32_32x32x16_bf16 v[40:55], v[104:107], v[116:119], v[40:55]
  ds_read_b128 v[92:95], v12 offset:36864
  ds_read_b128 v[100:103], v16 offset:36864
  v_mfma_f32_32x32x16_bf16 v[72:87], v[108:111], v[116:119], v[72:87]
  s_add_u32 m0, s32, 16384
  s_nop 0
  buffer_load_dwordx4 v4, s[24:27], s18 offen offset:0 lds
  v_mfma_f32_32x32x16_bf16 v[56:71], v[108:111], v[112:115], v[56:71]
  buffer_load_dwordx4 v5, s[24:27], s18 offen offset:1024 lds
  s_waitcnt lgkmcnt(2)
  v_mfma_f32_32x32x16_bf16 v[24:39], v[88:91], v[96:99], v[24:39]
  ds_read_b128 v[104:107], v13 offset:32768
  ds_read_b128 v[112:115], v17 offset:32768
  s_waitcnt lgkmcnt(2)
  v_mfma_f32_32x32x16_bf16 v[40:55], v[88:91], v[100:103], v[40:55]
  ds_read_b128 v[108:111], v13 offset:36864
  ds_read_b128 v[116:119], v17 offset:36864
  v_mfma_f32_32x32x16_bf16 v[72:87], v[92:95], v[100:103], v[72:87]
  buffer_load_dwordx4 v6, s[24:27], s18 offen offset:2048 lds
  v_mfma_f32_32x32x16_bf16 v[56:71], v[92:95], v[96:99], v[56:71]
  buffer_load_dwordx4 v7, s[24:27], s18 offen offset:3072 lds
  s_add_u32 s18, s18, 128
  s_waitcnt lgkmcnt(2)
  v_mfma_f32_32x32x16_bf16 v[24:39], v[104:107], v[112:115], v[24:39]
  ds_read_b128 v[88:91], v14 offset:32768
  ds_read_b128 v[96:99], v18 offset:32768
  s_waitcnt lgkmcnt(2)
  v_mfma_f32_32x32x16_bf16 v[40:55], v[104:107], v[116:119], v[40:55]
  ds_read_b128 v[92:95], v14 offset:36864
  ds_read_b128 v[100:103], v18 offset:36864
  v_mfma_f32_32x32x16_bf16 v[72:87], v[108:111], v[116:119], v[72:87]
  s_add_u32 m0, s33, 16384
  s_nop 0
  buffer_load_dwordx4 v8, s[28:31], s19 offen offset:0 lds
  v_mfma_f32_32x32x16_bf16 v[56:71], v[108:111], v[112:115], v[56:71]
  buffer_load_dwordx4 v9, s[28:31], s19 offen offset:1024 lds
  s_waitcnt lgkmcnt(2)
  v_mfma_f32_32x32x16_bf16 v[24:39], v[88:91], v[96:99], v[24:39]
  ds_read_b128 v[104:107], v15 offset:32768
  ds_read_b128 v[112:115], v19 offset:32768
  s_waitcnt lgkmcnt(2)
  v_mfma_f32_32x32x16_bf16 v[40:55], v[88:91], v[100:103], v[40:55]
  ds_read_b128 v[108:111], v15 offset:36864
  ds_read_b128 v[116:119], v19 offset:36864
  v_mfma_f32_32x32x16_bf16 v[72:87], v[92:95], v[100:103], v[72:87]
  buffer_load_dwordx4 v10, s[28:31], s19 offen offset:2048 lds
  v_mfma_f32_32x32x16_bf16 v[56:71], v[92:95], v[96:99], v[56:71]
  buffer_load_dwordx4 v11, s[28:31], s19 offen offset:3072 lds
  s_add_u32 s19, s19, 128
  s_waitcnt vmcnt(16) lgkmcnt(0)
  s_barrier
  v_mfma_f32_32x32x16_bf16 v[24:39], v[104:107], v[112:115], v[24:39]
  ds_read_b128 v[88:91], v12 offset:49152
  ds_read_b128 v[96:99], v16 offset:49152
  v_mfma_f32_32x32x16_bf16 v[40:55], v[104:107], v[116:119], v[40:55]
  ds_read_b128 v[92:95], v12 offset:53248
  ds_read_b128 v[100:103], v16 offset:53248
  v_mfma_f32_32x32x16_bf16 v[72:87], v[108:111], v[116:119], v[72:87]
  s_add_u32 m0, s32, 32768
  s_nop 0
  buffer_load_dwordx4 v4, s[24:27], s18 offen offset:0 lds
  v_mfma_f32_32x32x16_bf16 v[56:71], v[108:111], v[112:115], v[56:71]
  buffer_load_dwordx4 v5, s[24:27], s18 offen offset:1024 lds
  s_waitcnt lgkmcnt(2)
  v_mfma_f32_32x32x16_bf16 v[24:39], v[88:91], v[96:99], v[24:39]
  ds_read_b128 v[104:107], v13 offset:49152
  ds_read_b128 v[112:115], v17 offset:49152
  s_waitcnt lgkmcnt(2)
  v_mfma_f32_32x32x16_bf16 v[40:55], v[88:91], v[100:103], v[40:55]
  ds_read_b128 v[108:111], v13 offset:53248
  ds_read_b128 v[116:119], v17 offset:53248
  v_mfma_f32_32x32x16_bf16 v[72:87], v[92:95], v[100:103], v[72:87]
  buffer_load_dwordx4 v6, s[24:27], s18 offen offset:2048 lds
  v_mfma_f32_32x32x16_bf16 v[56:71], v[92:95], v[96:99], v[56:71]
  buffer_load_dwordx4 v7, s[24:27], s18 offen offset:3072 lds
  s_add_u32 s18, s18, 128
  s_waitcnt lgkmcnt(2)
  v_mfma_f32_32x32x16_bf16 v[24:39], v[104:107], v[112:115], v[24:39]
  ds_read_b128 v[88:91], v14 offset:49152
  ds_read_b128 v[96:99], v18 offset:49152
  s_waitcnt lgkmcnt(2)
  v_mfma_f32_32x32x16_bf16 v[40:55], v[104:107], v[116:119], v[40:55]
  ds_read_b128 v[92:95], v14 offset:53248
  ds_read_b128 v[100:103], v18 offset:53248
  v_mfma_f32_32x32x16_bf16 v[72:87], v[108:111], v[116:119], v[72:87]
  s_add_u32 m0, s33, 32768
  s_nop 0
  buffer_load_dwordx4 v8, s[28:31], s19 offen offset:0 lds
  v_mfma_f32_32x32x16_bf16 v[56:71], v[108:111], v[112:115], v[56:71]
  buffer_load_dwordx4 v9, s[28:31], s19 offen offset:1024 lds
  s_waitcnt lgkmcnt(2)
  v_mfma_f32_32x32x16_bf16 v[24:39], v[88:91], v[96:99], v[24:39]
  ds_read_b128 v[104:107], v15 offset:49152
  ds_read_b128 v[112:115], v19 offset:49152
  s_waitcnt lgkmcnt(2)
  v_mfma_f32_32x32x16_bf16 v[40:55], v[88:91], v[100:103], v[40:55]
  ds_read_b128 v[108:111], v15 offset:53248
  ds_read_b128 v[116:119], v19 offset:53248
  v_mfma_f32_32x32x16_bf16 v[72:87], v[92:95], v[100:103], v[72:87]
  buffer_load_dwordx4 v10, s[28:31], s19 offen offset:2048 lds
  v_mfma_f32_32x32x16_bf16 v[56:71], v[92:95], v[96:99], v[56:71]
  buffer_load_dwordx4 v11, s[28:31], s19 offen offset:3072 lds
  s_add_u32 s19, s19, 128
  s_waitcnt vmcnt(16) lgkmcnt(0)
  s_barrier
  v_mfma_f32_32x32x16_bf16 v[24:39], v[104:107], v[112:115], v[24:39]
  ds_read_b128 v[88:91], v12 offset:0
  ds_read_b128 v[96:99], v16 offset:0
  v_mfma_f32_32x32x16_bf16 v[40:55], v[104:107], v[116:119], v[40:55]
  ds_read_b128 v[92:95], v12 offset:4096
  ds_read_b128 v[100:103], v16 offset:4096
  v_mfma_f32_32x32x16_bf16 v[72:87], v[108:111], v[116:119], v[72:87]
  s_add_u32 m0, s32, 49152
  s_nop 0
  buffer_load_dwordx4 v4, s[24:27], s18 offen offset:0 lds
  v_mfma_f32_32x32x16_bf16 v[56:71], v[108:111], v[112:115], v[56:71]
  buffer_load_dwordx4 v5, s[24:27], s18 offen offset:1024 lds
  s_waitcnt lgkmcnt(2)
  v_mfma_f32_32x32x16_bf16 v[24:39], v[88:91], v[96:99], v[24:39]
  ds_read_b128 v[104:107], v13 offset:0
  ds_read_b128 v[112:115], v17 offset:0
  s_waitcnt lgkmcnt(2)
  v_mfma_f32_32x32x16_bf16 v[40:55], v[88:91], v[100:103], v[40:55]
  ds_read_b128 v[108:111], v13 offset:4096
  ds_read_b128 v[116:119], v17 offset:4096
  v_mfma_f32_32x32x16_bf16 v[72:87], v[92:95], v[100:103], v[72:87]
  buffer_load_dwordx4 v6, s[24:27], s18 offen offset:2048 lds
  v_mfma_f32_32x32x16_bf16 v[56:71], v[92:95], v[96:99], v[56:71]
  buffer_load_dwordx4 v7, s[24:27], s18 offen offset:3072 lds
  s_add_u32 s18, s18, 128
  s_waitcnt lgkmcnt(2)
  v_mfma_f32_32x32x16_bf16 v[24:39], v[104:107], v[112:115], v[24:39]
  ds_read_b128 v[88:91], v14 offset:0
  ds_read_b128 v[96:99], v18 offset:0
  s_waitcnt lgkmcnt(2)
  v_mfma_f32_32x32x16_bf16 v[40:55], v[104:107], v[116:119], v[40:55]
  ds_read_b128 v[92:95], v14 offset:4096
  ds_read_b128 v[100:103], v18 offset:4096
  v_mfma_f32_32x32x16_bf16 v[72:87], v[108:111], v[116:119], v[72:87]
  s_add_u32 m0, s33, 49152
  s_nop 0
  buffer_load_dwordx4 v8, s[28:31], s19 offen offset:0 lds
  v_mfma_f32_32x32x16_bf16 v[56:71], v[108:111], v[112:115], v[56:71]
  buffer_load_dwordx4 v9, s[28:31], s19 offen offset:1024 lds
  s_waitcnt lgkmcnt(2)
  v_mfma_f32_32x32x16_bf16 v[24:39], v[88:91], v[96:99], v[24:39]
  ds_read_b128 v[104:107], v15 offset:0
  ds_read_b128 v[112:115], v19 offset:0
  s_waitcnt lgkmcnt(2)
  v_mfma_f32_32x32x16_bf16 v[40:55], v[88:91], v[100:103], v[40:55]
  ds_read_b128 v[108:111], v15 offset:4096
  ds_read_b128 v[116:119], v19 offset:4096
  v_mfma_f32_32x32x16_bf16 v[72:87], v[92:95], v[100:103], v[72:87]
  buffer_load_dwordx4 v10, s[28:31], s19 offen offset:2048 lds
  v_mfma_f32_32x32x16_bf16 v[56:71], v[92:95], v[96:99], v[56:71]
  buffer_load_dwordx4 v11, s[28:31], s19 offen offset:3072 lds
  s_add_u32 s19, s19, 128
  s_waitcnt vmcnt(16) lgkmcnt(0)
  s_barrier
  v_mfma_f32_32x32x16_bf16 v[24:39], v[104:107], v[112:115], v[24:39]
  ds_read_b128 v[88:91], v12 offset:16384
  ds_read_b128 v[96:99], v16 offset:16384
  v_mfma_f32_32x32x16_bf16 v[40:55], v[104:107], v[116:119], v[40:55]
  ds_read_b128 v[92:95], v12 offset:20480
  ds_read_b128 v[100:103], v16 offset:20480
  v_mfma_f32_32x32x16_bf16 v[72:87], v[108:111], v[116:119], v[72:87]
  s_add_u32 m0, s32, 0
  s_nop 0
  buffer_load_dwordx4 v4, s[24:27], s18 offen offset:0 lds
  v_mfma_f32_32x32x16_bf16 v[56:71], v[108:111], v[112:115], v[56:71]
  buffer_load_dwordx4 v5, s[24:27], s18 offen offset:1024 lds
  s_waitcnt lgkmcnt(2)
  v_mfma_f32_32x32x16_bf16 v[24:39], v[88:91], v[96:99], v[24:39]
  ds_read_b128 v[104:107], v13 offset:16384
  ds_read_b128 v[112:115], v17 offset:16384
  s_waitcnt lgkmcnt(2)
  v_mfma_f32_32x32x16_bf16 v[40:55], v[88:91], v[100:103], v[40:55]
  ds_read_b128 v[108:111], v13 offset:20480
  ds_read_b128 v[116:119], v17 offset:20480
  v_mfma_f32_32x32x16_bf16 v[72:87], v[92:95], v[100:103], v[72:87]
  buffer_load_dwordx4 v6, s[24:27], s18 offen offset:2048 lds
  v_mfma_f32_32x32x16_bf16 v[56:71], v[92:95], v[96:99], v[56:71]
  buffer_load_dwordx4 v7, s[24:27], s18 offen offset:3072 lds
  s_add_u32 s18, s18, 128
  s_waitcnt lgkmcnt(2)
  v_mfma_f32_32x32x16_bf16 v[24:39], v[104:107], v[112:115], v[24:39]
  ds_read_b128 v[88:91], v14 offset:16384
  ds_read_b128 v[96:99], v18 offset:16384
  s_waitcnt lgkmcnt(2)
  v_mfma_f32_32x32x16_bf16 v[40:55], v[104:107], v[116:119], v[40:55]
  ds_read_b128 v[92:95], v14 offset:20480
  ds_read_b128 v[100:103], v18 offset:20480
  v_mfma_f32_32x32x16_bf16 v[72:87], v[108:111], v[116:119], v[72:87]
  s_add_u32 m0, s33, 0
  s_nop 0
  buffer_load_dwordx4 v8, s[28:31], s19 offen offset:0 lds
  v_mfma_f32_32x32x16_bf16 v[56:71], v[108:111], v[112:115], v[56:71]
  buffer_load_dwordx4 v9, s[28:31], s19 offen offset:1024 lds
  s_waitcnt lgkmcnt(2)
  v_mfma_f32_32x32x16_bf16 v[24:39], v[88:91], v[96:99], v[24:39]
  ds_read_b128 v[104:107], v15 offset:16384
  ds_read_b128 v[112:115], v19 offset:16384
  s_waitcnt lgkmcnt(2)
  v_mfma_f32_32x32x16_bf16 v[40:55], v[88:91], v[100:103], v[40:55]
  ds_read_b128 v[108:111], v15 offset:20480
  ds_read_b128 v[116:119], v19 offset:20480
  v_mfma_f32_32x32x16_bf16 v[72:87], v[92:95], v[100:103], v[72:87]
  buffer_load_dwordx4 v10, s[28:31], s19 offen offset:2048 lds
  v_mfma_f32_32x32x16_bf16 v[56:71], v[92:95], v[96:99], v[56:71]
  buffer_load_dwordx4 v11, s[28:31], s19 offen offset:3072 lds
  s_add_u32 s19, s19, 128
  s_waitcnt vmcnt(16) lgkmcnt(0)
  s_barrier
  v_mfma_f32_32x32x16_bf16 v[24:39], v[104:107], v[112:115], v[24:39]
  ds_read_b128 v[88:91], v12 offset:32768
  ds_read_b128 v[96:99], v16 offset:32768
  v_mfma_f32_32x32x16_bf16 v[40:55], v[104:107], v[116:119], v[40:55]
  ds_read_b128 v[92:95], v12 offset:36864
  ds_read_b128 v[100:103], v16 offset:36864
  v_mfma_f32_32x32x16_bf16 v[72:87], v[108:111], v[116:119], v[72:87]
  s_add_u32 m0, s32, 16384
  s_nop 0
  buffer_load_dwordx4 v4, s[24:27], s18 offen offset:0 lds
  v_mfma_f32_32x32x16_bf16 v[56:71], v[108:111], v[112:115], v[56:71]
  buffer_load_dwordx4 v5, s[24:27], s18 offen offset:1024 lds
  s_waitcnt lgkmcnt(2)
  v_mfma_f32_32x32x16_bf16 v[24:39], v[88:91], v[96:99], v[24:39]
  ds_read_b128 v[104:107], v13 offset:32768
  ds_read_b128 v[112:115], v17 offset:32768
  s_waitcnt lgkmcnt(2)
  v_mfma_f32_32x32x16_bf16 v[40:55], v[88:91], v[100:103], v[40:55]
  ds_read_b128 v[108:111], v13 offset:36864
  ds_read_b128 v[116:119], v17 offset:36864
  v_mfma_f32_32x32x16_bf16 v[72:87], v[92:95], v[100:103], v[72:87]
  buffer_load_dwordx4 v6, s[24:27], s18 offen offset:2048 lds
  v_mfma_f32_32x32x16_bf16 v[56:71], v[92:95], v[96:99], v[56:71]
  buffer_load_dwordx4 v7, s[24:27], s18 offen offset:3072 lds
  s_add_u32 s18, s18, 128
  s_waitcnt lgkmcnt(2)
  v_mfma_f32_32x32x16_bf16 v[24:39], v[104:107], v[112:115], v[24:39]
  ds_read_b128 v[88:91], v14 offset:32768
  ds_read_b128 v[96:99], v18 offset:32768
  s_waitcnt lgkmcnt(2)
  v_mfma_f32_32x32x16_bf16 v[40:55], v[104:107], v[116:119], v[40:55]
  ds_read_b128 v[92:95], v14 offset:36864
  ds_read_b128 v[100:103], v18 offset:36864
  v_mfma_f32_32x32x16_bf16 v[72:87], v[108:111], v[116:119], v[72:87]
  s_add_u32 m0, s33, 16384
  s_nop 0
  buffer_load_dwordx4 v8, s[28:31], s19 offen offset:0 lds
  v_mfma_f32_32x32x16_bf16 v[56:71], v[108:111], v[112:115], v[56:71]
  buffer_load_dwordx4 v9, s[28:31], s19 offen offset:1024 lds
  s_waitcnt lgkmcnt(2)
  v_mfma_f32_32x32x16_bf16 v[24:39], v[88:91], v[96:99], v[24:39]
  ds_read_b128 v[104:107], v15 offset:32768
  ds_read_b128 v[112:115], v19 offset:32768
  s_waitcnt lgkmcnt(2)
  v_mfma_f32_32x32x16_bf16 v[40:55], v[88:91], v[100:103], v[40:55]
  ds_read_b128 v[108:111], v15 offset:36864
  ds_read_b128 v[116:119], v19 offset:36864
  v_mfma_f32_32x32x16_bf16 v[72:87], v[92:95], v[100:103], v[72:87]
  buffer_load_dwordx4 v10, s[28:31], s19 offen offset:2048 lds
  v_mfma_f32_32x32x16_bf16 v[56:71], v[92:95], v[96:99], v[56:71]
  buffer_load_dwordx4 v11, s[28:31], s19 offen offset:3072 lds
  s_add_u32 s19, s19, 128
  s_waitcnt vmcnt(16) lgkmcnt(0)
  s_barrier
  v_mfma_f32_32x32x16_bf16 v[24:39], v[104:107], v[112:115], v[24:39]
  ds_read_b128 v[88:91], v12 offset:49152
  ds_read_b128 v[96:99], v16 offset:49152
  v_mfma_f32_32x32x16_bf16 v[40:55], v[104:107], v[116:119], v[40:55]
  ds_read_b128 v[92:95], v12 offset:53248
  ds_read_b128 v[100:103], v16 offset:53248
  v_mfma_f32_32x32x16_bf16 v[72:87], v[108:111], v[116:119], v[72:87]
  s_add_u32 m0, s32, 32768
  s_nop 0
  buffer_load_dwordx4 v4, s[24:27], s18 offen offset:0 lds
  v_mfma_f32_32x32x16_bf16 v[56:71], v[108:111], v[112:115], v[56:71]
  buffer_load_dwordx4 v5, s[24:27], s18 offen offset:1024 lds
  s_waitcnt lgkmcnt(2)
  v_mfma_f32_32x32x16_bf16 v[24:39], v[88:91], v[96:99], v[24:39]
  ds_read_b128 v[104:107], v13 offset:49152
  ds_read_b128 v[112:115], v17 offset:49152
  s_waitcnt lgkmcnt(2)
  v_mfma_f32_32x32x16_bf16 v[40:55], v[88:91], v[100:103], v[40:55]
  ds_read_b128 v[108:111], v13 offset:53248
  ds_read_b128 v[116:119], v17 offset:53248
  v_mfma_f32_32x32x16_bf16 v[72:87], v[92:95], v[100:103], v[72:87]
  buffer_load_dwordx4 v6, s[24:27], s18 offen offset:2048 lds
  v_mfma_f32_32x32x16_bf16 v[56:71], v[92:95], v[96:99], v[56:71]
  buffer_load_dwordx4 v7, s[24:27], s18 offen offset:3072 lds
  s_add_u32 s18, s18, 128
  s_waitcnt lgkmcnt(2)
  v_mfma_f32_32x32x16_bf16 v[24:39], v[104:107], v[112:115], v[24:39]
  ds_read_b128 v[88:91], v14 offset:49152
  ds_read_b128 v[96:99], v18 offset:49152
  s_waitcnt lgkmcnt(2)
  v_mfma_f32_32x32x16_bf16 v[40:55], v[104:107], v[116:119], v[40:55]
  ds_read_b128 v[92:95], v14 offset:53248
  ds_read_b128 v[100:103], v18 offset:53248
  v_mfma_f32_32x32x16_bf16 v[72:87], v[108:111], v[116:119], v[72:87]
  s_add_u32 m0, s33, 32768
  s_nop 0
  buffer_load_dwordx4 v8, s[28:31], s19 offen offset:0 lds
  v_mfma_f32_32x32x16_bf16 v[56:71], v[108:111], v[112:115], v[56:71]
  buffer_load_dwordx4 v9, s[28:31], s19 offen offset:1024 lds
  s_waitcnt lgkmcnt(2)
  v_mfma_f32_32x32x16_bf16 v[24:39], v[88:91], v[96:99], v[24:39]
  ds_read_b128 v[104:107], v15 offset:49152
  ds_read_b128 v[112:115], v19 offset:49152
  s_waitcnt lgkmcnt(2)
  v_mfma_f32_32x32x16_bf16 v[40:55], v[88:91], v[100:103], v[40:55]
  ds_read_b128 v[108:111], v15 offset:53248
  ds_read_b128 v[116:119], v19 offset:53248
  v_mfma_f32_32x32x16_bf16 v[72:87], v[92:95], v[100:103], v[72:87]
  buffer_load_dwordx4 v10, s[28:31], s19 offen offset:2048 lds
  v_mfma_f32_32x32x16_bf16 v[56:71], v[92:95], v[96:99], v[56:71]
  buffer_load_dwordx4 v11, s[28:31], s19 offen offset:3072 lds
  s_add_u32 s19, s19, 128
  s_waitcnt vmcnt(16) lgkmcnt(0)
  s_barrier
  v_mfma_f32_32x32x16_bf16 v[24:39], v[104:107], v[112:115], v[24:39]
  ds_read_b128 v[88:91], v12 offset:0
  ds_read_b128 v[96:99], v16 offset:0
  v_mfma_f32_32x32x16_bf16 v[40:55], v[104:107], v[116:119], v[40:55]
  ds_read_b128 v[92:95], v12 offset:4096
  ds_read_b128 v[100:103], v16 offset:4096
  v_mfma_f32_32x32x16_bf16 v[72:87], v[108:111], v[116:119], v[72:87]
  s_add_u32 m0, s32, 49152
  s_nop 0
  buffer_load_dwordx4 v4, s[24:27], s18 offen offset:0 lds
  v_mfma_f32_32x32x16_bf16 v[56:71], v[108:111], v[112:115], v[56:71]
  buffer_load_dwordx4 v5, s[24:27], s18 offen offset:1024 lds
  s_waitcnt lgkmcnt(2)
  v_mfma_f32_32x32x16_bf16 v[24:39], v[88:91], v[96:99], v[24:39]
  ds_read_b128 v[104:107], v13 offset:0
  ds_read_b128 v[112:115], v17 offset:0
  s_waitcnt lgkmcnt(2)
  v_mfma_f32_32x32x16_bf16 v[40:55], v[88:91], v[100:103], v[40:55]
  ds_read_b128 v[108:111], v13 offset:4096
  ds_read_b128 v[116:119], v17 offset:4096
  v_mfma_f32_32x32x16_bf16 v[72:87], v[92:95], v[100:103], v[72:87]
  buffer_load_dwordx4 v6, s[24:27], s18 offen offset:2048 lds
  v_mfma_f32_32x32x16_bf16 v[56:71], v[92:95], v[96:99], v[56:71]
  buffer_load_dwordx4 v7, s[24:27], s18 offen offset:3072 lds
  s_add_u32 s18, s18, 128
  s_waitcnt lgkmcnt(2)
  v_mfma_f32_32x32x16_bf16 v[24:39], v[104:107], v[112:115], v[24:39]
  ds_read_b128 v[88:91], v14 offset:0
  ds_read_b128 v[96:99], v18 offset:0
  s_waitcnt lgkmcnt(2)
  v_mfma_f32_32x32x16_bf16 v[40:55], v[104:107], v[116:119], v[40:55]
  ds_read_b128 v[92:95], v14 offset:4096
  ds_read_b128 v[100:103], v18 offset:4096
  v_mfma_f32_32x32x16_bf16 v[72:87], v[108:111], v[116:119], v[72:87]
  s_add_u32 m0, s33, 49152
  s_nop 0
  buffer_load_dwordx4 v8, s[28:31], s19 offen offset:0 lds
  v_mfma_f32_32x32x16_bf16 v[56:71], v[108:111], v[112:115], v[56:71]
  buffer_load_dwordx4 v9, s[28:31], s19 offen offset:1024 lds
  s_waitcnt lgkmcnt(2)
  v_mfma_f32_32x32x16_bf16 v[24:39], v[88:91], v[96:99], v[24:39]
  ds_read_b128 v[104:107], v15 offset:0
  ds_read_b128 v[112:115], v19 offset:0
  s_waitcnt lgkmcnt(2)
  v_mfma_f32_32x32x16_bf16 v[40:55], v[88:91], v[100:103], v[40:55]
  ds_read_b128 v[108:111], v15 offset:4096
  ds_read_b128 v[116:119], v19 offset:4096
  v_mfma_f32_32x32x16_bf16 v[72:87], v[92:95], v[100:103], v[72:87]
  buffer_load_dwordx4 v10, s[28:31], s19 offen offset:2048 lds
  v_mfma_f32_32x32x16_bf16 v[56:71], v[92:95], v[96:99], v[56:71]
  buffer_load_dwordx4 v11, s[28:31], s19 offen offset:3072 lds
  s_add_u32 s19, s19, 128
  s_waitcnt vmcnt(16) lgkmcnt(0)
  s_barrier
  v_mfma_f32_32x32x16_bf16 v[24:39], v[104:107], v[112:115], v[24:39]
  ds_read_b128 v[88:91], v12 offset:16384
  ds_read_b128 v[96:99], v16 offset:16384
  v_mfma_f32_32x32x16_bf16 v[40:55], v[104:107], v[116:119], v[40:55]
  ds_read_b128 v[92:95], v12 offset:20480
  ds_read_b128 v[100:103], v16 offset:20480
  v_mfma_f32_32x32x16_bf16 v[72:87], v[108:111], v[116:119], v[72:87]
  v_mfma_f32_32x32x16_bf16 v[56:71], v[108:111], v[112:115], v[56:71]
  s_waitcnt lgkmcnt(2)
  v_mfma_f32_32x32x16_bf16 v[24:39], v[88:91], v[96:99], v[24:39]
  ds_read_b128 v[104:107], v13 offset:16384
  ds_read_b128 v[112:115], v17 offset:16384
  s_waitcnt lgkmcnt(2)
  v_mfma_f32_32x32x16_bf16 v[40:55], v[88:91], v[100:103], v[40:55]
  ds_read_b128 v[108:111], v13 offset:20480
  ds_read_b128 v[116:119], v17 offset:20480
  v_mfma_f32_32x32x16_bf16 v[72:87], v[92:95], v[100:103], v[72:87]
  v_mfma_f32_32x32x16_bf16 v[56:71], v[92:95], v[96:99], v[56:71]
  s_waitcnt lgkmcnt(2)
  v_mfma_f32_32x32x16_bf16 v[24:39], v[104:107], v[112:115], v[24:39]
  ds_read_b128 v[88:91], v14 offset:16384
  ds_read_b128 v[96:99], v18 offset:16384
  s_waitcnt lgkmcnt(2)
  v_mfma_f32_32x32x16_bf16 v[40:55], v[104:107], v[116:119], v[40:55]
  ds_read_b128 v[92:95], v14 offset:20480
  ds_read_b128 v[100:103], v18 offset:20480
  v_mfma_f32_32x32x16_bf16 v[72:87], v[108:111], v[116:119], v[72:87]
  v_mfma_f32_32x32x16_bf16 v[56:71], v[108:111], v[112:115], v[56:71]
  s_waitcnt lgkmcnt(2)
  v_mfma_f32_32x32x16_bf16 v[24:39], v[88:91], v[96:99], v[24:39]
  ds_read_b128 v[104:107], v15 offset:16384
  ds_read_b128 v[112:115], v19 offset:16384
  s_waitcnt lgkmcnt(2)
  v_mfma_f32_32x32x16_bf16 v[40:55], v[88:91], v[100:103], v[40:55]
  ds_read_b128 v[108:111], v15 offset:20480
  ds_read_b128 v[116:119], v19 offset:20480
  v_mfma_f32_32x32x16_bf16 v[72:87], v[92:95], v[100:103], v[72:87]
  v_mfma_f32_32x32x16_bf16 v[56:71], v[92:95], v[96:99], v[56:71]
  s_waitcnt vmcnt(8) lgkmcnt(0)
  s_barrier
  v_mfma_f32_32x32x16_bf16 v[24:39], v[104:107], v[112:115], v[24:39]
  ds_read_b128 v[88:91], v12 offset:32768
  ds_read_b128 v[96:99], v16 offset:32768
  v_mfma_f32_32x32x16_bf16 v[40:55], v[104:107], v[116:119], v[40:55]
  ds_read_b128 v[92:95], v12 offset:36864
  ds_read_b128 v[100:103], v16 offset:36864
  v_mfma_f32_32x32x16_bf16 v[72:87], v[108:111], v[116:119], v[72:87]
  v_mfma_f32_32x32x16_bf16 v[56:71], v[108:111], v[112:115], v[56:71]
  s_waitcnt lgkmcnt(2)
  v_mfma_f32_32x32x16_bf16 v[24:39], v[88:91], v[96:99], v[24:39]
  ds_read_b128 v[104:107], v13 offset:32768
  ds_read_b128 v[112:115], v17 offset:32768
  s_waitcnt lgkmcnt(2)
  v_mfma_f32_32x32x16_bf16 v[40:55], v[88:91], v[100:103], v[40:55]
  ds_read_b128 v[108:111], v13 offset:36864
  ds_read_b128 v[116:119], v17 offset:36864
  v_mfma_f32_32x32x16_bf16 v[72:87], v[92:95], v[100:103], v[72:87]
  v_mfma_f32_32x32x16_bf16 v[56:71], v[92:95], v[96:99], v[56:71]
  s_waitcnt lgkmcnt(2)
  v_mfma_f32_32x32x16_bf16 v[24:39], v[104:107], v[112:115], v[24:39]
  ds_read_b128 v[88:91], v14 offset:32768
  ds_read_b128 v[96:99], v18 offset:32768
  s_waitcnt lgkmcnt(2)
  v_mfma_f32_32x32x16_bf16 v[40:55], v[104:107], v[116:119], v[40:55]
  ds_read_b128 v[92:95], v14 offset:36864
  ds_read_b128 v[100:103], v18 offset:36864
  v_mfma_f32_32x32x16_bf16 v[72:87], v[108:111], v[116:119], v[72:87]
  v_mfma_f32_32x32x16_bf16 v[56:71], v[108:111], v[112:115], v[56:71]
  s_waitcnt lgkmcnt(2)
  v_mfma_f32_32x32x16_bf16 v[24:39], v[88:91], v[96:99], v[24:39]
  ds_read_b128 v[104:107], v15 offset:32768
  ds_read_b128 v[112:115], v19 offset:32768
  s_waitcnt lgkmcnt(2)
  v_mfma_f32_32x32x16_bf16 v[40:55], v[88:91], v[100:103], v[40:55]
  ds_read_b128 v[108:111], v15 offset:36864
  ds_read_b128 v[116:119], v19 offset:36864
  v_mfma_f32_32x32x16_bf16 v[72:87], v[92:95], v[100:103], v[72:87]
  v_mfma_f32_32x32x16_bf16 v[56:71], v[92:95], v[96:99], v[56:71]
  s_waitcnt vmcnt(0) lgkmcnt(0)
  s_barrier
  v_mfma_f32_32x32x16_bf16 v[24:39], v[104:107], v[112:115], v[24:39]
  ds_read_b128 v[88:91], v12 offset:49152
  ds_read_b128 v[96:99], v16 offset:49152
  v_mfma_f32_32x32x16_bf16 v[40:55], v[104:107], v[116:119], v[40:55]
  ds_read_b128 v[92:95], v12 offset:53248
  ds_read_b128 v[100:103], v16 offset:53248
  v_mfma_f32_32x32x16_bf16 v[72:87], v[108:111], v[116:119], v[72:87]
  v_mfma_f32_32x32x16_bf16 v[56:71], v[108:111], v[112:115], v[56:71]
  s_waitcnt lgkmcnt(2)
  v_mfma_f32_32x32x16_bf16 v[24:39], v[88:91], v[96:99], v[24:39]
  ds_read_b128 v[104:107], v13 offset:49152
  ds_read_b128 v[112:115], v17 offset:49152
  s_waitcnt lgkmcnt(2)
  v_mfma_f32_32x32x16_bf16 v[40:55], v[88:91], v[100:103], v[40:55]
  ds_read_b128 v[108:111], v13 offset:53248
  ds_read_b128 v[116:119], v17 offset:53248
  v_mfma_f32_32x32x16_bf16 v[72:87], v[92:95], v[100:103], v[72:87]
  v_mfma_f32_32x32x16_bf16 v[56:71], v[92:95], v[96:99], v[56:71]
  s_waitcnt lgkmcnt(2)
  v_mfma_f32_32x32x16_bf16 v[24:39], v[104:107], v[112:115], v[24:39]
  ds_read_b128 v[88:91], v14 offset:49152
  ds_read_b128 v[96:99], v18 offset:49152
  s_waitcnt lgkmcnt(2)
  v_mfma_f32_32x32x16_bf16 v[40:55], v[104:107], v[116:119], v[40:55]
  ds_read_b128 v[92:95], v14 offset:53248
  ds_read_b128 v[100:103], v18 offset:53248
  v_mfma_f32_32x32x16_bf16 v[72:87], v[108:111], v[116:119], v[72:87]
  v_mfma_f32_32x32x16_bf16 v[56:71], v[108:111], v[112:115], v[56:71]
  s_waitcnt lgkmcnt(2)
  v_mfma_f32_32x32x16_bf16 v[24:39], v[88:91], v[96:99], v[24:39]
  ds_read_b128 v[104:107], v15 offset:49152
  ds_read_b128 v[112:115], v19 offset:49152
  s_waitcnt lgkmcnt(2)
  v_mfma_f32_32x32x16_bf16 v[40:55], v[88:91], v[100:103], v[40:55]
  ds_read_b128 v[108:111], v15 offset:53248
  ds_read_b128 v[116:119], v19 offset:53248
  v_mfma_f32_32x32x16_bf16 v[72:87], v[92:95], v[100:103], v[72:87]
  v_mfma_f32_32x32x16_bf16 v[56:71], v[92:95], v[96:99], v[56:71]
  s_waitcnt lgkmcnt(2)
  v_mfma_f32_32x32x16_bf16 v[24:39], v[104:107], v[112:115], v[24:39]
  s_waitcnt lgkmcnt(0)
  v_mfma_f32_32x32x16_bf16 v[40:55], v[104:107], v[116:119], v[40:55]
  v_mfma_f32_32x32x16_bf16 v[72:87], v[108:111], v[116:119], v[72:87]
  v_mfma_f32_32x32x16_bf16 v[56:71], v[108:111], v[112:115], v[56:71]
  v_lshlrev_b32 v20, 16, v20
  v_lshlrev_b32 v21, 16, v21
  v_lshlrev_b32 v22, 16, v22
  v_mul_f32 v22, 0x3fb8aa3b, v22
  v_exp_f32 v22, v22
  s_nop 0
  v_cvt_pk_bf16_f32 v22, v22, v22
  v_and_b32 v22, 0xffff0000, v22
  v_mul_f32 v16, v22, v20
  v_mul_f32 v17, v22, v21
  v_mul_f32 v16, 0x3fb8aa3b, v16
  v_mul_f32 v17, 0.15915494, v17
  v_exp_f32 v16, v16
  v_rndne_f32 v18, v17
  v_sub_f32 v17, v17, v18
  v_cos_f32 v18, v17
  v_sin_f32 v19, v17
  v_mul_f32 v4, v16, v18
  v_mul_f32 v5, v16, v19
  v_mul_f32 v16, v20, v20
  v_fma_f32 v16, v21, v21, v16
  v_rcp_f32 v16, v16
  v_add_f32 v17, -1.0, v4
  v_add_f32 v16, v16, v16
  v_mul_f32 v18, v17, v20
  v_fma_f32 v18, v5, v21, v18
  v_mul_f32 v19, v5, v20
  v_fma_f32 v19, -v17, v21, v19
  v_mul_f32 v14, v18, v16
  v_mul_f32 v15, v19, v16
  v_mul_f32 v16, v5, v5
  v_mul_f32 v7, v4, v5
  v_fma_f32 v6, v4, v4, -v16
  v_add_f32 v7, v7, v7
  v_mul_f32 v16, v7, v7
  v_mul_f32 v7, v6, v7
  v_fma_f32 v6, v6, v6, -v16
  v_add_f32 v7, v7, v7
  v_mul_f32 v16, v7, v7
  v_mul_f32 v7, v6, v7
  v_fma_f32 v6, v6, v6, -v16
  v_add_f32 v7, v7, v7
  v_mul_f32 v16, v7, v7
  v_mul_f32 v7, v6, v7
  v_fma_f32 v6, v6, v6, -v16
  v_add_f32 v7, v7, v7
  v_mul_f32 v16, v7, v7
  v_mul_f32 v9, v6, v7
  v_fma_f32 v8, v6, v6, -v16
  v_add_f32 v9, v9, v9
  v_mul_f32 v16, v9, v9
  v_mul_f32 v11, v8, v9
  v_fma_f32 v10, v8, v8, -v16
  v_add_f32 v11, v11, v11
  v_mul_f32 v16, v11, v11
  v_mul_f32 v13, v10, v11
  v_fma_f32 v12, v10, v10, -v16
  v_add_f32 v13, v13, v13
  v_mul_f32 v16, v13, v13
  v_mul_f32 v13, v12, v13
  v_fma_f32 v12, v12, v12, -v16
  v_add_f32 v13, v13, v13
  v_mul_f32 v16, v13, v13
  v_mul_f32 v13, v12, v13
  v_fma_f32 v12, v12, v12, -v16
  v_add_f32 v13, v13, v13
  v_mul_f32 v16, v13, v13
  v_mul_f32 v13, v12, v13
  v_fma_f32 v12, v12, v12, -v16
  v_add_f32 v13, v13, v13
  v_pk_fma_f32 v[16:17], v[4:5], v[24:25], v[26:27] op_sel:[0,0,0] op_sel_hi:[0,1,1]
  v_pk_fma_f32 v[18:19], v[4:5], v[40:41], v[42:43] op_sel:[0,0,0] op_sel_hi:[0,1,1]
  v_pk_fma_f32 v[16:17], v[4:5], v[40:41], v[16:17] op_sel:[1,0,0] op_sel_hi:[1,1,1] neg_lo:[1,0,0] neg_hi:[1,0,0]
  v_pk_fma_f32 v[18:19], v[4:5], v[24:25], v[18:19] op_sel:[1,0,0] op_sel_hi:[1,1,1]
  v_pk_fma_f32 v[20:21], v[4:5], v[16:17], v[28:29] op_sel:[0,0,0] op_sel_hi:[0,1,1]
  v_pk_fma_f32 v[22:23], v[4:5], v[18:19], v[44:45] op_sel:[0,0,0] op_sel_hi:[0,1,1]
  v_pk_fma_f32 v[20:21], v[4:5], v[18:19], v[20:21] op_sel:[1,0,0] op_sel_hi:[1,1,1] neg_lo:[1,0,0] neg_hi:[1,0,0]
  v_pk_fma_f32 v[22:23], v[4:5], v[16:17], v[22:23] op_sel:[1,0,0] op_sel_hi:[1,1,1]
  v_pk_fma_f32 v[16:17], v[4:5], v[20:21], v[30:31] op_sel:[0,0,0] op_sel_hi:[0,1,1]
  v_pk_fma_f32 v[18:19], v[4:5], v[22:23], v[46:47] op_sel:[0,0,0] op_sel_hi:[0,1,1]
  v_pk_fma_f32 v[16:17], v[4:5], v[22:23], v[16:17] op_sel:[1,0,0] op_sel_hi:[1,1,1] neg_lo:[1,0,0] neg_hi:[1,0,0]
  v_pk_fma_f32 v[18:19], v[4:5], v[20:21], v[18:19] op_sel:[1,0,0] op_sel_hi:[1,1,1]
  v_pk_fma_f32 v[20:21], v[4:5], v[16:17], v[32:33] op_sel:[0,0,0] op_sel_hi:[0,1,1]
  v_pk_fma_f32 v[22:23], v[4:5], v[18:19], v[48:49] op_sel:[0,0,0] op_sel_hi:[0,1,1]
  v_pk_fma_f32 v[20:21], v[4:5], v[18:19], v[20:21] op_sel:[1,0,0] op_sel_hi:[1,1,1] neg_lo:[1,0,0] neg_hi:[1,0,0]
  v_pk_fma_f32 v[22:23], v[4:5], v[16:17], v[22:23] op_sel:[1,0,0] op_sel_hi:[1,1,1]
  v_pk_fma_f32 v[16:17], v[4:5], v[20:21], v[34:35] op_sel:[0,0,0] op_sel_hi:[0,1,1]
  v_pk_fma_f32 v[18:19], v[4:5], v[22:23], v[50:51] op_sel:[0,0,0] op_sel_hi:[0,1,1]
  v_pk_fma_f32 v[16:17], v[4:5], v[22:23], v[16:17] op_sel:[1,0,0] op_sel_hi:[1,1,1] neg_lo:[1,0,0] neg_hi:[1,0,0]
  v_pk_fma_f32 v[18:19], v[4:5], v[20:21], v[18:19] op_sel:[1,0,0] op_sel_hi:[1,1,1]
  v_pk_fma_f32 v[20:21], v[4:5], v[16:17], v[36:37] op_sel:[0,0,0] op_sel_hi:[0,1,1]
  v_pk_fma_f32 v[22:23], v[4:5], v[18:19], v[52:53] op_sel:[0,0,0] op_sel_hi:[0,1,1]
  v_pk_fma_f32 v[20:21], v[4:5], v[18:19], v[20:21] op_sel:[1,0,0] op_sel_hi:[1,1,1] neg_lo:[1,0,0] neg_hi:[1,0,0]
  v_pk_fma_f32 v[22:23], v[4:5], v[16:17], v[22:23] op_sel:[1,0,0] op_sel_hi:[1,1,1]
  v_pk_fma_f32 v[16:17], v[4:5], v[20:21], v[38:39] op_sel:[0,0,0] op_sel_hi:[0,1,1]
  v_pk_fma_f32 v[18:19], v[4:5], v[22:23], v[54:55] op_sel:[0,0,0] op_sel_hi:[0,1,1]
  v_pk_fma_f32 v[16:17], v[4:5], v[22:23], v[16:17] op_sel:[1,0,0] op_sel_hi:[1,1,1] neg_lo:[1,0,0] neg_hi:[1,0,0]
  v_pk_fma_f32 v[18:19], v[4:5], v[20:21], v[18:19] op_sel:[1,0,0] op_sel_hi:[1,1,1]
  v_pk_fma_f32 v[20:21], v[4:5], v[16:17], v[56:57] op_sel:[0,0,0] op_sel_hi:[0,1,1]
  v_pk_fma_f32 v[22:23], v[4:5], v[18:19], v[72:73] op_sel:[0,0,0] op_sel_hi:[0,1,1]
  v_pk_fma_f32 v[20:21], v[4:5], v[18:19], v[20:21] op_sel:[1,0,0] op_sel_hi:[1,1,1] neg_lo:[1,0,0] neg_hi:[1,0,0]
  v_pk_fma_f32 v[22:23], v[4:5], v[16:17], v[22:23] op_sel:[1,0,0] op_sel_hi:[1,1,1]
  v_pk_fma_f32 v[16:17], v[4:5], v[20:21], v[58:59] op_sel:[0,0,0] op_sel_hi:[0,1,1]
  v_pk_fma_f32 v[18:19], v[4:5], v[22:23], v[74:75] op_sel:[0,0,0] op_sel_hi:[0,1,1]
  v_pk_fma_f32 v[16:17], v[4:5], v[22:23], v[16:17] op_sel:[1,0,0] op_sel_hi:[1,1,1] neg_lo:[1,0,0] neg_hi:[1,0,0]
  v_pk_fma_f32 v[18:19], v[4:5], v[20:21], v[18:19] op_sel:[1,0,0] op_sel_hi:[1,1,1]
  v_pk_fma_f32 v[20:21], v[4:5], v[16:17], v[60:61] op_sel:[0,0,0] op_sel_hi:[0,1,1]
  v_pk_fma_f32 v[22:23], v[4:5], v[18:19], v[76:77] op_sel:[0,0,0] op_sel_hi:[0,1,1]
  v_pk_fma_f32 v[20:21], v[4:5], v[18:19], v[20:21] op_sel:[1,0,0] op_sel_hi:[1,1,1] neg_lo:[1,0,0] neg_hi:[1,0,0]
  v_pk_fma_f32 v[22:23], v[4:5], v[16:17], v[22:23] op_sel:[1,0,0] op_sel_hi:[1,1,1]
  v_pk_fma_f32 v[16:17], v[4:5], v[20:21], v[62:63] op_sel:[0,0,0] op_sel_hi:[0,1,1]
  v_pk_fma_f32 v[18:19], v[4:5], v[22:23], v[78:79] op_sel:[0,0,0] op_sel_hi:[0,1,1]
  v_pk_fma_f32 v[16:17], v[4:5], v[22:23], v[16:17] op_sel:[1,0,0] op_sel_hi:[1,1,1] neg_lo:[1,0,0] neg_hi:[1,0,0]
  v_pk_fma_f32 v[18:19], v[4:5], v[20:21], v[18:19] op_sel:[1,0,0] op_sel_hi:[1,1,1]
  v_pk_fma_f32 v[20:21], v[4:5], v[16:17], v[64:65] op_sel:[0,0,0] op_sel_hi:[0,1,1]
  v_pk_fma_f32 v[22:23], v[4:5], v[18:19], v[80:81] op_sel:[0,0,0] op_sel_hi:[0,1,1]
  v_pk_fma_f32 v[20:21], v[4:5], v[18:19], v[20:21] op_sel:[1,0,0] op_sel_hi:[1,1,1] neg_lo:[1,0,0] neg_hi:[1,0,0]
  v_pk_fma_f32 v[22:23], v[4:5], v[16:17], v[22:23] op_sel:[1,0,0] op_sel_hi:[1,1,1]
  v_pk_fma_f32 v[16:17], v[4:5], v[20:21], v[66:67] op_sel:[0,0,0] op_sel_hi:[0,1,1]
  v_pk_fma_f32 v[18:19], v[4:5], v[22:23], v[82:83] op_sel:[0,0,0] op_sel_hi:[0,1,1]
  v_pk_fma_f32 v[16:17], v[4:5], v[22:23], v[16:17] op_sel:[1,0,0] op_sel_hi:[1,1,1] neg_lo:[1,0,0] neg_hi:[1,0,0]
  v_pk_fma_f32 v[18:19], v[4:5], v[20:21], v[18:19] op_sel:[1,0,0] op_sel_hi:[1,1,1]
  v_pk_fma_f32 v[20:21], v[4:5], v[16:17], v[68:69] op_sel:[0,0,0] op_sel_hi:[0,1,1]
  v_pk_fma_f32 v[22:23], v[4:5], v[18:19], v[84:85] op_sel:[0,0,0] op_sel_hi:[0,1,1]
  v_pk_fma_f32 v[20:21], v[4:5], v[18:19], v[20:21] op_sel:[1,0,0] op_sel_hi:[1,1,1] neg_lo:[1,0,0] neg_hi:[1,0,0]
  v_pk_fma_f32 v[22:23], v[4:5], v[16:17], v[22:23] op_sel:[1,0,0] op_sel_hi:[1,1,1]
  v_pk_fma_f32 v[16:17], v[4:5], v[20:21], v[70:71] op_sel:[0,0,0] op_sel_hi:[0,1,1]
  v_pk_fma_f32 v[18:19], v[4:5], v[22:23], v[86:87] op_sel:[0,0,0] op_sel_hi:[0,1,1]
  v_pk_fma_f32 v[16:17], v[4:5], v[22:23], v[16:17] op_sel:[1,0,0] op_sel_hi:[1,1,1] neg_lo:[1,0,0] neg_hi:[1,0,0]
  v_pk_fma_f32 v[18:19], v[4:5], v[20:21], v[18:19] op_sel:[1,0,0] op_sel_hi:[1,1,1]
  v_fma_f32 v20, v6, v16, v17
  v_fma_f32 v21, v6, v18, v19
  v_fma_f32 v20, -v7, v18, v20
  v_fma_f32 v21, v7, v16, v21
  v_mov_b32 v22, v20
  v_mov_b32 v23, v21
  s_nop 0
  v_permlane32_swap_b32 v20, v22
  v_permlane32_swap_b32 v21, v23
  v_fma_f32 v22, v8, v20, v22
  v_fma_f32 v23, v8, v21, v23
  v_fma_f32 v22, -v9, v21, v22
  v_fma_f32 v23, v9, v20, v23
  v_min_u32 v22, -2, v22
  v_min_u32 v23, -2, v23
  s_lshl_b32 s18, s20, 1
  s_lshr_b32 s19, s3, 1
  s_add_u32 s18, s18, s19
  s_sub_u32 s18, 31, s18
  s_lshl_b32 s18, s18, 9
  s_and_b32 s19, s3, 1
  s_lshl_b32 s19, s19, 8
  s_add_u32 s18, s18, s19
  v_and_b32 v88, 31, v1
  v_lshl_add_u32 v88, v88, 3, s18
  s_mov_b32 exec_hi, 0
  buffer_store_dwordx2 v[22:23], v88, s[48:51], 0 offen sc1
  s_mov_b64 exec, -1
  v_lshrrev_b32 v89, 5, v1
  v_lshl_add_u32 v88, v89, 13, v88
  v_add_u32 v88, 512, v88
  v_pk_mul_f32 v[94:95], v[14:15], v[24:25] op_sel:[1,0] op_sel_hi:[1,1]
  v_pk_mul_f32 v[24:25], v[14:15], v[24:25] op_sel:[0,0] op_sel_hi:[0,1]
  v_pk_fma_f32 v[24:25], v[14:15], v[40:41], v[24:25] op_sel:[1,0,0] op_sel_hi:[1,1,1] neg_lo:[1,0,0] neg_hi:[1,0,0]
  v_pk_fma_f32 v[40:41], v[14:15], v[40:41], v[94:95] op_sel:[0,0,0] op_sel_hi:[0,1,1]
  v_pk_mul_f32 v[92:93], v[14:15], v[26:27] op_sel:[1,0] op_sel_hi:[1,1]
  v_pk_mul_f32 v[26:27], v[14:15], v[26:27] op_sel:[0,0] op_sel_hi:[0,1]
  v_pk_fma_f32 v[26:27], v[14:15], v[42:43], v[26:27] op_sel:[1,0,0] op_sel_hi:[1,1,1] neg_lo:[1,0,0] neg_hi:[1,0,0]
  v_pk_fma_f32 v[42:43], v[14:15], v[42:43], v[92:93] op_sel:[0,0,0] op_sel_hi:[0,1,1]
  v_pk_mul_f32 v[94:95], v[14:15], v[28:29] op_sel:[1,0] op_sel_hi:[1,1]
  v_pk_mul_f32 v[28:29], v[14:15], v[28:29] op_sel:[0,0] op_sel_hi:[0,1]
  v_pk_fma_f32 v[28:29], v[14:15], v[44:45], v[28:29] op_sel:[1,0,0] op_sel_hi:[1,1,1] neg_lo:[1,0,0] neg_hi:[1,0,0]
  v_pk_fma_f32 v[44:45], v[14:15], v[44:45], v[94:95] op_sel:[0,0,0] op_sel_hi:[0,1,1]
  v_pk_mul_f32 v[92:93], v[14:15], v[30:31] op_sel:[1,0] op_sel_hi:[1,1]
  v_pk_mul_f32 v[30:31], v[14:15], v[30:31] op_sel:[0,0] op_sel_hi:[0,1]
  v_pk_fma_f32 v[30:31], v[14:15], v[46:47], v[30:31] op_sel:[1,0,0] op_sel_hi:[1,1,1] neg_lo:[1,0,0] neg_hi:[1,0,0]
  v_pk_fma_f32 v[46:47], v[14:15], v[46:47], v[92:93] op_sel:[0,0,0] op_sel_hi:[0,1,1]
  v_pk_mul_f32 v[94:95], v[14:15], v[32:33] op_sel:[1,0] op_sel_hi:[1,1]
  v_pk_mul_f32 v[32:33], v[14:15], v[32:33] op_sel:[0,0] op_sel_hi:[0,1]
  v_pk_fma_f32 v[32:33], v[14:15], v[48:49], v[32:33] op_sel:[1,0,0] op_sel_hi:[1,1,1] neg_lo:[1,0,0] neg_hi:[1,0,0]
  v_pk_fma_f32 v[48:49], v[14:15], v[48:49], v[94:95] op_sel:[0,0,0] op_sel_hi:[0,1,1]
  v_pk_mul_f32 v[92:93], v[14:15], v[34:35] op_sel:[1,0] op_sel_hi:[1,1]
  v_pk_mul_f32 v[34:35], v[14:15], v[34:35] op_sel:[0,0] op_sel_hi:[0,1]
  v_pk_fma_f32 v[34:35], v[14:15], v[50:51], v[34:35] op_sel:[1,0,0] op_sel_hi:[1,1,1] neg_lo:[1,0,0] neg_hi:[1,0,0]
  v_pk_fma_f32 v[50:51], v[14:15], v[50:51], v[92:93] op_sel:[0,0,0] op_sel_hi:[0,1,1]
  v_pk_mul_f32 v[94:95], v[14:15], v[36:37] op_sel:[1,0] op_sel_hi:[1,1]
  v_pk_mul_f32 v[36:37], v[14:15], v[36:37] op_sel:[0,0] op_sel_hi:[0,1]
  v_pk_fma_f32 v[36:37], v[14:15], v[52:53], v[36:37] op_sel:[1,0,0] op_sel_hi:[1,1,1] neg_lo:[1,0,0] neg_hi:[1,0,0]
  v_pk_fma_f32 v[52:53], v[14:15], v[52:53], v[94:95] op_sel:[0,0,0] op_sel_hi:[0,1,1]
  v_pk_mul_f32 v[92:93], v[14:15], v[38:39] op_sel:[1,0] op_sel_hi:[1,1]
  v_pk_mul_f32 v[38:39], v[14:15], v[38:39] op_sel:[0,0] op_sel_hi:[0,1]
  v_pk_fma_f32 v[38:39], v[14:15], v[54:55], v[38:39] op_sel:[1,0,0] op_sel_hi:[1,1,1] neg_lo:[1,0,0] neg_hi:[1,0,0]
  v_pk_fma_f32 v[54:55], v[14:15], v[54:55], v[92:93] op_sel:[0,0,0] op_sel_hi:[0,1,1]
  v_pk_mul_f32 v[94:95], v[14:15], v[56:57] op_sel:[1,0] op_sel_hi:[1,1]
  v_pk_mul_f32 v[56:57], v[14:15], v[56:57] op_sel:[0,0] op_sel_hi:[0,1]
  v_pk_fma_f32 v[56:57], v[14:15], v[72:73], v[56:57] op_sel:[1,0,0] op_sel_hi:[1,1,1] neg_lo:[1,0,0] neg_hi:[1,0,0]
  v_pk_fma_f32 v[72:73], v[14:15], v[72:73], v[94:95] op_sel:[0,0,0] op_sel_hi:[0,1,1]
  v_pk_mul_f32 v[92:93], v[14:15], v[58:59] op_sel:[1,0] op_sel_hi:[1,1]
  v_pk_mul_f32 v[58:59], v[14:15], v[58:59] op_sel:[0,0] op_sel_hi:[0,1]
  v_pk_fma_f32 v[58:59], v[14:15], v[74:75], v[58:59] op_sel:[1,0,0] op_sel_hi:[1,1,1] neg_lo:[1,0,0] neg_hi:[1,0,0]
  v_pk_fma_f32 v[74:75], v[14:15], v[74:75], v[92:93] op_sel:[0,0,0] op_sel_hi:[0,1,1]
  v_pk_mul_f32 v[94:95], v[14:15], v[60:61] op_sel:[1,0] op_sel_hi:[1,1]
  v_pk_mul_f32 v[60:61], v[14:15], v[60:61] op_sel:[0,0] op_sel_hi:[0,1]
  v_pk_fma_f32 v[60:61], v[14:15], v[76:77], v[60:61] op_sel:[1,0,0] op_sel_hi:[1,1,1] neg_lo:[1,0,0] neg_hi:[1,0,0]
  v_pk_fma_f32 v[76:77], v[14:15], v[76:77], v[94:95] op_sel:[0,0,0] op_sel_hi:[0,1,1]
  v_pk_mul_f32 v[92:93], v[14:15], v[62:63] op_sel:[1,0] op_sel_hi:[1,1]
  v_pk_mul_f32 v[62:63], v[14:15], v[62:63] op_sel:[0,0] op_sel_hi:[0,1]
  v_pk_fma_f32 v[62:63], v[14:15], v[78:79], v[62:63] op_sel:[1,0,0] op_sel_hi:[1,1,1] neg_lo:[1,0,0] neg_hi:[1,0,0]
  v_pk_fma_f32 v[78:79], v[14:15], v[78:79], v[92:93] op_sel:[0,0,0] op_sel_hi:[0,1,1]
  v_pk_mul_f32 v[94:95], v[14:15], v[64:65] op_sel:[1,0] op_sel_hi:[1,1]
  v_pk_mul_f32 v[64:65], v[14:15], v[64:65] op_sel:[0,0] op_sel_hi:[0,1]
  v_pk_fma_f32 v[64:65], v[14:15], v[80:81], v[64:65] op_sel:[1,0,0] op_sel_hi:[1,1,1] neg_lo:[1,0,0] neg_hi:[1,0,0]
  v_pk_fma_f32 v[80:81], v[14:15], v[80:81], v[94:95] op_sel:[0,0,0] op_sel_hi:[0,1,1]
  v_pk_mul_f32 v[92:93], v[14:15], v[66:67] op_sel:[1,0] op_sel_hi:[1,1]
  v_pk_mul_f32 v[66:67], v[14:15], v[66:67] op_sel:[0,0] op_sel_hi:[0,1]
  v_pk_fma_f32 v[66:67], v[14:15], v[82:83], v[66:67] op_sel:[1,0,0] op_sel_hi:[1,1,1] neg_lo:[1,0,0] neg_hi:[1,0,0]
  v_pk_fma_f32 v[82:83], v[14:15], v[82:83], v[92:93] op_sel:[0,0,0] op_sel_hi:[0,1,1]
  v_pk_mul_f32 v[94:95], v[14:15], v[68:69] op_sel:[1,0] op_sel_hi:[1,1]
  v_pk_mul_f32 v[68:69], v[14:15], v[68:69] op_sel:[0,0] op_sel_hi:[0,1]
  v_pk_fma_f32 v[68:69], v[14:15], v[84:85], v[68:69] op_sel:[1,0,0] op_sel_hi:[1,1,1] neg_lo:[1,0,0] neg_hi:[1,0,0]
  v_pk_fma_f32 v[84:85], v[14:15], v[84:85], v[94:95] op_sel:[0,0,0] op_sel_hi:[0,1,1]
  v_pk_mul_f32 v[92:93], v[14:15], v[70:71] op_sel:[1,0] op_sel_hi:[1,1]
  v_pk_mul_f32 v[70:71], v[14:15], v[70:71] op_sel:[0,0] op_sel_hi:[0,1]
  v_pk_fma_f32 v[70:71], v[14:15], v[86:87], v[70:71] op_sel:[1,0,0] op_sel_hi:[1,1,1] neg_lo:[1,0,0] neg_hi:[1,0,0]
  v_pk_fma_f32 v[86:87], v[14:15], v[86:87], v[92:93] op_sel:[0,0,0] op_sel_hi:[0,1,1]
  v_add_u32 v23, 4096, v88
  s_mov_b32 s18, 0
kc_kernel_lb1:
  buffer_load_dwordx2 v[92:93], v88, s[48:51], 0 offen offset:0 sc1
  buffer_load_dwordx2 v[94:95], v88, s[48:51], 0 offen offset:512 sc1
  buffer_load_dwordx2 v[96:97], v88, s[48:51], 0 offen offset:1024 sc1
  buffer_load_dwordx2 v[98:99], v88, s[48:51], 0 offen offset:1536 sc1
  buffer_load_dwordx2 v[100:101], v88, s[48:51], 0 offen offset:2048 sc1
  buffer_load_dwordx2 v[102:103], v88, s[48:51], 0 offen offset:2560 sc1
  buffer_load_dwordx2 v[104:105], v88, s[48:51], 0 offen offset:3072 sc1
  buffer_load_dwordx2 v[106:107], v88, s[48:51], 0 offen offset:3584 sc1
  buffer_load_dwordx2 v[108:109], v23, s[48:51], 0 offen offset:0 sc1
  buffer_load_dwordx2 v[110:111], v23, s[48:51], 0 offen offset:512 sc1
  buffer_load_dwordx2 v[112:113], v23, s[48:51], 0 offen offset:1024 sc1
  buffer_load_dwordx2 v[114:115], v23, s[48:51], 0 offen offset:1536 sc1
  buffer_load_dwordx2 v[116:117], v23, s[48:51], 0 offen offset:2048 sc1
  buffer_load_dwordx2 v[118:119], v23, s[48:51], 0 offen offset:2560 sc1
  buffer_load_dwordx2 v[120:121], v23, s[48:51], 0 offen offset:3072 sc1
  buffer_load_dwordx2 v[122:123], v23, s[48:51], 0 offen offset:3584 sc1
  s_waitcnt vmcnt(15)
  v_max_u32 v22, v92, v93
  s_waitcnt vmcnt(14)
  v_max3_u32 v22, v22, v94, v95
  s_waitcnt vmcnt(13)
  v_max3_u32 v22, v22, v96, v97
  s_waitcnt vmcnt(12)
  v_max3_u32 v22, v22, v98, v99
  s_waitcnt vmcnt(11)
  v_max3_u32 v22, v22, v100, v101
  s_waitcnt vmcnt(10)
  v_max3_u32 v22, v22, v102, v103
  s_waitcnt vmcnt(9)
  v_max3_u32 v22, v22, v104, v105
  s_waitcnt vmcnt(8)
  v_max3_u32 v22, v22, v106, v107
  s_waitcnt vmcnt(7)
  v_max3_u32 v22, v22, v108, v109
  s_waitcnt vmcnt(6)
  v_max3_u32 v22, v22, v110, v111
  s_waitcnt vmcnt(5)
  v_max3_u32 v22, v22, v112, v113
  s_waitcnt vmcnt(4)
  v_max3_u32 v22, v22, v114, v115
  s_waitcnt vmcnt(3)
  v_max3_u32 v22, v22, v116, v117
  s_waitcnt vmcnt(2)
  v_max3_u32 v22, v22, v118, v119
  s_waitcnt vmcnt(1)
  v_max3_u32 v22, v22, v120, v121
  s_waitcnt vmcnt(0)
  v_max3_u32 v22, v22, v122, v123
  v_cmp_eq_u32 vcc, -1, v22
  s_nop 0
  s_cbranch_vccz kc_kernel_lbdone2
  s_add_u32 s18, s18, 1
  s_cmp_lt_u32 s18, 1048576
  s_cbranch_scc1 kc_kernel_lb1
kc_kernel_lbdone2:
  v_fma_f32 v120, v10, v122, v120
  v_fma_f32 v121, v10, v123, v121
  v_fma_f32 v120, -v11, v123, v120
  v_fma_f32 v121, v11, v122, v121
  v_fma_f32 v118, v10, v120, v118
  v_fma_f32 v119, v10, v121, v119
  v_fma_f32 v118, -v11, v121, v118
  v_fma_f32 v119, v11, v120, v119
  v_fma_f32 v116, v10, v118, v116
  v_fma_f32 v117, v10, v119, v117
  v_fma_f32 v116, -v11, v119, v116
  v_fma_f32 v117, v11, v118, v117
  v_fma_f32 v114, v10, v116, v114
  v_fma_f32 v115, v10, v117, v115
  v_fma_f32 v114, -v11, v117, v114
  v_fma_f32 v115, v11, v116, v115
  v_fma_f32 v112, v10, v114, v112
  v_fma_f32 v113, v10, v115, v113
  v_fma_f32 v112, -v11, v115, v112
  v_fma_f32 v113, v11, v114, v113
  v_fma_f32 v110, v10, v112, v110
  v_fma_f32 v111, v10, v113, v111
  v_fma_f32 v110, -v11, v113, v110
  v_fma_f32 v111, v11, v112, v111
  v_fma_f32 v108, v10, v110, v108
  v_fma_f32 v109, v10, v111, v109
  v_fma_f32 v108, -v11, v111, v108
  v_fma_f32 v109, v11, v110, v109
  v_fma_f32 v106, v10, v108, v106
  v_fma_f32 v107, v10, v109, v107
  v_fma_f32 v106, -v11, v109, v106
  v_fma_f32 v107, v11, v108, v107
  v_fma_f32 v104, v10, v106, v104
  v_fma_f32 v105, v10, v107, v105
  v_fma_f32 v104, -v11, v107, v104
  v_fma_f32 v105, v11, v106, v105
  v_fma_f32 v102, v10, v104, v102
  v_fma_f32 v103, v10, v105, v103
  v_fma_f32 v102, -v11, v105, v102
  v_fma_f32 v103, v11, v104, v103
  v_fma_f32 v100, v10, v102, v100
  v_fma_f32 v101, v10, v103, v101
  v_fma_f32 v100, -v11, v103, v100
  v_fma_f32 v101, v11, v102, v101
  v_fma_f32 v98, v10, v100, v98
  v_fma_f32 v99, v10, v101, v99
  v_fma_f32 v98, -v11, v101, v98
  v_fma_f32 v99, v11, v100, v99
  v_fma_f32 v96, v10, v98, v96
  v_fma_f32 v97, v10, v99, v97
  v_fma_f32 v96, -v11, v99, v96
  v_fma_f32 v97, v11, v98, v97
  v_fma_f32 v94, v10, v96, v94
  v_fma_f32 v95, v10, v97, v95
  v_fma_f32 v94, -v11, v97, v94
  v_fma_f32 v95, v11, v96, v95
  v_fma_f32 v92, v10, v94, v92
  v_fma_f32 v93, v10, v95, v93
  v_fma_f32 v92, -v11, v95, v92
  v_fma_f32 v93, v11, v94, v93
  v_mov_b32 v94, v92
  v_mov_b32 v95, v93
  s_nop 0
  v_permlane32_swap_b32 v92, v94
  v_permlane32_swap_b32 v93, v95
  v_fma_f32 v92, v12, v94, v92
  v_fma_f32 v93, v12, v95, v93
  v_fma_f32 v92, -v13, v95, v92
  v_fma_f32 v93, v13, v94, v93
  v_fma_f32 v20, v8, v92, v20
  v_fma_f32 v21, v8, v93, v21
  v_fma_f32 v20, -v9, v93, v20
  v_fma_f32 v21, v9, v92, v21
  s_mov_b32 exec_lo, 0
  v_mov_b32 v92, v20
  v_mov_b32 v93, v21
  s_mov_b64 exec, -1
  v_fma_f32 v16, v6, v92, v16
  v_fma_f32 v18, v6, v93, v18
  v_fma_f32 v16, -v7, v93, v16
  v_fma_f32 v18, v7, v92, v18
  v_mul_f32 v96, v14, v92
  v_mul_f32 v98, v14, v93
  v_fma_f32 v96, -v15, v93, v96
  v_fma_f32 v98, v15, v92, v98
  v_mul_f32 v97, v14, v16
  v_mul_f32 v99, v14, v18
  v_fma_f32 v97, -v15, v18, v97
  v_fma_f32 v99, v15, v16, v99
  s_lshl_b32 s19, s20, 1
  s_lshr_b32 s32, s3, 1
  s_add_u32 s19, s19, s32
  s_lshl_b32 s18, s19, 9
  s_and_b32 s19, s19, 2
  s_lshl_b32 s19, s19, 1
  s_or_b32 s19, s19, s32
  s_lshl_b32 s19, s19, 2
  v_and_b32 v22, 31, v1
  v_xor_b32 v22, s19, v22
  v_lshlrev_b32 v22, 3, v22
  v_lshrrev_b32 v23, 5, v1
  v_lshl_or_b32 v22, v23, 14, v22
  s_and_b32 s32, s3, 1
  s_lshl_b32 s32, s32, 8
  s_add_u32 s18, s18, s32
  s_lshl_b32 s32, s21, 15
  s_add_u32 s18, s18, s32
  v_pk_fma_f32 v[24:25], v[4:5], v[96:97], v[24:25] op_sel:[0,0,0] op_sel_hi:[0,1,1]
  v_pk_fma_f32 v[40:41], v[4:5], v[98:99], v[40:41] op_sel:[0,0,0] op_sel_hi:[0,1,1]
  v_pk_fma_f32 v[24:25], v[4:5], v[98:99], v[24:25] op_sel:[1,0,0] op_sel_hi:[1,1,1] neg_lo:[1,0,0] neg_hi:[1,0,0]
  v_pk_fma_f32 v[40:41], v[4:5], v[96:97], v[40:41] op_sel:[1,0,0] op_sel_hi:[1,1,1]
  v_cvt_pk_bf16_f32 v100, v24, v25
  v_cvt_pk_bf16_f32 v101, -v40, -v41
  v_pk_fma_f32 v[26:27], v[4:5], v[24:25], v[26:27] op_sel:[0,0,0] op_sel_hi:[0,1,1]
  v_pk_fma_f32 v[42:43], v[4:5], v[40:41], v[42:43] op_sel:[0,0,0] op_sel_hi:[0,1,1]
  v_pk_fma_f32 v[26:27], v[4:5], v[40:41], v[26:27] op_sel:[1,0,0] op_sel_hi:[1,1,1] neg_lo:[1,0,0] neg_hi:[1,0,0]
  v_pk_fma_f32 v[42:43], v[4:5], v[24:25], v[42:43] op_sel:[1,0,0] op_sel_hi:[1,1,1]
  v_permlane32_swap_b32 v100, v101
  buffer_store_dwordx2 v[100:101], v22, s[52:55], s18 offen
  s_add_u32 s18, s18, 524288
  v_cvt_pk_bf16_f32 v102, v26, v27
  v_cvt_pk_bf16_f32 v103, -v42, -v43
  v_pk_fma_f32 v[28:29], v[4:5], v[26:27], v[28:29] op_sel:[0,0,0] op_sel_hi:[0,1,1]
  v_pk_fma_f32 v[44:45], v[4:5], v[42:43], v[44:45] op_sel:[0,0,0] op_sel_hi:[0,1,1]
  v_pk_fma_f32 v[28:29], v[4:5], v[42:43], v[28:29] op_sel:[1,0,0] op_sel_hi:[1,1,1] neg_lo:[1,0,0] neg_hi:[1,0,0]
  v_pk_fma_f32 v[44:45], v[4:5], v[26:27], v[44:45] op_sel:[1,0,0] op_sel_hi:[1,1,1]
  v_permlane32_swap_b32 v102, v103
  buffer_store_dwordx2 v[102:103], v22, s[52:55], s18 offen
  s_add_u32 s18, s18, 524288
  v_cvt_pk_bf16_f32 v104, v28, v29
  v_cvt_pk_bf16_f32 v105, -v44, -v45
  v_pk_fma_f32 v[30:31], v[4:5], v[28:29], v[30:31] op_sel:[0,0,0] op_sel_hi:[0,1,1]
  v_pk_fma_f32 v[46:47], v[4:5], v[44:45], v[46:47] op_sel:[0,0,0] op_sel_hi:[0,1,1]
  v_pk_fma_f32 v[30:31], v[4:5], v[44:45], v[30:31] op_sel:[1,0,0] op_sel_hi:[1,1,1] neg_lo:[1,0,0] neg_hi:[1,0,0]
  v_pk_fma_f32 v[46:47], v[4:5], v[28:29], v[46:47] op_sel:[1,0,0] op_sel_hi:[1,1,1]
  v_permlane32_swap_b32 v104, v105
  buffer_store_dwordx2 v[104:105], v22, s[52:55], s18 offen
  s_add_u32 s18, s18, 524288
  v_cvt_pk_bf16_f32 v106, v30, v31
  v_cvt_pk_bf16_f32 v107, -v46, -v47
  v_pk_fma_f32 v[32:33], v[4:5], v[30:31], v[32:33] op_sel:[0,0,0] op_sel_hi:[0,1,1]
  v_pk_fma_f32 v[48:49], v[4:5], v[46:47], v[48:49] op_sel:[0,0,0] op_sel_hi:[0,1,1]
  v_pk_fma_f32 v[32:33], v[4:5], v[46:47], v[32:33] op_sel:[1,0,0] op_sel_hi:[1,1,1] neg_lo:[1,0,0] neg_hi:[1,0,0]
  v_pk_fma_f32 v[48:49], v[4:5], v[30:31], v[48:49] op_sel:[1,0,0] op_sel_hi:[1,1,1]
  v_permlane32_swap_b32 v106, v107
  buffer_store_dwordx2 v[106:107], v22, s[52:55], s18 offen
  s_add_u32 s18, s18, 524288
  v_cvt_pk_bf16_f32 v108, v32, v33
  v_cvt_pk_bf16_f32 v109, -v48, -v49
  v_pk_fma_f32 v[34:35], v[4:5], v[32:33], v[34:35] op_sel:[0,0,0] op_sel_hi:[0,1,1]
  v_pk_fma_f32 v[50:51], v[4:5], v[48:49], v[50:51] op_sel:[0,0,0] op_sel_hi:[0,1,1]
  v_pk_fma_f32 v[34:35], v[4:5], v[48:49], v[34:35] op_sel:[1,0,0] op_sel_hi:[1,1,1] neg_lo:[1,0,0] neg_hi:[1,0,0]
  v_pk_fma_f32 v[50:51], v[4:5], v[32:33], v[50:51] op_sel:[1,0,0] op_sel_hi:[1,1,1]
  v_permlane32_swap_b32 v108, v109
  buffer_store_dwordx2 v[108:109], v22, s[52:55], s18 offen
  s_add_u32 s18, s18, 524288
  v_cvt_pk_bf16_f32 v110, v34, v35
  v_cvt_pk_bf16_f32 v111, -v50, -v51
  v_pk_fma_f32 v[36:37], v[4:5], v[34:35], v[36:37] op_sel:[0,0,0] op_sel_hi:[0,1,1]
  v_pk_fma_f32 v[52:53], v[4:5], v[50:51], v[52:53] op_sel:[0,0,0] op_sel_hi:[0,1,1]
  v_pk_fma_f32 v[36:37], v[4:5], v[50:51], v[36:37] op_sel:[1,0,0] op_sel_hi:[1,1,1] neg_lo:[1,0,0] neg_hi:[1,0,0]
  v_pk_fma_f32 v[52:53], v[4:5], v[34:35], v[52:53] op_sel:[1,0,0] op_sel_hi:[1,1,1]
  v_permlane32_swap_b32 v110, v111
  buffer_store_dwordx2 v[110:111], v22, s[52:55], s18 offen
  s_add_u32 s18, s18, 524288
  v_cvt_pk_bf16_f32 v112, v36, v37
  v_cvt_pk_bf16_f32 v113, -v52, -v53
  v_pk_fma_f32 v[38:39], v[4:5], v[36:37], v[38:39] op_sel:[0,0,0] op_sel_hi:[0,1,1]
  v_pk_fma_f32 v[54:55], v[4:5], v[52:53], v[54:55] op_sel:[0,0,0] op_sel_hi:[0,1,1]
  v_pk_fma_f32 v[38:39], v[4:5], v[52:53], v[38:39] op_sel:[1,0,0] op_sel_hi:[1,1,1] neg_lo:[1,0,0] neg_hi:[1,0,0]
  v_pk_fma_f32 v[54:55], v[4:5], v[36:37], v[54:55] op_sel:[1,0,0] op_sel_hi:[1,1,1]
  v_permlane32_swap_b32 v112, v113
  buffer_store_dwordx2 v[112:113], v22, s[52:55], s18 offen
  s_add_u32 s18, s18, 524288
  v_cvt_pk_bf16_f32 v114, v38, v39
  v_cvt_pk_bf16_f32 v115, -v54, -v55
  v_pk_fma_f32 v[56:57], v[4:5], v[38:39], v[56:57] op_sel:[0,0,0] op_sel_hi:[0,1,1]
  v_pk_fma_f32 v[72:73], v[4:5], v[54:55], v[72:73] op_sel:[0,0,0] op_sel_hi:[0,1,1]
  v_pk_fma_f32 v[56:57], v[4:5], v[54:55], v[56:57] op_sel:[1,0,0] op_sel_hi:[1,1,1] neg_lo:[1,0,0] neg_hi:[1,0,0]
  v_pk_fma_f32 v[72:73], v[4:5], v[38:39], v[72:73] op_sel:[1,0,0] op_sel_hi:[1,1,1]
  v_permlane32_swap_b32 v114, v115
  buffer_store_dwordx2 v[114:115], v22, s[52:55], s18 offen
  s_add_u32 s18, s18, 524288
  v_cvt_pk_bf16_f32 v116, v56, v57
  v_cvt_pk_bf16_f32 v117, -v72, -v73
  v_pk_fma_f32 v[58:59], v[4:5], v[56:57], v[58:59] op_sel:[0,0,0] op_sel_hi:[0,1,1]
  v_pk_fma_f32 v[74:75], v[4:5], v[72:73], v[74:75] op_sel:[0,0,0] op_sel_hi:[0,1,1]
  v_pk_fma_f32 v[58:59], v[4:5], v[72:73], v[58:59] op_sel:[1,0,0] op_sel_hi:[1,1,1] neg_lo:[1,0,0] neg_hi:[1,0,0]
  v_pk_fma_f32 v[74:75], v[4:5], v[56:57], v[74:75] op_sel:[1,0,0] op_sel_hi:[1,1,1]
  v_permlane32_swap_b32 v116, v117
  buffer_store_dwordx2 v[116:117], v22, s[52:55], s18 offen
  s_add_u32 s18, s18, 524288
  v_cvt_pk_bf16_f32 v118, v58, v59
  v_cvt_pk_bf16_f32 v119, -v74, -v75
  v_pk_fma_f32 v[60:61], v[4:5], v[58:59], v[60:61] op_sel:[0,0,0] op_sel_hi:[0,1,1]
  v_pk_fma_f32 v[76:77], v[4:5], v[74:75], v[76:77] op_sel:[0,0,0] op_sel_hi:[0,1,1]
  v_pk_fma_f32 v[60:61], v[4:5], v[74:75], v[60:61] op_sel:[1,0,0] op_sel_hi:[1,1,1] neg_lo:[1,0,0] neg_hi:[1,0,0]
  v_pk_fma_f32 v[76:77], v[4:5], v[58:59], v[76:77] op_sel:[1,0,0] op_sel_hi:[1,1,1]
  v_permlane32_swap_b32 v118, v119
  buffer_store_dwordx2 v[118:119], v22, s[52:55], s18 offen
  s_add_u32 s18, s18, 524288
  v_cvt_pk_bf16_f32 v120, v60, v61
  v_cvt_pk_bf16_f32 v121, -v76, -v77
  v_pk_fma_f32 v[62:63], v[4:5], v[60:61], v[62:63] op_sel:[0,0,0] op_sel_hi:[0,1,1]
  v_pk_fma_f32 v[78:79], v[4:5], v[76:77], v[78:79] op_sel:[0,0,0] op_sel_hi:[0,1,1]
  v_pk_fma_f32 v[62:63], v[4:5], v[76:77], v[62:63] op_sel:[1,0,0] op_sel_hi:[1,1,1] neg_lo:[1,0,0] neg_hi:[1,0,0]
  v_pk_fma_f32 v[78:79], v[4:5], v[60:61], v[78:79] op_sel:[1,0,0] op_sel_hi:[1,1,1]
  v_permlane32_swap_b32 v120, v121
  buffer_store_dwordx2 v[120:121], v22, s[52:55], s18 offen
  s_add_u32 s18, s18, 524288
  v_cvt_pk_bf16_f32 v122, v62, v63
  v_cvt_pk_bf16_f32 v123, -v78, -v79
  v_pk_fma_f32 v[64:65], v[4:5], v[62:63], v[64:65] op_sel:[0,0,0] op_sel_hi:[0,1,1]
  v_pk_fma_f32 v[80:81], v[4:5], v[78:79], v[80:81] op_sel:[0,0,0] op_sel_hi:[0,1,1]
  v_pk_fma_f32 v[64:65], v[4:5], v[78:79], v[64:65] op_sel:[1,0,0] op_sel_hi:[1,1,1] neg_lo:[1,0,0] neg_hi:[1,0,0]
  v_pk_fma_f32 v[80:81], v[4:5], v[62:63], v[80:81] op_sel:[1,0,0] op_sel_hi:[1,1,1]
  v_permlane32_swap_b32 v122, v123
  buffer_store_dwordx2 v[122:123], v22, s[52:55], s18 offen
  s_add_u32 s18, s18, 524288
  v_cvt_pk_bf16_f32 v100, v64, v65
  v_cvt_pk_bf16_f32 v101, -v80, -v81
  v_pk_fma_f32 v[66:67], v[4:5], v[64:65], v[66:67] op_sel:[0,0,0] op_sel_hi:[0,1,1]
  v_pk_fma_f32 v[82:83], v[4:5], v[80:81], v[82:83] op_sel:[0,0,0] op_sel_hi:[0,1,1]
  v_pk_fma_f32 v[66:67], v[4:5], v[80:81], v[66:67] op_sel:[1,0,0] op_sel_hi:[1,1,1] neg_lo:[1,0,0] neg_hi:[1,0,0]
  v_pk_fma_f32 v[82:83], v[4:5], v[64:65], v[82:83] op_sel:[1,0,0] op_sel_hi:[1,1,1]
  v_permlane32_swap_b32 v100, v101
  buffer_store_dwordx2 v[100:101], v22, s[52:55], s18 offen
  s_add_u32 s18, s18, 524288
  v_cvt_pk_bf16_f32 v102, v66, v67
  v_cvt_pk_bf16_f32 v103, -v82, -v83
  v_pk_fma_f32 v[68:69], v[4:5], v[66:67], v[68:69] op_sel:[0,0,0] op_sel_hi:[0,1,1]
  v_pk_fma_f32 v[84:85], v[4:5], v[82:83], v[84:85] op_sel:[0,0,0] op_sel_hi:[0,1,1]
  v_pk_fma_f32 v[68:69], v[4:5], v[82:83], v[68:69] op_sel:[1,0,0] op_sel_hi:[1,1,1] neg_lo:[1,0,0] neg_hi:[1,0,0]
  v_pk_fma_f32 v[84:85], v[4:5], v[66:67], v[84:85] op_sel:[1,0,0] op_sel_hi:[1,1,1]
  v_permlane32_swap_b32 v102, v103
  buffer_store_dwordx2 v[102:103], v22, s[52:55], s18 offen
  s_add_u32 s18, s18, 524288
  v_cvt_pk_bf16_f32 v104, v68, v69
  v_cvt_pk_bf16_f32 v105, -v84, -v85
  v_pk_fma_f32 v[70:71], v[4:5], v[68:69], v[70:71] op_sel:[0,0,0] op_sel_hi:[0,1,1]
  v_pk_fma_f32 v[86:87], v[4:5], v[84:85], v[86:87] op_sel:[0,0,0] op_sel_hi:[0,1,1]
  v_pk_fma_f32 v[70:71], v[4:5], v[84:85], v[70:71] op_sel:[1,0,0] op_sel_hi:[1,1,1] neg_lo:[1,0,0] neg_hi:[1,0,0]
  v_pk_fma_f32 v[86:87], v[4:5], v[68:69], v[86:87] op_sel:[1,0,0] op_sel_hi:[1,1,1]
  v_permlane32_swap_b32 v104, v105
  buffer_store_dwordx2 v[104:105], v22, s[52:55], s18 offen
  s_add_u32 s18, s18, 524288
  v_cvt_pk_bf16_f32 v106, v70, v71
  v_cvt_pk_bf16_f32 v107, -v86, -v87
  s_nop 1
  v_permlane32_swap_b32 v106, v107
  buffer_store_dwordx2 v[106:107], v22, s[52:55], s18 offen
kc_kernel_end:
  s_endpgm
.p2align 8
.globl kd_kernel
.type kd_kernel,@function
kd_kernel:
  s_cmp_ge_u32 s2, 256
  s_cbranch_scc1 kd_kernel_end
  s_load_dwordx2 s[4:5], s[0:1], 0
  s_load_dwordx2 s[6:7], s[0:1], 64
  s_load_dwordx2 s[8:9], s[0:1], 72
  s_load_dwordx2 s[10:11], s[0:1], 88
  s_load_dwordx2 s[12:13], s[0:1], 104
  s_load_dwordx2 s[14:15], s[0:1], 120
  v_lshrrev_b32 v1, 6, v0
  s_nop 0
  v_readfirstlane_b32 s3, v1
  v_and_b32 v1, 63, v0
  v_and_b32 v2, 15, v0
  v_bfe_u32 v3, v0, 4, 2
  s_and_b32 s16, s2, 7
  s_lshr_b32 s17, s2, 3
  s_and_b32 s21, s17, 3
  s_lshr_b32 s17, s17, 2
  s_lshl_b32 s20, s16, 3
  s_add_u32 s20, s20, s17
  s_and_b32 s18, s16, 3
  s_lshl_b32 s18, s18, 2
  s_add_u32 s18, s18, s21
  s_lshr_b32 s19, s16, 2
  s_lshl_b32 s19, s19, 3
  s_add_u32 s19, s19, s17
  s_waitcnt lgkmcnt(0)
  s_add_u32 s24, s14, 10485760
  s_addc_u32 s25, s15, 0
  s_mov_b32 s26, 8388608
  s_mov_b32 s27, 0x20000
  s_mov_b32 s28, s6
  s_mov_b32 s29, s7
  s_mov_b32 s30, 2097152
  s_mov_b32 s31, 0x20000
  s_mov_b32 s32, s8
  s_mov_b32 s33, s9
  s_mov_b32 s34, 2097152
  s_mov_b32 s35, 0x20000
  s_add_u32 s36, s14, 5242880
  s_addc_u32 s37, s15, 0
  s_mov_b32 s38, 4194304
  s_mov_b32 s39, 0x20000
  s_mov_b32 s40, s4
  s_mov_b32 s41, s5
  s_mov_b32 s42, 4194304
  s_mov_b32 s43, 0x20000
  s_add_u32 s44, s14, 19922944
  s_addc_u32 s45, s15, 0
  s_mov_b32 s46, 8192
  s_mov_b32 s47, 0x20000
  s_mov_b32 s48, s10
  s_mov_b32 s49, s11
  s_mov_b32 s50, 2048
  s_mov_b32 s51, 0x20000
  s_mov_b32 s52, s12
  s_mov_b32 s53, s13
  s_mov_b32 s54, 8388608
  s_mov_b32 s55, 0x20000
  v_lshrrev_b32 v20, 2, v1
  v_lshlrev_b32 v20, 8, v20
  v_and_b32 v21, 3, v1
  v_lshl_or_b32 v20, v21, 4, v20
  s_lshl_b32 s16, s18, 4
  s_add_u32 s16, s16, s19
  s_mul_i32 s16, s16, 16384
  s_lshl_b32 s17, s3, 12
  s_add_u32 s16, s16, s17
  buffer_load_dwordx4 v[4:7], v20, s[36:39], s16 offen offset:0
  buffer_load_dwordx4 v[8:11], v20, s[36:39], s16 offen offset:64
  buffer_load_dwordx4 v[12:15], v20, s[36:39], s16 offen offset:128
  buffer_load_dwordx4 v[16:19], v20, s[36:39], s16 offen offset:192
  v_lshlrev_b32 v22, 2, v2
  s_lshl_b32 s16, s18, 9
  s_lshl_b32 s17, s3, 7
  s_add_u32 s16, s16, s17
  buffer_load_dword v20, v22, s[44:47], s16 offen
  buffer_load_dword v21, v22, s[44:47], s16 offen offset:64
  v_lshlrev_b32 v22, 3, v3
  s_lshl_b32 s16, s19, 5
  buffer_load_dwordx2 v[24:25], v22, s[48:51], s16 offen offset:0
  buffer_load_dwordx2 v[26:27], v22, s[48:51], s16 offen offset:512
  buffer_load_dwordx2 v[28:29], v22, s[48:51], s16 offen offset:1024
  buffer_load_dwordx2 v[30:31], v22, s[48:51], s16 offen offset:1536
  v_bfe_u32 v23, v1, 1, 2
  v_xor_b32 v23, v23, v3
  v_lshlrev_b32 v22, 9, v23
  v_and_b32 v23, 1, v1
  v_lshl_or_b32 v22, v23, 4, v22
  v_lshrrev_b32 v23, 3, v1
  v_lshl_or_b32 v22, v23, 15, v22
  s_lshl_b32 s16, s18, 11
  s_lshl_b32 m0, s19, 5
  s_add_u32 s16, s16, m0
  s_lshl_b32 m0, s3, 20
  s_add_u32 s16, s16, m0
  s_lshl_b32 m0, s3, 12
  s_add_u32 m0, m0, 122880
  s_nop 0
  buffer_load_dwordx4 v22, s[40:43], s16 offen offset:0 lds
  s_add_u32 s16, s16, 261120
  buffer_load_dwordx4 v22, s[40:43], s16 offen offset:1024 lds
  s_add_u32 s16, s16, 261120
  buffer_load_dwordx4 v22, s[40:43], s16 offen offset:2048 lds
  s_add_u32 s16, s16, 261120
  buffer_load_dwordx4 v22, s[40:43], s16 offen offset:3072 lds
  v_lshlrev_b32 v22, 4, v1
  v_lshrrev_b32 v38, 3, v1
  v_lshlrev_b32 v38, 11, v38
  v_and_b32 v39, 7, v1
  v_xor_b32 v39, v39, v3
  v_lshl_or_b32 v32, v39, 4, v38
  v_xor_b32 v33, 64, v32
  v_add_u32 v33, 15360, v33
  s_lshl_b32 s16, s18, 19
  s_lshl_b32 s56, s3, 12
  s_add_u32 s16, s16, s56
  s_mul_i32 s22, s3, 20480
  s_add_u32 s22, s22, 0
  s_lshl_b32 s17, s3, 19
  s_lshl_b32 s56, s19, 15
  s_add_u32 s17, s17, s56
  s_lshl_b32 s23, s3, 11
  s_add_u32 s23, s23, 81920
  v_and_b32 v38, 3, v1
  v_lshlrev_b32 v39, 9, v38
  v_bfe_u32 v40, v1, 2, 2
  v_lshl_or_b32 v39, v40, 3, v39
  v_and_b32 v40, 2, v1
  v_xor_b32 v40, v40, v3
  v_lshl_or_b32 v39, v40, 6, v39
  v_and_b32 v40, 1, v1
  v_lshl_or_b32 v39, v40, 5, v39
  v_add_u32 v34, s22, v39
  v_xor_b32 v35, 32, v34
  v_lshrrev_b32 v38, 1, v2
  v_xor_b32 v38, v38, v3
  v_lshlrev_b32 v38, 4, v38
  v_lshl_or_b32 v38, v2, 7, v38
  v_add_u32 v36, 81920, v38
  v_xor_b32 v37, 64, v36
  s_add_u32 m0, s23, 0
  s_nop 0
  buffer_load_dwordx4 v32, s[28:31], s17 offen offset:0 lds
  buffer_load_dwordx4 v33, s[28:31], s17 offen offset:1024 lds
  s_add_u32 m0, s22, 0
  s_nop 0
  buffer_load_dwordx4 v22, s[24:27], s16 offen offset:0  lds
  buffer_load_dwordx4 v22, s[24:27], s16 offen offset:1024  lds
  buffer_load_dwordx4 v22, s[24:27], s16 offen offset:2048  lds
  buffer_load_dwordx4 v22, s[24:27], s16 offen offset:3072  lds
  s_add_u32 s16, s16, 16384
  s_add_u32 m0, s23, 8192
  s_nop 0
  buffer_load_dwordx4 v32, s[32:35], s17 offen offset:0 lds
  buffer_load_dwordx4 v33, s[32:35], s17 offen offset:1024 lds
  s_add_u32 s17, s17, 128
  s_add_u32 m0, s22, 4096
  s_nop 0
  buffer_load_dwordx4 v22, s[24:27], s16 offen offset:0  lds
  buffer_load_dwordx4 v22, s[24:27], s16 offen offset:1024  lds
  buffer_load_dwordx4 v22, s[24:27], s16 offen offset:2048  lds
  buffer_load_dwordx4 v22, s[24:27], s16 offen offset:3072  lds
  s_add_u32 s16, s16, 16384
  v_lshrrev_b32 v72, 1, v3
  v_lshlrev_b32 v72, 3, v72
  v_and_b32 v73, 1, v3
  v_lshl_add_u32 v72, v73, 1, v72
  v_cvt_f32_u32 v39, v72
  s_lshl_b32 s56, s3, 5
  s_add_u32 s56, s56, 0
  v_add_u32 v72, s56, v2
  v_cvt_f32_u32 v23, v72
  v_mul_f32 v23, 0x3c000000, v23
  v_mul_f32 v38, v23, v39
  v_fmamk_f32 v72, v23, 0x0, v38
  v_cos_f32 v73, v72
  v_sin_f32 v74, v72
  s_nop 0
  v_cvt_pk_bf16_f32 v40, v73, -v74
  v_fmamk_f32 v72, v23, 0x3f800000, v38
  v_cos_f32 v73, v72
  v_sin_f32 v74, v72
  s_nop 0
  v_cvt_pk_bf16_f32 v41, v73, -v74
  v_fmamk_f32 v72, v23, 0x40800000, v38
  v_cos_f32 v73, v72
  v_sin_f32 v74, v72
  s_nop 0
  v_cvt_pk_bf16_f32 v42, v73, -v74
  v_fmamk_f32 v72, v23, 0x40a00000, v38
  v_cos_f32 v73, v72
  v_sin_f32 v74, v72
  s_nop 0
  v_cvt_pk_bf16_f32 v43, v73, -v74
  v_fmamk_f32 v72, v23, 0x41800000, v38
  v_cos_f32 v73, v72
  v_sin_f32 v74, v72
  s_nop 0
  v_cvt_pk_bf16_f32 v44, v73, -v74
  v_fmamk_f32 v72, v23, 0x41880000, v38
  v_cos_f32 v73, v72
  v_sin_f32 v74, v72
  s_nop 0
  v_cvt_pk_bf16_f32 v45, v73, -v74
  v_fmamk_f32 v72, v23, 0x41a00000, v38
  v_cos_f32 v73, v72
  v_sin_f32 v74, v72
  s_nop 0
  v_cvt_pk_bf16_f32 v46, v73, -v74
  v_fmamk_f32 v72, v23, 0x41a80000, v38
  v_cos_f32 v73, v72
  v_sin_f32 v74, v72
  s_nop 0
  v_cvt_pk_bf16_f32 v47, v73, -v74
  v_fmamk_f32 v72, v23, 0x42000000, v38
  v_cos_f32 v73, v72
  v_sin_f32 v74, v72
  s_nop 0
  v_cvt_pk_bf16_f32 v48, v73, -v74
  v_fmamk_f32 v72, v23, 0x42040000, v38
  v_cos_f32 v73, v72
  v_sin_f32 v74, v72
  s_nop 0
  v_cvt_pk_bf16_f32 v49, v73, -v74
  v_fmamk_f32 v72, v23, 0x42100000, v38
  v_cos_f32 v73, v72
  v_sin_f32 v74, v72
  s_nop 0
  v_cvt_pk_bf16_f32 v50, v73, -v74
  v_fmamk_f32 v72, v23, 0x42140000, v38
  v_cos_f32 v73, v72
  v_sin_f32 v74, v72
  s_nop 0
  v_cvt_pk_bf16_f32 v51, v73, -v74
  v_fmamk_f32 v72, v23, 0x42400000, v38
  v_cos_f32 v73, v72
  v_sin_f32 v74, v72
  s_nop 0
  v_cvt_pk_bf16_f32 v52, v73, -v74
  v_fmamk_f32 v72, v23, 0x42440000, v38
  v_cos_f32 v73, v72
  v_sin_f32 v74, v72
  s_nop 0
  v_cvt_pk_bf16_f32 v53, v73, -v74
  v_fmamk_f32 v72, v23, 0x42500000, v38
  v_cos_f32 v73, v72
  v_sin_f32 v74, v72
  s_nop 0
  v_cvt_pk_bf16_f32 v54, v73, -v74
  v_fmamk_f32 v72, v23, 0x42540000, v38
  v_cos_f32 v73, v72
  v_sin_f32 v74, v72
  s_nop 0
  v_cvt_pk_bf16_f32 v55, v73, -v74
  v_lshlrev_b32 v73, 31, v2
  v_or_b32 v73, 0x3f003f00, v73
  v_cmp_eq_u32 vcc, 0, v3
  s_nop 1
  v_cndmask_b32 v40, v40, v73, vcc
  s_lshl_b32 s56, s3, 5
  s_add_u32 s56, s56, 16
  v_add_u32 v72, s56, v2
  v_cvt_f32_u32 v23, v72
  v_mul_f32 v23, 0x3c000000, v23
  v_mul_f32 v38, v23, v39
  v_fmamk_f32 v72, v23, 0x0, v38
  v_cos_f32 v73, v72
  v_sin_f32 v74, v72
  s_nop 0
  v_cvt_pk_bf16_f32 v56, v73, -v74
  v_fmamk_f32 v72, v23, 0x3f800000, v38
  v_cos_f32 v73, v72
  v_sin_f32 v74, v72
  s_nop 0
  v_cvt_pk_bf16_f32 v57, v73, -v74
  v_fmamk_f32 v72, v23, 0x40800000, v38
  v_cos_f32 v73, v72
  v_sin_f32 v74, v72
  s_nop 0
  v_cvt_pk_bf16_f32 v58, v73, -v74
  v_fmamk_f32 v72, v23, 0x40a00000, v38
  v_cos_f32 v73, v72
  v_sin_f32 v74, v72
  s_nop 0
  v_cvt_pk_bf16_f32 v59, v73, -v74
  v_fmamk_f32 v72, v23, 0x41800000, v38
  v_cos_f32 v73, v72
  v_sin_f32 v74, v72
  s_nop 0
  v_cvt_pk_bf16_f32 v60, v73, -v74
  v_fmamk_f32 v72, v23, 0x41880000, v38
  v_cos_f32 v73, v72
  v_sin_f32 v74, v72
  s_nop 0
  v_cvt_pk_bf16_f32 v61, v73, -v74
  v_fmamk_f32 v72, v23, 0x41a00000, v38
  v_cos_f32 v73, v72
  v_sin_f32 v74, v72
  s_nop 0
  v_cvt_pk_bf16_f32 v62, v73, -v74
  v_fmamk_f32 v72, v23, 0x41a80000, v38
  v_cos_f32 v73, v72
  v_sin_f32 v74, v72
  s_nop 0
  v_cvt_pk_bf16_f32 v63, v73, -v74
  v_fmamk_f32 v72, v23, 0x42000000, v38
  v_cos_f32 v73, v72
  v_sin_f32 v74, v72
  s_nop 0
  v_cvt_pk_bf16_f32 v64, v73, -v74
  v_fmamk_f32 v72, v23, 0x42040000, v38
  v_cos_f32 v73, v72
  v_sin_f32 v74, v72
  s_nop 0
  v_cvt_pk_bf16_f32 v65, v73, -v74
  v_fmamk_f32 v72, v23, 0x42100000, v38
  v_cos_f32 v73, v72
  v_sin_f32 v74, v72
  s_nop 0
  v_cvt_pk_bf16_f32 v66, v73, -v74
  v_fmamk_f32 v72, v23, 0x42140000, v38
  v_cos_f32 v73, v72
  v_sin_f32 v74, v72
  s_nop 0
  v_cvt_pk_bf16_f32 v67, v73, -v74
  v_fmamk_f32 v72, v23, 0x42400000, v38
  v_cos_f32 v73, v72
  v_sin_f32 v74, v72
  s_nop 0
  v_cvt_pk_bf16_f32 v68, v73, -v74
  v_fmamk_f32 v72, v23, 0x42440000, v38
  v_cos_f32 v73, v72
  v_sin_f32 v74, v72
  s_nop 0
  v_cvt_pk_bf16_f32 v69, v73, -v74
  v_fmamk_f32 v72, v23, 0x42500000, v38
  v_cos_f32 v73, v72
  v_sin_f32 v74, v72
  s_nop 0
  v_cvt_pk_bf16_f32 v70, v73, -v74
  v_fmamk_f32 v72, v23, 0x42540000, v38
  v_cos_f32 v73, v72
  v_sin_f32 v74, v72
  s_nop 0
  v_cvt_pk_bf16_f32 v71, v73, -v74
  v_lshlrev_b32 v73, 31, v2
  v_or_b32 v73, 0x3f003f00, v73
  v_cmp_eq_u32 vcc, 0, v3
  s_nop 1
  v_cndmask_b32 v56, v56, v73, vcc
  s_waitcnt vmcnt(25)
  v_lshlrev_b32 v72, 16, v4
  v_and_b32 v76, 0xffff0000, v4
  v_lshlrev_b32 v73, 16, v5
  v_and_b32 v77, 0xffff0000, v5
  v_lshlrev_b32 v74, 16, v6
  v_and_b32 v78, 0xffff0000, v6
  v_lshlrev_b32 v75, 16, v7
  v_and_b32 v79, 0xffff0000, v7
  s_waitcnt vmcnt(24)
  v_lshlrev_b32 v80, 16, v8
  v_and_b32 v84, 0xffff0000, v8
  v_lshlrev_b32 v81, 16, v9
  v_and_b32 v85, 0xffff0000, v9
  v_lshlrev_b32 v82, 16, v10
  v_and_b32 v86, 0xffff0000, v10
  v_lshlrev_b32 v83, 16, v11
  v_and_b32 v87, 0xffff0000, v11
  s_waitcnt vmcnt(23)
  v_lshlrev_b32 v88, 16, v12
  v_and_b32 v92, 0xffff0000, v12
  v_lshlrev_b32 v89, 16, v13
  v_and_b32 v93, 0xffff0000, v13
  v_lshlrev_b32 v90, 16, v14
  v_and_b32 v94, 0xffff0000, v14
  v_lshlrev_b32 v91, 16, v15
  v_and_b32 v95, 0xffff0000, v15
  s_waitcnt vmcnt(22)
  v_lshlrev_b32 v96, 16, v16
  v_and_b32 v100, 0xffff0000, v16
  v_lshlrev_b32 v97, 16, v17
  v_and_b32 v101, 0xffff0000, v17
  v_lshlrev_b32 v98, 16, v18
  v_and_b32 v102, 0xffff0000, v18
  v_lshlrev_b32 v99, 16, v19
  v_and_b32 v103, 0xffff0000, v19
  v_pk_add_f32 v[104:105], v[72:73], v[88:89]
  v_pk_add_f32 v[112:113], v[72:73], v[88:89] neg_lo:[0,1] neg_hi:[0,1]
  v_pk_add_f32 v[120:121], v[80:81], v[96:97]
  v_pk_add_f32 v[108:109], v[76:77], v[92:93]
  v_pk_add_f32 v[116:117], v[76:77], v[92:93] neg_lo:[0,1] neg_hi:[0,1]
  v_pk_add_f32 v[124:125], v[84:85], v[100:101]
  v_pk_add_f32 v[128:129], v[100:101], v[84:85] neg_lo:[0,1] neg_hi:[0,1]
  v_pk_add_f32 v[132:133], v[80:81], v[96:97] neg_lo:[0,1] neg_hi:[0,1]
  v_pk_add_f32 v[106:107], v[74:75], v[90:91]
  v_pk_add_f32 v[114:115], v[74:75], v[90:91] neg_lo:[0,1] neg_hi:[0,1]
  v_pk_add_f32 v[122:123], v[82:83], v[98:99]
  v_pk_add_f32 v[110:111], v[78:79], v[94:95]
  v_pk_add_f32 v[118:119], v[78:79], v[94:95] neg_lo:[0,1] neg_hi:[0,1]
  v_pk_add_f32 v[126:127], v[86:87], v[102:103]
  v_pk_add_f32 v[130:131], v[102:103], v[86:87] neg_lo:[0,1] neg_hi:[0,1]
  v_pk_add_f32 v[134:135], v[82:83], v[98:99] neg_lo:[0,1] neg_hi:[0,1]
  s_cmp_lg_u32 s3, 0
  s_cbranch_scc1 kd_kernel_skip1
  s_mov_b64 exec, 15
  v_mul_f32 v120, 2.0, v80
  v_mul_f32 v124, 2.0, v96
  v_mul_f32 v128, -2.0, v84
  v_mul_f32 v132, -2.0, v100
  v_mul_f32 v121, 2.0, v81
  v_mul_f32 v125, 2.0, v97
  v_mul_f32 v129, -2.0, v85
  v_mul_f32 v133, -2.0, v101
  v_mul_f32 v122, 2.0, v82
  v_mul_f32 v126, 2.0, v98
  v_mul_f32 v130, -2.0, v86
  v_mul_f32 v134, -2.0, v102
  v_mul_f32 v123, 2.0, v83
  v_mul_f32 v127, 2.0, v99
  v_mul_f32 v131, -2.0, v87
  v_mul_f32 v135, -2.0, v103
  s_mov_b64 exec, -1
kd_kernel_skip1:
  s_lshl_b32 s56, s3, 10
  s_add_u32 s56, s56, 139264
  v_lshl_add_u32 v23, v1, 4, s56
  v_pk_add_f32 v[72:73], v[104:105], v[120:121]
  v_cvt_pk_bf16_f32 v4, v72, v73
  v_pk_add_f32 v[74:75], v[106:107], v[122:123]
  v_cvt_pk_bf16_f32 v5, v74, v75
  v_pk_add_f32 v[76:77], v[108:109], v[124:125]
  v_cvt_pk_bf16_f32 v6, v76, v77
  v_pk_add_f32 v[78:79], v[110:111], v[126:127]
  v_cvt_pk_bf16_f32 v7, v78, v79
  ds_write_b128 v23, v[4:7] offset:0
  v_pk_add_f32 v[80:81], v[112:113], v[128:129]
  v_cvt_pk_bf16_f32 v8, v80, v81
  v_pk_add_f32 v[82:83], v[114:115], v[130:131]
  v_cvt_pk_bf16_f32 v9, v82, v83
  v_pk_add_f32 v[84:85], v[116:117], v[132:133]
  v_cvt_pk_bf16_f32 v10, v84, v85
  v_pk_add_f32 v[86:87], v[118:119], v[134:135]
  v_cvt_pk_bf16_f32 v11, v86, v87
  ds_write_b128 v23, v[8:11] offset:4096
  v_pk_add_f32 v[88:89], v[104:105], v[120:121] neg_lo:[0,1] neg_hi:[0,1]
  v_cvt_pk_bf16_f32 v12, v88, v89
  v_pk_add_f32 v[90:91], v[106:107], v[122:123] neg_lo:[0,1] neg_hi:[0,1]
  v_cvt_pk_bf16_f32 v13, v90, v91
  v_pk_add_f32 v[92:93], v[108:109], v[124:125] neg_lo:[0,1] neg_hi:[0,1]
  v_cvt_pk_bf16_f32 v14, v92, v93
  v_pk_add_f32 v[94:95], v[110:111], v[126:127] neg_lo:[0,1] neg_hi:[0,1]
  v_cvt_pk_bf16_f32 v15, v94, v95
  ds_write_b128 v23, v[12:15] offset:8192
  v_pk_add_f32 v[96:97], v[112:113], v[128:129] neg_lo:[0,1] neg_hi:[0,1]
  v_cvt_pk_bf16_f32 v16, v96, v97
  v_pk_add_f32 v[98:99], v[114:115], v[130:131] neg_lo:[0,1] neg_hi:[0,1]
  v_cvt_pk_bf16_f32 v17, v98, v99
  v_pk_add_f32 v[100:101], v[116:117], v[132:133] neg_lo:[0,1] neg_hi:[0,1]
  v_cvt_pk_bf16_f32 v18, v100, v101
  v_pk_add_f32 v[102:103], v[118:119], v[134:135] neg_lo:[0,1] neg_hi:[0,1]
  v_cvt_pk_bf16_f32 v19, v102, v103
  ds_write_b128 v23, v[16:19] offset:12288
  s_add_u32 m0, s23, 16384
  s_nop 0
  buffer_load_dwordx4 v32, s[28:31], s17 offen offset:0 lds
  buffer_load_dwordx4 v33, s[28:31], s17 offen offset:1024 lds
  s_add_u32 m0, s22, 8192
  s_nop 0
  buffer_load_dwordx4 v22, s[24:27], s16 offen offset:0  lds
  buffer_load_dwordx4 v22, s[24:27], s16 offen offset:1024  lds
  buffer_load_dwordx4 v22, s[24:27], s16 offen offset:2048  lds
  buffer_load_dwordx4 v22, s[24:27], s16 offen offset:3072  lds
  s_add_u32 s16, s16, 16384
  s_add_u32 m0, s23, 24576
  s_nop 0
  buffer_load_dwordx4 v32, s[32:35], s17 offen offset:0 lds
  buffer_load_dwordx4 v33, s[32:35], s17 offen offset:1024 lds
  s_add_u32 s17, s17, 128
  s_add_u32 m0, s22, 12288
  s_nop 0
  buffer_load_dwordx4 v22, s[24:27], s16 offen offset:0  lds
  buffer_load_dwordx4 v22, s[24:27], s16 offen offset:1024  lds
  buffer_load_dwordx4 v22, s[24:27], s16 offen offset:2048  lds
  buffer_load_dwordx4 v22, s[24:27], s16 offen offset:3072  lds
  s_add_u32 s16, s16, 16384
  s_add_u32 m0, s23, 32768
  s_nop 0
  buffer_load_dwordx4 v32, s[28:31], s17 offen offset:0 lds
  buffer_load_dwordx4 v33, s[28:31], s17 offen offset:1024 lds
  s_add_u32 m0, s22, 16384
  s_nop 0
  buffer_load_dwordx4 v22, s[24:27], s16 offen offset:0  lds
  buffer_load_dwordx4 v22, s[24:27], s16 offen offset:1024  lds
  buffer_load_dwordx4 v22, s[24:27], s16 offen offset:2048  lds
  buffer_load_dwordx4 v22, s[24:27], s16 offen offset:3072  lds
  s_add_u32 s16, s16, 16384
  s_waitcnt vmcnt(30) lgkmcnt(0)
  s_barrier
  v_lshrrev_b32 v4, 5, v1
  v_lshlrev_b32 v4, 9, v4
  v_bfe_u32 v5, v1, 3, 2
  v_lshl_or_b32 v4, v5, 6, v4
  v_and_b32 v5, 3, v1
  v_lshl_or_b32 v4, v5, 4, v4
  v_bfe_u32 v5, v1, 2, 1
  v_lshl_or_b32 v4, v5, 3, v4
  v_add_u32 v4, 139264, v4
  ds_read_b64_tr_b16 v[104:105], v4 offset:0
  ds_read_b64_tr_b16 v[106:107], v4 offset:256
  ds_read_b64_tr_b16 v[108:109], v4 offset:1024
  ds_read_b64_tr_b16 v[110:111], v4 offset:1280
  ds_read_b64_tr_b16 v[112:113], v4 offset:2048
  ds_read_b64_tr_b16 v[114:115], v4 offset:2304
  ds_read_b64_tr_b16 v[116:117], v4 offset:3072
  ds_read_b64_tr_b16 v[118:119], v4 offset:3328
  ds_read_b64_tr_b16 v[120:121], v4 offset:4096
  ds_read_b64_tr_b16 v[122:123], v4 offset:4352
  ds_read_b64_tr_b16 v[124:125], v4 offset:5120
  ds_read_b64_tr_b16 v[126:127], v4 offset:5376
  ds_read_b64_tr_b16 v[128:129], v4 offset:6144
  ds_read_b64_tr_b16 v[130:131], v4 offset:6400
  ds_read_b64_tr_b16 v[132:133], v4 offset:7168
  ds_read_b64_tr_b16 v[134:135], v4 offset:7424
  s_waitcnt lgkmcnt(14)
  v_mfma_f32_16x16x32_bf16 v[72:75], v[104:107], v[40:43], 0
  v_mfma_f32_16x16x32_bf16 v[76:79], v[104:107], v[56:59], 0
  s_waitcnt lgkmcnt(12)
  v_mfma_f32_16x16x32_bf16 v[72:75], v[108:111], v[44:47], v[72:75]
  v_mfma_f32_16x16x32_bf16 v[76:79], v[108:111], v[60:63], v[76:79]
  s_waitcnt lgkmcnt(10)
  v_mfma_f32_16x16x32_bf16 v[72:75], v[112:115], v[48:51], v[72:75]
  v_mfma_f32_16x16x32_bf16 v[76:79], v[112:115], v[64:67], v[76:79]
  s_waitcnt lgkmcnt(8)
  v_mfma_f32_16x16x32_bf16 v[72:75], v[116:119], v[52:55], v[72:75]
  v_mfma_f32_16x16x32_bf16 v[76:79], v[116:119], v[68:71], v[76:79]
  ds_read_b64_tr_b16 v[104:105], v4 offset:8192
  ds_read_b64_tr_b16 v[106:107], v4 offset:8448
  ds_read_b64_tr_b16 v[108:109], v4 offset:9216
  ds_read_b64_tr_b16 v[110:111], v4 offset:9472
  ds_read_b64_tr_b16 v[112:113], v4 offset:10240
  ds_read_b64_tr_b16 v[114:115], v4 offset:10496
  ds_read_b64_tr_b16 v[116:117], v4 offset:11264
  ds_read_b64_tr_b16 v[118:119], v4 offset:11520
  s_waitcnt lgkmcnt(14)
  v_mfma_f32_16x16x32_bf16 v[80:83], v[120:123], v[40:43], 0
  v_mfma_f32_16x16x32_bf16 v[84:87], v[120:123], v[56:59], 0
  s_waitcnt lgkmcnt(12)
  v_mfma_f32_16x16x32_bf16 v[80:83], v[124:127], v[44:47], v[80:83]
  v_mfma_f32_16x16x32_bf16 v[84:87], v[124:127], v[60:63], v[84:87]
  s_waitcnt lgkmcnt(10)
  v_mfma_f32_16x16x32_bf16 v[80:83], v[128:131], v[48:51], v[80:83]
  v_mfma_f32_16x16x32_bf16 v[84:87], v[128:131], v[64:67], v[84:87]
  s_waitcnt lgkmcnt(8)
  v_mfma_f32_16x16x32_bf16 v[80:83], v[132:135], v[52:55], v[80:83]
  v_mfma_f32_16x16x32_bf16 v[84:87], v[132:135], v[68:71], v[84:87]
  ds_read_b64_tr_b16 v[120:121], v4 offset:12288
  ds_read_b64_tr_b16 v[122:123], v4 offset:12544
  ds_read_b64_tr_b16 v[124:125], v4 offset:13312
  ds_read_b64_tr_b16 v[126:127], v4 offset:13568
  ds_read_b64_tr_b16 v[128:129], v4 offset:14336
  ds_read_b64_tr_b16 v[130:131], v4 offset:14592
  ds_read_b64_tr_b16 v[132:133], v4 offset:15360
  ds_read_b64_tr_b16 v[134:135], v4 offset:15616
  s_waitcnt lgkmcnt(14)
  v_mfma_f32_16x16x32_bf16 v[88:91], v[104:107], v[40:43], 0
  v_mfma_f32_16x16x32_bf16 v[92:95], v[104:107], v[56:59], 0
  s_waitcnt lgkmcnt(12)
  v_mfma_f32_16x16x32_bf16 v[88:91], v[108:111], v[44:47], v[88:91]
  v_mfma_f32_16x16x32_bf16 v[92:95], v[108:111], v[60:63], v[92:95]
  s_waitcnt lgkmcnt(10)
  v_mfma_f32_16x16x32_bf16 v[88:91], v[112:115], v[48:51], v[88:91]
  v_mfma_f32_16x16x32_bf16 v[92:95], v[112:115], v[64:67], v[92:95]
  s_waitcnt lgkmcnt(8)
  v_mfma_f32_16x16x32_bf16 v[88:91], v[116:119], v[52:55], v[88:91]
  v_mfma_f32_16x16x32_bf16 v[92:95], v[116:119], v[68:71], v[92:95]
  s_waitcnt lgkmcnt(6)
  v_mfma_f32_16x16x32_bf16 v[96:99], v[120:123], v[40:43], 0
  v_mfma_f32_16x16x32_bf16 v[100:103], v[120:123], v[56:59], 0
  s_waitcnt lgkmcnt(4)
  v_mfma_f32_16x16x32_bf16 v[96:99], v[124:127], v[44:47], v[96:99]
  v_mfma_f32_16x16x32_bf16 v[100:103], v[124:127], v[60:63], v[100:103]
  s_waitcnt lgkmcnt(2)
  v_mfma_f32_16x16x32_bf16 v[96:99], v[128:131], v[48:51], v[96:99]
  v_mfma_f32_16x16x32_bf16 v[100:103], v[128:131], v[64:67], v[100:103]
  s_waitcnt lgkmcnt(0)
  v_mfma_f32_16x16x32_bf16 v[96:99], v[132:135], v[52:55], v[96:99]
  v_mfma_f32_16x16x32_bf16 v[100:103], v[132:135], v[68:71], v[100:103]
  s_lshl_b32 s56, s3, 12
  s_add_u32 s56, s56, 122880
  v_lshlrev_b32 v38, 7, v2
  v_lshl_or_b32 v38, v3, 3, v38
  v_add_u32 v38, s56, v38
  v_bfe_u32 v39, v2, 1, 2
  v_xor_b32 v40, 0, v39
  v_lshl_add_u32 v40, v40, 5, v38
  ds_read_b64 v[4:5], v40 offset:0
  ds_read_b64 v[6:7], v40 offset:2048
  v_xor_b32 v41, 1, v39
  v_lshl_add_u32 v41, v41, 5, v38
  ds_read_b64 v[8:9], v41 offset:0
  ds_read_b64 v[10:11], v41 offset:2048
  v_xor_b32 v42, 2, v39
  v_lshl_add_u32 v42, v42, 5, v38
  ds_read_b64 v[12:13], v42 offset:0
  ds_read_b64 v[14:15], v42 offset:2048
  v_xor_b32 v43, 3, v39
  v_lshl_add_u32 v43, v43, 5, v38
  ds_read_b64 v[16:17], v43 offset:0
  ds_read_b64 v[18:19], v43 offset:2048
  v_mul_f32 v52, 0x35800000, v20
  v_sub_f32 v54, 1.0, v20
  v_cvt_pk_bf16_f32 v54, v54, v54
  v_and_b32 v54, 0xffff0000, v54
  v_mul_f32 v53, 0x35800000, v21
  v_sub_f32 v55, 1.0, v21
  v_cvt_pk_bf16_f32 v55, v55, v55
  v_and_b32 v55, 0xffff0000, v55
  v_lshlrev_b32 v44, 16, v24
  v_and_b32 v45, 0xffff0000, v24
  v_lshlrev_b32 v46, 16, v25
  v_and_b32 v47, 0xffff0000, v25
  s_waitcnt lgkmcnt(7)
  v_lshlrev_b32 v48, 16, v4
  v_and_b32 v49, 0xffff0000, v4
  v_pk_mul_f32 v[72:73], v[52:53], v[72:73] op_sel:[0,0] op_sel_hi:[0,1]
  v_pk_mul_f32 v[48:49], v[48:49], v[44:45]
  v_pk_fma_f32 v[72:73], v[54:55], v[48:49], v[72:73] op_sel:[0,0,0] op_sel_hi:[0,1,1]
  v_lshlrev_b32 v50, 16, v5
  v_and_b32 v51, 0xffff0000, v5
  v_pk_mul_f32 v[74:75], v[52:53], v[74:75] op_sel:[0,0] op_sel_hi:[0,1]
  v_pk_mul_f32 v[50:51], v[50:51], v[46:47]
  v_pk_fma_f32 v[74:75], v[54:55], v[50:51], v[74:75] op_sel:[0,0,0] op_sel_hi:[0,1,1]
  s_waitcnt lgkmcnt(6)
  v_lshlrev_b32 v48, 16, v6
  v_and_b32 v49, 0xffff0000, v6
  v_pk_mul_f32 v[76:77], v[52:53], v[76:77] op_sel:[1,0] op_sel_hi:[1,1]
  v_pk_mul_f32 v[48:49], v[48:49], v[44:45]
  v_pk_fma_f32 v[76:77], v[54:55], v[48:49], v[76:77] op_sel:[1,0,0] op_sel_hi:[1,1,1]
  v_lshlrev_b32 v50, 16, v7
  v_and_b32 v51, 0xffff0000, v7
  v_pk_mul_f32 v[78:79], v[52:53], v[78:79] op_sel:[1,0] op_sel_hi:[1,1]
  v_pk_mul_f32 v[50:51], v[50:51], v[46:47]
  v_pk_fma_f32 v[78:79], v[54:55], v[50:51], v[78:79] op_sel:[1,0,0] op_sel_hi:[1,1,1]
  v_lshlrev_b32 v44, 16, v26
  v_and_b32 v45, 0xffff0000, v26
  v_lshlrev_b32 v46, 16, v27
  v_and_b32 v47, 0xffff0000, v27
  s_waitcnt lgkmcnt(5)
  v_lshlrev_b32 v48, 16, v8
  v_and_b32 v49, 0xffff0000, v8
  v_pk_mul_f32 v[80:81], v[52:53], v[80:81] op_sel:[0,0] op_sel_hi:[0,1]
  v_pk_mul_f32 v[48:49], v[48:49], v[44:45]
  v_pk_fma_f32 v[80:81], v[54:55], v[48:49], v[80:81] op_sel:[0,0,0] op_sel_hi:[0,1,1]
  v_lshlrev_b32 v50, 16, v9
  v_and_b32 v51, 0xffff0000, v9
  v_pk_mul_f32 v[82:83], v[52:53], v[82:83] op_sel:[0,0] op_sel_hi:[0,1]
  v_pk_mul_f32 v[50:51], v[50:51], v[46:47]
  v_pk_fma_f32 v[82:83], v[54:55], v[50:51], v[82:83] op_sel:[0,0,0] op_sel_hi:[0,1,1]
  s_waitcnt lgkmcnt(4)
  v_lshlrev_b32 v48, 16, v10
  v_and_b32 v49, 0xffff0000, v10
  v_pk_mul_f32 v[84:85], v[52:53], v[84:85] op_sel:[1,0] op_sel_hi:[1,1]
  v_pk_mul_f32 v[48:49], v[48:49], v[44:45]
  v_pk_fma_f32 v[84:85], v[54:55], v[48:49], v[84:85] op_sel:[1,0,0] op_sel_hi:[1,1,1]
  v_lshlrev_b32 v50, 16, v11
  v_and_b32 v51, 0xffff0000, v11
  v_pk_mul_f32 v[86:87], v[52:53], v[86:87] op_sel:[1,0] op_sel_hi:[1,1]
  v_pk_mul_f32 v[50:51], v[50:51], v[46:47]
  v_pk_fma_f32 v[86:87], v[54:55], v[50:51], v[86:87] op_sel:[1,0,0] op_sel_hi:[1,1,1]
  v_lshlrev_b32 v44, 16, v28
  v_and_b32 v45, 0xffff0000, v28
  v_lshlrev_b32 v46, 16, v29
  v_and_b32 v47, 0xffff0000, v29
  s_waitcnt lgkmcnt(3)
  v_lshlrev_b32 v48, 16, v12
  v_and_b32 v49, 0xffff0000, v12
  v_pk_mul_f32 v[88:89], v[52:53], v[88:89] op_sel:[0,0] op_sel_hi:[0,1]
  v_pk_mul_f32 v[48:49], v[48:49], v[44:45]
  v_pk_fma_f32 v[88:89], v[54:55], v[48:49], v[88:89] op_sel:[0,0,0] op_sel_hi:[0,1,1]
  v_lshlrev_b32 v50, 16, v13
  v_and_b32 v51, 0xffff0000, v13
  v_pk_mul_f32 v[90:91], v[52:53], v[90:91] op_sel:[0,0] op_sel_hi:[0,1]
  v_pk_mul_f32 v[50:51], v[50:51], v[46:47]
  v_pk_fma_f32 v[90:91], v[54:55], v[50:51], v[90:91] op_sel:[0,0,0] op_sel_hi:[0,1,1]
  s_waitcnt lgkmcnt(2)
  v_lshlrev_b32 v48, 16, v14
  v_and_b32 v49, 0xffff0000, v14
  v_pk_mul_f32 v[92:93], v[52:53], v[92:93] op_sel:[1,0] op_sel_hi:[1,1]
  v_pk_mul_f32 v[48:49], v[48:49], v[44:45]
  v_pk_fma_f32 v[92:93], v[54:55], v[48:49], v[92:93] op_sel:[1,0,0] op_sel_hi:[1,1,1]
  v_lshlrev_b32 v50, 16, v15
  v_and_b32 v51, 0xffff0000, v15
  v_pk_mul_f32 v[94:95], v[52:53], v[94:95] op_sel:[1,0] op_sel_hi:[1,1]
  v_pk_mul_f32 v[50:51], v[50:51], v[46:47]
  v_pk_fma_f32 v[94:95], v[54:55], v[50:51], v[94:95] op_sel:[1,0,0] op_sel_hi:[1,1,1]
  v_lshlrev_b32 v44, 16, v30
  v_and_b32 v45, 0xffff0000, v30
  v_lshlrev_b32 v46, 16, v31
  v_and_b32 v47, 0xffff0000, v31
  s_waitcnt lgkmcnt(1)
  v_lshlrev_b32 v48, 16, v16
  v_and_b32 v49, 0xffff0000, v16
  v_pk_mul_f32 v[96:97], v[52:53], v[96:97] op_sel:[0,0] op_sel_hi:[0,1]
  v_pk_mul_f32 v[48:49], v[48:49], v[44:45]
  v_pk_fma_f32 v[96:97], v[54:55], v[48:49], v[96:97] op_sel:[0,0,0] op_sel_hi:[0,1,1]
  v_lshlrev_b32 v50, 16, v17
  v_and_b32 v51, 0xffff0000, v17
  v_pk_mul_f32 v[98:99], v[52:53], v[98:99] op_sel:[0,0] op_sel_hi:[0,1]
  v_pk_mul_f32 v[50:51], v[50:51], v[46:47]
  v_pk_fma_f32 v[98:99], v[54:55], v[50:51], v[98:99] op_sel:[0,0,0] op_sel_hi:[0,1,1]
  s_waitcnt lgkmcnt(0)
  v_lshlrev_b32 v48, 16, v18
  v_and_b32 v49, 0xffff0000, v18
  v_pk_mul_f32 v[100:101], v[52:53], v[100:101] op_sel:[1,0] op_sel_hi:[1,1]
  v_pk_mul_f32 v[48:49], v[48:49], v[44:45]
  v_pk_fma_f32 v[100:101], v[54:55], v[48:49], v[100:101] op_sel:[1,0,0] op_sel_hi:[1,1,1]
  v_lshlrev_b32 v50, 16, v19
  v_and_b32 v51, 0xffff0000, v19
  v_pk_mul_f32 v[102:103], v[52:53], v[102:103] op_sel:[1,0] op_sel_hi:[1,1]
  v_pk_mul_f32 v[50:51], v[50:51], v[46:47]
  v_pk_fma_f32 v[102:103], v[54:55], v[50:51], v[102:103] op_sel:[1,0,0] op_sel_hi:[1,1,1]
  s_waitcnt vmcnt(24)
  s_barrier
  ds_read_b64_tr_b16 v[136:137], v34 offset:0
  ds_read_b64_tr_b16 v[138:139], v35 offset:0
  ds_read_b128 v[144:147], v36 offset:0
  ds_read_b64_tr_b16 v[140:141], v34 offset:2048
  ds_read_b64_tr_b16 v[142:143], v35 offset:2048
  ds_read_b128 v[148:151], v36 offset:2048
  ds_read_b128 v[152:155], v36 offset:4096
  ds_read_b128 v[156:159], v36 offset:6144
  s_waitcnt lgkmcnt(5)
  v_mfma_f32_16x16x32_bf16 v[104:107], v[144:147], v[136:139], 0
  ds_read_b64_tr_b16 v[160:161], v34 offset:256
  ds_read_b64_tr_b16 v[162:163], v35 offset:256
  s_waitcnt lgkmcnt(5)
  v_mfma_f32_16x16x32_bf16 v[108:111], v[144:147], v[140:143], 0
  ds_read_b128 v[168:171], v37 offset:0
  ds_read_b64_tr_b16 v[164:165], v34 offset:2304
  s_waitcnt lgkmcnt(6)
  v_mfma_f32_16x16x32_bf16 v[112:115], v[148:151], v[136:139], 0
  ds_read_b64_tr_b16 v[166:167], v35 offset:2304
  ds_read_b128 v[172:175], v37 offset:2048
  v_mfma_f32_16x16x32_bf16 v[116:119], v[148:151], v[140:143], 0
  ds_read_b128 v[176:179], v37 offset:4096
  ds_read_b128 v[180:183], v37 offset:6144
  s_waitcnt lgkmcnt(9)
  v_mfma_f32_16x16x32_bf16 v[120:123], v[152:155], v[136:139], 0
  v_mfma_f32_16x16x32_bf16 v[124:127], v[152:155], v[140:143], 0
  s_waitcnt lgkmcnt(8)
  v_mfma_f32_16x16x32_bf16 v[128:131], v[156:159], v[136:139], 0
  v_mfma_f32_16x16x32_bf16 v[132:135], v[156:159], v[140:143], 0
  s_waitcnt vmcnt(18) lgkmcnt(0)
  s_barrier
  v_mfma_f32_16x16x32_bf16 v[104:107], v[168:171], v[160:163], v[104:107]
  ds_read_b64_tr_b16 v[136:137], v34 offset:4096
  ds_read_b64_tr_b16 v[138:139], v35 offset:4096
  v_mfma_f32_16x16x32_bf16 v[108:111], v[168:171], v[164:167], v[108:111]
  ds_read_b128 v[144:147], v36 offset:8192
  ds_read_b64_tr_b16 v[140:141], v34 offset:6144
  v_mfma_f32_16x16x32_bf16 v[112:115], v[172:175], v[160:163], v[112:115]
  ds_read_b64_tr_b16 v[142:143], v35 offset:6144
  ds_read_b128 v[148:151], v36 offset:10240
  v_mfma_f32_16x16x32_bf16 v[116:119], v[172:175], v[164:167], v[116:119]
  ds_read_b128 v[152:155], v36 offset:12288
  ds_read_b128 v[156:159], v36 offset:14336
  v_mfma_f32_16x16x32_bf16 v[120:123], v[176:179], v[160:163], v[120:123]
  s_add_u32 m0, s23, 0
  s_nop 0
  buffer_load_dwordx4 v32, s[32:35], s17 offen offset:0 lds
  v_mfma_f32_16x16x32_bf16 v[124:127], v[176:179], v[164:167], v[124:127]
  buffer_load_dwordx4 v33, s[32:35], s17 offen offset:1024 lds
  s_add_u32 s17, s17, 128
  v_mfma_f32_16x16x32_bf16 v[128:131], v[180:183], v[160:163], v[128:131]
  s_add_u32 m0, s22, 0
  s_nop 0
  buffer_load_dwordx4 v22, s[24:27], s16 offen offset:0  lds
  v_mfma_f32_16x16x32_bf16 v[132:135], v[180:183], v[164:167], v[132:135]
  s_waitcnt lgkmcnt(5)
  v_mfma_f32_16x16x32_bf16 v[104:107], v[144:147], v[136:139], v[104:107]
  ds_read_b64_tr_b16 v[160:161], v34 offset:4352
  ds_read_b64_tr_b16 v[162:163], v35 offset:4352
  s_waitcnt lgkmcnt(5)
  v_mfma_f32_16x16x32_bf16 v[108:111], v[144:147], v[140:143], v[108:111]
  ds_read_b128 v[168:171], v37 offset:8192
  ds_read_b64_tr_b16 v[164:165], v34 offset:6400
  s_waitcnt lgkmcnt(6)
  v_mfma_f32_16x16x32_bf16 v[112:115], v[148:151], v[136:139], v[112:115]
  ds_read_b64_tr_b16 v[166:167], v35 offset:6400
  ds_read_b128 v[172:175], v37 offset:10240
  v_mfma_f32_16x16x32_bf16 v[116:119], v[148:151], v[140:143], v[116:119]
  ds_read_b128 v[176:179], v37 offset:12288
  ds_read_b128 v[180:183], v37 offset:14336
  s_waitcnt lgkmcnt(9)
  v_mfma_f32_16x16x32_bf16 v[120:123], v[152:155], v[136:139], v[120:123]
  buffer_load_dwordx4 v22, s[24:27], s16 offen offset:1024  lds
  v_mfma_f32_16x16x32_bf16 v[124:127], v[152:155], v[140:143], v[124:127]
  buffer_load_dwordx4 v22, s[24:27], s16 offen offset:2048  lds
  s_waitcnt lgkmcnt(8)
  v_mfma_f32_16x16x32_bf16 v[128:131], v[156:159], v[136:139], v[128:131]
  buffer_load_dwordx4 v22, s[24:27], s16 offen offset:3072  lds
  s_add_u32 s16, s16, 16384
  v_mfma_f32_16x16x32_bf16 v[132:135], v[156:159], v[140:143], v[132:135]
  s_waitcnt vmcnt(18) lgkmcnt(0)
  s_barrier
  v_mfma_f32_16x16x32_bf16 v[104:107], v[168:171], v[160:163], v[104:107]
  ds_read_b64_tr_b16 v[136:137], v34 offset:8192
  ds_read_b64_tr_b16 v[138:139], v35 offset:8192
  v_mfma_f32_16x16x32_bf16 v[108:111], v[168:171], v[164:167], v[108:111]
  ds_read_b128 v[144:147], v36 offset:16384
  ds_read_b64_tr_b16 v[140:141], v34 offset:10240
  v_mfma_f32_16x16x32_bf16 v[112:115], v[172:175], v[160:163], v[112:115]
  ds_read_b64_tr_b16 v[142:143], v35 offset:10240
  ds_read_b128 v[148:151], v36 offset:18432
  v_mfma_f32_16x16x32_bf16 v[116:119], v[172:175], v[164:167], v[116:119]
  ds_read_b128 v[152:155], v36 offset:20480
  ds_read_b128 v[156:159], v36 offset:22528
  v_mfma_f32_16x16x32_bf16 v[120:123], v[176:179], v[160:163], v[120:123]
  s_add_u32 m0, s23, 8192
  s_nop 0
  buffer_load_dwordx4 v32, s[28:31], s17 offen offset:0 lds
  v_mfma_f32_16x16x32_bf16 v[124:127], v[176:179], v[164:167], v[124:127]
  buffer_load_dwordx4 v33, s[28:31], s17 offen offset:1024 lds
  v_mfma_f32_16x16x32_bf16 v[128:131], v[180:183], v[160:163], v[128:131]
  s_add_u32 m0, s22, 4096
  s_nop 0
  buffer_load_dwordx4 v22, s[24:27], s16 offen offset:0  lds
  v_mfma_f32_16x16x32_bf16 v[132:135], v[180:183], v[164:167], v[132:135]
  s_waitcnt lgkmcnt(5)
  v_mfma_f32_16x16x32_bf16 v[104:107], v[144:147], v[136:139], v[104:107]
  ds_read_b64_tr_b16 v[160:161], v34 offset:8448
  ds_read_b64_tr_b16 v[162:163], v35 offset:8448
  s_waitcnt lgkmcnt(5)
  v_mfma_f32_16x16x32_bf16 v[108:111], v[144:147], v[140:143], v[108:111]
  ds_read_b128 v[168:171], v37 offset:16384
  ds_read_b64_tr_b16 v[164:165], v34 offset:10496
  s_waitcnt lgkmcnt(6)
  v_mfma_f32_16x16x32_bf16 v[112:115], v[148:151], v[136:139], v[112:115]
  ds_read_b64_tr_b16 v[166:167], v35 offset:10496
  ds_read_b128 v[172:175], v37 offset:18432
  v_mfma_f32_16x16x32_bf16 v[116:119], v[148:151], v[140:143], v[116:119]
  ds_read_b128 v[176:179], v37 offset:20480
  ds_read_b128 v[180:183], v37 offset:22528
  s_waitcnt lgkmcnt(9)
  v_mfma_f32_16x16x32_bf16 v[120:123], v[152:155], v[136:139], v[120:123]
  buffer_load_dwordx4 v22, s[24:27], s16 offen offset:1024  lds
  v_mfma_f32_16x16x32_bf16 v[124:127], v[152:155], v[140:143], v[124:127]
  buffer_load_dwordx4 v22, s[24:27], s16 offen offset:2048  lds
  s_waitcnt lgkmcnt(8)
  v_mfma_f32_16x16x32_bf16 v[128:131], v[156:159], v[136:139], v[128:131]
  buffer_load_dwordx4 v22, s[24:27], s16 offen offset:3072  lds
  s_add_u32 s16, s16, 16384
  v_mfma_f32_16x16x32_bf16 v[132:135], v[156:159], v[140:143], v[132:135]
  s_waitcnt vmcnt(18) lgkmcnt(0)
  s_barrier
  v_mfma_f32_16x16x32_bf16 v[104:107], v[168:171], v[160:163], v[104:107]
  ds_read_b64_tr_b16 v[136:137], v34 offset:12288
  ds_read_b64_tr_b16 v[138:139], v35 offset:12288
  v_mfma_f32_16x16x32_bf16 v[108:111], v[168:171], v[164:167], v[108:111]
  ds_read_b128 v[144:147], v36 offset:24576
  ds_read_b64_tr_b16 v[140:141], v34 offset:14336
  v_mfma_f32_16x16x32_bf16 v[112:115], v[172:175], v[160:163], v[112:115]
  ds_read_b64_tr_b16 v[142:143], v35 offset:14336
  ds_read_b128 v[148:151], v36 offset:26624
  v_mfma_f32_16x16x32_bf16 v[116:119], v[172:175], v[164:167], v[116:119]
  ds_read_b128 v[152:155], v36 offset:28672
  ds_read_b128 v[156:159], v36 offset:30720
  v_mfma_f32_16x16x32_bf16 v[120:123], v[176:179], v[160:163], v[120:123]
  s_add_u32 m0, s23, 16384
  s_nop 0
  buffer_load_dwordx4 v32, s[32:35], s17 offen offset:0 lds
  v_mfma_f32_16x16x32_bf16 v[124:127], v[176:179], v[164:167], v[124:127]
  buffer_load_dwordx4 v33, s[32:35], s17 offen offset:1024 lds
  s_add_u32 s17, s17, 128
  v_mfma_f32_16x16x32_bf16 v[128:131], v[180:183], v[160:163], v[128:131]
  s_add_u32 m0, s22, 8192
  s_nop 0
  buffer_load_dwordx4 v22, s[24:27], s16 offen offset:0  lds
  v_mfma_f32_16x16x32_bf16 v[132:135], v[180:183], v[164:167], v[132:135]
  s_waitcnt lgkmcnt(5)
  v_mfma_f32_16x16x32_bf16 v[104:107], v[144:147], v[136:139], v[104:107]
  ds_read_b64_tr_b16 v[160:161], v34 offset:12544
  ds_read_b64_tr_b16 v[162:163], v35 offset:12544
  s_waitcnt lgkmcnt(5)
  v_mfma_f32_16x16x32_bf16 v[108:111], v[144:147], v[140:143], v[108:111]
  ds_read_b128 v[168:171], v37 offset:24576
  ds_read_b64_tr_b16 v[164:165], v34 offset:14592
  s_waitcnt lgkmcnt(6)
  v_mfma_f32_16x16x32_bf16 v[112:115], v[148:151], v[136:139], v[112:115]
  ds_read_b64_tr_b16 v[166:167], v35 offset:14592
  ds_read_b128 v[172:175], v37 offset:26624
  v_mfma_f32_16x16x32_bf16 v[116:119], v[148:151], v[140:143], v[116:119]
  ds_read_b128 v[176:179], v37 offset:28672
  ds_read_b128 v[180:183], v37 offset:30720
  s_waitcnt lgkmcnt(9)
  v_mfma_f32_16x16x32_bf16 v[120:123], v[152:155], v[136:139], v[120:123]
  buffer_load_dwordx4 v22, s[24:27], s16 offen offset:1024  lds
  v_mfma_f32_16x16x32_bf16 v[124:127], v[152:155], v[140:143], v[124:127]
  buffer_load_dwordx4 v22, s[24:27], s16 offen offset:2048  lds
  s_waitcnt lgkmcnt(8)
  v_mfma_f32_16x16x32_bf16 v[128:131], v[156:159], v[136:139], v[128:131]
  buffer_load_dwordx4 v22, s[24:27], s16 offen offset:3072  lds
  s_add_u32 s16, s16, 16384
  v_mfma_f32_16x16x32_bf16 v[132:135], v[156:159], v[140:143], v[132:135]
  s_waitcnt vmcnt(18) lgkmcnt(0)
  s_barrier
  v_mfma_f32_16x16x32_bf16 v[104:107], v[168:171], v[160:163], v[104:107]
  ds_read_b64_tr_b16 v[136:137], v34 offset:16384
  ds_read_b64_tr_b16 v[138:139], v35 offset:16384
  v_mfma_f32_16x16x32_bf16 v[108:111], v[168:171], v[164:167], v[108:111]
  ds_read_b128 v[144:147], v36 offset:32768
  ds_read_b64_tr_b16 v[140:141], v34 offset:18432
  v_mfma_f32_16x16x32_bf16 v[112:115], v[172:175], v[160:163], v[112:115]
  ds_read_b64_tr_b16 v[142:143], v35 offset:18432
  ds_read_b128 v[148:151], v36 offset:34816
  v_mfma_f32_16x16x32_bf16 v[116:119], v[172:175], v[164:167], v[116:119]
  ds_read_b128 v[152:155], v36 offset:36864
  ds_read_b128 v[156:159], v36 offset:38912
  v_mfma_f32_16x16x32_bf16 v[120:123], v[176:179], v[160:163], v[120:123]
  s_add_u32 m0, s23, 24576
  s_nop 0
  buffer_load_dwordx4 v32, s[28:31], s17 offen offset:0 lds
  v_mfma_f32_16x16x32_bf16 v[124:127], v[176:179], v[164:167], v[124:127]
  buffer_load_dwordx4 v33, s[28:31], s17 offen offset:1024 lds
  v_mfma_f32_16x16x32_bf16 v[128:131], v[180:183], v[160:163], v[128:131]
  s_add_u32 m0, s22, 12288
  s_nop 0
  buffer_load_dwordx4 v22, s[24:27], s16 offen offset:0  lds
  v_mfma_f32_16x16x32_bf16 v[132:135], v[180:183], v[164:167], v[132:135]
  s_waitcnt lgkmcnt(5)
  v_mfma_f32_16x16x32_bf16 v[104:107], v[144:147], v[136:139], v[104:107]
  ds_read_b64_tr_b16 v[160:161], v34 offset:16640
  ds_read_b64_tr_b16 v[162:163], v35 offset:16640
  s_waitcnt lgkmcnt(5)
  v_mfma_f32_16x16x32_bf16 v[108:111], v[144:147], v[140:143], v[108:111]
  ds_read_b128 v[168:171], v37 offset:32768
  ds_read_b64_tr_b16 v[164:165], v34 offset:18688
  s_waitcnt lgkmcnt(6)
  v_mfma_f32_16x16x32_bf16 v[112:115], v[148:151], v[136:139], v[112:115]
  ds_read_b64_tr_b16 v[166:167], v35 offset:18688
  ds_read_b128 v[172:175], v37 offset:34816
  v_mfma_f32_16x16x32_bf16 v[116:119], v[148:151], v[140:143], v[116:119]
  ds_read_b128 v[176:179], v37 offset:36864
  ds_read_b128 v[180:183], v37 offset:38912
  s_waitcnt lgkmcnt(9)
  v_mfma_f32_16x16x32_bf16 v[120:123], v[152:155], v[136:139], v[120:123]
  buffer_load_dwordx4 v22, s[24:27], s16 offen offset:1024  lds
  v_mfma_f32_16x16x32_bf16 v[124:127], v[152:155], v[140:143], v[124:127]
  buffer_load_dwordx4 v22, s[24:27], s16 offen offset:2048  lds
  s_waitcnt lgkmcnt(8)
  v_mfma_f32_16x16x32_bf16 v[128:131], v[156:159], v[136:139], v[128:131]
  buffer_load_dwordx4 v22, s[24:27], s16 offen offset:3072  lds
  s_add_u32 s16, s16, 16384
  v_mfma_f32_16x16x32_bf16 v[132:135], v[156:159], v[140:143], v[132:135]
  s_waitcnt vmcnt(18) lgkmcnt(0)
  s_barrier
  v_mfma_f32_16x16x32_bf16 v[104:107], v[168:171], v[160:163], v[104:107]
  ds_read_b64_tr_b16 v[136:137], v34 offset:0
  ds_read_b64_tr_b16 v[138:139], v35 offset:0
  v_mfma_f32_16x16x32_bf16 v[108:111], v[168:171], v[164:167], v[108:111]
  ds_read_b128 v[144:147], v36 offset:0
  ds_read_b64_tr_b16 v[140:141], v34 offset:2048
  v_mfma_f32_16x16x32_bf16 v[112:115], v[172:175], v[160:163], v[112:115]
  ds_read_b64_tr_b16 v[142:143], v35 offset:2048
  ds_read_b128 v[148:151], v36 offset:2048
  v_mfma_f32_16x16x32_bf16 v[116:119], v[172:175], v[164:167], v[116:119]
  ds_read_b128 v[152:155], v36 offset:4096
  ds_read_b128 v[156:159], v36 offset:6144
  v_mfma_f32_16x16x32_bf16 v[120:123], v[176:179], v[160:163], v[120:123]
  s_add_u32 m0, s23, 32768
  s_nop 0
  buffer_load_dwordx4 v32, s[32:35], s17 offen offset:0 lds
  v_mfma_f32_16x16x32_bf16 v[124:127], v[176:179], v[164:167], v[124:127]
  buffer_load_dwordx4 v33, s[32:35], s17 offen offset:1024 lds
  s_add_u32 s17, s17, 128
  v_mfma_f32_16x16x32_bf16 v[128:131], v[180:183], v[160:163], v[128:131]
  s_add_u32 m0, s22, 16384
  s_nop 0
  buffer_load_dwordx4 v22, s[24:27], s16 offen offset:0  lds
  v_mfma_f32_16x16x32_bf16 v[132:135], v[180:183], v[164:167], v[132:135]
  s_waitcnt lgkmcnt(5)
  v_mfma_f32_16x16x32_bf16 v[104:107], v[144:147], v[136:139], v[104:107]
  ds_read_b64_tr_b16 v[160:161], v34 offset:256
  ds_read_b64_tr_b16 v[162:163], v35 offset:256
  s_waitcnt lgkmcnt(5)
  v_mfma_f32_16x16x32_bf16 v[108:111], v[144:147], v[140:143], v[108:111]
  ds_read_b128 v[168:171], v37 offset:0
  ds_read_b64_tr_b16 v[164:165], v34 offset:2304
  s_waitcnt lgkmcnt(6)
  v_mfma_f32_16x16x32_bf16 v[112:115], v[148:151], v[136:139], v[112:115]
  ds_read_b64_tr_b16 v[166:167], v35 offset:2304
  ds_read_b128 v[172:175], v37 offset:2048
  v_mfma_f32_16x16x32_bf16 v[116:119], v[148:151], v[140:143], v[116:119]
  ds_read_b128 v[176:179], v37 offset:4096
  ds_read_b128 v[180:183], v37 offset:6144
  s_waitcnt lgkmcnt(9)
  v_mfma_f32_16x16x32_bf16 v[120:123], v[152:155], v[136:139], v[120:123]
  buffer_load_dwordx4 v22, s[24:27], s16 offen offset:1024  lds
  v_mfma_f32_16x16x32_bf16 v[124:127], v[152:155], v[140:143], v[124:127]
  buffer_load_dwordx4 v22, s[24:27], s16 offen offset:2048  lds
  s_waitcnt lgkmcnt(8)
  v_mfma_f32_16x16x32_bf16 v[128:131], v[156:159], v[136:139], v[128:131]
  buffer_load_dwordx4 v22, s[24:27], s16 offen offset:3072  lds
  s_add_u32 s16, s16, 16384
  v_mfma_f32_16x16x32_bf16 v[132:135], v[156:159], v[140:143], v[132:135]
  s_waitcnt vmcnt(18) lgkmcnt(0)
  s_barrier
  v_mfma_f32_16x16x32_bf16 v[104:107], v[168:171], v[160:163], v[104:107]
  ds_read_b64_tr_b16 v[136:137], v34 offset:4096
  ds_read_b64_tr_b16 v[138:139], v35 offset:4096
  v_mfma_f32_16x16x32_bf16 v[108:111], v[168:171], v[164:167], v[108:111]
  ds_read_b128 v[144:147], v36 offset:8192
  ds_read_b64_tr_b16 v[140:141], v34 offset:6144
  v_mfma_f32_16x16x32_bf16 v[112:115], v[172:175], v[160:163], v[112:115]
  ds_read_b64_tr_b16 v[142:143], v35 offset:6144
  ds_read_b128 v[148:151], v36 offset:10240
  v_mfma_f32_16x16x32_bf16 v[116:119], v[172:175], v[164:167], v[116:119]
  ds_read_b128 v[152:155], v36 offset:12288
  ds_read_b128 v[156:159], v36 offset:14336
  v_mfma_f32_16x16x32_bf16 v[120:123], v[176:179], v[160:163], v[120:123]
  s_add_u32 m0, s23, 0
  s_nop 0
  buffer_load_dwordx4 v32, s[28:31], s17 offen offset:0 lds
  v_mfma_f32_16x16x32_bf16 v[124:127], v[176:179], v[164:167], v[124:127]
  buffer_load_dwordx4 v33, s[28:31], s17 offen offset:1024 lds
  v_mfma_f32_16x16x32_bf16 v[128:131], v[180:183], v[160:163], v[128:131]
  s_add_u32 m0, s22, 0
  s_nop 0
  buffer_load_dwordx4 v22, s[24:27], s16 offen offset:0  lds
  v_mfma_f32_16x16x32_bf16 v[132:135], v[180:183], v[164:167], v[132:135]
  s_waitcnt lgkmcnt(5)
  v_mfma_f32_16x16x32_bf16 v[104:107], v[144:147], v[136:139], v[104:107]
  ds_read_b64_tr_b16 v[160:161], v34 offset:4352
  ds_read_b64_tr_b16 v[162:163], v35 offset:4352
  s_waitcnt lgkmcnt(5)
  v_mfma_f32_16x16x32_bf16 v[108:111], v[144:147], v[140:143], v[108:111]
  ds_read_b128 v[168:171], v37 offset:8192
  ds_read_b64_tr_b16 v[164:165], v34 offset:6400
  s_waitcnt lgkmcnt(6)
  v_mfma_f32_16x16x32_bf16 v[112:115], v[148:151], v[136:139], v[112:115]
  ds_read_b64_tr_b16 v[166:167], v35 offset:6400
  ds_read_b128 v[172:175], v37 offset:10240
  v_mfma_f32_16x16x32_bf16 v[116:119], v[148:151], v[140:143], v[116:119]
  ds_read_b128 v[176:179], v37 offset:12288
  ds_read_b128 v[180:183], v37 offset:14336
  s_waitcnt lgkmcnt(9)
  v_mfma_f32_16x16x32_bf16 v[120:123], v[152:155], v[136:139], v[120:123]
  buffer_load_dwordx4 v22, s[24:27], s16 offen offset:1024  lds
  v_mfma_f32_16x16x32_bf16 v[124:127], v[152:155], v[140:143], v[124:127]
  buffer_load_dwordx4 v22, s[24:27], s16 offen offset:2048  lds
  s_waitcnt lgkmcnt(8)
  v_mfma_f32_16x16x32_bf16 v[128:131], v[156:159], v[136:139], v[128:131]
  buffer_load_dwordx4 v22, s[24:27], s16 offen offset:3072  lds
  s_add_u32 s16, s16, 16384
  v_mfma_f32_16x16x32_bf16 v[132:135], v[156:159], v[140:143], v[132:135]
  s_waitcnt vmcnt(18) lgkmcnt(0)
  s_barrier
  v_mfma_f32_16x16x32_bf16 v[104:107], v[168:171], v[160:163], v[104:107]
  ds_read_b64_tr_b16 v[136:137], v34 offset:8192
  ds_read_b64_tr_b16 v[138:139], v35 offset:8192
  v_mfma_f32_16x16x32_bf16 v[108:111], v[168:171], v[164:167], v[108:111]
  ds_read_b128 v[144:147], v36 offset:16384
  ds_read_b64_tr_b16 v[140:141], v34 offset:10240
  v_mfma_f32_16x16x32_bf16 v[112:115], v[172:175], v[160:163], v[112:115]
  ds_read_b64_tr_b16 v[142:143], v35 offset:10240
  ds_read_b128 v[148:151], v36 offset:18432
  v_mfma_f32_16x16x32_bf16 v[116:119], v[172:175], v[164:167], v[116:119]
  ds_read_b128 v[152:155], v36 offset:20480
  ds_read_b128 v[156:159], v36 offset:22528
  v_mfma_f32_16x16x32_bf16 v[120:123], v[176:179], v[160:163], v[120:123]
  s_add_u32 m0, s23, 8192
  s_nop 0
  buffer_load_dwordx4 v32, s[32:35], s17 offen offset:0 lds
  v_mfma_f32_16x16x32_bf16 v[124:127], v[176:179], v[164:167], v[124:127]
  buffer_load_dwordx4 v33, s[32:35], s17 offen offset:1024 lds
  s_add_u32 s17, s17, 128
  v_mfma_f32_16x16x32_bf16 v[128:131], v[180:183], v[160:163], v[128:131]
  s_add_u32 m0, s22, 4096
  s_nop 0
  buffer_load_dwordx4 v22, s[24:27], s16 offen offset:0  lds
  v_mfma_f32_16x16x32_bf16 v[132:135], v[180:183], v[164:167], v[132:135]
  s_waitcnt lgkmcnt(5)
  v_mfma_f32_16x16x32_bf16 v[104:107], v[144:147], v[136:139], v[104:107]
  ds_read_b64_tr_b16 v[160:161], v34 offset:8448
  ds_read_b64_tr_b16 v[162:163], v35 offset:8448
  s_waitcnt lgkmcnt(5)
  v_mfma_f32_16x16x32_bf16 v[108:111], v[144:147], v[140:143], v[108:111]
  ds_read_b128 v[168:171], v37 offset:16384
  ds_read_b64_tr_b16 v[164:165], v34 offset:10496
  s_waitcnt lgkmcnt(6)
  v_mfma_f32_16x16x32_bf16 v[112:115], v[148:151], v[136:139], v[112:115]
  ds_read_b64_tr_b16 v[166:167], v35 offset:10496
  ds_read_b128 v[172:175], v37 offset:18432
  v_mfma_f32_16x16x32_bf16 v[116:119], v[148:151], v[140:143], v[116:119]
  ds_read_b128 v[176:179], v37 offset:20480
  ds_read_b128 v[180:183], v37 offset:22528
  s_waitcnt lgkmcnt(9)
  v_mfma_f32_16x16x32_bf16 v[120:123], v[152:155], v[136:139], v[120:123]
  buffer_load_dwordx4 v22, s[24:27], s16 offen offset:1024  lds
  v_mfma_f32_16x16x32_bf16 v[124:127], v[152:155], v[140:143], v[124:127]
  buffer_load_dwordx4 v22, s[24:27], s16 offen offset:2048  lds
  s_waitcnt lgkmcnt(8)
  v_mfma_f32_16x16x32_bf16 v[128:131], v[156:159], v[136:139], v[128:131]
  buffer_load_dwordx4 v22, s[24:27], s16 offen offset:3072  lds
  s_add_u32 s16, s16, 16384
  v_mfma_f32_16x16x32_bf16 v[132:135], v[156:159], v[140:143], v[132:135]
  s_waitcnt vmcnt(18) lgkmcnt(0)
  s_barrier
  v_mfma_f32_16x16x32_bf16 v[104:107], v[168:171], v[160:163], v[104:107]
  ds_read_b64_tr_b16 v[136:137], v34 offset:12288
  ds_read_b64_tr_b16 v[138:139], v35 offset:12288
  v_mfma_f32_16x16x32_bf16 v[108:111], v[168:171], v[164:167], v[108:111]
  ds_read_b128 v[144:147], v36 offset:24576
  ds_read_b64_tr_b16 v[140:141], v34 offset:14336
  v_mfma_f32_16x16x32_bf16 v[112:115], v[172:175], v[160:163], v[112:115]
  ds_read_b64_tr_b16 v[142:143], v35 offset:14336
  ds_read_b128 v[148:151], v36 offset:26624
  v_mfma_f32_16x16x32_bf16 v[116:119], v[172:175], v[164:167], v[116:119]
  ds_read_b128 v[152:155], v36 offset:28672
  ds_read_b128 v[156:159], v36 offset:30720
  v_mfma_f32_16x16x32_bf16 v[120:123], v[176:179], v[160:163], v[120:123]
  s_add_u32 m0, s23, 16384
  s_nop 0
  buffer_load_dwordx4 v32, s[28:31], s17 offen offset:0 lds
  v_mfma_f32_16x16x32_bf16 v[124:127], v[176:179], v[164:167], v[124:127]
  buffer_load_dwordx4 v33, s[28:31], s17 offen offset:1024 lds
  v_mfma_f32_16x16x32_bf16 v[128:131], v[180:183], v[160:163], v[128:131]
  s_add_u32 m0, s22, 8192
  s_nop 0
  buffer_load_dwordx4 v22, s[24:27], s16 offen offset:0  lds
  v_mfma_f32_16x16x32_bf16 v[132:135], v[180:183], v[164:167], v[132:135]
  s_waitcnt lgkmcnt(5)
  v_mfma_f32_16x16x32_bf16 v[104:107], v[144:147], v[136:139], v[104:107]
  ds_read_b64_tr_b16 v[160:161], v34 offset:12544
  ds_read_b64_tr_b16 v[162:163], v35 offset:12544
  s_waitcnt lgkmcnt(5)
  v_mfma_f32_16x16x32_bf16 v[108:111], v[144:147], v[140:143], v[108:111]
  ds_read_b128 v[168:171], v37 offset:24576
  ds_read_b64_tr_b16 v[164:165], v34 offset:14592
  s_waitcnt lgkmcnt(6)
  v_mfma_f32_16x16x32_bf16 v[112:115], v[148:151], v[136:139], v[112:115]
  ds_read_b64_tr_b16 v[166:167], v35 offset:14592
  ds_read_b128 v[172:175], v37 offset:26624
  v_mfma_f32_16x16x32_bf16 v[116:119], v[148:151], v[140:143], v[116:119]
  ds_read_b128 v[176:179], v37 offset:28672
  ds_read_b128 v[180:183], v37 offset:30720
  s_waitcnt lgkmcnt(9)
  v_mfma_f32_16x16x32_bf16 v[120:123], v[152:155], v[136:139], v[120:123]
  buffer_load_dwordx4 v22, s[24:27], s16 offen offset:1024  lds
  v_mfma_f32_16x16x32_bf16 v[124:127], v[152:155], v[140:143], v[124:127]
  buffer_load_dwordx4 v22, s[24:27], s16 offen offset:2048  lds
  s_waitcnt lgkmcnt(8)
  v_mfma_f32_16x16x32_bf16 v[128:131], v[156:159], v[136:139], v[128:131]
  buffer_load_dwordx4 v22, s[24:27], s16 offen offset:3072  lds
  s_add_u32 s16, s16, 16384
  v_mfma_f32_16x16x32_bf16 v[132:135], v[156:159], v[140:143], v[132:135]
  s_waitcnt vmcnt(18) lgkmcnt(0)
  s_barrier
  v_mfma_f32_16x16x32_bf16 v[104:107], v[168:171], v[160:163], v[104:107]
  ds_read_b64_tr_b16 v[136:137], v34 offset:16384
  ds_read_b64_tr_b16 v[138:139], v35 offset:16384
  v_mfma_f32_16x16x32_bf16 v[108:111], v[168:171], v[164:167], v[108:111]
  ds_read_b128 v[144:147], v36 offset:32768
  ds_read_b64_tr_b16 v[140:141], v34 offset:18432
  v_mfma_f32_16x16x32_bf16 v[112:115], v[172:175], v[160:163], v[112:115]
  ds_read_b64_tr_b16 v[142:143], v35 offset:18432
  ds_read_b128 v[148:151], v36 offset:34816
  v_mfma_f32_16x16x32_bf16 v[116:119], v[172:175], v[164:167], v[116:119]
  ds_read_b128 v[152:155], v36 offset:36864
  ds_read_b128 v[156:159], v36 offset:38912
  v_mfma_f32_16x16x32_bf16 v[120:123], v[176:179], v[160:163], v[120:123]
  s_add_u32 m0, s23, 24576
  s_nop 0
  buffer_load_dwordx4 v32, s[32:35], s17 offen offset:0 lds
  v_mfma_f32_16x16x32_bf16 v[124:127], v[176:179], v[164:167], v[124:127]
  buffer_load_dwordx4 v33, s[32:35], s17 offen offset:1024 lds
  s_add_u32 s17, s17, 128
  v_mfma_f32_16x16x32_bf16 v[128:131], v[180:183], v[160:163], v[128:131]
  s_add_u32 m0, s22, 12288
  s_nop 0
  buffer_load_dwordx4 v22, s[24:27], s16 offen offset:0  lds
  v_mfma_f32_16x16x32_bf16 v[132:135], v[180:183], v[164:167], v[132:135]
  s_waitcnt lgkmcnt(5)
  v_mfma_f32_16x16x32_bf16 v[104:107], v[144:147], v[136:139], v[104:107]
  ds_read_b64_tr_b16 v[160:161], v34 offset:16640
  ds_read_b64_tr_b16 v[162:163], v35 offset:16640
  s_waitcnt lgkmcnt(5)
  v_mfma_f32_16x16x32_bf16 v[108:111], v[144:147], v[140:143], v[108:111]
  ds_read_b128 v[168:171], v37 offset:32768
  ds_read_b64_tr_b16 v[164:165], v34 offset:18688
  s_waitcnt lgkmcnt(6)
  v_mfma_f32_16x16x32_bf16 v[112:115], v[148:151], v[136:139], v[112:115]
  ds_read_b64_tr_b16 v[166:167], v35 offset:18688
  ds_read_b128 v[172:175], v37 offset:34816
  v_mfma_f32_16x16x32_bf16 v[116:119], v[148:151], v[140:143], v[116:119]
  ds_read_b128 v[176:179], v37 offset:36864
  ds_read_b128 v[180:183], v37 offset:38912
  s_waitcnt lgkmcnt(9)
  v_mfma_f32_16x16x32_bf16 v[120:123], v[152:155], v[136:139], v[120:123]
  buffer_load_dwordx4 v22, s[24:27], s16 offen offset:1024  lds
  v_mfma_f32_16x16x32_bf16 v[124:127], v[152:155], v[140:143], v[124:127]
  buffer_load_dwordx4 v22, s[24:27], s16 offen offset:2048  lds
  s_waitcnt lgkmcnt(8)
  v_mfma_f32_16x16x32_bf16 v[128:131], v[156:159], v[136:139], v[128:131]
  buffer_load_dwordx4 v22, s[24:27], s16 offen offset:3072  lds
  s_add_u32 s16, s16, 16384
  v_mfma_f32_16x16x32_bf16 v[132:135], v[156:159], v[140:143], v[132:135]
  s_waitcnt vmcnt(18) lgkmcnt(0)
  s_barrier
  v_mfma_f32_16x16x32_bf16 v[104:107], v[168:171], v[160:163], v[104:107]
  ds_read_b64_tr_b16 v[136:137], v34 offset:0
  ds_read_b64_tr_b16 v[138:139], v35 offset:0
  v_mfma_f32_16x16x32_bf16 v[108:111], v[168:171], v[164:167], v[108:111]
  ds_read_b128 v[144:147], v36 offset:0
  ds_read_b64_tr_b16 v[140:141], v34 offset:2048
  v_mfma_f32_16x16x32_bf16 v[112:115], v[172:175], v[160:163], v[112:115]
  ds_read_b64_tr_b16 v[142:143], v35 offset:2048
  ds_read_b128 v[148:151], v36 offset:2048
  v_mfma_f32_16x16x32_bf16 v[116:119], v[172:175], v[164:167], v[116:119]
  ds_read_b128 v[152:155], v36 offset:4096
  ds_read_b128 v[156:159], v36 offset:6144
  v_mfma_f32_16x16x32_bf16 v[120:123], v[176:179], v[160:163], v[120:123]
  s_add_u32 m0, s23, 32768
  s_nop 0
  buffer_load_dwordx4 v32, s[28:31], s17 offen offset:0 lds
  v_mfma_f32_16x16x32_bf16 v[124:127], v[176:179], v[164:167], v[124:127]
  buffer_load_dwordx4 v33, s[28:31], s17 offen offset:1024 lds
  v_mfma_f32_16x16x32_bf16 v[128:131], v[180:183], v[160:163], v[128:131]
  s_add_u32 m0, s22, 16384
  s_nop 0
  buffer_load_dwordx4 v22, s[24:27], s16 offen offset:0  lds
  v_mfma_f32_16x16x32_bf16 v[132:135], v[180:183], v[164:167], v[132:135]
  s_waitcnt lgkmcnt(5)
  v_mfma_f32_16x16x32_bf16 v[104:107], v[144:147], v[136:139], v[104:107]
  ds_read_b64_tr_b16 v[160:161], v34 offset:256
  ds_read_b64_tr_b16 v[162:163], v35 offset:256
  s_waitcnt lgkmcnt(5)
  v_mfma_f32_16x16x32_bf16 v[108:111], v[144:147], v[140:143], v[108:111]
  ds_read_b128 v[168:171], v37 offset:0
  ds_read_b64_tr_b16 v[164:165], v34 offset:2304
  s_waitcnt lgkmcnt(6)
  v_mfma_f32_16x16x32_bf16 v[112:115], v[148:151], v[136:139], v[112:115]
  ds_read_b64_tr_b16 v[166:167], v35 offset:2304
  ds_read_b128 v[172:175], v37 offset:2048
  v_mfma_f32_16x16x32_bf16 v[116:119], v[148:151], v[140:143], v[116:119]
  ds_read_b128 v[176:179], v37 offset:4096
  ds_read_b128 v[180:183], v37 offset:6144
  s_waitcnt lgkmcnt(9)
  v_mfma_f32_16x16x32_bf16 v[120:123], v[152:155], v[136:139], v[120:123]
  buffer_load_dwordx4 v22, s[24:27], s16 offen offset:1024  lds
  v_mfma_f32_16x16x32_bf16 v[124:127], v[152:155], v[140:143], v[124:127]
  buffer_load_dwordx4 v22, s[24:27], s16 offen offset:2048  lds
  s_waitcnt lgkmcnt(8)
  v_mfma_f32_16x16x32_bf16 v[128:131], v[156:159], v[136:139], v[128:131]
  buffer_load_dwordx4 v22, s[24:27], s16 offen offset:3072  lds
  s_add_u32 s16, s16, 16384
  v_mfma_f32_16x16x32_bf16 v[132:135], v[156:159], v[140:143], v[132:135]
  s_waitcnt vmcnt(18) lgkmcnt(0)
  s_barrier
  v_mfma_f32_16x16x32_bf16 v[104:107], v[168:171], v[160:163], v[104:107]
  ds_read_b64_tr_b16 v[136:137], v34 offset:4096
  ds_read_b64_tr_b16 v[138:139], v35 offset:4096
  v_mfma_f32_16x16x32_bf16 v[108:111], v[168:171], v[164:167], v[108:111]
  ds_read_b128 v[144:147], v36 offset:8192
  ds_read_b64_tr_b16 v[140:141], v34 offset:6144
  v_mfma_f32_16x16x32_bf16 v[112:115], v[172:175], v[160:163], v[112:115]
  ds_read_b64_tr_b16 v[142:143], v35 offset:6144
  ds_read_b128 v[148:151], v36 offset:10240
  v_mfma_f32_16x16x32_bf16 v[116:119], v[172:175], v[164:167], v[116:119]
  ds_read_b128 v[152:155], v36 offset:12288
  ds_read_b128 v[156:159], v36 offset:14336
  v_mfma_f32_16x16x32_bf16 v[120:123], v[176:179], v[160:163], v[120:123]
  s_add_u32 m0, s23, 0
  s_nop 0
  buffer_load_dwordx4 v32, s[32:35], s17 offen offset:0 lds
  v_mfma_f32_16x16x32_bf16 v[124:127], v[176:179], v[164:167], v[124:127]
  buffer_load_dwordx4 v33, s[32:35], s17 offen offset:1024 lds
  s_add_u32 s17, s17, 128
  v_mfma_f32_16x16x32_bf16 v[128:131], v[180:183], v[160:163], v[128:131]
  s_add_u32 m0, s22, 0
  s_nop 0
  buffer_load_dwordx4 v22, s[24:27], s16 offen offset:0  lds
  v_mfma_f32_16x16x32_bf16 v[132:135], v[180:183], v[164:167], v[132:135]
  s_waitcnt lgkmcnt(5)
  v_mfma_f32_16x16x32_bf16 v[104:107], v[144:147], v[136:139], v[104:107]
  ds_read_b64_tr_b16 v[160:161], v34 offset:4352
  ds_read_b64_tr_b16 v[162:163], v35 offset:4352
  s_waitcnt lgkmcnt(5)
  v_mfma_f32_16x16x32_bf16 v[108:111], v[144:147], v[140:143], v[108:111]
  ds_read_b128 v[168:171], v37 offset:8192
  ds_read_b64_tr_b16 v[164:165], v34 offset:6400
  s_waitcnt lgkmcnt(6)
  v_mfma_f32_16x16x32_bf16 v[112:115], v[148:151], v[136:139], v[112:115]
  ds_read_b64_tr_b16 v[166:167], v35 offset:6400
  ds_read_b128 v[172:175], v37 offset:10240
  v_mfma_f32_16x16x32_bf16 v[116:119], v[148:151], v[140:143], v[116:119]
  ds_read_b128 v[176:179], v37 offset:12288
  ds_read_b128 v[180:183], v37 offset:14336
  s_waitcnt lgkmcnt(9)
  v_mfma_f32_16x16x32_bf16 v[120:123], v[152:155], v[136:139], v[120:123]
  buffer_load_dwordx4 v22, s[24:27], s16 offen offset:1024  lds
  v_mfma_f32_16x16x32_bf16 v[124:127], v[152:155], v[140:143], v[124:127]
  buffer_load_dwordx4 v22, s[24:27], s16 offen offset:2048  lds
  s_waitcnt lgkmcnt(8)
  v_mfma_f32_16x16x32_bf16 v[128:131], v[156:159], v[136:139], v[128:131]
  buffer_load_dwordx4 v22, s[24:27], s16 offen offset:3072  lds
  s_add_u32 s16, s16, 16384
  v_mfma_f32_16x16x32_bf16 v[132:135], v[156:159], v[140:143], v[132:135]
  s_waitcnt vmcnt(18) lgkmcnt(0)
  s_barrier
  v_mfma_f32_16x16x32_bf16 v[104:107], v[168:171], v[160:163], v[104:107]
  ds_read_b64_tr_b16 v[136:137], v34 offset:8192
  ds_read_b64_tr_b16 v[138:139], v35 offset:8192
  v_mfma_f32_16x16x32_bf16 v[108:111], v[168:171], v[164:167], v[108:111]
  ds_read_b128 v[144:147], v36 offset:16384
  ds_read_b64_tr_b16 v[140:141], v34 offset:10240
  v_mfma_f32_16x16x32_bf16 v[112:115], v[172:175], v[160:163], v[112:115]
  ds_read_b64_tr_b16 v[142:143], v35 offset:10240
  ds_read_b128 v[148:151], v36 offset:18432
  v_mfma_f32_16x16x32_bf16 v[116:119], v[172:175], v[164:167], v[116:119]
  ds_read_b128 v[152:155], v36 offset:20480
  ds_read_b128 v[156:159], v36 offset:22528
  v_mfma_f32_16x16x32_bf16 v[120:123], v[176:179], v[160:163], v[120:123]
  s_add_u32 m0, s23, 8192
  s_nop 0
  buffer_load_dwordx4 v32, s[28:31], s17 offen offset:0 lds
  v_mfma_f32_16x16x32_bf16 v[124:127], v[176:179], v[164:167], v[124:127]
  buffer_load_dwordx4 v33, s[28:31], s17 offen offset:1024 lds
  v_mfma_f32_16x16x32_bf16 v[128:131], v[180:183], v[160:163], v[128:131]
  s_add_u32 m0, s22, 4096
  s_nop 0
  buffer_load_dwordx4 v22, s[24:27], s16 offen offset:0  lds
  v_mfma_f32_16x16x32_bf16 v[132:135], v[180:183], v[164:167], v[132:135]
  s_waitcnt lgkmcnt(5)
  v_mfma_f32_16x16x32_bf16 v[104:107], v[144:147], v[136:139], v[104:107]
  ds_read_b64_tr_b16 v[160:161], v34 offset:8448
  ds_read_b64_tr_b16 v[162:163], v35 offset:8448
  s_waitcnt lgkmcnt(5)
  v_mfma_f32_16x16x32_bf16 v[108:111], v[144:147], v[140:143], v[108:111]
  ds_read_b128 v[168:171], v37 offset:16384
  ds_read_b64_tr_b16 v[164:165], v34 offset:10496
  s_waitcnt lgkmcnt(6)
  v_mfma_f32_16x16x32_bf16 v[112:115], v[148:151], v[136:139], v[112:115]
  ds_read_b64_tr_b16 v[166:167], v35 offset:10496
  ds_read_b128 v[172:175], v37 offset:18432
  v_mfma_f32_16x16x32_bf16 v[116:119], v[148:151], v[140:143], v[116:119]
  ds_read_b128 v[176:179], v37 offset:20480
  ds_read_b128 v[180:183], v37 offset:22528
  s_waitcnt lgkmcnt(9)
  v_mfma_f32_16x16x32_bf16 v[120:123], v[152:155], v[136:139], v[120:123]
  buffer_load_dwordx4 v22, s[24:27], s16 offen offset:1024  lds
  v_mfma_f32_16x16x32_bf16 v[124:127], v[152:155], v[140:143], v[124:127]
  buffer_load_dwordx4 v22, s[24:27], s16 offen offset:2048  lds
  s_waitcnt lgkmcnt(8)
  v_mfma_f32_16x16x32_bf16 v[128:131], v[156:159], v[136:139], v[128:131]
  buffer_load_dwordx4 v22, s[24:27], s16 offen offset:3072  lds
  s_add_u32 s16, s16, 16384
  v_mfma_f32_16x16x32_bf16 v[132:135], v[156:159], v[140:143], v[132:135]
  s_waitcnt vmcnt(18) lgkmcnt(0)
  s_barrier
  v_mfma_f32_16x16x32_bf16 v[104:107], v[168:171], v[160:163], v[104:107]
  ds_read_b64_tr_b16 v[136:137], v34 offset:12288
  ds_read_b64_tr_b16 v[138:139], v35 offset:12288
  v_mfma_f32_16x16x32_bf16 v[108:111], v[168:171], v[164:167], v[108:111]
  ds_read_b128 v[144:147], v36 offset:24576
  ds_read_b64_tr_b16 v[140:141], v34 offset:14336
  v_mfma_f32_16x16x32_bf16 v[112:115], v[172:175], v[160:163], v[112:115]
  ds_read_b64_tr_b16 v[142:143], v35 offset:14336
  ds_read_b128 v[148:151], v36 offset:26624
  v_mfma_f32_16x16x32_bf16 v[116:119], v[172:175], v[164:167], v[116:119]
  ds_read_b128 v[152:155], v36 offset:28672
  ds_read_b128 v[156:159], v36 offset:30720
  v_mfma_f32_16x16x32_bf16 v[120:123], v[176:179], v[160:163], v[120:123]
  s_add_u32 m0, s23, 16384
  s_nop 0
  buffer_load_dwordx4 v32, s[32:35], s17 offen offset:0 lds
  v_mfma_f32_16x16x32_bf16 v[124:127], v[176:179], v[164:167], v[124:127]
  buffer_load_dwordx4 v33, s[32:35], s17 offen offset:1024 lds
  s_add_u32 s17, s17, 128
  v_mfma_f32_16x16x32_bf16 v[128:131], v[180:183], v[160:163], v[128:131]
  s_add_u32 m0, s22, 8192
  s_nop 0
  buffer_load_dwordx4 v22, s[24:27], s16 offen offset:0  lds
  v_mfma_f32_16x16x32_bf16 v[132:135], v[180:183], v[164:167], v[132:135]
  s_waitcnt lgkmcnt(5)
  v_mfma_f32_16x16x32_bf16 v[104:107], v[144:147], v[136:139], v[104:107]
  ds_read_b64_tr_b16 v[160:161], v34 offset:12544
  ds_read_b64_tr_b16 v[162:163], v35 offset:12544
  s_waitcnt lgkmcnt(5)
  v_mfma_f32_16x16x32_bf16 v[108:111], v[144:147], v[140:143], v[108:111]
  ds_read_b128 v[168:171], v37 offset:24576
  ds_read_b64_tr_b16 v[164:165], v34 offset:14592
  s_waitcnt lgkmcnt(6)
  v_mfma_f32_16x16x32_bf16 v[112:115], v[148:151], v[136:139], v[112:115]
  ds_read_b64_tr_b16 v[166:167], v35 offset:14592
  ds_read_b128 v[172:175], v37 offset:26624
  v_mfma_f32_16x16x32_bf16 v[116:119], v[148:151], v[140:143], v[116:119]
  ds_read_b128 v[176:179], v37 offset:28672
  ds_read_b128 v[180:183], v37 offset:30720
  s_waitcnt lgkmcnt(9)
  v_mfma_f32_16x16x32_bf16 v[120:123], v[152:155], v[136:139], v[120:123]
  buffer_load_dwordx4 v22, s[24:27], s16 offen offset:1024  lds
  v_mfma_f32_16x16x32_bf16 v[124:127], v[152:155], v[140:143], v[124:127]
  buffer_load_dwordx4 v22, s[24:27], s16 offen offset:2048  lds
  s_waitcnt lgkmcnt(8)
  v_mfma_f32_16x16x32_bf16 v[128:131], v[156:159], v[136:139], v[128:131]
  buffer_load_dwordx4 v22, s[24:27], s16 offen offset:3072  lds
  s_add_u32 s16, s16, 16384
  v_mfma_f32_16x16x32_bf16 v[132:135], v[156:159], v[140:143], v[132:135]
  s_waitcnt vmcnt(18) lgkmcnt(0)
  s_barrier
  v_mfma_f32_16x16x32_bf16 v[104:107], v[168:171], v[160:163], v[104:107]
  ds_read_b64_tr_b16 v[136:137], v34 offset:16384
  ds_read_b64_tr_b16 v[138:139], v35 offset:16384
  v_mfma_f32_16x16x32_bf16 v[108:111], v[168:171], v[164:167], v[108:111]
  ds_read_b128 v[144:147], v36 offset:32768
  ds_read_b64_tr_b16 v[140:141], v34 offset:18432
  v_mfma_f32_16x16x32_bf16 v[112:115], v[172:175], v[160:163], v[112:115]
  ds_read_b64_tr_b16 v[142:143], v35 offset:18432
  ds_read_b128 v[148:151], v36 offset:34816
  v_mfma_f32_16x16x32_bf16 v[116:119], v[172:175], v[164:167], v[116:119]
  ds_read_b128 v[152:155], v36 offset:36864
  ds_read_b128 v[156:159], v36 offset:38912
  v_mfma_f32_16x16x32_bf16 v[120:123], v[176:179], v[160:163], v[120:123]
  s_add_u32 m0, s23, 24576
  s_nop 0
  buffer_load_dwordx4 v32, s[28:31], s17 offen offset:0 lds
  v_mfma_f32_16x16x32_bf16 v[124:127], v[176:179], v[164:167], v[124:127]
  buffer_load_dwordx4 v33, s[28:31], s17 offen offset:1024 lds
  v_mfma_f32_16x16x32_bf16 v[128:131], v[180:183], v[160:163], v[128:131]
  s_add_u32 m0, s22, 12288
  s_nop 0
  buffer_load_dwordx4 v22, s[24:27], s16 offen offset:0  lds
  v_mfma_f32_16x16x32_bf16 v[132:135], v[180:183], v[164:167], v[132:135]
  s_waitcnt lgkmcnt(5)
  v_mfma_f32_16x16x32_bf16 v[104:107], v[144:147], v[136:139], v[104:107]
  ds_read_b64_tr_b16 v[160:161], v34 offset:16640
  ds_read_b64_tr_b16 v[162:163], v35 offset:16640
  s_waitcnt lgkmcnt(5)
  v_mfma_f32_16x16x32_bf16 v[108:111], v[144:147], v[140:143], v[108:111]
  ds_read_b128 v[168:171], v37 offset:32768
  ds_read_b64_tr_b16 v[164:165], v34 offset:18688
  s_waitcnt lgkmcnt(6)
  v_mfma_f32_16x16x32_bf16 v[112:115], v[148:151], v[136:139], v[112:115]
  ds_read_b64_tr_b16 v[166:167], v35 offset:18688
  ds_read_b128 v[172:175], v37 offset:34816
  v_mfma_f32_16x16x32_bf16 v[116:119], v[148:151], v[140:143], v[116:119]
  ds_read_b128 v[176:179], v37 offset:36864
  ds_read_b128 v[180:183], v37 offset:38912
  s_waitcnt lgkmcnt(9)
  v_mfma_f32_16x16x32_bf16 v[120:123], v[152:155], v[136:139], v[120:123]
  buffer_load_dwordx4 v22, s[24:27], s16 offen offset:1024  lds
  v_mfma_f32_16x16x32_bf16 v[124:127], v[152:155], v[140:143], v[124:127]
  buffer_load_dwordx4 v22, s[24:27], s16 offen offset:2048  lds
  s_waitcnt lgkmcnt(8)
  v_mfma_f32_16x16x32_bf16 v[128:131], v[156:159], v[136:139], v[128:131]
  buffer_load_dwordx4 v22, s[24:27], s16 offen offset:3072  lds
  s_add_u32 s16, s16, 16384
  v_mfma_f32_16x16x32_bf16 v[132:135], v[156:159], v[140:143], v[132:135]
  s_waitcnt vmcnt(18) lgkmcnt(0)
  s_barrier
  v_mfma_f32_16x16x32_bf16 v[104:107], v[168:171], v[160:163], v[104:107]
  ds_read_b64_tr_b16 v[136:137], v34 offset:0
  ds_read_b64_tr_b16 v[138:139], v35 offset:0
  v_mfma_f32_16x16x32_bf16 v[108:111], v[168:171], v[164:167], v[108:111]
  ds_read_b128 v[144:147], v36 offset:0
  ds_read_b64_tr_b16 v[140:141], v34 offset:2048
  v_mfma_f32_16x16x32_bf16 v[112:115], v[172:175], v[160:163], v[112:115]
  ds_read_b64_tr_b16 v[142:143], v35 offset:2048
  ds_read_b128 v[148:151], v36 offset:2048
  v_mfma_f32_16x16x32_bf16 v[116:119], v[172:175], v[164:167], v[116:119]
  ds_read_b128 v[152:155], v36 offset:4096
  ds_read_b128 v[156:159], v36 offset:6144
  v_mfma_f32_16x16x32_bf16 v[120:123], v[176:179], v[160:163], v[120:123]
  s_add_u32 m0, s23, 32768
  s_nop 0
  buffer_load_dwordx4 v32, s[32:35], s17 offen offset:0 lds
  v_mfma_f32_16x16x32_bf16 v[124:127], v[176:179], v[164:167], v[124:127]
  buffer_load_dwordx4 v33, s[32:35], s17 offen offset:1024 lds
  s_add_u32 s17, s17, 128
  v_mfma_f32_16x16x32_bf16 v[128:131], v[180:183], v[160:163], v[128:131]
  s_add_u32 m0, s22, 16384
  s_nop 0
  buffer_load_dwordx4 v22, s[24:27], s16 offen offset:0  lds
  v_mfma_f32_16x16x32_bf16 v[132:135], v[180:183], v[164:167], v[132:135]
  s_waitcnt lgkmcnt(5)
  v_mfma_f32_16x16x32_bf16 v[104:107], v[144:147], v[136:139], v[104:107]
  ds_read_b64_tr_b16 v[160:161], v34 offset:256
  ds_read_b64_tr_b16 v[162:163], v35 offset:256
  s_waitcnt lgkmcnt(5)
  v_mfma_f32_16x16x32_bf16 v[108:111], v[144:147], v[140:143], v[108:111]
  ds_read_b128 v[168:171], v37 offset:0
  ds_read_b64_tr_b16 v[164:165], v34 offset:2304
  s_waitcnt lgkmcnt(6)
  v_mfma_f32_16x16x32_bf16 v[112:115], v[148:151], v[136:139], v[112:115]
  ds_read_b64_tr_b16 v[166:167], v35 offset:2304
  ds_read_b128 v[172:175], v37 offset:2048
  v_mfma_f32_16x16x32_bf16 v[116:119], v[148:151], v[140:143], v[116:119]
  ds_read_b128 v[176:179], v37 offset:4096
  ds_read_b128 v[180:183], v37 offset:6144
  s_waitcnt lgkmcnt(9)
  v_mfma_f32_16x16x32_bf16 v[120:123], v[152:155], v[136:139], v[120:123]
  buffer_load_dwordx4 v22, s[24:27], s16 offen offset:1024  lds
  v_mfma_f32_16x16x32_bf16 v[124:127], v[152:155], v[140:143], v[124:127]
  buffer_load_dwordx4 v22, s[24:27], s16 offen offset:2048  lds
  s_waitcnt lgkmcnt(8)
  v_mfma_f32_16x16x32_bf16 v[128:131], v[156:159], v[136:139], v[128:131]
  buffer_load_dwordx4 v22, s[24:27], s16 offen offset:3072  lds
  s_add_u32 s16, s16, 16384
  v_mfma_f32_16x16x32_bf16 v[132:135], v[156:159], v[140:143], v[132:135]
  s_waitcnt vmcnt(18) lgkmcnt(0)
  s_barrier
  v_mfma_f32_16x16x32_bf16 v[104:107], v[168:171], v[160:163], v[104:107]
  ds_read_b64_tr_b16 v[136:137], v34 offset:4096
  ds_read_b64_tr_b16 v[138:139], v35 offset:4096
  v_mfma_f32_16x16x32_bf16 v[108:111], v[168:171], v[164:167], v[108:111]
  ds_read_b128 v[144:147], v36 offset:8192
  ds_read_b64_tr_b16 v[140:141], v34 offset:6144
  v_mfma_f32_16x16x32_bf16 v[112:115], v[172:175], v[160:163], v[112:115]
  ds_read_b64_tr_b16 v[142:143], v35 offset:6144
  ds_read_b128 v[148:151], v36 offset:10240
  v_mfma_f32_16x16x32_bf16 v[116:119], v[172:175], v[164:167], v[116:119]
  ds_read_b128 v[152:155], v36 offset:12288
  ds_read_b128 v[156:159], v36 offset:14336
  v_mfma_f32_16x16x32_bf16 v[120:123], v[176:179], v[160:163], v[120:123]
  s_add_u32 m0, s23, 0
  s_nop 0
  buffer_load_dwordx4 v32, s[28:31], s17 offen offset:0 lds
  v_mfma_f32_16x16x32_bf16 v[124:127], v[176:179], v[164:167], v[124:127]
  buffer_load_dwordx4 v33, s[28:31], s17 offen offset:1024 lds
  v_mfma_f32_16x16x32_bf16 v[128:131], v[180:183], v[160:163], v[128:131]
  s_add_u32 m0, s22, 0
  s_nop 0
  buffer_load_dwordx4 v22, s[24:27], s16 offen offset:0  lds
  v_mfma_f32_16x16x32_bf16 v[132:135], v[180:183], v[164:167], v[132:135]
  s_waitcnt lgkmcnt(5)
  v_mfma_f32_16x16x32_bf16 v[104:107], v[144:147], v[136:139], v[104:107]
  ds_read_b64_tr_b16 v[160:161], v34 offset:4352
  ds_read_b64_tr_b16 v[162:163], v35 offset:4352
  s_waitcnt lgkmcnt(5)
  v_mfma_f32_16x16x32_bf16 v[108:111], v[144:147], v[140:143], v[108:111]
  ds_read_b128 v[168:171], v37 offset:8192
  ds_read_b64_tr_b16 v[164:165], v34 offset:6400
  s_waitcnt lgkmcnt(6)
  v_mfma_f32_16x16x32_bf16 v[112:115], v[148:151], v[136:139], v[112:115]
  ds_read_b64_tr_b16 v[166:167], v35 offset:6400
  ds_read_b128 v[172:175], v37 offset:10240
  v_mfma_f32_16x16x32_bf16 v[116:119], v[148:151], v[140:143], v[116:119]
  ds_read_b128 v[176:179], v37 offset:12288
  ds_read_b128 v[180:183], v37 offset:14336
  s_waitcnt lgkmcnt(9)
  v_mfma_f32_16x16x32_bf16 v[120:123], v[152:155], v[136:139], v[120:123]
  buffer_load_dwordx4 v22, s[24:27], s16 offen offset:1024  lds
  v_mfma_f32_16x16x32_bf16 v[124:127], v[152:155], v[140:143], v[124:127]
  buffer_load_dwordx4 v22, s[24:27], s16 offen offset:2048  lds
  s_waitcnt lgkmcnt(8)
  v_mfma_f32_16x16x32_bf16 v[128:131], v[156:159], v[136:139], v[128:131]
  buffer_load_dwordx4 v22, s[24:27], s16 offen offset:3072  lds
  s_add_u32 s16, s16, 16384
  v_mfma_f32_16x16x32_bf16 v[132:135], v[156:159], v[140:143], v[132:135]
  s_waitcnt vmcnt(18) lgkmcnt(0)
  s_barrier
  v_mfma_f32_16x16x32_bf16 v[104:107], v[168:171], v[160:163], v[104:107]
  ds_read_b64_tr_b16 v[136:137], v34 offset:8192
  ds_read_b64_tr_b16 v[138:139], v35 offset:8192
  v_mfma_f32_16x16x32_bf16 v[108:111], v[168:171], v[164:167], v[108:111]
  ds_read_b128 v[144:147], v36 offset:16384
  ds_read_b64_tr_b16 v[140:141], v34 offset:10240
  v_mfma_f32_16x16x32_bf16 v[112:115], v[172:175], v[160:163], v[112:115]
  ds_read_b64_tr_b16 v[142:143], v35 offset:10240
  ds_read_b128 v[148:151], v36 offset:18432
  v_mfma_f32_16x16x32_bf16 v[116:119], v[172:175], v[164:167], v[116:119]
  ds_read_b128 v[152:155], v36 offset:20480
  ds_read_b128 v[156:159], v36 offset:22528
  v_mfma_f32_16x16x32_bf16 v[120:123], v[176:179], v[160:163], v[120:123]
  s_add_u32 m0, s23, 8192
  s_nop 0
  buffer_load_dwordx4 v32, s[32:35], s17 offen offset:0 lds
  v_mfma_f32_16x16x32_bf16 v[124:127], v[176:179], v[164:167], v[124:127]
  buffer_load_dwordx4 v33, s[32:35], s17 offen offset:1024 lds
  s_add_u32 s17, s17, 128
  v_mfma_f32_16x16x32_bf16 v[128:131], v[180:183], v[160:163], v[128:131]
  s_add_u32 m0, s22, 4096
  s_nop 0
  buffer_load_dwordx4 v22, s[24:27], s16 offen offset:0  lds
  v_mfma_f32_16x16x32_bf16 v[132:135], v[180:183], v[164:167], v[132:135]
  s_waitcnt lgkmcnt(5)
  v_mfma_f32_16x16x32_bf16 v[104:107], v[144:147], v[136:139], v[104:107]
  ds_read_b64_tr_b16 v[160:161], v34 offset:8448
  ds_read_b64_tr_b16 v[162:163], v35 offset:8448
  s_waitcnt lgkmcnt(5)
  v_mfma_f32_16x16x32_bf16 v[108:111], v[144:147], v[140:143], v[108:111]
  ds_read_b128 v[168:171], v37 offset:16384
  ds_read_b64_tr_b16 v[164:165], v34 offset:10496
  s_waitcnt lgkmcnt(6)
  v_mfma_f32_16x16x32_bf16 v[112:115], v[148:151], v[136:139], v[112:115]
  ds_read_b64_tr_b16 v[166:167], v35 offset:10496
  ds_read_b128 v[172:175], v37 offset:18432
  v_mfma_f32_16x16x32_bf16 v[116:119], v[148:151], v[140:143], v[116:119]
  ds_read_b128 v[176:179], v37 offset:20480
  ds_read_b128 v[180:183], v37 offset:22528
  s_waitcnt lgkmcnt(9)
  v_mfma_f32_16x16x32_bf16 v[120:123], v[152:155], v[136:139], v[120:123]
  buffer_load_dwordx4 v22, s[24:27], s16 offen offset:1024  lds
  v_mfma_f32_16x16x32_bf16 v[124:127], v[152:155], v[140:143], v[124:127]
  buffer_load_dwordx4 v22, s[24:27], s16 offen offset:2048  lds
  s_waitcnt lgkmcnt(8)
  v_mfma_f32_16x16x32_bf16 v[128:131], v[156:159], v[136:139], v[128:131]
  buffer_load_dwordx4 v22, s[24:27], s16 offen offset:3072  lds
  s_add_u32 s16, s16, 16384
  v_mfma_f32_16x16x32_bf16 v[132:135], v[156:159], v[140:143], v[132:135]
  s_waitcnt vmcnt(18) lgkmcnt(0)
  s_barrier
  v_mfma_f32_16x16x32_bf16 v[104:107], v[168:171], v[160:163], v[104:107]
  ds_read_b64_tr_b16 v[136:137], v34 offset:12288
  ds_read_b64_tr_b16 v[138:139], v35 offset:12288
  v_mfma_f32_16x16x32_bf16 v[108:111], v[168:171], v[164:167], v[108:111]
  ds_read_b128 v[144:147], v36 offset:24576
  ds_read_b64_tr_b16 v[140:141], v34 offset:14336
  v_mfma_f32_16x16x32_bf16 v[112:115], v[172:175], v[160:163], v[112:115]
  ds_read_b64_tr_b16 v[142:143], v35 offset:14336
  ds_read_b128 v[148:151], v36 offset:26624
  v_mfma_f32_16x16x32_bf16 v[116:119], v[172:175], v[164:167], v[116:119]
  ds_read_b128 v[152:155], v36 offset:28672
  ds_read_b128 v[156:159], v36 offset:30720
  v_mfma_f32_16x16x32_bf16 v[120:123], v[176:179], v[160:163], v[120:123]
  s_add_u32 m0, s23, 16384
  s_nop 0
  buffer_load_dwordx4 v32, s[28:31], s17 offen offset:0 lds
  v_mfma_f32_16x16x32_bf16 v[124:127], v[176:179], v[164:167], v[124:127]
  buffer_load_dwordx4 v33, s[28:31], s17 offen offset:1024 lds
  v_mfma_f32_16x16x32_bf16 v[128:131], v[180:183], v[160:163], v[128:131]
  s_add_u32 m0, s22, 8192
  s_nop 0
  buffer_load_dwordx4 v22, s[24:27], s16 offen offset:0  lds
  v_mfma_f32_16x16x32_bf16 v[132:135], v[180:183], v[164:167], v[132:135]
  s_waitcnt lgkmcnt(5)
  v_mfma_f32_16x16x32_bf16 v[104:107], v[144:147], v[136:139], v[104:107]
  ds_read_b64_tr_b16 v[160:161], v34 offset:12544
  ds_read_b64_tr_b16 v[162:163], v35 offset:12544
  s_waitcnt lgkmcnt(5)
  v_mfma_f32_16x16x32_bf16 v[108:111], v[144:147], v[140:143], v[108:111]
  ds_read_b128 v[168:171], v37 offset:24576
  ds_read_b64_tr_b16 v[164:165], v34 offset:14592
  s_waitcnt lgkmcnt(6)
  v_mfma_f32_16x16x32_bf16 v[112:115], v[148:151], v[136:139], v[112:115]
  ds_read_b64_tr_b16 v[166:167], v35 offset:14592
  ds_read_b128 v[172:175], v37 offset:26624
  v_mfma_f32_16x16x32_bf16 v[116:119], v[148:151], v[140:143], v[116:119]
  ds_read_b128 v[176:179], v37 offset:28672
  ds_read_b128 v[180:183], v37 offset:30720
  s_waitcnt lgkmcnt(9)
  v_mfma_f32_16x16x32_bf16 v[120:123], v[152:155], v[136:139], v[120:123]
  buffer_load_dwordx4 v22, s[24:27], s16 offen offset:1024  lds
  v_mfma_f32_16x16x32_bf16 v[124:127], v[152:155], v[140:143], v[124:127]
  buffer_load_dwordx4 v22, s[24:27], s16 offen offset:2048  lds
  s_waitcnt lgkmcnt(8)
  v_mfma_f32_16x16x32_bf16 v[128:131], v[156:159], v[136:139], v[128:131]
  buffer_load_dwordx4 v22, s[24:27], s16 offen offset:3072  lds
  s_add_u32 s16, s16, 16384
  v_mfma_f32_16x16x32_bf16 v[132:135], v[156:159], v[140:143], v[132:135]
  s_waitcnt vmcnt(18) lgkmcnt(0)
  s_barrier
  v_mfma_f32_16x16x32_bf16 v[104:107], v[168:171], v[160:163], v[104:107]
  ds_read_b64_tr_b16 v[136:137], v34 offset:16384
  ds_read_b64_tr_b16 v[138:139], v35 offset:16384
  v_mfma_f32_16x16x32_bf16 v[108:111], v[168:171], v[164:167], v[108:111]
  ds_read_b128 v[144:147], v36 offset:32768
  ds_read_b64_tr_b16 v[140:141], v34 offset:18432
  v_mfma_f32_16x16x32_bf16 v[112:115], v[172:175], v[160:163], v[112:115]
  ds_read_b64_tr_b16 v[142:143], v35 offset:18432
  ds_read_b128 v[148:151], v36 offset:34816
  v_mfma_f32_16x16x32_bf16 v[116:119], v[172:175], v[164:167], v[116:119]
  ds_read_b128 v[152:155], v36 offset:36864
  ds_read_b128 v[156:159], v36 offset:38912
  v_mfma_f32_16x16x32_bf16 v[120:123], v[176:179], v[160:163], v[120:123]
  s_add_u32 m0, s23, 24576
  s_nop 0
  buffer_load_dwordx4 v32, s[32:35], s17 offen offset:0 lds
  v_mfma_f32_16x16x32_bf16 v[124:127], v[176:179], v[164:167], v[124:127]
  buffer_load_dwordx4 v33, s[32:35], s17 offen offset:1024 lds
  s_add_u32 s17, s17, 128
  v_mfma_f32_16x16x32_bf16 v[128:131], v[180:183], v[160:163], v[128:131]
  s_add_u32 m0, s22, 12288
  s_nop 0
  buffer_load_dwordx4 v22, s[24:27], s16 offen offset:0  lds
  v_mfma_f32_16x16x32_bf16 v[132:135], v[180:183], v[164:167], v[132:135]
  s_waitcnt lgkmcnt(5)
  v_mfma_f32_16x16x32_bf16 v[104:107], v[144:147], v[136:139], v[104:107]
  ds_read_b64_tr_b16 v[160:161], v34 offset:16640
  ds_read_b64_tr_b16 v[162:163], v35 offset:16640
  s_waitcnt lgkmcnt(5)
  v_mfma_f32_16x16x32_bf16 v[108:111], v[144:147], v[140:143], v[108:111]
  ds_read_b128 v[168:171], v37 offset:32768
  ds_read_b64_tr_b16 v[164:165], v34 offset:18688
  s_waitcnt lgkmcnt(6)
  v_mfma_f32_16x16x32_bf16 v[112:115], v[148:151], v[136:139], v[112:115]
  ds_read_b64_tr_b16 v[166:167], v35 offset:18688
  ds_read_b128 v[172:175], v37 offset:34816
  v_mfma_f32_16x16x32_bf16 v[116:119], v[148:151], v[140:143], v[116:119]
  ds_read_b128 v[176:179], v37 offset:36864
  ds_read_b128 v[180:183], v37 offset:38912
  s_waitcnt lgkmcnt(9)
  v_mfma_f32_16x16x32_bf16 v[120:123], v[152:155], v[136:139], v[120:123]
  buffer_load_dwordx4 v22, s[24:27], s16 offen offset:1024  lds
  v_mfma_f32_16x16x32_bf16 v[124:127], v[152:155], v[140:143], v[124:127]
  buffer_load_dwordx4 v22, s[24:27], s16 offen offset:2048  lds
  s_waitcnt lgkmcnt(8)
  v_mfma_f32_16x16x32_bf16 v[128:131], v[156:159], v[136:139], v[128:131]
  buffer_load_dwordx4 v22, s[24:27], s16 offen offset:3072  lds
  s_add_u32 s16, s16, 16384
  v_mfma_f32_16x16x32_bf16 v[132:135], v[156:159], v[140:143], v[132:135]
  s_waitcnt vmcnt(18) lgkmcnt(0)
  s_barrier
  v_mfma_f32_16x16x32_bf16 v[104:107], v[168:171], v[160:163], v[104:107]
  ds_read_b64_tr_b16 v[136:137], v34 offset:0
  ds_read_b64_tr_b16 v[138:139], v35 offset:0
  v_mfma_f32_16x16x32_bf16 v[108:111], v[168:171], v[164:167], v[108:111]
  ds_read_b128 v[144:147], v36 offset:0
  ds_read_b64_tr_b16 v[140:141], v34 offset:2048
  v_mfma_f32_16x16x32_bf16 v[112:115], v[172:175], v[160:163], v[112:115]
  ds_read_b64_tr_b16 v[142:143], v35 offset:2048
  ds_read_b128 v[148:151], v36 offset:2048
  v_mfma_f32_16x16x32_bf16 v[116:119], v[172:175], v[164:167], v[116:119]
  ds_read_b128 v[152:155], v36 offset:4096
  ds_read_b128 v[156:159], v36 offset:6144
  v_mfma_f32_16x16x32_bf16 v[120:123], v[176:179], v[160:163], v[120:123]
  s_add_u32 m0, s23, 32768
  s_nop 0
  buffer_load_dwordx4 v32, s[28:31], s17 offen offset:0 lds
  v_mfma_f32_16x16x32_bf16 v[124:127], v[176:179], v[164:167], v[124:127]
  buffer_load_dwordx4 v33, s[28:31], s17 offen offset:1024 lds
  v_mfma_f32_16x16x32_bf16 v[128:131], v[180:183], v[160:163], v[128:131]
  s_add_u32 m0, s22, 16384
  s_nop 0
  buffer_load_dwordx4 v22, s[24:27], s16 offen offset:0  lds
  v_mfma_f32_16x16x32_bf16 v[132:135], v[180:183], v[164:167], v[132:135]
  s_waitcnt lgkmcnt(5)
  v_mfma_f32_16x16x32_bf16 v[104:107], v[144:147], v[136:139], v[104:107]
  ds_read_b64_tr_b16 v[160:161], v34 offset:256
  ds_read_b64_tr_b16 v[162:163], v35 offset:256
  s_waitcnt lgkmcnt(5)
  v_mfma_f32_16x16x32_bf16 v[108:111], v[144:147], v[140:143], v[108:111]
  ds_read_b128 v[168:171], v37 offset:0
  ds_read_b64_tr_b16 v[164:165], v34 offset:2304
  s_waitcnt lgkmcnt(6)
  v_mfma_f32_16x16x32_bf16 v[112:115], v[148:151], v[136:139], v[112:115]
  ds_read_b64_tr_b16 v[166:167], v35 offset:2304
  ds_read_b128 v[172:175], v37 offset:2048
  v_mfma_f32_16x16x32_bf16 v[116:119], v[148:151], v[140:143], v[116:119]
  ds_read_b128 v[176:179], v37 offset:4096
  ds_read_b128 v[180:183], v37 offset:6144
  s_waitcnt lgkmcnt(9)
  v_mfma_f32_16x16x32_bf16 v[120:123], v[152:155], v[136:139], v[120:123]
  buffer_load_dwordx4 v22, s[24:27], s16 offen offset:1024  lds
  v_mfma_f32_16x16x32_bf16 v[124:127], v[152:155], v[140:143], v[124:127]
  buffer_load_dwordx4 v22, s[24:27], s16 offen offset:2048  lds
  s_waitcnt lgkmcnt(8)
  v_mfma_f32_16x16x32_bf16 v[128:131], v[156:159], v[136:139], v[128:131]
  buffer_load_dwordx4 v22, s[24:27], s16 offen offset:3072  lds
  s_add_u32 s16, s16, 16384
  v_mfma_f32_16x16x32_bf16 v[132:135], v[156:159], v[140:143], v[132:135]
  s_waitcnt vmcnt(18) lgkmcnt(0)
  s_barrier
  v_mfma_f32_16x16x32_bf16 v[104:107], v[168:171], v[160:163], v[104:107]
  ds_read_b64_tr_b16 v[136:137], v34 offset:4096
  ds_read_b64_tr_b16 v[138:139], v35 offset:4096
  v_mfma_f32_16x16x32_bf16 v[108:111], v[168:171], v[164:167], v[108:111]
  ds_read_b128 v[144:147], v36 offset:8192
  ds_read_b64_tr_b16 v[140:141], v34 offset:6144
  v_mfma_f32_16x16x32_bf16 v[112:115], v[172:175], v[160:163], v[112:115]
  ds_read_b64_tr_b16 v[142:143], v35 offset:6144
  ds_read_b128 v[148:151], v36 offset:10240
  v_mfma_f32_16x16x32_bf16 v[116:119], v[172:175], v[164:167], v[116:119]
  ds_read_b128 v[152:155], v36 offset:12288
  ds_read_b128 v[156:159], v36 offset:14336
  v_mfma_f32_16x16x32_bf16 v[120:123], v[176:179], v[160:163], v[120:123]
  s_add_u32 m0, s23, 0
  s_nop 0
  buffer_load_dwordx4 v32, s[32:35], s17 offen offset:0 lds
  v_mfma_f32_16x16x32_bf16 v[124:127], v[176:179], v[164:167], v[124:127]
  buffer_load_dwordx4 v33, s[32:35], s17 offen offset:1024 lds
  s_add_u32 s17, s17, 128
  v_mfma_f32_16x16x32_bf16 v[128:131], v[180:183], v[160:163], v[128:131]
  s_add_u32 m0, s22, 0
  s_nop 0
  buffer_load_dwordx4 v22, s[24:27], s16 offen offset:0  lds
  v_mfma_f32_16x16x32_bf16 v[132:135], v[180:183], v[164:167], v[132:135]
  s_waitcnt lgkmcnt(5)
  v_mfma_f32_16x16x32_bf16 v[104:107], v[144:147], v[136:139], v[104:107]
  ds_read_b64_tr_b16 v[160:161], v34 offset:4352
  ds_read_b64_tr_b16 v[162:163], v35 offset:4352
  s_waitcnt lgkmcnt(5)
  v_mfma_f32_16x16x32_bf16 v[108:111], v[144:147], v[140:143], v[108:111]
  ds_read_b128 v[168:171], v37 offset:8192
  ds_read_b64_tr_b16 v[164:165], v34 offset:6400
  s_waitcnt lgkmcnt(6)
  v_mfma_f32_16x16x32_bf16 v[112:115], v[148:151], v[136:139], v[112:115]
  ds_read_b64_tr_b16 v[166:167], v35 offset:6400
  ds_read_b128 v[172:175], v37 offset:10240
  v_mfma_f32_16x16x32_bf16 v[116:119], v[148:151], v[140:143], v[116:119]
  ds_read_b128 v[176:179], v37 offset:12288
  ds_read_b128 v[180:183], v37 offset:14336
  s_waitcnt lgkmcnt(9)
  v_mfma_f32_16x16x32_bf16 v[120:123], v[152:155], v[136:139], v[120:123]
  buffer_load_dwordx4 v22, s[24:27], s16 offen offset:1024  lds
  v_mfma_f32_16x16x32_bf16 v[124:127], v[152:155], v[140:143], v[124:127]
  buffer_load_dwordx4 v22, s[24:27], s16 offen offset:2048  lds
  s_waitcnt lgkmcnt(8)
  v_mfma_f32_16x16x32_bf16 v[128:131], v[156:159], v[136:139], v[128:131]
  buffer_load_dwordx4 v22, s[24:27], s16 offen offset:3072  lds
  s_add_u32 s16, s16, 16384
  v_mfma_f32_16x16x32_bf16 v[132:135], v[156:159], v[140:143], v[132:135]
  s_waitcnt vmcnt(18) lgkmcnt(0)
  s_barrier
  v_mfma_f32_16x16x32_bf16 v[104:107], v[168:171], v[160:163], v[104:107]
  ds_read_b64_tr_b16 v[136:137], v34 offset:8192
  ds_read_b64_tr_b16 v[138:139], v35 offset:8192
  v_mfma_f32_16x16x32_bf16 v[108:111], v[168:171], v[164:167], v[108:111]
  ds_read_b128 v[144:147], v36 offset:16384
  ds_read_b64_tr_b16 v[140:141], v34 offset:10240
  v_mfma_f32_16x16x32_bf16 v[112:115], v[172:175], v[160:163], v[112:115]
  ds_read_b64_tr_b16 v[142:143], v35 offset:10240
  ds_read_b128 v[148:151], v36 offset:18432
  v_mfma_f32_16x16x32_bf16 v[116:119], v[172:175], v[164:167], v[116:119]
  ds_read_b128 v[152:155], v36 offset:20480
  ds_read_b128 v[156:159], v36 offset:22528
  v_mfma_f32_16x16x32_bf16 v[120:123], v[176:179], v[160:163], v[120:123]
  s_add_u32 m0, s23, 8192
  s_nop 0
  buffer_load_dwordx4 v32, s[28:31], s17 offen offset:0 lds
  v_mfma_f32_16x16x32_bf16 v[124:127], v[176:179], v[164:167], v[124:127]
  buffer_load_dwordx4 v33, s[28:31], s17 offen offset:1024 lds
  v_mfma_f32_16x16x32_bf16 v[128:131], v[180:183], v[160:163], v[128:131]
  s_add_u32 m0, s22, 4096
  s_nop 0
  buffer_load_dwordx4 v22, s[24:27], s16 offen offset:0  lds
  v_mfma_f32_16x16x32_bf16 v[132:135], v[180:183], v[164:167], v[132:135]
  s_waitcnt lgkmcnt(5)
  v_mfma_f32_16x16x32_bf16 v[104:107], v[144:147], v[136:139], v[104:107]
  ds_read_b64_tr_b16 v[160:161], v34 offset:8448
  ds_read_b64_tr_b16 v[162:163], v35 offset:8448
  s_waitcnt lgkmcnt(5)
  v_mfma_f32_16x16x32_bf16 v[108:111], v[144:147], v[140:143], v[108:111]
  ds_read_b128 v[168:171], v37 offset:16384
  ds_read_b64_tr_b16 v[164:165], v34 offset:10496
  s_waitcnt lgkmcnt(6)
  v_mfma_f32_16x16x32_bf16 v[112:115], v[148:151], v[136:139], v[112:115]
  ds_read_b64_tr_b16 v[166:167], v35 offset:10496
  ds_read_b128 v[172:175], v37 offset:18432
  v_mfma_f32_16x16x32_bf16 v[116:119], v[148:151], v[140:143], v[116:119]
  ds_read_b128 v[176:179], v37 offset:20480
  ds_read_b128 v[180:183], v37 offset:22528
  s_waitcnt lgkmcnt(9)
  v_mfma_f32_16x16x32_bf16 v[120:123], v[152:155], v[136:139], v[120:123]
  buffer_load_dwordx4 v22, s[24:27], s16 offen offset:1024  lds
  v_mfma_f32_16x16x32_bf16 v[124:127], v[152:155], v[140:143], v[124:127]
  buffer_load_dwordx4 v22, s[24:27], s16 offen offset:2048  lds
  s_waitcnt lgkmcnt(8)
  v_mfma_f32_16x16x32_bf16 v[128:131], v[156:159], v[136:139], v[128:131]
  buffer_load_dwordx4 v22, s[24:27], s16 offen offset:3072  lds
  s_add_u32 s16, s16, 16384
  v_mfma_f32_16x16x32_bf16 v[132:135], v[156:159], v[140:143], v[132:135]
  s_waitcnt vmcnt(18) lgkmcnt(0)
  s_barrier
  v_mfma_f32_16x16x32_bf16 v[104:107], v[168:171], v[160:163], v[104:107]
  ds_read_b64_tr_b16 v[136:137], v34 offset:12288
  ds_read_b64_tr_b16 v[138:139], v35 offset:12288
  v_mfma_f32_16x16x32_bf16 v[108:111], v[168:171], v[164:167], v[108:111]
  ds_read_b128 v[144:147], v36 offset:24576
  ds_read_b64_tr_b16 v[140:141], v34 offset:14336
  v_mfma_f32_16x16x32_bf16 v[112:115], v[172:175], v[160:163], v[112:115]
  ds_read_b64_tr_b16 v[142:143], v35 offset:14336
  ds_read_b128 v[148:151], v36 offset:26624
  v_mfma_f32_16x16x32_bf16 v[116:119], v[172:175], v[164:167], v[116:119]
  ds_read_b128 v[152:155], v36 offset:28672
  ds_read_b128 v[156:159], v36 offset:30720
  v_mfma_f32_16x16x32_bf16 v[120:123], v[176:179], v[160:163], v[120:123]
  s_add_u32 m0, s23, 16384
  s_nop 0
  buffer_load_dwordx4 v32, s[32:35], s17 offen offset:0 lds
  v_mfma_f32_16x16x32_bf16 v[124:127], v[176:179], v[164:167], v[124:127]
  buffer_load_dwordx4 v33, s[32:35], s17 offen offset:1024 lds
  s_add_u32 s17, s17, 128
  v_mfma_f32_16x16x32_bf16 v[128:131], v[180:183], v[160:163], v[128:131]
  s_add_u32 m0, s22, 8192
  s_nop 0
  buffer_load_dwordx4 v22, s[24:27], s16 offen offset:0  lds
  v_mfma_f32_16x16x32_bf16 v[132:135], v[180:183], v[164:167], v[132:135]
  s_waitcnt lgkmcnt(5)
  v_mfma_f32_16x16x32_bf16 v[104:107], v[144:147], v[136:139], v[104:107]
  ds_read_b64_tr_b16 v[160:161], v34 offset:12544
  ds_read_b64_tr_b16 v[162:163], v35 offset:12544
  s_waitcnt lgkmcnt(5)
  v_mfma_f32_16x16x32_bf16 v[108:111], v[144:147], v[140:143], v[108:111]
  ds_read_b128 v[168:171], v37 offset:24576
  ds_read_b64_tr_b16 v[164:165], v34 offset:14592
  s_waitcnt lgkmcnt(6)
  v_mfma_f32_16x16x32_bf16 v[112:115], v[148:151], v[136:139], v[112:115]
  ds_read_b64_tr_b16 v[166:167], v35 offset:14592
  ds_read_b128 v[172:175], v37 offset:26624
  v_mfma_f32_16x16x32_bf16 v[116:119], v[148:151], v[140:143], v[116:119]
  ds_read_b128 v[176:179], v37 offset:28672
  ds_read_b128 v[180:183], v37 offset:30720
  s_waitcnt lgkmcnt(9)
  v_mfma_f32_16x16x32_bf16 v[120:123], v[152:155], v[136:139], v[120:123]
  buffer_load_dwordx4 v22, s[24:27], s16 offen offset:1024  lds
  v_mfma_f32_16x16x32_bf16 v[124:127], v[152:155], v[140:143], v[124:127]
  buffer_load_dwordx4 v22, s[24:27], s16 offen offset:2048  lds
  s_waitcnt lgkmcnt(8)
  v_mfma_f32_16x16x32_bf16 v[128:131], v[156:159], v[136:139], v[128:131]
  buffer_load_dwordx4 v22, s[24:27], s16 offen offset:3072  lds
  s_add_u32 s16, s16, 16384
  v_mfma_f32_16x16x32_bf16 v[132:135], v[156:159], v[140:143], v[132:135]
  s_waitcnt vmcnt(18) lgkmcnt(0)
  s_barrier
  v_mfma_f32_16x16x32_bf16 v[104:107], v[168:171], v[160:163], v[104:107]
  ds_read_b64_tr_b16 v[136:137], v34 offset:16384
  ds_read_b64_tr_b16 v[138:139], v35 offset:16384
  v_mfma_f32_16x16x32_bf16 v[108:111], v[168:171], v[164:167], v[108:111]
  ds_read_b128 v[144:147], v36 offset:32768
  ds_read_b64_tr_b16 v[140:141], v34 offset:18432
  v_mfma_f32_16x16x32_bf16 v[112:115], v[172:175], v[160:163], v[112:115]
  ds_read_b64_tr_b16 v[142:143], v35 offset:18432
  ds_read_b128 v[148:151], v36 offset:34816
  v_mfma_f32_16x16x32_bf16 v[116:119], v[172:175], v[164:167], v[116:119]
  ds_read_b128 v[152:155], v36 offset:36864
  ds_read_b128 v[156:159], v36 offset:38912
  v_mfma_f32_16x16x32_bf16 v[120:123], v[176:179], v[160:163], v[120:123]
  s_add_u32 m0, s23, 24576
  s_nop 0
  buffer_load_dwordx4 v32, s[28:31], s17 offen offset:0 lds
  v_mfma_f32_16x16x32_bf16 v[124:127], v[176:179], v[164:167], v[124:127]
  buffer_load_dwordx4 v33, s[28:31], s17 offen offset:1024 lds
  v_mfma_f32_16x16x32_bf16 v[128:131], v[180:183], v[160:163], v[128:131]
  s_add_u32 m0, s22, 12288
  s_nop 0
  buffer_load_dwordx4 v22, s[24:27], s16 offen offset:0  lds
  v_mfma_f32_16x16x32_bf16 v[132:135], v[180:183], v[164:167], v[132:135]
  s_waitcnt lgkmcnt(5)
  v_mfma_f32_16x16x32_bf16 v[104:107], v[144:147], v[136:139], v[104:107]
  ds_read_b64_tr_b16 v[160:161], v34 offset:16640
  ds_read_b64_tr_b16 v[162:163], v35 offset:16640
  s_waitcnt lgkmcnt(5)
  v_mfma_f32_16x16x32_bf16 v[108:111], v[144:147], v[140:143], v[108:111]
  ds_read_b128 v[168:171], v37 offset:32768
  ds_read_b64_tr_b16 v[164:165], v34 offset:18688
  s_waitcnt lgkmcnt(6)
  v_mfma_f32_16x16x32_bf16 v[112:115], v[148:151], v[136:139], v[112:115]
  ds_read_b64_tr_b16 v[166:167], v35 offset:18688
  ds_read_b128 v[172:175], v37 offset:34816
  v_mfma_f32_16x16x32_bf16 v[116:119], v[148:151], v[140:143], v[116:119]
  ds_read_b128 v[176:179], v37 offset:36864
  ds_read_b128 v[180:183], v37 offset:38912
  s_waitcnt lgkmcnt(9)
  v_mfma_f32_16x16x32_bf16 v[120:123], v[152:155], v[136:139], v[120:123]
  buffer_load_dwordx4 v22, s[24:27], s16 offen offset:1024  lds
  v_mfma_f32_16x16x32_bf16 v[124:127], v[152:155], v[140:143], v[124:127]
  buffer_load_dwordx4 v22, s[24:27], s16 offen offset:2048  lds
  s_waitcnt lgkmcnt(8)
  v_mfma_f32_16x16x32_bf16 v[128:131], v[156:159], v[136:139], v[128:131]
  buffer_load_dwordx4 v22, s[24:27], s16 offen offset:3072  lds
  s_add_u32 s16, s16, 16384
  v_mfma_f32_16x16x32_bf16 v[132:135], v[156:159], v[140:143], v[132:135]
  s_waitcnt vmcnt(18) lgkmcnt(0)
  s_barrier
  v_mfma_f32_16x16x32_bf16 v[104:107], v[168:171], v[160:163], v[104:107]
  ds_read_b64_tr_b16 v[136:137], v34 offset:0
  ds_read_b64_tr_b16 v[138:139], v35 offset:0
  v_mfma_f32_16x16x32_bf16 v[108:111], v[168:171], v[164:167], v[108:111]
  ds_read_b128 v[144:147], v36 offset:0
  ds_read_b64_tr_b16 v[140:141], v34 offset:2048
  v_mfma_f32_16x16x32_bf16 v[112:115], v[172:175], v[160:163], v[112:115]
  ds_read_b64_tr_b16 v[142:143], v35 offset:2048
  ds_read_b128 v[148:151], v36 offset:2048
  v_mfma_f32_16x16x32_bf16 v[116:119], v[172:175], v[164:167], v[116:119]
  ds_read_b128 v[152:155], v36 offset:4096
  ds_read_b128 v[156:159], v36 offset:6144
  v_mfma_f32_16x16x32_bf16 v[120:123], v[176:179], v[160:163], v[120:123]
  s_add_u32 m0, s23, 32768
  s_nop 0
  buffer_load_dwordx4 v32, s[32:35], s17 offen offset:0 lds
  v_mfma_f32_16x16x32_bf16 v[124:127], v[176:179], v[164:167], v[124:127]
  buffer_load_dwordx4 v33, s[32:35], s17 offen offset:1024 lds
  s_add_u32 s17, s17, 128
  v_mfma_f32_16x16x32_bf16 v[128:131], v[180:183], v[160:163], v[128:131]
  s_add_u32 m0, s22, 16384
  s_nop 0
  buffer_load_dwordx4 v22, s[24:27], s16 offen offset:0  lds
  v_mfma_f32_16x16x32_bf16 v[132:135], v[180:183], v[164:167], v[132:135]
  s_waitcnt lgkmcnt(5)
  v_mfma_f32_16x16x32_bf16 v[104:107], v[144:147], v[136:139], v[104:107]
  ds_read_b64_tr_b16 v[160:161], v34 offset:256
  ds_read_b64_tr_b16 v[162:163], v35 offset:256
  s_waitcnt lgkmcnt(5)
  v_mfma_f32_16x16x32_bf16 v[108:111], v[144:147], v[140:143], v[108:111]
  ds_read_b128 v[168:171], v37 offset:0
  ds_read_b64_tr_b16 v[164:165], v34 offset:2304
  s_waitcnt lgkmcnt(6)
  v_mfma_f32_16x16x32_bf16 v[112:115], v[148:151], v[136:139], v[112:115]
  ds_read_b64_tr_b16 v[166:167], v35 offset:2304
  ds_read_b128 v[172:175], v37 offset:2048
  v_mfma_f32_16x16x32_bf16 v[116:119], v[148:151], v[140:143], v[116:119]
  ds_read_b128 v[176:179], v37 offset:4096
  ds_read_b128 v[180:183], v37 offset:6144
  s_waitcnt lgkmcnt(9)
  v_mfma_f32_16x16x32_bf16 v[120:123], v[152:155], v[136:139], v[120:123]
  buffer_load_dwordx4 v22, s[24:27], s16 offen offset:1024  lds
  v_mfma_f32_16x16x32_bf16 v[124:127], v[152:155], v[140:143], v[124:127]
  buffer_load_dwordx4 v22, s[24:27], s16 offen offset:2048  lds
  s_waitcnt lgkmcnt(8)
  v_mfma_f32_16x16x32_bf16 v[128:131], v[156:159], v[136:139], v[128:131]
  buffer_load_dwordx4 v22, s[24:27], s16 offen offset:3072  lds
  s_add_u32 s16, s16, 16384
  v_mfma_f32_16x16x32_bf16 v[132:135], v[156:159], v[140:143], v[132:135]
  s_waitcnt vmcnt(18) lgkmcnt(0)
  s_barrier
  v_mfma_f32_16x16x32_bf16 v[104:107], v[168:171], v[160:163], v[104:107]
  ds_read_b64_tr_b16 v[136:137], v34 offset:4096
  ds_read_b64_tr_b16 v[138:139], v35 offset:4096
  v_mfma_f32_16x16x32_bf16 v[108:111], v[168:171], v[164:167], v[108:111]
  ds_read_b128 v[144:147], v36 offset:8192
  ds_read_b64_tr_b16 v[140:141], v34 offset:6144
  v_mfma_f32_16x16x32_bf16 v[112:115], v[172:175], v[160:163], v[112:115]
  ds_read_b64_tr_b16 v[142:143], v35 offset:6144
  ds_read_b128 v[148:151], v36 offset:10240
  v_mfma_f32_16x16x32_bf16 v[116:119], v[172:175], v[164:167], v[116:119]
  ds_read_b128 v[152:155], v36 offset:12288
  ds_read_b128 v[156:159], v36 offset:14336
  v_mfma_f32_16x16x32_bf16 v[120:123], v[176:179], v[160:163], v[120:123]
  s_add_u32 m0, s23, 0
  s_nop 0
  buffer_load_dwordx4 v32, s[28:31], s17 offen offset:0 lds
  v_mfma_f32_16x16x32_bf16 v[124:127], v[176:179], v[164:167], v[124:127]
  buffer_load_dwordx4 v33, s[28:31], s17 offen offset:1024 lds
  v_mfma_f32_16x16x32_bf16 v[128:131], v[180:183], v[160:163], v[128:131]
  s_add_u32 m0, s22, 0
  s_nop 0
  buffer_load_dwordx4 v22, s[24:27], s16 offen offset:0  lds
  v_mfma_f32_16x16x32_bf16 v[132:135], v[180:183], v[164:167], v[132:135]
  s_waitcnt lgkmcnt(5)
  v_mfma_f32_16x16x32_bf16 v[104:107], v[144:147], v[136:139], v[104:107]
  ds_read_b64_tr_b16 v[160:161], v34 offset:4352
  ds_read_b64_tr_b16 v[162:163], v35 offset:4352
  s_waitcnt lgkmcnt(5)
  v_mfma_f32_16x16x32_bf16 v[108:111], v[144:147], v[140:143], v[108:111]
  ds_read_b128 v[168:171], v37 offset:8192
  ds_read_b64_tr_b16 v[164:165], v34 offset:6400
  s_waitcnt lgkmcnt(6)
  v_mfma_f32_16x16x32_bf16 v[112:115], v[148:151], v[136:139], v[112:115]
  ds_read_b64_tr_b16 v[166:167], v35 offset:6400
  ds_read_b128 v[172:175], v37 offset:10240
  v_mfma_f32_16x16x32_bf16 v[116:119], v[148:151], v[140:143], v[116:119]
  ds_read_b128 v[176:179], v37 offset:12288
  ds_read_b128 v[180:183], v37 offset:14336
  s_waitcnt lgkmcnt(9)
  v_mfma_f32_16x16x32_bf16 v[120:123], v[152:155], v[136:139], v[120:123]
  buffer_load_dwordx4 v22, s[24:27], s16 offen offset:1024  lds
  v_mfma_f32_16x16x32_bf16 v[124:127], v[152:155], v[140:143], v[124:127]
  buffer_load_dwordx4 v22, s[24:27], s16 offen offset:2048  lds
  s_waitcnt lgkmcnt(8)
  v_mfma_f32_16x16x32_bf16 v[128:131], v[156:159], v[136:139], v[128:131]
  buffer_load_dwordx4 v22, s[24:27], s16 offen offset:3072  lds
  s_add_u32 s16, s16, 16384
  v_mfma_f32_16x16x32_bf16 v[132:135], v[156:159], v[140:143], v[132:135]
  s_waitcnt vmcnt(18) lgkmcnt(0)
  s_barrier
  v_mfma_f32_16x16x32_bf16 v[104:107], v[168:171], v[160:163], v[104:107]
  ds_read_b64_tr_b16 v[136:137], v34 offset:8192
  ds_read_b64_tr_b16 v[138:139], v35 offset:8192
  v_mfma_f32_16x16x32_bf16 v[108:111], v[168:171], v[164:167], v[108:111]
  ds_read_b128 v[144:147], v36 offset:16384
  ds_read_b64_tr_b16 v[140:141], v34 offset:10240
  v_mfma_f32_16x16x32_bf16 v[112:115], v[172:175], v[160:163], v[112:115]
  ds_read_b64_tr_b16 v[142:143], v35 offset:10240
  ds_read_b128 v[148:151], v36 offset:18432
  v_mfma_f32_16x16x32_bf16 v[116:119], v[172:175], v[164:167], v[116:119]
  ds_read_b128 v[152:155], v36 offset:20480
  ds_read_b128 v[156:159], v36 offset:22528
  v_mfma_f32_16x16x32_bf16 v[120:123], v[176:179], v[160:163], v[120:123]
  s_add_u32 m0, s23, 8192
  s_nop 0
  buffer_load_dwordx4 v32, s[32:35], s17 offen offset:0 lds
  v_mfma_f32_16x16x32_bf16 v[124:127], v[176:179], v[164:167], v[124:127]
  buffer_load_dwordx4 v33, s[32:35], s17 offen offset:1024 lds
  s_add_u32 s17, s17, 128
  v_mfma_f32_16x16x32_bf16 v[128:131], v[180:183], v[160:163], v[128:131]
  s_add_u32 m0, s22, 4096
  s_nop 0
  buffer_load_dwordx4 v22, s[24:27], s16 offen offset:0  lds
  v_mfma_f32_16x16x32_bf16 v[132:135], v[180:183], v[164:167], v[132:135]
  s_waitcnt lgkmcnt(5)
  v_mfma_f32_16x16x32_bf16 v[104:107], v[144:147], v[136:139], v[104:107]
  ds_read_b64_tr_b16 v[160:161], v34 offset:8448
  ds_read_b64_tr_b16 v[162:163], v35 offset:8448
  s_waitcnt lgkmcnt(5)
  v_mfma_f32_16x16x32_bf16 v[108:111], v[144:147], v[140:143], v[108:111]
  ds_read_b128 v[168:171], v37 offset:16384
  ds_read_b64_tr_b16 v[164:165], v34 offset:10496
  s_waitcnt lgkmcnt(6)
  v_mfma_f32_16x16x32_bf16 v[112:115], v[148:151], v[136:139], v[112:115]
  ds_read_b64_tr_b16 v[166:167], v35 offset:10496
  ds_read_b128 v[172:175], v37 offset:18432
  v_mfma_f32_16x16x32_bf16 v[116:119], v[148:151], v[140:143], v[116:119]
  ds_read_b128 v[176:179], v37 offset:20480
  ds_read_b128 v[180:183], v37 offset:22528
  s_waitcnt lgkmcnt(9)
  v_mfma_f32_16x16x32_bf16 v[120:123], v[152:155], v[136:139], v[120:123]
  buffer_load_dwordx4 v22, s[24:27], s16 offen offset:1024  lds
  v_mfma_f32_16x16x32_bf16 v[124:127], v[152:155], v[140:143], v[124:127]
  buffer_load_dwordx4 v22, s[24:27], s16 offen offset:2048  lds
  s_waitcnt lgkmcnt(8)
  v_mfma_f32_16x16x32_bf16 v[128:131], v[156:159], v[136:139], v[128:131]
  buffer_load_dwordx4 v22, s[24:27], s16 offen offset:3072  lds
  s_add_u32 s16, s16, 16384
  v_mfma_f32_16x16x32_bf16 v[132:135], v[156:159], v[140:143], v[132:135]
  s_waitcnt vmcnt(18) lgkmcnt(0)
  s_barrier
  v_mfma_f32_16x16x32_bf16 v[104:107], v[168:171], v[160:163], v[104:107]
  ds_read_b64_tr_b16 v[136:137], v34 offset:12288
  ds_read_b64_tr_b16 v[138:139], v35 offset:12288
  v_mfma_f32_16x16x32_bf16 v[108:111], v[168:171], v[164:167], v[108:111]
  ds_read_b128 v[144:147], v36 offset:24576
  ds_read_b64_tr_b16 v[140:141], v34 offset:14336
  v_mfma_f32_16x16x32_bf16 v[112:115], v[172:175], v[160:163], v[112:115]
  ds_read_b64_tr_b16 v[142:143], v35 offset:14336
  ds_read_b128 v[148:151], v36 offset:26624
  v_mfma_f32_16x16x32_bf16 v[116:119], v[172:175], v[164:167], v[116:119]
  ds_read_b128 v[152:155], v36 offset:28672
  ds_read_b128 v[156:159], v36 offset:30720
  v_mfma_f32_16x16x32_bf16 v[120:123], v[176:179], v[160:163], v[120:123]
  v_mfma_f32_16x16x32_bf16 v[124:127], v[176:179], v[164:167], v[124:127]
  v_mfma_f32_16x16x32_bf16 v[128:131], v[180:183], v[160:163], v[128:131]
  v_mfma_f32_16x16x32_bf16 v[132:135], v[180:183], v[164:167], v[132:135]
  s_waitcnt lgkmcnt(5)
  v_mfma_f32_16x16x32_bf16 v[104:107], v[144:147], v[136:139], v[104:107]
  ds_read_b64_tr_b16 v[160:161], v34 offset:12544
  ds_read_b64_tr_b16 v[162:163], v35 offset:12544
  s_waitcnt lgkmcnt(5)
  v_mfma_f32_16x16x32_bf16 v[108:111], v[144:147], v[140:143], v[108:111]
  ds_read_b128 v[168:171], v37 offset:24576
  ds_read_b64_tr_b16 v[164:165], v34 offset:14592
  s_waitcnt lgkmcnt(6)
  v_mfma_f32_16x16x32_bf16 v[112:115], v[148:151], v[136:139], v[112:115]
  ds_read_b64_tr_b16 v[166:167], v35 offset:14592
  ds_read_b128 v[172:175], v37 offset:26624
  v_mfma_f32_16x16x32_bf16 v[116:119], v[148:151], v[140:143], v[116:119]
  ds_read_b128 v[176:179], v37 offset:28672
  ds_read_b128 v[180:183], v37 offset:30720
  s_waitcnt lgkmcnt(9)
  v_mfma_f32_16x16x32_bf16 v[120:123], v[152:155], v[136:139], v[120:123]
  v_mfma_f32_16x16x32_bf16 v[124:127], v[152:155], v[140:143], v[124:127]
  s_waitcnt lgkmcnt(8)
  v_mfma_f32_16x16x32_bf16 v[128:131], v[156:159], v[136:139], v[128:131]
  v_mfma_f32_16x16x32_bf16 v[132:135], v[156:159], v[140:143], v[132:135]
  s_waitcnt vmcnt(12) lgkmcnt(0)
  s_barrier
  v_mfma_f32_16x16x32_bf16 v[104:107], v[168:171], v[160:163], v[104:107]
  ds_read_b64_tr_b16 v[136:137], v34 offset:16384
  ds_read_b64_tr_b16 v[138:139], v35 offset:16384
  v_mfma_f32_16x16x32_bf16 v[108:111], v[168:171], v[164:167], v[108:111]
  ds_read_b128 v[144:147], v36 offset:32768
  ds_read_b64_tr_b16 v[140:141], v34 offset:18432
  v_mfma_f32_16x16x32_bf16 v[112:115], v[172:175], v[160:163], v[112:115]
  ds_read_b64_tr_b16 v[142:143], v35 offset:18432
  ds_read_b128 v[148:151], v36 offset:34816
  v_mfma_f32_16x16x32_bf16 v[116:119], v[172:175], v[164:167], v[116:119]
  ds_read_b128 v[152:155], v36 offset:36864
  ds_read_b128 v[156:159], v36 offset:38912
  v_mfma_f32_16x16x32_bf16 v[120:123], v[176:179], v[160:163], v[120:123]
  v_mfma_f32_16x16x32_bf16 v[124:127], v[176:179], v[164:167], v[124:127]
  v_mfma_f32_16x16x32_bf16 v[128:131], v[180:183], v[160:163], v[128:131]
  v_mfma_f32_16x16x32_bf16 v[132:135], v[180:183], v[164:167], v[132:135]
  s_waitcnt lgkmcnt(5)
  v_mfma_f32_16x16x32_bf16 v[104:107], v[144:147], v[136:139], v[104:107]
  ds_read_b64_tr_b16 v[160:161], v34 offset:16640
  ds_read_b64_tr_b16 v[162:163], v35 offset:16640
  s_waitcnt lgkmcnt(5)
  v_mfma_f32_16x16x32_bf16 v[108:111], v[144:147], v[140:143], v[108:111]
  ds_read_b128 v[168:171], v37 offset:32768
  ds_read_b64_tr_b16 v[164:165], v34 offset:18688
  s_waitcnt lgkmcnt(6)
  v_mfma_f32_16x16x32_bf16 v[112:115], v[148:151], v[136:139], v[112:115]
  ds_read_b64_tr_b16 v[166:167], v35 offset:18688
  ds_read_b128 v[172:175], v37 offset:34816
  v_mfma_f32_16x16x32_bf16 v[116:119], v[148:151], v[140:143], v[116:119]
  ds_read_b128 v[176:179], v37 offset:36864
  ds_read_b128 v[180:183], v37 offset:38912
  s_waitcnt lgkmcnt(9)
  v_mfma_f32_16x16x32_bf16 v[120:123], v[152:155], v[136:139], v[120:123]
  v_mfma_f32_16x16x32_bf16 v[124:127], v[152:155], v[140:143], v[124:127]
  s_waitcnt lgkmcnt(8)
  v_mfma_f32_16x16x32_bf16 v[128:131], v[156:159], v[136:139], v[128:131]
  v_mfma_f32_16x16x32_bf16 v[132:135], v[156:159], v[140:143], v[132:135]
  s_waitcnt vmcnt(6) lgkmcnt(0)
  s_barrier
  v_mfma_f32_16x16x32_bf16 v[104:107], v[168:171], v[160:163], v[104:107]
  ds_read_b64_tr_b16 v[136:137], v34 offset:0
  ds_read_b64_tr_b16 v[138:139], v35 offset:0
  v_mfma_f32_16x16x32_bf16 v[108:111], v[168:171], v[164:167], v[108:111]
  ds_read_b128 v[144:147], v36 offset:0
  ds_read_b64_tr_b16 v[140:141], v34 offset:2048
  v_mfma_f32_16x16x32_bf16 v[112:115], v[172:175], v[160:163], v[112:115]
  ds_read_b64_tr_b16 v[142:143], v35 offset:2048
  ds_read_b128 v[148:151], v36 offset:2048
  v_mfma_f32_16x16x32_bf16 v[116:119], v[172:175], v[164:167], v[116:119]
  ds_read_b128 v[152:155], v36 offset:4096
  ds_read_b128 v[156:159], v36 offset:6144
  v_mfma_f32_16x16x32_bf16 v[120:123], v[176:179], v[160:163], v[120:123]
  v_mfma_f32_16x16x32_bf16 v[124:127], v[176:179], v[164:167], v[124:127]
  v_mfma_f32_16x16x32_bf16 v[128:131], v[180:183], v[160:163], v[128:131]
  v_mfma_f32_16x16x32_bf16 v[132:135], v[180:183], v[164:167], v[132:135]
  s_waitcnt lgkmcnt(5)
  v_mfma_f32_16x16x32_bf16 v[104:107], v[144:147], v[136:139], v[104:107]
  ds_read_b64_tr_b16 v[160:161], v34 offset:256
  ds_read_b64_tr_b16 v[162:163], v35 offset:256
  s_waitcnt lgkmcnt(5)
  v_mfma_f32_16x16x32_bf16 v[108:111], v[144:147], v[140:143], v[108:111]
  ds_read_b128 v[168:171], v37 offset:0
  ds_read_b64_tr_b16 v[164:165], v34 offset:2304
  s_waitcnt lgkmcnt(6)
  v_mfma_f32_16x16x32_bf16 v[112:115], v[148:151], v[136:139], v[112:115]
  ds_read_b64_tr_b16 v[166:167], v35 offset:2304
  ds_read_b128 v[172:175], v37 offset:2048
  v_mfma_f32_16x16x32_bf16 v[116:119], v[148:151], v[140:143], v[116:119]
  ds_read_b128 v[176:179], v37 offset:4096
  ds_read_b128 v[180:183], v37 offset:6144
  s_waitcnt lgkmcnt(9)
  v_mfma_f32_16x16x32_bf16 v[120:123], v[152:155], v[136:139], v[120:123]
  v_mfma_f32_16x16x32_bf16 v[124:127], v[152:155], v[140:143], v[124:127]
  s_waitcnt lgkmcnt(8)
  v_mfma_f32_16x16x32_bf16 v[128:131], v[156:159], v[136:139], v[128:131]
  v_mfma_f32_16x16x32_bf16 v[132:135], v[156:159], v[140:143], v[132:135]
  s_waitcnt vmcnt(0) lgkmcnt(0)
  s_barrier
  v_mfma_f32_16x16x32_bf16 v[104:107], v[168:171], v[160:163], v[104:107]
  ds_read_b64_tr_b16 v[136:137], v34 offset:4096
  ds_read_b64_tr_b16 v[138:139], v35 offset:4096
  v_mfma_f32_16x16x32_bf16 v[108:111], v[168:171], v[164:167], v[108:111]
  ds_read_b128 v[144:147], v36 offset:8192
  ds_read_b64_tr_b16 v[140:141], v34 offset:6144
  v_mfma_f32_16x16x32_bf16 v[112:115], v[172:175], v[160:163], v[112:115]
  ds_read_b64_tr_b16 v[142:143], v35 offset:6144
  ds_read_b128 v[148:151], v36 offset:10240
  v_mfma_f32_16x16x32_bf16 v[116:119], v[172:175], v[164:167], v[116:119]
  ds_read_b128 v[152:155], v36 offset:12288
  ds_read_b128 v[156:159], v36 offset:14336
  v_mfma_f32_16x16x32_bf16 v[120:123], v[176:179], v[160:163], v[120:123]
  v_mfma_f32_16x16x32_bf16 v[124:127], v[176:179], v[164:167], v[124:127]
  v_mfma_f32_16x16x32_bf16 v[128:131], v[180:183], v[160:163], v[128:131]
  v_mfma_f32_16x16x32_bf16 v[132:135], v[180:183], v[164:167], v[132:135]
  s_waitcnt lgkmcnt(5)
  v_mfma_f32_16x16x32_bf16 v[104:107], v[144:147], v[136:139], v[104:107]
  ds_read_b64_tr_b16 v[160:161], v34 offset:4352
  ds_read_b64_tr_b16 v[162:163], v35 offset:4352
  s_waitcnt lgkmcnt(5)
  v_mfma_f32_16x16x32_bf16 v[108:111], v[144:147], v[140:143], v[108:111]
  ds_read_b128 v[168:171], v37 offset:8192
  ds_read_b64_tr_b16 v[164:165], v34 offset:6400
  s_waitcnt lgkmcnt(6)
  v_mfma_f32_16x16x32_bf16 v[112:115], v[148:151], v[136:139], v[112:115]
  ds_read_b64_tr_b16 v[166:167], v35 offset:6400
  ds_read_b128 v[172:175], v37 offset:10240
  v_mfma_f32_16x16x32_bf16 v[116:119], v[148:151], v[140:143], v[116:119]
  ds_read_b128 v[176:179], v37 offset:12288
  ds_read_b128 v[180:183], v37 offset:14336
  s_waitcnt lgkmcnt(9)
  v_mfma_f32_16x16x32_bf16 v[120:123], v[152:155], v[136:139], v[120:123]
  v_mfma_f32_16x16x32_bf16 v[124:127], v[152:155], v[140:143], v[124:127]
  s_waitcnt lgkmcnt(8)
  v_mfma_f32_16x16x32_bf16 v[128:131], v[156:159], v[136:139], v[128:131]
  v_mfma_f32_16x16x32_bf16 v[132:135], v[156:159], v[140:143], v[132:135]
  s_waitcnt lgkmcnt(5)
  v_mfma_f32_16x16x32_bf16 v[104:107], v[168:171], v[160:163], v[104:107]
  s_waitcnt lgkmcnt(3)
  v_mfma_f32_16x16x32_bf16 v[108:111], v[168:171], v[164:167], v[108:111]
  s_waitcnt lgkmcnt(2)
  v_mfma_f32_16x16x32_bf16 v[112:115], v[172:175], v[160:163], v[112:115]
  v_mfma_f32_16x16x32_bf16 v[116:119], v[172:175], v[164:167], v[116:119]
  s_waitcnt lgkmcnt(1)
  v_mfma_f32_16x16x32_bf16 v[120:123], v[176:179], v[160:163], v[120:123]
  v_mfma_f32_16x16x32_bf16 v[124:127], v[176:179], v[164:167], v[124:127]
  s_waitcnt lgkmcnt(0)
  v_mfma_f32_16x16x32_bf16 v[128:131], v[180:183], v[160:163], v[128:131]
  v_mfma_f32_16x16x32_bf16 v[132:135], v[180:183], v[164:167], v[132:135]
  v_lshlrev_b32 v4, 16, v2
  v_lshl_or_b32 v4, v3, 4, v4
  s_lshl_b32 s16, s3, 21
  s_lshl_b32 s17, s18, 12
  s_add_u32 s16, s16, s17
  s_lshl_b32 s17, s19, 6
  s_add_u32 s16, s16, s17
  s_add_u32 s17, s16, 1048576
  v_pk_fma_f32 v[72:73], v[54:55], v[104:105], v[72:73] op_sel:[0,0,0] op_sel_hi:[0,1,1]
  v_pk_fma_f32 v[74:75], v[54:55], v[106:107], v[74:75] op_sel:[0,0,0] op_sel_hi:[0,1,1]
  buffer_store_dwordx4 v[72:75], v4, s[52:55], s16 offen offset:0
  v_pk_fma_f32 v[76:77], v[54:55], v[108:109], v[76:77] op_sel:[1,0,0] op_sel_hi:[1,1,1]
  v_pk_fma_f32 v[78:79], v[54:55], v[110:111], v[78:79] op_sel:[1,0,0] op_sel_hi:[1,1,1]
  buffer_store_dwordx4 v[76:79], v4, s[52:55], s17 offen offset:0
  v_pk_fma_f32 v[80:81], v[54:55], v[112:113], v[80:81] op_sel:[0,0,0] op_sel_hi:[0,1,1]
  v_pk_fma_f32 v[82:83], v[54:55], v[114:115], v[82:83] op_sel:[0,0,0] op_sel_hi:[0,1,1]
  buffer_store_dwordx4 v[80:83], v4, s[52:55], s16 offen offset:1024
  v_pk_fma_f32 v[84:85], v[54:55], v[116:117], v[84:85] op_sel:[1,0,0] op_sel_hi:[1,1,1]
  v_pk_fma_f32 v[86:87], v[54:55], v[118:119], v[86:87] op_sel:[1,0,0] op_sel_hi:[1,1,1]
  buffer_store_dwordx4 v[84:87], v4, s[52:55], s17 offen offset:1024
  v_pk_fma_f32 v[88:89], v[54:55], v[120:121], v[88:89] op_sel:[0,0,0] op_sel_hi:[0,1,1]
  v_pk_fma_f32 v[90:91], v[54:55], v[122:123], v[90:91] op_sel:[0,0,0] op_sel_hi:[0,1,1]
  buffer_store_dwordx4 v[88:91], v4, s[52:55], s16 offen offset:2048
  v_pk_fma_f32 v[92:93], v[54:55], v[124:125], v[92:93] op_sel:[1,0,0] op_sel_hi:[1,1,1]
  v_pk_fma_f32 v[94:95], v[54:55], v[126:127], v[94:95] op_sel:[1,0,0] op_sel_hi:[1,1,1]
  buffer_store_dwordx4 v[92:95], v4, s[52:55], s17 offen offset:2048
  v_pk_fma_f32 v[96:97], v[54:55], v[128:129], v[96:97] op_sel:[0,0,0] op_sel_hi:[0,1,1]
  v_pk_fma_f32 v[98:99], v[54:55], v[130:131], v[98:99] op_sel:[0,0,0] op_sel_hi:[0,1,1]
  buffer_store_dwordx4 v[96:99], v4, s[52:55], s16 offen offset:3072
  v_pk_fma_f32 v[100:101], v[54:55], v[132:133], v[100:101] op_sel:[1,0,0] op_sel_hi:[1,1,1]
  v_pk_fma_f32 v[102:103], v[54:55], v[134:135], v[102:103] op_sel:[1,0,0] op_sel_hi:[1,1,1]
  buffer_store_dwordx4 v[100:103], v4, s[52:55], s17 offen offset:3072
kd_kernel_end:
  s_endpgm
.section .rodata,"a"
.p2align 6
.amdhsa_kernel ka_kernel
  .amdhsa_next_free_vgpr 164
  .amdhsa_next_free_sgpr 102
  .amdhsa_accum_offset 164
  .amdhsa_group_segment_fixed_size 0
  .amdhsa_kernarg_size 128
  .amdhsa_user_sgpr_count 2
  .amdhsa_user_sgpr_kernarg_segment_ptr 1
  .amdhsa_system_sgpr_workgroup_id_x 1
  .amdhsa_float_denorm_mode_32 3
.end_amdhsa_kernel
.p2align 6
.amdhsa_kernel kb_kernel
  .amdhsa_next_free_vgpr 196
  .amdhsa_next_free_sgpr 102
  .amdhsa_accum_offset 196
  .amdhsa_group_segment_fixed_size 0
  .amdhsa_kernarg_size 128
  .amdhsa_user_sgpr_count 2
  .amdhsa_user_sgpr_kernarg_segment_ptr 1
  .amdhsa_system_sgpr_workgroup_id_x 1
  .amdhsa_float_denorm_mode_32 3
.end_amdhsa_kernel
.p2align 6
.amdhsa_kernel kc_kernel
  .amdhsa_next_free_vgpr 124
  .amdhsa_next_free_sgpr 102
  .amdhsa_accum_offset 124
  .amdhsa_group_segment_fixed_size 0
  .amdhsa_kernarg_size 128
  .amdhsa_user_sgpr_count 2
  .amdhsa_user_sgpr_kernarg_segment_ptr 1
  .amdhsa_system_sgpr_workgroup_id_x 1
  .amdhsa_float_denorm_mode_32 3
.end_amdhsa_kernel
.p2align 6
.amdhsa_kernel kd_kernel
  .amdhsa_next_free_vgpr 184
  .amdhsa_next_free_sgpr 102
  .amdhsa_accum_offset 184
  .amdhsa_group_segment_fixed_size 0
  .amdhsa_kernarg_size 128
  .amdhsa_user_sgpr_count 2
  .amdhsa_user_sgpr_kernarg_segment_ptr 1
  .amdhsa_system_sgpr_workgroup_id_x 1
  .amdhsa_float_denorm_mode_32 3
.end_amdhsa_kernel
```

```asm
; @launch grid=(256,1,1) block=(256,1,1) lds=147456
.amdgcn_target "amdgcn-amd-amdhsa--gfx950"
.text
.p2align 8
.globl gated_mix__spectral_gfnet__ssm_conv_s5__prompt_kernel
.type gated_mix__spectral_gfnet__ssm_conv_s5__prompt_kernel,@function
gated_mix__spectral_gfnet__ssm_conv_s5__prompt_kernel:
  s_cmp_ge_u32 s2, 256
  s_cbranch_scc1 gated_mix__spectral_gfnet__ssm_conv_s5__prompt_kernel_end
  s_load_dwordx16 s[4:19], s[0:1], 0
  s_load_dwordx16 s[20:35], s[0:1], 64
  s_getpc_b64 s[36:37]
gated_mix__spectral_gfnet__ssm_conv_s5__prompt_kernel_pc1:
  s_lshr_b32 s3, s2, 3
  s_mul_i32 s3, s3, 1280
  s_add_u32 s3, s3, 0
  v_min_u32 v2, 9, v0
  v_lshl_add_u32 v2, v2, 7, s3
  v_min_u32 v2, gated_mix__spectral_gfnet__ssm_conv_s5__prompt_kernel_end-gated_mix__spectral_gfnet__ssm_conv_s5__prompt_kernel_pc1, v2
  v_mov_b32 v3, s37
  v_add_co_u32 v2, vcc, s36, v2
  s_nop 1
  v_addc_co_u32 v3, vcc, 0, v3, vcc
  v_lshrrev_b32 v4, 6, v0
  s_nop 0
  v_readfirstlane_b32 s3, v4
  v_and_b32 v4, 63, v0
  v_and_b32 v5, 15, v0
  v_bfe_u32 v6, v0, 4, 2
  s_and_b32 s36, s2, 7
  s_lshr_b32 s37, s2, 3
  s_and_b32 s41, s37, 3
  s_lshr_b32 s37, s37, 2
  s_lshl_b32 s40, s36, 3
  s_add_u32 s40, s40, s37
  s_and_b32 s38, s36, 3
  s_lshl_b32 s38, s38, 2
  s_add_u32 s38, s38, s41
  s_lshr_b32 s39, s36, 2
  s_lshl_b32 s39, s39, 3
  s_add_u32 s39, s39, s37
  s_cmp_lg_u32 s3, 0
  s_cbranch_scc1 gated_mix__spectral_gfnet__ssm_conv_s5__prompt_kernel_skip2
  global_load_dword v1, v[2:3], off
gated_mix__spectral_gfnet__ssm_conv_s5__prompt_kernel_skip2:
  s_waitcnt lgkmcnt(0)
  s_mov_b32 s44, s4
  s_mov_b32 s45, s5
  s_mov_b32 s46, 4194304
  s_mov_b32 s47, 0x20000
  v_bfe_u32 v3, v4, 1, 2
  v_xor_b32 v3, v3, v6
  v_lshlrev_b32 v2, 9, v3
  v_and_b32 v3, 1, v4
  v_lshl_or_b32 v2, v3, 4, v2
  v_lshrrev_b32 v3, 3, v4
  v_lshl_or_b32 v2, v3, 15, v2
  s_lshl_b32 s36, s38, 11
  s_lshl_b32 m0, s39, 5
  s_add_u32 s36, s36, m0
  s_lshl_b32 m0, s3, 20
  s_add_u32 s36, s36, m0
  s_lshl_b32 m0, s3, 12
  s_add_u32 m0, m0, 131072
  s_nop 0
  buffer_load_dwordx4 v2, s[44:47], s36 offen offset:0 lds
  s_add_u32 s36, s36, 261120
  buffer_load_dwordx4 v2, s[44:47], s36 offen offset:1024 lds
  s_add_u32 s36, s36, 261120
  buffer_load_dwordx4 v2, s[44:47], s36 offen offset:2048 lds
  s_add_u32 s36, s36, 261120
  buffer_load_dwordx4 v2, s[44:47], s36 offen offset:3072 lds
  s_mov_b32 s48, s6
  s_mov_b32 s49, s7
  s_mov_b32 s50, 2101248
  s_mov_b32 s51, 0x20000
  s_mov_b32 s52, s8
  s_mov_b32 s53, s9
  s_mov_b32 s54, 2101248
  s_mov_b32 s55, 0x20000
  s_bitcmp1_b32 s3, 0
  s_cselect_b32 s56, s18, s16
  s_cselect_b32 s57, s19, s17
  s_mov_b32 s58, 2097152
  s_mov_b32 s59, 0x20000
  v_lshrrev_b32 v24, 5, v4
  v_lshlrev_b32 v24, 5, v24
  v_bfe_u32 v25, v4, 3, 1
  v_lshl_or_b32 v24, v25, 4, v24
  v_bfe_u32 v25, v4, 4, 1
  v_or_b32 v24, v24, v25
  v_lshlrev_b32 v24, 11, v24
  v_lshrrev_b32 v25, 3, v4
  v_lshlrev_b32 v25, 11, v25
  v_and_b32 v26, 7, v4
  v_xor_b32 v26, v26, v6
  v_lshlrev_b32 v26, 4, v26
  v_or_b32 v24, v24, v26
  v_or_b32 v25, v25, v26
  v_xor_b32 v8, 0, v24
  v_add_u32 v8, 0, v8
  v_xor_b32 v12, 0, v25
  v_add_u32 v12, 0, v12
  v_xor_b32 v9, 64, v24
  v_add_u32 v9, 3072, v9
  v_xor_b32 v13, 64, v25
  v_add_u32 v13, 15360, v13
  v_xor_b32 v10, 0, v24
  v_add_u32 v10, 6144, v10
  v_xor_b32 v14, 0, v25
  v_add_u32 v14, 30720, v14
  v_xor_b32 v11, 64, v24
  v_add_u32 v11, 9216, v11
  v_xor_b32 v15, 64, v25
  v_add_u32 v15, 46080, v15
  s_lshl_b32 s36, s38, 18
  s_lshr_b32 s60, s3, 1
  s_lshl_b32 s42, s60, 17
  s_add_u32 s36, s36, s42
  s_lshl_b32 s37, s39, 17
  s_lshl_b32 s42, s60, 16
  s_add_u32 s37, s37, s42
  s_and_b32 s60, s3, 1
  s_lshl_b32 s60, s60, 14
  s_add_u32 s36, s36, s60
  s_lshl_b32 s60, s3, 12
  s_add_u32 s42, s60, 0
  s_add_u32 s43, s60, 65536
  v_and_b32 v24, 31, v4
  v_lshlrev_b32 v24, 7, v24
  v_bfe_u32 v25, v4, 1, 3
  v_lshrrev_b32 v26, 5, v4
  v_xor_b32 v25, v25, v26
  v_lshl_or_b32 v24, v25, 4, v24
  s_lshr_b32 s60, s3, 1
  s_lshl_b32 s60, s60, 13
  s_add_u32 s60, s60, 0
  v_add_u32 v25, s60, v24
  s_and_b32 s60, s3, 1
  s_lshl_b32 s60, s60, 13
  s_add_u32 s60, s60, 65536
  v_add_u32 v26, s60, v24
  v_xor_b32 v16, 0, v25
  v_xor_b32 v20, 0, v26
  v_xor_b32 v17, 32, v25
  v_xor_b32 v21, 32, v26
  v_xor_b32 v18, 64, v25
  v_xor_b32 v22, 64, v26
  v_xor_b32 v19, 96, v25
  v_xor_b32 v23, 96, v26
  v_add_u32 v8, s36, v8
  v_add_u32 v12, s37, v12
  v_add_u32 v9, s36, v9
  v_add_u32 v13, s37, v13
  v_add_u32 v10, s36, v10
  v_add_u32 v14, s37, v14
  v_add_u32 v11, s36, v11
  v_add_u32 v15, s37, v15
  s_add_u32 s36, s38, s39
  s_and_b32 s36, s36, 15
  s_lshl_b32 s36, s36, 7
  s_lshl_b32 s60, s3, 4
  v_add_u32 v57, s60, v5
  v_cvt_f32_u32 v2, v57
  v_mul_f32 v2, 0x3c000000, v2
  v_cmp_eq_u32 vcc, 0, v57
  s_nop 1
  v_cndmask_b32 v3, v2, 0.5, vcc
  v_mov_b32 v7, 0x3e800000
  v_cndmask_b32 v7, v7, 0, vcc
  v_lshrrev_b32 v57, 1, v6
  v_lshlrev_b32 v57, 4, v57
  v_and_b32 v58, 1, v6
  v_lshl_add_u32 v57, v58, 2, v57
  v_cvt_f32_u32 v56, v57
  v_fma_f32 v7, v56, v3, v7
  v_mul_f32 v56, v56, v2
  v_fmamk_f32 v57, v2, 0x0, v56
  v_fmamk_f32 v58, v2, 0x3f800000, v56
  v_cos_f32 v57, v57
  v_cos_f32 v58, v58
  s_nop 0
  v_cvt_pk_bf16_f32 v24, v57, v58
  v_fmamk_f32 v57, v2, 0x40000000, v56
  v_fmamk_f32 v58, v2, 0x40400000, v56
  v_cos_f32 v57, v57
  v_cos_f32 v58, v58
  s_nop 0
  v_cvt_pk_bf16_f32 v25, v57, v58
  v_fmamk_f32 v57, v2, 0x41000000, v56
  v_fmamk_f32 v58, v2, 0x41100000, v56
  v_cos_f32 v57, v57
  v_cos_f32 v58, v58
  s_nop 0
  v_cvt_pk_bf16_f32 v26, v57, v58
  v_fmamk_f32 v57, v2, 0x41200000, v56
  v_fmamk_f32 v58, v2, 0x41300000, v56
  v_cos_f32 v57, v57
  v_cos_f32 v58, v58
  s_nop 0
  v_cvt_pk_bf16_f32 v27, v57, v58
  v_fmamk_f32 v57, v2, 0x42000000, v56
  v_fmamk_f32 v58, v2, 0x42040000, v56
  v_cos_f32 v57, v57
  v_cos_f32 v58, v58
  s_nop 0
  v_cvt_pk_bf16_f32 v28, v57, v58
  v_fmamk_f32 v57, v2, 0x42080000, v56
  v_fmamk_f32 v58, v2, 0x420c0000, v56
  v_cos_f32 v57, v57
  v_cos_f32 v58, v58
  s_nop 0
  v_cvt_pk_bf16_f32 v29, v57, v58
  v_fmamk_f32 v57, v2, 0x42200000, v56
  v_fmamk_f32 v58, v2, 0x42240000, v56
  v_cos_f32 v57, v57
  v_cos_f32 v58, v58
  s_nop 0
  v_cvt_pk_bf16_f32 v30, v57, v58
  v_fmamk_f32 v57, v2, 0x42280000, v56
  v_fmamk_f32 v58, v2, 0x422c0000, v56
  v_cos_f32 v57, v57
  v_cos_f32 v58, v58
  s_nop 0
  v_cvt_pk_bf16_f32 v31, v57, v58
  v_fmamk_f32 v57, v2, 0x42800000, v56
  v_fmamk_f32 v58, v2, 0x42820000, v56
  v_cos_f32 v57, v57
  v_cos_f32 v58, v58
  s_nop 0
  v_cvt_pk_bf16_f32 v32, v57, v58
  v_fmamk_f32 v57, v2, 0x42840000, v56
  v_fmamk_f32 v58, v2, 0x42860000, v56
  v_cos_f32 v57, v57
  v_cos_f32 v58, v58
  s_nop 0
  v_cvt_pk_bf16_f32 v33, v57, v58
  v_fmamk_f32 v57, v2, 0x42900000, v56
  v_fmamk_f32 v58, v2, 0x42920000, v56
  v_cos_f32 v57, v57
  v_cos_f32 v58, v58
  s_nop 0
  v_cvt_pk_bf16_f32 v34, v57, v58
  v_fmamk_f32 v57, v2, 0x42940000, v56
  v_fmamk_f32 v58, v2, 0x42960000, v56
  v_cos_f32 v57, v57
  v_cos_f32 v58, v58
  s_nop 0
  v_cvt_pk_bf16_f32 v35, v57, v58
  v_fmamk_f32 v57, v2, 0x42c00000, v56
  v_fmamk_f32 v58, v2, 0x42c20000, v56
  v_cos_f32 v57, v57
  v_cos_f32 v58, v58
  s_nop 0
  v_cvt_pk_bf16_f32 v36, v57, v58
  v_fmamk_f32 v57, v2, 0x42c40000, v56
  v_fmamk_f32 v58, v2, 0x42c60000, v56
  v_cos_f32 v57, v57
  v_cos_f32 v58, v58
  s_nop 0
  v_cvt_pk_bf16_f32 v37, v57, v58
  v_fmamk_f32 v57, v2, 0x42d00000, v56
  v_fmamk_f32 v58, v2, 0x42d20000, v56
  v_cos_f32 v57, v57
  v_cos_f32 v58, v58
  s_nop 0
  v_cvt_pk_bf16_f32 v38, v57, v58
  v_fmamk_f32 v57, v2, 0x42d40000, v56
  v_fmamk_f32 v58, v2, 0x42d60000, v56
  v_cos_f32 v57, v57
  v_cos_f32 v58, v58
  s_nop 0
  v_cvt_pk_bf16_f32 v39, v57, v58
  v_fmamk_f32 v57, v3, 0x0, v7
  v_fmamk_f32 v58, v3, 0x3f800000, v7
  v_cos_f32 v57, v57
  v_cos_f32 v58, v58
  s_nop 0
  v_cvt_pk_bf16_f32 v40, v57, v58
  v_fmamk_f32 v57, v3, 0x40000000, v7
  v_fmamk_f32 v58, v3, 0x40400000, v7
  v_cos_f32 v57, v57
  v_cos_f32 v58, v58
  s_nop 0
  v_cvt_pk_bf16_f32 v41, v57, v58
  v_fmamk_f32 v57, v3, 0x41000000, v7
  v_fmamk_f32 v58, v3, 0x41100000, v7
  v_cos_f32 v57, v57
  v_cos_f32 v58, v58
  s_nop 0
  v_cvt_pk_bf16_f32 v42, v57, v58
  v_fmamk_f32 v57, v3, 0x41200000, v7
  v_fmamk_f32 v58, v3, 0x41300000, v7
  v_cos_f32 v57, v57
  v_cos_f32 v58, v58
  s_nop 0
  v_cvt_pk_bf16_f32 v43, v57, v58
  v_fmamk_f32 v57, v3, 0x42000000, v7
  v_fmamk_f32 v58, v3, 0x42040000, v7
  v_cos_f32 v57, v57
  v_cos_f32 v58, v58
  s_nop 0
  v_cvt_pk_bf16_f32 v44, v57, v58
  v_fmamk_f32 v57, v3, 0x42080000, v7
  v_fmamk_f32 v58, v3, 0x420c0000, v7
  v_cos_f32 v57, v57
  v_cos_f32 v58, v58
  s_nop 0
  v_cvt_pk_bf16_f32 v45, v57, v58
  v_fmamk_f32 v57, v3, 0x42200000, v7
  v_fmamk_f32 v58, v3, 0x42240000, v7
  v_cos_f32 v57, v57
  v_cos_f32 v58, v58
  s_nop 0
  v_cvt_pk_bf16_f32 v46, v57, v58
  v_fmamk_f32 v57, v3, 0x42280000, v7
  v_fmamk_f32 v58, v3, 0x422c0000, v7
  v_cos_f32 v57, v57
  v_cos_f32 v58, v58
  s_nop 0
  v_cvt_pk_bf16_f32 v47, v57, v58
  v_fmamk_f32 v57, v3, 0x42800000, v7
  v_fmamk_f32 v58, v3, 0x42820000, v7
  v_cos_f32 v57, v57
  v_cos_f32 v58, v58
  s_nop 0
  v_cvt_pk_bf16_f32 v48, v57, v58
  v_fmamk_f32 v57, v3, 0x42840000, v7
  v_fmamk_f32 v58, v3, 0x42860000, v7
  v_cos_f32 v57, v57
  v_cos_f32 v58, v58
  s_nop 0
  v_cvt_pk_bf16_f32 v49, v57, v58
  v_fmamk_f32 v57, v3, 0x42900000, v7
  v_fmamk_f32 v58, v3, 0x42920000, v7
  v_cos_f32 v57, v57
  v_cos_f32 v58, v58
  s_nop 0
  v_cvt_pk_bf16_f32 v50, v57, v58
  v_fmamk_f32 v57, v3, 0x42940000, v7
  v_fmamk_f32 v58, v3, 0x42960000, v7
  v_cos_f32 v57, v57
  v_cos_f32 v58, v58
  s_nop 0
  v_cvt_pk_bf16_f32 v51, v57, v58
  v_fmamk_f32 v57, v3, 0x42c00000, v7
  v_fmamk_f32 v58, v3, 0x42c20000, v7
  v_cos_f32 v57, v57
  v_cos_f32 v58, v58
  s_nop 0
  v_cvt_pk_bf16_f32 v52, v57, v58
  v_fmamk_f32 v57, v3, 0x42c40000, v7
  v_fmamk_f32 v58, v3, 0x42c60000, v7
  v_cos_f32 v57, v57
  v_cos_f32 v58, v58
  s_nop 0
  v_cvt_pk_bf16_f32 v53, v57, v58
  v_fmamk_f32 v57, v3, 0x42d00000, v7
  v_fmamk_f32 v58, v3, 0x42d20000, v7
  v_cos_f32 v57, v57
  v_cos_f32 v58, v58
  s_nop 0
  v_cvt_pk_bf16_f32 v54, v57, v58
  v_fmamk_f32 v57, v3, 0x42d40000, v7
  v_fmamk_f32 v58, v3, 0x42d60000, v7
  v_cos_f32 v57, v57
  v_cos_f32 v58, v58
  s_nop 0
  v_cvt_pk_bf16_f32 v55, v57, v58
  s_lshl_b32 s66, s41, 2
  s_add_u32 s66, s66, s3
  s_lshl_b32 s64, s66, 7
  s_add_u32 s64, s64, s40
  s_sub_u32 s65, 2048, s64
  s_and_b32 s65, s65, 2047
  s_mul_i32 s64, s64, 1026
  s_mul_i32 s65, s65, 1026
  v_lshlrev_b32 v7, 9, v6
  v_lshl_add_u32 v7, v5, 3, v7
  v_add_u32 v73, s64, v7
  v_sub_u32 v72, s65, v7
  v_add_u32 v72, 1658, v72
  v_cmp_lt_u32 vcc, 1, v6
  s_nop 1
  v_cndmask_b32 v73, v73, v72, vcc
  buffer_load_dwordx2 v[56:57], v73, s[48:51], 0 offen offset:0
  buffer_load_dwordx2 v[64:65], v73, s[52:55], 0 offen offset:0
  buffer_load_dwordx2 v[58:59], v73, s[48:51], 0 offen offset:128
  buffer_load_dwordx2 v[66:67], v73, s[52:55], 0 offen offset:128
  buffer_load_dwordx2 v[60:61], v73, s[48:51], 0 offen offset:256
  buffer_load_dwordx2 v[68:69], v73, s[52:55], 0 offen offset:256
  buffer_load_dwordx2 v[62:63], v73, s[48:51], 0 offen offset:384
  buffer_load_dwordx2 v[70:71], v73, s[52:55], 0 offen offset:384
  s_add_u32 s64, s64, 1024
  v_mov_b32 v72, s65
  v_mov_b32 v7, s64
  v_cndmask_b32 v72, v72, v7, vcc
  buffer_load_ushort v2, v72, s[48:51], 0 offen
  buffer_load_ushort v3, v72, s[52:55], 0 offen
  s_lshl_b32 s60, s40, 16
  s_lshl_b32 s64, s66, 10
  s_add_u32 s60, s60, s64
  s_add_u32 s61, s60, 16384
  s_add_u32 s62, s60, 32768
  s_add_u32 s63, s60, 49152
  s_cmp_lg_u32 s40, 0
  s_cbranch_scc1 gated_mix__spectral_gfnet__ssm_conv_s5__prompt_kernel_skip3
  s_mov_b32 s63, 2130706432
  s_cmp_gt_u32 s66, 8
  s_cselect_b32 s60, 2130706432, s60
  s_cselect_b32 s62, 2130706432, s62
  s_cmp_eq_u32 s66, 8
  s_cselect_b32 s60, 4194304, s60
  s_cselect_b32 s62, 4195328, s62
gated_mix__spectral_gfnet__ssm_conv_s5__prompt_kernel_skip3:
  s_mov_b32 s64, s28
  s_mov_b32 s65, s29
  s_mov_b32 s66, 2048
  s_mov_b32 s67, 0x20000
  v_lshlrev_b32 v7, 4, v4
  s_lshl_b32 s68, s2, 14
  s_lshl_b32 s69, s3, 12
  s_add_u32 s68, s68, s69
  buffer_load_dwordx4 v[72:75], v7, s[44:47], s68 offen offset:0
  buffer_load_dwordx4 v[76:79], v7, s[44:47], s68 offen offset:1024
  buffer_load_dwordx4 v[80:83], v7, s[44:47], s68 offen offset:2048
  buffer_load_dwordx4 v[84:87], v7, s[44:47], s68 offen offset:3072
  buffer_load_dwordx4 v[88:91], v7, s[64:67], 0 offen offset:0
  buffer_load_dwordx4 v[92:95], v7, s[64:67], 0 offen offset:1024
  s_mov_b32 s64, s12
  s_mov_b32 s65, s13
  s_mov_b32 s66, 2048
  s_mov_b32 s67, 0x20000
  s_mov_b32 s68, s14
  s_mov_b32 s69, s15
  s_mov_b32 s70, 2048
  s_mov_b32 s71, 0x20000
  s_mov_b32 s72, s24
  s_mov_b32 s73, s25
  s_mov_b32 s74, 2048
  s_mov_b32 s75, 0x20000
  v_and_b32 v7, 31, v4
  v_lshlrev_b32 v7, 1, v7
  s_lshl_b32 s76, s39, 7
  s_and_b32 s77, s3, 1
  s_lshl_b32 s77, s77, 6
  s_add_u32 s76, s76, s77
  buffer_load_ushort v96, v7, s[64:67], s76 offen
  buffer_load_ushort v97, v7, s[68:71], s76 offen
  buffer_load_ushort v98, v7, s[72:75], s76 offen
  s_add_u32 m0, s43, 0
  s_nop 0
  buffer_load_dwordx4 v12, s[56:59], s36 offen offset:0 lds
  buffer_load_dwordx4 v13, s[56:59], s36 offen offset:1024 lds
  buffer_load_dwordx4 v14, s[56:59], s36 offen offset:2048 lds
  buffer_load_dwordx4 v15, s[56:59], s36 offen offset:3072 lds
  s_add_u32 m0, s42, 0
  s_nop 0
  buffer_load_dwordx4 v8, s[44:47], s36 offen offset:0 lds
  buffer_load_dwordx4 v9, s[44:47], s36 offen offset:1024 lds
  buffer_load_dwordx4 v10, s[44:47], s36 offen offset:2048 lds
  buffer_load_dwordx4 v11, s[44:47], s36 offen offset:3072 lds
  s_add_u32 s36, s36, 128
  s_and_b32 s36, s36, 0x7ff
  s_waitcnt vmcnt(27)
  s_barrier
  s_mov_b32 s64, s34
  s_mov_b32 s65, s35
  s_mov_b32 s66, 4194304
  s_mov_b32 s67, 0x20000
  v_bfe_u32 v7, v4, 2, 3
  v_lshrrev_b32 v99, 5, v4
  v_lshl_or_b32 v7, v99, 4, v7
  v_lshlrev_b32 v7, 7, v7
  v_and_b32 v99, 3, v4
  v_lshl_or_b32 v7, v99, 3, v7
  v_add_u32 v7, 131072, v7
  v_bfe_u32 v99, v4, 3, 2
  v_xor_b32 v100, 0, v99
  v_lshl_add_u32 v100, v100, 5, v7
  v_xor_b32 v101, 1, v99
  v_lshl_add_u32 v101, v101, 5, v7
  v_xor_b32 v102, 2, v99
  v_lshl_add_u32 v102, v102, 5, v7
  v_xor_b32 v103, 3, v99
  v_lshl_add_u32 v103, v103, 5, v7
  ds_read_b64_tr_b16 v[136:137], v100 offset:0
  ds_read_b64_tr_b16 v[138:139], v100 offset:1024
  ds_read_b64_tr_b16 v[140:141], v100 offset:4096
  ds_read_b64_tr_b16 v[142:143], v100 offset:5120
  ds_read_b64_tr_b16 v[144:145], v100 offset:8192
  ds_read_b64_tr_b16 v[146:147], v100 offset:9216
  ds_read_b64_tr_b16 v[148:149], v100 offset:12288
  ds_read_b64_tr_b16 v[150:151], v100 offset:13312
  ds_read_b64_tr_b16 v[152:153], v101 offset:0
  ds_read_b64_tr_b16 v[154:155], v101 offset:1024
  ds_read_b64_tr_b16 v[156:157], v101 offset:4096
  ds_read_b64_tr_b16 v[158:159], v101 offset:5120
  ds_read_b64_tr_b16 v[160:161], v101 offset:8192
  ds_read_b64_tr_b16 v[162:163], v101 offset:9216
  ds_read_b64_tr_b16 v[164:165], v101 offset:12288
  ds_read_b64_tr_b16 v[166:167], v101 offset:13312
  ds_read_b64_tr_b16 v[168:169], v102 offset:0
  ds_read_b64_tr_b16 v[170:171], v102 offset:1024
  ds_read_b64_tr_b16 v[172:173], v102 offset:4096
  ds_read_b64_tr_b16 v[174:175], v102 offset:5120
  ds_read_b64_tr_b16 v[176:177], v102 offset:8192
  ds_read_b64_tr_b16 v[178:179], v102 offset:9216
  ds_read_b64_tr_b16 v[180:181], v102 offset:12288
  ds_read_b64_tr_b16 v[182:183], v102 offset:13312
  ds_read_b64_tr_b16 v[184:185], v103 offset:0
  ds_read_b64_tr_b16 v[186:187], v103 offset:1024
  ds_read_b64_tr_b16 v[188:189], v103 offset:4096
  ds_read_b64_tr_b16 v[190:191], v103 offset:5120
  ds_read_b64_tr_b16 v[192:193], v103 offset:8192
  ds_read_b64_tr_b16 v[194:195], v103 offset:9216
  ds_read_b64_tr_b16 v[196:197], v103 offset:12288
  ds_read_b64_tr_b16 v[198:199], v103 offset:13312
  s_waitcnt lgkmcnt(15)
  v_mfma_f32_16x16x32_bf16 v[104:107], v[136:139], v[24:27], 0
  v_mfma_f32_16x16x32_bf16 v[108:111], v[136:139], v[40:43], 0
  s_waitcnt lgkmcnt(15)
  v_mfma_f32_16x16x32_bf16 v[104:107], v[140:143], v[28:31], v[104:107]
  v_mfma_f32_16x16x32_bf16 v[108:111], v[140:143], v[44:47], v[108:111]
  s_waitcnt lgkmcnt(15)
  v_mfma_f32_16x16x32_bf16 v[104:107], v[144:147], v[32:35], v[104:107]
  v_mfma_f32_16x16x32_bf16 v[108:111], v[144:147], v[48:51], v[108:111]
  s_waitcnt lgkmcnt(15)
  v_mfma_f32_16x16x32_bf16 v[104:107], v[148:151], v[36:39], v[104:107]
  v_mfma_f32_16x16x32_bf16 v[108:111], v[148:151], v[52:55], v[108:111]
  s_waitcnt lgkmcnt(15)
  v_mfma_f32_16x16x32_bf16 v[112:115], v[152:155], v[24:27], 0
  v_mfma_f32_16x16x32_bf16 v[116:119], v[152:155], v[40:43], 0
  s_waitcnt lgkmcnt(15)
  v_mfma_f32_16x16x32_bf16 v[112:115], v[156:159], v[28:31], v[112:115]
  v_mfma_f32_16x16x32_bf16 v[116:119], v[156:159], v[44:47], v[116:119]
  s_waitcnt lgkmcnt(15)
  v_mfma_f32_16x16x32_bf16 v[112:115], v[160:163], v[32:35], v[112:115]
  v_mfma_f32_16x16x32_bf16 v[116:119], v[160:163], v[48:51], v[116:119]
  s_waitcnt lgkmcnt(15)
  v_mfma_f32_16x16x32_bf16 v[112:115], v[164:167], v[36:39], v[112:115]
  v_mfma_f32_16x16x32_bf16 v[116:119], v[164:167], v[52:55], v[116:119]
  s_waitcnt lgkmcnt(14)
  v_mfma_f32_16x16x32_bf16 v[120:123], v[168:171], v[24:27], 0
  v_mfma_f32_16x16x32_bf16 v[124:127], v[168:171], v[40:43], 0
  s_waitcnt lgkmcnt(12)
  v_mfma_f32_16x16x32_bf16 v[120:123], v[172:175], v[28:31], v[120:123]
  v_mfma_f32_16x16x32_bf16 v[124:127], v[172:175], v[44:47], v[124:127]
  s_waitcnt lgkmcnt(10)
  v_mfma_f32_16x16x32_bf16 v[120:123], v[176:179], v[32:35], v[120:123]
  v_mfma_f32_16x16x32_bf16 v[124:127], v[176:179], v[48:51], v[124:127]
  s_waitcnt lgkmcnt(8)
  v_mfma_f32_16x16x32_bf16 v[120:123], v[180:183], v[36:39], v[120:123]
  v_mfma_f32_16x16x32_bf16 v[124:127], v[180:183], v[52:55], v[124:127]
  s_waitcnt lgkmcnt(6)
  v_mfma_f32_16x16x32_bf16 v[128:131], v[184:187], v[24:27], 0
  v_mfma_f32_16x16x32_bf16 v[132:135], v[184:187], v[40:43], 0
  s_waitcnt lgkmcnt(4)
  v_mfma_f32_16x16x32_bf16 v[128:131], v[188:191], v[28:31], v[128:131]
  v_mfma_f32_16x16x32_bf16 v[132:135], v[188:191], v[44:47], v[132:135]
  s_waitcnt lgkmcnt(2)
  v_mfma_f32_16x16x32_bf16 v[128:131], v[192:195], v[32:35], v[128:131]
  v_mfma_f32_16x16x32_bf16 v[132:135], v[192:195], v[48:51], v[132:135]
  s_waitcnt lgkmcnt(0)
  v_mfma_f32_16x16x32_bf16 v[128:131], v[196:199], v[36:39], v[128:131]
  v_mfma_f32_16x16x32_bf16 v[132:135], v[196:199], v[52:55], v[132:135]
  v_pk_add_f32 v[136:137], v[104:105], v[120:121]
  v_pk_add_f32 v[152:153], v[104:105], v[120:121] neg_lo:[0,1] neg_hi:[0,1]
  s_nop 4
  v_pk_add_f32 v[144:145], v[112:113], v[128:129]
  v_pk_add_f32 v[160:161], v[112:113], v[128:129] neg_lo:[0,1] neg_hi:[0,1]
  v_pk_add_f32 v[138:139], v[106:107], v[122:123]
  v_pk_add_f32 v[154:155], v[106:107], v[122:123] neg_lo:[0,1] neg_hi:[0,1]
  v_pk_add_f32 v[146:147], v[114:115], v[130:131]
  v_pk_add_f32 v[162:163], v[114:115], v[130:131] neg_lo:[0,1] neg_hi:[0,1]
  v_pk_add_f32 v[140:141], v[108:109], v[124:125]
  v_pk_add_f32 v[156:157], v[108:109], v[124:125] neg_lo:[0,1] neg_hi:[0,1]
  v_pk_add_f32 v[148:149], v[116:117], v[132:133]
  v_pk_add_f32 v[164:165], v[116:117], v[132:133] neg_lo:[0,1] neg_hi:[0,1]
  v_pk_add_f32 v[142:143], v[110:111], v[126:127]
  v_pk_add_f32 v[158:159], v[110:111], v[126:127] neg_lo:[0,1] neg_hi:[0,1]
  v_pk_add_f32 v[150:151], v[118:119], v[134:135]
  v_pk_add_f32 v[166:167], v[118:119], v[134:135] neg_lo:[0,1] neg_hi:[0,1]
  v_pk_add_f32 v[104:105], v[136:137], v[144:145]
  v_pk_add_f32 v[120:121], v[136:137], v[144:145] neg_lo:[0,1] neg_hi:[0,1]
  v_pk_add_f32 v[108:109], v[140:141], v[148:149]
  v_pk_add_f32 v[124:125], v[140:141], v[148:149] neg_lo:[0,1] neg_hi:[0,1]
  v_pk_add_f32 v[112:113], v[152:153], v[164:165]
  v_pk_add_f32 v[116:117], v[156:157], v[160:161] neg_lo:[0,1] neg_hi:[0,1]
  v_pk_add_f32 v[128:129], v[152:153], v[164:165] neg_lo:[0,1] neg_hi:[0,1]
  v_pk_add_f32 v[132:133], v[156:157], v[160:161]
  v_pk_add_f32 v[106:107], v[138:139], v[146:147]
  v_pk_add_f32 v[122:123], v[138:139], v[146:147] neg_lo:[0,1] neg_hi:[0,1]
  v_pk_add_f32 v[110:111], v[142:143], v[150:151]
  v_pk_add_f32 v[126:127], v[142:143], v[150:151] neg_lo:[0,1] neg_hi:[0,1]
  v_pk_add_f32 v[114:115], v[154:155], v[166:167]
  v_pk_add_f32 v[118:119], v[158:159], v[162:163] neg_lo:[0,1] neg_hi:[0,1]
  v_pk_add_f32 v[130:131], v[154:155], v[166:167] neg_lo:[0,1] neg_hi:[0,1]
  v_pk_add_f32 v[134:135], v[158:159], v[162:163]
  s_cmp_lg_u32 s3, 0
  s_cbranch_scc1 gated_mix__spectral_gfnet__ssm_conv_s5__prompt_kernel_skip4
  s_mov_b32 exec_lo, 0x00010001
  s_mov_b32 exec_hi, 0x00010001
  v_mov_b32 v112, v152
  v_sub_f32 v116, 0, v160
  v_mov_b32 v128, v156
  v_sub_f32 v132, 0, v164
  v_mov_b32 v113, v153
  v_sub_f32 v117, 0, v161
  v_mov_b32 v129, v157
  v_sub_f32 v133, 0, v165
  v_mov_b32 v114, v154
  v_sub_f32 v118, 0, v162
  v_mov_b32 v130, v158
  v_sub_f32 v134, 0, v166
  v_mov_b32 v115, v155
  v_sub_f32 v119, 0, v163
  v_mov_b32 v131, v159
  v_sub_f32 v135, 0, v167
  s_mov_b64 exec, -1
gated_mix__spectral_gfnet__ssm_conv_s5__prompt_kernel_skip4:
  s_mov_b32 s68, 65536
  v_mul_lo_u32 v7, v5, s68
  v_lshl_add_u32 v7, v6, 4, v7
  s_mul_i32 s68, s3, 1048576
  s_lshl_b32 s69, s38, 10
  s_add_u32 s68, s68, s69
  s_lshl_b32 s69, s39, 6
  s_add_u32 s68, s68, s69
  v_cvt_pk_bf16_f32 v168, v104, v108
  v_cvt_pk_bf16_f32 v169, v105, v109
  v_cvt_pk_bf16_f32 v170, v106, v110
  v_cvt_pk_bf16_f32 v171, v107, v111
  buffer_store_dwordx4 v[168:171], v7, s[64:67], s68 offen sc1
  s_add_u32 s68, s68, 16384
  v_cvt_pk_bf16_f32 v172, v112, v116
  v_cvt_pk_bf16_f32 v173, v113, v117
  v_cvt_pk_bf16_f32 v174, v114, v118
  v_cvt_pk_bf16_f32 v175, v115, v119
  buffer_store_dwordx4 v[172:175], v7, s[64:67], s68 offen sc1
  s_add_u32 s68, s68, 16384
  v_cvt_pk_bf16_f32 v176, v120, v124
  v_cvt_pk_bf16_f32 v177, v121, v125
  v_cvt_pk_bf16_f32 v178, v122, v126
  v_cvt_pk_bf16_f32 v179, v123, v127
  buffer_store_dwordx4 v[176:179], v7, s[64:67], s68 offen sc1
  s_add_u32 s68, s68, 16384
  v_cvt_pk_bf16_f32 v180, v128, v132
  v_cvt_pk_bf16_f32 v181, v129, v133
  v_cvt_pk_bf16_f32 v182, v130, v134
  v_cvt_pk_bf16_f32 v183, v131, v135
  buffer_store_dwordx4 v[180:183], v7, s[64:67], s68 offen sc1
  s_add_u32 m0, s43, 16384
  s_nop 0
  buffer_load_dwordx4 v12, s[56:59], s36 offen offset:0 lds
  buffer_load_dwordx4 v13, s[56:59], s36 offen offset:1024 lds
  buffer_load_dwordx4 v14, s[56:59], s36 offen offset:2048 lds
  buffer_load_dwordx4 v15, s[56:59], s36 offen offset:3072 lds
  s_add_u32 m0, s42, 16384
  s_nop 0
  buffer_load_dwordx4 v8, s[44:47], s36 offen offset:0 lds
  buffer_load_dwordx4 v9, s[44:47], s36 offen offset:1024 lds
  buffer_load_dwordx4 v10, s[44:47], s36 offen offset:2048 lds
  buffer_load_dwordx4 v11, s[44:47], s36 offen offset:3072 lds
  s_add_u32 s36, s36, 128
  s_and_b32 s36, s36, 0x7ff
  s_add_u32 s68, s34, 20971520
  s_addc_u32 s69, s35, 0
  s_mov_b32 s70, 4196352
  s_mov_b32 s71, 0x20000
  v_mov_b32 v40, 0x05040100
  v_mov_b32 v41, 0x07060302
  s_waitcnt vmcnt(30)
  v_lshlrev_b32 v2, 16, v2
  s_waitcnt vmcnt(29)
  v_lshlrev_b32 v3, 16, v3
  v_xor_b32 v3, 0x80000000, v3
  s_mov_b32 exec_lo, 0
  v_swap_b32 v40, v41
  v_xor_b32 v3, 0x80000000, v3
  v_swap_b32 v56, v57
  v_swap_b32 v64, v65
  v_xor_b32 v64, 0x80008000, v64
  v_xor_b32 v65, 0x80008000, v65
  v_swap_b32 v58, v59
  v_swap_b32 v66, v67
  v_xor_b32 v66, 0x80008000, v66
  v_xor_b32 v67, 0x80008000, v67
  v_swap_b32 v60, v61
  v_swap_b32 v68, v69
  v_xor_b32 v68, 0x80008000, v68
  v_xor_b32 v69, 0x80008000, v69
  v_swap_b32 v62, v63
  v_swap_b32 v70, v71
  v_xor_b32 v70, 0x80008000, v70
  v_xor_b32 v71, 0x80008000, v71
  s_mov_b64 exec, -1
  v_perm_b32 v24, v64, v56, v40
  v_perm_b32 v25, v66, v58, v40
  v_perm_b32 v26, v68, v60, v40
  v_perm_b32 v27, v70, v62, v40
  v_perm_b32 v28, v64, v56, v41
  v_perm_b32 v29, v66, v58, v41
  v_perm_b32 v30, v68, v60, v41
  v_perm_b32 v31, v70, v62, v41
  v_perm_b32 v32, v65, v57, v40
  v_perm_b32 v33, v67, v59, v40
  v_perm_b32 v34, v69, v61, v40
  v_perm_b32 v35, v71, v63, v40
  v_perm_b32 v36, v65, v57, v41
  v_perm_b32 v37, v67, v59, v41
  v_perm_b32 v38, v69, v61, v41
  v_perm_b32 v39, v71, v63, v41
  v_cmp_lt_u32 vcc, 1, v6
  s_nop 1
  v_cndmask_b32 v42, v24, v27, vcc
  v_lshlrev_b32 v43, 16, v42
  v_and_b32 v44, 0xffff0000, v42
  v_add_f32 v43, v43, v2
  v_add_f32 v44, v44, v3
  v_mul_f32 v43, 0.5, v43
  v_mul_f32 v44, 0.5, v44
  v_cvt_pk_bf16_f32 v42, v43, v44
  v_cmp_eq_u32 vcc, 0, v4
  s_nop 1
  v_cndmask_b32 v24, v24, v42, vcc
  v_cmp_eq_u32 vcc, 32, v4
  s_nop 1
  v_cndmask_b32 v27, v27, v42, vcc
  v_lshl_add_u32 v7, v4, 4, s60
  buffer_store_dwordx4 v[24:27], v7, s[68:71], 0 offen sc1
  v_lshl_add_u32 v7, v4, 4, s61
  buffer_store_dwordx4 v[28:31], v7, s[68:71], 0 offen sc1
  v_lshl_add_u32 v7, v4, 4, s62
  buffer_store_dwordx4 v[32:35], v7, s[68:71], 0 offen sc1
  v_lshl_add_u32 v7, v4, 4, s63
  buffer_store_dwordx4 v[36:39], v7, s[68:71], 0 offen sc1
  s_cmp_lg_u32 s40, 0
  s_cbranch_scc1 gated_mix__spectral_gfnet__ssm_conv_s5__prompt_kernel_skip5
  s_lshl_b32 s74, s41, 2
  s_add_u32 s74, s74, s3
  s_lshl_b32 s72, s74, 7
  s_add_u32 s72, s72, 64
  s_sub_u32 s73, 2048, s72
  s_and_b32 s73, s73, 2047
  s_mul_i32 s72, s72, 1026
  s_mul_i32 s73, s73, 1026
  v_lshlrev_b32 v7, 9, v6
  v_lshl_add_u32 v7, v5, 3, v7
  v_add_u32 v41, s72, v7
  v_sub_u32 v40, s73, v7
  v_add_u32 v40, 1658, v40
  v_cmp_lt_u32 vcc, 1, v6
  s_nop 1
  v_cndmask_b32 v41, v41, v40, vcc
  buffer_load_dwordx2 v[24:25], v41, s[48:51], 0 offen offset:0
  buffer_load_dwordx2 v[32:33], v41, s[52:55], 0 offen offset:0
  buffer_load_dwordx2 v[26:27], v41, s[48:51], 0 offen offset:128
  buffer_load_dwordx2 v[34:35], v41, s[52:55], 0 offen offset:128
  buffer_load_dwordx2 v[28:29], v41, s[48:51], 0 offen offset:256
  buffer_load_dwordx2 v[36:37], v41, s[52:55], 0 offen offset:256
  buffer_load_dwordx2 v[30:31], v41, s[48:51], 0 offen offset:384
  buffer_load_dwordx2 v[38:39], v41, s[52:55], 0 offen offset:384
  s_add_u32 s72, s72, 1024
  v_mov_b32 v40, s73
  v_mov_b32 v7, s72
  v_cndmask_b32 v40, v40, v7, vcc
  buffer_load_ushort v2, v40, s[48:51], 0 offen
  buffer_load_ushort v3, v40, s[52:55], 0 offen
  s_lshl_b32 s72, s74, 10
  s_add_u32 s60, s72, 8192
  s_add_u32 s61, s72, 49152
  s_add_u32 s62, s72, 40960
  s_mov_b32 s63, 2130706432
  s_cmp_gt_u32 s74, 7
  s_cselect_b32 s60, 2130706432, s60
  s_cselect_b32 s62, 2130706432, s62
  v_mov_b32 v56, 0x05040100
  v_mov_b32 v57, 0x07060302
  s_waitcnt vmcnt(1)
  v_lshlrev_b32 v2, 16, v2
  s_waitcnt vmcnt(0)
  v_lshlrev_b32 v3, 16, v3
  v_xor_b32 v3, 0x80000000, v3
  s_mov_b32 exec_lo, 0
  v_swap_b32 v56, v57
  v_xor_b32 v3, 0x80000000, v3
  v_swap_b32 v24, v25
  v_swap_b32 v32, v33
  v_xor_b32 v32, 0x80008000, v32
  v_xor_b32 v33, 0x80008000, v33
  v_swap_b32 v26, v27
  v_swap_b32 v34, v35
  v_xor_b32 v34, 0x80008000, v34
  v_xor_b32 v35, 0x80008000, v35
  v_swap_b32 v28, v29
  v_swap_b32 v36, v37
  v_xor_b32 v36, 0x80008000, v36
  v_xor_b32 v37, 0x80008000, v37
  v_swap_b32 v30, v31
  v_swap_b32 v38, v39
  v_xor_b32 v38, 0x80008000, v38
  v_xor_b32 v39, 0x80008000, v39
  s_mov_b64 exec, -1
  v_perm_b32 v40, v32, v24, v56
  v_perm_b32 v41, v34, v26, v56
  v_perm_b32 v42, v36, v28, v56
  v_perm_b32 v43, v38, v30, v56
  v_perm_b32 v44, v32, v24, v57
  v_perm_b32 v45, v34, v26, v57
  v_perm_b32 v46, v36, v28, v57
  v_perm_b32 v47, v38, v30, v57
  v_perm_b32 v48, v33, v25, v56
  v_perm_b32 v49, v35, v27, v56
  v_perm_b32 v50, v37, v29, v56
  v_perm_b32 v51, v39, v31, v56
  v_perm_b32 v52, v33, v25, v57
  v_perm_b32 v53, v35, v27, v57
  v_perm_b32 v54, v37, v29, v57
  v_perm_b32 v55, v39, v31, v57
  v_cmp_lt_u32 vcc, 1, v6
  s_nop 1
  v_cndmask_b32 v58, v40, v43, vcc
  v_lshlrev_b32 v59, 16, v58
  v_and_b32 v60, 0xffff0000, v58
  v_add_f32 v59, v59, v2
  v_add_f32 v60, v60, v3
  v_mul_f32 v59, 0.5, v59
  v_mul_f32 v60, 0.5, v60
  v_cvt_pk_bf16_f32 v58, v59, v60
  v_cmp_eq_u32 vcc, 0, v4
  s_nop 1
  v_cndmask_b32 v40, v40, v58, vcc
  v_cmp_eq_u32 vcc, 32, v4
  s_nop 1
  v_cndmask_b32 v43, v43, v58, vcc
  v_lshl_add_u32 v7, v4, 4, s60
  buffer_store_dwordx4 v[40:43], v7, s[68:71], 0 offen sc1
  v_lshl_add_u32 v7, v4, 4, s61
  buffer_store_dwordx4 v[44:47], v7, s[68:71], 0 offen sc1
  v_lshl_add_u32 v7, v4, 4, s62
  buffer_store_dwordx4 v[48:51], v7, s[68:71], 0 offen sc1
  v_lshl_add_u32 v7, v4, 4, s63
  buffer_store_dwordx4 v[52:55], v7, s[68:71], 0 offen sc1
gated_mix__spectral_gfnet__ssm_conv_s5__prompt_kernel_skip5:
  s_add_u32 m0, s43, 32768
  s_nop 0
  buffer_load_dwordx4 v12, s[56:59], s36 offen offset:0 lds
  buffer_load_dwordx4 v13, s[56:59], s36 offen offset:1024 lds
  buffer_load_dwordx4 v14, s[56:59], s36 offen offset:2048 lds
  buffer_load_dwordx4 v15, s[56:59], s36 offen offset:3072 lds
  s_add_u32 m0, s42, 32768
  s_nop 0
  buffer_load_dwordx4 v8, s[44:47], s36 offen offset:0 lds
  buffer_load_dwordx4 v9, s[44:47], s36 offen offset:1024 lds
  buffer_load_dwordx4 v10, s[44:47], s36 offen offset:2048 lds
  buffer_load_dwordx4 v11, s[44:47], s36 offen offset:3072 lds
  s_add_u32 s36, s36, 128
  s_and_b32 s36, s36, 0x7ff
  s_add_u32 s48, s34, 19922944
  s_addc_u32 s49, s35, 0
  s_mov_b32 s50, 8192
  s_mov_b32 s51, 0x20000
  v_mov_b32 v2, 0
  v_mov_b32 v3, 0
  s_waitcnt vmcnt(36)
  v_dot2c_f32_bf16 v2, v72, v88
  v_dot2c_f32_bf16 v3, v80, v88
  v_dot2c_f32_bf16 v2, v73, v89
  v_dot2c_f32_bf16 v3, v81, v89
  v_dot2c_f32_bf16 v2, v74, v90
  v_dot2c_f32_bf16 v3, v82, v90
  v_dot2c_f32_bf16 v2, v75, v91
  v_dot2c_f32_bf16 v3, v83, v91
  s_waitcnt vmcnt(35)
  v_dot2c_f32_bf16 v2, v76, v92
  v_dot2c_f32_bf16 v3, v84, v92
  v_dot2c_f32_bf16 v2, v77, v93
  v_dot2c_f32_bf16 v3, v85, v93
  v_dot2c_f32_bf16 v2, v78, v94
  v_dot2c_f32_bf16 v3, v86, v94
  v_dot2c_f32_bf16 v2, v79, v95
  v_dot2c_f32_bf16 v3, v87, v95
  s_nop 2
  v_permlane32_swap_b32 v2, v3
  v_add_f32 v2, v2, v3
  v_mov_b32 v3, v2
  s_nop 1
  v_permlane16_swap_b32 v2, v3
  v_add_f32 v2, v2, v3
  s_nop 1
  v_add_f32 v2, v2, v2 row_ror:8 row_mask:0xf bank_mask:0xf
  s_nop 1
  v_add_f32 v2, v2, v2 row_ror:4 row_mask:0xf bank_mask:0xf
  s_nop 1
  v_add_f32 v2, v2, v2 row_ror:2 row_mask:0xf bank_mask:0xf
  s_nop 1
  v_add_f32 v2, v2, v2 row_ror:1 row_mask:0xf bank_mask:0xf
  v_cvt_pk_bf16_f32 v2, v2, v2
  v_and_b32 v2, 0xffff0000, v2
  v_mul_f32 v2, 0xbfb8aa3b, v2
  v_exp_f32 v2, v2
  s_nop 0
  v_add_f32 v2, 1.0, v2
  v_rcp_f32 v2, v2
  s_nop 0
  v_cvt_pk_bf16_f32 v2, v2, v2
  v_and_b32 v2, 0xffff0000, v2
  s_and_b32 s52, s2, 1
  s_lshl_b32 s52, s52, 2
  s_add_u32 s52, s52, s3
  s_lshl_b32 s52, s52, 10
  s_lshr_b32 s53, s2, 1
  s_lshl_b32 s53, s53, 2
  s_add_u32 s52, s52, s53
  v_lshrrev_b32 v24, 5, v4
  v_lshlrev_b32 v24, 9, v24
  s_mov_b32 exec_lo, 1
  s_mov_b32 exec_hi, 1
  buffer_store_dword v2, v24, s[48:51], s52 offen sc1
  s_mov_b64 exec, -1
  s_lshl_b32 s52, s39, 14
  s_add_u32 s62, s52, 19988480
  s_add_u32 s60, s34, s62
  s_addc_u32 s61, s35, 0
  s_mov_b32 s62, 16384
  s_mov_b32 s63, 0x20000
  s_add_u32 s72, s34, 20316160
  s_addc_u32 s73, s35, 0
  s_mov_b32 s74, 2048
  s_mov_b32 s75, 0x20000
  s_lshl_b32 s52, s38, 10
  s_sub_u32 s52, 15360, s52
  v_lshl_add_u32 v2, v0, 2, s52
  v_mov_b32 v3, -1
  buffer_store_dword v3, v2, s[60:63], 0 offen sc1
  s_lshl_b32 s52, s2, 2
  v_mov_b32 v7, s52
  v_mov_b32 v3, 0
  s_mov_b64 exec, 1
  buffer_store_dword v3, v7, s[72:75], 0 offen sc1
  buffer_store_dword v3, v7, s[72:75], 0 offen offset:1024 sc1
  s_mov_b64 exec, -1
  s_add_u32 m0, s43, 49152
  s_nop 0
  buffer_load_dwordx4 v12, s[56:59], s36 offen offset:0 lds
  buffer_load_dwordx4 v13, s[56:59], s36 offen offset:1024 lds
  buffer_load_dwordx4 v14, s[56:59], s36 offen offset:2048 lds
  buffer_load_dwordx4 v15, s[56:59], s36 offen offset:3072 lds
  s_add_u32 m0, s42, 49152
  s_nop 0
  buffer_load_dwordx4 v8, s[44:47], s36 offen offset:0 lds
  buffer_load_dwordx4 v9, s[44:47], s36 offen offset:1024 lds
  buffer_load_dwordx4 v10, s[44:47], s36 offen offset:2048 lds
  buffer_load_dwordx4 v11, s[44:47], s36 offen offset:3072 lds
  s_add_u32 s36, s36, 128
  s_and_b32 s36, s36, 0x7ff
  s_waitcnt vmcnt(46)
  v_lshlrev_b32 v96, 16, v96
  s_waitcnt vmcnt(45)
  v_lshlrev_b32 v97, 16, v97
  s_waitcnt vmcnt(44)
  v_lshlrev_b32 v98, 16, v98
  v_mul_f32 v98, 0x3fb8aa3b, v98
  v_exp_f32 v98, v98
  s_nop 0
  v_cvt_pk_bf16_f32 v98, v98, v98
  v_and_b32 v98, 0xffff0000, v98
  v_mul_f32 v36, v98, v96
  v_mul_f32 v37, v98, v97
  v_mul_f32 v36, 0x3fb8aa3b, v36
  v_mul_f32 v37, 0.15915494, v37
  v_exp_f32 v36, v36
  v_rndne_f32 v38, v37
  v_sub_f32 v37, v37, v38
  v_cos_f32 v38, v37
  v_sin_f32 v39, v37
  v_mul_f32 v2, v36, v38
  v_mul_f32 v3, v36, v39
  v_mul_f32 v36, v96, v96
  v_fma_f32 v36, v97, v97, v36
  v_rcp_f32 v36, v36
  v_add_f32 v37, -1.0, v2
  v_add_f32 v36, v36, v36
  v_mul_f32 v38, v37, v96
  v_fma_f32 v38, v3, v97, v38
  v_mul_f32 v39, v3, v96
  v_fma_f32 v39, -v37, v97, v39
  v_mul_f32 v32, v38, v36
  v_mul_f32 v33, v39, v36
  v_mul_f32 v36, v3, v3
  v_mul_f32 v25, v2, v3
  v_fma_f32 v24, v2, v2, -v36
  v_add_f32 v25, v25, v25
  v_mul_f32 v36, v25, v25
  v_mul_f32 v25, v24, v25
  v_fma_f32 v24, v24, v24, -v36
  v_add_f32 v25, v25, v25
  v_mul_f32 v36, v25, v25
  v_mul_f32 v25, v24, v25
  v_fma_f32 v24, v24, v24, -v36
  v_add_f32 v25, v25, v25
  v_mul_f32 v36, v25, v25
  v_mul_f32 v25, v24, v25
  v_fma_f32 v24, v24, v24, -v36
  v_add_f32 v25, v25, v25
  v_mul_f32 v36, v25, v25
  v_mul_f32 v27, v24, v25
  v_fma_f32 v26, v24, v24, -v36
  v_add_f32 v27, v27, v27
  v_mul_f32 v36, v27, v27
  v_mul_f32 v29, v26, v27
  v_fma_f32 v28, v26, v26, -v36
  v_add_f32 v29, v29, v29
  v_mul_f32 v36, v29, v29
  v_mul_f32 v31, v28, v29
  v_fma_f32 v30, v28, v28, -v36
  v_add_f32 v31, v31, v31
  v_mul_f32 v36, v31, v31
  v_mul_f32 v31, v30, v31
  v_fma_f32 v30, v30, v30, -v36
  v_add_f32 v31, v31, v31
  v_mul_f32 v36, v31, v31
  v_mul_f32 v31, v30, v31
  v_fma_f32 v30, v30, v30, -v36
  v_add_f32 v31, v31, v31
  v_mul_f32 v36, v31, v31
  v_mul_f32 v31, v30, v31
  v_fma_f32 v30, v30, v30, -v36
  v_add_f32 v31, v31, v31
  s_bitcmp1_b32 s3, 0
  s_cselect_b32 s52, s22, s20
  s_cselect_b32 s53, s23, s21
  s_mov_b32 s54, 2097152
  s_mov_b32 s55, 0x20000
  v_lshlrev_b32 v34, 11, v5
  v_and_b32 v36, 1, v6
  v_lshl_or_b32 v34, v36, 5, v34
  v_lshrrev_b32 v36, 1, v6
  v_lshl_or_b32 v34, v36, 4, v34
  s_lshr_b32 s77, s3, 1
  s_lshl_b32 s77, s77, 20
  s_lshl_b32 s76, s39, 15
  s_add_u32 s77, s77, s76
  v_add_u32 v34, s77, v34
  v_add_u32 v35, 524288, v34
  s_lshl_b32 s76, s38, 7
  s_mov_b32 s80, s32
  s_mov_b32 s81, s33
  s_mov_b32 s82, 256
  s_mov_b32 s83, 0x20000
  v_mov_b32 v36, 1
  v_and_b32 v37, 60, v7
  v_lshlrev_b32 v37, 2, v37
  v_lshlrev_b32 v38, 4, v5
  s_waitcnt vmcnt(36)
  s_barrier
  ds_read_b128 v[104:107], v16 offset:0
  ds_read_b128 v[112:115], v20 offset:0
  ds_read_b128 v[108:111], v16 offset:4096
  ds_read_b128 v[116:119], v20 offset:4096
  s_waitcnt lgkmcnt(2)
  v_mfma_f32_32x32x16_bf16 v[40:55], v[104:107], v[112:115], 0
  ds_read_b128 v[120:123], v17 offset:0
  ds_read_b128 v[128:131], v21 offset:0
  s_waitcnt lgkmcnt(2)
  v_mfma_f32_32x32x16_bf16 v[56:71], v[104:107], v[116:119], 0
  ds_read_b128 v[124:127], v17 offset:4096
  ds_read_b128 v[132:135], v21 offset:4096
  v_mfma_f32_32x32x16_bf16 v[88:103], v[108:111], v[116:119], 0
  v_mfma_f32_32x32x16_bf16 v[72:87], v[108:111], v[112:115], 0
  s_waitcnt lgkmcnt(2)
  v_mfma_f32_32x32x16_bf16 v[40:55], v[120:123], v[128:131], v[40:55]
  ds_read_b128 v[104:107], v18 offset:0
  ds_read_b128 v[112:115], v22 offset:0
  s_waitcnt lgkmcnt(2)
  v_mfma_f32_32x32x16_bf16 v[56:71], v[120:123], v[132:135], v[56:71]
  ds_read_b128 v[108:111], v18 offset:4096
  ds_read_b128 v[116:119], v22 offset:4096
  v_mfma_f32_32x32x16_bf16 v[88:103], v[124:127], v[132:135], v[88:103]
  v_mfma_f32_32x32x16_bf16 v[72:87], v[124:127], v[128:131], v[72:87]
  s_waitcnt lgkmcnt(2)
  v_mfma_f32_32x32x16_bf16 v[40:55], v[104:107], v[112:115], v[40:55]
  ds_read_b128 v[120:123], v19 offset:0
  ds_read_b128 v[128:131], v23 offset:0
  s_waitcnt lgkmcnt(2)
  v_mfma_f32_32x32x16_bf16 v[56:71], v[104:107], v[116:119], v[56:71]
  ds_read_b128 v[124:127], v19 offset:4096
  ds_read_b128 v[132:135], v23 offset:4096
  v_mfma_f32_32x32x16_bf16 v[88:103], v[108:111], v[116:119], v[88:103]
  v_mfma_f32_32x32x16_bf16 v[72:87], v[108:111], v[112:115], v[72:87]
  s_waitcnt vmcnt(24) lgkmcnt(0)
  s_barrier
  v_mfma_f32_32x32x16_bf16 v[40:55], v[120:123], v[128:131], v[40:55]
  ds_read_b128 v[104:107], v16 offset:16384
  ds_read_b128 v[112:115], v20 offset:16384
  v_mfma_f32_32x32x16_bf16 v[56:71], v[120:123], v[132:135], v[56:71]
  ds_read_b128 v[108:111], v16 offset:20480
  ds_read_b128 v[116:119], v20 offset:20480
  v_mfma_f32_32x32x16_bf16 v[88:103], v[124:127], v[132:135], v[88:103]
  s_add_u32 m0, s43, 0
  s_nop 0
  buffer_load_dwordx4 v12, s[56:59], s36 offen offset:0 lds
  v_mfma_f32_32x32x16_bf16 v[72:87], v[124:127], v[128:131], v[72:87]
  buffer_load_dwordx4 v13, s[56:59], s36 offen offset:1024 lds
  s_waitcnt lgkmcnt(2)
  v_mfma_f32_32x32x16_bf16 v[40:55], v[104:107], v[112:115], v[40:55]
  ds_read_b128 v[120:123], v17 offset:16384
  ds_read_b128 v[128:131], v21 offset:16384
  s_waitcnt lgkmcnt(2)
  v_mfma_f32_32x32x16_bf16 v[56:71], v[104:107], v[116:119], v[56:71]
  ds_read_b128 v[124:127], v17 offset:20480
  ds_read_b128 v[132:135], v21 offset:20480
  v_mfma_f32_32x32x16_bf16 v[88:103], v[108:111], v[116:119], v[88:103]
  buffer_load_dwordx4 v14, s[56:59], s36 offen offset:2048 lds
  v_mfma_f32_32x32x16_bf16 v[72:87], v[108:111], v[112:115], v[72:87]
  buffer_load_dwordx4 v15, s[56:59], s36 offen offset:3072 lds
  s_waitcnt lgkmcnt(2)
  v_mfma_f32_32x32x16_bf16 v[40:55], v[120:123], v[128:131], v[40:55]
  ds_read_b128 v[104:107], v18 offset:16384
  ds_read_b128 v[112:115], v22 offset:16384
  s_waitcnt lgkmcnt(2)
  v_mfma_f32_32x32x16_bf16 v[56:71], v[120:123], v[132:135], v[56:71]
  ds_read_b128 v[108:111], v18 offset:20480
  ds_read_b128 v[116:119], v22 offset:20480
  v_mfma_f32_32x32x16_bf16 v[88:103], v[124:127], v[132:135], v[88:103]
  s_add_u32 m0, s42, 0
  s_nop 0
  buffer_load_dwordx4 v8, s[44:47], s36 offen offset:0 lds
  v_mfma_f32_32x32x16_bf16 v[72:87], v[124:127], v[128:131], v[72:87]
  buffer_load_dwordx4 v9, s[44:47], s36 offen offset:1024 lds
  s_waitcnt lgkmcnt(2)
  v_mfma_f32_32x32x16_bf16 v[40:55], v[104:107], v[112:115], v[40:55]
  ds_read_b128 v[120:123], v19 offset:16384
  ds_read_b128 v[128:131], v23 offset:16384
  s_waitcnt lgkmcnt(2)
  v_mfma_f32_32x32x16_bf16 v[56:71], v[104:107], v[116:119], v[56:71]
  ds_read_b128 v[124:127], v19 offset:20480
  ds_read_b128 v[132:135], v23 offset:20480
  v_mfma_f32_32x32x16_bf16 v[88:103], v[108:111], v[116:119], v[88:103]
  buffer_load_dwordx4 v10, s[44:47], s36 offen offset:2048 lds
  v_mfma_f32_32x32x16_bf16 v[72:87], v[108:111], v[112:115], v[72:87]
  buffer_load_dwordx4 v11, s[44:47], s36 offen offset:3072 lds
  s_add_u32 s36, s36, 128
  s_and_b32 s36, s36, 0x7ff
  s_waitcnt vmcnt(20) lgkmcnt(0)
  s_barrier
  v_mfma_f32_32x32x16_bf16 v[40:55], v[120:123], v[128:131], v[40:55]
  ds_read_b128 v[104:107], v16 offset:32768
  ds_read_b128 v[112:115], v20 offset:32768
  v_mfma_f32_32x32x16_bf16 v[56:71], v[120:123], v[132:135], v[56:71]
  ds_read_b128 v[108:111], v16 offset:36864
  ds_read_b128 v[116:119], v20 offset:36864
  v_mfma_f32_32x32x16_bf16 v[88:103], v[124:127], v[132:135], v[88:103]
  s_add_u32 m0, s43, 16384
  s_nop 0
  buffer_load_dwordx4 v12, s[56:59], s36 offen offset:0 lds
  v_mfma_f32_32x32x16_bf16 v[72:87], v[124:127], v[128:131], v[72:87]
  buffer_load_dwordx4 v13, s[56:59], s36 offen offset:1024 lds
  s_waitcnt lgkmcnt(2)
  v_mfma_f32_32x32x16_bf16 v[40:55], v[104:107], v[112:115], v[40:55]
  ds_read_b128 v[120:123], v17 offset:32768
  ds_read_b128 v[128:131], v21 offset:32768
  s_waitcnt lgkmcnt(2)
  v_mfma_f32_32x32x16_bf16 v[56:71], v[104:107], v[116:119], v[56:71]
  ds_read_b128 v[124:127], v17 offset:36864
  ds_read_b128 v[132:135], v21 offset:36864
  v_mfma_f32_32x32x16_bf16 v[88:103], v[108:111], v[116:119], v[88:103]
  buffer_load_dwordx4 v14, s[56:59], s36 offen offset:2048 lds
  v_mfma_f32_32x32x16_bf16 v[72:87], v[108:111], v[112:115], v[72:87]
  buffer_load_dwordx4 v15, s[56:59], s36 offen offset:3072 lds
  s_waitcnt lgkmcnt(2)
  v_mfma_f32_32x32x16_bf16 v[40:55], v[120:123], v[128:131], v[40:55]
  ds_read_b128 v[104:107], v18 offset:32768
  ds_read_b128 v[112:115], v22 offset:32768
  s_waitcnt lgkmcnt(2)
  v_mfma_f32_32x32x16_bf16 v[56:71], v[120:123], v[132:135], v[56:71]
  ds_read_b128 v[108:111], v18 offset:36864
  ds_read_b128 v[116:119], v22 offset:36864
  v_mfma_f32_32x32x16_bf16 v[88:103], v[124:127], v[132:135], v[88:103]
  s_add_u32 m0, s42, 16384
  s_nop 0
  buffer_load_dwordx4 v8, s[44:47], s36 offen offset:0 lds
  v_mfma_f32_32x32x16_bf16 v[72:87], v[124:127], v[128:131], v[72:87]
  buffer_load_dwordx4 v9, s[44:47], s36 offen offset:1024 lds
  s_waitcnt lgkmcnt(2)
  v_mfma_f32_32x32x16_bf16 v[40:55], v[104:107], v[112:115], v[40:55]
  ds_read_b128 v[120:123], v19 offset:32768
  ds_read_b128 v[128:131], v23 offset:32768
  s_waitcnt lgkmcnt(2)
  v_mfma_f32_32x32x16_bf16 v[56:71], v[104:107], v[116:119], v[56:71]
  ds_read_b128 v[124:127], v19 offset:36864
  ds_read_b128 v[132:135], v23 offset:36864
  v_mfma_f32_32x32x16_bf16 v[88:103], v[108:111], v[116:119], v[88:103]
  buffer_load_dwordx4 v10, s[44:47], s36 offen offset:2048 lds
  v_mfma_f32_32x32x16_bf16 v[72:87], v[108:111], v[112:115], v[72:87]
  buffer_load_dwordx4 v11, s[44:47], s36 offen offset:3072 lds
  s_add_u32 s36, s36, 128
  s_and_b32 s36, s36, 0x7ff
  s_waitcnt vmcnt(24)
  s_waitcnt vmcnt(16) lgkmcnt(0)
  s_barrier
  v_mfma_f32_32x32x16_bf16 v[40:55], v[120:123], v[128:131], v[40:55]
  ds_read_b128 v[104:107], v16 offset:49152
  ds_read_b128 v[112:115], v20 offset:49152
  v_mfma_f32_32x32x16_bf16 v[56:71], v[120:123], v[132:135], v[56:71]
  ds_read_b128 v[108:111], v16 offset:53248
  ds_read_b128 v[116:119], v20 offset:53248
  s_cmp_lg_u32 s3, 0
  s_cbranch_scc1 gated_mix__spectral_gfnet__ssm_conv_s5__prompt_kernel_skip6
  s_mov_b64 exec, 1
  buffer_atomic_add v36, v37, s[80:83], 0 offen sc1
  s_mov_b64 exec, -1
gated_mix__spectral_gfnet__ssm_conv_s5__prompt_kernel_skip6:
  v_mfma_f32_32x32x16_bf16 v[88:103], v[124:127], v[132:135], v[88:103]
  s_add_u32 m0, s43, 32768
  s_nop 0
  buffer_load_dwordx4 v12, s[56:59], s36 offen offset:0 lds
  v_mfma_f32_32x32x16_bf16 v[72:87], v[124:127], v[128:131], v[72:87]
  buffer_load_dwordx4 v13, s[56:59], s36 offen offset:1024 lds
  s_waitcnt lgkmcnt(2)
  v_mfma_f32_32x32x16_bf16 v[40:55], v[104:107], v[112:115], v[40:55]
  ds_read_b128 v[120:123], v17 offset:49152
  ds_read_b128 v[128:131], v21 offset:49152
  s_waitcnt lgkmcnt(2)
  v_mfma_f32_32x32x16_bf16 v[56:71], v[104:107], v[116:119], v[56:71]
  ds_read_b128 v[124:127], v17 offset:53248
  ds_read_b128 v[132:135], v21 offset:53248
  v_mfma_f32_32x32x16_bf16 v[88:103], v[108:111], v[116:119], v[88:103]
  buffer_load_dwordx4 v14, s[56:59], s36 offen offset:2048 lds
  v_mfma_f32_32x32x16_bf16 v[72:87], v[108:111], v[112:115], v[72:87]
  buffer_load_dwordx4 v15, s[56:59], s36 offen offset:3072 lds
  s_waitcnt lgkmcnt(2)
  v_mfma_f32_32x32x16_bf16 v[40:55], v[120:123], v[128:131], v[40:55]
  ds_read_b128 v[104:107], v18 offset:49152
  ds_read_b128 v[112:115], v22 offset:49152
  s_waitcnt lgkmcnt(2)
  v_mfma_f32_32x32x16_bf16 v[56:71], v[120:123], v[132:135], v[56:71]
  ds_read_b128 v[108:111], v18 offset:53248
  ds_read_b128 v[116:119], v22 offset:53248
  v_mfma_f32_32x32x16_bf16 v[88:103], v[124:127], v[132:135], v[88:103]
  s_add_u32 m0, s42, 32768
  s_nop 0
  buffer_load_dwordx4 v8, s[44:47], s36 offen offset:0 lds
  v_mfma_f32_32x32x16_bf16 v[72:87], v[124:127], v[128:131], v[72:87]
  buffer_load_dwordx4 v9, s[44:47], s36 offen offset:1024 lds
  s_waitcnt lgkmcnt(2)
  v_mfma_f32_32x32x16_bf16 v[40:55], v[104:107], v[112:115], v[40:55]
  ds_read_b128 v[120:123], v19 offset:49152
  ds_read_b128 v[128:131], v23 offset:49152
  s_waitcnt lgkmcnt(2)
  v_mfma_f32_32x32x16_bf16 v[56:71], v[104:107], v[116:119], v[56:71]
  ds_read_b128 v[124:127], v19 offset:53248
  ds_read_b128 v[132:135], v23 offset:53248
  v_mfma_f32_32x32x16_bf16 v[88:103], v[108:111], v[116:119], v[88:103]
  buffer_load_dwordx4 v10, s[44:47], s36 offen offset:2048 lds
  v_mfma_f32_32x32x16_bf16 v[72:87], v[108:111], v[112:115], v[72:87]
  buffer_load_dwordx4 v11, s[44:47], s36 offen offset:3072 lds
  s_add_u32 s36, s36, 128
  s_and_b32 s36, s36, 0x7ff
  s_waitcnt vmcnt(16) lgkmcnt(0)
  s_barrier
  v_mfma_f32_32x32x16_bf16 v[40:55], v[120:123], v[128:131], v[40:55]
  ds_read_b128 v[104:107], v16 offset:0
  ds_read_b128 v[112:115], v20 offset:0
  v_mfma_f32_32x32x16_bf16 v[56:71], v[120:123], v[132:135], v[56:71]
  ds_read_b128 v[108:111], v16 offset:4096
  ds_read_b128 v[116:119], v20 offset:4096
  v_mfma_f32_32x32x16_bf16 v[88:103], v[124:127], v[132:135], v[88:103]
  s_add_u32 m0, s43, 49152
  s_nop 0
  buffer_load_dwordx4 v12, s[56:59], s36 offen offset:0 lds
  v_mfma_f32_32x32x16_bf16 v[72:87], v[124:127], v[128:131], v[72:87]
  buffer_load_dwordx4 v13, s[56:59], s36 offen offset:1024 lds
  s_waitcnt lgkmcnt(2)
  v_mfma_f32_32x32x16_bf16 v[40:55], v[104:107], v[112:115], v[40:55]
  ds_read_b128 v[120:123], v17 offset:0
  ds_read_b128 v[128:131], v21 offset:0
  s_waitcnt lgkmcnt(2)
  v_mfma_f32_32x32x16_bf16 v[56:71], v[104:107], v[116:119], v[56:71]
  ds_read_b128 v[124:127], v17 offset:4096
  ds_read_b128 v[132:135], v21 offset:4096
  v_mfma_f32_32x32x16_bf16 v[88:103], v[108:111], v[116:119], v[88:103]
  buffer_load_dwordx4 v14, s[56:59], s36 offen offset:2048 lds
  v_mfma_f32_32x32x16_bf16 v[72:87], v[108:111], v[112:115], v[72:87]
  buffer_load_dwordx4 v15, s[56:59], s36 offen offset:3072 lds
  s_waitcnt lgkmcnt(2)
  v_mfma_f32_32x32x16_bf16 v[40:55], v[120:123], v[128:131], v[40:55]
  ds_read_b128 v[104:107], v18 offset:0
  ds_read_b128 v[112:115], v22 offset:0
  s_waitcnt lgkmcnt(2)
  v_mfma_f32_32x32x16_bf16 v[56:71], v[120:123], v[132:135], v[56:71]
  ds_read_b128 v[108:111], v18 offset:4096
  ds_read_b128 v[116:119], v22 offset:4096
  v_mfma_f32_32x32x16_bf16 v[88:103], v[124:127], v[132:135], v[88:103]
  s_add_u32 m0, s42, 49152
  s_nop 0
  buffer_load_dwordx4 v8, s[44:47], s36 offen offset:0 lds
  v_mfma_f32_32x32x16_bf16 v[72:87], v[124:127], v[128:131], v[72:87]
  buffer_load_dwordx4 v9, s[44:47], s36 offen offset:1024 lds
  s_waitcnt lgkmcnt(2)
  v_mfma_f32_32x32x16_bf16 v[40:55], v[104:107], v[112:115], v[40:55]
  ds_read_b128 v[120:123], v19 offset:0
  ds_read_b128 v[128:131], v23 offset:0
  s_waitcnt lgkmcnt(2)
  v_mfma_f32_32x32x16_bf16 v[56:71], v[104:107], v[116:119], v[56:71]
  ds_read_b128 v[124:127], v19 offset:4096
  ds_read_b128 v[132:135], v23 offset:4096
  v_mfma_f32_32x32x16_bf16 v[88:103], v[108:111], v[116:119], v[88:103]
  buffer_load_dwordx4 v10, s[44:47], s36 offen offset:2048 lds
  v_mfma_f32_32x32x16_bf16 v[72:87], v[108:111], v[112:115], v[72:87]
  buffer_load_dwordx4 v11, s[44:47], s36 offen offset:3072 lds
  s_add_u32 s36, s36, 128
  s_and_b32 s36, s36, 0x7ff
  s_waitcnt vmcnt(16) lgkmcnt(0)
  s_barrier
  v_mfma_f32_32x32x16_bf16 v[40:55], v[120:123], v[128:131], v[40:55]
  ds_read_b128 v[104:107], v16 offset:16384
  ds_read_b128 v[112:115], v20 offset:16384
  v_mfma_f32_32x32x16_bf16 v[56:71], v[120:123], v[132:135], v[56:71]
  ds_read_b128 v[108:111], v16 offset:20480
  ds_read_b128 v[116:119], v20 offset:20480
  v_mfma_f32_32x32x16_bf16 v[88:103], v[124:127], v[132:135], v[88:103]
  s_add_u32 m0, s43, 0
  s_nop 0
  buffer_load_dwordx4 v12, s[56:59], s36 offen offset:0 lds
  v_mfma_f32_32x32x16_bf16 v[72:87], v[124:127], v[128:131], v[72:87]
  buffer_load_dwordx4 v13, s[56:59], s36 offen offset:1024 lds
  s_waitcnt lgkmcnt(2)
  v_mfma_f32_32x32x16_bf16 v[40:55], v[104:107], v[112:115], v[40:55]
  ds_read_b128 v[120:123], v17 offset:16384
  ds_read_b128 v[128:131], v21 offset:16384
  s_waitcnt lgkmcnt(2)
  v_mfma_f32_32x32x16_bf16 v[56:71], v[104:107], v[116:119], v[56:71]
  ds_read_b128 v[124:127], v17 offset:20480
  ds_read_b128 v[132:135], v21 offset:20480
  v_mfma_f32_32x32x16_bf16 v[88:103], v[108:111], v[116:119], v[88:103]
  buffer_load_dwordx4 v14, s[56:59], s36 offen offset:2048 lds
  v_mfma_f32_32x32x16_bf16 v[72:87], v[108:111], v[112:115], v[72:87]
  buffer_load_dwordx4 v15, s[56:59], s36 offen offset:3072 lds
  s_waitcnt lgkmcnt(2)
  v_mfma_f32_32x32x16_bf16 v[40:55], v[120:123], v[128:131], v[40:55]
  ds_read_b128 v[104:107], v18 offset:16384
  ds_read_b128 v[112:115], v22 offset:16384
  s_waitcnt lgkmcnt(2)
  v_mfma_f32_32x32x16_bf16 v[56:71], v[120:123], v[132:135], v[56:71]
  ds_read_b128 v[108:111], v18 offset:20480
  ds_read_b128 v[116:119], v22 offset:20480
  v_mfma_f32_32x32x16_bf16 v[88:103], v[124:127], v[132:135], v[88:103]
  s_add_u32 m0, s42, 0
  s_nop 0
  buffer_load_dwordx4 v8, s[44:47], s36 offen offset:0 lds
  v_mfma_f32_32x32x16_bf16 v[72:87], v[124:127], v[128:131], v[72:87]
  buffer_load_dwordx4 v9, s[44:47], s36 offen offset:1024 lds
  s_waitcnt lgkmcnt(2)
  v_mfma_f32_32x32x16_bf16 v[40:55], v[104:107], v[112:115], v[40:55]
  ds_read_b128 v[120:123], v19 offset:16384
  ds_read_b128 v[128:131], v23 offset:16384
  s_waitcnt lgkmcnt(2)
  v_mfma_f32_32x32x16_bf16 v[56:71], v[104:107], v[116:119], v[56:71]
  ds_read_b128 v[124:127], v19 offset:20480
  ds_read_b128 v[132:135], v23 offset:20480
  v_mfma_f32_32x32x16_bf16 v[88:103], v[108:111], v[116:119], v[88:103]
  buffer_load_dwordx4 v10, s[44:47], s36 offen offset:2048 lds
  v_mfma_f32_32x32x16_bf16 v[72:87], v[108:111], v[112:115], v[72:87]
  buffer_load_dwordx4 v11, s[44:47], s36 offen offset:3072 lds
  s_add_u32 s36, s36, 128
  s_and_b32 s36, s36, 0x7ff
  s_waitcnt vmcnt(16) lgkmcnt(0)
  s_barrier
  v_mfma_f32_32x32x16_bf16 v[40:55], v[120:123], v[128:131], v[40:55]
  ds_read_b128 v[104:107], v16 offset:32768
  ds_read_b128 v[112:115], v20 offset:32768
  v_mfma_f32_32x32x16_bf16 v[56:71], v[120:123], v[132:135], v[56:71]
  ds_read_b128 v[108:111], v16 offset:36864
  ds_read_b128 v[116:119], v20 offset:36864
  v_mfma_f32_32x32x16_bf16 v[88:103], v[124:127], v[132:135], v[88:103]
  s_add_u32 m0, s43, 16384
  s_nop 0
  buffer_load_dwordx4 v12, s[56:59], s36 offen offset:0 lds
  v_mfma_f32_32x32x16_bf16 v[72:87], v[124:127], v[128:131], v[72:87]
  buffer_load_dwordx4 v13, s[56:59], s36 offen offset:1024 lds
  s_waitcnt lgkmcnt(2)
  v_mfma_f32_32x32x16_bf16 v[40:55], v[104:107], v[112:115], v[40:55]
  ds_read_b128 v[120:123], v17 offset:32768
  ds_read_b128 v[128:131], v21 offset:32768
  s_waitcnt lgkmcnt(2)
  v_mfma_f32_32x32x16_bf16 v[56:71], v[104:107], v[116:119], v[56:71]
  ds_read_b128 v[124:127], v17 offset:36864
  ds_read_b128 v[132:135], v21 offset:36864
  v_mfma_f32_32x32x16_bf16 v[88:103], v[108:111], v[116:119], v[88:103]
  buffer_load_dwordx4 v14, s[56:59], s36 offen offset:2048 lds
  v_mfma_f32_32x32x16_bf16 v[72:87], v[108:111], v[112:115], v[72:87]
  buffer_load_dwordx4 v15, s[56:59], s36 offen offset:3072 lds
  s_waitcnt lgkmcnt(2)
  v_mfma_f32_32x32x16_bf16 v[40:55], v[120:123], v[128:131], v[40:55]
  ds_read_b128 v[104:107], v18 offset:32768
  ds_read_b128 v[112:115], v22 offset:32768
  s_waitcnt lgkmcnt(2)
  v_mfma_f32_32x32x16_bf16 v[56:71], v[120:123], v[132:135], v[56:71]
  ds_read_b128 v[108:111], v18 offset:36864
  ds_read_b128 v[116:119], v22 offset:36864
  v_mfma_f32_32x32x16_bf16 v[88:103], v[124:127], v[132:135], v[88:103]
  s_add_u32 m0, s42, 16384
  s_nop 0
  buffer_load_dwordx4 v8, s[44:47], s36 offen offset:0 lds
  v_mfma_f32_32x32x16_bf16 v[72:87], v[124:127], v[128:131], v[72:87]
  buffer_load_dwordx4 v9, s[44:47], s36 offen offset:1024 lds
  s_waitcnt lgkmcnt(2)
  v_mfma_f32_32x32x16_bf16 v[40:55], v[104:107], v[112:115], v[40:55]
  ds_read_b128 v[120:123], v19 offset:32768
  ds_read_b128 v[128:131], v23 offset:32768
  s_waitcnt lgkmcnt(2)
  v_mfma_f32_32x32x16_bf16 v[56:71], v[104:107], v[116:119], v[56:71]
  ds_read_b128 v[124:127], v19 offset:36864
  ds_read_b128 v[132:135], v23 offset:36864
  v_mfma_f32_32x32x16_bf16 v[88:103], v[108:111], v[116:119], v[88:103]
  buffer_load_dwordx4 v10, s[44:47], s36 offen offset:2048 lds
  v_mfma_f32_32x32x16_bf16 v[72:87], v[108:111], v[112:115], v[72:87]
  buffer_load_dwordx4 v11, s[44:47], s36 offen offset:3072 lds
  s_add_u32 s36, s36, 128
  s_and_b32 s36, s36, 0x7ff
  s_waitcnt vmcnt(16) lgkmcnt(0)
  s_barrier
  v_mfma_f32_32x32x16_bf16 v[40:55], v[120:123], v[128:131], v[40:55]
  ds_read_b128 v[104:107], v16 offset:49152
  ds_read_b128 v[112:115], v20 offset:49152
  v_mfma_f32_32x32x16_bf16 v[56:71], v[120:123], v[132:135], v[56:71]
  ds_read_b128 v[108:111], v16 offset:53248
  ds_read_b128 v[116:119], v20 offset:53248
  v_mfma_f32_32x32x16_bf16 v[88:103], v[124:127], v[132:135], v[88:103]
  s_add_u32 m0, s43, 32768
  s_nop 0
  buffer_load_dwordx4 v12, s[56:59], s36 offen offset:0 lds
  v_mfma_f32_32x32x16_bf16 v[72:87], v[124:127], v[128:131], v[72:87]
  buffer_load_dwordx4 v13, s[56:59], s36 offen offset:1024 lds
  s_waitcnt lgkmcnt(2)
  v_mfma_f32_32x32x16_bf16 v[40:55], v[104:107], v[112:115], v[40:55]
  ds_read_b128 v[120:123], v17 offset:49152
  ds_read_b128 v[128:131], v21 offset:49152
  s_waitcnt lgkmcnt(2)
  v_mfma_f32_32x32x16_bf16 v[56:71], v[104:107], v[116:119], v[56:71]
  ds_read_b128 v[124:127], v17 offset:53248
  ds_read_b128 v[132:135], v21 offset:53248
  v_mfma_f32_32x32x16_bf16 v[88:103], v[108:111], v[116:119], v[88:103]
  buffer_load_dwordx4 v14, s[56:59], s36 offen offset:2048 lds
  v_mfma_f32_32x32x16_bf16 v[72:87], v[108:111], v[112:115], v[72:87]
  buffer_load_dwordx4 v15, s[56:59], s36 offen offset:3072 lds
  s_waitcnt lgkmcnt(2)
  v_mfma_f32_32x32x16_bf16 v[40:55], v[120:123], v[128:131], v[40:55]
  ds_read_b128 v[104:107], v18 offset:49152
  ds_read_b128 v[112:115], v22 offset:49152
  s_waitcnt lgkmcnt(2)
  v_mfma_f32_32x32x16_bf16 v[56:71], v[120:123], v[132:135], v[56:71]
  ds_read_b128 v[108:111], v18 offset:53248
  ds_read_b128 v[116:119], v22 offset:53248
  v_mfma_f32_32x32x16_bf16 v[88:103], v[124:127], v[132:135], v[88:103]
  s_add_u32 m0, s42, 32768
  s_nop 0
  buffer_load_dwordx4 v8, s[44:47], s36 offen offset:0 lds
  v_mfma_f32_32x32x16_bf16 v[72:87], v[124:127], v[128:131], v[72:87]
  buffer_load_dwordx4 v9, s[44:47], s36 offen offset:1024 lds
  s_waitcnt lgkmcnt(2)
  v_mfma_f32_32x32x16_bf16 v[40:55], v[104:107], v[112:115], v[40:55]
  ds_read_b128 v[120:123], v19 offset:49152
  ds_read_b128 v[128:131], v23 offset:49152
  s_waitcnt lgkmcnt(2)
  v_mfma_f32_32x32x16_bf16 v[56:71], v[104:107], v[116:119], v[56:71]
  ds_read_b128 v[124:127], v19 offset:53248
  ds_read_b128 v[132:135], v23 offset:53248
  v_mfma_f32_32x32x16_bf16 v[88:103], v[108:111], v[116:119], v[88:103]
  buffer_load_dwordx4 v10, s[44:47], s36 offen offset:2048 lds
  v_mfma_f32_32x32x16_bf16 v[72:87], v[108:111], v[112:115], v[72:87]
  buffer_load_dwordx4 v11, s[44:47], s36 offen offset:3072 lds
  s_add_u32 s36, s36, 128
  s_and_b32 s36, s36, 0x7ff
  s_waitcnt vmcnt(16) lgkmcnt(0)
  s_barrier
  v_mfma_f32_32x32x16_bf16 v[40:55], v[120:123], v[128:131], v[40:55]
  ds_read_b128 v[104:107], v16 offset:0
  ds_read_b128 v[112:115], v20 offset:0
  v_mfma_f32_32x32x16_bf16 v[56:71], v[120:123], v[132:135], v[56:71]
  ds_read_b128 v[108:111], v16 offset:4096
  ds_read_b128 v[116:119], v20 offset:4096
  v_mfma_f32_32x32x16_bf16 v[88:103], v[124:127], v[132:135], v[88:103]
  s_add_u32 m0, s43, 49152
  s_nop 0
  buffer_load_dwordx4 v12, s[56:59], s36 offen offset:0 lds
  v_mfma_f32_32x32x16_bf16 v[72:87], v[124:127], v[128:131], v[72:87]
  buffer_load_dwordx4 v13, s[56:59], s36 offen offset:1024 lds
  s_waitcnt lgkmcnt(2)
  v_mfma_f32_32x32x16_bf16 v[40:55], v[104:107], v[112:115], v[40:55]
  ds_read_b128 v[120:123], v17 offset:0
  ds_read_b128 v[128:131], v21 offset:0
  s_waitcnt lgkmcnt(2)
  v_mfma_f32_32x32x16_bf16 v[56:71], v[104:107], v[116:119], v[56:71]
  ds_read_b128 v[124:127], v17 offset:4096
  ds_read_b128 v[132:135], v21 offset:4096
  v_mfma_f32_32x32x16_bf16 v[88:103], v[108:111], v[116:119], v[88:103]
  buffer_load_dwordx4 v14, s[56:59], s36 offen offset:2048 lds
  v_mfma_f32_32x32x16_bf16 v[72:87], v[108:111], v[112:115], v[72:87]
  buffer_load_dwordx4 v15, s[56:59], s36 offen offset:3072 lds
  s_waitcnt lgkmcnt(2)
  v_mfma_f32_32x32x16_bf16 v[40:55], v[120:123], v[128:131], v[40:55]
  ds_read_b128 v[104:107], v18 offset:0
  ds_read_b128 v[112:115], v22 offset:0
  s_waitcnt lgkmcnt(2)
  v_mfma_f32_32x32x16_bf16 v[56:71], v[120:123], v[132:135], v[56:71]
  ds_read_b128 v[108:111], v18 offset:4096
  ds_read_b128 v[116:119], v22 offset:4096
  v_mfma_f32_32x32x16_bf16 v[88:103], v[124:127], v[132:135], v[88:103]
  s_add_u32 m0, s42, 49152
  s_nop 0
  buffer_load_dwordx4 v8, s[44:47], s36 offen offset:0 lds
  v_mfma_f32_32x32x16_bf16 v[72:87], v[124:127], v[128:131], v[72:87]
  buffer_load_dwordx4 v9, s[44:47], s36 offen offset:1024 lds
  s_waitcnt lgkmcnt(2)
  v_mfma_f32_32x32x16_bf16 v[40:55], v[104:107], v[112:115], v[40:55]
  ds_read_b128 v[120:123], v19 offset:0
  ds_read_b128 v[128:131], v23 offset:0
  s_waitcnt lgkmcnt(2)
  v_mfma_f32_32x32x16_bf16 v[56:71], v[104:107], v[116:119], v[56:71]
  ds_read_b128 v[124:127], v19 offset:4096
  ds_read_b128 v[132:135], v23 offset:4096
  v_mfma_f32_32x32x16_bf16 v[88:103], v[108:111], v[116:119], v[88:103]
  buffer_load_dwordx4 v10, s[44:47], s36 offen offset:2048 lds
  v_mfma_f32_32x32x16_bf16 v[72:87], v[108:111], v[112:115], v[72:87]
  buffer_load_dwordx4 v11, s[44:47], s36 offen offset:3072 lds
  s_add_u32 s36, s36, 128
  s_and_b32 s36, s36, 0x7ff
  s_waitcnt vmcnt(16) lgkmcnt(0)
  s_barrier
  v_mfma_f32_32x32x16_bf16 v[40:55], v[120:123], v[128:131], v[40:55]
  ds_read_b128 v[104:107], v16 offset:16384
  ds_read_b128 v[112:115], v20 offset:16384
  v_mfma_f32_32x32x16_bf16 v[56:71], v[120:123], v[132:135], v[56:71]
  ds_read_b128 v[108:111], v16 offset:20480
  ds_read_b128 v[116:119], v20 offset:20480
  v_mfma_f32_32x32x16_bf16 v[88:103], v[124:127], v[132:135], v[88:103]
  s_add_u32 m0, s43, 0
  s_nop 0
  buffer_load_dwordx4 v12, s[56:59], s36 offen offset:0 lds
  v_mfma_f32_32x32x16_bf16 v[72:87], v[124:127], v[128:131], v[72:87]
  buffer_load_dwordx4 v13, s[56:59], s36 offen offset:1024 lds
  s_waitcnt lgkmcnt(2)
  v_mfma_f32_32x32x16_bf16 v[40:55], v[104:107], v[112:115], v[40:55]
  ds_read_b128 v[120:123], v17 offset:16384
  ds_read_b128 v[128:131], v21 offset:16384
  s_waitcnt lgkmcnt(2)
  v_mfma_f32_32x32x16_bf16 v[56:71], v[104:107], v[116:119], v[56:71]
  ds_read_b128 v[124:127], v17 offset:20480
  ds_read_b128 v[132:135], v21 offset:20480
  v_mfma_f32_32x32x16_bf16 v[88:103], v[108:111], v[116:119], v[88:103]
  buffer_load_dwordx4 v14, s[56:59], s36 offen offset:2048 lds
  v_mfma_f32_32x32x16_bf16 v[72:87], v[108:111], v[112:115], v[72:87]
  buffer_load_dwordx4 v15, s[56:59], s36 offen offset:3072 lds
  s_waitcnt lgkmcnt(2)
  v_mfma_f32_32x32x16_bf16 v[40:55], v[120:123], v[128:131], v[40:55]
  ds_read_b128 v[104:107], v18 offset:16384
  ds_read_b128 v[112:115], v22 offset:16384
  s_waitcnt lgkmcnt(2)
  v_mfma_f32_32x32x16_bf16 v[56:71], v[120:123], v[132:135], v[56:71]
  ds_read_b128 v[108:111], v18 offset:20480
  ds_read_b128 v[116:119], v22 offset:20480
  v_mfma_f32_32x32x16_bf16 v[88:103], v[124:127], v[132:135], v[88:103]
  s_add_u32 m0, s42, 0
  s_nop 0
  buffer_load_dwordx4 v8, s[44:47], s36 offen offset:0 lds
  v_mfma_f32_32x32x16_bf16 v[72:87], v[124:127], v[128:131], v[72:87]
  buffer_load_dwordx4 v9, s[44:47], s36 offen offset:1024 lds
  s_waitcnt lgkmcnt(2)
  v_mfma_f32_32x32x16_bf16 v[40:55], v[104:107], v[112:115], v[40:55]
  ds_read_b128 v[120:123], v19 offset:16384
  ds_read_b128 v[128:131], v23 offset:16384
  s_waitcnt lgkmcnt(2)
  v_mfma_f32_32x32x16_bf16 v[56:71], v[104:107], v[116:119], v[56:71]
  ds_read_b128 v[124:127], v19 offset:20480
  ds_read_b128 v[132:135], v23 offset:20480
  v_mfma_f32_32x32x16_bf16 v[88:103], v[108:111], v[116:119], v[88:103]
  buffer_load_dwordx4 v10, s[44:47], s36 offen offset:2048 lds
  v_mfma_f32_32x32x16_bf16 v[72:87], v[108:111], v[112:115], v[72:87]
  buffer_load_dwordx4 v11, s[44:47], s36 offen offset:3072 lds
  s_add_u32 s36, s36, 128
  s_and_b32 s36, s36, 0x7ff
  s_waitcnt vmcnt(16) lgkmcnt(0)
  s_barrier
  v_mfma_f32_32x32x16_bf16 v[40:55], v[120:123], v[128:131], v[40:55]
  ds_read_b128 v[104:107], v16 offset:32768
  ds_read_b128 v[112:115], v20 offset:32768
  v_mfma_f32_32x32x16_bf16 v[56:71], v[120:123], v[132:135], v[56:71]
  ds_read_b128 v[108:111], v16 offset:36864
  ds_read_b128 v[116:119], v20 offset:36864
  v_mfma_f32_32x32x16_bf16 v[88:103], v[124:127], v[132:135], v[88:103]
  s_add_u32 m0, s43, 16384
  s_nop 0
  buffer_load_dwordx4 v12, s[56:59], s36 offen offset:0 lds
  v_mfma_f32_32x32x16_bf16 v[72:87], v[124:127], v[128:131], v[72:87]
  buffer_load_dwordx4 v13, s[56:59], s36 offen offset:1024 lds
  s_waitcnt lgkmcnt(2)
  v_mfma_f32_32x32x16_bf16 v[40:55], v[104:107], v[112:115], v[40:55]
  ds_read_b128 v[120:123], v17 offset:32768
  ds_read_b128 v[128:131], v21 offset:32768
  s_waitcnt lgkmcnt(2)
  v_mfma_f32_32x32x16_bf16 v[56:71], v[104:107], v[116:119], v[56:71]
  ds_read_b128 v[124:127], v17 offset:36864
  ds_read_b128 v[132:135], v21 offset:36864
  v_mfma_f32_32x32x16_bf16 v[88:103], v[108:111], v[116:119], v[88:103]
  buffer_load_dwordx4 v14, s[56:59], s36 offen offset:2048 lds
  v_mfma_f32_32x32x16_bf16 v[72:87], v[108:111], v[112:115], v[72:87]
  buffer_load_dwordx4 v15, s[56:59], s36 offen offset:3072 lds
  s_waitcnt lgkmcnt(2)
  v_mfma_f32_32x32x16_bf16 v[40:55], v[120:123], v[128:131], v[40:55]
  ds_read_b128 v[104:107], v18 offset:32768
  ds_read_b128 v[112:115], v22 offset:32768
  s_waitcnt lgkmcnt(2)
  v_mfma_f32_32x32x16_bf16 v[56:71], v[120:123], v[132:135], v[56:71]
  ds_read_b128 v[108:111], v18 offset:36864
  ds_read_b128 v[116:119], v22 offset:36864
  v_mfma_f32_32x32x16_bf16 v[88:103], v[124:127], v[132:135], v[88:103]
  s_add_u32 m0, s42, 16384
  s_nop 0
  buffer_load_dwordx4 v8, s[44:47], s36 offen offset:0 lds
  v_mfma_f32_32x32x16_bf16 v[72:87], v[124:127], v[128:131], v[72:87]
  buffer_load_dwordx4 v9, s[44:47], s36 offen offset:1024 lds
  s_waitcnt lgkmcnt(2)
  v_mfma_f32_32x32x16_bf16 v[40:55], v[104:107], v[112:115], v[40:55]
  ds_read_b128 v[120:123], v19 offset:32768
  ds_read_b128 v[128:131], v23 offset:32768
  s_waitcnt lgkmcnt(2)
  v_mfma_f32_32x32x16_bf16 v[56:71], v[104:107], v[116:119], v[56:71]
  ds_read_b128 v[124:127], v19 offset:36864
  ds_read_b128 v[132:135], v23 offset:36864
  v_mfma_f32_32x32x16_bf16 v[88:103], v[108:111], v[116:119], v[88:103]
  buffer_load_dwordx4 v10, s[44:47], s36 offen offset:2048 lds
  v_mfma_f32_32x32x16_bf16 v[72:87], v[108:111], v[112:115], v[72:87]
  buffer_load_dwordx4 v11, s[44:47], s36 offen offset:3072 lds
  s_add_u32 s36, s36, 128
  s_and_b32 s36, s36, 0x7ff
  s_waitcnt vmcnt(16) lgkmcnt(0)
  s_barrier
  v_mfma_f32_32x32x16_bf16 v[40:55], v[120:123], v[128:131], v[40:55]
  ds_read_b128 v[104:107], v16 offset:49152
  ds_read_b128 v[112:115], v20 offset:49152
  v_mfma_f32_32x32x16_bf16 v[56:71], v[120:123], v[132:135], v[56:71]
  ds_read_b128 v[108:111], v16 offset:53248
  ds_read_b128 v[116:119], v20 offset:53248
  v_mfma_f32_32x32x16_bf16 v[88:103], v[124:127], v[132:135], v[88:103]
  s_add_u32 m0, s43, 32768
  s_nop 0
  buffer_load_dwordx4 v12, s[56:59], s36 offen offset:0 lds
  v_mfma_f32_32x32x16_bf16 v[72:87], v[124:127], v[128:131], v[72:87]
  buffer_load_dwordx4 v13, s[56:59], s36 offen offset:1024 lds
  s_waitcnt lgkmcnt(2)
  v_mfma_f32_32x32x16_bf16 v[40:55], v[104:107], v[112:115], v[40:55]
  ds_read_b128 v[120:123], v17 offset:49152
  ds_read_b128 v[128:131], v21 offset:49152
  s_waitcnt lgkmcnt(2)
  v_mfma_f32_32x32x16_bf16 v[56:71], v[104:107], v[116:119], v[56:71]
  ds_read_b128 v[124:127], v17 offset:53248
  ds_read_b128 v[132:135], v21 offset:53248
  v_mfma_f32_32x32x16_bf16 v[88:103], v[108:111], v[116:119], v[88:103]
  buffer_load_dwordx4 v14, s[56:59], s36 offen offset:2048 lds
  v_mfma_f32_32x32x16_bf16 v[72:87], v[108:111], v[112:115], v[72:87]
  buffer_load_dwordx4 v15, s[56:59], s36 offen offset:3072 lds
  s_waitcnt lgkmcnt(2)
  v_mfma_f32_32x32x16_bf16 v[40:55], v[120:123], v[128:131], v[40:55]
  ds_read_b128 v[104:107], v18 offset:49152
  ds_read_b128 v[112:115], v22 offset:49152
  s_waitcnt lgkmcnt(2)
  v_mfma_f32_32x32x16_bf16 v[56:71], v[120:123], v[132:135], v[56:71]
  ds_read_b128 v[108:111], v18 offset:53248
  ds_read_b128 v[116:119], v22 offset:53248
  v_mfma_f32_32x32x16_bf16 v[88:103], v[124:127], v[132:135], v[88:103]
  s_add_u32 m0, s42, 32768
  s_nop 0
  buffer_load_dwordx4 v8, s[44:47], s36 offen offset:0 lds
  v_mfma_f32_32x32x16_bf16 v[72:87], v[124:127], v[128:131], v[72:87]
  buffer_load_dwordx4 v9, s[44:47], s36 offen offset:1024 lds
  s_waitcnt lgkmcnt(2)
  v_mfma_f32_32x32x16_bf16 v[40:55], v[104:107], v[112:115], v[40:55]
  ds_read_b128 v[120:123], v19 offset:49152
  ds_read_b128 v[128:131], v23 offset:49152
  s_waitcnt lgkmcnt(2)
  v_mfma_f32_32x32x16_bf16 v[56:71], v[104:107], v[116:119], v[56:71]
  ds_read_b128 v[124:127], v19 offset:53248
  ds_read_b128 v[132:135], v23 offset:53248
  v_mfma_f32_32x32x16_bf16 v[88:103], v[108:111], v[116:119], v[88:103]
  buffer_load_dwordx4 v10, s[44:47], s36 offen offset:2048 lds
  v_mfma_f32_32x32x16_bf16 v[72:87], v[108:111], v[112:115], v[72:87]
  buffer_load_dwordx4 v11, s[44:47], s36 offen offset:3072 lds
  s_add_u32 s36, s36, 128
  s_and_b32 s36, s36, 0x7ff
  s_waitcnt vmcnt(16) lgkmcnt(0)
  s_barrier
  v_mfma_f32_32x32x16_bf16 v[40:55], v[120:123], v[128:131], v[40:55]
  ds_read_b128 v[104:107], v16 offset:0
  ds_read_b128 v[112:115], v20 offset:0
  v_mfma_f32_32x32x16_bf16 v[56:71], v[120:123], v[132:135], v[56:71]
  ds_read_b128 v[108:111], v16 offset:4096
  ds_read_b128 v[116:119], v20 offset:4096
  v_mfma_f32_32x32x16_bf16 v[88:103], v[124:127], v[132:135], v[88:103]
  s_add_u32 m0, s43, 49152
  s_nop 0
  buffer_load_dwordx4 v12, s[56:59], s36 offen offset:0 lds
  v_mfma_f32_32x32x16_bf16 v[72:87], v[124:127], v[128:131], v[72:87]
  buffer_load_dwordx4 v13, s[56:59], s36 offen offset:1024 lds
  s_waitcnt lgkmcnt(2)
  v_mfma_f32_32x32x16_bf16 v[40:55], v[104:107], v[112:115], v[40:55]
  ds_read_b128 v[120:123], v17 offset:0
  ds_read_b128 v[128:131], v21 offset:0
  s_waitcnt lgkmcnt(2)
  v_mfma_f32_32x32x16_bf16 v[56:71], v[104:107], v[116:119], v[56:71]
  ds_read_b128 v[124:127], v17 offset:4096
  ds_read_b128 v[132:135], v21 offset:4096
  v_mfma_f32_32x32x16_bf16 v[88:103], v[108:111], v[116:119], v[88:103]
  buffer_load_dwordx4 v14, s[56:59], s36 offen offset:2048 lds
  v_mfma_f32_32x32x16_bf16 v[72:87], v[108:111], v[112:115], v[72:87]
  buffer_load_dwordx4 v15, s[56:59], s36 offen offset:3072 lds
  s_waitcnt lgkmcnt(2)
  v_mfma_f32_32x32x16_bf16 v[40:55], v[120:123], v[128:131], v[40:55]
  ds_read_b128 v[104:107], v18 offset:0
  ds_read_b128 v[112:115], v22 offset:0
  s_waitcnt lgkmcnt(2)
  v_mfma_f32_32x32x16_bf16 v[56:71], v[120:123], v[132:135], v[56:71]
  ds_read_b128 v[108:111], v18 offset:4096
  ds_read_b128 v[116:119], v22 offset:4096
  v_mfma_f32_32x32x16_bf16 v[88:103], v[124:127], v[132:135], v[88:103]
  s_add_u32 m0, s42, 49152
  s_nop 0
  buffer_load_dwordx4 v8, s[44:47], s36 offen offset:0 lds
  v_mfma_f32_32x32x16_bf16 v[72:87], v[124:127], v[128:131], v[72:87]
  buffer_load_dwordx4 v9, s[44:47], s36 offen offset:1024 lds
  s_waitcnt lgkmcnt(2)
  v_mfma_f32_32x32x16_bf16 v[40:55], v[104:107], v[112:115], v[40:55]
  ds_read_b128 v[120:123], v19 offset:0
  ds_read_b128 v[128:131], v23 offset:0
  s_waitcnt lgkmcnt(2)
  v_mfma_f32_32x32x16_bf16 v[56:71], v[104:107], v[116:119], v[56:71]
  ds_read_b128 v[124:127], v19 offset:4096
  ds_read_b128 v[132:135], v23 offset:4096
  v_mfma_f32_32x32x16_bf16 v[88:103], v[108:111], v[116:119], v[88:103]
  buffer_load_dwordx4 v10, s[44:47], s36 offen offset:2048 lds
  v_mfma_f32_32x32x16_bf16 v[72:87], v[108:111], v[112:115], v[72:87]
  buffer_load_dwordx4 v11, s[44:47], s36 offen offset:3072 lds
  s_add_u32 s36, s36, 128
  s_and_b32 s36, s36, 0x7ff
  s_waitcnt vmcnt(16) lgkmcnt(0)
  s_barrier
  v_mfma_f32_32x32x16_bf16 v[40:55], v[120:123], v[128:131], v[40:55]
  ds_read_b128 v[104:107], v16 offset:16384
  ds_read_b128 v[112:115], v20 offset:16384
  v_mfma_f32_32x32x16_bf16 v[56:71], v[120:123], v[132:135], v[56:71]
  ds_read_b128 v[108:111], v16 offset:20480
  ds_read_b128 v[116:119], v20 offset:20480
  v_mfma_f32_32x32x16_bf16 v[88:103], v[124:127], v[132:135], v[88:103]
  buffer_load_dword v39, v38, s[80:83], 0 offen offset:0 sc1
  buffer_load_dwordx4 a[0:3], v34, s[52:55], s76 offen offset:0
  v_mfma_f32_32x32x16_bf16 v[72:87], v[124:127], v[128:131], v[72:87]
  buffer_load_dwordx4 a[4:7], v34, s[52:55], s76 offen offset:64
  s_waitcnt lgkmcnt(2)
  v_mfma_f32_32x32x16_bf16 v[40:55], v[104:107], v[112:115], v[40:55]
  ds_read_b128 v[120:123], v17 offset:16384
  ds_read_b128 v[128:131], v21 offset:16384
  s_waitcnt lgkmcnt(2)
  v_mfma_f32_32x32x16_bf16 v[56:71], v[104:107], v[116:119], v[56:71]
  ds_read_b128 v[124:127], v17 offset:20480
  ds_read_b128 v[132:135], v21 offset:20480
  v_mfma_f32_32x32x16_bf16 v[88:103], v[108:111], v[116:119], v[88:103]
  buffer_load_dwordx4 a[8:11], v35, s[52:55], s76 offen offset:0
  v_mfma_f32_32x32x16_bf16 v[72:87], v[108:111], v[112:115], v[72:87]
  buffer_load_dwordx4 a[12:15], v35, s[52:55], s76 offen offset:64
  s_add_u32 s76, s76, 128
  s_and_b32 s76, s76, 0x7ff
  s_waitcnt lgkmcnt(2)
  v_mfma_f32_32x32x16_bf16 v[40:55], v[120:123], v[128:131], v[40:55]
  ds_read_b128 v[104:107], v18 offset:16384
  ds_read_b128 v[112:115], v22 offset:16384
  s_waitcnt lgkmcnt(2)
  v_mfma_f32_32x32x16_bf16 v[56:71], v[120:123], v[132:135], v[56:71]
  ds_read_b128 v[108:111], v18 offset:20480
  ds_read_b128 v[116:119], v22 offset:20480
  v_mfma_f32_32x32x16_bf16 v[88:103], v[124:127], v[132:135], v[88:103]
  buffer_load_dwordx4 a[16:19], v34, s[52:55], s76 offen offset:0
  v_mfma_f32_32x32x16_bf16 v[72:87], v[124:127], v[128:131], v[72:87]
  buffer_load_dwordx4 a[20:23], v34, s[52:55], s76 offen offset:64
  s_waitcnt lgkmcnt(2)
  v_mfma_f32_32x32x16_bf16 v[40:55], v[104:107], v[112:115], v[40:55]
  ds_read_b128 v[120:123], v19 offset:16384
  ds_read_b128 v[128:131], v23 offset:16384
  s_waitcnt lgkmcnt(2)
  v_mfma_f32_32x32x16_bf16 v[56:71], v[104:107], v[116:119], v[56:71]
  ds_read_b128 v[124:127], v19 offset:20480
  ds_read_b128 v[132:135], v23 offset:20480
  v_mfma_f32_32x32x16_bf16 v[88:103], v[108:111], v[116:119], v[88:103]
  buffer_load_dwordx4 a[24:27], v35, s[52:55], s76 offen offset:0
  v_mfma_f32_32x32x16_bf16 v[72:87], v[108:111], v[112:115], v[72:87]
  buffer_load_dwordx4 a[28:31], v35, s[52:55], s76 offen offset:64
  s_add_u32 s76, s76, 128
  s_and_b32 s76, s76, 0x7ff
  s_waitcnt vmcnt(17) lgkmcnt(0)
  s_barrier
  v_mfma_f32_32x32x16_bf16 v[40:55], v[120:123], v[128:131], v[40:55]
  ds_read_b128 v[104:107], v16 offset:32768
  ds_read_b128 v[112:115], v20 offset:32768
  v_mfma_f32_32x32x16_bf16 v[56:71], v[120:123], v[132:135], v[56:71]
  ds_read_b128 v[108:111], v16 offset:36864
  ds_read_b128 v[116:119], v20 offset:36864
  v_mfma_f32_32x32x16_bf16 v[88:103], v[124:127], v[132:135], v[88:103]
  buffer_load_dwordx4 a[32:35], v34, s[52:55], s76 offen offset:0
  v_mfma_f32_32x32x16_bf16 v[72:87], v[124:127], v[128:131], v[72:87]
  buffer_load_dwordx4 a[36:39], v34, s[52:55], s76 offen offset:64
  s_waitcnt lgkmcnt(2)
  v_mfma_f32_32x32x16_bf16 v[40:55], v[104:107], v[112:115], v[40:55]
  ds_read_b128 v[120:123], v17 offset:32768
  ds_read_b128 v[128:131], v21 offset:32768
  s_waitcnt lgkmcnt(2)
  v_mfma_f32_32x32x16_bf16 v[56:71], v[104:107], v[116:119], v[56:71]
  ds_read_b128 v[124:127], v17 offset:36864
  ds_read_b128 v[132:135], v21 offset:36864
  v_mfma_f32_32x32x16_bf16 v[88:103], v[108:111], v[116:119], v[88:103]
  buffer_load_dwordx4 a[40:43], v35, s[52:55], s76 offen offset:0
  v_mfma_f32_32x32x16_bf16 v[72:87], v[108:111], v[112:115], v[72:87]
  buffer_load_dwordx4 a[44:47], v35, s[52:55], s76 offen offset:64
  s_add_u32 s76, s76, 128
  s_and_b32 s76, s76, 0x7ff
  s_waitcnt lgkmcnt(2)
  v_mfma_f32_32x32x16_bf16 v[40:55], v[120:123], v[128:131], v[40:55]
  ds_read_b128 v[104:107], v18 offset:32768
  ds_read_b128 v[112:115], v22 offset:32768
  s_waitcnt lgkmcnt(2)
  v_mfma_f32_32x32x16_bf16 v[56:71], v[120:123], v[132:135], v[56:71]
  ds_read_b128 v[108:111], v18 offset:36864
  ds_read_b128 v[116:119], v22 offset:36864
  v_mfma_f32_32x32x16_bf16 v[88:103], v[124:127], v[132:135], v[88:103]
  buffer_load_dwordx4 a[48:51], v34, s[52:55], s76 offen offset:0
  v_mfma_f32_32x32x16_bf16 v[72:87], v[124:127], v[128:131], v[72:87]
  buffer_load_dwordx4 a[52:55], v34, s[52:55], s76 offen offset:64
  s_waitcnt lgkmcnt(2)
  v_mfma_f32_32x32x16_bf16 v[40:55], v[104:107], v[112:115], v[40:55]
  ds_read_b128 v[120:123], v19 offset:32768
  ds_read_b128 v[128:131], v23 offset:32768
  s_waitcnt lgkmcnt(2)
  v_mfma_f32_32x32x16_bf16 v[56:71], v[104:107], v[116:119], v[56:71]
  ds_read_b128 v[124:127], v19 offset:36864
  ds_read_b128 v[132:135], v23 offset:36864
  v_mfma_f32_32x32x16_bf16 v[88:103], v[108:111], v[116:119], v[88:103]
  buffer_load_dwordx4 a[56:59], v35, s[52:55], s76 offen offset:0
  v_mfma_f32_32x32x16_bf16 v[72:87], v[108:111], v[112:115], v[72:87]
  buffer_load_dwordx4 a[60:63], v35, s[52:55], s76 offen offset:64
  s_add_u32 s76, s76, 128
  s_and_b32 s76, s76, 0x7ff
  s_waitcnt vmcnt(17) lgkmcnt(0)
  s_barrier
  v_mfma_f32_32x32x16_bf16 v[40:55], v[120:123], v[128:131], v[40:55]
  ds_read_b128 v[104:107], v16 offset:49152
  ds_read_b128 v[112:115], v20 offset:49152
  v_mfma_f32_32x32x16_bf16 v[56:71], v[120:123], v[132:135], v[56:71]
  ds_read_b128 v[108:111], v16 offset:53248
  ds_read_b128 v[116:119], v20 offset:53248
  v_mfma_f32_32x32x16_bf16 v[88:103], v[124:127], v[132:135], v[88:103]
  buffer_load_dwordx4 a[64:67], v34, s[52:55], s76 offen offset:0
  v_mfma_f32_32x32x16_bf16 v[72:87], v[124:127], v[128:131], v[72:87]
  buffer_load_dwordx4 a[68:71], v34, s[52:55], s76 offen offset:64
  s_waitcnt lgkmcnt(2)
  v_mfma_f32_32x32x16_bf16 v[40:55], v[104:107], v[112:115], v[40:55]
  ds_read_b128 v[120:123], v17 offset:49152
  ds_read_b128 v[128:131], v21 offset:49152
  s_waitcnt lgkmcnt(2)
  v_mfma_f32_32x32x16_bf16 v[56:71], v[104:107], v[116:119], v[56:71]
  ds_read_b128 v[124:127], v17 offset:53248
  ds_read_b128 v[132:135], v21 offset:53248
  v_mfma_f32_32x32x16_bf16 v[88:103], v[108:111], v[116:119], v[88:103]
  buffer_load_dwordx4 a[72:75], v35, s[52:55], s76 offen offset:0
  v_mfma_f32_32x32x16_bf16 v[72:87], v[108:111], v[112:115], v[72:87]
  buffer_load_dwordx4 a[76:79], v35, s[52:55], s76 offen offset:64
  s_add_u32 s76, s76, 128
  s_and_b32 s76, s76, 0x7ff
  s_waitcnt lgkmcnt(2)
  v_mfma_f32_32x32x16_bf16 v[40:55], v[120:123], v[128:131], v[40:55]
  ds_read_b128 v[104:107], v18 offset:49152
  ds_read_b128 v[112:115], v22 offset:49152
  s_waitcnt lgkmcnt(2)
  v_mfma_f32_32x32x16_bf16 v[56:71], v[120:123], v[132:135], v[56:71]
  ds_read_b128 v[108:111], v18 offset:53248
  ds_read_b128 v[116:119], v22 offset:53248
  v_mfma_f32_32x32x16_bf16 v[88:103], v[124:127], v[132:135], v[88:103]
  buffer_load_dwordx4 a[80:83], v34, s[52:55], s76 offen offset:0
  v_mfma_f32_32x32x16_bf16 v[72:87], v[124:127], v[128:131], v[72:87]
  buffer_load_dwordx4 a[84:87], v34, s[52:55], s76 offen offset:64
  s_waitcnt lgkmcnt(2)
  v_mfma_f32_32x32x16_bf16 v[40:55], v[104:107], v[112:115], v[40:55]
  ds_read_b128 v[120:123], v19 offset:49152
  ds_read_b128 v[128:131], v23 offset:49152
  s_waitcnt lgkmcnt(2)
  v_mfma_f32_32x32x16_bf16 v[56:71], v[104:107], v[116:119], v[56:71]
  ds_read_b128 v[124:127], v19 offset:53248
  ds_read_b128 v[132:135], v23 offset:53248
  v_mfma_f32_32x32x16_bf16 v[88:103], v[108:111], v[116:119], v[88:103]
  buffer_load_dwordx4 a[88:91], v35, s[52:55], s76 offen offset:0
  v_mfma_f32_32x32x16_bf16 v[72:87], v[108:111], v[112:115], v[72:87]
  buffer_load_dwordx4 a[92:95], v35, s[52:55], s76 offen offset:64
  s_add_u32 s76, s76, 128
  s_and_b32 s76, s76, 0x7ff
  s_waitcnt lgkmcnt(2)
  v_mfma_f32_32x32x16_bf16 v[40:55], v[120:123], v[128:131], v[40:55]
  s_waitcnt lgkmcnt(0)
  v_mfma_f32_32x32x16_bf16 v[56:71], v[120:123], v[132:135], v[56:71]
  v_mfma_f32_32x32x16_bf16 v[88:103], v[124:127], v[132:135], v[88:103]
  buffer_load_dwordx4 a[96:99], v34, s[52:55], s76 offen offset:0
  v_mfma_f32_32x32x16_bf16 v[72:87], v[124:127], v[128:131], v[72:87]
  buffer_load_dwordx4 a[100:103], v34, s[52:55], s76 offen offset:64
  s_nop 5
  v_pk_fma_f32 v[8:9], v[2:3], v[40:41], v[42:43] op_sel:[0,0,0] op_sel_hi:[0,1,1]
  s_nop 0
  v_pk_fma_f32 v[10:11], v[2:3], v[56:57], v[58:59] op_sel:[0,0,0] op_sel_hi:[0,1,1]
  v_pk_fma_f32 v[8:9], v[2:3], v[56:57], v[8:9] op_sel:[1,0,0] op_sel_hi:[1,1,1] neg_lo:[1,0,0] neg_hi:[1,0,0]
  v_pk_fma_f32 v[10:11], v[2:3], v[40:41], v[10:11] op_sel:[1,0,0] op_sel_hi:[1,1,1]
  v_pk_fma_f32 v[12:13], v[2:3], v[8:9], v[44:45] op_sel:[0,0,0] op_sel_hi:[0,1,1]
  v_pk_fma_f32 v[14:15], v[2:3], v[10:11], v[60:61] op_sel:[0,0,0] op_sel_hi:[0,1,1]
  v_pk_fma_f32 v[12:13], v[2:3], v[10:11], v[12:13] op_sel:[1,0,0] op_sel_hi:[1,1,1] neg_lo:[1,0,0] neg_hi:[1,0,0]
  v_pk_fma_f32 v[14:15], v[2:3], v[8:9], v[14:15] op_sel:[1,0,0] op_sel_hi:[1,1,1]
  v_pk_fma_f32 v[8:9], v[2:3], v[12:13], v[46:47] op_sel:[0,0,0] op_sel_hi:[0,1,1]
  v_pk_fma_f32 v[10:11], v[2:3], v[14:15], v[62:63] op_sel:[0,0,0] op_sel_hi:[0,1,1]
  v_pk_fma_f32 v[8:9], v[2:3], v[14:15], v[8:9] op_sel:[1,0,0] op_sel_hi:[1,1,1] neg_lo:[1,0,0] neg_hi:[1,0,0]
  v_pk_fma_f32 v[10:11], v[2:3], v[12:13], v[10:11] op_sel:[1,0,0] op_sel_hi:[1,1,1]
  v_pk_fma_f32 v[12:13], v[2:3], v[8:9], v[48:49] op_sel:[0,0,0] op_sel_hi:[0,1,1]
  v_pk_fma_f32 v[14:15], v[2:3], v[10:11], v[64:65] op_sel:[0,0,0] op_sel_hi:[0,1,1]
  v_pk_fma_f32 v[12:13], v[2:3], v[10:11], v[12:13] op_sel:[1,0,0] op_sel_hi:[1,1,1] neg_lo:[1,0,0] neg_hi:[1,0,0]
  v_pk_fma_f32 v[14:15], v[2:3], v[8:9], v[14:15] op_sel:[1,0,0] op_sel_hi:[1,1,1]
  v_pk_fma_f32 v[8:9], v[2:3], v[12:13], v[50:51] op_sel:[0,0,0] op_sel_hi:[0,1,1]
  v_pk_fma_f32 v[10:11], v[2:3], v[14:15], v[66:67] op_sel:[0,0,0] op_sel_hi:[0,1,1]
  v_pk_fma_f32 v[8:9], v[2:3], v[14:15], v[8:9] op_sel:[1,0,0] op_sel_hi:[1,1,1] neg_lo:[1,0,0] neg_hi:[1,0,0]
  v_pk_fma_f32 v[10:11], v[2:3], v[12:13], v[10:11] op_sel:[1,0,0] op_sel_hi:[1,1,1]
  v_pk_fma_f32 v[12:13], v[2:3], v[8:9], v[52:53] op_sel:[0,0,0] op_sel_hi:[0,1,1]
  v_pk_fma_f32 v[14:15], v[2:3], v[10:11], v[68:69] op_sel:[0,0,0] op_sel_hi:[0,1,1]
  v_pk_fma_f32 v[12:13], v[2:3], v[10:11], v[12:13] op_sel:[1,0,0] op_sel_hi:[1,1,1] neg_lo:[1,0,0] neg_hi:[1,0,0]
  v_pk_fma_f32 v[14:15], v[2:3], v[8:9], v[14:15] op_sel:[1,0,0] op_sel_hi:[1,1,1]
  v_pk_fma_f32 v[8:9], v[2:3], v[12:13], v[54:55] op_sel:[0,0,0] op_sel_hi:[0,1,1]
  v_pk_fma_f32 v[10:11], v[2:3], v[14:15], v[70:71] op_sel:[0,0,0] op_sel_hi:[0,1,1]
  v_pk_fma_f32 v[8:9], v[2:3], v[14:15], v[8:9] op_sel:[1,0,0] op_sel_hi:[1,1,1] neg_lo:[1,0,0] neg_hi:[1,0,0]
  v_pk_fma_f32 v[10:11], v[2:3], v[12:13], v[10:11] op_sel:[1,0,0] op_sel_hi:[1,1,1]
  v_pk_fma_f32 v[12:13], v[2:3], v[8:9], v[72:73] op_sel:[0,0,0] op_sel_hi:[0,1,1]
  v_pk_fma_f32 v[14:15], v[2:3], v[10:11], v[88:89] op_sel:[0,0,0] op_sel_hi:[0,1,1]
  v_pk_fma_f32 v[12:13], v[2:3], v[10:11], v[12:13] op_sel:[1,0,0] op_sel_hi:[1,1,1] neg_lo:[1,0,0] neg_hi:[1,0,0]
  v_pk_fma_f32 v[14:15], v[2:3], v[8:9], v[14:15] op_sel:[1,0,0] op_sel_hi:[1,1,1]
  v_pk_fma_f32 v[8:9], v[2:3], v[12:13], v[74:75] op_sel:[0,0,0] op_sel_hi:[0,1,1]
  v_pk_fma_f32 v[10:11], v[2:3], v[14:15], v[90:91] op_sel:[0,0,0] op_sel_hi:[0,1,1]
  v_pk_fma_f32 v[8:9], v[2:3], v[14:15], v[8:9] op_sel:[1,0,0] op_sel_hi:[1,1,1] neg_lo:[1,0,0] neg_hi:[1,0,0]
  v_pk_fma_f32 v[10:11], v[2:3], v[12:13], v[10:11] op_sel:[1,0,0] op_sel_hi:[1,1,1]
  v_pk_fma_f32 v[12:13], v[2:3], v[8:9], v[76:77] op_sel:[0,0,0] op_sel_hi:[0,1,1]
  v_pk_fma_f32 v[14:15], v[2:3], v[10:11], v[92:93] op_sel:[0,0,0] op_sel_hi:[0,1,1]
  v_pk_fma_f32 v[12:13], v[2:3], v[10:11], v[12:13] op_sel:[1,0,0] op_sel_hi:[1,1,1] neg_lo:[1,0,0] neg_hi:[1,0,0]
  v_pk_fma_f32 v[14:15], v[2:3], v[8:9], v[14:15] op_sel:[1,0,0] op_sel_hi:[1,1,1]
  v_pk_fma_f32 v[8:9], v[2:3], v[12:13], v[78:79] op_sel:[0,0,0] op_sel_hi:[0,1,1]
  v_pk_fma_f32 v[10:11], v[2:3], v[14:15], v[94:95] op_sel:[0,0,0] op_sel_hi:[0,1,1]
  v_pk_fma_f32 v[8:9], v[2:3], v[14:15], v[8:9] op_sel:[1,0,0] op_sel_hi:[1,1,1] neg_lo:[1,0,0] neg_hi:[1,0,0]
  v_pk_fma_f32 v[10:11], v[2:3], v[12:13], v[10:11] op_sel:[1,0,0] op_sel_hi:[1,1,1]
  v_pk_fma_f32 v[12:13], v[2:3], v[8:9], v[80:81] op_sel:[0,0,0] op_sel_hi:[0,1,1]
  v_pk_fma_f32 v[14:15], v[2:3], v[10:11], v[96:97] op_sel:[0,0,0] op_sel_hi:[0,1,1]
  v_pk_fma_f32 v[12:13], v[2:3], v[10:11], v[12:13] op_sel:[1,0,0] op_sel_hi:[1,1,1] neg_lo:[1,0,0] neg_hi:[1,0,0]
  v_pk_fma_f32 v[14:15], v[2:3], v[8:9], v[14:15] op_sel:[1,0,0] op_sel_hi:[1,1,1]
  v_pk_fma_f32 v[8:9], v[2:3], v[12:13], v[82:83] op_sel:[0,0,0] op_sel_hi:[0,1,1]
  v_pk_fma_f32 v[10:11], v[2:3], v[14:15], v[98:99] op_sel:[0,0,0] op_sel_hi:[0,1,1]
  v_pk_fma_f32 v[8:9], v[2:3], v[14:15], v[8:9] op_sel:[1,0,0] op_sel_hi:[1,1,1] neg_lo:[1,0,0] neg_hi:[1,0,0]
  v_pk_fma_f32 v[10:11], v[2:3], v[12:13], v[10:11] op_sel:[1,0,0] op_sel_hi:[1,1,1]
  v_pk_fma_f32 v[12:13], v[2:3], v[8:9], v[84:85] op_sel:[0,0,0] op_sel_hi:[0,1,1]
  v_pk_fma_f32 v[14:15], v[2:3], v[10:11], v[100:101] op_sel:[0,0,0] op_sel_hi:[0,1,1]
  v_pk_fma_f32 v[12:13], v[2:3], v[10:11], v[12:13] op_sel:[1,0,0] op_sel_hi:[1,1,1] neg_lo:[1,0,0] neg_hi:[1,0,0]
  v_pk_fma_f32 v[14:15], v[2:3], v[8:9], v[14:15] op_sel:[1,0,0] op_sel_hi:[1,1,1]
  v_pk_fma_f32 v[8:9], v[2:3], v[12:13], v[86:87] op_sel:[0,0,0] op_sel_hi:[0,1,1]
  v_pk_fma_f32 v[10:11], v[2:3], v[14:15], v[102:103] op_sel:[0,0,0] op_sel_hi:[0,1,1]
  v_pk_fma_f32 v[8:9], v[2:3], v[14:15], v[8:9] op_sel:[1,0,0] op_sel_hi:[1,1,1] neg_lo:[1,0,0] neg_hi:[1,0,0]
  v_pk_fma_f32 v[10:11], v[2:3], v[12:13], v[10:11] op_sel:[1,0,0] op_sel_hi:[1,1,1]
  v_fma_f32 v12, v24, v8, v9
  v_fma_f32 v13, v24, v10, v11
  v_fma_f32 v12, -v25, v10, v12
  v_fma_f32 v13, v25, v8, v13
  v_mov_b32 v14, v12
  v_mov_b32 v15, v13
  s_nop 0
  v_permlane32_swap_b32 v12, v14
  v_permlane32_swap_b32 v13, v15
  v_fma_f32 v14, v26, v12, v14
  v_fma_f32 v15, v26, v13, v15
  v_fma_f32 v14, -v27, v13, v14
  v_fma_f32 v15, v27, v12, v15
  v_min_u32 v14, -2, v14
  v_min_u32 v15, -2, v15
  s_lshl_b32 s36, s38, 1
  s_lshr_b32 s37, s3, 1
  s_add_u32 s36, s36, s37
  s_sub_u32 s36, 31, s36
  s_lshl_b32 s36, s36, 9
  s_and_b32 s37, s3, 1
  s_lshl_b32 s37, s37, 8
  s_add_u32 s36, s36, s37
  v_and_b32 v16, 31, v4
  v_lshl_add_u32 v16, v16, 3, s36
  s_mov_b32 exec_hi, 0
  buffer_store_dwordx2 v[14:15], v16, s[60:63], 0 offen sc1
  s_mov_b64 exec, -1
  v_lshrrev_b32 v17, 5, v4
  v_lshl_add_u32 v16, v17, 13, v16
  v_add_u32 v16, 512, v16
  s_waitcnt vmcnt(27)
  v_cmp_ne_u32 vcc, 16, v39
  s_nop 0
  s_cbranch_vccz gated_mix__spectral_gfnet__ssm_conv_s5__prompt_kernel_skip7
  s_mov_b32 s36, 0
gated_mix__spectral_gfnet__ssm_conv_s5__prompt_kernel_poll8:
  buffer_load_dword v39, v38, s[80:83], 0 offen offset:0 sc1
  s_waitcnt vmcnt(0)
  v_cmp_ne_u32 vcc, 16, v39
  s_nop 0
  s_cbranch_vccz gated_mix__spectral_gfnet__ssm_conv_s5__prompt_kernel_pollout9
  s_add_u32 s36, s36, 1
  s_cmp_lt_u32 s36, 1048576
  s_cbranch_scc1 gated_mix__spectral_gfnet__ssm_conv_s5__prompt_kernel_poll8
gated_mix__spectral_gfnet__ssm_conv_s5__prompt_kernel_pollout9:
gated_mix__spectral_gfnet__ssm_conv_s5__prompt_kernel_skip7:
  s_lshl_b32 s43, s40, 2
  s_add_u32 s43, s43, s41
  s_cmp_eq_u32 s43, 3
  s_cselect_b32 s36, 1, s41
  s_cselect_b32 s37, 64, s40
  s_and_b32 s42, s43, 0xfd
  s_cmp_eq_u32 s42, 0
  s_cselect_b32 s42, 1, 0
  v_and_b32 v15, 3, v5
  v_lshlrev_b32 v14, 6, v15
  v_lshrrev_b32 v15, 2, v5
  v_lshl_or_b32 v14, v15, 4, v14
  v_lshl_or_b32 v14, v6, 12, v14
  s_mul_i32 s44, s43, 16384
  s_lshl_b32 s45, s3, 8
  s_add_u32 s44, s44, s45
  buffer_load_dwordx4 v[104:107], v14, s[64:67], s44 offen offset:0 sc1
  buffer_load_dwordx4 v[108:111], v14, s[64:67], s44 offen offset:1024 sc1
  buffer_load_dwordx4 v[112:115], v14, s[64:67], s44 offen offset:2048 sc1
  buffer_load_dwordx4 v[116:119], v14, s[64:67], s44 offen offset:3072 sc1
  v_lshlrev_b32 v14, 4, v4
  s_lshl_b32 s44, s43, 14
  s_lshl_b32 s45, s3, 12
  s_add_u32 s44, s44, s45
  buffer_load_dwordx4 v[120:123], v14, s[68:71], s44 offen offset:0 sc1
  buffer_load_dwordx4 v[124:127], v14, s[68:71], s44 offen offset:1024 sc1
  buffer_load_dwordx4 v[128:131], v14, s[68:71], s44 offen offset:2048 sc1
  buffer_load_dwordx4 v[132:135], v14, s[68:71], s44 offen offset:3072 sc1
  s_cmp_eq_u32 s42, 0
  s_cbranch_scc1 gated_mix__spectral_gfnet__ssm_conv_s5__prompt_kernel_skip10
  s_lshl_b32 s44, s43, 9
  s_add_u32 s44, s44, 4194304
  buffer_load_dwordx4 v[136:139], v14, s[68:71], s44 offen sc1
gated_mix__spectral_gfnet__ssm_conv_s5__prompt_kernel_skip10:
  v_pk_mul_f32 v[22:23], v[32:33], v[40:41] op_sel:[1,0] op_sel_hi:[1,1]
  v_pk_mul_f32 v[40:41], v[32:33], v[40:41] op_sel:[0,0] op_sel_hi:[0,1]
  v_pk_fma_f32 v[40:41], v[32:33], v[56:57], v[40:41] op_sel:[1,0,0] op_sel_hi:[1,1,1] neg_lo:[1,0,0] neg_hi:[1,0,0]
  v_pk_fma_f32 v[56:57], v[32:33], v[56:57], v[22:23] op_sel:[0,0,0] op_sel_hi:[0,1,1]
  v_pk_mul_f32 v[20:21], v[32:33], v[42:43] op_sel:[1,0] op_sel_hi:[1,1]
  v_pk_mul_f32 v[42:43], v[32:33], v[42:43] op_sel:[0,0] op_sel_hi:[0,1]
  v_pk_fma_f32 v[42:43], v[32:33], v[58:59], v[42:43] op_sel:[1,0,0] op_sel_hi:[1,1,1] neg_lo:[1,0,0] neg_hi:[1,0,0]
  v_pk_fma_f32 v[58:59], v[32:33], v[58:59], v[20:21] op_sel:[0,0,0] op_sel_hi:[0,1,1]
  v_pk_mul_f32 v[22:23], v[32:33], v[44:45] op_sel:[1,0] op_sel_hi:[1,1]
  v_pk_mul_f32 v[44:45], v[32:33], v[44:45] op_sel:[0,0] op_sel_hi:[0,1]
  v_pk_fma_f32 v[44:45], v[32:33], v[60:61], v[44:45] op_sel:[1,0,0] op_sel_hi:[1,1,1] neg_lo:[1,0,0] neg_hi:[1,0,0]
  v_pk_fma_f32 v[60:61], v[32:33], v[60:61], v[22:23] op_sel:[0,0,0] op_sel_hi:[0,1,1]
  v_pk_mul_f32 v[20:21], v[32:33], v[46:47] op_sel:[1,0] op_sel_hi:[1,1]
  v_pk_mul_f32 v[46:47], v[32:33], v[46:47] op_sel:[0,0] op_sel_hi:[0,1]
  v_pk_fma_f32 v[46:47], v[32:33], v[62:63], v[46:47] op_sel:[1,0,0] op_sel_hi:[1,1,1] neg_lo:[1,0,0] neg_hi:[1,0,0]
  v_pk_fma_f32 v[62:63], v[32:33], v[62:63], v[20:21] op_sel:[0,0,0] op_sel_hi:[0,1,1]
  v_pk_mul_f32 v[22:23], v[32:33], v[48:49] op_sel:[1,0] op_sel_hi:[1,1]
  v_pk_mul_f32 v[48:49], v[32:33], v[48:49] op_sel:[0,0] op_sel_hi:[0,1]
  v_pk_fma_f32 v[48:49], v[32:33], v[64:65], v[48:49] op_sel:[1,0,0] op_sel_hi:[1,1,1] neg_lo:[1,0,0] neg_hi:[1,0,0]
  v_pk_fma_f32 v[64:65], v[32:33], v[64:65], v[22:23] op_sel:[0,0,0] op_sel_hi:[0,1,1]
  v_pk_mul_f32 v[20:21], v[32:33], v[50:51] op_sel:[1,0] op_sel_hi:[1,1]
  v_pk_mul_f32 v[50:51], v[32:33], v[50:51] op_sel:[0,0] op_sel_hi:[0,1]
  v_pk_fma_f32 v[50:51], v[32:33], v[66:67], v[50:51] op_sel:[1,0,0] op_sel_hi:[1,1,1] neg_lo:[1,0,0] neg_hi:[1,0,0]
  v_pk_fma_f32 v[66:67], v[32:33], v[66:67], v[20:21] op_sel:[0,0,0] op_sel_hi:[0,1,1]
  v_pk_mul_f32 v[22:23], v[32:33], v[52:53] op_sel:[1,0] op_sel_hi:[1,1]
  v_pk_mul_f32 v[52:53], v[32:33], v[52:53] op_sel:[0,0] op_sel_hi:[0,1]
  v_pk_fma_f32 v[52:53], v[32:33], v[68:69], v[52:53] op_sel:[1,0,0] op_sel_hi:[1,1,1] neg_lo:[1,0,0] neg_hi:[1,0,0]
  v_pk_fma_f32 v[68:69], v[32:33], v[68:69], v[22:23] op_sel:[0,0,0] op_sel_hi:[0,1,1]
  v_pk_mul_f32 v[20:21], v[32:33], v[54:55] op_sel:[1,0] op_sel_hi:[1,1]
  v_pk_mul_f32 v[54:55], v[32:33], v[54:55] op_sel:[0,0] op_sel_hi:[0,1]
  v_pk_fma_f32 v[54:55], v[32:33], v[70:71], v[54:55] op_sel:[1,0,0] op_sel_hi:[1,1,1] neg_lo:[1,0,0] neg_hi:[1,0,0]
  v_pk_fma_f32 v[70:71], v[32:33], v[70:71], v[20:21] op_sel:[0,0,0] op_sel_hi:[0,1,1]
  v_pk_mul_f32 v[22:23], v[32:33], v[72:73] op_sel:[1,0] op_sel_hi:[1,1]
  v_pk_mul_f32 v[72:73], v[32:33], v[72:73] op_sel:[0,0] op_sel_hi:[0,1]
  v_pk_fma_f32 v[72:73], v[32:33], v[88:89], v[72:73] op_sel:[1,0,0] op_sel_hi:[1,1,1] neg_lo:[1,0,0] neg_hi:[1,0,0]
  v_pk_fma_f32 v[88:89], v[32:33], v[88:89], v[22:23] op_sel:[0,0,0] op_sel_hi:[0,1,1]
  v_pk_mul_f32 v[20:21], v[32:33], v[74:75] op_sel:[1,0] op_sel_hi:[1,1]
  v_pk_mul_f32 v[74:75], v[32:33], v[74:75] op_sel:[0,0] op_sel_hi:[0,1]
  v_pk_fma_f32 v[74:75], v[32:33], v[90:91], v[74:75] op_sel:[1,0,0] op_sel_hi:[1,1,1] neg_lo:[1,0,0] neg_hi:[1,0,0]
  v_pk_fma_f32 v[90:91], v[32:33], v[90:91], v[20:21] op_sel:[0,0,0] op_sel_hi:[0,1,1]
  v_pk_mul_f32 v[22:23], v[32:33], v[76:77] op_sel:[1,0] op_sel_hi:[1,1]
  v_pk_mul_f32 v[76:77], v[32:33], v[76:77] op_sel:[0,0] op_sel_hi:[0,1]
  v_pk_fma_f32 v[76:77], v[32:33], v[92:93], v[76:77] op_sel:[1,0,0] op_sel_hi:[1,1,1] neg_lo:[1,0,0] neg_hi:[1,0,0]
  v_pk_fma_f32 v[92:93], v[32:33], v[92:93], v[22:23] op_sel:[0,0,0] op_sel_hi:[0,1,1]
  v_pk_mul_f32 v[20:21], v[32:33], v[78:79] op_sel:[1,0] op_sel_hi:[1,1]
  v_pk_mul_f32 v[78:79], v[32:33], v[78:79] op_sel:[0,0] op_sel_hi:[0,1]
  v_pk_fma_f32 v[78:79], v[32:33], v[94:95], v[78:79] op_sel:[1,0,0] op_sel_hi:[1,1,1] neg_lo:[1,0,0] neg_hi:[1,0,0]
  v_pk_fma_f32 v[94:95], v[32:33], v[94:95], v[20:21] op_sel:[0,0,0] op_sel_hi:[0,1,1]
  v_pk_mul_f32 v[22:23], v[32:33], v[80:81] op_sel:[1,0] op_sel_hi:[1,1]
  v_pk_mul_f32 v[80:81], v[32:33], v[80:81] op_sel:[0,0] op_sel_hi:[0,1]
  v_pk_fma_f32 v[80:81], v[32:33], v[96:97], v[80:81] op_sel:[1,0,0] op_sel_hi:[1,1,1] neg_lo:[1,0,0] neg_hi:[1,0,0]
  v_pk_fma_f32 v[96:97], v[32:33], v[96:97], v[22:23] op_sel:[0,0,0] op_sel_hi:[0,1,1]
  v_pk_mul_f32 v[20:21], v[32:33], v[82:83] op_sel:[1,0] op_sel_hi:[1,1]
  v_pk_mul_f32 v[82:83], v[32:33], v[82:83] op_sel:[0,0] op_sel_hi:[0,1]
  v_pk_fma_f32 v[82:83], v[32:33], v[98:99], v[82:83] op_sel:[1,0,0] op_sel_hi:[1,1,1] neg_lo:[1,0,0] neg_hi:[1,0,0]
  v_pk_fma_f32 v[98:99], v[32:33], v[98:99], v[20:21] op_sel:[0,0,0] op_sel_hi:[0,1,1]
  v_pk_mul_f32 v[22:23], v[32:33], v[84:85] op_sel:[1,0] op_sel_hi:[1,1]
  v_pk_mul_f32 v[84:85], v[32:33], v[84:85] op_sel:[0,0] op_sel_hi:[0,1]
  v_pk_fma_f32 v[84:85], v[32:33], v[100:101], v[84:85] op_sel:[1,0,0] op_sel_hi:[1,1,1] neg_lo:[1,0,0] neg_hi:[1,0,0]
  v_pk_fma_f32 v[100:101], v[32:33], v[100:101], v[22:23] op_sel:[0,0,0] op_sel_hi:[0,1,1]
  v_pk_mul_f32 v[20:21], v[32:33], v[86:87] op_sel:[1,0] op_sel_hi:[1,1]
  v_pk_mul_f32 v[86:87], v[32:33], v[86:87] op_sel:[0,0] op_sel_hi:[0,1]
  v_pk_fma_f32 v[86:87], v[32:33], v[102:103], v[86:87] op_sel:[1,0,0] op_sel_hi:[1,1,1] neg_lo:[1,0,0] neg_hi:[1,0,0]
  v_pk_fma_f32 v[102:103], v[32:33], v[102:103], v[20:21] op_sel:[0,0,0] op_sel_hi:[0,1,1]
  s_lshl_b32 s45, s38, 1
  s_lshr_b32 s46, s3, 1
  s_add_u32 s45, s45, s46
  s_lshl_b32 s44, s45, 9
  s_and_b32 s45, s45, 3
  s_lshl_b32 s45, s45, 2
  v_xor_b32 v14, s45, v5
  v_lshlrev_b32 v14, 4, v14
  v_lshrrev_b32 v15, 1, v6
  v_lshl_or_b32 v14, v15, 14, v14
  v_and_b32 v15, 1, v6
  v_lshl_or_b32 v14, v15, 19, v14
  s_and_b32 s46, s3, 1
  s_lshl_b32 s46, s46, 8
  s_add_u32 s44, s44, s46
  s_lshl_b32 s46, s39, 15
  s_add_u32 s44, s44, s46
  v_cvt_f32_u32 v19, v5
  v_cvt_f32_u32 v20, v6
  v_mul_f32 v20, 4.0, v20
  v_cvt_f32_u32 v37, s36
  v_cvt_f32_u32 v38, s37
  v_cvt_f32_u32 v39, s42
  v_mul_f32 v39, 0xc4700000, v39
  v_cmp_lt_u32 vcc, 7, v5
  s_nop 1
  v_cndmask_b32 v23, 0, v39, vcc
  v_add_f32 v23, v23, v38
  v_fmamk_f32 v21, v19, 0x43000000, v23
  v_mul_f32 v21, 0x3a000000, v21
  v_mul_f32 v22, v21, v20
  v_fmamk_f32 v15, v21, 0x0, v22
  v_cos_f32 v17, v15
  v_sin_f32 v18, v15
  s_nop 0
  v_cvt_pk_bf16_f32 v140, v17, v18
  v_cvt_pk_bf16_f32 v144, -v18, v17
  v_fmamk_f32 v15, v21, 0x3f800000, v22
  v_cos_f32 v17, v15
  v_sin_f32 v18, v15
  s_nop 0
  v_cvt_pk_bf16_f32 v141, v17, v18
  v_cvt_pk_bf16_f32 v145, -v18, v17
  v_fmamk_f32 v15, v21, 0x40000000, v22
  v_cos_f32 v17, v15
  v_sin_f32 v18, v15
  s_nop 0
  v_cvt_pk_bf16_f32 v142, v17, v18
  v_cvt_pk_bf16_f32 v146, -v18, v17
  v_fmamk_f32 v15, v21, 0x40400000, v22
  v_cos_f32 v17, v15
  v_sin_f32 v18, v15
  s_nop 0
  v_cvt_pk_bf16_f32 v143, v17, v18
  v_cvt_pk_bf16_f32 v147, -v18, v17
  v_cmp_lt_u32 vcc, 1, v6
  s_nop 1
  v_cndmask_b32 v23, 0, v39, vcc
  v_add_f32 v23, v23, v38
  v_fmamk_f32 v23, v20, 0x43000000, v23
  v_mul_f32 v22, v23, v19
  v_mul_f32 v22, 0x3a000000, v22
  v_mul_f32 v21, 0x3d800000, v19
  v_fmamk_f32 v15, v21, 0x0, v22
  v_cos_f32 v17, v15
  v_sin_f32 v18, v15
  s_nop 0
  v_cvt_pk_bf16_f32 v148, v17, -v18
  v_cvt_pk_bf16_f32 v152, v18, v17
  v_fmamk_f32 v15, v21, 0x3f800000, v22
  v_cos_f32 v17, v15
  v_sin_f32 v18, v15
  s_nop 0
  v_cvt_pk_bf16_f32 v149, v17, -v18
  v_cvt_pk_bf16_f32 v153, v18, v17
  v_fmamk_f32 v15, v21, 0x40000000, v22
  v_cos_f32 v17, v15
  v_sin_f32 v18, v15
  s_nop 0
  v_cvt_pk_bf16_f32 v150, v17, -v18
  v_cvt_pk_bf16_f32 v154, v18, v17
  v_fmamk_f32 v15, v21, 0x40400000, v22
  v_cos_f32 v17, v15
  v_sin_f32 v18, v15
  s_nop 0
  v_cvt_pk_bf16_f32 v151, v17, -v18
  v_cvt_pk_bf16_f32 v155, v18, v17
  s_cmp_eq_u32 s42, 0
  s_cbranch_scc1 gated_mix__spectral_gfnet__ssm_conv_s5__prompt_kernel_skip11
  v_cmp_lt_u32 vcc, 7, v5
  s_nop 1
  v_cndmask_b32 v15, 0, 16, vcc
  v_and_b32 v140, 0xffff, v140
  v_lshlrev_b32 v140, v15, v140
  v_and_b32 v141, 0xffff, v141
  v_lshlrev_b32 v141, v15, v141
  v_and_b32 v142, 0xffff, v142
  v_lshlrev_b32 v142, v15, v142
  v_and_b32 v143, 0xffff, v143
  v_lshlrev_b32 v143, v15, v143
  v_and_b32 v144, 0xffff, v144
  v_lshlrev_b32 v144, v15, v144
  v_and_b32 v145, 0xffff, v145
  v_lshlrev_b32 v145, v15, v145
  v_and_b32 v146, 0xffff, v146
  v_lshlrev_b32 v146, v15, v146
  v_and_b32 v147, 0xffff, v147
  v_lshlrev_b32 v147, v15, v147
  v_cmp_eq_u32 vcc, 0, v5
  v_mov_b32 v17, 0x3f80
  s_nop 0
  v_cndmask_b32 v144, v144, v17, vcc
  v_mov_b32 v17, 0xbf80
  v_cndmask_b32 v145, v145, v17, vcc
  v_mov_b32 v17, 0x3f80
  v_cndmask_b32 v146, v146, v17, vcc
  v_mov_b32 v17, 0xbf80
  v_cndmask_b32 v147, v147, v17, vcc
  v_cmp_lt_u32 vcc, 1, v6
  v_lshlrev_b32 v17, 16, v148
  v_and_b32 v18, 0xffff0000, v148
  v_add_f32 v17, v17, v17
  v_add_f32 v18, v18, v18
  v_cvt_pk_bf16_f32 v17, v17, v18
  v_cndmask_b32 v148, v17, 0, vcc
  v_cndmask_b32 v152, 0, v17, vcc
  v_lshlrev_b32 v17, 16, v149
  v_and_b32 v18, 0xffff0000, v149
  v_add_f32 v17, v17, v17
  v_add_f32 v18, v18, v18
  v_cvt_pk_bf16_f32 v17, v17, v18
  v_cndmask_b32 v149, v17, 0, vcc
  v_cndmask_b32 v153, 0, v17, vcc
  v_lshlrev_b32 v17, 16, v150
  v_and_b32 v18, 0xffff0000, v150
  v_add_f32 v17, v17, v17
  v_add_f32 v18, v18, v18
  v_cvt_pk_bf16_f32 v17, v17, v18
  v_cndmask_b32 v150, v17, 0, vcc
  v_cndmask_b32 v154, 0, v17, vcc
  v_lshlrev_b32 v17, 16, v151
  v_and_b32 v18, 0xffff0000, v151
  v_add_f32 v17, v17, v17
  v_add_f32 v18, v18, v18
  v_cvt_pk_bf16_f32 v17, v17, v18
  v_cndmask_b32 v151, v17, 0, vcc
  v_cndmask_b32 v155, 0, v17, vcc
  v_lshlrev_b32 v17, 31, v5
  v_or_b32 v17, 0x3f803f80, v17
  v_cmp_eq_u32 vcc, 0, v6
  s_nop 1
  v_cndmask_b32 v148, v148, v17, vcc
gated_mix__spectral_gfnet__ssm_conv_s5__prompt_kernel_skip11:
  v_fma_f32 v23, v19, 4.0, v37
  v_mul_f32 v21, 0x3c800000, v23
  v_mul_f32 v22, v21, v20
  v_fmamk_f32 v15, v21, 0x0, v22
  v_cos_f32 v17, v15
  v_sin_f32 v18, v15
  s_nop 0
  v_cvt_pk_bf16_f32 v156, v17, v18
  v_cvt_pk_bf16_f32 v160, -v18, v17
  v_fmamk_f32 v15, v21, 0x3f800000, v22
  v_cos_f32 v17, v15
  v_sin_f32 v18, v15
  s_nop 0
  v_cvt_pk_bf16_f32 v157, v17, v18
  v_cvt_pk_bf16_f32 v161, -v18, v17
  v_fmamk_f32 v15, v21, 0x40000000, v22
  v_cos_f32 v17, v15
  v_sin_f32 v18, v15
  s_nop 0
  v_cvt_pk_bf16_f32 v158, v17, v18
  v_cvt_pk_bf16_f32 v162, -v18, v17
  v_fmamk_f32 v15, v21, 0x40400000, v22
  v_cos_f32 v17, v15
  v_sin_f32 v18, v15
  s_nop 0
  v_cvt_pk_bf16_f32 v159, v17, v18
  v_cvt_pk_bf16_f32 v163, -v18, v17
  v_mul_f32 v21, 0x3d800000, v21
  v_mul_f32 v22, 0x3d800000, v22
  v_fmamk_f32 v15, v21, 0x0, v22
  v_cos_f32 v164, v15
  v_sin_f32 v168, v15
  v_fmamk_f32 v15, v21, 0x3f800000, v22
  v_cos_f32 v165, v15
  v_sin_f32 v169, v15
  v_fmamk_f32 v15, v21, 0x40000000, v22
  v_cos_f32 v166, v15
  v_sin_f32 v170, v15
  v_fmamk_f32 v15, v21, 0x40400000, v22
  v_cos_f32 v167, v15
  v_sin_f32 v171, v15
  v_fma_f32 v23, v20, 4.0, v37
  v_mul_f32 v22, v23, v19
  v_mul_f32 v22, 0x3c800000, v22
  v_mul_f32 v21, 0x3d800000, v19
  v_fmamk_f32 v15, v21, 0x0, v22
  v_cos_f32 v17, v15
  v_sin_f32 v18, v15
  s_nop 0
  v_cvt_pk_bf16_f32 v172, v17, -v18
  v_cvt_pk_bf16_f32 v176, v18, v17
  v_fmamk_f32 v15, v21, 0x3f800000, v22
  v_cos_f32 v17, v15
  v_sin_f32 v18, v15
  s_nop 0
  v_cvt_pk_bf16_f32 v173, v17, -v18
  v_cvt_pk_bf16_f32 v177, v18, v17
  v_fmamk_f32 v15, v21, 0x40000000, v22
  v_cos_f32 v17, v15
  v_sin_f32 v18, v15
  s_nop 0
  v_cvt_pk_bf16_f32 v174, v17, -v18
  v_cvt_pk_bf16_f32 v178, v18, v17
  v_fmamk_f32 v15, v21, 0x40400000, v22
  v_cos_f32 v17, v15
  v_sin_f32 v18, v15
  s_nop 0
  v_cvt_pk_bf16_f32 v175, v17, -v18
  v_cvt_pk_bf16_f32 v179, v18, v17
  v_mul_f32 v21, 0x3d800000, v21
  v_mul_f32 v22, 0x3d800000, v22
  v_fmamk_f32 v15, v21, 0x0, v22
  v_cos_f32 v180, v15
  v_sin_f32 v184, v15
  v_fmamk_f32 v15, v21, 0x3f800000, v22
  v_cos_f32 v181, v15
  v_sin_f32 v185, v15
  v_fmamk_f32 v15, v21, 0x40000000, v22
  v_cos_f32 v182, v15
  v_sin_f32 v186, v15
  v_fmamk_f32 v15, v21, 0x40400000, v22
  v_cos_f32 v183, v15
  v_sin_f32 v187, v15
  v_xor_b32 v23, 3, v5
  v_cmp_lt_u32 vcc, 7, v5
  s_nop 1
  v_cndmask_b32 v23, v5, v23, vcc
  v_cvt_f32_u32 v21, v23
  v_mul_f32 v21, 0x3d800000, v21
  v_mul_f32 v22, v21, v20
  v_fmamk_f32 v15, v21, 0x0, v22
  v_cos_f32 v17, v15
  v_sin_f32 v18, v15
  s_nop 0
  v_cvt_pk_bf16_f32 v188, v17, v18
  v_cvt_pk_bf16_f32 v192, -v18, v17
  v_fmamk_f32 v15, v21, 0x3f800000, v22
  v_cos_f32 v17, v15
  v_sin_f32 v18, v15
  s_nop 0
  v_cvt_pk_bf16_f32 v189, v17, v18
  v_cvt_pk_bf16_f32 v193, -v18, v17
  v_fmamk_f32 v15, v21, 0x40000000, v22
  v_cos_f32 v17, v15
  v_sin_f32 v18, v15
  s_nop 0
  v_cvt_pk_bf16_f32 v190, v17, v18
  v_cvt_pk_bf16_f32 v194, -v18, v17
  v_fmamk_f32 v15, v21, 0x40400000, v22
  v_cos_f32 v17, v15
  v_sin_f32 v18, v15
  s_nop 0
  v_cvt_pk_bf16_f32 v191, v17, v18
  v_cvt_pk_bf16_f32 v195, -v18, v17
  v_mul_f32 v21, 0x3d800000, v19
  v_add_f32 v23, 0x40400000, v20
  v_cmp_lt_u32 vcc, 1, v6
  s_nop 1
  v_cndmask_b32 v23, v20, v23, vcc
  v_mul_f32 v22, v21, v23
  v_cndmask_b32 v21, v21, -v21, vcc
  v_fmamk_f32 v15, v21, 0x0, v22
  v_cos_f32 v17, v15
  v_sin_f32 v18, v15
  s_nop 0
  v_cvt_pk_bf16_f32 v196, v17, -v18
  v_cvt_pk_bf16_f32 v200, v18, v17
  v_fmamk_f32 v15, v21, 0x3f800000, v22
  v_cos_f32 v17, v15
  v_sin_f32 v18, v15
  s_nop 0
  v_cvt_pk_bf16_f32 v197, v17, -v18
  v_cvt_pk_bf16_f32 v201, v18, v17
  v_fmamk_f32 v15, v21, 0x40000000, v22
  v_cos_f32 v17, v15
  v_sin_f32 v18, v15
  s_nop 0
  v_cvt_pk_bf16_f32 v198, v17, -v18
  v_cvt_pk_bf16_f32 v202, v18, v17
  v_fmamk_f32 v15, v21, 0x40400000, v22
  v_cos_f32 v17, v15
  v_sin_f32 v18, v15
  s_nop 0
  v_cvt_pk_bf16_f32 v199, v17, -v18
  v_cvt_pk_bf16_f32 v203, v18, v17
  v_add_u32 v17, 4096, v16
  s_mov_b32 s45, 0
gated_mix__spectral_gfnet__ssm_conv_s5__prompt_kernel_lb12:
  buffer_load_dwordx2 v[204:205], v16, s[60:63], 0 offen offset:0 sc1
  buffer_load_dwordx2 v[206:207], v16, s[60:63], 0 offen offset:512 sc1
  buffer_load_dwordx2 v[208:209], v16, s[60:63], 0 offen offset:1024 sc1
  buffer_load_dwordx2 v[210:211], v16, s[60:63], 0 offen offset:1536 sc1
  buffer_load_dwordx2 v[212:213], v16, s[60:63], 0 offen offset:2048 sc1
  buffer_load_dwordx2 v[214:215], v16, s[60:63], 0 offen offset:2560 sc1
  buffer_load_dwordx2 v[216:217], v16, s[60:63], 0 offen offset:3072 sc1
  buffer_load_dwordx2 v[218:219], v16, s[60:63], 0 offen offset:3584 sc1
  buffer_load_dwordx2 v[220:221], v17, s[60:63], 0 offen offset:0 sc1
  buffer_load_dwordx2 v[222:223], v17, s[60:63], 0 offen offset:512 sc1
  buffer_load_dwordx2 v[224:225], v17, s[60:63], 0 offen offset:1024 sc1
  buffer_load_dwordx2 v[226:227], v17, s[60:63], 0 offen offset:1536 sc1
  buffer_load_dwordx2 v[228:229], v17, s[60:63], 0 offen offset:2048 sc1
  buffer_load_dwordx2 v[230:231], v17, s[60:63], 0 offen offset:2560 sc1
  buffer_load_dwordx2 v[232:233], v17, s[60:63], 0 offen offset:3072 sc1
  buffer_load_dwordx2 v[234:235], v17, s[60:63], 0 offen offset:3584 sc1
  s_waitcnt vmcnt(15)
  v_max_u32 v15, v204, v205
  s_waitcnt vmcnt(14)
  v_max3_u32 v15, v15, v206, v207
  s_waitcnt vmcnt(13)
  v_max3_u32 v15, v15, v208, v209
  s_waitcnt vmcnt(12)
  v_max3_u32 v15, v15, v210, v211
  s_waitcnt vmcnt(11)
  v_max3_u32 v15, v15, v212, v213
  s_waitcnt vmcnt(10)
  v_max3_u32 v15, v15, v214, v215
  s_waitcnt vmcnt(9)
  v_max3_u32 v15, v15, v216, v217
  s_waitcnt vmcnt(8)
  v_max3_u32 v15, v15, v218, v219
  s_waitcnt vmcnt(7)
  v_max3_u32 v15, v15, v220, v221
  s_waitcnt vmcnt(6)
  v_max3_u32 v15, v15, v222, v223
  s_waitcnt vmcnt(5)
  v_max3_u32 v15, v15, v224, v225
  s_waitcnt vmcnt(4)
  v_max3_u32 v15, v15, v226, v227
  s_waitcnt vmcnt(3)
  v_max3_u32 v15, v15, v228, v229
  s_waitcnt vmcnt(2)
  v_max3_u32 v15, v15, v230, v231
  s_waitcnt vmcnt(1)
  v_max3_u32 v15, v15, v232, v233
  s_waitcnt vmcnt(0)
  v_max3_u32 v15, v15, v234, v235
  v_cmp_eq_u32 vcc, -1, v15
  s_nop 0
  s_cbranch_vccz gated_mix__spectral_gfnet__ssm_conv_s5__prompt_kernel_lbdone13
  s_add_u32 s45, s45, 1
  s_cmp_lt_u32 s45, 1048576
  s_cbranch_scc1 gated_mix__spectral_gfnet__ssm_conv_s5__prompt_kernel_lb12
gated_mix__spectral_gfnet__ssm_conv_s5__prompt_kernel_lbdone13:
  s_add_u32 s56, s34, 10485760
  s_addc_u32 s57, s35, 0
  s_mov_b32 s58, 8388608
  s_mov_b32 s59, 0x20000
  v_fma_f32 v232, v28, v234, v232
  v_fma_f32 v233, v28, v235, v233
  v_fma_f32 v232, -v29, v235, v232
  v_fma_f32 v233, v29, v234, v233
  v_fma_f32 v230, v28, v232, v230
  v_fma_f32 v231, v28, v233, v231
  v_fma_f32 v230, -v29, v233, v230
  v_fma_f32 v231, v29, v232, v231
  v_fma_f32 v228, v28, v230, v228
  v_fma_f32 v229, v28, v231, v229
  v_fma_f32 v228, -v29, v231, v228
  v_fma_f32 v229, v29, v230, v229
  v_fma_f32 v226, v28, v228, v226
  v_fma_f32 v227, v28, v229, v227
  v_fma_f32 v226, -v29, v229, v226
  v_fma_f32 v227, v29, v228, v227
  v_fma_f32 v224, v28, v226, v224
  v_fma_f32 v225, v28, v227, v225
  v_fma_f32 v224, -v29, v227, v224
  v_fma_f32 v225, v29, v226, v225
  v_fma_f32 v222, v28, v224, v222
  v_fma_f32 v223, v28, v225, v223
  v_fma_f32 v222, -v29, v225, v222
  v_fma_f32 v223, v29, v224, v223
  v_fma_f32 v220, v28, v222, v220
  v_fma_f32 v221, v28, v223, v221
  v_fma_f32 v220, -v29, v223, v220
  v_fma_f32 v221, v29, v222, v221
  v_fma_f32 v218, v28, v220, v218
  v_fma_f32 v219, v28, v221, v219
  v_fma_f32 v218, -v29, v221, v218
  v_fma_f32 v219, v29, v220, v219
  v_fma_f32 v216, v28, v218, v216
  v_fma_f32 v217, v28, v219, v217
  v_fma_f32 v216, -v29, v219, v216
  v_fma_f32 v217, v29, v218, v217
  v_fma_f32 v214, v28, v216, v214
  v_fma_f32 v215, v28, v217, v215
  v_fma_f32 v214, -v29, v217, v214
  v_fma_f32 v215, v29, v216, v215
  v_fma_f32 v212, v28, v214, v212
  v_fma_f32 v213, v28, v215, v213
  v_fma_f32 v212, -v29, v215, v212
  v_fma_f32 v213, v29, v214, v213
  v_fma_f32 v210, v28, v212, v210
  v_fma_f32 v211, v28, v213, v211
  v_fma_f32 v210, -v29, v213, v210
  v_fma_f32 v211, v29, v212, v211
  v_fma_f32 v208, v28, v210, v208
  v_fma_f32 v209, v28, v211, v209
  v_fma_f32 v208, -v29, v211, v208
  v_fma_f32 v209, v29, v210, v209
  v_fma_f32 v206, v28, v208, v206
  v_fma_f32 v207, v28, v209, v207
  v_fma_f32 v206, -v29, v209, v206
  v_fma_f32 v207, v29, v208, v207
  v_fma_f32 v204, v28, v206, v204
  v_fma_f32 v205, v28, v207, v205
  v_fma_f32 v204, -v29, v207, v204
  v_fma_f32 v205, v29, v206, v205
  v_mov_b32 v206, v204
  v_mov_b32 v207, v205
  s_nop 0
  v_permlane32_swap_b32 v204, v206
  v_permlane32_swap_b32 v205, v207
  v_fma_f32 v204, v30, v206, v204
  v_fma_f32 v205, v30, v207, v205
  v_fma_f32 v204, -v31, v207, v204
  v_fma_f32 v205, v31, v206, v205
  v_fma_f32 v12, v26, v204, v12
  v_fma_f32 v13, v26, v205, v13
  v_fma_f32 v12, -v27, v205, v12
  v_fma_f32 v13, v27, v204, v13
  s_mov_b32 exec_lo, 0
  v_mov_b32 v204, v12
  v_mov_b32 v205, v13
  s_mov_b64 exec, -1
  v_fma_f32 v8, v24, v204, v8
  v_fma_f32 v10, v24, v205, v10
  v_fma_f32 v8, -v25, v205, v8
  v_fma_f32 v10, v25, v204, v10
  v_mul_f32 v208, v32, v204
  v_mul_f32 v210, v32, v205
  v_fma_f32 v208, -v33, v205, v208
  v_fma_f32 v210, v33, v204, v210
  v_mul_f32 v209, v32, v8
  v_mul_f32 v211, v32, v10
  v_fma_f32 v209, -v33, v10, v209
  v_fma_f32 v211, v33, v8, v211
  v_pk_fma_f32 v[40:41], v[2:3], v[208:209], v[40:41] op_sel:[0,0,0] op_sel_hi:[0,1,1]
  v_pk_fma_f32 v[56:57], v[2:3], v[210:211], v[56:57] op_sel:[0,0,0] op_sel_hi:[0,1,1]
  v_pk_fma_f32 v[40:41], v[2:3], v[210:211], v[40:41] op_sel:[1,0,0] op_sel_hi:[1,1,1] neg_lo:[1,0,0] neg_hi:[1,0,0]
  v_pk_fma_f32 v[56:57], v[2:3], v[208:209], v[56:57] op_sel:[1,0,0] op_sel_hi:[1,1,1]
  v_cvt_pk_bf16_f32 v212, v40, v41
  v_cvt_pk_bf16_f32 v213, -v56, -v57
  v_pk_fma_f32 v[42:43], v[2:3], v[40:41], v[42:43] op_sel:[0,0,0] op_sel_hi:[0,1,1]
  v_pk_fma_f32 v[58:59], v[2:3], v[56:57], v[58:59] op_sel:[0,0,0] op_sel_hi:[0,1,1]
  v_pk_fma_f32 v[42:43], v[2:3], v[56:57], v[42:43] op_sel:[1,0,0] op_sel_hi:[1,1,1] neg_lo:[1,0,0] neg_hi:[1,0,0]
  v_pk_fma_f32 v[58:59], v[2:3], v[40:41], v[58:59] op_sel:[1,0,0] op_sel_hi:[1,1,1]
  v_cvt_pk_bf16_f32 v214, v42, v43
  v_cvt_pk_bf16_f32 v215, -v58, -v59
  v_pk_fma_f32 v[44:45], v[2:3], v[42:43], v[44:45] op_sel:[0,0,0] op_sel_hi:[0,1,1]
  v_pk_fma_f32 v[60:61], v[2:3], v[58:59], v[60:61] op_sel:[0,0,0] op_sel_hi:[0,1,1]
  v_pk_fma_f32 v[44:45], v[2:3], v[58:59], v[44:45] op_sel:[1,0,0] op_sel_hi:[1,1,1] neg_lo:[1,0,0] neg_hi:[1,0,0]
  v_pk_fma_f32 v[60:61], v[2:3], v[42:43], v[60:61] op_sel:[1,0,0] op_sel_hi:[1,1,1]
  v_permlane32_swap_b32 v212, v213
  v_permlane32_swap_b32 v214, v215
  s_nop 1
  v_permlane16_swap_b32 v212, v214
  v_permlane16_swap_b32 v213, v215
  buffer_store_dwordx4 v[212:215], v14, s[56:59], s44 offen sc1
  s_add_u32 s44, s44, 1048576
  v_cvt_pk_bf16_f32 v216, v44, v45
  v_cvt_pk_bf16_f32 v217, -v60, -v61
  v_pk_fma_f32 v[46:47], v[2:3], v[44:45], v[46:47] op_sel:[0,0,0] op_sel_hi:[0,1,1]
  v_pk_fma_f32 v[62:63], v[2:3], v[60:61], v[62:63] op_sel:[0,0,0] op_sel_hi:[0,1,1]
  v_pk_fma_f32 v[46:47], v[2:3], v[60:61], v[46:47] op_sel:[1,0,0] op_sel_hi:[1,1,1] neg_lo:[1,0,0] neg_hi:[1,0,0]
  v_pk_fma_f32 v[62:63], v[2:3], v[44:45], v[62:63] op_sel:[1,0,0] op_sel_hi:[1,1,1]
  v_cvt_pk_bf16_f32 v218, v46, v47
  v_cvt_pk_bf16_f32 v219, -v62, -v63
  v_pk_fma_f32 v[48:49], v[2:3], v[46:47], v[48:49] op_sel:[0,0,0] op_sel_hi:[0,1,1]
  v_pk_fma_f32 v[64:65], v[2:3], v[62:63], v[64:65] op_sel:[0,0,0] op_sel_hi:[0,1,1]
  v_pk_fma_f32 v[48:49], v[2:3], v[62:63], v[48:49] op_sel:[1,0,0] op_sel_hi:[1,1,1] neg_lo:[1,0,0] neg_hi:[1,0,0]
  v_pk_fma_f32 v[64:65], v[2:3], v[46:47], v[64:65] op_sel:[1,0,0] op_sel_hi:[1,1,1]
  v_permlane32_swap_b32 v216, v217
  v_permlane32_swap_b32 v218, v219
  s_nop 1
  v_permlane16_swap_b32 v216, v218
  v_permlane16_swap_b32 v217, v219
  buffer_store_dwordx4 v[216:219], v14, s[56:59], s44 offen sc1
  s_add_u32 s44, s44, 1048576
  v_cvt_pk_bf16_f32 v220, v48, v49
  v_cvt_pk_bf16_f32 v221, -v64, -v65
  v_pk_fma_f32 v[50:51], v[2:3], v[48:49], v[50:51] op_sel:[0,0,0] op_sel_hi:[0,1,1]
  v_pk_fma_f32 v[66:67], v[2:3], v[64:65], v[66:67] op_sel:[0,0,0] op_sel_hi:[0,1,1]
  v_pk_fma_f32 v[50:51], v[2:3], v[64:65], v[50:51] op_sel:[1,0,0] op_sel_hi:[1,1,1] neg_lo:[1,0,0] neg_hi:[1,0,0]
  v_pk_fma_f32 v[66:67], v[2:3], v[48:49], v[66:67] op_sel:[1,0,0] op_sel_hi:[1,1,1]
  v_cvt_pk_bf16_f32 v222, v50, v51
  v_cvt_pk_bf16_f32 v223, -v66, -v67
  v_pk_fma_f32 v[52:53], v[2:3], v[50:51], v[52:53] op_sel:[0,0,0] op_sel_hi:[0,1,1]
  v_pk_fma_f32 v[68:69], v[2:3], v[66:67], v[68:69] op_sel:[0,0,0] op_sel_hi:[0,1,1]
  v_pk_fma_f32 v[52:53], v[2:3], v[66:67], v[52:53] op_sel:[1,0,0] op_sel_hi:[1,1,1] neg_lo:[1,0,0] neg_hi:[1,0,0]
  v_pk_fma_f32 v[68:69], v[2:3], v[50:51], v[68:69] op_sel:[1,0,0] op_sel_hi:[1,1,1]
  v_permlane32_swap_b32 v220, v221
  v_permlane32_swap_b32 v222, v223
  s_nop 1
  v_permlane16_swap_b32 v220, v222
  v_permlane16_swap_b32 v221, v223
  buffer_store_dwordx4 v[220:223], v14, s[56:59], s44 offen sc1
  s_add_u32 s44, s44, 1048576
  v_cvt_pk_bf16_f32 v224, v52, v53
  v_cvt_pk_bf16_f32 v225, -v68, -v69
  v_pk_fma_f32 v[54:55], v[2:3], v[52:53], v[54:55] op_sel:[0,0,0] op_sel_hi:[0,1,1]
  v_pk_fma_f32 v[70:71], v[2:3], v[68:69], v[70:71] op_sel:[0,0,0] op_sel_hi:[0,1,1]
  v_pk_fma_f32 v[54:55], v[2:3], v[68:69], v[54:55] op_sel:[1,0,0] op_sel_hi:[1,1,1] neg_lo:[1,0,0] neg_hi:[1,0,0]
  v_pk_fma_f32 v[70:71], v[2:3], v[52:53], v[70:71] op_sel:[1,0,0] op_sel_hi:[1,1,1]
  v_cvt_pk_bf16_f32 v226, v54, v55
  v_cvt_pk_bf16_f32 v227, -v70, -v71
  v_pk_fma_f32 v[72:73], v[2:3], v[54:55], v[72:73] op_sel:[0,0,0] op_sel_hi:[0,1,1]
  v_pk_fma_f32 v[88:89], v[2:3], v[70:71], v[88:89] op_sel:[0,0,0] op_sel_hi:[0,1,1]
  v_pk_fma_f32 v[72:73], v[2:3], v[70:71], v[72:73] op_sel:[1,0,0] op_sel_hi:[1,1,1] neg_lo:[1,0,0] neg_hi:[1,0,0]
  v_pk_fma_f32 v[88:89], v[2:3], v[54:55], v[88:89] op_sel:[1,0,0] op_sel_hi:[1,1,1]
  v_permlane32_swap_b32 v224, v225
  v_permlane32_swap_b32 v226, v227
  s_nop 1
  v_permlane16_swap_b32 v224, v226
  v_permlane16_swap_b32 v225, v227
  buffer_store_dwordx4 v[224:227], v14, s[56:59], s44 offen sc1
  s_add_u32 s44, s44, 1048576
  v_cvt_pk_bf16_f32 v228, v72, v73
  v_cvt_pk_bf16_f32 v229, -v88, -v89
  v_pk_fma_f32 v[74:75], v[2:3], v[72:73], v[74:75] op_sel:[0,0,0] op_sel_hi:[0,1,1]
  v_pk_fma_f32 v[90:91], v[2:3], v[88:89], v[90:91] op_sel:[0,0,0] op_sel_hi:[0,1,1]
  v_pk_fma_f32 v[74:75], v[2:3], v[88:89], v[74:75] op_sel:[1,0,0] op_sel_hi:[1,1,1] neg_lo:[1,0,0] neg_hi:[1,0,0]
  v_pk_fma_f32 v[90:91], v[2:3], v[72:73], v[90:91] op_sel:[1,0,0] op_sel_hi:[1,1,1]
  v_cvt_pk_bf16_f32 v230, v74, v75
  v_cvt_pk_bf16_f32 v231, -v90, -v91
  v_pk_fma_f32 v[76:77], v[2:3], v[74:75], v[76:77] op_sel:[0,0,0] op_sel_hi:[0,1,1]
  v_pk_fma_f32 v[92:93], v[2:3], v[90:91], v[92:93] op_sel:[0,0,0] op_sel_hi:[0,1,1]
  v_pk_fma_f32 v[76:77], v[2:3], v[90:91], v[76:77] op_sel:[1,0,0] op_sel_hi:[1,1,1] neg_lo:[1,0,0] neg_hi:[1,0,0]
  v_pk_fma_f32 v[92:93], v[2:3], v[74:75], v[92:93] op_sel:[1,0,0] op_sel_hi:[1,1,1]
  v_permlane32_swap_b32 v228, v229
  v_permlane32_swap_b32 v230, v231
  s_nop 1
  v_permlane16_swap_b32 v228, v230
  v_permlane16_swap_b32 v229, v231
  buffer_store_dwordx4 v[228:231], v14, s[56:59], s44 offen sc1
  s_add_u32 s44, s44, 1048576
  v_cvt_pk_bf16_f32 v232, v76, v77
  v_cvt_pk_bf16_f32 v233, -v92, -v93
  v_pk_fma_f32 v[78:79], v[2:3], v[76:77], v[78:79] op_sel:[0,0,0] op_sel_hi:[0,1,1]
  v_pk_fma_f32 v[94:95], v[2:3], v[92:93], v[94:95] op_sel:[0,0,0] op_sel_hi:[0,1,1]
  v_pk_fma_f32 v[78:79], v[2:3], v[92:93], v[78:79] op_sel:[1,0,0] op_sel_hi:[1,1,1] neg_lo:[1,0,0] neg_hi:[1,0,0]
  v_pk_fma_f32 v[94:95], v[2:3], v[76:77], v[94:95] op_sel:[1,0,0] op_sel_hi:[1,1,1]
  v_cvt_pk_bf16_f32 v234, v78, v79
  v_cvt_pk_bf16_f32 v235, -v94, -v95
  v_pk_fma_f32 v[80:81], v[2:3], v[78:79], v[80:81] op_sel:[0,0,0] op_sel_hi:[0,1,1]
  v_pk_fma_f32 v[96:97], v[2:3], v[94:95], v[96:97] op_sel:[0,0,0] op_sel_hi:[0,1,1]
  v_pk_fma_f32 v[80:81], v[2:3], v[94:95], v[80:81] op_sel:[1,0,0] op_sel_hi:[1,1,1] neg_lo:[1,0,0] neg_hi:[1,0,0]
  v_pk_fma_f32 v[96:97], v[2:3], v[78:79], v[96:97] op_sel:[1,0,0] op_sel_hi:[1,1,1]
  v_permlane32_swap_b32 v232, v233
  v_permlane32_swap_b32 v234, v235
  s_nop 1
  v_permlane16_swap_b32 v232, v234
  v_permlane16_swap_b32 v233, v235
  buffer_store_dwordx4 v[232:235], v14, s[56:59], s44 offen sc1
  s_add_u32 s44, s44, 1048576
  v_cvt_pk_bf16_f32 v212, v80, v81
  v_cvt_pk_bf16_f32 v213, -v96, -v97
  v_pk_fma_f32 v[82:83], v[2:3], v[80:81], v[82:83] op_sel:[0,0,0] op_sel_hi:[0,1,1]
  v_pk_fma_f32 v[98:99], v[2:3], v[96:97], v[98:99] op_sel:[0,0,0] op_sel_hi:[0,1,1]
  v_pk_fma_f32 v[82:83], v[2:3], v[96:97], v[82:83] op_sel:[1,0,0] op_sel_hi:[1,1,1] neg_lo:[1,0,0] neg_hi:[1,0,0]
  v_pk_fma_f32 v[98:99], v[2:3], v[80:81], v[98:99] op_sel:[1,0,0] op_sel_hi:[1,1,1]
  v_cvt_pk_bf16_f32 v214, v82, v83
  v_cvt_pk_bf16_f32 v215, -v98, -v99
  v_pk_fma_f32 v[84:85], v[2:3], v[82:83], v[84:85] op_sel:[0,0,0] op_sel_hi:[0,1,1]
  v_pk_fma_f32 v[100:101], v[2:3], v[98:99], v[100:101] op_sel:[0,0,0] op_sel_hi:[0,1,1]
  v_pk_fma_f32 v[84:85], v[2:3], v[98:99], v[84:85] op_sel:[1,0,0] op_sel_hi:[1,1,1] neg_lo:[1,0,0] neg_hi:[1,0,0]
  v_pk_fma_f32 v[100:101], v[2:3], v[82:83], v[100:101] op_sel:[1,0,0] op_sel_hi:[1,1,1]
  v_permlane32_swap_b32 v212, v213
  v_permlane32_swap_b32 v214, v215
  s_nop 1
  v_permlane16_swap_b32 v212, v214
  v_permlane16_swap_b32 v213, v215
  buffer_store_dwordx4 v[212:215], v14, s[56:59], s44 offen sc1
  s_add_u32 s44, s44, 1048576
  v_cvt_pk_bf16_f32 v216, v84, v85
  v_cvt_pk_bf16_f32 v217, -v100, -v101
  v_pk_fma_f32 v[86:87], v[2:3], v[84:85], v[86:87] op_sel:[0,0,0] op_sel_hi:[0,1,1]
  v_pk_fma_f32 v[102:103], v[2:3], v[100:101], v[102:103] op_sel:[0,0,0] op_sel_hi:[0,1,1]
  v_pk_fma_f32 v[86:87], v[2:3], v[100:101], v[86:87] op_sel:[1,0,0] op_sel_hi:[1,1,1] neg_lo:[1,0,0] neg_hi:[1,0,0]
  v_pk_fma_f32 v[102:103], v[2:3], v[84:85], v[102:103] op_sel:[1,0,0] op_sel_hi:[1,1,1]
  v_cvt_pk_bf16_f32 v218, v86, v87
  v_cvt_pk_bf16_f32 v219, -v102, -v103
  v_permlane32_swap_b32 v216, v217
  s_nop 0
  v_permlane32_swap_b32 v218, v219
  s_nop 1
  v_permlane16_swap_b32 v216, v218
  v_permlane16_swap_b32 v217, v219
  buffer_store_dwordx4 v[216:219], v14, s[56:59], s44 offen sc1
  s_add_u32 s44, s34, 5242880
  s_addc_u32 s45, s35, 0
  s_mov_b32 s46, 4194304
  s_mov_b32 s47, 0x20000
  v_mov_b32 v8, v104
  v_mov_b32 v9, v108
  v_mov_b32 v10, v112
  v_mov_b32 v11, v116
  v_mov_b32 v12, v105
  v_mov_b32 v13, v109
  v_mov_b32 v14, v113
  v_mov_b32 v15, v117
  v_mov_b32 v16, v106
  v_mov_b32 v17, v110
  v_mov_b32 v18, v114
  v_mov_b32 v19, v118
  v_mov_b32 v20, v107
  v_mov_b32 v21, v111
  v_mov_b32 v22, v115
  v_mov_b32 v23, v119
  v_mfma_f32_16x16x32_bf16 v[40:43], v[8:11], v[140:143], 0
  v_mfma_f32_16x16x32_bf16 v[44:47], v[8:11], v[144:147], 0
  v_mfma_f32_16x16x32_bf16 v[48:51], v[12:15], v[140:143], 0
  v_mfma_f32_16x16x32_bf16 v[52:55], v[12:15], v[144:147], 0
  v_mfma_f32_16x16x32_bf16 v[56:59], v[16:19], v[140:143], 0
  v_mfma_f32_16x16x32_bf16 v[60:63], v[16:19], v[144:147], 0
  v_mfma_f32_16x16x32_bf16 v[64:67], v[20:23], v[140:143], 0
  v_mfma_f32_16x16x32_bf16 v[68:71], v[20:23], v[144:147], 0
  s_mov_b32 s64, 1040
  v_mul_lo_u32 v2, v5, s64
  v_lshl_add_u32 v2, v6, 6, v2
  s_lshl_b32 s64, s3, 8
  s_add_u32 s64, s64, 0
  v_add_u32 v2, s64, v2
  v_cvt_pk_bf16_f32 v8, v40, v44
  v_cvt_pk_bf16_f32 v9, v41, v45
  v_cvt_pk_bf16_f32 v10, v42, v46
  v_cvt_pk_bf16_f32 v11, v43, v47
  ds_write_b128 v2, v[8:11] offset:0
  v_cvt_pk_bf16_f32 v12, v48, v52
  v_cvt_pk_bf16_f32 v13, v49, v53
  v_cvt_pk_bf16_f32 v14, v50, v54
  v_cvt_pk_bf16_f32 v15, v51, v55
  ds_write_b128 v2, v[12:15] offset:16
  v_cvt_pk_bf16_f32 v16, v56, v60
  v_cvt_pk_bf16_f32 v17, v57, v61
  v_cvt_pk_bf16_f32 v18, v58, v62
  v_cvt_pk_bf16_f32 v19, v59, v63
  ds_write_b128 v2, v[16:19] offset:32
  v_cvt_pk_bf16_f32 v20, v64, v68
  v_cvt_pk_bf16_f32 v21, v65, v69
  v_cvt_pk_bf16_f32 v22, v66, v70
  v_cvt_pk_bf16_f32 v23, v67, v71
  ds_write_b128 v2, v[20:23] offset:48
  s_mul_i32 s64, s3, 4160
  s_add_u32 s64, s64, 0
  v_lshl_add_u32 v2, v4, 4, s64
  s_waitcnt vmcnt(0)
  s_waitcnt lgkmcnt(0)
  s_barrier
  ds_read_b128 v[8:11], v2 offset:0
  ds_read_b128 v[12:15], v2 offset:1040
  ds_read_b128 v[16:19], v2 offset:2080
  ds_read_b128 v[20:23], v2 offset:3120
  s_cmp_lg_u32 s3, 0
  s_cbranch_scc1 gated_mix__spectral_gfnet__ssm_conv_s5__prompt_kernel_skip14
  s_mov_b64 exec, 1
  buffer_store_dword v36, v7, s[72:75], 0 offen sc1
  s_mov_b64 exec, -1
gated_mix__spectral_gfnet__ssm_conv_s5__prompt_kernel_skip14:
  s_waitcnt lgkmcnt(3)
  v_mfma_f32_16x16x32_bf16 v[40:43], v[8:11], v[156:159], 0
  v_mfma_f32_16x16x32_bf16 v[44:47], v[8:11], v[160:163], 0
  buffer_load_dwordx4 a[104:107], v35, s[52:55], s76 offen offset:0
  buffer_load_dwordx4 a[108:111], v35, s[52:55], s76 offen offset:64
  s_add_u32 s76, s76, 128
  s_and_b32 s76, s76, 0x7ff
  s_waitcnt lgkmcnt(2)
  v_mfma_f32_16x16x32_bf16 v[48:51], v[12:15], v[156:159], 0
  v_mfma_f32_16x16x32_bf16 v[52:55], v[12:15], v[160:163], 0
  buffer_load_dwordx4 a[112:115], v34, s[52:55], s76 offen offset:0
  buffer_load_dwordx4 a[116:119], v34, s[52:55], s76 offen offset:64
  s_waitcnt lgkmcnt(1)
  v_mfma_f32_16x16x32_bf16 v[56:59], v[16:19], v[156:159], 0
  v_mfma_f32_16x16x32_bf16 v[60:63], v[16:19], v[160:163], 0
  buffer_load_dwordx4 a[120:123], v35, s[52:55], s76 offen offset:0
  buffer_load_dwordx4 a[124:127], v35, s[52:55], s76 offen offset:64
  s_add_u32 s76, s76, 128
  s_and_b32 s76, s76, 0x7ff
  s_waitcnt lgkmcnt(0)
  v_mfma_f32_16x16x32_bf16 v[64:67], v[20:23], v[156:159], 0
  v_mfma_f32_16x16x32_bf16 v[68:71], v[20:23], v[160:163], 0
  buffer_load_dwordx4 a[128:131], v34, s[52:55], s76 offen offset:0
  buffer_load_dwordx4 a[132:135], v34, s[52:55], s76 offen offset:64
  v_pk_mul_f32 v[24:25], v[40:41], v[164:165]
  v_pk_mul_f32 v[26:27], v[44:45], v[164:165]
  v_pk_fma_f32 v[24:25], v[44:45], v[168:169], v[24:25]
  v_pk_fma_f32 v[26:27], v[40:41], v[168:169], v[26:27] neg_lo:[0,1,0] neg_hi:[0,1,0]
  v_cvt_pk_bf16_f32 v8, v24, v26
  v_cvt_pk_bf16_f32 v9, v25, v27
  v_pk_mul_f32 v[24:25], v[42:43], v[166:167]
  v_pk_mul_f32 v[26:27], v[46:47], v[166:167]
  v_pk_fma_f32 v[24:25], v[46:47], v[170:171], v[24:25]
  v_pk_fma_f32 v[26:27], v[42:43], v[170:171], v[26:27] neg_lo:[0,1,0] neg_hi:[0,1,0]
  v_cvt_pk_bf16_f32 v10, v24, v26
  v_cvt_pk_bf16_f32 v11, v25, v27
  buffer_load_dwordx4 a[136:139], v35, s[52:55], s76 offen offset:0
  buffer_load_dwordx4 a[140:143], v35, s[52:55], s76 offen offset:64
  s_add_u32 s76, s76, 128
  s_and_b32 s76, s76, 0x7ff
  v_pk_mul_f32 v[24:25], v[48:49], v[164:165]
  v_pk_mul_f32 v[26:27], v[52:53], v[164:165]
  v_pk_fma_f32 v[24:25], v[52:53], v[168:169], v[24:25]
  v_pk_fma_f32 v[26:27], v[48:49], v[168:169], v[26:27] neg_lo:[0,1,0] neg_hi:[0,1,0]
  v_cvt_pk_bf16_f32 v12, v24, v26
  v_cvt_pk_bf16_f32 v13, v25, v27
  v_pk_mul_f32 v[24:25], v[50:51], v[166:167]
  v_pk_mul_f32 v[26:27], v[54:55], v[166:167]
  v_pk_fma_f32 v[24:25], v[54:55], v[170:171], v[24:25]
  v_pk_fma_f32 v[26:27], v[50:51], v[170:171], v[26:27] neg_lo:[0,1,0] neg_hi:[0,1,0]
  v_cvt_pk_bf16_f32 v14, v24, v26
  v_cvt_pk_bf16_f32 v15, v25, v27
  buffer_load_dwordx4 a[144:147], v34, s[52:55], s76 offen offset:0
  buffer_load_dwordx4 a[148:151], v34, s[52:55], s76 offen offset:64
  v_pk_mul_f32 v[24:25], v[56:57], v[164:165]
  v_pk_mul_f32 v[26:27], v[60:61], v[164:165]
  v_pk_fma_f32 v[24:25], v[60:61], v[168:169], v[24:25]
  v_pk_fma_f32 v[26:27], v[56:57], v[168:169], v[26:27] neg_lo:[0,1,0] neg_hi:[0,1,0]
  v_cvt_pk_bf16_f32 v16, v24, v26
  v_cvt_pk_bf16_f32 v17, v25, v27
  v_pk_mul_f32 v[24:25], v[58:59], v[166:167]
  v_pk_mul_f32 v[26:27], v[62:63], v[166:167]
  v_pk_fma_f32 v[24:25], v[62:63], v[170:171], v[24:25]
  v_pk_fma_f32 v[26:27], v[58:59], v[170:171], v[26:27] neg_lo:[0,1,0] neg_hi:[0,1,0]
  v_cvt_pk_bf16_f32 v18, v24, v26
  v_cvt_pk_bf16_f32 v19, v25, v27
  buffer_load_dwordx4 a[152:155], v35, s[52:55], s76 offen offset:0
  buffer_load_dwordx4 a[156:159], v35, s[52:55], s76 offen offset:64
  s_add_u32 s76, s76, 128
  s_and_b32 s76, s76, 0x7ff
  v_pk_mul_f32 v[24:25], v[64:65], v[164:165]
  v_pk_mul_f32 v[26:27], v[68:69], v[164:165]
  v_pk_fma_f32 v[24:25], v[68:69], v[168:169], v[24:25]
  v_pk_fma_f32 v[26:27], v[64:65], v[168:169], v[26:27] neg_lo:[0,1,0] neg_hi:[0,1,0]
  v_cvt_pk_bf16_f32 v20, v24, v26
  v_cvt_pk_bf16_f32 v21, v25, v27
  v_pk_mul_f32 v[24:25], v[66:67], v[166:167]
  v_pk_mul_f32 v[26:27], v[70:71], v[166:167]
  v_pk_fma_f32 v[24:25], v[70:71], v[170:171], v[24:25]
  v_pk_fma_f32 v[26:27], v[66:67], v[170:171], v[26:27] neg_lo:[0,1,0] neg_hi:[0,1,0]
  v_cvt_pk_bf16_f32 v22, v24, v26
  v_cvt_pk_bf16_f32 v23, v25, v27
  buffer_load_dwordx4 a[160:163], v34, s[52:55], s76 offen offset:0
  buffer_load_dwordx4 a[164:167], v34, s[52:55], s76 offen offset:64
  v_mfma_f32_16x16x32_bf16 v[40:43], v[188:191], v[8:11], 0
  v_mfma_f32_16x16x32_bf16 v[44:47], v[192:195], v[8:11], 0
  buffer_load_dwordx4 a[168:171], v35, s[52:55], s76 offen offset:0
  buffer_load_dwordx4 a[172:175], v35, s[52:55], s76 offen offset:64
  s_add_u32 s76, s76, 128
  s_and_b32 s76, s76, 0x7ff
  v_mfma_f32_16x16x32_bf16 v[48:51], v[188:191], v[12:15], 0
  v_mfma_f32_16x16x32_bf16 v[52:55], v[192:195], v[12:15], 0
  buffer_load_dwordx4 a[176:179], v34, s[52:55], s76 offen offset:0
  buffer_load_dwordx4 a[180:183], v34, s[52:55], s76 offen offset:64
  v_mfma_f32_16x16x32_bf16 v[56:59], v[188:191], v[16:19], 0
  v_mfma_f32_16x16x32_bf16 v[60:63], v[192:195], v[16:19], 0
  buffer_load_dwordx4 a[184:187], v35, s[52:55], s76 offen offset:0
  buffer_load_dwordx4 a[188:191], v35, s[52:55], s76 offen offset:64
  s_add_u32 s76, s76, 128
  s_and_b32 s76, s76, 0x7ff
  v_mfma_f32_16x16x32_bf16 v[64:67], v[188:191], v[20:23], 0
  v_mfma_f32_16x16x32_bf16 v[68:71], v[192:195], v[20:23], 0
  buffer_load_dwordx4 a[192:195], v34, s[52:55], s76 offen offset:0
  buffer_load_dwordx4 a[196:199], v34, s[52:55], s76 offen offset:64
  s_cmp_eq_u32 s42, 0
  s_cbranch_scc1 gated_mix__spectral_gfnet__ssm_conv_s5__prompt_kernel_skip15
  v_lshlrev_b32 v72, 16, v136
  v_and_b32 v76, 0xffff0000, v136
  v_lshlrev_b32 v73, 16, v137
  v_and_b32 v77, 0xffff0000, v137
  v_lshlrev_b32 v74, 16, v138
  v_and_b32 v78, 0xffff0000, v138
  v_lshlrev_b32 v75, 16, v139
  v_and_b32 v79, 0xffff0000, v139
  v_pk_mul_f32 v[24:25], v[40:41], v[72:73]
  v_pk_mul_f32 v[26:27], v[44:45], v[72:73]
  v_pk_fma_f32 v[24:25], v[44:45], v[76:77], v[24:25] neg_lo:[0,1,0] neg_hi:[0,1,0]
  v_pk_fma_f32 v[26:27], v[40:41], v[76:77], v[26:27]
  v_cvt_pk_bf16_f32 v112, v24, v26
  v_cvt_pk_bf16_f32 v113, v25, v27
  v_pk_mul_f32 v[24:25], v[42:43], v[74:75]
  v_pk_mul_f32 v[26:27], v[46:47], v[74:75]
  v_pk_fma_f32 v[24:25], v[46:47], v[78:79], v[24:25] neg_lo:[0,1,0] neg_hi:[0,1,0]
  v_pk_fma_f32 v[26:27], v[42:43], v[78:79], v[26:27]
  v_cvt_pk_bf16_f32 v114, v24, v26
  v_cvt_pk_bf16_f32 v115, v25, v27
  s_nop 1
  v_mfma_f32_16x16x32_bf16 v[104:107], v[112:115], v[196:199], 0
  v_mfma_f32_16x16x32_bf16 v[108:111], v[112:115], v[200:203], 0
  s_nop 6
  v_pk_mul_f32 v[24:25], v[104:105], v[180:181]
  v_pk_mul_f32 v[26:27], v[108:109], v[180:181]
  v_pk_fma_f32 v[24:25], v[108:109], v[184:185], v[24:25] neg_lo:[0,1,0] neg_hi:[0,1,0]
  v_pk_fma_f32 v[26:27], v[104:105], v[184:185], v[26:27]
  v_cvt_pk_bf16_f32 v112, v24, v26
  v_cvt_pk_bf16_f32 v113, v25, v27
  v_pk_mul_f32 v[24:25], v[106:107], v[182:183]
  v_pk_mul_f32 v[26:27], v[110:111], v[182:183]
  v_pk_fma_f32 v[24:25], v[110:111], v[186:187], v[24:25] neg_lo:[0,1,0] neg_hi:[0,1,0]
  v_pk_fma_f32 v[26:27], v[106:107], v[186:187], v[26:27]
  v_cvt_pk_bf16_f32 v114, v24, v26
  v_cvt_pk_bf16_f32 v115, v25, v27
  s_nop 1
  v_mfma_f32_16x16x32_bf16 v[104:107], v[172:175], v[112:115], 0
  v_mfma_f32_16x16x32_bf16 v[108:111], v[176:179], v[112:115], 0
gated_mix__spectral_gfnet__ssm_conv_s5__prompt_kernel_skip15:
  v_lshlrev_b32 v72, 16, v120
  v_and_b32 v76, 0xffff0000, v120
  v_lshlrev_b32 v73, 16, v121
  v_and_b32 v77, 0xffff0000, v121
  v_lshlrev_b32 v74, 16, v122
  v_and_b32 v78, 0xffff0000, v122
  v_lshlrev_b32 v75, 16, v123
  v_and_b32 v79, 0xffff0000, v123
  v_pk_mul_f32 v[24:25], v[40:41], v[72:73]
  v_pk_mul_f32 v[26:27], v[44:45], v[72:73]
  v_pk_fma_f32 v[24:25], v[44:45], v[76:77], v[24:25] neg_lo:[0,1,0] neg_hi:[0,1,0]
  v_pk_fma_f32 v[26:27], v[40:41], v[76:77], v[26:27]
  v_cvt_pk_bf16_f32 v8, v24, v26
  v_cvt_pk_bf16_f32 v9, v25, v27
  v_pk_mul_f32 v[24:25], v[42:43], v[74:75]
  v_pk_mul_f32 v[26:27], v[46:47], v[74:75]
  v_pk_fma_f32 v[24:25], v[46:47], v[78:79], v[24:25] neg_lo:[0,1,0] neg_hi:[0,1,0]
  v_pk_fma_f32 v[26:27], v[42:43], v[78:79], v[26:27]
  v_cvt_pk_bf16_f32 v10, v24, v26
  v_cvt_pk_bf16_f32 v11, v25, v27
  buffer_load_dwordx4 a[200:203], v35, s[52:55], s76 offen offset:0
  buffer_load_dwordx4 a[204:207], v35, s[52:55], s76 offen offset:64
  s_add_u32 s76, s76, 128
  s_and_b32 s76, s76, 0x7ff
  v_lshlrev_b32 v72, 16, v124
  v_and_b32 v76, 0xffff0000, v124
  v_lshlrev_b32 v73, 16, v125
  v_and_b32 v77, 0xffff0000, v125
  v_lshlrev_b32 v74, 16, v126
  v_and_b32 v78, 0xffff0000, v126
  v_lshlrev_b32 v75, 16, v127
  v_and_b32 v79, 0xffff0000, v127
  v_pk_mul_f32 v[24:25], v[48:49], v[72:73]
  v_pk_mul_f32 v[26:27], v[52:53], v[72:73]
  v_pk_fma_f32 v[24:25], v[52:53], v[76:77], v[24:25] neg_lo:[0,1,0] neg_hi:[0,1,0]
  v_pk_fma_f32 v[26:27], v[48:49], v[76:77], v[26:27]
  v_cvt_pk_bf16_f32 v12, v24, v26
  v_cvt_pk_bf16_f32 v13, v25, v27
  v_pk_mul_f32 v[24:25], v[50:51], v[74:75]
  v_pk_mul_f32 v[26:27], v[54:55], v[74:75]
  v_pk_fma_f32 v[24:25], v[54:55], v[78:79], v[24:25] neg_lo:[0,1,0] neg_hi:[0,1,0]
  v_pk_fma_f32 v[26:27], v[50:51], v[78:79], v[26:27]
  v_cvt_pk_bf16_f32 v14, v24, v26
  v_cvt_pk_bf16_f32 v15, v25, v27
  buffer_load_dwordx4 a[208:211], v34, s[52:55], s76 offen offset:0
  buffer_load_dwordx4 a[212:215], v34, s[52:55], s76 offen offset:64
  v_lshlrev_b32 v72, 16, v128
  v_and_b32 v76, 0xffff0000, v128
  v_lshlrev_b32 v73, 16, v129
  v_and_b32 v77, 0xffff0000, v129
  v_lshlrev_b32 v74, 16, v130
  v_and_b32 v78, 0xffff0000, v130
  v_lshlrev_b32 v75, 16, v131
  v_and_b32 v79, 0xffff0000, v131
  v_pk_mul_f32 v[24:25], v[56:57], v[72:73]
  v_pk_mul_f32 v[26:27], v[60:61], v[72:73]
  v_pk_fma_f32 v[24:25], v[60:61], v[76:77], v[24:25] neg_lo:[0,1,0] neg_hi:[0,1,0]
  v_pk_fma_f32 v[26:27], v[56:57], v[76:77], v[26:27]
  v_cvt_pk_bf16_f32 v16, v24, v26
  v_cvt_pk_bf16_f32 v17, v25, v27
  v_pk_mul_f32 v[24:25], v[58:59], v[74:75]
  v_pk_mul_f32 v[26:27], v[62:63], v[74:75]
  v_pk_fma_f32 v[24:25], v[62:63], v[78:79], v[24:25] neg_lo:[0,1,0] neg_hi:[0,1,0]
  v_pk_fma_f32 v[26:27], v[58:59], v[78:79], v[26:27]
  v_cvt_pk_bf16_f32 v18, v24, v26
  v_cvt_pk_bf16_f32 v19, v25, v27
  buffer_load_dwordx4 a[216:219], v35, s[52:55], s76 offen offset:0
  buffer_load_dwordx4 a[220:223], v35, s[52:55], s76 offen offset:64
  s_add_u32 s76, s76, 128
  s_and_b32 s76, s76, 0x7ff
  v_lshlrev_b32 v72, 16, v132
  v_and_b32 v76, 0xffff0000, v132
  v_lshlrev_b32 v73, 16, v133
  v_and_b32 v77, 0xffff0000, v133
  v_lshlrev_b32 v74, 16, v134
  v_and_b32 v78, 0xffff0000, v134
  v_lshlrev_b32 v75, 16, v135
  v_and_b32 v79, 0xffff0000, v135
  v_pk_mul_f32 v[24:25], v[64:65], v[72:73]
  v_pk_mul_f32 v[26:27], v[68:69], v[72:73]
  v_pk_fma_f32 v[24:25], v[68:69], v[76:77], v[24:25] neg_lo:[0,1,0] neg_hi:[0,1,0]
  v_pk_fma_f32 v[26:27], v[64:65], v[76:77], v[26:27]
  v_cvt_pk_bf16_f32 v20, v24, v26
  v_cvt_pk_bf16_f32 v21, v25, v27
  v_pk_mul_f32 v[24:25], v[66:67], v[74:75]
  v_pk_mul_f32 v[26:27], v[70:71], v[74:75]
  v_pk_fma_f32 v[24:25], v[70:71], v[78:79], v[24:25] neg_lo:[0,1,0] neg_hi:[0,1,0]
  v_pk_fma_f32 v[26:27], v[66:67], v[78:79], v[26:27]
  v_cvt_pk_bf16_f32 v22, v24, v26
  v_cvt_pk_bf16_f32 v23, v25, v27
  buffer_load_dwordx4 a[224:227], v34, s[52:55], s76 offen offset:0
  buffer_load_dwordx4 a[228:231], v34, s[52:55], s76 offen offset:64
  v_mfma_f32_16x16x32_bf16 v[40:43], v[8:11], v[196:199], 0
  v_mfma_f32_16x16x32_bf16 v[44:47], v[8:11], v[200:203], 0
  buffer_load_dwordx4 a[232:235], v35, s[52:55], s76 offen offset:0
  buffer_load_dwordx4 a[236:239], v35, s[52:55], s76 offen offset:64
  s_add_u32 s76, s76, 128
  s_and_b32 s76, s76, 0x7ff
  v_mfma_f32_16x16x32_bf16 v[48:51], v[12:15], v[196:199], 0
  v_mfma_f32_16x16x32_bf16 v[52:55], v[12:15], v[200:203], 0
  buffer_load_dwordx4 a[240:243], v34, s[52:55], s76 offen offset:0
  buffer_load_dwordx4 a[244:247], v34, s[52:55], s76 offen offset:64
  v_mfma_f32_16x16x32_bf16 v[56:59], v[16:19], v[196:199], 0
  v_mfma_f32_16x16x32_bf16 v[60:63], v[16:19], v[200:203], 0
  buffer_load_dwordx4 a[248:251], v35, s[52:55], s76 offen offset:0
  buffer_load_dwordx4 a[252:255], v35, s[52:55], s76 offen offset:64
  s_add_u32 s76, s76, 128
  s_and_b32 s76, s76, 0x7ff
  v_mfma_f32_16x16x32_bf16 v[64:67], v[20:23], v[196:199], 0
  v_mfma_f32_16x16x32_bf16 v[68:71], v[20:23], v[200:203], 0
  v_pk_mul_f32 v[24:25], v[40:41], v[180:181]
  v_pk_mul_f32 v[26:27], v[44:45], v[180:181]
  v_pk_fma_f32 v[24:25], v[44:45], v[184:185], v[24:25] neg_lo:[0,1,0] neg_hi:[0,1,0]
  v_pk_fma_f32 v[26:27], v[40:41], v[184:185], v[26:27]
  v_cvt_pk_bf16_f32 v8, v24, v26
  v_cvt_pk_bf16_f32 v9, v25, v27
  v_pk_mul_f32 v[24:25], v[42:43], v[182:183]
  v_pk_mul_f32 v[26:27], v[46:47], v[182:183]
  v_pk_fma_f32 v[24:25], v[46:47], v[186:187], v[24:25] neg_lo:[0,1,0] neg_hi:[0,1,0]
  v_pk_fma_f32 v[26:27], v[42:43], v[186:187], v[26:27]
  v_cvt_pk_bf16_f32 v10, v24, v26
  v_cvt_pk_bf16_f32 v11, v25, v27
  v_pk_mul_f32 v[24:25], v[48:49], v[180:181]
  v_pk_mul_f32 v[26:27], v[52:53], v[180:181]
  v_pk_fma_f32 v[24:25], v[52:53], v[184:185], v[24:25] neg_lo:[0,1,0] neg_hi:[0,1,0]
  v_pk_fma_f32 v[26:27], v[48:49], v[184:185], v[26:27]
  v_cvt_pk_bf16_f32 v12, v24, v26
  v_cvt_pk_bf16_f32 v13, v25, v27
  v_pk_mul_f32 v[24:25], v[50:51], v[182:183]
  v_pk_mul_f32 v[26:27], v[54:55], v[182:183]
  v_pk_fma_f32 v[24:25], v[54:55], v[186:187], v[24:25] neg_lo:[0,1,0] neg_hi:[0,1,0]
  v_pk_fma_f32 v[26:27], v[50:51], v[186:187], v[26:27]
  v_cvt_pk_bf16_f32 v14, v24, v26
  v_cvt_pk_bf16_f32 v15, v25, v27
  v_pk_mul_f32 v[24:25], v[56:57], v[180:181]
  v_pk_mul_f32 v[26:27], v[60:61], v[180:181]
  v_pk_fma_f32 v[24:25], v[60:61], v[184:185], v[24:25] neg_lo:[0,1,0] neg_hi:[0,1,0]
  v_pk_fma_f32 v[26:27], v[56:57], v[184:185], v[26:27]
  v_cvt_pk_bf16_f32 v16, v24, v26
  v_cvt_pk_bf16_f32 v17, v25, v27
  v_pk_mul_f32 v[24:25], v[58:59], v[182:183]
  v_pk_mul_f32 v[26:27], v[62:63], v[182:183]
  v_pk_fma_f32 v[24:25], v[62:63], v[186:187], v[24:25] neg_lo:[0,1,0] neg_hi:[0,1,0]
  v_pk_fma_f32 v[26:27], v[58:59], v[186:187], v[26:27]
  v_cvt_pk_bf16_f32 v18, v24, v26
  v_cvt_pk_bf16_f32 v19, v25, v27
  v_pk_mul_f32 v[24:25], v[64:65], v[180:181]
  v_pk_mul_f32 v[26:27], v[68:69], v[180:181]
  v_pk_fma_f32 v[24:25], v[68:69], v[184:185], v[24:25] neg_lo:[0,1,0] neg_hi:[0,1,0]
  v_pk_fma_f32 v[26:27], v[64:65], v[184:185], v[26:27]
  v_cvt_pk_bf16_f32 v20, v24, v26
  v_cvt_pk_bf16_f32 v21, v25, v27
  v_pk_mul_f32 v[24:25], v[66:67], v[182:183]
  v_pk_mul_f32 v[26:27], v[70:71], v[182:183]
  v_pk_fma_f32 v[24:25], v[70:71], v[186:187], v[24:25] neg_lo:[0,1,0] neg_hi:[0,1,0]
  v_pk_fma_f32 v[26:27], v[66:67], v[186:187], v[26:27]
  v_cvt_pk_bf16_f32 v22, v24, v26
  v_cvt_pk_bf16_f32 v23, v25, v27
  v_mfma_f32_16x16x32_bf16 v[40:43], v[172:175], v[8:11], 0
  v_mfma_f32_16x16x32_bf16 v[44:47], v[176:179], v[8:11], 0
  v_mfma_f32_16x16x32_bf16 v[48:51], v[172:175], v[12:15], 0
  v_mfma_f32_16x16x32_bf16 v[52:55], v[176:179], v[12:15], 0
  v_mfma_f32_16x16x32_bf16 v[56:59], v[172:175], v[16:19], 0
  v_mfma_f32_16x16x32_bf16 v[60:63], v[176:179], v[16:19], 0
  v_mfma_f32_16x16x32_bf16 v[64:67], v[172:175], v[20:23], 0
  v_mfma_f32_16x16x32_bf16 v[68:71], v[176:179], v[20:23], 0
  s_sub_u32 s64, s42, 1
  s_or_b32 s64, s64, s3
  s_cmp_lg_u32 s64, 0
  s_cbranch_scc1 gated_mix__spectral_gfnet__ssm_conv_s5__prompt_kernel_skip16
  v_mov_b32 v44, v108
  v_mov_b32 v45, v109
  v_mov_b32 v46, v110
  v_mov_b32 v47, v111
gated_mix__spectral_gfnet__ssm_conv_s5__prompt_kernel_skip16:
  v_lshlrev_b32 v2, 12, v6
  v_lshl_add_u32 v2, v5, 4, v2
  s_lshl_b32 s64, s3, 8
  s_add_u32 s64, s64, 17408
  v_add_u32 v2, s64, v2
  v_cvt_pk_bf16_f32 v8, v40, v44
  v_cvt_pk_bf16_f32 v9, v48, v52
  v_cvt_pk_bf16_f32 v10, v56, v60
  v_cvt_pk_bf16_f32 v11, v64, v68
  ds_write_b128 v2, v[8:11] offset:0
  v_cvt_pk_bf16_f32 v12, v41, v45
  v_cvt_pk_bf16_f32 v13, v49, v53
  v_cvt_pk_bf16_f32 v14, v57, v61
  v_cvt_pk_bf16_f32 v15, v65, v69
  ds_write_b128 v2, v[12:15] offset:1024
  v_cvt_pk_bf16_f32 v16, v42, v46
  v_cvt_pk_bf16_f32 v17, v50, v54
  v_cvt_pk_bf16_f32 v18, v58, v62
  v_cvt_pk_bf16_f32 v19, v66, v70
  ds_write_b128 v2, v[16:19] offset:2048
  v_cvt_pk_bf16_f32 v20, v43, v47
  v_cvt_pk_bf16_f32 v21, v51, v55
  v_cvt_pk_bf16_f32 v22, v59, v63
  v_cvt_pk_bf16_f32 v23, v67, v71
  ds_write_b128 v2, v[20:23] offset:3072
  s_lshl_b32 s64, s3, 12
  s_add_u32 s64, s64, 17408
  v_lshl_add_u32 v2, v4, 4, s64
  s_waitcnt lgkmcnt(0)
  s_barrier
  ds_read_b128 v[8:11], v2 offset:0
  ds_read_b128 v[12:15], v2 offset:1024
  ds_read_b128 v[16:19], v2 offset:2048
  ds_read_b128 v[20:23], v2 offset:3072
  s_waitcnt lgkmcnt(3)
  v_mfma_f32_16x16x32_bf16 v[40:43], v[8:11], v[148:151], 0
  v_mfma_f32_16x16x32_bf16 v[44:47], v[8:11], v[152:155], 0
  s_waitcnt lgkmcnt(2)
  v_mfma_f32_16x16x32_bf16 v[48:51], v[12:15], v[148:151], 0
  v_mfma_f32_16x16x32_bf16 v[52:55], v[12:15], v[152:155], 0
  s_waitcnt lgkmcnt(1)
  v_mfma_f32_16x16x32_bf16 v[56:59], v[16:19], v[148:151], 0
  v_mfma_f32_16x16x32_bf16 v[60:63], v[16:19], v[152:155], 0
  s_waitcnt lgkmcnt(0)
  v_mfma_f32_16x16x32_bf16 v[64:67], v[20:23], v[148:151], 0
  v_mfma_f32_16x16x32_bf16 v[68:71], v[20:23], v[152:155], 0
  s_mov_b32 s64, 262144
  v_mul_lo_u32 v2, v5, s64
  v_lshl_add_u32 v2, v6, 4, v2
  s_mul_i32 s65, s3, 65536
  s_lshl_b32 s64, s43, 6
  s_add_u32 s65, s65, s64
  v_cvt_pk_bf16_f32 v8, v40, v44
  v_cvt_pk_bf16_f32 v9, v41, v45
  v_cvt_pk_bf16_f32 v10, v42, v46
  v_cvt_pk_bf16_f32 v11, v43, v47
  buffer_store_dwordx4 v[8:11], v2, s[44:47], s65 offen sc1
  s_add_u32 s65, s65, 16384
  v_cvt_pk_bf16_f32 v12, v48, v52
  v_cvt_pk_bf16_f32 v13, v49, v53
  v_cvt_pk_bf16_f32 v14, v50, v54
  v_cvt_pk_bf16_f32 v15, v51, v55
  buffer_store_dwordx4 v[12:15], v2, s[44:47], s65 offen sc1
  s_add_u32 s65, s65, 16384
  v_cvt_pk_bf16_f32 v16, v56, v60
  v_cvt_pk_bf16_f32 v17, v57, v61
  v_cvt_pk_bf16_f32 v18, v58, v62
  v_cvt_pk_bf16_f32 v19, v59, v63
  buffer_store_dwordx4 v[16:19], v2, s[44:47], s65 offen sc1
  s_add_u32 s65, s65, 16384
  v_cvt_pk_bf16_f32 v20, v64, v68
  v_cvt_pk_bf16_f32 v21, v65, v69
  v_cvt_pk_bf16_f32 v22, v66, v70
  v_cvt_pk_bf16_f32 v23, v67, v71
  buffer_store_dwordx4 v[20:23], v2, s[44:47], s65 offen sc1
  s_mov_b32 s64, s26
  s_mov_b32 s65, s27
  s_mov_b32 s66, 2048
  s_mov_b32 s67, 0x20000
  v_lshlrev_b32 v2, 2, v5
  s_lshl_b32 s68, s38, 9
  s_and_b32 s69, s3, 1
  s_lshl_b32 s69, s69, 8
  s_add_u32 s68, s68, s69
  buffer_load_dword v8, v2, s[48:51], s68 offen offset:0 sc1
  buffer_load_dword v9, v2, s[48:51], s68 offen offset:64 sc1
  buffer_load_dword v10, v2, s[48:51], s68 offen offset:128 sc1
  buffer_load_dword v11, v2, s[48:51], s68 offen offset:192 sc1
  v_lshlrev_b32 v2, 3, v6
  s_lshl_b32 s68, s39, 5
  s_lshr_b32 s69, s3, 1
  s_lshl_b32 s69, s69, 10
  s_add_u32 s68, s68, s69
  buffer_load_dwordx2 v[12:13], v2, s[64:67], s68 offen offset:0
  buffer_load_dwordx2 v[14:15], v2, s[64:67], s68 offen offset:512
  v_lshlrev_b32 v2, 4, v4
  s_lshr_b32 s66, s3, 1
  s_xor_b32 s66, s66, s3
  s_lshl_b32 s66, s66, 13
  s_lshl_b32 s64, s38, 19
  s_add_u32 s66, s66, s64
  v_lshl_add_u32 v16, v4, 4, s66
  v_add_u32 v17, 4096, v16
  s_lshl_b32 s64, s38, 15
  s_lshl_b32 s65, s3, 13
  v_and_b32 v18, 3, v4
  v_and_b32 v19, 2, v6
  v_xor_b32 v19, v19, v18
  v_lshlrev_b32 v18, 9, v18
  v_lshl_or_b32 v18, v19, 6, v18
  v_bfe_u32 v19, v4, 2, 2
  v_lshl_or_b32 v18, v19, 4, v18
  v_and_b32 v19, 1, v6
  v_lshl_or_b32 v18, v19, 3, v18
  s_and_b32 s66, s3, 1
  s_lshl_b32 s66, s66, 14
  v_add_u32 v20, s66, v18
  v_xor_b32 v21, 64, v20
  v_add_u32 v22, 0x10000, v20
  v_add_u32 v23, 0x10000, v21
  v_lshrrev_b32 v24, 1, v6
  v_lshlrev_b32 v24, 3, v24
  v_and_b32 v25, 1, v6
  v_lshl_add_u32 v24, v25, 1, v24
  v_cvt_f32_u32 v19, v24
  v_mul_u32_u24 v27, 0x8000, v25
  v_lshl_or_b32 v27, v27, 16, v27
  s_and_b32 s66, s3, 1
  s_lshl_b32 s66, s66, 6
  s_add_u32 s66, s66, 0
  v_add_u32 v24, s66, v5
  v_cvt_f32_u32 v3, v24
  v_mul_f32 v3, 0x3c000000, v3
  v_mul_f32 v18, v3, v19
  v_fmamk_f32 v24, v3, 0x0, v18
  v_cos_f32 v25, v24
  v_sin_f32 v26, v24
  s_nop 0
  v_cvt_pk_bf16_f32 v40, v25, -v26
  v_xor_b32 v72, v27, v40
  v_fmamk_f32 v24, v3, 0x3f800000, v18
  v_cos_f32 v25, v24
  v_sin_f32 v26, v24
  s_nop 0
  v_cvt_pk_bf16_f32 v41, v25, -v26
  v_cvt_pk_bf16_f32 v73, -v26, -v25
  v_xor_b32 v73, v27, v73
  v_fmamk_f32 v24, v3, 0x40800000, v18
  v_cos_f32 v25, v24
  v_sin_f32 v26, v24
  s_nop 0
  v_cvt_pk_bf16_f32 v42, v25, -v26
  v_xor_b32 v74, v27, v42
  v_fmamk_f32 v24, v3, 0x40a00000, v18
  v_cos_f32 v25, v24
  v_sin_f32 v26, v24
  s_nop 0
  v_cvt_pk_bf16_f32 v43, v25, -v26
  v_cvt_pk_bf16_f32 v75, -v26, -v25
  v_xor_b32 v75, v27, v75
  v_fmamk_f32 v24, v3, 0x41800000, v18
  v_cos_f32 v25, v24
  v_sin_f32 v26, v24
  s_nop 0
  v_cvt_pk_bf16_f32 v44, v25, -v26
  v_xor_b32 v76, v27, v44
  v_fmamk_f32 v24, v3, 0x41880000, v18
  v_cos_f32 v25, v24
  v_sin_f32 v26, v24
  s_nop 0
  v_cvt_pk_bf16_f32 v45, v25, -v26
  v_cvt_pk_bf16_f32 v77, -v26, -v25
  v_xor_b32 v77, v27, v77
  v_fmamk_f32 v24, v3, 0x41a00000, v18
  v_cos_f32 v25, v24
  v_sin_f32 v26, v24
  s_nop 0
  v_cvt_pk_bf16_f32 v46, v25, -v26
  v_xor_b32 v78, v27, v46
  v_fmamk_f32 v24, v3, 0x41a80000, v18
  v_cos_f32 v25, v24
  v_sin_f32 v26, v24
  s_nop 0
  v_cvt_pk_bf16_f32 v47, v25, -v26
  v_cvt_pk_bf16_f32 v79, -v26, -v25
  v_xor_b32 v79, v27, v79
  v_fmamk_f32 v24, v3, 0x42000000, v18
  v_cos_f32 v25, v24
  v_sin_f32 v26, v24
  s_nop 0
  v_cvt_pk_bf16_f32 v48, v25, -v26
  v_xor_b32 v80, v27, v48
  v_fmamk_f32 v24, v3, 0x42040000, v18
  v_cos_f32 v25, v24
  v_sin_f32 v26, v24
  s_nop 0
  v_cvt_pk_bf16_f32 v49, v25, -v26
  v_cvt_pk_bf16_f32 v81, -v26, -v25
  v_xor_b32 v81, v27, v81
  v_fmamk_f32 v24, v3, 0x42100000, v18
  v_cos_f32 v25, v24
  v_sin_f32 v26, v24
  s_nop 0
  v_cvt_pk_bf16_f32 v50, v25, -v26
  v_xor_b32 v82, v27, v50
  v_fmamk_f32 v24, v3, 0x42140000, v18
  v_cos_f32 v25, v24
  v_sin_f32 v26, v24
  s_nop 0
  v_cvt_pk_bf16_f32 v51, v25, -v26
  v_cvt_pk_bf16_f32 v83, -v26, -v25
  v_xor_b32 v83, v27, v83
  v_fmamk_f32 v24, v3, 0x42400000, v18
  v_cos_f32 v25, v24
  v_sin_f32 v26, v24
  s_nop 0
  v_cvt_pk_bf16_f32 v52, v25, -v26
  v_xor_b32 v84, v27, v52
  v_fmamk_f32 v24, v3, 0x42440000, v18
  v_cos_f32 v25, v24
  v_sin_f32 v26, v24
  s_nop 0
  v_cvt_pk_bf16_f32 v53, v25, -v26
  v_cvt_pk_bf16_f32 v85, -v26, -v25
  v_xor_b32 v85, v27, v85
  v_fmamk_f32 v24, v3, 0x42500000, v18
  v_cos_f32 v25, v24
  v_sin_f32 v26, v24
  s_nop 0
  v_cvt_pk_bf16_f32 v54, v25, -v26
  v_xor_b32 v86, v27, v54
  v_fmamk_f32 v24, v3, 0x42540000, v18
  v_cos_f32 v25, v24
  v_sin_f32 v26, v24
  s_nop 0
  v_cvt_pk_bf16_f32 v55, v25, -v26
  v_cvt_pk_bf16_f32 v87, -v26, -v25
  v_xor_b32 v87, v27, v87
  s_and_b32 s66, s3, 1
  s_lshl_b32 s66, s66, 6
  s_add_u32 s66, s66, 16
  v_add_u32 v24, s66, v5
  v_cvt_f32_u32 v3, v24
  v_mul_f32 v3, 0x3c000000, v3
  v_mul_f32 v18, v3, v19
  v_fmamk_f32 v24, v3, 0x0, v18
  v_cos_f32 v25, v24
  v_sin_f32 v26, v24
  s_nop 0
  v_cvt_pk_bf16_f32 v56, v25, -v26
  v_xor_b32 v88, v27, v56
  v_fmamk_f32 v24, v3, 0x3f800000, v18
  v_cos_f32 v25, v24
  v_sin_f32 v26, v24
  s_nop 0
  v_cvt_pk_bf16_f32 v57, v25, -v26
  v_cvt_pk_bf16_f32 v89, -v26, -v25
  v_xor_b32 v89, v27, v89
  v_fmamk_f32 v24, v3, 0x40800000, v18
  v_cos_f32 v25, v24
  v_sin_f32 v26, v24
  s_nop 0
  v_cvt_pk_bf16_f32 v58, v25, -v26
  v_xor_b32 v90, v27, v58
  v_fmamk_f32 v24, v3, 0x40a00000, v18
  v_cos_f32 v25, v24
  v_sin_f32 v26, v24
  s_nop 0
  v_cvt_pk_bf16_f32 v59, v25, -v26
  v_cvt_pk_bf16_f32 v91, -v26, -v25
  v_xor_b32 v91, v27, v91
  v_fmamk_f32 v24, v3, 0x41800000, v18
  v_cos_f32 v25, v24
  v_sin_f32 v26, v24
  s_nop 0
  v_cvt_pk_bf16_f32 v60, v25, -v26
  v_xor_b32 v92, v27, v60
  v_fmamk_f32 v24, v3, 0x41880000, v18
  v_cos_f32 v25, v24
  v_sin_f32 v26, v24
  s_nop 0
  v_cvt_pk_bf16_f32 v61, v25, -v26
  v_cvt_pk_bf16_f32 v93, -v26, -v25
  v_xor_b32 v93, v27, v93
  v_fmamk_f32 v24, v3, 0x41a00000, v18
  v_cos_f32 v25, v24
  v_sin_f32 v26, v24
  s_nop 0
  v_cvt_pk_bf16_f32 v62, v25, -v26
  v_xor_b32 v94, v27, v62
  v_fmamk_f32 v24, v3, 0x41a80000, v18
  v_cos_f32 v25, v24
  v_sin_f32 v26, v24
  s_nop 0
  v_cvt_pk_bf16_f32 v63, v25, -v26
  v_cvt_pk_bf16_f32 v95, -v26, -v25
  v_xor_b32 v95, v27, v95
  v_fmamk_f32 v24, v3, 0x42000000, v18
  v_cos_f32 v25, v24
  v_sin_f32 v26, v24
  s_nop 0
  v_cvt_pk_bf16_f32 v64, v25, -v26
  v_xor_b32 v96, v27, v64
  v_fmamk_f32 v24, v3, 0x42040000, v18
  v_cos_f32 v25, v24
  v_sin_f32 v26, v24
  s_nop 0
  v_cvt_pk_bf16_f32 v65, v25, -v26
  v_cvt_pk_bf16_f32 v97, -v26, -v25
  v_xor_b32 v97, v27, v97
  v_fmamk_f32 v24, v3, 0x42100000, v18
  v_cos_f32 v25, v24
  v_sin_f32 v26, v24
  s_nop 0
  v_cvt_pk_bf16_f32 v66, v25, -v26
  v_xor_b32 v98, v27, v66
  v_fmamk_f32 v24, v3, 0x42140000, v18
  v_cos_f32 v25, v24
  v_sin_f32 v26, v24
  s_nop 0
  v_cvt_pk_bf16_f32 v67, v25, -v26
  v_cvt_pk_bf16_f32 v99, -v26, -v25
  v_xor_b32 v99, v27, v99
  v_fmamk_f32 v24, v3, 0x42400000, v18
  v_cos_f32 v25, v24
  v_sin_f32 v26, v24
  s_nop 0
  v_cvt_pk_bf16_f32 v68, v25, -v26
  v_xor_b32 v100, v27, v68
  v_fmamk_f32 v24, v3, 0x42440000, v18
  v_cos_f32 v25, v24
  v_sin_f32 v26, v24
  s_nop 0
  v_cvt_pk_bf16_f32 v69, v25, -v26
  v_cvt_pk_bf16_f32 v101, -v26, -v25
  v_xor_b32 v101, v27, v101
  v_fmamk_f32 v24, v3, 0x42500000, v18
  v_cos_f32 v25, v24
  v_sin_f32 v26, v24
  s_nop 0
  v_cvt_pk_bf16_f32 v70, v25, -v26
  v_xor_b32 v102, v27, v70
  v_fmamk_f32 v24, v3, 0x42540000, v18
  v_cos_f32 v25, v24
  v_sin_f32 v26, v24
  s_nop 0
  v_cvt_pk_bf16_f32 v71, v25, -v26
  v_cvt_pk_bf16_f32 v103, -v26, -v25
  v_xor_b32 v103, v27, v103
  v_lshlrev_b32 v25, 31, v5
  v_or_b32 v25, 0x3f003f00, v25
  v_cmp_eq_u32 vcc, 0, v6
  s_nop 1
  v_cndmask_b32 v40, v40, v25, vcc
  v_cndmask_b32 v56, v56, v25, vcc
  v_cndmask_b32 v72, v72, v25, vcc
  v_cndmask_b32 v88, v88, v25, vcc
  buffer_load_dwordx4 v[24:27], v2, s[72:75], 0 offen offset:0 sc1
  s_waitcnt vmcnt(0)
  v_min_u32 v24, v24, v25
  v_min3_u32 v24, v24, v26, v27
  v_cmp_ne_u32 vcc, 1, v24
  s_nop 0
  s_cbranch_vccz gated_mix__spectral_gfnet__ssm_conv_s5__prompt_kernel_skip17
  s_mov_b32 s66, 0
gated_mix__spectral_gfnet__ssm_conv_s5__prompt_kernel_poll18:
  buffer_load_dwordx4 v[24:27], v2, s[72:75], 0 offen offset:0 sc1
  s_waitcnt vmcnt(0)
  v_min_u32 v24, v24, v25
  v_min3_u32 v24, v24, v26, v27
  v_cmp_ne_u32 vcc, 1, v24
  s_nop 0
  s_cbranch_vccz gated_mix__spectral_gfnet__ssm_conv_s5__prompt_kernel_pollout19
  s_add_u32 s66, s66, 1
  s_cmp_lt_u32 s66, 1048576
  s_cbranch_scc1 gated_mix__spectral_gfnet__ssm_conv_s5__prompt_kernel_poll18
gated_mix__spectral_gfnet__ssm_conv_s5__prompt_kernel_pollout19:
gated_mix__spectral_gfnet__ssm_conv_s5__prompt_kernel_skip17:
  s_barrier
  s_add_u32 m0, s65, 0
  s_nop 0
  buffer_load_dwordx4 v16, s[56:59], s64 offen offset:0 sc1 lds
  buffer_load_dwordx4 v16, s[56:59], s64 offen offset:1024 sc1 lds
  buffer_load_dwordx4 v16, s[56:59], s64 offen offset:2048 sc1 lds
  buffer_load_dwordx4 v16, s[56:59], s64 offen offset:3072 sc1 lds
  s_add_u32 m0, s65, 4096
  s_nop 0
  buffer_load_dwordx4 v17, s[56:59], s64 offen offset:0 sc1 lds
  buffer_load_dwordx4 v17, s[56:59], s64 offen offset:1024 sc1 lds
  buffer_load_dwordx4 v17, s[56:59], s64 offen offset:2048 sc1 lds
  buffer_load_dwordx4 v17, s[56:59], s64 offen offset:3072 sc1 lds
  s_add_u32 s64, s64, 32768
  s_and_b32 s64, s64, 0x7ffff
  s_add_u32 m0, s65, 32768
  s_nop 0
  buffer_load_dwordx4 v16, s[56:59], s64 offen offset:0 sc1 lds
  buffer_load_dwordx4 v16, s[56:59], s64 offen offset:1024 sc1 lds
  buffer_load_dwordx4 v16, s[56:59], s64 offen offset:2048 sc1 lds
  buffer_load_dwordx4 v16, s[56:59], s64 offen offset:3072 sc1 lds
  s_add_u32 m0, s65, 36864
  s_nop 0
  buffer_load_dwordx4 v17, s[56:59], s64 offen offset:0 sc1 lds
  buffer_load_dwordx4 v17, s[56:59], s64 offen offset:1024 sc1 lds
  buffer_load_dwordx4 v17, s[56:59], s64 offen offset:2048 sc1 lds
  buffer_load_dwordx4 v17, s[56:59], s64 offen offset:3072 sc1 lds
  s_add_u32 s64, s64, 32768
  s_and_b32 s64, s64, 0x7ffff
  s_add_u32 m0, s65, 65536
  s_nop 0
  buffer_load_dwordx4 v16, s[56:59], s64 offen offset:0 sc1 lds
  buffer_load_dwordx4 v16, s[56:59], s64 offen offset:1024 sc1 lds
  buffer_load_dwordx4 v16, s[56:59], s64 offen offset:2048 sc1 lds
  buffer_load_dwordx4 v16, s[56:59], s64 offen offset:3072 sc1 lds
  s_add_u32 m0, s65, 69632
  s_nop 0
  buffer_load_dwordx4 v17, s[56:59], s64 offen offset:0 sc1 lds
  buffer_load_dwordx4 v17, s[56:59], s64 offen offset:1024 sc1 lds
  buffer_load_dwordx4 v17, s[56:59], s64 offen offset:2048 sc1 lds
  buffer_load_dwordx4 v17, s[56:59], s64 offen offset:3072 sc1 lds
  s_add_u32 s64, s64, 32768
  s_and_b32 s64, s64, 0x7ffff
  s_add_u32 m0, s65, 98304
  s_nop 0
  buffer_load_dwordx4 v16, s[56:59], s64 offen offset:0 sc1 lds
  buffer_load_dwordx4 v16, s[56:59], s64 offen offset:1024 sc1 lds
  buffer_load_dwordx4 v16, s[56:59], s64 offen offset:2048 sc1 lds
  buffer_load_dwordx4 v16, s[56:59], s64 offen offset:3072 sc1 lds
  s_add_u32 m0, s65, 102400
  s_nop 0
  buffer_load_dwordx4 v17, s[56:59], s64 offen offset:0 sc1 lds
  buffer_load_dwordx4 v17, s[56:59], s64 offen offset:1024 sc1 lds
  buffer_load_dwordx4 v17, s[56:59], s64 offen offset:2048 sc1 lds
  buffer_load_dwordx4 v17, s[56:59], s64 offen offset:3072 sc1 lds
  s_add_u32 s64, s64, 32768
  s_and_b32 s64, s64, 0x7ffff
  s_and_b32 s66, s3, 1
  s_lshl_b32 s66, s66, 13
  s_add_u32 s66, s66, 131072
  v_lshlrev_b32 v24, 7, v5
  v_lshl_or_b32 v24, v6, 3, v24
  v_add_u32 v24, s66, v24
  v_bfe_u32 v25, v5, 1, 2
  s_and_b32 s66, s3, 2
  v_xor_b32 v25, s66, v25
  v_lshl_add_u32 v18, v25, 5, v24
  v_xor_b32 v19, 32, v18
  ds_read_b64 v[106:107], v18 offset:0
  ds_read_b64 v[110:111], v18 offset:2048
  ds_read_b64 v[114:115], v18 offset:4096
  ds_read_b64 v[118:119], v18 offset:6144
  ds_read_b64 v[138:139], v19 offset:0
  ds_read_b64 v[142:143], v19 offset:2048
  ds_read_b64 v[146:147], v19 offset:4096
  ds_read_b64 v[150:151], v19 offset:6144
  v_sub_f32 v32, 1.0, v8
  v_mul_f32 v8, 0x35800000, v8
  v_cvt_pk_bf16_f32 v32, v32, v32
  v_and_b32 v32, 0xffff0000, v32
  v_sub_f32 v33, 1.0, v9
  v_mul_f32 v9, 0x35800000, v9
  v_cvt_pk_bf16_f32 v33, v33, v33
  v_and_b32 v33, 0xffff0000, v33
  v_sub_f32 v34, 1.0, v10
  v_mul_f32 v10, 0x35800000, v10
  v_cvt_pk_bf16_f32 v34, v34, v34
  v_and_b32 v34, 0xffff0000, v34
  v_sub_f32 v35, 1.0, v11
  v_mul_f32 v11, 0x35800000, v11
  v_cvt_pk_bf16_f32 v35, v35, v35
  v_and_b32 v35, 0xffff0000, v35
  v_lshlrev_b32 v28, 16, v12
  v_and_b32 v29, 0xffff0000, v12
  v_lshlrev_b32 v30, 16, v13
  v_and_b32 v31, 0xffff0000, v13
  s_waitcnt lgkmcnt(7)
  v_lshlrev_b32 v104, 16, v106
  v_and_b32 v105, 0xffff0000, v106
  v_lshlrev_b32 v106, 16, v107
  v_and_b32 v107, 0xffff0000, v107
  v_pk_mul_f32 v[104:105], v[104:105], v[28:29]
  v_pk_mul_f32 v[106:107], v[106:107], v[30:31]
  s_waitcnt lgkmcnt(6)
  v_lshlrev_b32 v108, 16, v110
  v_and_b32 v109, 0xffff0000, v110
  v_lshlrev_b32 v110, 16, v111
  v_and_b32 v111, 0xffff0000, v111
  v_pk_mul_f32 v[108:109], v[108:109], v[28:29]
  v_pk_mul_f32 v[110:111], v[110:111], v[30:31]
  s_waitcnt lgkmcnt(5)
  v_lshlrev_b32 v112, 16, v114
  v_and_b32 v113, 0xffff0000, v114
  v_lshlrev_b32 v114, 16, v115
  v_and_b32 v115, 0xffff0000, v115
  v_pk_mul_f32 v[112:113], v[112:113], v[28:29]
  v_pk_mul_f32 v[114:115], v[114:115], v[30:31]
  s_waitcnt lgkmcnt(4)
  v_lshlrev_b32 v116, 16, v118
  v_and_b32 v117, 0xffff0000, v118
  v_lshlrev_b32 v118, 16, v119
  v_and_b32 v119, 0xffff0000, v119
  v_pk_mul_f32 v[116:117], v[116:117], v[28:29]
  v_pk_mul_f32 v[118:119], v[118:119], v[30:31]
  v_lshlrev_b32 v28, 16, v14
  v_and_b32 v29, 0xffff0000, v14
  v_lshlrev_b32 v30, 16, v15
  v_and_b32 v31, 0xffff0000, v15
  s_waitcnt lgkmcnt(3)
  v_lshlrev_b32 v136, 16, v138
  v_and_b32 v137, 0xffff0000, v138
  v_lshlrev_b32 v138, 16, v139
  v_and_b32 v139, 0xffff0000, v139
  v_pk_mul_f32 v[136:137], v[136:137], v[28:29]
  v_pk_mul_f32 v[138:139], v[138:139], v[30:31]
  s_waitcnt lgkmcnt(2)
  v_lshlrev_b32 v140, 16, v142
  v_and_b32 v141, 0xffff0000, v142
  v_lshlrev_b32 v142, 16, v143
  v_and_b32 v143, 0xffff0000, v143
  v_pk_mul_f32 v[140:141], v[140:141], v[28:29]
  v_pk_mul_f32 v[142:143], v[142:143], v[30:31]
  s_waitcnt lgkmcnt(1)
  v_lshlrev_b32 v144, 16, v146
  v_and_b32 v145, 0xffff0000, v146
  v_lshlrev_b32 v146, 16, v147
  v_and_b32 v147, 0xffff0000, v147
  v_pk_mul_f32 v[144:145], v[144:145], v[28:29]
  v_pk_mul_f32 v[146:147], v[146:147], v[30:31]
  s_waitcnt lgkmcnt(0)
  v_lshlrev_b32 v148, 16, v150
  v_and_b32 v149, 0xffff0000, v150
  v_lshlrev_b32 v150, 16, v151
  v_and_b32 v151, 0xffff0000, v151
  v_pk_mul_f32 v[148:149], v[148:149], v[28:29]
  v_pk_mul_f32 v[150:151], v[150:151], v[30:31]
  s_waitcnt vmcnt(24)
  s_barrier
  ds_read_b64_tr_b16 v[168:169], v20 offset:0
  ds_read_b64_tr_b16 v[170:171], v21 offset:0
  ds_read_b64_tr_b16 v[172:173], v20 offset:2048
  ds_read_b64_tr_b16 v[174:175], v21 offset:2048
  ds_read_b64_tr_b16 v[176:177], v20 offset:4096
  ds_read_b64_tr_b16 v[178:179], v21 offset:4096
  ds_read_b64_tr_b16 v[180:181], v20 offset:6144
  ds_read_b64_tr_b16 v[182:183], v21 offset:6144
  ds_read_b64_tr_b16 v[184:185], v20 offset:8192
  ds_read_b64_tr_b16 v[186:187], v21 offset:8192
  ds_read_b64_tr_b16 v[188:189], v20 offset:10240
  ds_read_b64_tr_b16 v[190:191], v21 offset:10240
  ds_read_b64_tr_b16 v[192:193], v20 offset:12288
  ds_read_b64_tr_b16 v[194:195], v21 offset:12288
  ds_read_b64_tr_b16 v[196:197], v20 offset:14336
  ds_read_b64_tr_b16 v[198:199], v21 offset:14336
  s_cmp_lg_u32 s3, 0
  s_cbranch_scc1 gated_mix__spectral_gfnet__ssm_conv_s5__prompt_kernel_skip20
  s_mov_b64 exec, 1
  buffer_store_dword v36, v7, s[72:75], 0 offen offset:1024 sc1
  s_mov_b64 exec, -1
gated_mix__spectral_gfnet__ssm_conv_s5__prompt_kernel_skip20:
  s_waitcnt lgkmcnt(14)
  v_mfma_f32_16x16x32_bf16 v[104:107], a[0:3], v[168:171], v[104:107]
  ds_read_b64_tr_b16 v[200:201], v20 offset:256
  ds_read_b64_tr_b16 v[202:203], v21 offset:256
  v_mfma_f32_16x16x32_bf16 v[136:139], a[8:11], v[168:171], v[136:139]
  ds_read_b64_tr_b16 v[204:205], v20 offset:2304
  ds_read_b64_tr_b16 v[206:207], v21 offset:2304
  s_waitcnt lgkmcnt(15)
  v_mfma_f32_16x16x32_bf16 v[108:111], a[0:3], v[172:175], v[108:111]
  ds_read_b64_tr_b16 v[208:209], v20 offset:4352
  ds_read_b64_tr_b16 v[210:211], v21 offset:4352
  v_mfma_f32_16x16x32_bf16 v[140:143], a[8:11], v[172:175], v[140:143]
  ds_read_b64_tr_b16 v[212:213], v20 offset:6400
  ds_read_b64_tr_b16 v[214:215], v21 offset:6400
  s_waitcnt lgkmcnt(15)
  v_mfma_f32_16x16x32_bf16 v[112:115], a[0:3], v[176:179], v[112:115]
  ds_read_b64_tr_b16 v[216:217], v20 offset:8448
  ds_read_b64_tr_b16 v[218:219], v21 offset:8448
  v_mfma_f32_16x16x32_bf16 v[144:147], a[8:11], v[176:179], v[144:147]
  ds_read_b64_tr_b16 v[220:221], v20 offset:10496
  ds_read_b64_tr_b16 v[222:223], v21 offset:10496
  s_waitcnt lgkmcnt(15)
  v_mfma_f32_16x16x32_bf16 v[116:119], a[0:3], v[180:183], v[116:119]
  ds_read_b64_tr_b16 v[224:225], v20 offset:12544
  ds_read_b64_tr_b16 v[226:227], v21 offset:12544
  v_mfma_f32_16x16x32_bf16 v[148:151], a[8:11], v[180:183], v[148:151]
  ds_read_b64_tr_b16 v[228:229], v20 offset:14592
  ds_read_b64_tr_b16 v[230:231], v21 offset:14592
  s_waitcnt lgkmcnt(15)
  v_mfma_f32_16x16x32_bf16 v[120:123], a[0:3], v[184:187], 0
  v_mfma_f32_16x16x32_bf16 v[152:155], a[8:11], v[184:187], 0
  s_waitcnt lgkmcnt(15)
  v_mfma_f32_16x16x32_bf16 v[124:127], a[0:3], v[188:191], 0
  v_mfma_f32_16x16x32_bf16 v[156:159], a[8:11], v[188:191], 0
  s_waitcnt lgkmcnt(15)
  v_mfma_f32_16x16x32_bf16 v[128:131], a[0:3], v[192:195], 0
  v_mfma_f32_16x16x32_bf16 v[160:163], a[8:11], v[192:195], 0
  s_waitcnt lgkmcnt(15)
  v_mfma_f32_16x16x32_bf16 v[132:135], a[0:3], v[196:199], 0
  v_mfma_f32_16x16x32_bf16 v[164:167], a[8:11], v[196:199], 0
  s_waitcnt vmcnt(16) lgkmcnt(0)
  s_barrier
  v_mfma_f32_16x16x32_bf16 v[104:107], a[4:7], v[200:203], v[104:107]
  ds_read_b64_tr_b16 v[168:169], v20 offset:32768
  ds_read_b64_tr_b16 v[170:171], v21 offset:32768
  v_mfma_f32_16x16x32_bf16 v[136:139], a[12:15], v[200:203], v[136:139]
  ds_read_b64_tr_b16 v[172:173], v20 offset:34816
  ds_read_b64_tr_b16 v[174:175], v21 offset:34816
  v_mfma_f32_16x16x32_bf16 v[108:111], a[4:7], v[204:207], v[108:111]
  ds_read_b64_tr_b16 v[176:177], v20 offset:36864
  ds_read_b64_tr_b16 v[178:179], v21 offset:36864
  v_mfma_f32_16x16x32_bf16 v[140:143], a[12:15], v[204:207], v[140:143]
  ds_read_b64_tr_b16 v[180:181], v20 offset:38912
  ds_read_b64_tr_b16 v[182:183], v21 offset:38912
  v_mfma_f32_16x16x32_bf16 v[112:115], a[4:7], v[208:211], v[112:115]
  ds_read_b64_tr_b16 v[184:185], v20 offset:40960
  ds_read_b64_tr_b16 v[186:187], v21 offset:40960
  v_mfma_f32_16x16x32_bf16 v[144:147], a[12:15], v[208:211], v[144:147]
  ds_read_b64_tr_b16 v[188:189], v20 offset:43008
  ds_read_b64_tr_b16 v[190:191], v21 offset:43008
  v_mfma_f32_16x16x32_bf16 v[116:119], a[4:7], v[212:215], v[116:119]
  ds_read_b64_tr_b16 v[192:193], v20 offset:45056
  ds_read_b64_tr_b16 v[194:195], v21 offset:45056
  v_mfma_f32_16x16x32_bf16 v[148:151], a[12:15], v[212:215], v[148:151]
  ds_read_b64_tr_b16 v[196:197], v20 offset:47104
  ds_read_b64_tr_b16 v[198:199], v21 offset:47104
  v_mfma_f32_16x16x32_bf16 v[120:123], a[4:7], v[216:219], v[120:123]
  s_add_u32 m0, s65, 0
  s_nop 0
  buffer_load_dwordx4 v16, s[56:59], s64 offen offset:0 sc1 lds
  v_mfma_f32_16x16x32_bf16 v[152:155], a[12:15], v[216:219], v[152:155]
  v_mfma_f32_16x16x32_bf16 v[124:127], a[4:7], v[220:223], v[124:127]
  buffer_load_dwordx4 v16, s[56:59], s64 offen offset:1024 sc1 lds
  v_mfma_f32_16x16x32_bf16 v[156:159], a[12:15], v[220:223], v[156:159]
  v_mfma_f32_16x16x32_bf16 v[128:131], a[4:7], v[224:227], v[128:131]
  buffer_load_dwordx4 v16, s[56:59], s64 offen offset:2048 sc1 lds
  v_mfma_f32_16x16x32_bf16 v[160:163], a[12:15], v[224:227], v[160:163]
  v_mfma_f32_16x16x32_bf16 v[132:135], a[4:7], v[228:231], v[132:135]
  buffer_load_dwordx4 v16, s[56:59], s64 offen offset:3072 sc1 lds
  v_mfma_f32_16x16x32_bf16 v[164:167], a[12:15], v[228:231], v[164:167]
  s_waitcnt lgkmcnt(14)
  v_mfma_f32_16x16x32_bf16 v[104:107], a[16:19], v[168:171], v[104:107]
  ds_read_b64_tr_b16 v[200:201], v20 offset:33024
  ds_read_b64_tr_b16 v[202:203], v21 offset:33024
  v_mfma_f32_16x16x32_bf16 v[136:139], a[24:27], v[168:171], v[136:139]
  ds_read_b64_tr_b16 v[204:205], v20 offset:35072
  ds_read_b64_tr_b16 v[206:207], v21 offset:35072
  s_waitcnt lgkmcnt(15)
  v_mfma_f32_16x16x32_bf16 v[108:111], a[16:19], v[172:175], v[108:111]
  ds_read_b64_tr_b16 v[208:209], v20 offset:37120
  ds_read_b64_tr_b16 v[210:211], v21 offset:37120
  v_mfma_f32_16x16x32_bf16 v[140:143], a[24:27], v[172:175], v[140:143]
  ds_read_b64_tr_b16 v[212:213], v20 offset:39168
  ds_read_b64_tr_b16 v[214:215], v21 offset:39168
  s_waitcnt lgkmcnt(15)
  v_mfma_f32_16x16x32_bf16 v[112:115], a[16:19], v[176:179], v[112:115]
  ds_read_b64_tr_b16 v[216:217], v20 offset:41216
  ds_read_b64_tr_b16 v[218:219], v21 offset:41216
  v_mfma_f32_16x16x32_bf16 v[144:147], a[24:27], v[176:179], v[144:147]
  ds_read_b64_tr_b16 v[220:221], v20 offset:43264
  ds_read_b64_tr_b16 v[222:223], v21 offset:43264
  s_waitcnt lgkmcnt(15)
  v_mfma_f32_16x16x32_bf16 v[116:119], a[16:19], v[180:183], v[116:119]
  ds_read_b64_tr_b16 v[224:225], v20 offset:45312
  ds_read_b64_tr_b16 v[226:227], v21 offset:45312
  v_mfma_f32_16x16x32_bf16 v[148:151], a[24:27], v[180:183], v[148:151]
  ds_read_b64_tr_b16 v[228:229], v20 offset:47360
  ds_read_b64_tr_b16 v[230:231], v21 offset:47360
  s_waitcnt lgkmcnt(15)
  v_mfma_f32_16x16x32_bf16 v[120:123], a[16:19], v[184:187], v[120:123]
  s_add_u32 m0, s65, 4096
  s_nop 0
  buffer_load_dwordx4 v17, s[56:59], s64 offen offset:0 sc1 lds
  v_mfma_f32_16x16x32_bf16 v[152:155], a[24:27], v[184:187], v[152:155]
  s_waitcnt lgkmcnt(15)
  v_mfma_f32_16x16x32_bf16 v[124:127], a[16:19], v[188:191], v[124:127]
  buffer_load_dwordx4 v17, s[56:59], s64 offen offset:1024 sc1 lds
  v_mfma_f32_16x16x32_bf16 v[156:159], a[24:27], v[188:191], v[156:159]
  s_waitcnt lgkmcnt(15)
  v_mfma_f32_16x16x32_bf16 v[128:131], a[16:19], v[192:195], v[128:131]
  buffer_load_dwordx4 v17, s[56:59], s64 offen offset:2048 sc1 lds
  v_mfma_f32_16x16x32_bf16 v[160:163], a[24:27], v[192:195], v[160:163]
  s_waitcnt lgkmcnt(15)
  v_mfma_f32_16x16x32_bf16 v[132:135], a[16:19], v[196:199], v[132:135]
  buffer_load_dwordx4 v17, s[56:59], s64 offen offset:3072 sc1 lds
  s_add_u32 s64, s64, 32768
  s_and_b32 s64, s64, 0x7ffff
  v_mfma_f32_16x16x32_bf16 v[164:167], a[24:27], v[196:199], v[164:167]
  s_waitcnt vmcnt(16) lgkmcnt(0)
  s_barrier
  v_mfma_f32_16x16x32_bf16 v[104:107], a[20:23], v[200:203], v[104:107]
  ds_read_b64_tr_b16 v[168:169], v22 offset:0
  ds_read_b64_tr_b16 v[170:171], v23 offset:0
  v_mfma_f32_16x16x32_bf16 v[136:139], a[28:31], v[200:203], v[136:139]
  ds_read_b64_tr_b16 v[172:173], v22 offset:2048
  ds_read_b64_tr_b16 v[174:175], v23 offset:2048
  v_mfma_f32_16x16x32_bf16 v[108:111], a[20:23], v[204:207], v[108:111]
  ds_read_b64_tr_b16 v[176:177], v22 offset:4096
  ds_read_b64_tr_b16 v[178:179], v23 offset:4096
  v_mfma_f32_16x16x32_bf16 v[140:143], a[28:31], v[204:207], v[140:143]
  ds_read_b64_tr_b16 v[180:181], v22 offset:6144
  ds_read_b64_tr_b16 v[182:183], v23 offset:6144
  v_mfma_f32_16x16x32_bf16 v[112:115], a[20:23], v[208:211], v[112:115]
  ds_read_b64_tr_b16 v[184:185], v22 offset:8192
  ds_read_b64_tr_b16 v[186:187], v23 offset:8192
  v_mfma_f32_16x16x32_bf16 v[144:147], a[28:31], v[208:211], v[144:147]
  ds_read_b64_tr_b16 v[188:189], v22 offset:10240
  ds_read_b64_tr_b16 v[190:191], v23 offset:10240
  v_mfma_f32_16x16x32_bf16 v[116:119], a[20:23], v[212:215], v[116:119]
  ds_read_b64_tr_b16 v[192:193], v22 offset:12288
  ds_read_b64_tr_b16 v[194:195], v23 offset:12288
  v_mfma_f32_16x16x32_bf16 v[148:151], a[28:31], v[212:215], v[148:151]
  ds_read_b64_tr_b16 v[196:197], v22 offset:14336
  ds_read_b64_tr_b16 v[198:199], v23 offset:14336
  v_mfma_f32_16x16x32_bf16 v[120:123], a[20:23], v[216:219], v[120:123]
  s_add_u32 m0, s65, 32768
  s_nop 0
  buffer_load_dwordx4 v16, s[56:59], s64 offen offset:0 sc1 lds
  v_mfma_f32_16x16x32_bf16 v[152:155], a[28:31], v[216:219], v[152:155]
  v_mfma_f32_16x16x32_bf16 v[124:127], a[20:23], v[220:223], v[124:127]
  buffer_load_dwordx4 v16, s[56:59], s64 offen offset:1024 sc1 lds
  v_mfma_f32_16x16x32_bf16 v[156:159], a[28:31], v[220:223], v[156:159]
  v_mfma_f32_16x16x32_bf16 v[128:131], a[20:23], v[224:227], v[128:131]
  buffer_load_dwordx4 v16, s[56:59], s64 offen offset:2048 sc1 lds
  v_mfma_f32_16x16x32_bf16 v[160:163], a[28:31], v[224:227], v[160:163]
  v_mfma_f32_16x16x32_bf16 v[132:135], a[20:23], v[228:231], v[132:135]
  buffer_load_dwordx4 v16, s[56:59], s64 offen offset:3072 sc1 lds
  v_mfma_f32_16x16x32_bf16 v[164:167], a[28:31], v[228:231], v[164:167]
  s_waitcnt lgkmcnt(14)
  v_mfma_f32_16x16x32_bf16 v[104:107], a[32:35], v[168:171], v[104:107]
  ds_read_b64_tr_b16 v[200:201], v22 offset:256
  ds_read_b64_tr_b16 v[202:203], v23 offset:256
  v_mfma_f32_16x16x32_bf16 v[136:139], a[40:43], v[168:171], v[136:139]
  ds_read_b64_tr_b16 v[204:205], v22 offset:2304
  ds_read_b64_tr_b16 v[206:207], v23 offset:2304
  s_waitcnt lgkmcnt(15)
  v_mfma_f32_16x16x32_bf16 v[108:111], a[32:35], v[172:175], v[108:111]
  ds_read_b64_tr_b16 v[208:209], v22 offset:4352
  ds_read_b64_tr_b16 v[210:211], v23 offset:4352
  v_mfma_f32_16x16x32_bf16 v[140:143], a[40:43], v[172:175], v[140:143]
  ds_read_b64_tr_b16 v[212:213], v22 offset:6400
  ds_read_b64_tr_b16 v[214:215], v23 offset:6400
  s_waitcnt lgkmcnt(15)
  v_mfma_f32_16x16x32_bf16 v[112:115], a[32:35], v[176:179], v[112:115]
  ds_read_b64_tr_b16 v[216:217], v22 offset:8448
  ds_read_b64_tr_b16 v[218:219], v23 offset:8448
  v_mfma_f32_16x16x32_bf16 v[144:147], a[40:43], v[176:179], v[144:147]
  ds_read_b64_tr_b16 v[220:221], v22 offset:10496
  ds_read_b64_tr_b16 v[222:223], v23 offset:10496
  s_waitcnt lgkmcnt(15)
  v_mfma_f32_16x16x32_bf16 v[116:119], a[32:35], v[180:183], v[116:119]
  ds_read_b64_tr_b16 v[224:225], v22 offset:12544
  ds_read_b64_tr_b16 v[226:227], v23 offset:12544
  v_mfma_f32_16x16x32_bf16 v[148:151], a[40:43], v[180:183], v[148:151]
  ds_read_b64_tr_b16 v[228:229], v22 offset:14592
  ds_read_b64_tr_b16 v[230:231], v23 offset:14592
  s_waitcnt lgkmcnt(15)
  v_mfma_f32_16x16x32_bf16 v[120:123], a[32:35], v[184:187], v[120:123]
  s_add_u32 m0, s65, 36864
  s_nop 0
  buffer_load_dwordx4 v17, s[56:59], s64 offen offset:0 sc1 lds
  v_mfma_f32_16x16x32_bf16 v[152:155], a[40:43], v[184:187], v[152:155]
  s_waitcnt lgkmcnt(15)
  v_mfma_f32_16x16x32_bf16 v[124:127], a[32:35], v[188:191], v[124:127]
  buffer_load_dwordx4 v17, s[56:59], s64 offen offset:1024 sc1 lds
  v_mfma_f32_16x16x32_bf16 v[156:159], a[40:43], v[188:191], v[156:159]
  s_waitcnt lgkmcnt(15)
  v_mfma_f32_16x16x32_bf16 v[128:131], a[32:35], v[192:195], v[128:131]
  buffer_load_dwordx4 v17, s[56:59], s64 offen offset:2048 sc1 lds
  v_mfma_f32_16x16x32_bf16 v[160:163], a[40:43], v[192:195], v[160:163]
  s_waitcnt lgkmcnt(15)
  v_mfma_f32_16x16x32_bf16 v[132:135], a[32:35], v[196:199], v[132:135]
  buffer_load_dwordx4 v17, s[56:59], s64 offen offset:3072 sc1 lds
  s_add_u32 s64, s64, 32768
  s_and_b32 s64, s64, 0x7ffff
  v_mfma_f32_16x16x32_bf16 v[164:167], a[40:43], v[196:199], v[164:167]
  s_waitcnt vmcnt(16) lgkmcnt(0)
  s_barrier
  v_mfma_f32_16x16x32_bf16 v[104:107], a[36:39], v[200:203], v[104:107]
  ds_read_b64_tr_b16 v[168:169], v22 offset:32768
  ds_read_b64_tr_b16 v[170:171], v23 offset:32768
  v_mfma_f32_16x16x32_bf16 v[136:139], a[44:47], v[200:203], v[136:139]
  ds_read_b64_tr_b16 v[172:173], v22 offset:34816
  ds_read_b64_tr_b16 v[174:175], v23 offset:34816
  v_mfma_f32_16x16x32_bf16 v[108:111], a[36:39], v[204:207], v[108:111]
  ds_read_b64_tr_b16 v[176:177], v22 offset:36864
  ds_read_b64_tr_b16 v[178:179], v23 offset:36864
  v_mfma_f32_16x16x32_bf16 v[140:143], a[44:47], v[204:207], v[140:143]
  ds_read_b64_tr_b16 v[180:181], v22 offset:38912
  ds_read_b64_tr_b16 v[182:183], v23 offset:38912
  v_mfma_f32_16x16x32_bf16 v[112:115], a[36:39], v[208:211], v[112:115]
  ds_read_b64_tr_b16 v[184:185], v22 offset:40960
  ds_read_b64_tr_b16 v[186:187], v23 offset:40960
  v_mfma_f32_16x16x32_bf16 v[144:147], a[44:47], v[208:211], v[144:147]
  ds_read_b64_tr_b16 v[188:189], v22 offset:43008
  ds_read_b64_tr_b16 v[190:191], v23 offset:43008
  v_mfma_f32_16x16x32_bf16 v[116:119], a[36:39], v[212:215], v[116:119]
  ds_read_b64_tr_b16 v[192:193], v22 offset:45056
  ds_read_b64_tr_b16 v[194:195], v23 offset:45056
  v_mfma_f32_16x16x32_bf16 v[148:151], a[44:47], v[212:215], v[148:151]
  ds_read_b64_tr_b16 v[196:197], v22 offset:47104
  ds_read_b64_tr_b16 v[198:199], v23 offset:47104
  v_mfma_f32_16x16x32_bf16 v[120:123], a[36:39], v[216:219], v[120:123]
  s_add_u32 m0, s65, 65536
  s_nop 0
  buffer_load_dwordx4 v16, s[56:59], s64 offen offset:0 sc1 lds
  v_mfma_f32_16x16x32_bf16 v[152:155], a[44:47], v[216:219], v[152:155]
  v_mfma_f32_16x16x32_bf16 v[124:127], a[36:39], v[220:223], v[124:127]
  buffer_load_dwordx4 v16, s[56:59], s64 offen offset:1024 sc1 lds
  v_mfma_f32_16x16x32_bf16 v[156:159], a[44:47], v[220:223], v[156:159]
  v_mfma_f32_16x16x32_bf16 v[128:131], a[36:39], v[224:227], v[128:131]
  buffer_load_dwordx4 v16, s[56:59], s64 offen offset:2048 sc1 lds
  v_mfma_f32_16x16x32_bf16 v[160:163], a[44:47], v[224:227], v[160:163]
  v_mfma_f32_16x16x32_bf16 v[132:135], a[36:39], v[228:231], v[132:135]
  buffer_load_dwordx4 v16, s[56:59], s64 offen offset:3072 sc1 lds
  v_mfma_f32_16x16x32_bf16 v[164:167], a[44:47], v[228:231], v[164:167]
  s_waitcnt lgkmcnt(14)
  v_mfma_f32_16x16x32_bf16 v[104:107], a[48:51], v[168:171], v[104:107]
  ds_read_b64_tr_b16 v[200:201], v22 offset:33024
  ds_read_b64_tr_b16 v[202:203], v23 offset:33024
  v_mfma_f32_16x16x32_bf16 v[136:139], a[56:59], v[168:171], v[136:139]
  ds_read_b64_tr_b16 v[204:205], v22 offset:35072
  ds_read_b64_tr_b16 v[206:207], v23 offset:35072
  s_waitcnt lgkmcnt(15)
  v_mfma_f32_16x16x32_bf16 v[108:111], a[48:51], v[172:175], v[108:111]
  ds_read_b64_tr_b16 v[208:209], v22 offset:37120
  ds_read_b64_tr_b16 v[210:211], v23 offset:37120
  v_mfma_f32_16x16x32_bf16 v[140:143], a[56:59], v[172:175], v[140:143]
  ds_read_b64_tr_b16 v[212:213], v22 offset:39168
  ds_read_b64_tr_b16 v[214:215], v23 offset:39168
  s_waitcnt lgkmcnt(15)
  v_mfma_f32_16x16x32_bf16 v[112:115], a[48:51], v[176:179], v[112:115]
  ds_read_b64_tr_b16 v[216:217], v22 offset:41216
  ds_read_b64_tr_b16 v[218:219], v23 offset:41216
  v_mfma_f32_16x16x32_bf16 v[144:147], a[56:59], v[176:179], v[144:147]
  ds_read_b64_tr_b16 v[220:221], v22 offset:43264
  ds_read_b64_tr_b16 v[222:223], v23 offset:43264
  s_waitcnt lgkmcnt(15)
  v_mfma_f32_16x16x32_bf16 v[116:119], a[48:51], v[180:183], v[116:119]
  ds_read_b64_tr_b16 v[224:225], v22 offset:45312
  ds_read_b64_tr_b16 v[226:227], v23 offset:45312
  v_mfma_f32_16x16x32_bf16 v[148:151], a[56:59], v[180:183], v[148:151]
  ds_read_b64_tr_b16 v[228:229], v22 offset:47360
  ds_read_b64_tr_b16 v[230:231], v23 offset:47360
  s_waitcnt lgkmcnt(15)
  v_mfma_f32_16x16x32_bf16 v[120:123], a[48:51], v[184:187], v[120:123]
  s_add_u32 m0, s65, 69632
  s_nop 0
  buffer_load_dwordx4 v17, s[56:59], s64 offen offset:0 sc1 lds
  v_mfma_f32_16x16x32_bf16 v[152:155], a[56:59], v[184:187], v[152:155]
  s_waitcnt lgkmcnt(15)
  v_mfma_f32_16x16x32_bf16 v[124:127], a[48:51], v[188:191], v[124:127]
  buffer_load_dwordx4 v17, s[56:59], s64 offen offset:1024 sc1 lds
  v_mfma_f32_16x16x32_bf16 v[156:159], a[56:59], v[188:191], v[156:159]
  s_waitcnt lgkmcnt(15)
  v_mfma_f32_16x16x32_bf16 v[128:131], a[48:51], v[192:195], v[128:131]
  buffer_load_dwordx4 v17, s[56:59], s64 offen offset:2048 sc1 lds
  v_mfma_f32_16x16x32_bf16 v[160:163], a[56:59], v[192:195], v[160:163]
  s_waitcnt lgkmcnt(15)
  v_mfma_f32_16x16x32_bf16 v[132:135], a[48:51], v[196:199], v[132:135]
  buffer_load_dwordx4 v17, s[56:59], s64 offen offset:3072 sc1 lds
  s_add_u32 s64, s64, 32768
  s_and_b32 s64, s64, 0x7ffff
  v_mfma_f32_16x16x32_bf16 v[164:167], a[56:59], v[196:199], v[164:167]
  s_waitcnt vmcnt(16) lgkmcnt(0)
  s_barrier
  v_mfma_f32_16x16x32_bf16 v[104:107], a[52:55], v[200:203], v[104:107]
  ds_read_b64_tr_b16 v[168:169], v20 offset:0
  ds_read_b64_tr_b16 v[170:171], v21 offset:0
  v_mfma_f32_16x16x32_bf16 v[136:139], a[60:63], v[200:203], v[136:139]
  ds_read_b64_tr_b16 v[172:173], v20 offset:2048
  ds_read_b64_tr_b16 v[174:175], v21 offset:2048
  v_mfma_f32_16x16x32_bf16 v[108:111], a[52:55], v[204:207], v[108:111]
  ds_read_b64_tr_b16 v[176:177], v20 offset:4096
  ds_read_b64_tr_b16 v[178:179], v21 offset:4096
  v_mfma_f32_16x16x32_bf16 v[140:143], a[60:63], v[204:207], v[140:143]
  ds_read_b64_tr_b16 v[180:181], v20 offset:6144
  ds_read_b64_tr_b16 v[182:183], v21 offset:6144
  v_mfma_f32_16x16x32_bf16 v[112:115], a[52:55], v[208:211], v[112:115]
  ds_read_b64_tr_b16 v[184:185], v20 offset:8192
  ds_read_b64_tr_b16 v[186:187], v21 offset:8192
  v_mfma_f32_16x16x32_bf16 v[144:147], a[60:63], v[208:211], v[144:147]
  ds_read_b64_tr_b16 v[188:189], v20 offset:10240
  ds_read_b64_tr_b16 v[190:191], v21 offset:10240
  v_mfma_f32_16x16x32_bf16 v[116:119], a[52:55], v[212:215], v[116:119]
  ds_read_b64_tr_b16 v[192:193], v20 offset:12288
  ds_read_b64_tr_b16 v[194:195], v21 offset:12288
  v_mfma_f32_16x16x32_bf16 v[148:151], a[60:63], v[212:215], v[148:151]
  ds_read_b64_tr_b16 v[196:197], v20 offset:14336
  ds_read_b64_tr_b16 v[198:199], v21 offset:14336
  v_mfma_f32_16x16x32_bf16 v[120:123], a[52:55], v[216:219], v[120:123]
  s_add_u32 m0, s65, 98304
  s_nop 0
  buffer_load_dwordx4 v16, s[56:59], s64 offen offset:0 sc1 lds
  v_mfma_f32_16x16x32_bf16 v[152:155], a[60:63], v[216:219], v[152:155]
  v_mfma_f32_16x16x32_bf16 v[124:127], a[52:55], v[220:223], v[124:127]
  buffer_load_dwordx4 v16, s[56:59], s64 offen offset:1024 sc1 lds
  v_mfma_f32_16x16x32_bf16 v[156:159], a[60:63], v[220:223], v[156:159]
  v_mfma_f32_16x16x32_bf16 v[128:131], a[52:55], v[224:227], v[128:131]
  buffer_load_dwordx4 v16, s[56:59], s64 offen offset:2048 sc1 lds
  v_mfma_f32_16x16x32_bf16 v[160:163], a[60:63], v[224:227], v[160:163]
  v_mfma_f32_16x16x32_bf16 v[132:135], a[52:55], v[228:231], v[132:135]
  buffer_load_dwordx4 v16, s[56:59], s64 offen offset:3072 sc1 lds
  v_mfma_f32_16x16x32_bf16 v[164:167], a[60:63], v[228:231], v[164:167]
  s_waitcnt lgkmcnt(14)
  v_mfma_f32_16x16x32_bf16 v[104:107], a[64:67], v[168:171], v[104:107]
  ds_read_b64_tr_b16 v[200:201], v20 offset:256
  ds_read_b64_tr_b16 v[202:203], v21 offset:256
  v_mfma_f32_16x16x32_bf16 v[136:139], a[72:75], v[168:171], v[136:139]
  ds_read_b64_tr_b16 v[204:205], v20 offset:2304
  ds_read_b64_tr_b16 v[206:207], v21 offset:2304
  s_waitcnt lgkmcnt(15)
  v_mfma_f32_16x16x32_bf16 v[108:111], a[64:67], v[172:175], v[108:111]
  ds_read_b64_tr_b16 v[208:209], v20 offset:4352
  ds_read_b64_tr_b16 v[210:211], v21 offset:4352
  v_mfma_f32_16x16x32_bf16 v[140:143], a[72:75], v[172:175], v[140:143]
  ds_read_b64_tr_b16 v[212:213], v20 offset:6400
  ds_read_b64_tr_b16 v[214:215], v21 offset:6400
  s_waitcnt lgkmcnt(15)
  v_mfma_f32_16x16x32_bf16 v[112:115], a[64:67], v[176:179], v[112:115]
  ds_read_b64_tr_b16 v[216:217], v20 offset:8448
  ds_read_b64_tr_b16 v[218:219], v21 offset:8448
  v_mfma_f32_16x16x32_bf16 v[144:147], a[72:75], v[176:179], v[144:147]
  ds_read_b64_tr_b16 v[220:221], v20 offset:10496
  ds_read_b64_tr_b16 v[222:223], v21 offset:10496
  s_waitcnt lgkmcnt(15)
  v_mfma_f32_16x16x32_bf16 v[116:119], a[64:67], v[180:183], v[116:119]
  ds_read_b64_tr_b16 v[224:225], v20 offset:12544
  ds_read_b64_tr_b16 v[226:227], v21 offset:12544
  v_mfma_f32_16x16x32_bf16 v[148:151], a[72:75], v[180:183], v[148:151]
  ds_read_b64_tr_b16 v[228:229], v20 offset:14592
  ds_read_b64_tr_b16 v[230:231], v21 offset:14592
  s_waitcnt lgkmcnt(15)
  v_mfma_f32_16x16x32_bf16 v[120:123], a[64:67], v[184:187], v[120:123]
  s_add_u32 m0, s65, 102400
  s_nop 0
  buffer_load_dwordx4 v17, s[56:59], s64 offen offset:0 sc1 lds
  v_mfma_f32_16x16x32_bf16 v[152:155], a[72:75], v[184:187], v[152:155]
  s_waitcnt lgkmcnt(15)
  v_mfma_f32_16x16x32_bf16 v[124:127], a[64:67], v[188:191], v[124:127]
  buffer_load_dwordx4 v17, s[56:59], s64 offen offset:1024 sc1 lds
  v_mfma_f32_16x16x32_bf16 v[156:159], a[72:75], v[188:191], v[156:159]
  s_waitcnt lgkmcnt(15)
  v_mfma_f32_16x16x32_bf16 v[128:131], a[64:67], v[192:195], v[128:131]
  buffer_load_dwordx4 v17, s[56:59], s64 offen offset:2048 sc1 lds
  v_mfma_f32_16x16x32_bf16 v[160:163], a[72:75], v[192:195], v[160:163]
  s_waitcnt lgkmcnt(15)
  v_mfma_f32_16x16x32_bf16 v[132:135], a[64:67], v[196:199], v[132:135]
  buffer_load_dwordx4 v17, s[56:59], s64 offen offset:3072 sc1 lds
  s_add_u32 s64, s64, 32768
  s_and_b32 s64, s64, 0x7ffff
  v_mfma_f32_16x16x32_bf16 v[164:167], a[72:75], v[196:199], v[164:167]
  s_waitcnt vmcnt(16) lgkmcnt(0)
  s_barrier
  v_mfma_f32_16x16x32_bf16 v[104:107], a[68:71], v[200:203], v[104:107]
  ds_read_b64_tr_b16 v[168:169], v20 offset:32768
  ds_read_b64_tr_b16 v[170:171], v21 offset:32768
  v_mfma_f32_16x16x32_bf16 v[136:139], a[76:79], v[200:203], v[136:139]
  ds_read_b64_tr_b16 v[172:173], v20 offset:34816
  ds_read_b64_tr_b16 v[174:175], v21 offset:34816
  v_mfma_f32_16x16x32_bf16 v[108:111], a[68:71], v[204:207], v[108:111]
  ds_read_b64_tr_b16 v[176:177], v20 offset:36864
  ds_read_b64_tr_b16 v[178:179], v21 offset:36864
  v_mfma_f32_16x16x32_bf16 v[140:143], a[76:79], v[204:207], v[140:143]
  ds_read_b64_tr_b16 v[180:181], v20 offset:38912
  ds_read_b64_tr_b16 v[182:183], v21 offset:38912
  v_mfma_f32_16x16x32_bf16 v[112:115], a[68:71], v[208:211], v[112:115]
  ds_read_b64_tr_b16 v[184:185], v20 offset:40960
  ds_read_b64_tr_b16 v[186:187], v21 offset:40960
  v_mfma_f32_16x16x32_bf16 v[144:147], a[76:79], v[208:211], v[144:147]
  ds_read_b64_tr_b16 v[188:189], v20 offset:43008
  ds_read_b64_tr_b16 v[190:191], v21 offset:43008
  v_mfma_f32_16x16x32_bf16 v[116:119], a[68:71], v[212:215], v[116:119]
  ds_read_b64_tr_b16 v[192:193], v20 offset:45056
  ds_read_b64_tr_b16 v[194:195], v21 offset:45056
  v_mfma_f32_16x16x32_bf16 v[148:151], a[76:79], v[212:215], v[148:151]
  ds_read_b64_tr_b16 v[196:197], v20 offset:47104
  ds_read_b64_tr_b16 v[198:199], v21 offset:47104
  v_mfma_f32_16x16x32_bf16 v[120:123], a[68:71], v[216:219], v[120:123]
  s_add_u32 m0, s65, 0
  s_nop 0
  buffer_load_dwordx4 v16, s[56:59], s64 offen offset:0 sc1 lds
  v_mfma_f32_16x16x32_bf16 v[152:155], a[76:79], v[216:219], v[152:155]
  v_mfma_f32_16x16x32_bf16 v[124:127], a[68:71], v[220:223], v[124:127]
  buffer_load_dwordx4 v16, s[56:59], s64 offen offset:1024 sc1 lds
  v_mfma_f32_16x16x32_bf16 v[156:159], a[76:79], v[220:223], v[156:159]
  v_mfma_f32_16x16x32_bf16 v[128:131], a[68:71], v[224:227], v[128:131]
  buffer_load_dwordx4 v16, s[56:59], s64 offen offset:2048 sc1 lds
  v_mfma_f32_16x16x32_bf16 v[160:163], a[76:79], v[224:227], v[160:163]
  v_mfma_f32_16x16x32_bf16 v[132:135], a[68:71], v[228:231], v[132:135]
  buffer_load_dwordx4 v16, s[56:59], s64 offen offset:3072 sc1 lds
  v_mfma_f32_16x16x32_bf16 v[164:167], a[76:79], v[228:231], v[164:167]
  s_waitcnt lgkmcnt(14)
  v_mfma_f32_16x16x32_bf16 v[104:107], a[80:83], v[168:171], v[104:107]
  ds_read_b64_tr_b16 v[200:201], v20 offset:33024
  ds_read_b64_tr_b16 v[202:203], v21 offset:33024
  v_mfma_f32_16x16x32_bf16 v[136:139], a[88:91], v[168:171], v[136:139]
  ds_read_b64_tr_b16 v[204:205], v20 offset:35072
  ds_read_b64_tr_b16 v[206:207], v21 offset:35072
  s_waitcnt lgkmcnt(15)
  v_mfma_f32_16x16x32_bf16 v[108:111], a[80:83], v[172:175], v[108:111]
  ds_read_b64_tr_b16 v[208:209], v20 offset:37120
  ds_read_b64_tr_b16 v[210:211], v21 offset:37120
  v_mfma_f32_16x16x32_bf16 v[140:143], a[88:91], v[172:175], v[140:143]
  ds_read_b64_tr_b16 v[212:213], v20 offset:39168
  ds_read_b64_tr_b16 v[214:215], v21 offset:39168
  s_waitcnt lgkmcnt(15)
  v_mfma_f32_16x16x32_bf16 v[112:115], a[80:83], v[176:179], v[112:115]
  ds_read_b64_tr_b16 v[216:217], v20 offset:41216
  ds_read_b64_tr_b16 v[218:219], v21 offset:41216
  v_mfma_f32_16x16x32_bf16 v[144:147], a[88:91], v[176:179], v[144:147]
  ds_read_b64_tr_b16 v[220:221], v20 offset:43264
  ds_read_b64_tr_b16 v[222:223], v21 offset:43264
  s_waitcnt lgkmcnt(15)
  v_mfma_f32_16x16x32_bf16 v[116:119], a[80:83], v[180:183], v[116:119]
  ds_read_b64_tr_b16 v[224:225], v20 offset:45312
  ds_read_b64_tr_b16 v[226:227], v21 offset:45312
  v_mfma_f32_16x16x32_bf16 v[148:151], a[88:91], v[180:183], v[148:151]
  ds_read_b64_tr_b16 v[228:229], v20 offset:47360
  ds_read_b64_tr_b16 v[230:231], v21 offset:47360
  s_waitcnt lgkmcnt(15)
  v_mfma_f32_16x16x32_bf16 v[120:123], a[80:83], v[184:187], v[120:123]
  s_add_u32 m0, s65, 4096
  s_nop 0
  buffer_load_dwordx4 v17, s[56:59], s64 offen offset:0 sc1 lds
  v_mfma_f32_16x16x32_bf16 v[152:155], a[88:91], v[184:187], v[152:155]
  s_waitcnt lgkmcnt(15)
  v_mfma_f32_16x16x32_bf16 v[124:127], a[80:83], v[188:191], v[124:127]
  buffer_load_dwordx4 v17, s[56:59], s64 offen offset:1024 sc1 lds
  v_mfma_f32_16x16x32_bf16 v[156:159], a[88:91], v[188:191], v[156:159]
  s_waitcnt lgkmcnt(15)
  v_mfma_f32_16x16x32_bf16 v[128:131], a[80:83], v[192:195], v[128:131]
  buffer_load_dwordx4 v17, s[56:59], s64 offen offset:2048 sc1 lds
  v_mfma_f32_16x16x32_bf16 v[160:163], a[88:91], v[192:195], v[160:163]
  s_waitcnt lgkmcnt(15)
  v_mfma_f32_16x16x32_bf16 v[132:135], a[80:83], v[196:199], v[132:135]
  buffer_load_dwordx4 v17, s[56:59], s64 offen offset:3072 sc1 lds
  s_add_u32 s64, s64, 32768
  s_and_b32 s64, s64, 0x7ffff
  v_mfma_f32_16x16x32_bf16 v[164:167], a[88:91], v[196:199], v[164:167]
  s_waitcnt vmcnt(16) lgkmcnt(0)
  s_barrier
  v_mfma_f32_16x16x32_bf16 v[104:107], a[84:87], v[200:203], v[104:107]
  ds_read_b64_tr_b16 v[168:169], v22 offset:0
  ds_read_b64_tr_b16 v[170:171], v23 offset:0
  v_mfma_f32_16x16x32_bf16 v[136:139], a[92:95], v[200:203], v[136:139]
  ds_read_b64_tr_b16 v[172:173], v22 offset:2048
  ds_read_b64_tr_b16 v[174:175], v23 offset:2048
  v_mfma_f32_16x16x32_bf16 v[108:111], a[84:87], v[204:207], v[108:111]
  ds_read_b64_tr_b16 v[176:177], v22 offset:4096
  ds_read_b64_tr_b16 v[178:179], v23 offset:4096
  v_mfma_f32_16x16x32_bf16 v[140:143], a[92:95], v[204:207], v[140:143]
  ds_read_b64_tr_b16 v[180:181], v22 offset:6144
  ds_read_b64_tr_b16 v[182:183], v23 offset:6144
  v_mfma_f32_16x16x32_bf16 v[112:115], a[84:87], v[208:211], v[112:115]
  ds_read_b64_tr_b16 v[184:185], v22 offset:8192
  ds_read_b64_tr_b16 v[186:187], v23 offset:8192
  v_mfma_f32_16x16x32_bf16 v[144:147], a[92:95], v[208:211], v[144:147]
  ds_read_b64_tr_b16 v[188:189], v22 offset:10240
  ds_read_b64_tr_b16 v[190:191], v23 offset:10240
  v_mfma_f32_16x16x32_bf16 v[116:119], a[84:87], v[212:215], v[116:119]
  ds_read_b64_tr_b16 v[192:193], v22 offset:12288
  ds_read_b64_tr_b16 v[194:195], v23 offset:12288
  v_mfma_f32_16x16x32_bf16 v[148:151], a[92:95], v[212:215], v[148:151]
  ds_read_b64_tr_b16 v[196:197], v22 offset:14336
  ds_read_b64_tr_b16 v[198:199], v23 offset:14336
  v_mfma_f32_16x16x32_bf16 v[120:123], a[84:87], v[216:219], v[120:123]
  s_add_u32 m0, s65, 32768
  s_nop 0
  buffer_load_dwordx4 v16, s[56:59], s64 offen offset:0 sc1 lds
  v_mfma_f32_16x16x32_bf16 v[152:155], a[92:95], v[216:219], v[152:155]
  v_mfma_f32_16x16x32_bf16 v[124:127], a[84:87], v[220:223], v[124:127]
  buffer_load_dwordx4 v16, s[56:59], s64 offen offset:1024 sc1 lds
  v_mfma_f32_16x16x32_bf16 v[156:159], a[92:95], v[220:223], v[156:159]
  v_mfma_f32_16x16x32_bf16 v[128:131], a[84:87], v[224:227], v[128:131]
  buffer_load_dwordx4 v16, s[56:59], s64 offen offset:2048 sc1 lds
  v_mfma_f32_16x16x32_bf16 v[160:163], a[92:95], v[224:227], v[160:163]
  v_mfma_f32_16x16x32_bf16 v[132:135], a[84:87], v[228:231], v[132:135]
  buffer_load_dwordx4 v16, s[56:59], s64 offen offset:3072 sc1 lds
  v_mfma_f32_16x16x32_bf16 v[164:167], a[92:95], v[228:231], v[164:167]
  s_waitcnt lgkmcnt(14)
  v_mfma_f32_16x16x32_bf16 v[104:107], a[96:99], v[168:171], v[104:107]
  ds_read_b64_tr_b16 v[200:201], v22 offset:256
  ds_read_b64_tr_b16 v[202:203], v23 offset:256
  v_mfma_f32_16x16x32_bf16 v[136:139], a[104:107], v[168:171], v[136:139]
  ds_read_b64_tr_b16 v[204:205], v22 offset:2304
  ds_read_b64_tr_b16 v[206:207], v23 offset:2304
  s_waitcnt lgkmcnt(15)
  v_mfma_f32_16x16x32_bf16 v[108:111], a[96:99], v[172:175], v[108:111]
  ds_read_b64_tr_b16 v[208:209], v22 offset:4352
  ds_read_b64_tr_b16 v[210:211], v23 offset:4352
  v_mfma_f32_16x16x32_bf16 v[140:143], a[104:107], v[172:175], v[140:143]
  ds_read_b64_tr_b16 v[212:213], v22 offset:6400
  ds_read_b64_tr_b16 v[214:215], v23 offset:6400
  s_waitcnt lgkmcnt(15)
  v_mfma_f32_16x16x32_bf16 v[112:115], a[96:99], v[176:179], v[112:115]
  ds_read_b64_tr_b16 v[216:217], v22 offset:8448
  ds_read_b64_tr_b16 v[218:219], v23 offset:8448
  v_mfma_f32_16x16x32_bf16 v[144:147], a[104:107], v[176:179], v[144:147]
  ds_read_b64_tr_b16 v[220:221], v22 offset:10496
  ds_read_b64_tr_b16 v[222:223], v23 offset:10496
  s_waitcnt lgkmcnt(15)
  v_mfma_f32_16x16x32_bf16 v[116:119], a[96:99], v[180:183], v[116:119]
  ds_read_b64_tr_b16 v[224:225], v22 offset:12544
  ds_read_b64_tr_b16 v[226:227], v23 offset:12544
  v_mfma_f32_16x16x32_bf16 v[148:151], a[104:107], v[180:183], v[148:151]
  ds_read_b64_tr_b16 v[228:229], v22 offset:14592
  ds_read_b64_tr_b16 v[230:231], v23 offset:14592
  s_waitcnt lgkmcnt(15)
  v_mfma_f32_16x16x32_bf16 v[120:123], a[96:99], v[184:187], v[120:123]
  s_add_u32 m0, s65, 36864
  s_nop 0
  buffer_load_dwordx4 v17, s[56:59], s64 offen offset:0 sc1 lds
  v_mfma_f32_16x16x32_bf16 v[152:155], a[104:107], v[184:187], v[152:155]
  s_waitcnt lgkmcnt(15)
  v_mfma_f32_16x16x32_bf16 v[124:127], a[96:99], v[188:191], v[124:127]
  buffer_load_dwordx4 v17, s[56:59], s64 offen offset:1024 sc1 lds
  v_mfma_f32_16x16x32_bf16 v[156:159], a[104:107], v[188:191], v[156:159]
  s_waitcnt lgkmcnt(15)
  v_mfma_f32_16x16x32_bf16 v[128:131], a[96:99], v[192:195], v[128:131]
  buffer_load_dwordx4 v17, s[56:59], s64 offen offset:2048 sc1 lds
  v_mfma_f32_16x16x32_bf16 v[160:163], a[104:107], v[192:195], v[160:163]
  s_waitcnt lgkmcnt(15)
  v_mfma_f32_16x16x32_bf16 v[132:135], a[96:99], v[196:199], v[132:135]
  buffer_load_dwordx4 v17, s[56:59], s64 offen offset:3072 sc1 lds
  s_add_u32 s64, s64, 32768
  s_and_b32 s64, s64, 0x7ffff
  v_mfma_f32_16x16x32_bf16 v[164:167], a[104:107], v[196:199], v[164:167]
  s_waitcnt vmcnt(16) lgkmcnt(0)
  s_barrier
  v_mfma_f32_16x16x32_bf16 v[104:107], a[100:103], v[200:203], v[104:107]
  ds_read_b64_tr_b16 v[168:169], v22 offset:32768
  ds_read_b64_tr_b16 v[170:171], v23 offset:32768
  v_mfma_f32_16x16x32_bf16 v[136:139], a[108:111], v[200:203], v[136:139]
  ds_read_b64_tr_b16 v[172:173], v22 offset:34816
  ds_read_b64_tr_b16 v[174:175], v23 offset:34816
  v_mfma_f32_16x16x32_bf16 v[108:111], a[100:103], v[204:207], v[108:111]
  ds_read_b64_tr_b16 v[176:177], v22 offset:36864
  ds_read_b64_tr_b16 v[178:179], v23 offset:36864
  v_mfma_f32_16x16x32_bf16 v[140:143], a[108:111], v[204:207], v[140:143]
  ds_read_b64_tr_b16 v[180:181], v22 offset:38912
  ds_read_b64_tr_b16 v[182:183], v23 offset:38912
  v_mfma_f32_16x16x32_bf16 v[112:115], a[100:103], v[208:211], v[112:115]
  ds_read_b64_tr_b16 v[184:185], v22 offset:40960
  ds_read_b64_tr_b16 v[186:187], v23 offset:40960
  v_mfma_f32_16x16x32_bf16 v[144:147], a[108:111], v[208:211], v[144:147]
  ds_read_b64_tr_b16 v[188:189], v22 offset:43008
  ds_read_b64_tr_b16 v[190:191], v23 offset:43008
  v_mfma_f32_16x16x32_bf16 v[116:119], a[100:103], v[212:215], v[116:119]
  ds_read_b64_tr_b16 v[192:193], v22 offset:45056
  ds_read_b64_tr_b16 v[194:195], v23 offset:45056
  v_mfma_f32_16x16x32_bf16 v[148:151], a[108:111], v[212:215], v[148:151]
  ds_read_b64_tr_b16 v[196:197], v22 offset:47104
  ds_read_b64_tr_b16 v[198:199], v23 offset:47104
  v_mfma_f32_16x16x32_bf16 v[120:123], a[100:103], v[216:219], v[120:123]
  s_add_u32 m0, s65, 65536
  s_nop 0
  buffer_load_dwordx4 v16, s[56:59], s64 offen offset:0 sc1 lds
  v_mfma_f32_16x16x32_bf16 v[152:155], a[108:111], v[216:219], v[152:155]
  v_mfma_f32_16x16x32_bf16 v[124:127], a[100:103], v[220:223], v[124:127]
  buffer_load_dwordx4 v16, s[56:59], s64 offen offset:1024 sc1 lds
  v_mfma_f32_16x16x32_bf16 v[156:159], a[108:111], v[220:223], v[156:159]
  v_mfma_f32_16x16x32_bf16 v[128:131], a[100:103], v[224:227], v[128:131]
  buffer_load_dwordx4 v16, s[56:59], s64 offen offset:2048 sc1 lds
  v_mfma_f32_16x16x32_bf16 v[160:163], a[108:111], v[224:227], v[160:163]
  v_mfma_f32_16x16x32_bf16 v[132:135], a[100:103], v[228:231], v[132:135]
  buffer_load_dwordx4 v16, s[56:59], s64 offen offset:3072 sc1 lds
  v_mfma_f32_16x16x32_bf16 v[164:167], a[108:111], v[228:231], v[164:167]
  s_waitcnt lgkmcnt(14)
  v_mfma_f32_16x16x32_bf16 v[104:107], a[112:115], v[168:171], v[104:107]
  ds_read_b64_tr_b16 v[200:201], v22 offset:33024
  ds_read_b64_tr_b16 v[202:203], v23 offset:33024
  v_mfma_f32_16x16x32_bf16 v[136:139], a[120:123], v[168:171], v[136:139]
  ds_read_b64_tr_b16 v[204:205], v22 offset:35072
  ds_read_b64_tr_b16 v[206:207], v23 offset:35072
  s_waitcnt lgkmcnt(15)
  v_mfma_f32_16x16x32_bf16 v[108:111], a[112:115], v[172:175], v[108:111]
  ds_read_b64_tr_b16 v[208:209], v22 offset:37120
  ds_read_b64_tr_b16 v[210:211], v23 offset:37120
  v_mfma_f32_16x16x32_bf16 v[140:143], a[120:123], v[172:175], v[140:143]
  ds_read_b64_tr_b16 v[212:213], v22 offset:39168
  ds_read_b64_tr_b16 v[214:215], v23 offset:39168
  s_waitcnt lgkmcnt(15)
  v_mfma_f32_16x16x32_bf16 v[112:115], a[112:115], v[176:179], v[112:115]
  ds_read_b64_tr_b16 v[216:217], v22 offset:41216
  ds_read_b64_tr_b16 v[218:219], v23 offset:41216
  v_mfma_f32_16x16x32_bf16 v[144:147], a[120:123], v[176:179], v[144:147]
  ds_read_b64_tr_b16 v[220:221], v22 offset:43264
  ds_read_b64_tr_b16 v[222:223], v23 offset:43264
  s_waitcnt lgkmcnt(15)
  v_mfma_f32_16x16x32_bf16 v[116:119], a[112:115], v[180:183], v[116:119]
  ds_read_b64_tr_b16 v[224:225], v22 offset:45312
  ds_read_b64_tr_b16 v[226:227], v23 offset:45312
  v_mfma_f32_16x16x32_bf16 v[148:151], a[120:123], v[180:183], v[148:151]
  ds_read_b64_tr_b16 v[228:229], v22 offset:47360
  ds_read_b64_tr_b16 v[230:231], v23 offset:47360
  s_waitcnt lgkmcnt(15)
  v_mfma_f32_16x16x32_bf16 v[120:123], a[112:115], v[184:187], v[120:123]
  s_add_u32 m0, s65, 69632
  s_nop 0
  buffer_load_dwordx4 v17, s[56:59], s64 offen offset:0 sc1 lds
  v_mfma_f32_16x16x32_bf16 v[152:155], a[120:123], v[184:187], v[152:155]
  s_waitcnt lgkmcnt(15)
  v_mfma_f32_16x16x32_bf16 v[124:127], a[112:115], v[188:191], v[124:127]
  buffer_load_dwordx4 v17, s[56:59], s64 offen offset:1024 sc1 lds
  v_mfma_f32_16x16x32_bf16 v[156:159], a[120:123], v[188:191], v[156:159]
  s_waitcnt lgkmcnt(15)
  v_mfma_f32_16x16x32_bf16 v[128:131], a[112:115], v[192:195], v[128:131]
  buffer_load_dwordx4 v17, s[56:59], s64 offen offset:2048 sc1 lds
  v_mfma_f32_16x16x32_bf16 v[160:163], a[120:123], v[192:195], v[160:163]
  s_waitcnt lgkmcnt(15)
  v_mfma_f32_16x16x32_bf16 v[132:135], a[112:115], v[196:199], v[132:135]
  buffer_load_dwordx4 v17, s[56:59], s64 offen offset:3072 sc1 lds
  s_add_u32 s64, s64, 32768
  s_and_b32 s64, s64, 0x7ffff
  v_mfma_f32_16x16x32_bf16 v[164:167], a[120:123], v[196:199], v[164:167]
  s_waitcnt vmcnt(16) lgkmcnt(0)
  s_barrier
  v_mfma_f32_16x16x32_bf16 v[104:107], a[116:119], v[200:203], v[104:107]
  ds_read_b64_tr_b16 v[168:169], v20 offset:0
  ds_read_b64_tr_b16 v[170:171], v21 offset:0
  v_mfma_f32_16x16x32_bf16 v[136:139], a[124:127], v[200:203], v[136:139]
  ds_read_b64_tr_b16 v[172:173], v20 offset:2048
  ds_read_b64_tr_b16 v[174:175], v21 offset:2048
  v_mfma_f32_16x16x32_bf16 v[108:111], a[116:119], v[204:207], v[108:111]
  ds_read_b64_tr_b16 v[176:177], v20 offset:4096
  ds_read_b64_tr_b16 v[178:179], v21 offset:4096
  v_mfma_f32_16x16x32_bf16 v[140:143], a[124:127], v[204:207], v[140:143]
  ds_read_b64_tr_b16 v[180:181], v20 offset:6144
  ds_read_b64_tr_b16 v[182:183], v21 offset:6144
  v_mfma_f32_16x16x32_bf16 v[112:115], a[116:119], v[208:211], v[112:115]
  ds_read_b64_tr_b16 v[184:185], v20 offset:8192
  ds_read_b64_tr_b16 v[186:187], v21 offset:8192
  v_mfma_f32_16x16x32_bf16 v[144:147], a[124:127], v[208:211], v[144:147]
  ds_read_b64_tr_b16 v[188:189], v20 offset:10240
  ds_read_b64_tr_b16 v[190:191], v21 offset:10240
  v_mfma_f32_16x16x32_bf16 v[116:119], a[116:119], v[212:215], v[116:119]
  ds_read_b64_tr_b16 v[192:193], v20 offset:12288
  ds_read_b64_tr_b16 v[194:195], v21 offset:12288
  v_mfma_f32_16x16x32_bf16 v[148:151], a[124:127], v[212:215], v[148:151]
  ds_read_b64_tr_b16 v[196:197], v20 offset:14336
  ds_read_b64_tr_b16 v[198:199], v21 offset:14336
  v_mfma_f32_16x16x32_bf16 v[120:123], a[116:119], v[216:219], v[120:123]
  s_add_u32 m0, s65, 98304
  s_nop 0
  buffer_load_dwordx4 v16, s[56:59], s64 offen offset:0 sc1 lds
  v_mfma_f32_16x16x32_bf16 v[152:155], a[124:127], v[216:219], v[152:155]
  v_mfma_f32_16x16x32_bf16 v[124:127], a[116:119], v[220:223], v[124:127]
  buffer_load_dwordx4 v16, s[56:59], s64 offen offset:1024 sc1 lds
  v_mfma_f32_16x16x32_bf16 v[156:159], a[124:127], v[220:223], v[156:159]
  v_mfma_f32_16x16x32_bf16 v[128:131], a[116:119], v[224:227], v[128:131]
  buffer_load_dwordx4 v16, s[56:59], s64 offen offset:2048 sc1 lds
  v_mfma_f32_16x16x32_bf16 v[160:163], a[124:127], v[224:227], v[160:163]
  v_mfma_f32_16x16x32_bf16 v[132:135], a[116:119], v[228:231], v[132:135]
  buffer_load_dwordx4 v16, s[56:59], s64 offen offset:3072 sc1 lds
  v_mfma_f32_16x16x32_bf16 v[164:167], a[124:127], v[228:231], v[164:167]
  s_waitcnt lgkmcnt(14)
  v_mfma_f32_16x16x32_bf16 v[104:107], a[128:131], v[168:171], v[104:107]
  ds_read_b64_tr_b16 v[200:201], v20 offset:256
  ds_read_b64_tr_b16 v[202:203], v21 offset:256
  v_mfma_f32_16x16x32_bf16 v[136:139], a[136:139], v[168:171], v[136:139]
  ds_read_b64_tr_b16 v[204:205], v20 offset:2304
  ds_read_b64_tr_b16 v[206:207], v21 offset:2304
  s_waitcnt lgkmcnt(15)
  v_mfma_f32_16x16x32_bf16 v[108:111], a[128:131], v[172:175], v[108:111]
  ds_read_b64_tr_b16 v[208:209], v20 offset:4352
  ds_read_b64_tr_b16 v[210:211], v21 offset:4352
  v_mfma_f32_16x16x32_bf16 v[140:143], a[136:139], v[172:175], v[140:143]
  ds_read_b64_tr_b16 v[212:213], v20 offset:6400
  ds_read_b64_tr_b16 v[214:215], v21 offset:6400
  s_waitcnt lgkmcnt(15)
  v_mfma_f32_16x16x32_bf16 v[112:115], a[128:131], v[176:179], v[112:115]
  ds_read_b64_tr_b16 v[216:217], v20 offset:8448
  ds_read_b64_tr_b16 v[218:219], v21 offset:8448
  v_mfma_f32_16x16x32_bf16 v[144:147], a[136:139], v[176:179], v[144:147]
  ds_read_b64_tr_b16 v[220:221], v20 offset:10496
  ds_read_b64_tr_b16 v[222:223], v21 offset:10496
  s_waitcnt lgkmcnt(15)
  v_mfma_f32_16x16x32_bf16 v[116:119], a[128:131], v[180:183], v[116:119]
  ds_read_b64_tr_b16 v[224:225], v20 offset:12544
  ds_read_b64_tr_b16 v[226:227], v21 offset:12544
  v_mfma_f32_16x16x32_bf16 v[148:151], a[136:139], v[180:183], v[148:151]
  ds_read_b64_tr_b16 v[228:229], v20 offset:14592
  ds_read_b64_tr_b16 v[230:231], v21 offset:14592
  s_waitcnt lgkmcnt(15)
  v_mfma_f32_16x16x32_bf16 v[120:123], a[128:131], v[184:187], v[120:123]
  s_add_u32 m0, s65, 102400
  s_nop 0
  buffer_load_dwordx4 v17, s[56:59], s64 offen offset:0 sc1 lds
  v_mfma_f32_16x16x32_bf16 v[152:155], a[136:139], v[184:187], v[152:155]
  s_waitcnt lgkmcnt(15)
  v_mfma_f32_16x16x32_bf16 v[124:127], a[128:131], v[188:191], v[124:127]
  buffer_load_dwordx4 v17, s[56:59], s64 offen offset:1024 sc1 lds
  v_mfma_f32_16x16x32_bf16 v[156:159], a[136:139], v[188:191], v[156:159]
  s_waitcnt lgkmcnt(15)
  v_mfma_f32_16x16x32_bf16 v[128:131], a[128:131], v[192:195], v[128:131]
  buffer_load_dwordx4 v17, s[56:59], s64 offen offset:2048 sc1 lds
  v_mfma_f32_16x16x32_bf16 v[160:163], a[136:139], v[192:195], v[160:163]
  s_waitcnt lgkmcnt(15)
  v_mfma_f32_16x16x32_bf16 v[132:135], a[128:131], v[196:199], v[132:135]
  buffer_load_dwordx4 v17, s[56:59], s64 offen offset:3072 sc1 lds
  s_add_u32 s64, s64, 32768
  s_and_b32 s64, s64, 0x7ffff
  v_mfma_f32_16x16x32_bf16 v[164:167], a[136:139], v[196:199], v[164:167]
  s_waitcnt vmcnt(16) lgkmcnt(0)
  s_barrier
  v_mfma_f32_16x16x32_bf16 v[104:107], a[132:135], v[200:203], v[104:107]
  ds_read_b64_tr_b16 v[168:169], v20 offset:32768
  ds_read_b64_tr_b16 v[170:171], v21 offset:32768
  v_mfma_f32_16x16x32_bf16 v[136:139], a[140:143], v[200:203], v[136:139]
  ds_read_b64_tr_b16 v[172:173], v20 offset:34816
  ds_read_b64_tr_b16 v[174:175], v21 offset:34816
  v_mfma_f32_16x16x32_bf16 v[108:111], a[132:135], v[204:207], v[108:111]
  ds_read_b64_tr_b16 v[176:177], v20 offset:36864
  ds_read_b64_tr_b16 v[178:179], v21 offset:36864
  v_mfma_f32_16x16x32_bf16 v[140:143], a[140:143], v[204:207], v[140:143]
  ds_read_b64_tr_b16 v[180:181], v20 offset:38912
  ds_read_b64_tr_b16 v[182:183], v21 offset:38912
  v_mfma_f32_16x16x32_bf16 v[112:115], a[132:135], v[208:211], v[112:115]
  ds_read_b64_tr_b16 v[184:185], v20 offset:40960
  ds_read_b64_tr_b16 v[186:187], v21 offset:40960
  v_mfma_f32_16x16x32_bf16 v[144:147], a[140:143], v[208:211], v[144:147]
  ds_read_b64_tr_b16 v[188:189], v20 offset:43008
  ds_read_b64_tr_b16 v[190:191], v21 offset:43008
  v_mfma_f32_16x16x32_bf16 v[116:119], a[132:135], v[212:215], v[116:119]
  ds_read_b64_tr_b16 v[192:193], v20 offset:45056
  ds_read_b64_tr_b16 v[194:195], v21 offset:45056
  v_mfma_f32_16x16x32_bf16 v[148:151], a[140:143], v[212:215], v[148:151]
  ds_read_b64_tr_b16 v[196:197], v20 offset:47104
  ds_read_b64_tr_b16 v[198:199], v21 offset:47104
  v_mfma_f32_16x16x32_bf16 v[120:123], a[132:135], v[216:219], v[120:123]
  s_add_u32 m0, s65, 0
  s_nop 0
  buffer_load_dwordx4 v16, s[56:59], s64 offen offset:0 sc1 lds
  v_mfma_f32_16x16x32_bf16 v[152:155], a[140:143], v[216:219], v[152:155]
  v_mfma_f32_16x16x32_bf16 v[124:127], a[132:135], v[220:223], v[124:127]
  buffer_load_dwordx4 v16, s[56:59], s64 offen offset:1024 sc1 lds
  v_mfma_f32_16x16x32_bf16 v[156:159], a[140:143], v[220:223], v[156:159]
  v_mfma_f32_16x16x32_bf16 v[128:131], a[132:135], v[224:227], v[128:131]
  buffer_load_dwordx4 v16, s[56:59], s64 offen offset:2048 sc1 lds
  v_mfma_f32_16x16x32_bf16 v[160:163], a[140:143], v[224:227], v[160:163]
  v_mfma_f32_16x16x32_bf16 v[132:135], a[132:135], v[228:231], v[132:135]
  buffer_load_dwordx4 v16, s[56:59], s64 offen offset:3072 sc1 lds
  v_mfma_f32_16x16x32_bf16 v[164:167], a[140:143], v[228:231], v[164:167]
  s_waitcnt lgkmcnt(14)
  v_mfma_f32_16x16x32_bf16 v[104:107], a[144:147], v[168:171], v[104:107]
  ds_read_b64_tr_b16 v[200:201], v20 offset:33024
  ds_read_b64_tr_b16 v[202:203], v21 offset:33024
  v_mfma_f32_16x16x32_bf16 v[136:139], a[152:155], v[168:171], v[136:139]
  ds_read_b64_tr_b16 v[204:205], v20 offset:35072
  ds_read_b64_tr_b16 v[206:207], v21 offset:35072
  s_waitcnt lgkmcnt(15)
  v_mfma_f32_16x16x32_bf16 v[108:111], a[144:147], v[172:175], v[108:111]
  ds_read_b64_tr_b16 v[208:209], v20 offset:37120
  ds_read_b64_tr_b16 v[210:211], v21 offset:37120
  v_mfma_f32_16x16x32_bf16 v[140:143], a[152:155], v[172:175], v[140:143]
  ds_read_b64_tr_b16 v[212:213], v20 offset:39168
  ds_read_b64_tr_b16 v[214:215], v21 offset:39168
  s_waitcnt lgkmcnt(15)
  v_mfma_f32_16x16x32_bf16 v[112:115], a[144:147], v[176:179], v[112:115]
  ds_read_b64_tr_b16 v[216:217], v20 offset:41216
  ds_read_b64_tr_b16 v[218:219], v21 offset:41216
  v_mfma_f32_16x16x32_bf16 v[144:147], a[152:155], v[176:179], v[144:147]
  ds_read_b64_tr_b16 v[220:221], v20 offset:43264
  ds_read_b64_tr_b16 v[222:223], v21 offset:43264
  s_waitcnt lgkmcnt(15)
  v_mfma_f32_16x16x32_bf16 v[116:119], a[144:147], v[180:183], v[116:119]
  ds_read_b64_tr_b16 v[224:225], v20 offset:45312
  ds_read_b64_tr_b16 v[226:227], v21 offset:45312
  v_mfma_f32_16x16x32_bf16 v[148:151], a[152:155], v[180:183], v[148:151]
  ds_read_b64_tr_b16 v[228:229], v20 offset:47360
  ds_read_b64_tr_b16 v[230:231], v21 offset:47360
  s_waitcnt lgkmcnt(15)
  v_mfma_f32_16x16x32_bf16 v[120:123], a[144:147], v[184:187], v[120:123]
  s_add_u32 m0, s65, 4096
  s_nop 0
  buffer_load_dwordx4 v17, s[56:59], s64 offen offset:0 sc1 lds
  v_mfma_f32_16x16x32_bf16 v[152:155], a[152:155], v[184:187], v[152:155]
  s_waitcnt lgkmcnt(15)
  v_mfma_f32_16x16x32_bf16 v[124:127], a[144:147], v[188:191], v[124:127]
  buffer_load_dwordx4 v17, s[56:59], s64 offen offset:1024 sc1 lds
  v_mfma_f32_16x16x32_bf16 v[156:159], a[152:155], v[188:191], v[156:159]
  s_waitcnt lgkmcnt(15)
  v_mfma_f32_16x16x32_bf16 v[128:131], a[144:147], v[192:195], v[128:131]
  buffer_load_dwordx4 v17, s[56:59], s64 offen offset:2048 sc1 lds
  v_mfma_f32_16x16x32_bf16 v[160:163], a[152:155], v[192:195], v[160:163]
  s_waitcnt lgkmcnt(15)
  v_mfma_f32_16x16x32_bf16 v[132:135], a[144:147], v[196:199], v[132:135]
  buffer_load_dwordx4 v17, s[56:59], s64 offen offset:3072 sc1 lds
  s_add_u32 s64, s64, 32768
  s_and_b32 s64, s64, 0x7ffff
  v_mfma_f32_16x16x32_bf16 v[164:167], a[152:155], v[196:199], v[164:167]
  s_waitcnt vmcnt(16) lgkmcnt(0)
  s_barrier
  v_mfma_f32_16x16x32_bf16 v[104:107], a[148:151], v[200:203], v[104:107]
  ds_read_b64_tr_b16 v[168:169], v22 offset:0
  ds_read_b64_tr_b16 v[170:171], v23 offset:0
  v_mfma_f32_16x16x32_bf16 v[136:139], a[156:159], v[200:203], v[136:139]
  ds_read_b64_tr_b16 v[172:173], v22 offset:2048
  ds_read_b64_tr_b16 v[174:175], v23 offset:2048
  v_mfma_f32_16x16x32_bf16 v[108:111], a[148:151], v[204:207], v[108:111]
  ds_read_b64_tr_b16 v[176:177], v22 offset:4096
  ds_read_b64_tr_b16 v[178:179], v23 offset:4096
  v_mfma_f32_16x16x32_bf16 v[140:143], a[156:159], v[204:207], v[140:143]
  ds_read_b64_tr_b16 v[180:181], v22 offset:6144
  ds_read_b64_tr_b16 v[182:183], v23 offset:6144
  v_mfma_f32_16x16x32_bf16 v[112:115], a[148:151], v[208:211], v[112:115]
  ds_read_b64_tr_b16 v[184:185], v22 offset:8192
  ds_read_b64_tr_b16 v[186:187], v23 offset:8192
  v_mfma_f32_16x16x32_bf16 v[144:147], a[156:159], v[208:211], v[144:147]
  ds_read_b64_tr_b16 v[188:189], v22 offset:10240
  ds_read_b64_tr_b16 v[190:191], v23 offset:10240
  v_mfma_f32_16x16x32_bf16 v[116:119], a[148:151], v[212:215], v[116:119]
  ds_read_b64_tr_b16 v[192:193], v22 offset:12288
  ds_read_b64_tr_b16 v[194:195], v23 offset:12288
  v_mfma_f32_16x16x32_bf16 v[148:151], a[156:159], v[212:215], v[148:151]
  ds_read_b64_tr_b16 v[196:197], v22 offset:14336
  ds_read_b64_tr_b16 v[198:199], v23 offset:14336
  v_mfma_f32_16x16x32_bf16 v[120:123], a[148:151], v[216:219], v[120:123]
  s_add_u32 m0, s65, 32768
  s_nop 0
  buffer_load_dwordx4 v16, s[56:59], s64 offen offset:0 sc1 lds
  v_mfma_f32_16x16x32_bf16 v[152:155], a[156:159], v[216:219], v[152:155]
  v_mfma_f32_16x16x32_bf16 v[124:127], a[148:151], v[220:223], v[124:127]
  buffer_load_dwordx4 v16, s[56:59], s64 offen offset:1024 sc1 lds
  v_mfma_f32_16x16x32_bf16 v[156:159], a[156:159], v[220:223], v[156:159]
  v_mfma_f32_16x16x32_bf16 v[128:131], a[148:151], v[224:227], v[128:131]
  buffer_load_dwordx4 v16, s[56:59], s64 offen offset:2048 sc1 lds
  v_mfma_f32_16x16x32_bf16 v[160:163], a[156:159], v[224:227], v[160:163]
  v_mfma_f32_16x16x32_bf16 v[132:135], a[148:151], v[228:231], v[132:135]
  buffer_load_dwordx4 v16, s[56:59], s64 offen offset:3072 sc1 lds
  v_mfma_f32_16x16x32_bf16 v[164:167], a[156:159], v[228:231], v[164:167]
  s_waitcnt lgkmcnt(14)
  v_mfma_f32_16x16x32_bf16 v[104:107], a[160:163], v[168:171], v[104:107]
  ds_read_b64_tr_b16 v[200:201], v22 offset:256
  ds_read_b64_tr_b16 v[202:203], v23 offset:256
  v_mfma_f32_16x16x32_bf16 v[136:139], a[168:171], v[168:171], v[136:139]
  ds_read_b64_tr_b16 v[204:205], v22 offset:2304
  ds_read_b64_tr_b16 v[206:207], v23 offset:2304
  s_waitcnt lgkmcnt(15)
  v_mfma_f32_16x16x32_bf16 v[108:111], a[160:163], v[172:175], v[108:111]
  ds_read_b64_tr_b16 v[208:209], v22 offset:4352
  ds_read_b64_tr_b16 v[210:211], v23 offset:4352
  v_mfma_f32_16x16x32_bf16 v[140:143], a[168:171], v[172:175], v[140:143]
  ds_read_b64_tr_b16 v[212:213], v22 offset:6400
  ds_read_b64_tr_b16 v[214:215], v23 offset:6400
  s_waitcnt lgkmcnt(15)
  v_mfma_f32_16x16x32_bf16 v[112:115], a[160:163], v[176:179], v[112:115]
  ds_read_b64_tr_b16 v[216:217], v22 offset:8448
  ds_read_b64_tr_b16 v[218:219], v23 offset:8448
  v_mfma_f32_16x16x32_bf16 v[144:147], a[168:171], v[176:179], v[144:147]
  ds_read_b64_tr_b16 v[220:221], v22 offset:10496
  ds_read_b64_tr_b16 v[222:223], v23 offset:10496
  s_waitcnt lgkmcnt(15)
  v_mfma_f32_16x16x32_bf16 v[116:119], a[160:163], v[180:183], v[116:119]
  ds_read_b64_tr_b16 v[224:225], v22 offset:12544
  ds_read_b64_tr_b16 v[226:227], v23 offset:12544
  v_mfma_f32_16x16x32_bf16 v[148:151], a[168:171], v[180:183], v[148:151]
  ds_read_b64_tr_b16 v[228:229], v22 offset:14592
  ds_read_b64_tr_b16 v[230:231], v23 offset:14592
  s_waitcnt lgkmcnt(15)
  v_mfma_f32_16x16x32_bf16 v[120:123], a[160:163], v[184:187], v[120:123]
  s_add_u32 m0, s65, 36864
  s_nop 0
  buffer_load_dwordx4 v17, s[56:59], s64 offen offset:0 sc1 lds
  v_mfma_f32_16x16x32_bf16 v[152:155], a[168:171], v[184:187], v[152:155]
  s_waitcnt lgkmcnt(15)
  v_mfma_f32_16x16x32_bf16 v[124:127], a[160:163], v[188:191], v[124:127]
  buffer_load_dwordx4 v17, s[56:59], s64 offen offset:1024 sc1 lds
  v_mfma_f32_16x16x32_bf16 v[156:159], a[168:171], v[188:191], v[156:159]
  s_waitcnt lgkmcnt(15)
  v_mfma_f32_16x16x32_bf16 v[128:131], a[160:163], v[192:195], v[128:131]
  buffer_load_dwordx4 v17, s[56:59], s64 offen offset:2048 sc1 lds
  v_mfma_f32_16x16x32_bf16 v[160:163], a[168:171], v[192:195], v[160:163]
  s_waitcnt lgkmcnt(15)
  v_mfma_f32_16x16x32_bf16 v[132:135], a[160:163], v[196:199], v[132:135]
  buffer_load_dwordx4 v17, s[56:59], s64 offen offset:3072 sc1 lds
  s_add_u32 s64, s64, 32768
  s_and_b32 s64, s64, 0x7ffff
  v_mfma_f32_16x16x32_bf16 v[164:167], a[168:171], v[196:199], v[164:167]
  s_waitcnt vmcnt(16) lgkmcnt(0)
  s_barrier
  v_mfma_f32_16x16x32_bf16 v[104:107], a[164:167], v[200:203], v[104:107]
  ds_read_b64_tr_b16 v[168:169], v22 offset:32768
  ds_read_b64_tr_b16 v[170:171], v23 offset:32768
  v_mfma_f32_16x16x32_bf16 v[136:139], a[172:175], v[200:203], v[136:139]
  ds_read_b64_tr_b16 v[172:173], v22 offset:34816
  ds_read_b64_tr_b16 v[174:175], v23 offset:34816
  v_mfma_f32_16x16x32_bf16 v[108:111], a[164:167], v[204:207], v[108:111]
  ds_read_b64_tr_b16 v[176:177], v22 offset:36864
  ds_read_b64_tr_b16 v[178:179], v23 offset:36864
  v_mfma_f32_16x16x32_bf16 v[140:143], a[172:175], v[204:207], v[140:143]
  ds_read_b64_tr_b16 v[180:181], v22 offset:38912
  ds_read_b64_tr_b16 v[182:183], v23 offset:38912
  v_mfma_f32_16x16x32_bf16 v[112:115], a[164:167], v[208:211], v[112:115]
  ds_read_b64_tr_b16 v[184:185], v22 offset:40960
  ds_read_b64_tr_b16 v[186:187], v23 offset:40960
  v_mfma_f32_16x16x32_bf16 v[144:147], a[172:175], v[208:211], v[144:147]
  ds_read_b64_tr_b16 v[188:189], v22 offset:43008
  ds_read_b64_tr_b16 v[190:191], v23 offset:43008
  v_mfma_f32_16x16x32_bf16 v[116:119], a[164:167], v[212:215], v[116:119]
  ds_read_b64_tr_b16 v[192:193], v22 offset:45056
  ds_read_b64_tr_b16 v[194:195], v23 offset:45056
  v_mfma_f32_16x16x32_bf16 v[148:151], a[172:175], v[212:215], v[148:151]
  ds_read_b64_tr_b16 v[196:197], v22 offset:47104
  ds_read_b64_tr_b16 v[198:199], v23 offset:47104
  v_mfma_f32_16x16x32_bf16 v[120:123], a[164:167], v[216:219], v[120:123]
  s_add_u32 m0, s65, 65536
  s_nop 0
  buffer_load_dwordx4 v16, s[56:59], s64 offen offset:0 sc1 lds
  v_mfma_f32_16x16x32_bf16 v[152:155], a[172:175], v[216:219], v[152:155]
  v_mfma_f32_16x16x32_bf16 v[124:127], a[164:167], v[220:223], v[124:127]
  buffer_load_dwordx4 v16, s[56:59], s64 offen offset:1024 sc1 lds
  v_mfma_f32_16x16x32_bf16 v[156:159], a[172:175], v[220:223], v[156:159]
  v_mfma_f32_16x16x32_bf16 v[128:131], a[164:167], v[224:227], v[128:131]
  buffer_load_dwordx4 v16, s[56:59], s64 offen offset:2048 sc1 lds
  v_mfma_f32_16x16x32_bf16 v[160:163], a[172:175], v[224:227], v[160:163]
  v_mfma_f32_16x16x32_bf16 v[132:135], a[164:167], v[228:231], v[132:135]
  buffer_load_dwordx4 v16, s[56:59], s64 offen offset:3072 sc1 lds
  v_mfma_f32_16x16x32_bf16 v[164:167], a[172:175], v[228:231], v[164:167]
  s_waitcnt lgkmcnt(14)
  v_mfma_f32_16x16x32_bf16 v[104:107], a[176:179], v[168:171], v[104:107]
  ds_read_b64_tr_b16 v[200:201], v22 offset:33024
  ds_read_b64_tr_b16 v[202:203], v23 offset:33024
  v_mfma_f32_16x16x32_bf16 v[136:139], a[184:187], v[168:171], v[136:139]
  ds_read_b64_tr_b16 v[204:205], v22 offset:35072
  ds_read_b64_tr_b16 v[206:207], v23 offset:35072
  s_waitcnt lgkmcnt(15)
  v_mfma_f32_16x16x32_bf16 v[108:111], a[176:179], v[172:175], v[108:111]
  ds_read_b64_tr_b16 v[208:209], v22 offset:37120
  ds_read_b64_tr_b16 v[210:211], v23 offset:37120
  v_mfma_f32_16x16x32_bf16 v[140:143], a[184:187], v[172:175], v[140:143]
  ds_read_b64_tr_b16 v[212:213], v22 offset:39168
  ds_read_b64_tr_b16 v[214:215], v23 offset:39168
  s_waitcnt lgkmcnt(15)
  v_mfma_f32_16x16x32_bf16 v[112:115], a[176:179], v[176:179], v[112:115]
  ds_read_b64_tr_b16 v[216:217], v22 offset:41216
  ds_read_b64_tr_b16 v[218:219], v23 offset:41216
  v_mfma_f32_16x16x32_bf16 v[144:147], a[184:187], v[176:179], v[144:147]
  ds_read_b64_tr_b16 v[220:221], v22 offset:43264
  ds_read_b64_tr_b16 v[222:223], v23 offset:43264
  s_waitcnt lgkmcnt(15)
  v_mfma_f32_16x16x32_bf16 v[116:119], a[176:179], v[180:183], v[116:119]
  ds_read_b64_tr_b16 v[224:225], v22 offset:45312
  ds_read_b64_tr_b16 v[226:227], v23 offset:45312
  v_mfma_f32_16x16x32_bf16 v[148:151], a[184:187], v[180:183], v[148:151]
  ds_read_b64_tr_b16 v[228:229], v22 offset:47360
  ds_read_b64_tr_b16 v[230:231], v23 offset:47360
  s_waitcnt lgkmcnt(15)
  v_mfma_f32_16x16x32_bf16 v[120:123], a[176:179], v[184:187], v[120:123]
  s_add_u32 m0, s65, 69632
  s_nop 0
  buffer_load_dwordx4 v17, s[56:59], s64 offen offset:0 sc1 lds
  v_mfma_f32_16x16x32_bf16 v[152:155], a[184:187], v[184:187], v[152:155]
  s_waitcnt lgkmcnt(15)
  v_mfma_f32_16x16x32_bf16 v[124:127], a[176:179], v[188:191], v[124:127]
  buffer_load_dwordx4 v17, s[56:59], s64 offen offset:1024 sc1 lds
  v_mfma_f32_16x16x32_bf16 v[156:159], a[184:187], v[188:191], v[156:159]
  s_waitcnt lgkmcnt(15)
  v_mfma_f32_16x16x32_bf16 v[128:131], a[176:179], v[192:195], v[128:131]
  buffer_load_dwordx4 v17, s[56:59], s64 offen offset:2048 sc1 lds
  v_mfma_f32_16x16x32_bf16 v[160:163], a[184:187], v[192:195], v[160:163]
  s_waitcnt lgkmcnt(15)
  v_mfma_f32_16x16x32_bf16 v[132:135], a[176:179], v[196:199], v[132:135]
  buffer_load_dwordx4 v17, s[56:59], s64 offen offset:3072 sc1 lds
  s_add_u32 s64, s64, 32768
  s_and_b32 s64, s64, 0x7ffff
  v_mfma_f32_16x16x32_bf16 v[164:167], a[184:187], v[196:199], v[164:167]
  s_waitcnt vmcnt(16) lgkmcnt(0)
  s_barrier
  v_mfma_f32_16x16x32_bf16 v[104:107], a[180:183], v[200:203], v[104:107]
  ds_read_b64_tr_b16 v[168:169], v20 offset:0
  ds_read_b64_tr_b16 v[170:171], v21 offset:0
  v_mfma_f32_16x16x32_bf16 v[136:139], a[188:191], v[200:203], v[136:139]
  ds_read_b64_tr_b16 v[172:173], v20 offset:2048
  ds_read_b64_tr_b16 v[174:175], v21 offset:2048
  v_mfma_f32_16x16x32_bf16 v[108:111], a[180:183], v[204:207], v[108:111]
  ds_read_b64_tr_b16 v[176:177], v20 offset:4096
  ds_read_b64_tr_b16 v[178:179], v21 offset:4096
  v_mfma_f32_16x16x32_bf16 v[140:143], a[188:191], v[204:207], v[140:143]
  ds_read_b64_tr_b16 v[180:181], v20 offset:6144
  ds_read_b64_tr_b16 v[182:183], v21 offset:6144
  v_mfma_f32_16x16x32_bf16 v[112:115], a[180:183], v[208:211], v[112:115]
  ds_read_b64_tr_b16 v[184:185], v20 offset:8192
  ds_read_b64_tr_b16 v[186:187], v21 offset:8192
  v_mfma_f32_16x16x32_bf16 v[144:147], a[188:191], v[208:211], v[144:147]
  ds_read_b64_tr_b16 v[188:189], v20 offset:10240
  ds_read_b64_tr_b16 v[190:191], v21 offset:10240
  v_mfma_f32_16x16x32_bf16 v[116:119], a[180:183], v[212:215], v[116:119]
  ds_read_b64_tr_b16 v[192:193], v20 offset:12288
  ds_read_b64_tr_b16 v[194:195], v21 offset:12288
  v_mfma_f32_16x16x32_bf16 v[148:151], a[188:191], v[212:215], v[148:151]
  ds_read_b64_tr_b16 v[196:197], v20 offset:14336
  ds_read_b64_tr_b16 v[198:199], v21 offset:14336
  v_mfma_f32_16x16x32_bf16 v[120:123], a[180:183], v[216:219], v[120:123]
  s_add_u32 m0, s65, 98304
  s_nop 0
  buffer_load_dwordx4 v16, s[56:59], s64 offen offset:0 sc1 lds
  v_mfma_f32_16x16x32_bf16 v[152:155], a[188:191], v[216:219], v[152:155]
  v_mfma_f32_16x16x32_bf16 v[124:127], a[180:183], v[220:223], v[124:127]
  buffer_load_dwordx4 v16, s[56:59], s64 offen offset:1024 sc1 lds
  v_mfma_f32_16x16x32_bf16 v[156:159], a[188:191], v[220:223], v[156:159]
  v_mfma_f32_16x16x32_bf16 v[128:131], a[180:183], v[224:227], v[128:131]
  buffer_load_dwordx4 v16, s[56:59], s64 offen offset:2048 sc1 lds
  v_mfma_f32_16x16x32_bf16 v[160:163], a[188:191], v[224:227], v[160:163]
  v_mfma_f32_16x16x32_bf16 v[132:135], a[180:183], v[228:231], v[132:135]
  buffer_load_dwordx4 v16, s[56:59], s64 offen offset:3072 sc1 lds
  v_mfma_f32_16x16x32_bf16 v[164:167], a[188:191], v[228:231], v[164:167]
  s_waitcnt lgkmcnt(14)
  v_mfma_f32_16x16x32_bf16 v[104:107], a[192:195], v[168:171], v[104:107]
  ds_read_b64_tr_b16 v[200:201], v20 offset:256
  ds_read_b64_tr_b16 v[202:203], v21 offset:256
  v_mfma_f32_16x16x32_bf16 v[136:139], a[200:203], v[168:171], v[136:139]
  ds_read_b64_tr_b16 v[204:205], v20 offset:2304
  ds_read_b64_tr_b16 v[206:207], v21 offset:2304
  s_waitcnt lgkmcnt(15)
  v_mfma_f32_16x16x32_bf16 v[108:111], a[192:195], v[172:175], v[108:111]
  ds_read_b64_tr_b16 v[208:209], v20 offset:4352
  ds_read_b64_tr_b16 v[210:211], v21 offset:4352
  v_mfma_f32_16x16x32_bf16 v[140:143], a[200:203], v[172:175], v[140:143]
  ds_read_b64_tr_b16 v[212:213], v20 offset:6400
  ds_read_b64_tr_b16 v[214:215], v21 offset:6400
  s_waitcnt lgkmcnt(15)
  v_mfma_f32_16x16x32_bf16 v[112:115], a[192:195], v[176:179], v[112:115]
  ds_read_b64_tr_b16 v[216:217], v20 offset:8448
  ds_read_b64_tr_b16 v[218:219], v21 offset:8448
  v_mfma_f32_16x16x32_bf16 v[144:147], a[200:203], v[176:179], v[144:147]
  ds_read_b64_tr_b16 v[220:221], v20 offset:10496
  ds_read_b64_tr_b16 v[222:223], v21 offset:10496
  s_waitcnt lgkmcnt(15)
  v_mfma_f32_16x16x32_bf16 v[116:119], a[192:195], v[180:183], v[116:119]
  ds_read_b64_tr_b16 v[224:225], v20 offset:12544
  ds_read_b64_tr_b16 v[226:227], v21 offset:12544
  v_mfma_f32_16x16x32_bf16 v[148:151], a[200:203], v[180:183], v[148:151]
  ds_read_b64_tr_b16 v[228:229], v20 offset:14592
  ds_read_b64_tr_b16 v[230:231], v21 offset:14592
  s_waitcnt lgkmcnt(15)
  v_mfma_f32_16x16x32_bf16 v[120:123], a[192:195], v[184:187], v[120:123]
  s_add_u32 m0, s65, 102400
  s_nop 0
  buffer_load_dwordx4 v17, s[56:59], s64 offen offset:0 sc1 lds
  v_mfma_f32_16x16x32_bf16 v[152:155], a[200:203], v[184:187], v[152:155]
  s_waitcnt lgkmcnt(15)
  v_mfma_f32_16x16x32_bf16 v[124:127], a[192:195], v[188:191], v[124:127]
  buffer_load_dwordx4 v17, s[56:59], s64 offen offset:1024 sc1 lds
  v_mfma_f32_16x16x32_bf16 v[156:159], a[200:203], v[188:191], v[156:159]
  s_waitcnt lgkmcnt(15)
  v_mfma_f32_16x16x32_bf16 v[128:131], a[192:195], v[192:195], v[128:131]
  buffer_load_dwordx4 v17, s[56:59], s64 offen offset:2048 sc1 lds
  v_mfma_f32_16x16x32_bf16 v[160:163], a[200:203], v[192:195], v[160:163]
  s_waitcnt lgkmcnt(15)
  v_mfma_f32_16x16x32_bf16 v[132:135], a[192:195], v[196:199], v[132:135]
  buffer_load_dwordx4 v17, s[56:59], s64 offen offset:3072 sc1 lds
  s_add_u32 s64, s64, 32768
  s_and_b32 s64, s64, 0x7ffff
  v_mfma_f32_16x16x32_bf16 v[164:167], a[200:203], v[196:199], v[164:167]
  s_waitcnt vmcnt(16) lgkmcnt(0)
  s_barrier
  v_mfma_f32_16x16x32_bf16 v[104:107], a[196:199], v[200:203], v[104:107]
  ds_read_b64_tr_b16 v[168:169], v20 offset:32768
  ds_read_b64_tr_b16 v[170:171], v21 offset:32768
  v_mfma_f32_16x16x32_bf16 v[136:139], a[204:207], v[200:203], v[136:139]
  ds_read_b64_tr_b16 v[172:173], v20 offset:34816
  ds_read_b64_tr_b16 v[174:175], v21 offset:34816
  v_mfma_f32_16x16x32_bf16 v[108:111], a[196:199], v[204:207], v[108:111]
  ds_read_b64_tr_b16 v[176:177], v20 offset:36864
  ds_read_b64_tr_b16 v[178:179], v21 offset:36864
  v_mfma_f32_16x16x32_bf16 v[140:143], a[204:207], v[204:207], v[140:143]
  ds_read_b64_tr_b16 v[180:181], v20 offset:38912
  ds_read_b64_tr_b16 v[182:183], v21 offset:38912
  v_mfma_f32_16x16x32_bf16 v[112:115], a[196:199], v[208:211], v[112:115]
  ds_read_b64_tr_b16 v[184:185], v20 offset:40960
  ds_read_b64_tr_b16 v[186:187], v21 offset:40960
  v_mfma_f32_16x16x32_bf16 v[144:147], a[204:207], v[208:211], v[144:147]
  ds_read_b64_tr_b16 v[188:189], v20 offset:43008
  ds_read_b64_tr_b16 v[190:191], v21 offset:43008
  v_mfma_f32_16x16x32_bf16 v[116:119], a[196:199], v[212:215], v[116:119]
  ds_read_b64_tr_b16 v[192:193], v20 offset:45056
  ds_read_b64_tr_b16 v[194:195], v21 offset:45056
  v_mfma_f32_16x16x32_bf16 v[148:151], a[204:207], v[212:215], v[148:151]
  ds_read_b64_tr_b16 v[196:197], v20 offset:47104
  ds_read_b64_tr_b16 v[198:199], v21 offset:47104
  v_mfma_f32_16x16x32_bf16 v[120:123], a[196:199], v[216:219], v[120:123]
  buffer_load_dwordx4 v[12:15], v2, s[72:75], 0 offen offset:1024 sc1
  v_mfma_f32_16x16x32_bf16 v[152:155], a[204:207], v[216:219], v[152:155]
  v_mfma_f32_16x16x32_bf16 v[124:127], a[196:199], v[220:223], v[124:127]
  v_mfma_f32_16x16x32_bf16 v[156:159], a[204:207], v[220:223], v[156:159]
  v_mfma_f32_16x16x32_bf16 v[128:131], a[196:199], v[224:227], v[128:131]
  v_mfma_f32_16x16x32_bf16 v[160:163], a[204:207], v[224:227], v[160:163]
  v_mfma_f32_16x16x32_bf16 v[132:135], a[196:199], v[228:231], v[132:135]
  v_mfma_f32_16x16x32_bf16 v[164:167], a[204:207], v[228:231], v[164:167]
  s_waitcnt lgkmcnt(14)
  v_mfma_f32_16x16x32_bf16 v[104:107], a[208:211], v[168:171], v[104:107]
  ds_read_b64_tr_b16 v[200:201], v20 offset:33024
  ds_read_b64_tr_b16 v[202:203], v21 offset:33024
  v_mfma_f32_16x16x32_bf16 v[136:139], a[216:219], v[168:171], v[136:139]
  ds_read_b64_tr_b16 v[204:205], v20 offset:35072
  ds_read_b64_tr_b16 v[206:207], v21 offset:35072
  s_waitcnt lgkmcnt(15)
  v_mfma_f32_16x16x32_bf16 v[108:111], a[208:211], v[172:175], v[108:111]
  ds_read_b64_tr_b16 v[208:209], v20 offset:37120
  ds_read_b64_tr_b16 v[210:211], v21 offset:37120
  v_mfma_f32_16x16x32_bf16 v[140:143], a[216:219], v[172:175], v[140:143]
  ds_read_b64_tr_b16 v[212:213], v20 offset:39168
  ds_read_b64_tr_b16 v[214:215], v21 offset:39168
  s_waitcnt lgkmcnt(15)
  v_mfma_f32_16x16x32_bf16 v[112:115], a[208:211], v[176:179], v[112:115]
  ds_read_b64_tr_b16 v[216:217], v20 offset:41216
  ds_read_b64_tr_b16 v[218:219], v21 offset:41216
  v_mfma_f32_16x16x32_bf16 v[144:147], a[216:219], v[176:179], v[144:147]
  ds_read_b64_tr_b16 v[220:221], v20 offset:43264
  ds_read_b64_tr_b16 v[222:223], v21 offset:43264
  s_waitcnt lgkmcnt(15)
  v_mfma_f32_16x16x32_bf16 v[116:119], a[208:211], v[180:183], v[116:119]
  ds_read_b64_tr_b16 v[224:225], v20 offset:45312
  ds_read_b64_tr_b16 v[226:227], v21 offset:45312
  v_mfma_f32_16x16x32_bf16 v[148:151], a[216:219], v[180:183], v[148:151]
  ds_read_b64_tr_b16 v[228:229], v20 offset:47360
  ds_read_b64_tr_b16 v[230:231], v21 offset:47360
  s_waitcnt lgkmcnt(15)
  v_mfma_f32_16x16x32_bf16 v[120:123], a[208:211], v[184:187], v[120:123]
  v_mfma_f32_16x16x32_bf16 v[152:155], a[216:219], v[184:187], v[152:155]
  s_waitcnt lgkmcnt(15)
  v_mfma_f32_16x16x32_bf16 v[124:127], a[208:211], v[188:191], v[124:127]
  v_mfma_f32_16x16x32_bf16 v[156:159], a[216:219], v[188:191], v[156:159]
  s_waitcnt lgkmcnt(15)
  v_mfma_f32_16x16x32_bf16 v[128:131], a[208:211], v[192:195], v[128:131]
  v_mfma_f32_16x16x32_bf16 v[160:163], a[216:219], v[192:195], v[160:163]
  s_waitcnt lgkmcnt(15)
  v_mfma_f32_16x16x32_bf16 v[132:135], a[208:211], v[196:199], v[132:135]
  v_mfma_f32_16x16x32_bf16 v[164:167], a[216:219], v[196:199], v[164:167]
  s_waitcnt vmcnt(9) lgkmcnt(0)
  s_barrier
  v_mfma_f32_16x16x32_bf16 v[104:107], a[212:215], v[200:203], v[104:107]
  ds_read_b64_tr_b16 v[168:169], v22 offset:0
  ds_read_b64_tr_b16 v[170:171], v23 offset:0
  v_mfma_f32_16x16x32_bf16 v[136:139], a[220:223], v[200:203], v[136:139]
  ds_read_b64_tr_b16 v[172:173], v22 offset:2048
  ds_read_b64_tr_b16 v[174:175], v23 offset:2048
  v_mfma_f32_16x16x32_bf16 v[108:111], a[212:215], v[204:207], v[108:111]
  ds_read_b64_tr_b16 v[176:177], v22 offset:4096
  ds_read_b64_tr_b16 v[178:179], v23 offset:4096
  v_mfma_f32_16x16x32_bf16 v[140:143], a[220:223], v[204:207], v[140:143]
  ds_read_b64_tr_b16 v[180:181], v22 offset:6144
  ds_read_b64_tr_b16 v[182:183], v23 offset:6144
  v_mfma_f32_16x16x32_bf16 v[112:115], a[212:215], v[208:211], v[112:115]
  ds_read_b64_tr_b16 v[184:185], v22 offset:8192
  ds_read_b64_tr_b16 v[186:187], v23 offset:8192
  v_mfma_f32_16x16x32_bf16 v[144:147], a[220:223], v[208:211], v[144:147]
  ds_read_b64_tr_b16 v[188:189], v22 offset:10240
  ds_read_b64_tr_b16 v[190:191], v23 offset:10240
  v_mfma_f32_16x16x32_bf16 v[116:119], a[212:215], v[212:215], v[116:119]
  ds_read_b64_tr_b16 v[192:193], v22 offset:12288
  ds_read_b64_tr_b16 v[194:195], v23 offset:12288
  v_mfma_f32_16x16x32_bf16 v[148:151], a[220:223], v[212:215], v[148:151]
  ds_read_b64_tr_b16 v[196:197], v22 offset:14336
  ds_read_b64_tr_b16 v[198:199], v23 offset:14336
  v_mfma_f32_16x16x32_bf16 v[120:123], a[212:215], v[216:219], v[120:123]
  v_mfma_f32_16x16x32_bf16 v[152:155], a[220:223], v[216:219], v[152:155]
  v_mfma_f32_16x16x32_bf16 v[124:127], a[212:215], v[220:223], v[124:127]
  v_mfma_f32_16x16x32_bf16 v[156:159], a[220:223], v[220:223], v[156:159]
  v_mfma_f32_16x16x32_bf16 v[128:131], a[212:215], v[224:227], v[128:131]
  v_mfma_f32_16x16x32_bf16 v[160:163], a[220:223], v[224:227], v[160:163]
  v_mfma_f32_16x16x32_bf16 v[132:135], a[212:215], v[228:231], v[132:135]
  v_mfma_f32_16x16x32_bf16 v[164:167], a[220:223], v[228:231], v[164:167]
  s_waitcnt lgkmcnt(14)
  v_mfma_f32_16x16x32_bf16 v[104:107], a[224:227], v[168:171], v[104:107]
  ds_read_b64_tr_b16 v[200:201], v22 offset:256
  ds_read_b64_tr_b16 v[202:203], v23 offset:256
  v_mfma_f32_16x16x32_bf16 v[136:139], a[232:235], v[168:171], v[136:139]
  ds_read_b64_tr_b16 v[204:205], v22 offset:2304
  ds_read_b64_tr_b16 v[206:207], v23 offset:2304
  s_waitcnt lgkmcnt(15)
  v_mfma_f32_16x16x32_bf16 v[108:111], a[224:227], v[172:175], v[108:111]
  ds_read_b64_tr_b16 v[208:209], v22 offset:4352
  ds_read_b64_tr_b16 v[210:211], v23 offset:4352
  v_mfma_f32_16x16x32_bf16 v[140:143], a[232:235], v[172:175], v[140:143]
  ds_read_b64_tr_b16 v[212:213], v22 offset:6400
  ds_read_b64_tr_b16 v[214:215], v23 offset:6400
  s_waitcnt lgkmcnt(15)
  v_mfma_f32_16x16x32_bf16 v[112:115], a[224:227], v[176:179], v[112:115]
  ds_read_b64_tr_b16 v[216:217], v22 offset:8448
  ds_read_b64_tr_b16 v[218:219], v23 offset:8448
  v_mfma_f32_16x16x32_bf16 v[144:147], a[232:235], v[176:179], v[144:147]
  ds_read_b64_tr_b16 v[220:221], v22 offset:10496
  ds_read_b64_tr_b16 v[222:223], v23 offset:10496
  s_waitcnt lgkmcnt(15)
  v_mfma_f32_16x16x32_bf16 v[116:119], a[224:227], v[180:183], v[116:119]
  ds_read_b64_tr_b16 v[224:225], v22 offset:12544
  ds_read_b64_tr_b16 v[226:227], v23 offset:12544
  v_mfma_f32_16x16x32_bf16 v[148:151], a[232:235], v[180:183], v[148:151]
  ds_read_b64_tr_b16 v[228:229], v22 offset:14592
  ds_read_b64_tr_b16 v[230:231], v23 offset:14592
  s_waitcnt lgkmcnt(15)
  v_mfma_f32_16x16x32_bf16 v[120:123], a[224:227], v[184:187], v[120:123]
  s_waitcnt vmcnt(0)
  v_min_u32 v12, v12, v13
  v_min3_u32 v12, v12, v14, v15
  v_cmp_ne_u32 vcc, 1, v12
  s_nop 0
  s_cbranch_vccz gated_mix__spectral_gfnet__ssm_conv_s5__prompt_kernel_skip21
  s_mov_b32 s66, 0
gated_mix__spectral_gfnet__ssm_conv_s5__prompt_kernel_poll22:
  buffer_load_dwordx4 v[12:15], v2, s[72:75], 0 offen offset:1024 sc1
  s_waitcnt vmcnt(0)
  v_min_u32 v12, v12, v13
  v_min3_u32 v12, v12, v14, v15
  v_cmp_ne_u32 vcc, 1, v12
  s_nop 0
  s_cbranch_vccz gated_mix__spectral_gfnet__ssm_conv_s5__prompt_kernel_pollout23
  s_add_u32 s66, s66, 1
  s_cmp_lt_u32 s66, 1048576
  s_cbranch_scc1 gated_mix__spectral_gfnet__ssm_conv_s5__prompt_kernel_poll22
gated_mix__spectral_gfnet__ssm_conv_s5__prompt_kernel_pollout23:
gated_mix__spectral_gfnet__ssm_conv_s5__prompt_kernel_skip21:
  v_lshrrev_b32 v3, 2, v4
  v_lshlrev_b32 v3, 8, v3
  v_and_b32 v12, 3, v4
  v_lshl_or_b32 v3, v12, 4, v3
  s_lshl_b32 s66, s38, 4
  s_add_u32 s66, s66, s39
  s_mul_i32 s66, s66, 16384
  s_lshl_b32 s67, s3, 12
  s_add_u32 s66, s66, s67
  buffer_load_dwordx4 v[232:235], v3, s[44:47], s66 offen offset:0 sc1
  buffer_load_dwordx4 v[236:239], v3, s[44:47], s66 offen offset:64 sc1
  buffer_load_dwordx4 v[240:243], v3, s[44:47], s66 offen offset:128 sc1
  buffer_load_dwordx4 v[244:247], v3, s[44:47], s66 offen offset:192 sc1
  v_mfma_f32_16x16x32_bf16 v[152:155], a[232:235], v[184:187], v[152:155]
  s_waitcnt lgkmcnt(15)
  v_mfma_f32_16x16x32_bf16 v[124:127], a[224:227], v[188:191], v[124:127]
  v_mfma_f32_16x16x32_bf16 v[156:159], a[232:235], v[188:191], v[156:159]
  s_waitcnt lgkmcnt(15)
  v_mfma_f32_16x16x32_bf16 v[128:131], a[224:227], v[192:195], v[128:131]
  v_mfma_f32_16x16x32_bf16 v[160:163], a[232:235], v[192:195], v[160:163]
  s_waitcnt lgkmcnt(15)
  v_mfma_f32_16x16x32_bf16 v[132:135], a[224:227], v[196:199], v[132:135]
  v_mfma_f32_16x16x32_bf16 v[164:167], a[232:235], v[196:199], v[164:167]
  s_waitcnt lgkmcnt(0)
  s_barrier
  v_mfma_f32_16x16x32_bf16 v[104:107], a[228:231], v[200:203], v[104:107]
  ds_read_b64_tr_b16 v[168:169], v22 offset:32768
  ds_read_b64_tr_b16 v[170:171], v23 offset:32768
  v_mfma_f32_16x16x32_bf16 v[136:139], a[236:239], v[200:203], v[136:139]
  ds_read_b64_tr_b16 v[172:173], v22 offset:34816
  ds_read_b64_tr_b16 v[174:175], v23 offset:34816
  v_mfma_f32_16x16x32_bf16 v[108:111], a[228:231], v[204:207], v[108:111]
  ds_read_b64_tr_b16 v[176:177], v22 offset:36864
  ds_read_b64_tr_b16 v[178:179], v23 offset:36864
  v_mfma_f32_16x16x32_bf16 v[140:143], a[236:239], v[204:207], v[140:143]
  ds_read_b64_tr_b16 v[180:181], v22 offset:38912
  ds_read_b64_tr_b16 v[182:183], v23 offset:38912
  v_mfma_f32_16x16x32_bf16 v[112:115], a[228:231], v[208:211], v[112:115]
  ds_read_b64_tr_b16 v[184:185], v22 offset:40960
  ds_read_b64_tr_b16 v[186:187], v23 offset:40960
  v_mfma_f32_16x16x32_bf16 v[144:147], a[236:239], v[208:211], v[144:147]
  ds_read_b64_tr_b16 v[188:189], v22 offset:43008
  ds_read_b64_tr_b16 v[190:191], v23 offset:43008
  v_mfma_f32_16x16x32_bf16 v[116:119], a[228:231], v[212:215], v[116:119]
  ds_read_b64_tr_b16 v[192:193], v22 offset:45056
  ds_read_b64_tr_b16 v[194:195], v23 offset:45056
  v_mfma_f32_16x16x32_bf16 v[148:151], a[236:239], v[212:215], v[148:151]
  ds_read_b64_tr_b16 v[196:197], v22 offset:47104
  ds_read_b64_tr_b16 v[198:199], v23 offset:47104
  v_mfma_f32_16x16x32_bf16 v[120:123], a[228:231], v[216:219], v[120:123]
  v_mfma_f32_16x16x32_bf16 v[152:155], a[236:239], v[216:219], v[152:155]
  v_mfma_f32_16x16x32_bf16 v[124:127], a[228:231], v[220:223], v[124:127]
  v_mfma_f32_16x16x32_bf16 v[156:159], a[236:239], v[220:223], v[156:159]
  v_mfma_f32_16x16x32_bf16 v[128:131], a[228:231], v[224:227], v[128:131]
  v_mfma_f32_16x16x32_bf16 v[160:163], a[236:239], v[224:227], v[160:163]
  v_mfma_f32_16x16x32_bf16 v[132:135], a[228:231], v[228:231], v[132:135]
  v_mfma_f32_16x16x32_bf16 v[164:167], a[236:239], v[228:231], v[164:167]
  s_waitcnt lgkmcnt(14)
  v_mfma_f32_16x16x32_bf16 v[104:107], a[240:243], v[168:171], v[104:107]
  ds_read_b64_tr_b16 v[200:201], v22 offset:33024
  ds_read_b64_tr_b16 v[202:203], v23 offset:33024
  v_mfma_f32_16x16x32_bf16 v[136:139], a[248:251], v[168:171], v[136:139]
  ds_read_b64_tr_b16 v[204:205], v22 offset:35072
  ds_read_b64_tr_b16 v[206:207], v23 offset:35072
  s_waitcnt lgkmcnt(15)
  v_mfma_f32_16x16x32_bf16 v[108:111], a[240:243], v[172:175], v[108:111]
  ds_read_b64_tr_b16 v[208:209], v22 offset:37120
  ds_read_b64_tr_b16 v[210:211], v23 offset:37120
  v_mfma_f32_16x16x32_bf16 v[140:143], a[248:251], v[172:175], v[140:143]
  ds_read_b64_tr_b16 v[212:213], v22 offset:39168
  ds_read_b64_tr_b16 v[214:215], v23 offset:39168
  s_waitcnt lgkmcnt(15)
  v_mfma_f32_16x16x32_bf16 v[112:115], a[240:243], v[176:179], v[112:115]
  ds_read_b64_tr_b16 v[216:217], v22 offset:41216
  ds_read_b64_tr_b16 v[218:219], v23 offset:41216
  v_mfma_f32_16x16x32_bf16 v[144:147], a[248:251], v[176:179], v[144:147]
  ds_read_b64_tr_b16 v[220:221], v22 offset:43264
  ds_read_b64_tr_b16 v[222:223], v23 offset:43264
  s_waitcnt lgkmcnt(15)
  v_mfma_f32_16x16x32_bf16 v[116:119], a[240:243], v[180:183], v[116:119]
  ds_read_b64_tr_b16 v[224:225], v22 offset:45312
  ds_read_b64_tr_b16 v[226:227], v23 offset:45312
  v_mfma_f32_16x16x32_bf16 v[148:151], a[248:251], v[180:183], v[148:151]
  ds_read_b64_tr_b16 v[228:229], v22 offset:47360
  ds_read_b64_tr_b16 v[230:231], v23 offset:47360
  s_waitcnt lgkmcnt(15)
  v_mfma_f32_16x16x32_bf16 v[120:123], a[240:243], v[184:187], v[120:123]
  v_mfma_f32_16x16x32_bf16 v[152:155], a[248:251], v[184:187], v[152:155]
  s_waitcnt lgkmcnt(15)
  v_mfma_f32_16x16x32_bf16 v[124:127], a[240:243], v[188:191], v[124:127]
  v_mfma_f32_16x16x32_bf16 v[156:159], a[248:251], v[188:191], v[156:159]
  s_waitcnt lgkmcnt(15)
  v_mfma_f32_16x16x32_bf16 v[128:131], a[240:243], v[192:195], v[128:131]
  v_mfma_f32_16x16x32_bf16 v[160:163], a[248:251], v[192:195], v[160:163]
  s_waitcnt lgkmcnt(15)
  v_mfma_f32_16x16x32_bf16 v[132:135], a[240:243], v[196:199], v[132:135]
  v_mfma_f32_16x16x32_bf16 v[164:167], a[248:251], v[196:199], v[164:167]
  s_waitcnt lgkmcnt(14)
  v_mfma_f32_16x16x32_bf16 v[104:107], a[244:247], v[200:203], v[104:107]
  v_mfma_f32_16x16x32_bf16 v[136:139], a[252:255], v[200:203], v[136:139]
  s_waitcnt lgkmcnt(12)
  v_mfma_f32_16x16x32_bf16 v[108:111], a[244:247], v[204:207], v[108:111]
  v_mfma_f32_16x16x32_bf16 v[140:143], a[252:255], v[204:207], v[140:143]
  s_waitcnt lgkmcnt(10)
  v_mfma_f32_16x16x32_bf16 v[112:115], a[244:247], v[208:211], v[112:115]
  v_mfma_f32_16x16x32_bf16 v[144:147], a[252:255], v[208:211], v[144:147]
  s_waitcnt lgkmcnt(8)
  v_mfma_f32_16x16x32_bf16 v[116:119], a[244:247], v[212:215], v[116:119]
  v_mfma_f32_16x16x32_bf16 v[148:151], a[252:255], v[212:215], v[148:151]
  s_waitcnt lgkmcnt(6)
  v_mfma_f32_16x16x32_bf16 v[120:123], a[244:247], v[216:219], v[120:123]
  v_mfma_f32_16x16x32_bf16 v[152:155], a[252:255], v[216:219], v[152:155]
  s_waitcnt lgkmcnt(4)
  v_mfma_f32_16x16x32_bf16 v[124:127], a[244:247], v[220:223], v[124:127]
  v_mfma_f32_16x16x32_bf16 v[156:159], a[252:255], v[220:223], v[156:159]
  s_waitcnt lgkmcnt(2)
  v_mfma_f32_16x16x32_bf16 v[128:131], a[244:247], v[224:227], v[128:131]
  v_mfma_f32_16x16x32_bf16 v[160:163], a[252:255], v[224:227], v[160:163]
  s_waitcnt lgkmcnt(0)
  v_mfma_f32_16x16x32_bf16 v[132:135], a[244:247], v[228:231], v[132:135]
  v_mfma_f32_16x16x32_bf16 v[164:167], a[252:255], v[228:231], v[164:167]
  s_mov_b32 s64, s30
  s_mov_b32 s65, s31
  s_mov_b32 s66, 8388608
  s_mov_b32 s67, 0x20000
  s_lshl_b32 s68, s3, 13
  s_add_u32 s68, s68, 0
  v_lshl_add_u32 v3, v4, 4, s68
  ds_write_b128 v3, v[120:123] offset:0
  ds_write_b128 v3, v[124:127] offset:1024
  ds_write_b128 v3, v[128:131] offset:2048
  ds_write_b128 v3, v[132:135] offset:3072
  ds_write_b128 v3, v[152:155] offset:4096
  ds_write_b128 v3, v[156:159] offset:5120
  ds_write_b128 v3, v[160:163] offset:6144
  ds_write_b128 v3, v[164:167] offset:7168
  s_waitcnt vmcnt(3)
  v_lshlrev_b32 v168, 16, v232
  v_and_b32 v172, 0xffff0000, v232
  v_lshlrev_b32 v169, 16, v233
  v_and_b32 v173, 0xffff0000, v233
  v_lshlrev_b32 v170, 16, v234
  v_and_b32 v174, 0xffff0000, v234
  v_lshlrev_b32 v171, 16, v235
  v_and_b32 v175, 0xffff0000, v235
  s_waitcnt vmcnt(2)
  v_lshlrev_b32 v176, 16, v236
  v_and_b32 v180, 0xffff0000, v236
  v_lshlrev_b32 v177, 16, v237
  v_and_b32 v181, 0xffff0000, v237
  v_lshlrev_b32 v178, 16, v238
  v_and_b32 v182, 0xffff0000, v238
  v_lshlrev_b32 v179, 16, v239
  v_and_b32 v183, 0xffff0000, v239
  s_waitcnt vmcnt(1)
  v_lshlrev_b32 v184, 16, v240
  v_and_b32 v188, 0xffff0000, v240
  v_lshlrev_b32 v185, 16, v241
  v_and_b32 v189, 0xffff0000, v241
  v_lshlrev_b32 v186, 16, v242
  v_and_b32 v190, 0xffff0000, v242
  v_lshlrev_b32 v187, 16, v243
  v_and_b32 v191, 0xffff0000, v243
  s_waitcnt vmcnt(0)
  v_lshlrev_b32 v192, 16, v244
  v_and_b32 v196, 0xffff0000, v244
  v_lshlrev_b32 v193, 16, v245
  v_and_b32 v197, 0xffff0000, v245
  v_lshlrev_b32 v194, 16, v246
  v_and_b32 v198, 0xffff0000, v246
  v_lshlrev_b32 v195, 16, v247
  v_and_b32 v199, 0xffff0000, v247
  v_pk_add_f32 v[200:201], v[168:169], v[184:185]
  v_pk_add_f32 v[208:209], v[168:169], v[184:185] neg_lo:[0,1] neg_hi:[0,1]
  v_pk_add_f32 v[216:217], v[176:177], v[192:193]
  v_pk_add_f32 v[204:205], v[172:173], v[188:189]
  v_pk_add_f32 v[212:213], v[172:173], v[188:189] neg_lo:[0,1] neg_hi:[0,1]
  v_pk_add_f32 v[220:221], v[180:181], v[196:197]
  v_pk_add_f32 v[224:225], v[196:197], v[180:181] neg_lo:[0,1] neg_hi:[0,1]
  v_pk_add_f32 v[228:229], v[176:177], v[192:193] neg_lo:[0,1] neg_hi:[0,1]
  v_pk_add_f32 v[202:203], v[170:171], v[186:187]
  v_pk_add_f32 v[210:211], v[170:171], v[186:187] neg_lo:[0,1] neg_hi:[0,1]
  v_pk_add_f32 v[218:219], v[178:179], v[194:195]
  v_pk_add_f32 v[206:207], v[174:175], v[190:191]
  v_pk_add_f32 v[214:215], v[174:175], v[190:191] neg_lo:[0,1] neg_hi:[0,1]
  v_pk_add_f32 v[222:223], v[182:183], v[198:199]
  v_pk_add_f32 v[226:227], v[198:199], v[182:183] neg_lo:[0,1] neg_hi:[0,1]
  v_pk_add_f32 v[230:231], v[178:179], v[194:195] neg_lo:[0,1] neg_hi:[0,1]
  s_cmp_lg_u32 s3, 0
  s_cbranch_scc1 gated_mix__spectral_gfnet__ssm_conv_s5__prompt_kernel_skip24
  s_mov_b64 exec, 15
  v_mul_f32 v216, 2.0, v176
  v_mul_f32 v220, 2.0, v192
  v_mul_f32 v224, -2.0, v180
  v_mul_f32 v228, -2.0, v196
  v_mul_f32 v217, 2.0, v177
  v_mul_f32 v221, 2.0, v193
  v_mul_f32 v225, -2.0, v181
  v_mul_f32 v229, -2.0, v197
  v_mul_f32 v218, 2.0, v178
  v_mul_f32 v222, 2.0, v194
  v_mul_f32 v226, -2.0, v182
  v_mul_f32 v230, -2.0, v198
  v_mul_f32 v219, 2.0, v179
  v_mul_f32 v223, 2.0, v195
  v_mul_f32 v227, -2.0, v183
  v_mul_f32 v231, -2.0, v199
  s_mov_b64 exec, -1
gated_mix__spectral_gfnet__ssm_conv_s5__prompt_kernel_skip24:
  s_lshl_b32 s69, s3, 10
  s_add_u32 s69, s69, 32768
  v_lshl_add_u32 v13, v4, 4, s69
  v_pk_add_f32 v[168:169], v[200:201], v[216:217]
  v_cvt_pk_bf16_f32 v232, v168, v169
  v_pk_add_f32 v[170:171], v[202:203], v[218:219]
  v_cvt_pk_bf16_f32 v233, v170, v171
  v_pk_add_f32 v[172:173], v[204:205], v[220:221]
  v_cvt_pk_bf16_f32 v234, v172, v173
  v_pk_add_f32 v[174:175], v[206:207], v[222:223]
  v_cvt_pk_bf16_f32 v235, v174, v175
  ds_write_b128 v13, v[232:235] offset:0
  v_pk_add_f32 v[176:177], v[208:209], v[224:225]
  v_cvt_pk_bf16_f32 v236, v176, v177
  v_pk_add_f32 v[178:179], v[210:211], v[226:227]
  v_cvt_pk_bf16_f32 v237, v178, v179
  v_pk_add_f32 v[180:181], v[212:213], v[228:229]
  v_cvt_pk_bf16_f32 v238, v180, v181
  v_pk_add_f32 v[182:183], v[214:215], v[230:231]
  v_cvt_pk_bf16_f32 v239, v182, v183
  ds_write_b128 v13, v[236:239] offset:4096
  v_pk_add_f32 v[184:185], v[200:201], v[216:217] neg_lo:[0,1] neg_hi:[0,1]
  v_cvt_pk_bf16_f32 v240, v184, v185
  v_pk_add_f32 v[186:187], v[202:203], v[218:219] neg_lo:[0,1] neg_hi:[0,1]
  v_cvt_pk_bf16_f32 v241, v186, v187
  v_pk_add_f32 v[188:189], v[204:205], v[220:221] neg_lo:[0,1] neg_hi:[0,1]
  v_cvt_pk_bf16_f32 v242, v188, v189
  v_pk_add_f32 v[190:191], v[206:207], v[222:223] neg_lo:[0,1] neg_hi:[0,1]
  v_cvt_pk_bf16_f32 v243, v190, v191
  ds_write_b128 v13, v[240:243] offset:8192
  v_pk_add_f32 v[192:193], v[208:209], v[224:225] neg_lo:[0,1] neg_hi:[0,1]
  v_cvt_pk_bf16_f32 v244, v192, v193
  v_pk_add_f32 v[194:195], v[210:211], v[226:227] neg_lo:[0,1] neg_hi:[0,1]
  v_cvt_pk_bf16_f32 v245, v194, v195
  v_pk_add_f32 v[196:197], v[212:213], v[228:229] neg_lo:[0,1] neg_hi:[0,1]
  v_cvt_pk_bf16_f32 v246, v196, v197
  v_pk_add_f32 v[198:199], v[214:215], v[230:231] neg_lo:[0,1] neg_hi:[0,1]
  v_cvt_pk_bf16_f32 v247, v198, v199
  ds_write_b128 v13, v[244:247] offset:12288
  v_xor_b32 v3, 0x2000, v3
  v_lshrrev_b32 v13, 5, v4
  v_lshlrev_b32 v13, 9, v13
  v_bfe_u32 v12, v4, 3, 2
  v_lshl_or_b32 v13, v12, 6, v13
  v_and_b32 v12, 3, v4
  v_lshl_or_b32 v13, v12, 4, v13
  v_bfe_u32 v12, v4, 2, 1
  v_lshl_or_b32 v13, v12, 3, v13
  s_lshr_b32 s68, s3, 1
  s_lshl_b32 s68, s68, 13
  s_add_u32 s68, s68, 32768
  v_add_u32 v13, s68, v13
  s_waitcnt lgkmcnt(0)
  s_barrier
  ds_read_b64_tr_b16 v[200:201], v13 offset:0
  ds_read_b64_tr_b16 v[202:203], v13 offset:256
  ds_read_b64_tr_b16 v[204:205], v13 offset:1024
  ds_read_b64_tr_b16 v[206:207], v13 offset:1280
  ds_read_b64_tr_b16 v[208:209], v13 offset:2048
  ds_read_b64_tr_b16 v[210:211], v13 offset:2304
  ds_read_b64_tr_b16 v[212:213], v13 offset:3072
  ds_read_b64_tr_b16 v[214:215], v13 offset:3328
  ds_read_b64_tr_b16 v[216:217], v13 offset:4096
  ds_read_b64_tr_b16 v[218:219], v13 offset:4352
  ds_read_b64_tr_b16 v[220:221], v13 offset:5120
  ds_read_b64_tr_b16 v[222:223], v13 offset:5376
  ds_read_b64_tr_b16 v[224:225], v13 offset:6144
  ds_read_b64_tr_b16 v[226:227], v13 offset:6400
  ds_read_b64_tr_b16 v[228:229], v13 offset:7168
  ds_read_b64_tr_b16 v[230:231], v13 offset:7424
  ds_read_b128 v[168:171], v3 offset:0
  ds_read_b128 v[172:175], v3 offset:1024
  ds_read_b128 v[176:179], v3 offset:2048
  ds_read_b128 v[180:183], v3 offset:3072
  ds_read_b128 v[184:187], v3 offset:4096
  ds_read_b128 v[188:191], v3 offset:5120
  ds_read_b128 v[192:195], v3 offset:6144
  ds_read_b128 v[196:199], v3 offset:7168
  v_lshlrev_b32 v14, 16, v5
  v_lshl_or_b32 v14, v6, 4, v14
  s_and_b32 s69, s3, 1
  s_lshl_b32 s69, s69, 22
  s_lshl_b32 s68, s38, 12
  s_add_u32 s69, s69, s68
  s_lshl_b32 s68, s39, 6
  s_add_u32 s69, s69, s68
  s_lshr_b32 s68, s3, 1
  s_lshl_b32 s68, s68, 11
  s_add_u32 s69, s69, s68
  s_waitcnt lgkmcnt(15)
  v_mfma_f32_16x16x32_bf16 v[120:123], v[200:203], v[40:43], 0
  s_waitcnt lgkmcnt(14)
  v_mfma_f32_16x16x32_bf16 v[152:155], v[216:219], v[40:43], 0
  v_mfma_f32_16x16x32_bf16 v[120:123], v[204:207], v[44:47], v[120:123]
  s_waitcnt lgkmcnt(12)
  v_mfma_f32_16x16x32_bf16 v[152:155], v[220:223], v[44:47], v[152:155]
  v_mfma_f32_16x16x32_bf16 v[120:123], v[208:211], v[48:51], v[120:123]
  s_waitcnt lgkmcnt(10)
  v_mfma_f32_16x16x32_bf16 v[152:155], v[224:227], v[48:51], v[152:155]
  v_mfma_f32_16x16x32_bf16 v[120:123], v[212:215], v[52:55], v[120:123]
  s_waitcnt lgkmcnt(8)
  v_mfma_f32_16x16x32_bf16 v[152:155], v[228:231], v[52:55], v[152:155]
  v_mfma_f32_16x16x32_bf16 v[124:127], v[200:203], v[56:59], 0
  v_mfma_f32_16x16x32_bf16 v[156:159], v[216:219], v[56:59], 0
  v_mfma_f32_16x16x32_bf16 v[124:127], v[204:207], v[60:63], v[124:127]
  v_mfma_f32_16x16x32_bf16 v[156:159], v[220:223], v[60:63], v[156:159]
  v_mfma_f32_16x16x32_bf16 v[124:127], v[208:211], v[64:67], v[124:127]
  v_mfma_f32_16x16x32_bf16 v[156:159], v[224:227], v[64:67], v[156:159]
  v_mfma_f32_16x16x32_bf16 v[124:127], v[212:215], v[68:71], v[124:127]
  v_mfma_f32_16x16x32_bf16 v[156:159], v[228:231], v[68:71], v[156:159]
  s_waitcnt lgkmcnt(7)
  v_pk_add_f32 v[104:105], v[104:105], v[168:169]
  v_pk_mul_f32 v[104:105], v[32:33], v[104:105] op_sel:[0,0] op_sel_hi:[0,1]
  v_pk_add_f32 v[106:107], v[106:107], v[170:171]
  v_pk_mul_f32 v[106:107], v[32:33], v[106:107] op_sel:[0,0] op_sel_hi:[0,1]
  v_pk_fma_f32 v[104:105], v[8:9], v[120:121], v[104:105] op_sel:[0,0,0] op_sel_hi:[0,1,1]
  v_pk_fma_f32 v[106:107], v[8:9], v[122:123], v[106:107] op_sel:[0,0,0] op_sel_hi:[0,1,1]
  buffer_store_dwordx4 v[104:107], v14, s[64:67], s69 offen offset:0
  s_waitcnt lgkmcnt(3)
  v_pk_add_f32 v[136:137], v[136:137], v[184:185]
  v_pk_mul_f32 v[136:137], v[32:33], v[136:137] op_sel:[0,0] op_sel_hi:[0,1]
  v_pk_add_f32 v[138:139], v[138:139], v[186:187]
  v_pk_mul_f32 v[138:139], v[32:33], v[138:139] op_sel:[0,0] op_sel_hi:[0,1]
  v_pk_fma_f32 v[136:137], v[8:9], v[152:153], v[136:137] op_sel:[0,0,0] op_sel_hi:[0,1,1]
  v_pk_fma_f32 v[138:139], v[8:9], v[154:155], v[138:139] op_sel:[0,0,0] op_sel_hi:[0,1,1]
  buffer_store_dwordx4 v[136:139], v14, s[64:67], s69 offen offset:1024
  s_add_u32 s69, s69, 1048576
  v_mfma_f32_16x16x32_bf16 v[128:131], v[200:203], v[72:75], 0
  v_mfma_f32_16x16x32_bf16 v[160:163], v[216:219], v[72:75], 0
  v_mfma_f32_16x16x32_bf16 v[128:131], v[204:207], v[76:79], v[128:131]
  v_mfma_f32_16x16x32_bf16 v[160:163], v[220:223], v[76:79], v[160:163]
  v_mfma_f32_16x16x32_bf16 v[128:131], v[208:211], v[80:83], v[128:131]
  v_mfma_f32_16x16x32_bf16 v[160:163], v[224:227], v[80:83], v[160:163]
  v_mfma_f32_16x16x32_bf16 v[128:131], v[212:215], v[84:87], v[128:131]
  v_mfma_f32_16x16x32_bf16 v[160:163], v[228:231], v[84:87], v[160:163]
  v_pk_add_f32 v[108:109], v[108:109], v[172:173]
  v_pk_mul_f32 v[108:109], v[32:33], v[108:109] op_sel:[1,0] op_sel_hi:[1,1]
  v_pk_add_f32 v[110:111], v[110:111], v[174:175]
  v_pk_mul_f32 v[110:111], v[32:33], v[110:111] op_sel:[1,0] op_sel_hi:[1,1]
  v_pk_fma_f32 v[108:109], v[8:9], v[124:125], v[108:109] op_sel:[1,0,0] op_sel_hi:[1,1,1]
  v_pk_fma_f32 v[110:111], v[8:9], v[126:127], v[110:111] op_sel:[1,0,0] op_sel_hi:[1,1,1]
  buffer_store_dwordx4 v[108:111], v14, s[64:67], s69 offen offset:0
  s_waitcnt lgkmcnt(2)
  v_pk_add_f32 v[140:141], v[140:141], v[188:189]
  v_pk_mul_f32 v[140:141], v[32:33], v[140:141] op_sel:[1,0] op_sel_hi:[1,1]
  v_pk_add_f32 v[142:143], v[142:143], v[190:191]
  v_pk_mul_f32 v[142:143], v[32:33], v[142:143] op_sel:[1,0] op_sel_hi:[1,1]
  v_pk_fma_f32 v[140:141], v[8:9], v[156:157], v[140:141] op_sel:[1,0,0] op_sel_hi:[1,1,1]
  v_pk_fma_f32 v[142:143], v[8:9], v[158:159], v[142:143] op_sel:[1,0,0] op_sel_hi:[1,1,1]
  buffer_store_dwordx4 v[140:143], v14, s[64:67], s69 offen offset:1024
  s_add_u32 s69, s69, 1048576
  v_mfma_f32_16x16x32_bf16 v[132:135], v[200:203], v[88:91], 0
  v_mfma_f32_16x16x32_bf16 v[164:167], v[216:219], v[88:91], 0
  v_mfma_f32_16x16x32_bf16 v[132:135], v[204:207], v[92:95], v[132:135]
  v_mfma_f32_16x16x32_bf16 v[164:167], v[220:223], v[92:95], v[164:167]
  v_mfma_f32_16x16x32_bf16 v[132:135], v[208:211], v[96:99], v[132:135]
  v_mfma_f32_16x16x32_bf16 v[164:167], v[224:227], v[96:99], v[164:167]
  v_mfma_f32_16x16x32_bf16 v[132:135], v[212:215], v[100:103], v[132:135]
  v_mfma_f32_16x16x32_bf16 v[164:167], v[228:231], v[100:103], v[164:167]
  v_pk_add_f32 v[112:113], v[112:113], v[176:177]
  v_pk_mul_f32 v[112:113], v[34:35], v[112:113] op_sel:[0,0] op_sel_hi:[0,1]
  v_pk_add_f32 v[114:115], v[114:115], v[178:179]
  v_pk_mul_f32 v[114:115], v[34:35], v[114:115] op_sel:[0,0] op_sel_hi:[0,1]
  v_pk_fma_f32 v[112:113], v[10:11], v[128:129], v[112:113] op_sel:[0,0,0] op_sel_hi:[0,1,1]
  v_pk_fma_f32 v[114:115], v[10:11], v[130:131], v[114:115] op_sel:[0,0,0] op_sel_hi:[0,1,1]
  buffer_store_dwordx4 v[112:115], v14, s[64:67], s69 offen offset:0
  s_waitcnt lgkmcnt(1)
  v_pk_add_f32 v[144:145], v[144:145], v[192:193]
  v_pk_mul_f32 v[144:145], v[34:35], v[144:145] op_sel:[0,0] op_sel_hi:[0,1]
  v_pk_add_f32 v[146:147], v[146:147], v[194:195]
  v_pk_mul_f32 v[146:147], v[34:35], v[146:147] op_sel:[0,0] op_sel_hi:[0,1]
  v_pk_fma_f32 v[144:145], v[10:11], v[160:161], v[144:145] op_sel:[0,0,0] op_sel_hi:[0,1,1]
  v_pk_fma_f32 v[146:147], v[10:11], v[162:163], v[146:147] op_sel:[0,0,0] op_sel_hi:[0,1,1]
  buffer_store_dwordx4 v[144:147], v14, s[64:67], s69 offen offset:1024
  s_add_u32 s69, s69, 1048576
  v_pk_add_f32 v[116:117], v[116:117], v[180:181]
  v_pk_mul_f32 v[116:117], v[34:35], v[116:117] op_sel:[1,0] op_sel_hi:[1,1]
  v_pk_add_f32 v[118:119], v[118:119], v[182:183]
  v_pk_mul_f32 v[118:119], v[34:35], v[118:119] op_sel:[1,0] op_sel_hi:[1,1]
  v_pk_fma_f32 v[116:117], v[10:11], v[132:133], v[116:117] op_sel:[1,0,0] op_sel_hi:[1,1,1]
  v_pk_fma_f32 v[118:119], v[10:11], v[134:135], v[118:119] op_sel:[1,0,0] op_sel_hi:[1,1,1]
  buffer_store_dwordx4 v[116:119], v14, s[64:67], s69 offen offset:0
  s_waitcnt lgkmcnt(0)
  v_pk_add_f32 v[148:149], v[148:149], v[196:197]
  v_pk_mul_f32 v[148:149], v[34:35], v[148:149] op_sel:[1,0] op_sel_hi:[1,1]
  v_pk_add_f32 v[150:151], v[150:151], v[198:199]
  v_pk_mul_f32 v[150:151], v[34:35], v[150:151] op_sel:[1,0] op_sel_hi:[1,1]
  v_pk_fma_f32 v[148:149], v[10:11], v[164:165], v[148:149] op_sel:[1,0,0] op_sel_hi:[1,1,1]
  v_pk_fma_f32 v[150:151], v[10:11], v[166:167], v[150:151] op_sel:[1,0,0] op_sel_hi:[1,1,1]
  buffer_store_dwordx4 v[148:151], v14, s[64:67], s69 offen offset:1024
gated_mix__spectral_gfnet__ssm_conv_s5__prompt_kernel_end:
  s_endpgm
.section .rodata,"a"
.p2align 6
.amdhsa_kernel gated_mix__spectral_gfnet__ssm_conv_s5__prompt_kernel
  .amdhsa_next_free_vgpr 504
  .amdhsa_next_free_sgpr 102
  .amdhsa_accum_offset 248
  .amdhsa_group_segment_fixed_size 0
  .amdhsa_kernarg_size 128
  .amdhsa_user_sgpr_count 2
  .amdhsa_user_sgpr_kernarg_segment_ptr 1
  .amdhsa_system_sgpr_workgroup_id_x 1
  .amdhsa_float_denorm_mode_32 3
.end_amdhsa_kernel
```

```asm
; @launch grid=(256,1,1) block=(256,1,1) lds=163840
.amdgcn_target "amdgcn-amd-amdhsa--gfx950"
.text
.p2align 8
.globl gated_mix__spectral_gfnet__ssm_conv_s5__prompt_kernel
.type gated_mix__spectral_gfnet__ssm_conv_s5__prompt_kernel,@function
gated_mix__spectral_gfnet__ssm_conv_s5__prompt_kernel:
  s_cmp_ge_u32 s2, 256
  s_cbranch_scc1 gated_mix__spectral_gfnet__ssm_conv_s5__prompt_kernel_end
  s_load_dwordx16 s[4:19], s[0:1], 0
  s_load_dwordx16 s[20:35], s[0:1], 64
  s_getpc_b64 s[36:37]
gated_mix__spectral_gfnet__ssm_conv_s5__prompt_kernel_pc1:
  s_lshr_b32 s3, s2, 3
  s_mul_i32 s3, s3, 1280
  s_add_u32 s3, s3, 0
  v_min_u32 v2, 9, v0
  v_lshl_add_u32 v2, v2, 7, s3
  v_min_u32 v2, gated_mix__spectral_gfnet__ssm_conv_s5__prompt_kernel_end-gated_mix__spectral_gfnet__ssm_conv_s5__prompt_kernel_pc1, v2
  v_mov_b32 v3, s37
  v_add_co_u32 v2, vcc, s36, v2
  s_nop 1
  v_addc_co_u32 v3, vcc, 0, v3, vcc
  v_lshrrev_b32 v4, 6, v0
  s_nop 0
  v_readfirstlane_b32 s3, v4
  v_and_b32 v4, 63, v0
  v_and_b32 v5, 15, v0
  v_bfe_u32 v6, v0, 4, 2
  s_and_b32 s36, s2, 7
  s_lshr_b32 s37, s2, 3
  s_and_b32 s41, s37, 3
  s_lshr_b32 s37, s37, 2
  s_lshl_b32 s40, s36, 3
  s_add_u32 s40, s40, s37
  s_and_b32 s38, s36, 3
  s_lshl_b32 s38, s38, 2
  s_add_u32 s38, s38, s41
  s_lshr_b32 s39, s36, 2
  s_lshl_b32 s39, s39, 3
  s_add_u32 s39, s39, s37
  s_cmp_lg_u32 s3, 0
  s_cbranch_scc1 gated_mix__spectral_gfnet__ssm_conv_s5__prompt_kernel_skip2
  global_load_dword v1, v[2:3], off
gated_mix__spectral_gfnet__ssm_conv_s5__prompt_kernel_skip2:
  s_waitcnt lgkmcnt(0)
  s_mov_b32 s44, s4
  s_mov_b32 s45, s5
  s_mov_b32 s46, 4194304
  s_mov_b32 s47, 0x20000
  s_add_u32 s48, s34, 20316160
  s_addc_u32 s49, s35, 0
  s_mov_b32 s50, 98304
  s_mov_b32 s51, 0x20000
  s_mov_b32 s52, s32
  s_mov_b32 s53, s33
  s_mov_b32 s54, 256
  s_mov_b32 s55, 0x20000
  s_mov_b32 s36, 0
  s_mov_b32 s37, 32768
  s_lshl_b32 s42, s2, 7
  v_mov_b32 v8, s42
  s_mov_b32 s42, 65536
  v_mov_b32 v2, 1
  v_mov_b32 v3, 0
  v_lshlrev_b32 v7, 7, v0
  s_cmp_lg_u32 s2, 0
  s_cbranch_scc1 gated_mix__spectral_gfnet__ssm_conv_s5__prompt_kernel_skip3
  buffer_store_dword v3, v7, s[48:51], 0 offen sc1
gated_mix__spectral_gfnet__ssm_conv_s5__prompt_kernel_skip3:
  v_bfe_u32 v10, v4, 1, 2
  v_xor_b32 v10, v10, v6
  v_lshlrev_b32 v9, 9, v10
  v_and_b32 v10, 1, v4
  v_lshl_or_b32 v9, v10, 4, v9
  v_lshrrev_b32 v10, 3, v4
  v_lshl_or_b32 v9, v10, 15, v9
  s_lshl_b32 s43, s38, 11
  s_lshl_b32 m0, s39, 5
  s_add_u32 s43, s43, m0
  s_lshl_b32 m0, s3, 20
  s_add_u32 s43, s43, m0
  s_lshl_b32 m0, s3, 12
  s_add_u32 m0, m0, 131072
  s_nop 0
  buffer_load_dwordx4 v9, s[44:47], s43 offen offset:0 lds
  s_add_u32 s43, s43, 261120
  buffer_load_dwordx4 v9, s[44:47], s43 offen offset:1024 lds
  s_add_u32 s43, s43, 261120
  buffer_load_dwordx4 v9, s[44:47], s43 offen offset:2048 lds
  s_add_u32 s43, s43, 261120
  buffer_load_dwordx4 v9, s[44:47], s43 offen offset:3072 lds
  s_bitcmp1_b32 s3, 0
  s_cselect_b32 s56, s18, s16
  s_cselect_b32 s57, s19, s17
  s_mov_b32 s58, 2097152
  s_mov_b32 s59, 0x20000
  v_lshrrev_b32 v28, 5, v4
  v_lshlrev_b32 v28, 5, v28
  v_bfe_u32 v29, v4, 3, 1
  v_lshl_or_b32 v28, v29, 4, v28
  v_bfe_u32 v29, v4, 4, 1
  v_or_b32 v28, v28, v29
  v_lshlrev_b32 v28, 11, v28
  v_lshrrev_b32 v29, 3, v4
  v_lshlrev_b32 v29, 11, v29
  v_and_b32 v30, 7, v4
  v_xor_b32 v30, v30, v6
  v_lshlrev_b32 v30, 4, v30
  v_or_b32 v28, v28, v30
  v_or_b32 v29, v29, v30
  v_xor_b32 v12, 0, v28
  v_add_u32 v12, 0, v12
  v_xor_b32 v16, 0, v29
  v_add_u32 v16, 0, v16
  v_xor_b32 v13, 64, v28
  v_add_u32 v13, 3072, v13
  v_xor_b32 v17, 64, v29
  v_add_u32 v17, 15360, v17
  v_xor_b32 v14, 0, v28
  v_add_u32 v14, 6144, v14
  v_xor_b32 v18, 0, v29
  v_add_u32 v18, 30720, v18
  v_xor_b32 v15, 64, v28
  v_add_u32 v15, 9216, v15
  v_xor_b32 v19, 64, v29
  v_add_u32 v19, 46080, v19
  s_lshl_b32 s43, s38, 18
  s_lshr_b32 s63, s3, 1
  s_lshl_b32 s61, s63, 17
  s_add_u32 s43, s43, s61
  s_lshl_b32 s60, s39, 17
  s_lshl_b32 s61, s63, 16
  s_add_u32 s60, s60, s61
  s_and_b32 s63, s3, 1
  s_lshl_b32 s63, s63, 14
  s_add_u32 s43, s43, s63
  s_lshl_b32 s63, s3, 12
  s_add_u32 s61, s63, 0
  s_add_u32 s62, s63, 65536
  v_and_b32 v28, 31, v4
  v_lshlrev_b32 v28, 7, v28
  v_bfe_u32 v29, v4, 1, 3
  v_lshrrev_b32 v30, 5, v4
  v_xor_b32 v29, v29, v30
  v_lshl_or_b32 v28, v29, 4, v28
  s_lshr_b32 s63, s3, 1
  s_lshl_b32 s63, s63, 13
  s_add_u32 s63, s63, 0
  v_add_u32 v29, s63, v28
  s_and_b32 s63, s3, 1
  s_lshl_b32 s63, s63, 13
  s_add_u32 s63, s63, 65536
  v_add_u32 v30, s63, v28
  v_xor_b32 v20, 0, v29
  v_xor_b32 v24, 0, v30
  v_xor_b32 v21, 32, v29
  v_xor_b32 v25, 32, v30
  v_xor_b32 v22, 64, v29
  v_xor_b32 v26, 64, v30
  v_xor_b32 v23, 96, v29
  v_xor_b32 v27, 96, v30
  v_add_u32 v12, s43, v12
  v_add_u32 v16, s60, v16
  v_add_u32 v13, s43, v13
  v_add_u32 v17, s60, v17
  v_add_u32 v14, s43, v14
  v_add_u32 v18, s60, v18
  v_add_u32 v15, s43, v15
  v_add_u32 v19, s60, v19
  s_add_u32 s43, s38, s39
  s_and_b32 s43, s43, 15
  s_lshl_b32 s43, s43, 7
  s_lshl_b32 s63, s3, 4
  v_add_u32 v61, s63, v5
  v_cvt_f32_u32 v9, v61
  v_mul_f32 v9, 0x3c000000, v9
  v_cmp_eq_u32 vcc, 0, v61
  s_nop 1
  v_cndmask_b32 v10, v9, 0.5, vcc
  v_mov_b32 v11, 0x3e800000
  v_cndmask_b32 v11, v11, 0, vcc
  v_lshrrev_b32 v61, 1, v6
  v_lshlrev_b32 v61, 4, v61
  v_and_b32 v62, 1, v6
  v_lshl_add_u32 v61, v62, 2, v61
  v_cvt_f32_u32 v60, v61
  v_fma_f32 v11, v60, v10, v11
  v_mul_f32 v60, v60, v9
  v_fmamk_f32 v61, v9, 0x0, v60
  v_fmamk_f32 v62, v9, 0x3f800000, v60
  v_cos_f32 v61, v61
  v_cos_f32 v62, v62
  s_nop 0
  v_cvt_pk_bf16_f32 v28, v61, v62
  v_fmamk_f32 v61, v9, 0x40000000, v60
  v_fmamk_f32 v62, v9, 0x40400000, v60
  v_cos_f32 v61, v61
  v_cos_f32 v62, v62
  s_nop 0
  v_cvt_pk_bf16_f32 v29, v61, v62
  v_fmamk_f32 v61, v9, 0x41000000, v60
  v_fmamk_f32 v62, v9, 0x41100000, v60
  v_cos_f32 v61, v61
  v_cos_f32 v62, v62
  s_nop 0
  v_cvt_pk_bf16_f32 v30, v61, v62
  v_fmamk_f32 v61, v9, 0x41200000, v60
  v_fmamk_f32 v62, v9, 0x41300000, v60
  v_cos_f32 v61, v61
  v_cos_f32 v62, v62
  s_nop 0
  v_cvt_pk_bf16_f32 v31, v61, v62
  v_fmamk_f32 v61, v9, 0x42000000, v60
  v_fmamk_f32 v62, v9, 0x42040000, v60
  v_cos_f32 v61, v61
  v_cos_f32 v62, v62
  s_nop 0
  v_cvt_pk_bf16_f32 v32, v61, v62
  v_fmamk_f32 v61, v9, 0x42080000, v60
  v_fmamk_f32 v62, v9, 0x420c0000, v60
  v_cos_f32 v61, v61
  v_cos_f32 v62, v62
  s_nop 0
  v_cvt_pk_bf16_f32 v33, v61, v62
  v_fmamk_f32 v61, v9, 0x42200000, v60
  v_fmamk_f32 v62, v9, 0x42240000, v60
  v_cos_f32 v61, v61
  v_cos_f32 v62, v62
  s_nop 0
  v_cvt_pk_bf16_f32 v34, v61, v62
  v_fmamk_f32 v61, v9, 0x42280000, v60
  v_fmamk_f32 v62, v9, 0x422c0000, v60
  v_cos_f32 v61, v61
  v_cos_f32 v62, v62
  s_nop 0
  v_cvt_pk_bf16_f32 v35, v61, v62
  v_fmamk_f32 v61, v9, 0x42800000, v60
  v_fmamk_f32 v62, v9, 0x42820000, v60
  v_cos_f32 v61, v61
  v_cos_f32 v62, v62
  s_nop 0
  v_cvt_pk_bf16_f32 v36, v61, v62
  v_fmamk_f32 v61, v9, 0x42840000, v60
  v_fmamk_f32 v62, v9, 0x42860000, v60
  v_cos_f32 v61, v61
  v_cos_f32 v62, v62
  s_nop 0
  v_cvt_pk_bf16_f32 v37, v61, v62
  v_fmamk_f32 v61, v9, 0x42900000, v60
  v_fmamk_f32 v62, v9, 0x42920000, v60
  v_cos_f32 v61, v61
  v_cos_f32 v62, v62
  s_nop 0
  v_cvt_pk_bf16_f32 v38, v61, v62
  v_fmamk_f32 v61, v9, 0x42940000, v60
  v_fmamk_f32 v62, v9, 0x42960000, v60
  v_cos_f32 v61, v61
  v_cos_f32 v62, v62
  s_nop 0
  v_cvt_pk_bf16_f32 v39, v61, v62
  v_fmamk_f32 v61, v9, 0x42c00000, v60
  v_fmamk_f32 v62, v9, 0x42c20000, v60
  v_cos_f32 v61, v61
  v_cos_f32 v62, v62
  s_nop 0
  v_cvt_pk_bf16_f32 v40, v61, v62
  v_fmamk_f32 v61, v9, 0x42c40000, v60
  v_fmamk_f32 v62, v9, 0x42c60000, v60
  v_cos_f32 v61, v61
  v_cos_f32 v62, v62
  s_nop 0
  v_cvt_pk_bf16_f32 v41, v61, v62
  v_fmamk_f32 v61, v9, 0x42d00000, v60
  v_fmamk_f32 v62, v9, 0x42d20000, v60
  v_cos_f32 v61, v61
  v_cos_f32 v62, v62
  s_nop 0
  v_cvt_pk_bf16_f32 v42, v61, v62
  v_fmamk_f32 v61, v9, 0x42d40000, v60
  v_fmamk_f32 v62, v9, 0x42d60000, v60
  v_cos_f32 v61, v61
  v_cos_f32 v62, v62
  s_nop 0
  v_cvt_pk_bf16_f32 v43, v61, v62
  v_fmamk_f32 v61, v10, 0x0, v11
  v_fmamk_f32 v62, v10, 0x3f800000, v11
  v_cos_f32 v61, v61
  v_cos_f32 v62, v62
  s_nop 0
  v_cvt_pk_bf16_f32 v44, v61, v62
  v_fmamk_f32 v61, v10, 0x40000000, v11
  v_fmamk_f32 v62, v10, 0x40400000, v11
  v_cos_f32 v61, v61
  v_cos_f32 v62, v62
  s_nop 0
  v_cvt_pk_bf16_f32 v45, v61, v62
  v_fmamk_f32 v61, v10, 0x41000000, v11
  v_fmamk_f32 v62, v10, 0x41100000, v11
  v_cos_f32 v61, v61
  v_cos_f32 v62, v62
  s_nop 0
  v_cvt_pk_bf16_f32 v46, v61, v62
  v_fmamk_f32 v61, v10, 0x41200000, v11
  v_fmamk_f32 v62, v10, 0x41300000, v11
  v_cos_f32 v61, v61
  v_cos_f32 v62, v62
  s_nop 0
  v_cvt_pk_bf16_f32 v47, v61, v62
  v_fmamk_f32 v61, v10, 0x42000000, v11
  v_fmamk_f32 v62, v10, 0x42040000, v11
  v_cos_f32 v61, v61
  v_cos_f32 v62, v62
  s_nop 0
  v_cvt_pk_bf16_f32 v48, v61, v62
  v_fmamk_f32 v61, v10, 0x42080000, v11
  v_fmamk_f32 v62, v10, 0x420c0000, v11
  v_cos_f32 v61, v61
  v_cos_f32 v62, v62
  s_nop 0
  v_cvt_pk_bf16_f32 v49, v61, v62
  v_fmamk_f32 v61, v10, 0x42200000, v11
  v_fmamk_f32 v62, v10, 0x42240000, v11
  v_cos_f32 v61, v61
  v_cos_f32 v62, v62
  s_nop 0
  v_cvt_pk_bf16_f32 v50, v61, v62
  v_fmamk_f32 v61, v10, 0x42280000, v11
  v_fmamk_f32 v62, v10, 0x422c0000, v11
  v_cos_f32 v61, v61
  v_cos_f32 v62, v62
  s_nop 0
  v_cvt_pk_bf16_f32 v51, v61, v62
  v_fmamk_f32 v61, v10, 0x42800000, v11
  v_fmamk_f32 v62, v10, 0x42820000, v11
  v_cos_f32 v61, v61
  v_cos_f32 v62, v62
  s_nop 0
  v_cvt_pk_bf16_f32 v52, v61, v62
  v_fmamk_f32 v61, v10, 0x42840000, v11
  v_fmamk_f32 v62, v10, 0x42860000, v11
  v_cos_f32 v61, v61
  v_cos_f32 v62, v62
  s_nop 0
  v_cvt_pk_bf16_f32 v53, v61, v62
  v_fmamk_f32 v61, v10, 0x42900000, v11
  v_fmamk_f32 v62, v10, 0x42920000, v11
  v_cos_f32 v61, v61
  v_cos_f32 v62, v62
  s_nop 0
  v_cvt_pk_bf16_f32 v54, v61, v62
  v_fmamk_f32 v61, v10, 0x42940000, v11
  v_fmamk_f32 v62, v10, 0x42960000, v11
  v_cos_f32 v61, v61
  v_cos_f32 v62, v62
  s_nop 0
  v_cvt_pk_bf16_f32 v55, v61, v62
  v_fmamk_f32 v61, v10, 0x42c00000, v11
  v_fmamk_f32 v62, v10, 0x42c20000, v11
  v_cos_f32 v61, v61
  v_cos_f32 v62, v62
  s_nop 0
  v_cvt_pk_bf16_f32 v56, v61, v62
  v_fmamk_f32 v61, v10, 0x42c40000, v11
  v_fmamk_f32 v62, v10, 0x42c60000, v11
  v_cos_f32 v61, v61
  v_cos_f32 v62, v62
  s_nop 0
  v_cvt_pk_bf16_f32 v57, v61, v62
  v_fmamk_f32 v61, v10, 0x42d00000, v11
  v_fmamk_f32 v62, v10, 0x42d20000, v11
  v_cos_f32 v61, v61
  v_cos_f32 v62, v62
  s_nop 0
  v_cvt_pk_bf16_f32 v58, v61, v62
  v_fmamk_f32 v61, v10, 0x42d40000, v11
  v_fmamk_f32 v62, v10, 0x42d60000, v11
  v_cos_f32 v61, v61
  v_cos_f32 v62, v62
  s_nop 0
  v_cvt_pk_bf16_f32 v59, v61, v62
  s_mov_b32 s64, s28
  s_mov_b32 s65, s29
  s_mov_b32 s66, 2048
  s_mov_b32 s67, 0x20000
  v_lshlrev_b32 v9, 4, v4
  s_lshl_b32 s63, s2, 14
  s_lshl_b32 s68, s3, 12
  s_add_u32 s63, s63, s68
  buffer_load_dwordx4 v[60:63], v9, s[44:47], s63 offen offset:0
  buffer_load_dwordx4 v[64:67], v9, s[44:47], s63 offen offset:1024
  buffer_load_dwordx4 v[68:71], v9, s[44:47], s63 offen offset:2048
  buffer_load_dwordx4 v[72:75], v9, s[44:47], s63 offen offset:3072
  buffer_load_dwordx4 v[76:79], v9, s[64:67], 0 offen offset:0
  buffer_load_dwordx4 v[80:83], v9, s[64:67], 0 offen offset:1024
  s_mov_b32 s64, s6
  s_mov_b32 s65, s7
  s_mov_b32 s66, 2101248
  s_mov_b32 s67, 0x20000
  s_mov_b32 s68, s8
  s_mov_b32 s69, s9
  s_mov_b32 s70, 2101248
  s_mov_b32 s71, 0x20000
  s_lshl_b32 s77, s41, 2
  s_add_u32 s77, s77, s3
  s_lshl_b32 s63, s77, 7
  s_add_u32 s63, s63, s40
  s_sub_u32 s76, 2048, s63
  s_and_b32 s76, s76, 2047
  s_mul_i32 s63, s63, 1026
  s_mul_i32 s76, s76, 1026
  v_lshlrev_b32 v9, 9, v6
  v_lshl_add_u32 v9, v5, 3, v9
  v_add_u32 v101, s63, v9
  v_sub_u32 v100, s76, v9
  v_add_u32 v100, 1658, v100
  v_cmp_lt_u32 vcc, 1, v6
  s_nop 1
  v_cndmask_b32 v101, v101, v100, vcc
  buffer_load_dwordx2 v[84:85], v101, s[64:67], 0 offen offset:0
  buffer_load_dwordx2 v[92:93], v101, s[68:71], 0 offen offset:0
  buffer_load_dwordx2 v[86:87], v101, s[64:67], 0 offen offset:128
  buffer_load_dwordx2 v[94:95], v101, s[68:71], 0 offen offset:128
  buffer_load_dwordx2 v[88:89], v101, s[64:67], 0 offen offset:256
  buffer_load_dwordx2 v[96:97], v101, s[68:71], 0 offen offset:256
  buffer_load_dwordx2 v[90:91], v101, s[64:67], 0 offen offset:384
  buffer_load_dwordx2 v[98:99], v101, s[68:71], 0 offen offset:384
  s_add_u32 s63, s63, 1024
  v_mov_b32 v100, s76
  v_mov_b32 v9, s63
  v_cndmask_b32 v100, v100, v9, vcc
  buffer_load_ushort v10, v100, s[64:67], 0 offen
  buffer_load_ushort v11, v100, s[68:71], 0 offen
  s_lshl_b32 s72, s40, 16
  s_lshl_b32 s63, s77, 10
  s_add_u32 s72, s72, s63
  s_add_u32 s73, s72, 16384
  s_add_u32 s74, s72, 32768
  s_add_u32 s75, s72, 49152
  s_cmp_lg_u32 s40, 0
  s_cbranch_scc1 gated_mix__spectral_gfnet__ssm_conv_s5__prompt_kernel_skip4
  s_mov_b32 s75, 2130706432
  s_cmp_gt_u32 s77, 8
  s_cselect_b32 s72, 2130706432, s72
  s_cselect_b32 s74, 2130706432, s74
  s_cmp_eq_u32 s77, 8
  s_cselect_b32 s72, 4194304, s72
  s_cselect_b32 s74, 4195328, s74
gated_mix__spectral_gfnet__ssm_conv_s5__prompt_kernel_skip4:
  s_cmp_lg_u32 s40, 0
  s_cbranch_scc1 gated_mix__spectral_gfnet__ssm_conv_s5__prompt_kernel_skip5
  s_lshl_b32 s81, s41, 2
  s_add_u32 s81, s81, s3
  s_lshl_b32 s63, s81, 7
  s_add_u32 s63, s63, 64
  s_sub_u32 s80, 2048, s63
  s_and_b32 s80, s80, 2047
  s_mul_i32 s63, s63, 1026
  s_mul_i32 s80, s80, 1026
  v_lshlrev_b32 v9, 9, v6
  v_lshl_add_u32 v9, v5, 3, v9
  v_add_u32 v119, s63, v9
  v_sub_u32 v118, s80, v9
  v_add_u32 v118, 1658, v118
  v_cmp_lt_u32 vcc, 1, v6
  s_nop 1
  v_cndmask_b32 v119, v119, v118, vcc
  buffer_load_dwordx2 v[100:101], v119, s[64:67], 0 offen offset:0
  buffer_load_dwordx2 v[108:109], v119, s[68:71], 0 offen offset:0
  buffer_load_dwordx2 v[102:103], v119, s[64:67], 0 offen offset:128
  buffer_load_dwordx2 v[110:111], v119, s[68:71], 0 offen offset:128
  buffer_load_dwordx2 v[104:105], v119, s[64:67], 0 offen offset:256
  buffer_load_dwordx2 v[112:113], v119, s[68:71], 0 offen offset:256
  buffer_load_dwordx2 v[106:107], v119, s[64:67], 0 offen offset:384
  buffer_load_dwordx2 v[114:115], v119, s[68:71], 0 offen offset:384
  s_add_u32 s63, s63, 1024
  v_mov_b32 v118, s80
  v_mov_b32 v9, s63
  v_cndmask_b32 v118, v118, v9, vcc
  buffer_load_ushort v116, v118, s[64:67], 0 offen
  buffer_load_ushort v117, v118, s[68:71], 0 offen
  s_lshl_b32 s63, s81, 10
  s_add_u32 s76, s63, 8192
  s_add_u32 s77, s63, 49152
  s_add_u32 s78, s63, 40960
  s_mov_b32 s79, 2130706432
  s_cmp_gt_u32 s81, 7
  s_cselect_b32 s76, 2130706432, s76
  s_cselect_b32 s78, 2130706432, s78
gated_mix__spectral_gfnet__ssm_conv_s5__prompt_kernel_skip5:
  s_mov_b32 s64, s12
  s_mov_b32 s65, s13
  s_mov_b32 s66, 2048
  s_mov_b32 s67, 0x20000
  s_mov_b32 s68, s14
  s_mov_b32 s69, s15
  s_mov_b32 s70, 2048
  s_mov_b32 s71, 0x20000
  s_mov_b32 s80, s24
  s_mov_b32 s81, s25
  s_mov_b32 s82, 2048
  s_mov_b32 s83, 0x20000
  v_and_b32 v9, 31, v4
  v_lshlrev_b32 v9, 1, v9
  s_lshl_b32 s63, s39, 7
  s_and_b32 s84, s3, 1
  s_lshl_b32 s84, s84, 6
  s_add_u32 s63, s63, s84
  buffer_load_ushort v118, v9, s[64:67], s63 offen
  buffer_load_ushort v119, v9, s[68:71], s63 offen
  buffer_load_ushort v120, v9, s[80:83], s63 offen
  s_add_u32 m0, s62, 0
  s_nop 0
  buffer_load_dwordx4 v16, s[56:59], s43 offen offset:0 lds
  buffer_load_dwordx4 v17, s[56:59], s43 offen offset:1024 lds
  buffer_load_dwordx4 v18, s[56:59], s43 offen offset:2048 lds
  buffer_load_dwordx4 v19, s[56:59], s43 offen offset:3072 lds
  s_add_u32 m0, s61, 0
  s_nop 0
  buffer_load_dwordx4 v12, s[44:47], s43 offen offset:0 lds
  buffer_load_dwordx4 v13, s[44:47], s43 offen offset:1024 lds
  buffer_load_dwordx4 v14, s[44:47], s43 offen offset:2048 lds
  buffer_load_dwordx4 v15, s[44:47], s43 offen offset:3072 lds
  s_add_u32 s43, s43, 128
  s_and_b32 s43, s43, 0x7ff
  s_mov_b32 s64, s34
  s_mov_b32 s65, s35
  s_mov_b32 s66, 4194304
  s_mov_b32 s67, 0x20000
  v_bfe_u32 v9, v4, 2, 3
  v_lshrrev_b32 v121, 5, v4
  v_lshl_or_b32 v9, v121, 4, v9
  v_lshlrev_b32 v9, 7, v9
  v_and_b32 v121, 3, v4
  v_lshl_or_b32 v9, v121, 3, v9
  v_add_u32 v9, 131072, v9
  v_bfe_u32 v121, v4, 3, 2
  v_xor_b32 v124, 0, v121
  v_lshl_add_u32 v124, v124, 5, v9
  v_xor_b32 v125, 1, v121
  v_lshl_add_u32 v125, v125, 5, v9
  v_xor_b32 v126, 2, v121
  v_lshl_add_u32 v126, v126, 5, v9
  v_xor_b32 v127, 3, v121
  v_lshl_add_u32 v127, v127, 5, v9
  s_waitcnt vmcnt(27)
  s_barrier
  s_or_b32 m0, s3, s2
  s_cmp_lg_u32 m0, 0
  s_cbranch_scc1 gated_mix__spectral_gfnet__ssm_conv_s5__prompt_kernel_skip6
  s_mov_b64 exec, 1
  buffer_store_dword v2, v3, s[52:55], 0 offen sc1
  s_mov_b64 exec, -1
gated_mix__spectral_gfnet__ssm_conv_s5__prompt_kernel_skip6:
  ds_read_b64_tr_b16 v[160:161], v124 offset:0
  ds_read_b64_tr_b16 v[162:163], v124 offset:1024
  ds_read_b64_tr_b16 v[164:165], v124 offset:4096
  ds_read_b64_tr_b16 v[166:167], v124 offset:5120
  ds_read_b64_tr_b16 v[168:169], v124 offset:8192
  ds_read_b64_tr_b16 v[170:171], v124 offset:9216
  ds_read_b64_tr_b16 v[172:173], v124 offset:12288
  ds_read_b64_tr_b16 v[174:175], v124 offset:13312
  ds_read_b64_tr_b16 v[192:193], v126 offset:0
  ds_read_b64_tr_b16 v[194:195], v126 offset:1024
  ds_read_b64_tr_b16 v[196:197], v126 offset:4096
  ds_read_b64_tr_b16 v[198:199], v126 offset:5120
  ds_read_b64_tr_b16 v[200:201], v126 offset:8192
  ds_read_b64_tr_b16 v[202:203], v126 offset:9216
  ds_read_b64_tr_b16 v[204:205], v126 offset:12288
  ds_read_b64_tr_b16 v[206:207], v126 offset:13312
  ds_read_b64_tr_b16 v[176:177], v125 offset:0
  ds_read_b64_tr_b16 v[178:179], v125 offset:1024
  ds_read_b64_tr_b16 v[180:181], v125 offset:4096
  ds_read_b64_tr_b16 v[182:183], v125 offset:5120
  ds_read_b64_tr_b16 v[184:185], v125 offset:8192
  ds_read_b64_tr_b16 v[186:187], v125 offset:9216
  ds_read_b64_tr_b16 v[188:189], v125 offset:12288
  ds_read_b64_tr_b16 v[190:191], v125 offset:13312
  s_waitcnt lgkmcnt(15)
  v_mfma_f32_16x16x32_bf16 v[128:131], v[28:31], v[160:163], 0
  v_mfma_f32_16x16x32_bf16 v[132:135], v[44:47], v[160:163], 0
  s_waitcnt lgkmcnt(15)
  v_mfma_f32_16x16x32_bf16 v[128:131], v[32:35], v[164:167], v[128:131]
  v_mfma_f32_16x16x32_bf16 v[132:135], v[48:51], v[164:167], v[132:135]
  s_add_u32 m0, s62, 16384
  s_nop 0
  buffer_load_dwordx4 v16, s[56:59], s43 offen offset:0 lds
  s_waitcnt lgkmcnt(15)
  v_mfma_f32_16x16x32_bf16 v[128:131], v[36:39], v[168:171], v[128:131]
  v_mfma_f32_16x16x32_bf16 v[132:135], v[52:55], v[168:171], v[132:135]
  s_waitcnt lgkmcnt(15)
  v_mfma_f32_16x16x32_bf16 v[128:131], v[40:43], v[172:175], v[128:131]
  v_mfma_f32_16x16x32_bf16 v[132:135], v[56:59], v[172:175], v[132:135]
  buffer_load_dwordx4 v17, s[56:59], s43 offen offset:1024 lds
  ds_read_b64_tr_b16 v[208:209], v127 offset:0
  ds_read_b64_tr_b16 v[210:211], v127 offset:1024
  ds_read_b64_tr_b16 v[212:213], v127 offset:4096
  ds_read_b64_tr_b16 v[214:215], v127 offset:5120
  ds_read_b64_tr_b16 v[216:217], v127 offset:8192
  ds_read_b64_tr_b16 v[218:219], v127 offset:9216
  ds_read_b64_tr_b16 v[220:221], v127 offset:12288
  ds_read_b64_tr_b16 v[222:223], v127 offset:13312
  s_waitcnt lgkmcnt(15)
  v_mfma_f32_16x16x32_bf16 v[144:147], v[28:31], v[192:195], 0
  v_mfma_f32_16x16x32_bf16 v[148:151], v[44:47], v[192:195], 0
  s_waitcnt lgkmcnt(15)
  v_mfma_f32_16x16x32_bf16 v[144:147], v[32:35], v[196:199], v[144:147]
  v_mfma_f32_16x16x32_bf16 v[148:151], v[48:51], v[196:199], v[148:151]
  buffer_load_dwordx4 v18, s[56:59], s43 offen offset:2048 lds
  s_waitcnt lgkmcnt(15)
  v_mfma_f32_16x16x32_bf16 v[144:147], v[36:39], v[200:203], v[144:147]
  v_mfma_f32_16x16x32_bf16 v[148:151], v[52:55], v[200:203], v[148:151]
  s_waitcnt lgkmcnt(15)
  v_mfma_f32_16x16x32_bf16 v[144:147], v[40:43], v[204:207], v[144:147]
  v_mfma_f32_16x16x32_bf16 v[148:151], v[56:59], v[204:207], v[148:151]
  buffer_load_dwordx4 v19, s[56:59], s43 offen offset:3072 lds
  s_waitcnt lgkmcnt(14)
  v_mfma_f32_16x16x32_bf16 v[136:139], v[28:31], v[176:179], 0
  v_mfma_f32_16x16x32_bf16 v[140:143], v[44:47], v[176:179], 0
  s_waitcnt lgkmcnt(12)
  v_mfma_f32_16x16x32_bf16 v[136:139], v[32:35], v[180:183], v[136:139]
  v_mfma_f32_16x16x32_bf16 v[140:143], v[48:51], v[180:183], v[140:143]
  s_add_u32 m0, s61, 16384
  s_nop 0
  buffer_load_dwordx4 v12, s[44:47], s43 offen offset:0 lds
  s_waitcnt lgkmcnt(10)
  v_mfma_f32_16x16x32_bf16 v[136:139], v[36:39], v[184:187], v[136:139]
  v_mfma_f32_16x16x32_bf16 v[140:143], v[52:55], v[184:187], v[140:143]
  s_waitcnt lgkmcnt(8)
  v_mfma_f32_16x16x32_bf16 v[136:139], v[40:43], v[188:191], v[136:139]
  v_mfma_f32_16x16x32_bf16 v[140:143], v[56:59], v[188:191], v[140:143]
  buffer_load_dwordx4 v13, s[44:47], s43 offen offset:1024 lds
  s_waitcnt lgkmcnt(6)
  v_mfma_f32_16x16x32_bf16 v[152:155], v[28:31], v[208:211], 0
  v_mfma_f32_16x16x32_bf16 v[156:159], v[44:47], v[208:211], 0
  s_waitcnt lgkmcnt(4)
  v_mfma_f32_16x16x32_bf16 v[152:155], v[32:35], v[212:215], v[152:155]
  v_mfma_f32_16x16x32_bf16 v[156:159], v[48:51], v[212:215], v[156:159]
  buffer_load_dwordx4 v14, s[44:47], s43 offen offset:2048 lds
  s_waitcnt lgkmcnt(2)
  v_mfma_f32_16x16x32_bf16 v[152:155], v[36:39], v[216:219], v[152:155]
  v_mfma_f32_16x16x32_bf16 v[156:159], v[52:55], v[216:219], v[156:159]
  s_waitcnt lgkmcnt(0)
  v_mfma_f32_16x16x32_bf16 v[152:155], v[40:43], v[220:223], v[152:155]
  v_mfma_f32_16x16x32_bf16 v[156:159], v[56:59], v[220:223], v[156:159]
  buffer_load_dwordx4 v15, s[44:47], s43 offen offset:3072 lds
  s_add_u32 s43, s43, 128
  s_and_b32 s43, s43, 0x7ff
  v_pk_add_f32 v[160:161], v[128:129], v[144:145]
  v_pk_add_f32 v[192:193], v[128:129], v[144:145] neg_lo:[0,1] neg_hi:[0,1]
  v_pk_add_f32 v[162:163], v[130:131], v[146:147]
  v_pk_add_f32 v[194:195], v[130:131], v[146:147] neg_lo:[0,1] neg_hi:[0,1]
  v_pk_add_f32 v[164:165], v[132:133], v[148:149]
  v_pk_add_f32 v[196:197], v[132:133], v[148:149] neg_lo:[0,1] neg_hi:[0,1]
  v_pk_add_f32 v[166:167], v[134:135], v[150:151]
  v_pk_add_f32 v[198:199], v[134:135], v[150:151] neg_lo:[0,1] neg_hi:[0,1]
  v_pk_add_f32 v[168:169], v[136:137], v[152:153]
  v_pk_add_f32 v[200:201], v[136:137], v[152:153] neg_lo:[0,1] neg_hi:[0,1]
  v_pk_add_f32 v[170:171], v[138:139], v[154:155]
  v_pk_add_f32 v[202:203], v[138:139], v[154:155] neg_lo:[0,1] neg_hi:[0,1]
  v_pk_add_f32 v[172:173], v[140:141], v[156:157]
  v_pk_add_f32 v[204:205], v[140:141], v[156:157] neg_lo:[0,1] neg_hi:[0,1]
  v_pk_add_f32 v[174:175], v[142:143], v[158:159]
  v_pk_add_f32 v[206:207], v[142:143], v[158:159] neg_lo:[0,1] neg_hi:[0,1]
  v_pk_add_f32 v[128:129], v[160:161], v[168:169]
  v_pk_add_f32 v[144:145], v[160:161], v[168:169] neg_lo:[0,1] neg_hi:[0,1]
  v_pk_add_f32 v[132:133], v[164:165], v[172:173]
  v_pk_add_f32 v[148:149], v[164:165], v[172:173] neg_lo:[0,1] neg_hi:[0,1]
  v_pk_add_f32 v[136:137], v[192:193], v[204:205]
  v_pk_add_f32 v[140:141], v[196:197], v[200:201] neg_lo:[0,1] neg_hi:[0,1]
  v_pk_add_f32 v[152:153], v[192:193], v[204:205] neg_lo:[0,1] neg_hi:[0,1]
  v_pk_add_f32 v[156:157], v[196:197], v[200:201]
  v_pk_add_f32 v[130:131], v[162:163], v[170:171]
  v_pk_add_f32 v[146:147], v[162:163], v[170:171] neg_lo:[0,1] neg_hi:[0,1]
  v_pk_add_f32 v[134:135], v[166:167], v[174:175]
  v_pk_add_f32 v[150:151], v[166:167], v[174:175] neg_lo:[0,1] neg_hi:[0,1]
  v_pk_add_f32 v[138:139], v[194:195], v[206:207]
  v_pk_add_f32 v[142:143], v[198:199], v[202:203] neg_lo:[0,1] neg_hi:[0,1]
  v_pk_add_f32 v[154:155], v[194:195], v[206:207] neg_lo:[0,1] neg_hi:[0,1]
  v_pk_add_f32 v[158:159], v[198:199], v[202:203]
  v_cmp_gt_u32 vcc, 16, v0
  s_nop 1
  v_cndmask_b32 v136, v136, v192, vcc
  v_cndmask_b32 v140, v140, -v200, vcc
  v_cndmask_b32 v152, v152, v196, vcc
  v_cndmask_b32 v156, v156, -v204, vcc
  v_cvt_pk_bf16_f32 v224, v128, v132
  v_cvt_pk_bf16_f32 v225, v136, v140
  v_cvt_pk_bf16_f32 v226, v144, v148
  v_cvt_pk_bf16_f32 v227, v152, v156
  v_cvt_pk_bf16_f32 v228, v129, v133
  v_cvt_pk_bf16_f32 v229, v137, v141
  v_cvt_pk_bf16_f32 v230, v145, v149
  v_cvt_pk_bf16_f32 v231, v153, v157
  v_cvt_pk_bf16_f32 v232, v130, v134
  v_cvt_pk_bf16_f32 v233, v138, v142
  v_cvt_pk_bf16_f32 v234, v146, v150
  v_cvt_pk_bf16_f32 v235, v154, v158
  v_cvt_pk_bf16_f32 v236, v131, v135
  v_cvt_pk_bf16_f32 v237, v139, v143
  v_cvt_pk_bf16_f32 v238, v147, v151
  v_cvt_pk_bf16_f32 v239, v155, v159
  s_mov_b32 s63, 262144
  v_mul_lo_u32 v9, v6, s63
  v_lshl_add_u32 v9, v5, 2, v9
  s_mul_i32 s63, s3, 1048576
  s_lshl_b32 s68, s38, 10
  s_add_u32 s63, s63, s68
  s_lshl_b32 s68, s39, 6
  s_add_u32 s63, s63, s68
  s_add_u32 s68, s34, 20971520
  s_addc_u32 s69, s35, 0
  s_mov_b32 s70, 4196352
  s_mov_b32 s71, 0x20000
  s_add_u32 s80, s34, 19922944
  s_addc_u32 s81, s35, 0
  s_mov_b32 s82, 8192
  s_mov_b32 s83, 0x20000
  s_lshl_b32 s84, s39, 14
  s_add_u32 s90, s84, 19988480
  s_add_u32 s88, s34, s90
  s_addc_u32 s89, s35, 0
  s_mov_b32 s90, 16384
  s_mov_b32 s91, 0x20000
  buffer_store_dword v224, v9, s[64:67], s63 offen sc1
  s_add_u32 s63, s63, 16384
  buffer_store_dword v225, v9, s[64:67], s63 offen sc1
  s_add_u32 s63, s63, 16384
  buffer_store_dword v226, v9, s[64:67], s63 offen sc1
  s_add_u32 s63, s63, 16384
  buffer_store_dword v227, v9, s[64:67], s63 offen sc1
  s_add_u32 s63, s63, 16384
  buffer_store_dword v228, v9, s[64:67], s63 offen sc1
  s_add_u32 s63, s63, 16384
  buffer_store_dword v229, v9, s[64:67], s63 offen sc1
  s_add_u32 s63, s63, 16384
  buffer_store_dword v230, v9, s[64:67], s63 offen sc1
  s_add_u32 s63, s63, 16384
  buffer_store_dword v231, v9, s[64:67], s63 offen sc1
  s_add_u32 s63, s63, 16384
  buffer_store_dword v232, v9, s[64:67], s63 offen sc1
  s_add_u32 s63, s63, 16384
  buffer_store_dword v233, v9, s[64:67], s63 offen sc1
  s_add_u32 s63, s63, 16384
  buffer_store_dword v234, v9, s[64:67], s63 offen sc1
  s_add_u32 s63, s63, 16384
  buffer_store_dword v235, v9, s[64:67], s63 offen sc1
  s_add_u32 s63, s63, 16384
  buffer_store_dword v236, v9, s[64:67], s63 offen sc1
  s_add_u32 s63, s63, 16384
  buffer_store_dword v237, v9, s[64:67], s63 offen sc1
  s_add_u32 s63, s63, 16384
  buffer_store_dword v238, v9, s[64:67], s63 offen sc1
  s_add_u32 s63, s63, 16384
  buffer_store_dword v239, v9, s[64:67], s63 offen sc1
  s_lshl_b32 s84, s38, 10
  s_sub_u32 s84, 15360, s84
  v_lshl_add_u32 v28, v0, 2, s84
  v_mov_b32 v29, -1
  buffer_store_dword v29, v28, s[88:91], 0 offen sc1
  s_cmp_lg_u32 s3, 0
  s_cbranch_scc1 gated_mix__spectral_gfnet__ssm_conv_s5__prompt_kernel_skip7
  s_mov_b64 exec, 1
  buffer_store_dword v3, v8, s[48:51], s37 offen sc1
  buffer_store_dword v3, v8, s[48:51], s42 offen sc1
  s_mov_b64 exec, -1
gated_mix__spectral_gfnet__ssm_conv_s5__prompt_kernel_skip7:
  v_mov_b32 v28, 0
  v_mov_b32 v29, 0
  s_waitcnt vmcnt(47)
  v_dot2c_f32_bf16 v28, v60, v76
  v_dot2c_f32_bf16 v29, v68, v76
  v_dot2c_f32_bf16 v28, v61, v77
  v_dot2c_f32_bf16 v29, v69, v77
  v_dot2c_f32_bf16 v28, v62, v78
  v_dot2c_f32_bf16 v29, v70, v78
  v_dot2c_f32_bf16 v28, v63, v79
  v_dot2c_f32_bf16 v29, v71, v79
  s_waitcnt vmcnt(46)
  v_dot2c_f32_bf16 v28, v64, v80
  v_dot2c_f32_bf16 v29, v72, v80
  v_dot2c_f32_bf16 v28, v65, v81
  v_dot2c_f32_bf16 v29, v73, v81
  v_dot2c_f32_bf16 v28, v66, v82
  v_dot2c_f32_bf16 v29, v74, v82
  v_dot2c_f32_bf16 v28, v67, v83
  v_dot2c_f32_bf16 v29, v75, v83
  s_nop 2
  v_permlane32_swap_b32 v28, v29
  v_add_f32 v28, v28, v29
  v_mov_b32 v29, v28
  s_nop 1
  v_permlane16_swap_b32 v28, v29
  v_add_f32 v28, v28, v29
  s_nop 1
  v_add_f32 v28, v28, v28 row_ror:8 row_mask:0xf bank_mask:0xf
  s_nop 1
  v_add_f32 v28, v28, v28 row_ror:4 row_mask:0xf bank_mask:0xf
  s_nop 1
  v_add_f32 v28, v28, v28 row_ror:2 row_mask:0xf bank_mask:0xf
  s_nop 1
  v_add_f32 v28, v28, v28 row_ror:1 row_mask:0xf bank_mask:0xf
  v_cvt_pk_bf16_f32 v28, v28, v28
  v_and_b32 v28, 0xffff0000, v28
  v_mul_f32 v28, 0xbfb8aa3b, v28
  v_exp_f32 v28, v28
  s_nop 0
  v_add_f32 v28, 1.0, v28
  v_rcp_f32 v28, v28
  s_nop 0
  v_cvt_pk_bf16_f32 v28, v28, v28
  v_and_b32 v28, 0xffff0000, v28
  s_and_b32 s63, s2, 1
  s_lshl_b32 s63, s63, 2
  s_add_u32 s63, s63, s3
  s_lshl_b32 s63, s63, 10
  s_lshr_b32 s84, s2, 1
  s_lshl_b32 s84, s84, 2
  s_add_u32 s63, s63, s84
  v_lshrrev_b32 v30, 5, v4
  v_lshlrev_b32 v30, 9, v30
  s_mov_b32 exec_lo, 1
  s_mov_b32 exec_hi, 1
  buffer_store_dword v28, v30, s[80:83], s63 offen sc1
  s_mov_b64 exec, -1
  s_cmp_lg_u32 s40, 0
  s_cbranch_scc1 gated_mix__spectral_gfnet__ssm_conv_s5__prompt_kernel_skip8
  v_mov_b32 v44, 0x05040100
  v_mov_b32 v45, 0x07060302
  s_waitcnt vmcnt(37)
  v_lshlrev_b32 v116, 16, v116
  s_waitcnt vmcnt(37)
  v_lshlrev_b32 v117, 16, v117
  s_waitcnt vmcnt(37)
  v_xor_b32 v117, 0x80000000, v117
  s_mov_b32 exec_lo, 0
  v_swap_b32 v44, v45
  s_waitcnt vmcnt(37)
  v_xor_b32 v117, 0x80000000, v117
  s_waitcnt vmcnt(37)
  v_swap_b32 v100, v101
  s_waitcnt vmcnt(37)
  v_swap_b32 v108, v109
  s_waitcnt vmcnt(37)
  v_xor_b32 v108, 0x80008000, v108
  s_waitcnt vmcnt(37)
  v_xor_b32 v109, 0x80008000, v109
  s_waitcnt vmcnt(37)
  v_swap_b32 v102, v103
  s_waitcnt vmcnt(37)
  v_swap_b32 v110, v111
  s_waitcnt vmcnt(37)
  v_xor_b32 v110, 0x80008000, v110
  s_waitcnt vmcnt(37)
  v_xor_b32 v111, 0x80008000, v111
  s_waitcnt vmcnt(37)
  v_swap_b32 v104, v105
  s_waitcnt vmcnt(37)
  v_swap_b32 v112, v113
  s_waitcnt vmcnt(37)
  v_xor_b32 v112, 0x80008000, v112
  s_waitcnt vmcnt(37)
  v_xor_b32 v113, 0x80008000, v113
  s_waitcnt vmcnt(37)
  v_swap_b32 v106, v107
  s_waitcnt vmcnt(37)
  v_swap_b32 v114, v115
  s_waitcnt vmcnt(37)
  v_xor_b32 v114, 0x80008000, v114
  s_waitcnt vmcnt(37)
  v_xor_b32 v115, 0x80008000, v115
  s_mov_b64 exec, -1
  s_waitcnt vmcnt(37)
  v_perm_b32 v28, v108, v100, v44
  s_waitcnt vmcnt(37)
  v_perm_b32 v29, v110, v102, v44
  s_waitcnt vmcnt(37)
  v_perm_b32 v30, v112, v104, v44
  s_waitcnt vmcnt(37)
  v_perm_b32 v31, v114, v106, v44
  s_waitcnt vmcnt(37)
  v_perm_b32 v32, v108, v100, v45
  s_waitcnt vmcnt(37)
  v_perm_b32 v33, v110, v102, v45
  s_waitcnt vmcnt(37)
  v_perm_b32 v34, v112, v104, v45
  s_waitcnt vmcnt(37)
  v_perm_b32 v35, v114, v106, v45
  s_waitcnt vmcnt(37)
  v_perm_b32 v36, v109, v101, v44
  s_waitcnt vmcnt(37)
  v_perm_b32 v37, v111, v103, v44
  s_waitcnt vmcnt(37)
  v_perm_b32 v38, v113, v105, v44
  s_waitcnt vmcnt(37)
  v_perm_b32 v39, v115, v107, v44
  s_waitcnt vmcnt(37)
  v_perm_b32 v40, v109, v101, v45
  s_waitcnt vmcnt(37)
  v_perm_b32 v41, v111, v103, v45
  s_waitcnt vmcnt(37)
  v_perm_b32 v42, v113, v105, v45
  s_waitcnt vmcnt(37)
  v_perm_b32 v43, v115, v107, v45
  v_cmp_lt_u32 vcc, 1, v6
  s_nop 1
  v_cndmask_b32 v46, v28, v31, vcc
  v_lshlrev_b32 v47, 16, v46
  v_and_b32 v48, 0xffff0000, v46
  s_waitcnt vmcnt(37)
  v_add_f32 v47, v47, v116
  s_waitcnt vmcnt(37)
  v_add_f32 v48, v48, v117
  v_mul_f32 v47, 0.5, v47
  v_mul_f32 v48, 0.5, v48
  v_cvt_pk_bf16_f32 v46, v47, v48
  v_cmp_eq_u32 vcc, 0, v4
  s_nop 1
  v_cndmask_b32 v28, v28, v46, vcc
  v_cmp_eq_u32 vcc, 32, v4
  s_nop 1
  v_cndmask_b32 v31, v31, v46, vcc
  v_lshl_add_u32 v9, v4, 4, s76
  buffer_store_dwordx4 v[28:31], v9, s[68:71], 0 offen sc1
  v_lshl_add_u32 v9, v4, 4, s77
  buffer_store_dwordx4 v[32:35], v9, s[68:71], 0 offen sc1
  v_lshl_add_u32 v9, v4, 4, s78
  buffer_store_dwordx4 v[36:39], v9, s[68:71], 0 offen sc1
  v_lshl_add_u32 v9, v4, 4, s79
  buffer_store_dwordx4 v[40:43], v9, s[68:71], 0 offen sc1
gated_mix__spectral_gfnet__ssm_conv_s5__prompt_kernel_skip8:
  v_mov_b32 v44, 0x05040100
  v_mov_b32 v45, 0x07060302
  s_waitcnt vmcnt(38)
  v_lshlrev_b32 v10, 16, v10
  s_waitcnt vmcnt(37)
  v_lshlrev_b32 v11, 16, v11
  v_xor_b32 v11, 0x80000000, v11
  s_mov_b32 exec_lo, 0
  v_swap_b32 v44, v45
  v_xor_b32 v11, 0x80000000, v11
  v_swap_b32 v84, v85
  v_swap_b32 v92, v93
  v_xor_b32 v92, 0x80008000, v92
  v_xor_b32 v93, 0x80008000, v93
  v_swap_b32 v86, v87
  v_swap_b32 v94, v95
  v_xor_b32 v94, 0x80008000, v94
  v_xor_b32 v95, 0x80008000, v95
  v_swap_b32 v88, v89
  v_swap_b32 v96, v97
  v_xor_b32 v96, 0x80008000, v96
  v_xor_b32 v97, 0x80008000, v97
  v_swap_b32 v90, v91
  v_swap_b32 v98, v99
  v_xor_b32 v98, 0x80008000, v98
  v_xor_b32 v99, 0x80008000, v99
  s_mov_b64 exec, -1
  v_perm_b32 v28, v92, v84, v44
  v_perm_b32 v29, v94, v86, v44
  v_perm_b32 v30, v96, v88, v44
  v_perm_b32 v31, v98, v90, v44
  v_perm_b32 v32, v92, v84, v45
  v_perm_b32 v33, v94, v86, v45
  v_perm_b32 v34, v96, v88, v45
  v_perm_b32 v35, v98, v90, v45
  v_perm_b32 v36, v93, v85, v44
  v_perm_b32 v37, v95, v87, v44
  v_perm_b32 v38, v97, v89, v44
  v_perm_b32 v39, v99, v91, v44
  v_perm_b32 v40, v93, v85, v45
  v_perm_b32 v41, v95, v87, v45
  v_perm_b32 v42, v97, v89, v45
  v_perm_b32 v43, v99, v91, v45
  v_cmp_lt_u32 vcc, 1, v6
  s_nop 1
  v_cndmask_b32 v46, v28, v31, vcc
  v_lshlrev_b32 v47, 16, v46
  v_and_b32 v48, 0xffff0000, v46
  v_add_f32 v47, v47, v10
  v_add_f32 v48, v48, v11
  v_mul_f32 v47, 0.5, v47
  v_mul_f32 v48, 0.5, v48
  v_cvt_pk_bf16_f32 v46, v47, v48
  v_cmp_eq_u32 vcc, 0, v4
  s_nop 1
  v_cndmask_b32 v28, v28, v46, vcc
  v_cmp_eq_u32 vcc, 32, v4
  s_nop 1
  v_cndmask_b32 v31, v31, v46, vcc
  v_lshl_add_u32 v9, v4, 4, s72
  buffer_store_dwordx4 v[28:31], v9, s[68:71], 0 offen sc1
  v_lshl_add_u32 v9, v4, 4, s73
  buffer_store_dwordx4 v[32:35], v9, s[68:71], 0 offen sc1
  v_lshl_add_u32 v9, v4, 4, s74
  buffer_store_dwordx4 v[36:39], v9, s[68:71], 0 offen sc1
  v_lshl_add_u32 v9, v4, 4, s75
  buffer_store_dwordx4 v[40:43], v9, s[68:71], 0 offen sc1
  s_add_u32 m0, s62, 32768
  s_nop 0
  buffer_load_dwordx4 v16, s[56:59], s43 offen offset:0 lds
  buffer_load_dwordx4 v17, s[56:59], s43 offen offset:1024 lds
  buffer_load_dwordx4 v18, s[56:59], s43 offen offset:2048 lds
  buffer_load_dwordx4 v19, s[56:59], s43 offen offset:3072 lds
  s_add_u32 m0, s61, 32768
  s_nop 0
  buffer_load_dwordx4 v12, s[44:47], s43 offen offset:0 lds
  buffer_load_dwordx4 v13, s[44:47], s43 offen offset:1024 lds
  buffer_load_dwordx4 v14, s[44:47], s43 offen offset:2048 lds
  buffer_load_dwordx4 v15, s[44:47], s43 offen offset:3072 lds
  s_add_u32 s43, s43, 128
  s_and_b32 s43, s43, 0x7ff
  s_add_u32 m0, s62, 49152
  s_nop 0
  buffer_load_dwordx4 v16, s[56:59], s43 offen offset:0 lds
  buffer_load_dwordx4 v17, s[56:59], s43 offen offset:1024 lds
  buffer_load_dwordx4 v18, s[56:59], s43 offen offset:2048 lds
  buffer_load_dwordx4 v19, s[56:59], s43 offen offset:3072 lds
  s_add_u32 m0, s61, 49152
  s_nop 0
  buffer_load_dwordx4 v12, s[44:47], s43 offen offset:0 lds
  buffer_load_dwordx4 v13, s[44:47], s43 offen offset:1024 lds
  buffer_load_dwordx4 v14, s[44:47], s43 offen offset:2048 lds
  buffer_load_dwordx4 v15, s[44:47], s43 offen offset:3072 lds
  s_add_u32 s43, s43, 128
  s_and_b32 s43, s43, 0x7ff
  s_bitcmp1_b32 s3, 0
  s_cselect_b32 s72, s22, s20
  s_cselect_b32 s73, s23, s21
  s_mov_b32 s74, 2097152
  s_mov_b32 s75, 0x20000
  s_waitcnt vmcnt(46)
  s_barrier
  ds_read_b128 v[92:95], v20 offset:0
  ds_read_b128 v[100:103], v24 offset:0
  ds_read_b128 v[96:99], v20 offset:4096
  ds_read_b128 v[104:107], v24 offset:4096
  s_waitcnt lgkmcnt(2)
  v_mfma_f32_32x32x16_bf16 v[28:43], v[92:95], v[100:103], 0
  ds_read_b128 v[108:111], v21 offset:0
  ds_read_b128 v[124:127], v25 offset:0
  v_lshlrev_b32 v118, 16, v118
  v_lshlrev_b32 v119, 16, v119
  v_lshlrev_b32 v120, 16, v120
  s_waitcnt lgkmcnt(2)
  v_mfma_f32_32x32x16_bf16 v[44:59], v[92:95], v[104:107], 0
  ds_read_b128 v[112:115], v21 offset:4096
  ds_read_b128 v[128:131], v25 offset:4096
  v_mul_f32 v120, 0x3fb8aa3b, v120
  v_exp_f32 v120, v120
  s_nop 0
  v_cvt_pk_bf16_f32 v120, v120, v120
  v_mfma_f32_32x32x16_bf16 v[76:91], v[96:99], v[104:107], 0
  v_and_b32 v120, 0xffff0000, v120
  v_mul_f32 v140, v120, v118
  v_mul_f32 v141, v120, v119
  v_mfma_f32_32x32x16_bf16 v[60:75], v[96:99], v[100:103], 0
  v_mul_f32 v140, 0x3fb8aa3b, v140
  v_mul_f32 v141, 0.15915494, v141
  v_exp_f32 v140, v140
  s_waitcnt lgkmcnt(2)
  v_mfma_f32_32x32x16_bf16 v[28:43], v[108:111], v[124:127], v[28:43]
  ds_read_b128 v[92:95], v22 offset:0
  ds_read_b128 v[100:103], v26 offset:0
  v_rndne_f32 v142, v141
  v_sub_f32 v141, v141, v142
  v_cos_f32 v142, v141
  s_waitcnt lgkmcnt(2)
  v_mfma_f32_32x32x16_bf16 v[44:59], v[108:111], v[128:131], v[44:59]
  ds_read_b128 v[96:99], v22 offset:4096
  ds_read_b128 v[104:107], v26 offset:4096
  v_sin_f32 v143, v141
  v_mul_f32 v10, v140, v142
  v_mul_f32 v11, v140, v143
  v_mfma_f32_32x32x16_bf16 v[76:91], v[112:115], v[128:131], v[76:91]
  v_mul_f32 v140, v118, v118
  v_fma_f32 v140, v119, v119, v140
  v_rcp_f32 v140, v140
  v_mfma_f32_32x32x16_bf16 v[60:75], v[112:115], v[124:127], v[60:75]
  v_add_f32 v141, -1.0, v10
  v_add_f32 v140, v140, v140
  v_mul_f32 v142, v141, v118
  s_waitcnt lgkmcnt(2)
  v_mfma_f32_32x32x16_bf16 v[28:43], v[92:95], v[100:103], v[28:43]
  ds_read_b128 v[108:111], v23 offset:0
  ds_read_b128 v[124:127], v27 offset:0
  v_fma_f32 v142, v11, v119, v142
  v_mul_f32 v143, v11, v118
  v_fma_f32 v143, -v141, v119, v143
  s_waitcnt lgkmcnt(2)
  v_mfma_f32_32x32x16_bf16 v[44:59], v[92:95], v[104:107], v[44:59]
  ds_read_b128 v[112:115], v23 offset:4096
  ds_read_b128 v[128:131], v27 offset:4096
  v_mul_f32 v136, v142, v140
  v_mul_f32 v137, v143, v140
  v_mul_f32 v140, v11, v11
  v_mfma_f32_32x32x16_bf16 v[76:91], v[96:99], v[104:107], v[76:91]
  v_mul_f32 v117, v10, v11
  v_fma_f32 v116, v10, v10, -v140
  v_add_f32 v117, v117, v117
  v_mfma_f32_32x32x16_bf16 v[60:75], v[96:99], v[100:103], v[60:75]
  v_mul_f32 v140, v117, v117
  v_mul_f32 v117, v116, v117
  v_fma_f32 v116, v116, v116, -v140
  s_waitcnt vmcnt(38) lgkmcnt(0)
  s_barrier
  v_mfma_f32_32x32x16_bf16 v[28:43], v[108:111], v[124:127], v[28:43]
  ds_read_b128 v[92:95], v20 offset:16384
  ds_read_b128 v[100:103], v24 offset:16384
  v_add_f32 v117, v117, v117
  v_mul_f32 v140, v117, v117
  v_mul_f32 v117, v116, v117
  v_mfma_f32_32x32x16_bf16 v[44:59], v[108:111], v[128:131], v[44:59]
  ds_read_b128 v[96:99], v20 offset:20480
  ds_read_b128 v[104:107], v24 offset:20480
  v_fma_f32 v116, v116, v116, -v140
  v_add_f32 v117, v117, v117
  v_mul_f32 v140, v117, v117
  v_mfma_f32_32x32x16_bf16 v[76:91], v[112:115], v[128:131], v[76:91]
  s_add_u32 m0, s62, 0
  s_nop 0
  buffer_load_dwordx4 v16, s[56:59], s43 offen offset:0 lds
  v_mul_f32 v117, v116, v117
  v_fma_f32 v116, v116, v116, -v140
  v_add_f32 v117, v117, v117
  v_mfma_f32_32x32x16_bf16 v[60:75], v[112:115], v[124:127], v[60:75]
  buffer_load_dwordx4 v17, s[56:59], s43 offen offset:1024 lds
  v_mul_f32 v140, v117, v117
  v_mul_f32 v123, v116, v117
  v_fma_f32 v122, v116, v116, -v140
  s_waitcnt lgkmcnt(2)
  v_mfma_f32_32x32x16_bf16 v[28:43], v[92:95], v[100:103], v[28:43]
  ds_read_b128 v[108:111], v21 offset:16384
  ds_read_b128 v[124:127], v25 offset:16384
  v_add_f32 v123, v123, v123
  v_mul_f32 v140, v123, v123
  v_mul_f32 v133, v122, v123
  s_waitcnt lgkmcnt(2)
  v_mfma_f32_32x32x16_bf16 v[44:59], v[92:95], v[104:107], v[44:59]
  ds_read_b128 v[112:115], v21 offset:20480
  ds_read_b128 v[128:131], v25 offset:20480
  v_fma_f32 v132, v122, v122, -v140
  v_add_f32 v133, v133, v133
  v_mul_f32 v140, v133, v133
  v_mfma_f32_32x32x16_bf16 v[76:91], v[96:99], v[104:107], v[76:91]
  buffer_load_dwordx4 v18, s[56:59], s43 offen offset:2048 lds
  v_mul_f32 v135, v132, v133
  v_fma_f32 v134, v132, v132, -v140
  v_add_f32 v135, v135, v135
  v_mfma_f32_32x32x16_bf16 v[60:75], v[96:99], v[100:103], v[60:75]
  buffer_load_dwordx4 v19, s[56:59], s43 offen offset:3072 lds
  v_mul_f32 v140, v135, v135
  v_mul_f32 v135, v134, v135
  v_fma_f32 v134, v134, v134, -v140
  s_waitcnt lgkmcnt(2)
  v_mfma_f32_32x32x16_bf16 v[28:43], v[108:111], v[124:127], v[28:43]
  ds_read_b128 v[92:95], v22 offset:16384
  ds_read_b128 v[100:103], v26 offset:16384
  v_add_f32 v135, v135, v135
  v_mul_f32 v140, v135, v135
  v_mul_f32 v135, v134, v135
  s_waitcnt lgkmcnt(2)
  v_mfma_f32_32x32x16_bf16 v[44:59], v[108:111], v[128:131], v[44:59]
  ds_read_b128 v[96:99], v22 offset:20480
  ds_read_b128 v[104:107], v26 offset:20480
  v_fma_f32 v134, v134, v134, -v140
  v_add_f32 v135, v135, v135
  v_mul_f32 v140, v135, v135
  v_mfma_f32_32x32x16_bf16 v[76:91], v[112:115], v[128:131], v[76:91]
  s_add_u32 m0, s61, 0
  s_nop 0
  buffer_load_dwordx4 v12, s[44:47], s43 offen offset:0 lds
  v_mul_f32 v135, v134, v135
  v_fma_f32 v134, v134, v134, -v140
  v_add_f32 v135, v135, v135
  v_mfma_f32_32x32x16_bf16 v[60:75], v[112:115], v[124:127], v[60:75]
  buffer_load_dwordx4 v13, s[44:47], s43 offen offset:1024 lds
  v_and_b32 v118, 7, v4
  v_xor_b32 v118, v118, v6
  v_and_b32 v119, 4, v118
  s_waitcnt lgkmcnt(2)
  v_mfma_f32_32x32x16_bf16 v[28:43], v[92:95], v[100:103], v[28:43]
  ds_read_b128 v[108:111], v23 offset:16384
  ds_read_b128 v[124:127], v27 offset:16384
  v_lshlrev_b32 v140, 4, v119
  v_and_b32 v119, 1, v118
  v_lshl_or_b32 v140, v119, 5, v140
  s_waitcnt lgkmcnt(2)
  v_mfma_f32_32x32x16_bf16 v[44:59], v[92:95], v[104:107], v[44:59]
  ds_read_b128 v[112:115], v23 offset:20480
  ds_read_b128 v[128:131], v27 offset:20480
  v_bfe_u32 v119, v118, 1, 1
  v_lshl_or_b32 v140, v119, 4, v140
  v_lshrrev_b32 v119, 3, v4
  v_mfma_f32_32x32x16_bf16 v[76:91], v[96:99], v[104:107], v[76:91]
  buffer_load_dwordx4 v14, s[44:47], s43 offen offset:2048 lds
  v_lshl_or_b32 v140, v119, 11, v140
  s_lshr_b32 s77, s3, 1
  s_lshl_b32 s77, s77, 20
  v_mfma_f32_32x32x16_bf16 v[60:75], v[96:99], v[100:103], v[60:75]
  buffer_load_dwordx4 v15, s[44:47], s43 offen offset:3072 lds
  s_add_u32 s43, s43, 128
  s_and_b32 s43, s43, 0x7ff
  s_lshl_b32 s63, s39, 15
  s_add_u32 s77, s77, s63
  v_add_u32 v140, s77, v140
  s_waitcnt vmcnt(16) lgkmcnt(0)
  s_barrier
  v_mfma_f32_32x32x16_bf16 v[28:43], v[108:111], v[124:127], v[28:43]
  ds_read_b128 v[92:95], v20 offset:32768
  ds_read_b128 v[100:103], v24 offset:32768
  v_xor_b32 v141, 64, v140
  v_add_u32 v141, 15360, v141
  v_add_u32 v142, 522240, v140
  v_mfma_f32_32x32x16_bf16 v[44:59], v[108:111], v[128:131], v[44:59]
  ds_read_b128 v[96:99], v20 offset:36864
  ds_read_b128 v[104:107], v24 offset:36864
  v_add_u32 v143, 522240, v141
  s_lshl_b32 s63, s38, 7
  s_lshl_b32 s76, s3, 12
  v_mfma_f32_32x32x16_bf16 v[76:91], v[112:115], v[128:131], v[76:91]
  s_add_u32 m0, s62, 16384
  s_nop 0
  buffer_load_dwordx4 v16, s[56:59], s43 offen offset:0 lds
  v_lshrrev_b32 v118, 1, v5
  v_xor_b32 v118, v118, v6
  v_lshlrev_b32 v118, 4, v118
  v_mfma_f32_32x32x16_bf16 v[60:75], v[112:115], v[124:127], v[60:75]
  buffer_load_dwordx4 v17, s[56:59], s43 offen offset:1024 lds
  v_lshl_or_b32 v118, v5, 7, v118
  v_add_u32 v144, s76, v118
  v_xor_b32 v145, 64, v144
  s_waitcnt lgkmcnt(2)
  v_mfma_f32_32x32x16_bf16 v[28:43], v[92:95], v[100:103], v[28:43]
  ds_read_b128 v[108:111], v21 offset:32768
  ds_read_b128 v[124:127], v25 offset:32768
  v_add_u32 v146, 0x10000, v144
  v_add_u32 v147, 0x10000, v145
  s_lshl_b32 s84, s40, 2
  s_waitcnt lgkmcnt(2)
  v_mfma_f32_32x32x16_bf16 v[44:59], v[92:95], v[104:107], v[44:59]
  ds_read_b128 v[112:115], v21 offset:36864
  ds_read_b128 v[128:131], v25 offset:36864
  s_add_u32 s84, s84, s41
  s_cmp_eq_u32 s84, 3
  s_cselect_b32 s77, 1, s41
  s_cselect_b32 s78, 64, s40
  v_mfma_f32_32x32x16_bf16 v[76:91], v[96:99], v[104:107], v[76:91]
  buffer_load_dwordx4 v18, s[56:59], s43 offen offset:2048 lds
  s_and_b32 s79, s84, 0xfd
  s_cmp_eq_u32 s79, 0
  s_cselect_b32 s79, 1, 0
  v_mfma_f32_32x32x16_bf16 v[60:75], v[96:99], v[100:103], v[60:75]
  buffer_load_dwordx4 v19, s[56:59], s43 offen offset:3072 lds
  v_cvt_f32_u32 v120, v5
  v_cvt_f32_u32 v121, v6
  v_mul_f32 v121, 4.0, v121
  s_waitcnt lgkmcnt(2)
  v_mfma_f32_32x32x16_bf16 v[28:43], v[108:111], v[124:127], v[28:43]
  ds_read_b128 v[92:95], v22 offset:32768
  ds_read_b128 v[100:103], v26 offset:32768
  v_cvt_f32_u32 v149, s77
  v_cvt_f32_u32 v150, s78
  v_cvt_f32_u32 v151, s79
  s_waitcnt lgkmcnt(2)
  v_mfma_f32_32x32x16_bf16 v[44:59], v[108:111], v[128:131], v[44:59]
  ds_read_b128 v[96:99], v22 offset:36864
  ds_read_b128 v[104:107], v26 offset:36864
  v_mul_f32 v151, 0xc4700000, v151
  v_cmp_lt_u32 vcc, 7, v5
  s_nop 1
  v_cndmask_b32 v148, 0, v151, vcc
  v_mfma_f32_32x32x16_bf16 v[76:91], v[112:115], v[128:131], v[76:91]
  s_add_u32 m0, s61, 16384
  s_nop 0
  buffer_load_dwordx4 v12, s[44:47], s43 offen offset:0 lds
  v_add_f32 v148, v148, v150
  v_fmamk_f32 v138, v120, 0x43000000, v148
  v_mul_f32 v138, 0x3a000000, v138
  v_mfma_f32_32x32x16_bf16 v[60:75], v[112:115], v[124:127], v[60:75]
  buffer_load_dwordx4 v13, s[44:47], s43 offen offset:1024 lds
  v_mul_f32 v139, v138, v121
  v_fmamk_f32 v9, v138, 0x0, v139
  v_cos_f32 v118, v9
  s_waitcnt lgkmcnt(2)
  v_mfma_f32_32x32x16_bf16 v[28:43], v[92:95], v[100:103], v[28:43]
  ds_read_b128 v[108:111], v23 offset:32768
  ds_read_b128 v[124:127], v27 offset:32768
  v_sin_f32 v119, v9
  s_nop 0
  v_cvt_pk_bf16_f32 v152, v118, v119
  v_cvt_pk_bf16_f32 v156, -v119, v118
  s_waitcnt lgkmcnt(2)
  v_mfma_f32_32x32x16_bf16 v[44:59], v[92:95], v[104:107], v[44:59]
  ds_read_b128 v[112:115], v23 offset:36864
  ds_read_b128 v[128:131], v27 offset:36864
  v_fmamk_f32 v9, v138, 0x3f800000, v139
  v_cos_f32 v118, v9
  v_sin_f32 v119, v9
  v_mfma_f32_32x32x16_bf16 v[76:91], v[96:99], v[104:107], v[76:91]
  buffer_load_dwordx4 v14, s[44:47], s43 offen offset:2048 lds
  v_cvt_pk_bf16_f32 v153, v118, v119
  v_cvt_pk_bf16_f32 v157, -v119, v118
  v_fmamk_f32 v9, v138, 0x40000000, v139
  v_mfma_f32_32x32x16_bf16 v[60:75], v[96:99], v[100:103], v[60:75]
  buffer_load_dwordx4 v15, s[44:47], s43 offen offset:3072 lds
  s_add_u32 s43, s43, 128
  s_and_b32 s43, s43, 0x7ff
  v_cos_f32 v118, v9
  v_sin_f32 v119, v9
  s_nop 0
  v_cvt_pk_bf16_f32 v154, v118, v119
  s_waitcnt vmcnt(16) lgkmcnt(0)
  s_barrier
  v_mfma_f32_32x32x16_bf16 v[28:43], v[108:111], v[124:127], v[28:43]
  ds_read_b128 v[92:95], v20 offset:49152
  ds_read_b128 v[100:103], v24 offset:49152
  v_cvt_pk_bf16_f32 v158, -v119, v118
  v_fmamk_f32 v9, v138, 0x40400000, v139
  v_cos_f32 v118, v9
  v_mfma_f32_32x32x16_bf16 v[44:59], v[108:111], v[128:131], v[44:59]
  ds_read_b128 v[96:99], v20 offset:53248
  ds_read_b128 v[104:107], v24 offset:53248
  v_sin_f32 v119, v9
  s_nop 0
  v_cvt_pk_bf16_f32 v155, v118, v119
  v_cvt_pk_bf16_f32 v159, -v119, v118
  v_mfma_f32_32x32x16_bf16 v[76:91], v[112:115], v[128:131], v[76:91]
  s_add_u32 m0, s62, 32768
  s_nop 0
  buffer_load_dwordx4 v16, s[56:59], s43 offen offset:0 lds
  v_cmp_lt_u32 vcc, 1, v6
  s_nop 1
  v_cndmask_b32 v148, 0, v151, vcc
  v_add_f32 v148, v148, v150
  v_mfma_f32_32x32x16_bf16 v[60:75], v[112:115], v[124:127], v[60:75]
  buffer_load_dwordx4 v17, s[56:59], s43 offen offset:1024 lds
  v_fmamk_f32 v148, v121, 0x43000000, v148
  v_mul_f32 v139, v148, v120
  v_mul_f32 v139, 0x3a000000, v139
  s_waitcnt lgkmcnt(2)
  v_mfma_f32_32x32x16_bf16 v[28:43], v[92:95], v[100:103], v[28:43]
  ds_read_b128 v[108:111], v21 offset:49152
  ds_read_b128 v[124:127], v25 offset:49152
  v_mul_f32 v138, 0x3d800000, v120
  v_fmamk_f32 v9, v138, 0x0, v139
  v_cos_f32 v118, v9
  s_waitcnt lgkmcnt(2)
  v_mfma_f32_32x32x16_bf16 v[44:59], v[92:95], v[104:107], v[44:59]
  ds_read_b128 v[112:115], v21 offset:53248
  ds_read_b128 v[128:131], v25 offset:53248
  v_sin_f32 v119, v9
  s_nop 0
  v_cvt_pk_bf16_f32 v160, v118, -v119
  v_cvt_pk_bf16_f32 v164, v119, v118
  v_mfma_f32_32x32x16_bf16 v[76:91], v[96:99], v[104:107], v[76:91]
  buffer_load_dwordx4 v18, s[56:59], s43 offen offset:2048 lds
  v_fmamk_f32 v9, v138, 0x3f800000, v139
  v_cos_f32 v118, v9
  v_sin_f32 v119, v9
  v_mfma_f32_32x32x16_bf16 v[60:75], v[96:99], v[100:103], v[60:75]
  buffer_load_dwordx4 v19, s[56:59], s43 offen offset:3072 lds
  v_cvt_pk_bf16_f32 v161, v118, -v119
  v_cvt_pk_bf16_f32 v165, v119, v118
  v_fmamk_f32 v9, v138, 0x40000000, v139
  s_waitcnt lgkmcnt(2)
  v_mfma_f32_32x32x16_bf16 v[28:43], v[108:111], v[124:127], v[28:43]
  ds_read_b128 v[92:95], v22 offset:49152
  ds_read_b128 v[100:103], v26 offset:49152
  v_cos_f32 v118, v9
  v_sin_f32 v119, v9
  s_nop 0
  v_cvt_pk_bf16_f32 v162, v118, -v119
  s_waitcnt lgkmcnt(2)
  v_mfma_f32_32x32x16_bf16 v[44:59], v[108:111], v[128:131], v[44:59]
  ds_read_b128 v[96:99], v22 offset:53248
  ds_read_b128 v[104:107], v26 offset:53248
  v_cvt_pk_bf16_f32 v166, v119, v118
  v_fmamk_f32 v9, v138, 0x40400000, v139
  v_cos_f32 v118, v9
  v_mfma_f32_32x32x16_bf16 v[76:91], v[112:115], v[128:131], v[76:91]
  s_add_u32 m0, s61, 32768
  s_nop 0
  buffer_load_dwordx4 v12, s[44:47], s43 offen offset:0 lds
  v_sin_f32 v119, v9
  s_nop 0
  v_cvt_pk_bf16_f32 v163, v118, -v119
  v_cvt_pk_bf16_f32 v167, v119, v118
  v_mfma_f32_32x32x16_bf16 v[60:75], v[112:115], v[124:127], v[60:75]
  buffer_load_dwordx4 v13, s[44:47], s43 offen offset:1024 lds
  s_cmp_eq_u32 s79, 0
  s_cbranch_scc1 gated_mix__spectral_gfnet__ssm_conv_s5__prompt_kernel_skip9
  v_cmp_lt_u32 vcc, 7, v5
  s_nop 1
  v_cndmask_b32 v9, 0, 16, vcc
  v_and_b32 v152, 0xffff, v152
  v_lshlrev_b32 v152, v9, v152
  v_and_b32 v153, 0xffff, v153
  v_lshlrev_b32 v153, v9, v153
  v_and_b32 v154, 0xffff, v154
  v_lshlrev_b32 v154, v9, v154
  v_and_b32 v155, 0xffff, v155
  v_lshlrev_b32 v155, v9, v155
  v_and_b32 v156, 0xffff, v156
  v_lshlrev_b32 v156, v9, v156
  v_and_b32 v157, 0xffff, v157
  v_lshlrev_b32 v157, v9, v157
  v_and_b32 v158, 0xffff, v158
  v_lshlrev_b32 v158, v9, v158
  v_and_b32 v159, 0xffff, v159
  v_lshlrev_b32 v159, v9, v159
  v_cmp_eq_u32 vcc, 0, v5
  v_mov_b32 v118, 0x3f80
  s_nop 0
  v_cndmask_b32 v156, v156, v118, vcc
  v_mov_b32 v118, 0xbf80
  v_cndmask_b32 v157, v157, v118, vcc
  v_mov_b32 v118, 0x3f80
  v_cndmask_b32 v158, v158, v118, vcc
  v_mov_b32 v118, 0xbf80
  v_cndmask_b32 v159, v159, v118, vcc
  v_cmp_lt_u32 vcc, 1, v6
  v_lshlrev_b32 v118, 16, v160
  v_and_b32 v119, 0xffff0000, v160
  v_add_f32 v118, v118, v118
  v_add_f32 v119, v119, v119
  v_cvt_pk_bf16_f32 v118, v118, v119
  v_cndmask_b32 v160, v118, 0, vcc
  v_cndmask_b32 v164, 0, v118, vcc
  v_lshlrev_b32 v118, 16, v161
  v_and_b32 v119, 0xffff0000, v161
  v_add_f32 v118, v118, v118
  v_add_f32 v119, v119, v119
  v_cvt_pk_bf16_f32 v118, v118, v119
  v_cndmask_b32 v161, v118, 0, vcc
  v_cndmask_b32 v165, 0, v118, vcc
  v_lshlrev_b32 v118, 16, v162
  v_and_b32 v119, 0xffff0000, v162
  v_add_f32 v118, v118, v118
  v_add_f32 v119, v119, v119
  v_cvt_pk_bf16_f32 v118, v118, v119
  v_cndmask_b32 v162, v118, 0, vcc
  v_cndmask_b32 v166, 0, v118, vcc
  v_lshlrev_b32 v118, 16, v163
  v_and_b32 v119, 0xffff0000, v163
  v_add_f32 v118, v118, v118
  v_add_f32 v119, v119, v119
  v_cvt_pk_bf16_f32 v118, v118, v119
  v_cndmask_b32 v163, v118, 0, vcc
  v_cndmask_b32 v167, 0, v118, vcc
  v_lshlrev_b32 v118, 31, v5
  v_or_b32 v118, 0x3f803f80, v118
  v_cmp_eq_u32 vcc, 0, v6
  s_nop 1
  v_cndmask_b32 v160, v160, v118, vcc
gated_mix__spectral_gfnet__ssm_conv_s5__prompt_kernel_skip9:
  s_waitcnt lgkmcnt(2)
  v_mfma_f32_32x32x16_bf16 v[28:43], v[92:95], v[100:103], v[28:43]
  ds_read_b128 v[108:111], v23 offset:49152
  ds_read_b128 v[124:127], v27 offset:49152
  v_fma_f32 v148, v120, 4.0, v149
  v_mul_f32 v138, 0x3c800000, v148
  v_mul_f32 v139, v138, v121
  s_waitcnt lgkmcnt(2)
  v_mfma_f32_32x32x16_bf16 v[44:59], v[92:95], v[104:107], v[44:59]
  ds_read_b128 v[112:115], v23 offset:53248
  ds_read_b128 v[128:131], v27 offset:53248
  v_fmamk_f32 v9, v138, 0x0, v139
  v_cos_f32 v118, v9
  v_sin_f32 v119, v9
  v_mfma_f32_32x32x16_bf16 v[76:91], v[96:99], v[104:107], v[76:91]
  buffer_load_dwordx4 v14, s[44:47], s43 offen offset:2048 lds
  v_cvt_pk_bf16_f32 v168, v118, v119
  v_cvt_pk_bf16_f32 v172, -v119, v118
  v_fmamk_f32 v9, v138, 0x3f800000, v139
  v_mfma_f32_32x32x16_bf16 v[60:75], v[96:99], v[100:103], v[60:75]
  buffer_load_dwordx4 v15, s[44:47], s43 offen offset:3072 lds
  s_add_u32 s43, s43, 128
  s_and_b32 s43, s43, 0x7ff
  v_cos_f32 v118, v9
  v_sin_f32 v119, v9
  s_nop 0
  v_cvt_pk_bf16_f32 v169, v118, v119
  s_waitcnt vmcnt(16) lgkmcnt(0)
  s_barrier
  v_mfma_f32_32x32x16_bf16 v[28:43], v[108:111], v[124:127], v[28:43]
  ds_read_b128 v[92:95], v20 offset:0
  ds_read_b128 v[100:103], v24 offset:0
  v_cvt_pk_bf16_f32 v173, -v119, v118
  v_fmamk_f32 v9, v138, 0x40000000, v139
  v_cos_f32 v118, v9
  v_mfma_f32_32x32x16_bf16 v[44:59], v[108:111], v[128:131], v[44:59]
  ds_read_b128 v[96:99], v20 offset:4096
  ds_read_b128 v[104:107], v24 offset:4096
  buffer_load_dword v216, v3, s[52:55], 0 offen sc1
  v_sin_f32 v119, v9
  s_nop 0
  v_cvt_pk_bf16_f32 v170, v118, v119
  v_cvt_pk_bf16_f32 v174, -v119, v118
  v_mfma_f32_32x32x16_bf16 v[76:91], v[112:115], v[128:131], v[76:91]
  s_add_u32 m0, s62, 49152
  s_nop 0
  buffer_load_dwordx4 v16, s[56:59], s43 offen offset:0 lds
  v_fmamk_f32 v9, v138, 0x40400000, v139
  v_cos_f32 v118, v9
  v_sin_f32 v119, v9
  v_mfma_f32_32x32x16_bf16 v[60:75], v[112:115], v[124:127], v[60:75]
  buffer_load_dwordx4 v17, s[56:59], s43 offen offset:1024 lds
  v_cvt_pk_bf16_f32 v171, v118, v119
  v_cvt_pk_bf16_f32 v175, -v119, v118
  v_mul_f32 v138, 0x3d800000, v138
  s_waitcnt lgkmcnt(2)
  v_mfma_f32_32x32x16_bf16 v[28:43], v[92:95], v[100:103], v[28:43]
  ds_read_b128 v[108:111], v21 offset:0
  ds_read_b128 v[124:127], v25 offset:0
  v_mul_f32 v139, 0x3d800000, v139
  v_fmamk_f32 v9, v138, 0x0, v139
  v_cos_f32 v176, v9
  s_waitcnt lgkmcnt(2)
  v_mfma_f32_32x32x16_bf16 v[44:59], v[92:95], v[104:107], v[44:59]
  ds_read_b128 v[112:115], v21 offset:4096
  ds_read_b128 v[128:131], v25 offset:4096
  v_sin_f32 v180, v9
  v_fmamk_f32 v9, v138, 0x3f800000, v139
  v_cos_f32 v177, v9
  v_mfma_f32_32x32x16_bf16 v[76:91], v[96:99], v[104:107], v[76:91]
  buffer_load_dwordx4 v18, s[56:59], s43 offen offset:2048 lds
  v_sin_f32 v181, v9
  v_fmamk_f32 v9, v138, 0x40000000, v139
  v_cos_f32 v178, v9
  v_mfma_f32_32x32x16_bf16 v[60:75], v[96:99], v[100:103], v[60:75]
  buffer_load_dwordx4 v19, s[56:59], s43 offen offset:3072 lds
  v_sin_f32 v182, v9
  v_fmamk_f32 v9, v138, 0x40400000, v139
  v_cos_f32 v179, v9
  s_waitcnt lgkmcnt(2)
  v_mfma_f32_32x32x16_bf16 v[28:43], v[108:111], v[124:127], v[28:43]
  ds_read_b128 v[92:95], v22 offset:0
  ds_read_b128 v[100:103], v26 offset:0
  v_sin_f32 v183, v9
  v_fma_f32 v148, v121, 4.0, v149
  v_mul_f32 v139, v148, v120
  s_waitcnt lgkmcnt(2)
  v_mfma_f32_32x32x16_bf16 v[44:59], v[108:111], v[128:131], v[44:59]
  ds_read_b128 v[96:99], v22 offset:4096
  ds_read_b128 v[104:107], v26 offset:4096
  v_mul_f32 v139, 0x3c800000, v139
  v_mul_f32 v138, 0x3d800000, v120
  v_fmamk_f32 v9, v138, 0x0, v139
  v_mfma_f32_32x32x16_bf16 v[76:91], v[112:115], v[128:131], v[76:91]
  s_add_u32 m0, s61, 49152
  s_nop 0
  buffer_load_dwordx4 v12, s[44:47], s43 offen offset:0 lds
  v_cos_f32 v118, v9
  v_sin_f32 v119, v9
  s_nop 0
  v_cvt_pk_bf16_f32 v184, v118, -v119
  v_mfma_f32_32x32x16_bf16 v[60:75], v[112:115], v[124:127], v[60:75]
  buffer_load_dwordx4 v13, s[44:47], s43 offen offset:1024 lds
  v_cvt_pk_bf16_f32 v188, v119, v118
  v_fmamk_f32 v9, v138, 0x3f800000, v139
  v_cos_f32 v118, v9
  s_waitcnt lgkmcnt(2)
  v_mfma_f32_32x32x16_bf16 v[28:43], v[92:95], v[100:103], v[28:43]
  ds_read_b128 v[108:111], v23 offset:0
  ds_read_b128 v[124:127], v27 offset:0
  v_sin_f32 v119, v9
  s_nop 0
  v_cvt_pk_bf16_f32 v185, v118, -v119
  v_cvt_pk_bf16_f32 v189, v119, v118
  s_waitcnt lgkmcnt(2)
  v_mfma_f32_32x32x16_bf16 v[44:59], v[92:95], v[104:107], v[44:59]
  ds_read_b128 v[112:115], v23 offset:4096
  ds_read_b128 v[128:131], v27 offset:4096
  v_fmamk_f32 v9, v138, 0x40000000, v139
  v_cos_f32 v118, v9
  v_sin_f32 v119, v9
  v_mfma_f32_32x32x16_bf16 v[76:91], v[96:99], v[104:107], v[76:91]
  buffer_load_dwordx4 v14, s[44:47], s43 offen offset:2048 lds
  v_cvt_pk_bf16_f32 v186, v118, -v119
  v_cvt_pk_bf16_f32 v190, v119, v118
  v_fmamk_f32 v9, v138, 0x40400000, v139
  v_mfma_f32_32x32x16_bf16 v[60:75], v[96:99], v[100:103], v[60:75]
  buffer_load_dwordx4 v15, s[44:47], s43 offen offset:3072 lds
  s_add_u32 s43, s43, 128
  s_and_b32 s43, s43, 0x7ff
  v_cos_f32 v118, v9
  v_sin_f32 v119, v9
  s_nop 0
  v_cvt_pk_bf16_f32 v187, v118, -v119
  s_waitcnt vmcnt(17) lgkmcnt(0)
  s_barrier
  v_mfma_f32_32x32x16_bf16 v[28:43], v[108:111], v[124:127], v[28:43]
  ds_read_b128 v[92:95], v20 offset:16384
  ds_read_b128 v[100:103], v24 offset:16384
  v_cvt_pk_bf16_f32 v191, v119, v118
  v_mul_f32 v138, 0x3d800000, v138
  v_mul_f32 v139, 0x3d800000, v139
  v_mfma_f32_32x32x16_bf16 v[44:59], v[108:111], v[128:131], v[44:59]
  ds_read_b128 v[96:99], v20 offset:20480
  ds_read_b128 v[104:107], v24 offset:20480
  v_fmamk_f32 v9, v138, 0x0, v139
  v_cos_f32 v192, v9
  v_sin_f32 v196, v9
  v_mfma_f32_32x32x16_bf16 v[76:91], v[112:115], v[128:131], v[76:91]
  s_add_u32 m0, s62, 0
  s_nop 0
  buffer_load_dwordx4 v16, s[56:59], s43 offen offset:0 lds
  v_fmamk_f32 v9, v138, 0x3f800000, v139
  v_cos_f32 v193, v9
  v_sin_f32 v197, v9
  v_mfma_f32_32x32x16_bf16 v[60:75], v[112:115], v[124:127], v[60:75]
  buffer_load_dwordx4 v17, s[56:59], s43 offen offset:1024 lds
  v_fmamk_f32 v9, v138, 0x40000000, v139
  v_cos_f32 v194, v9
  v_sin_f32 v198, v9
  s_waitcnt lgkmcnt(2)
  v_mfma_f32_32x32x16_bf16 v[28:43], v[92:95], v[100:103], v[28:43]
  ds_read_b128 v[108:111], v21 offset:16384
  ds_read_b128 v[124:127], v25 offset:16384
  v_fmamk_f32 v9, v138, 0x40400000, v139
  v_cos_f32 v195, v9
  v_sin_f32 v199, v9
  s_waitcnt lgkmcnt(2)
  v_mfma_f32_32x32x16_bf16 v[44:59], v[92:95], v[104:107], v[44:59]
  ds_read_b128 v[112:115], v21 offset:20480
  ds_read_b128 v[128:131], v25 offset:20480
  v_mul_f32 v192, 0x35800000, v192
  v_mul_f32 v193, 0x35800000, v193
  v_mul_f32 v194, 0x35800000, v194
  v_mfma_f32_32x32x16_bf16 v[76:91], v[96:99], v[104:107], v[76:91]
  buffer_load_dwordx4 v18, s[56:59], s43 offen offset:2048 lds
  v_mul_f32 v195, 0x35800000, v195
  v_mul_f32 v196, 0x35800000, v196
  v_mul_f32 v197, 0x35800000, v197
  v_mfma_f32_32x32x16_bf16 v[60:75], v[96:99], v[100:103], v[60:75]
  buffer_load_dwordx4 v19, s[56:59], s43 offen offset:3072 lds
  v_mul_f32 v198, 0x35800000, v198
  v_mul_f32 v199, 0x35800000, v199
  v_xor_b32 v148, 3, v5
  s_waitcnt lgkmcnt(2)
  v_mfma_f32_32x32x16_bf16 v[28:43], v[108:111], v[124:127], v[28:43]
  ds_read_b128 v[92:95], v22 offset:16384
  ds_read_b128 v[100:103], v26 offset:16384
  v_cmp_lt_u32 vcc, 7, v5
  s_nop 1
  v_cndmask_b32 v148, v5, v148, vcc
  v_cvt_f32_u32 v138, v148
  s_waitcnt lgkmcnt(2)
  v_mfma_f32_32x32x16_bf16 v[44:59], v[108:111], v[128:131], v[44:59]
  ds_read_b128 v[96:99], v22 offset:20480
  ds_read_b128 v[104:107], v26 offset:20480
  v_mul_f32 v138, 0x3d800000, v138
  v_mul_f32 v139, v138, v121
  v_fmamk_f32 v9, v138, 0x0, v139
  v_mfma_f32_32x32x16_bf16 v[76:91], v[112:115], v[128:131], v[76:91]
  s_add_u32 m0, s61, 0
  s_nop 0
  buffer_load_dwordx4 v12, s[44:47], s43 offen offset:0 lds
  v_cos_f32 v118, v9
  v_sin_f32 v119, v9
  s_nop 0
  v_cvt_pk_bf16_f32 v200, v118, v119
  v_mfma_f32_32x32x16_bf16 v[60:75], v[112:115], v[124:127], v[60:75]
  buffer_load_dwordx4 v13, s[44:47], s43 offen offset:1024 lds
  v_cvt_pk_bf16_f32 v204, -v119, v118
  v_fmamk_f32 v9, v138, 0x3f800000, v139
  v_cos_f32 v118, v9
  s_waitcnt lgkmcnt(2)
  v_mfma_f32_32x32x16_bf16 v[28:43], v[92:95], v[100:103], v[28:43]
  ds_read_b128 v[108:111], v23 offset:16384
  ds_read_b128 v[124:127], v27 offset:16384
  v_sin_f32 v119, v9
  s_nop 0
  v_cvt_pk_bf16_f32 v201, v118, v119
  v_cvt_pk_bf16_f32 v205, -v119, v118
  s_waitcnt lgkmcnt(2)
  v_mfma_f32_32x32x16_bf16 v[44:59], v[92:95], v[104:107], v[44:59]
  ds_read_b128 v[112:115], v23 offset:20480
  ds_read_b128 v[128:131], v27 offset:20480
  v_fmamk_f32 v9, v138, 0x40000000, v139
  v_cos_f32 v118, v9
  v_sin_f32 v119, v9
  v_mfma_f32_32x32x16_bf16 v[76:91], v[96:99], v[104:107], v[76:91]
  buffer_load_dwordx4 v14, s[44:47], s43 offen offset:2048 lds
  v_cvt_pk_bf16_f32 v202, v118, v119
  v_cvt_pk_bf16_f32 v206, -v119, v118
  v_fmamk_f32 v9, v138, 0x40400000, v139
  v_mfma_f32_32x32x16_bf16 v[60:75], v[96:99], v[100:103], v[60:75]
  buffer_load_dwordx4 v15, s[44:47], s43 offen offset:3072 lds
  s_add_u32 s43, s43, 128
  s_and_b32 s43, s43, 0x7ff
  v_cos_f32 v118, v9
  v_sin_f32 v119, v9
  s_nop 0
  v_cvt_pk_bf16_f32 v203, v118, v119
  s_waitcnt vmcnt(17) lgkmcnt(0)
  s_barrier
  v_mfma_f32_32x32x16_bf16 v[28:43], v[108:111], v[124:127], v[28:43]
  ds_read_b128 v[92:95], v20 offset:32768
  ds_read_b128 v[100:103], v24 offset:32768
  v_cvt_pk_bf16_f32 v207, -v119, v118
  v_mul_f32 v138, 0x3d800000, v120
  v_add_f32 v148, 0x40400000, v121
  v_mfma_f32_32x32x16_bf16 v[44:59], v[108:111], v[128:131], v[44:59]
  ds_read_b128 v[96:99], v20 offset:36864
  ds_read_b128 v[104:107], v24 offset:36864
  v_cmp_lt_u32 vcc, 1, v6
  s_nop 1
  v_cndmask_b32 v148, v121, v148, vcc
  v_mul_f32 v139, v138, v148
  v_mfma_f32_32x32x16_bf16 v[76:91], v[112:115], v[128:131], v[76:91]
  s_add_u32 m0, s62, 16384
  s_nop 0
  buffer_load_dwordx4 v16, s[56:59], s43 offen offset:0 lds
  v_cndmask_b32 v138, v138, -v138, vcc
  v_fmamk_f32 v9, v138, 0x0, v139
  v_cos_f32 v118, v9
  v_mfma_f32_32x32x16_bf16 v[60:75], v[112:115], v[124:127], v[60:75]
  buffer_load_dwordx4 v17, s[56:59], s43 offen offset:1024 lds
  v_sin_f32 v119, v9
  s_nop 0
  v_cvt_pk_bf16_f32 v208, v118, -v119
  v_cvt_pk_bf16_f32 v212, v119, v118
  s_waitcnt lgkmcnt(2)
  v_mfma_f32_32x32x16_bf16 v[28:43], v[92:95], v[100:103], v[28:43]
  ds_read_b128 v[108:111], v21 offset:32768
  ds_read_b128 v[124:127], v25 offset:32768
  v_fmamk_f32 v9, v138, 0x3f800000, v139
  v_cos_f32 v118, v9
  v_sin_f32 v119, v9
  s_waitcnt lgkmcnt(2)
  v_mfma_f32_32x32x16_bf16 v[44:59], v[92:95], v[104:107], v[44:59]
  ds_read_b128 v[112:115], v21 offset:36864
  ds_read_b128 v[128:131], v25 offset:36864
  v_cvt_pk_bf16_f32 v209, v118, -v119
  v_cvt_pk_bf16_f32 v213, v119, v118
  v_fmamk_f32 v9, v138, 0x40000000, v139
  v_mfma_f32_32x32x16_bf16 v[76:91], v[96:99], v[104:107], v[76:91]
  buffer_load_dwordx4 v18, s[56:59], s43 offen offset:2048 lds
  v_cos_f32 v118, v9
  v_sin_f32 v119, v9
  s_nop 0
  v_cvt_pk_bf16_f32 v210, v118, -v119
  v_mfma_f32_32x32x16_bf16 v[60:75], v[96:99], v[100:103], v[60:75]
  buffer_load_dwordx4 v19, s[56:59], s43 offen offset:3072 lds
  v_cvt_pk_bf16_f32 v214, v119, v118
  v_fmamk_f32 v9, v138, 0x40400000, v139
  v_cos_f32 v118, v9
  s_waitcnt lgkmcnt(2)
  v_mfma_f32_32x32x16_bf16 v[28:43], v[108:111], v[124:127], v[28:43]
  ds_read_b128 v[92:95], v22 offset:32768
  ds_read_b128 v[100:103], v26 offset:32768
  v_sin_f32 v119, v9
  s_nop 0
  v_cvt_pk_bf16_f32 v211, v118, -v119
  v_cvt_pk_bf16_f32 v215, v119, v118
  s_waitcnt lgkmcnt(2)
  v_mfma_f32_32x32x16_bf16 v[44:59], v[108:111], v[128:131], v[44:59]
  ds_read_b128 v[96:99], v22 offset:36864
  ds_read_b128 v[104:107], v26 offset:36864
  v_mfma_f32_32x32x16_bf16 v[76:91], v[112:115], v[128:131], v[76:91]
  s_add_u32 m0, s61, 16384
  s_nop 0
  buffer_load_dwordx4 v12, s[44:47], s43 offen offset:0 lds
  v_mfma_f32_32x32x16_bf16 v[60:75], v[112:115], v[124:127], v[60:75]
  buffer_load_dwordx4 v13, s[44:47], s43 offen offset:1024 lds
  s_waitcnt lgkmcnt(2)
  v_mfma_f32_32x32x16_bf16 v[28:43], v[92:95], v[100:103], v[28:43]
  ds_read_b128 v[108:111], v23 offset:32768
  ds_read_b128 v[124:127], v27 offset:32768
  s_waitcnt lgkmcnt(2)
  v_mfma_f32_32x32x16_bf16 v[44:59], v[92:95], v[104:107], v[44:59]
  ds_read_b128 v[112:115], v23 offset:36864
  ds_read_b128 v[128:131], v27 offset:36864
  v_mfma_f32_32x32x16_bf16 v[76:91], v[96:99], v[104:107], v[76:91]
  buffer_load_dwordx4 v14, s[44:47], s43 offen offset:2048 lds
  v_mfma_f32_32x32x16_bf16 v[60:75], v[96:99], v[100:103], v[60:75]
  buffer_load_dwordx4 v15, s[44:47], s43 offen offset:3072 lds
  s_add_u32 s43, s43, 128
  s_and_b32 s43, s43, 0x7ff
  s_waitcnt vmcnt(16) lgkmcnt(0)
  s_barrier
  v_mfma_f32_32x32x16_bf16 v[28:43], v[108:111], v[124:127], v[28:43]
  ds_read_b128 v[92:95], v20 offset:49152
  ds_read_b128 v[100:103], v24 offset:49152
  v_mfma_f32_32x32x16_bf16 v[44:59], v[108:111], v[128:131], v[44:59]
  ds_read_b128 v[96:99], v20 offset:53248
  ds_read_b128 v[104:107], v24 offset:53248
  v_cmp_ne_u32 vcc, 1, v216
  s_nop 0
  s_cbranch_vccz gated_mix__spectral_gfnet__ssm_conv_s5__prompt_kernel_skip10
  s_mov_b32 s85, 0
gated_mix__spectral_gfnet__ssm_conv_s5__prompt_kernel_poll11:
  s_sleep 2
  buffer_load_dword v216, v3, s[52:55], 0 offen sc1
  s_waitcnt vmcnt(0)
  v_cmp_ne_u32 vcc, 1, v216
  s_nop 0
  s_cbranch_vccz gated_mix__spectral_gfnet__ssm_conv_s5__prompt_kernel_pollout12
  s_add_u32 s85, s85, 1
  s_cmp_lt_u32 s85, 1048576
  s_cbranch_scc1 gated_mix__spectral_gfnet__ssm_conv_s5__prompt_kernel_poll11
gated_mix__spectral_gfnet__ssm_conv_s5__prompt_kernel_pollout12:
gated_mix__spectral_gfnet__ssm_conv_s5__prompt_kernel_skip10:
  s_cmp_lg_u32 s3, 0
  s_cbranch_scc1 gated_mix__spectral_gfnet__ssm_conv_s5__prompt_kernel_skip13
  s_mov_b64 exec, 1
  buffer_store_dword v2, v8, s[48:51], s36 offen sc1
  s_mov_b64 exec, -1
gated_mix__spectral_gfnet__ssm_conv_s5__prompt_kernel_skip13:
  v_mfma_f32_32x32x16_bf16 v[76:91], v[112:115], v[128:131], v[76:91]
  s_add_u32 m0, s62, 32768
  s_nop 0
  buffer_load_dwordx4 v16, s[56:59], s43 offen offset:0 lds
  v_mfma_f32_32x32x16_bf16 v[60:75], v[112:115], v[124:127], v[60:75]
  buffer_load_dwordx4 v17, s[56:59], s43 offen offset:1024 lds
  s_waitcnt lgkmcnt(2)
  v_mfma_f32_32x32x16_bf16 v[28:43], v[92:95], v[100:103], v[28:43]
  ds_read_b128 v[108:111], v21 offset:49152
  ds_read_b128 v[124:127], v25 offset:49152
  s_waitcnt lgkmcnt(2)
  v_mfma_f32_32x32x16_bf16 v[44:59], v[92:95], v[104:107], v[44:59]
  ds_read_b128 v[112:115], v21 offset:53248
  ds_read_b128 v[128:131], v25 offset:53248
  v_mfma_f32_32x32x16_bf16 v[76:91], v[96:99], v[104:107], v[76:91]
  buffer_load_dwordx4 v18, s[56:59], s43 offen offset:2048 lds
  v_mfma_f32_32x32x16_bf16 v[60:75], v[96:99], v[100:103], v[60:75]
  buffer_load_dwordx4 v19, s[56:59], s43 offen offset:3072 lds
  s_waitcnt lgkmcnt(2)
  v_mfma_f32_32x32x16_bf16 v[28:43], v[108:111], v[124:127], v[28:43]
  ds_read_b128 v[92:95], v22 offset:49152
  ds_read_b128 v[100:103], v26 offset:49152
  s_waitcnt lgkmcnt(2)
  v_mfma_f32_32x32x16_bf16 v[44:59], v[108:111], v[128:131], v[44:59]
  ds_read_b128 v[96:99], v22 offset:53248
  ds_read_b128 v[104:107], v26 offset:53248
  v_mfma_f32_32x32x16_bf16 v[76:91], v[112:115], v[128:131], v[76:91]
  s_add_u32 m0, s61, 32768
  s_nop 0
  buffer_load_dwordx4 v12, s[44:47], s43 offen offset:0 lds
  v_mfma_f32_32x32x16_bf16 v[60:75], v[112:115], v[124:127], v[60:75]
  buffer_load_dwordx4 v13, s[44:47], s43 offen offset:1024 lds
  s_waitcnt lgkmcnt(2)
  v_mfma_f32_32x32x16_bf16 v[28:43], v[92:95], v[100:103], v[28:43]
  ds_read_b128 v[108:111], v23 offset:49152
  ds_read_b128 v[124:127], v27 offset:49152
  s_waitcnt lgkmcnt(2)
  v_mfma_f32_32x32x16_bf16 v[44:59], v[92:95], v[104:107], v[44:59]
  ds_read_b128 v[112:115], v23 offset:53248
  ds_read_b128 v[128:131], v27 offset:53248
  v_mfma_f32_32x32x16_bf16 v[76:91], v[96:99], v[104:107], v[76:91]
  buffer_load_dwordx4 v14, s[44:47], s43 offen offset:2048 lds
  v_mfma_f32_32x32x16_bf16 v[60:75], v[96:99], v[100:103], v[60:75]
  buffer_load_dwordx4 v15, s[44:47], s43 offen offset:3072 lds
  s_add_u32 s43, s43, 128
  s_and_b32 s43, s43, 0x7ff
  s_waitcnt vmcnt(16) lgkmcnt(0)
  s_barrier
  v_mfma_f32_32x32x16_bf16 v[28:43], v[108:111], v[124:127], v[28:43]
  ds_read_b128 v[92:95], v20 offset:0
  ds_read_b128 v[100:103], v24 offset:0
  v_mfma_f32_32x32x16_bf16 v[44:59], v[108:111], v[128:131], v[44:59]
  ds_read_b128 v[96:99], v20 offset:4096
  ds_read_b128 v[104:107], v24 offset:4096
  v_mfma_f32_32x32x16_bf16 v[76:91], v[112:115], v[128:131], v[76:91]
  s_add_u32 m0, s62, 49152
  s_nop 0
  buffer_load_dwordx4 v16, s[56:59], s43 offen offset:0 lds
  v_mfma_f32_32x32x16_bf16 v[60:75], v[112:115], v[124:127], v[60:75]
  buffer_load_dwordx4 v17, s[56:59], s43 offen offset:1024 lds
  s_waitcnt lgkmcnt(2)
  v_mfma_f32_32x32x16_bf16 v[28:43], v[92:95], v[100:103], v[28:43]
  ds_read_b128 v[108:111], v21 offset:0
  ds_read_b128 v[124:127], v25 offset:0
  s_waitcnt lgkmcnt(2)
  v_mfma_f32_32x32x16_bf16 v[44:59], v[92:95], v[104:107], v[44:59]
  ds_read_b128 v[112:115], v21 offset:4096
  ds_read_b128 v[128:131], v25 offset:4096
  v_mfma_f32_32x32x16_bf16 v[76:91], v[96:99], v[104:107], v[76:91]
  buffer_load_dwordx4 v18, s[56:59], s43 offen offset:2048 lds
  v_mfma_f32_32x32x16_bf16 v[60:75], v[96:99], v[100:103], v[60:75]
  buffer_load_dwordx4 v19, s[56:59], s43 offen offset:3072 lds
  s_waitcnt lgkmcnt(2)
  v_mfma_f32_32x32x16_bf16 v[28:43], v[108:111], v[124:127], v[28:43]
  ds_read_b128 v[92:95], v22 offset:0
  ds_read_b128 v[100:103], v26 offset:0
  s_waitcnt lgkmcnt(2)
  v_mfma_f32_32x32x16_bf16 v[44:59], v[108:111], v[128:131], v[44:59]
  ds_read_b128 v[96:99], v22 offset:4096
  ds_read_b128 v[104:107], v26 offset:4096
  v_mfma_f32_32x32x16_bf16 v[76:91], v[112:115], v[128:131], v[76:91]
  s_add_u32 m0, s61, 49152
  s_nop 0
  buffer_load_dwordx4 v12, s[44:47], s43 offen offset:0 lds
  v_mfma_f32_32x32x16_bf16 v[60:75], v[112:115], v[124:127], v[60:75]
  buffer_load_dwordx4 v13, s[44:47], s43 offen offset:1024 lds
  s_waitcnt lgkmcnt(2)
  v_mfma_f32_32x32x16_bf16 v[28:43], v[92:95], v[100:103], v[28:43]
  ds_read_b128 v[108:111], v23 offset:0
  ds_read_b128 v[124:127], v27 offset:0
  s_waitcnt lgkmcnt(2)
  v_mfma_f32_32x32x16_bf16 v[44:59], v[92:95], v[104:107], v[44:59]
  ds_read_b128 v[112:115], v23 offset:4096
  ds_read_b128 v[128:131], v27 offset:4096
  v_mfma_f32_32x32x16_bf16 v[76:91], v[96:99], v[104:107], v[76:91]
  buffer_load_dwordx4 v14, s[44:47], s43 offen offset:2048 lds
  v_mfma_f32_32x32x16_bf16 v[60:75], v[96:99], v[100:103], v[60:75]
  buffer_load_dwordx4 v15, s[44:47], s43 offen offset:3072 lds
  s_add_u32 s43, s43, 128
  s_and_b32 s43, s43, 0x7ff
  s_waitcnt vmcnt(16) lgkmcnt(0)
  s_barrier
  v_mfma_f32_32x32x16_bf16 v[28:43], v[108:111], v[124:127], v[28:43]
  ds_read_b128 v[92:95], v20 offset:16384
  ds_read_b128 v[100:103], v24 offset:16384
  v_mfma_f32_32x32x16_bf16 v[44:59], v[108:111], v[128:131], v[44:59]
  ds_read_b128 v[96:99], v20 offset:20480
  ds_read_b128 v[104:107], v24 offset:20480
  v_mfma_f32_32x32x16_bf16 v[76:91], v[112:115], v[128:131], v[76:91]
  s_add_u32 m0, s62, 0
  s_nop 0
  buffer_load_dwordx4 v16, s[56:59], s43 offen offset:0 lds
  v_mfma_f32_32x32x16_bf16 v[60:75], v[112:115], v[124:127], v[60:75]
  buffer_load_dwordx4 v17, s[56:59], s43 offen offset:1024 lds
  s_waitcnt lgkmcnt(2)
  v_mfma_f32_32x32x16_bf16 v[28:43], v[92:95], v[100:103], v[28:43]
  ds_read_b128 v[108:111], v21 offset:16384
  ds_read_b128 v[124:127], v25 offset:16384
  s_waitcnt lgkmcnt(2)
  v_mfma_f32_32x32x16_bf16 v[44:59], v[92:95], v[104:107], v[44:59]
  ds_read_b128 v[112:115], v21 offset:20480
  ds_read_b128 v[128:131], v25 offset:20480
  v_mfma_f32_32x32x16_bf16 v[76:91], v[96:99], v[104:107], v[76:91]
  buffer_load_dwordx4 v18, s[56:59], s43 offen offset:2048 lds
  v_mfma_f32_32x32x16_bf16 v[60:75], v[96:99], v[100:103], v[60:75]
  buffer_load_dwordx4 v19, s[56:59], s43 offen offset:3072 lds
  s_waitcnt lgkmcnt(2)
  v_mfma_f32_32x32x16_bf16 v[28:43], v[108:111], v[124:127], v[28:43]
  ds_read_b128 v[92:95], v22 offset:16384
  ds_read_b128 v[100:103], v26 offset:16384
  s_waitcnt lgkmcnt(2)
  v_mfma_f32_32x32x16_bf16 v[44:59], v[108:111], v[128:131], v[44:59]
  ds_read_b128 v[96:99], v22 offset:20480
  ds_read_b128 v[104:107], v26 offset:20480
  v_mfma_f32_32x32x16_bf16 v[76:91], v[112:115], v[128:131], v[76:91]
  s_add_u32 m0, s61, 0
  s_nop 0
  buffer_load_dwordx4 v12, s[44:47], s43 offen offset:0 lds
  v_mfma_f32_32x32x16_bf16 v[60:75], v[112:115], v[124:127], v[60:75]
  buffer_load_dwordx4 v13, s[44:47], s43 offen offset:1024 lds
  s_waitcnt lgkmcnt(2)
  v_mfma_f32_32x32x16_bf16 v[28:43], v[92:95], v[100:103], v[28:43]
  ds_read_b128 v[108:111], v23 offset:16384
  ds_read_b128 v[124:127], v27 offset:16384
  s_waitcnt lgkmcnt(2)
  v_mfma_f32_32x32x16_bf16 v[44:59], v[92:95], v[104:107], v[44:59]
  ds_read_b128 v[112:115], v23 offset:20480
  ds_read_b128 v[128:131], v27 offset:20480
  v_mfma_f32_32x32x16_bf16 v[76:91], v[96:99], v[104:107], v[76:91]
  buffer_load_dwordx4 v14, s[44:47], s43 offen offset:2048 lds
  v_mfma_f32_32x32x16_bf16 v[60:75], v[96:99], v[100:103], v[60:75]
  buffer_load_dwordx4 v15, s[44:47], s43 offen offset:3072 lds
  s_add_u32 s43, s43, 128
  s_and_b32 s43, s43, 0x7ff
  s_waitcnt vmcnt(16) lgkmcnt(0)
  s_barrier
  v_mfma_f32_32x32x16_bf16 v[28:43], v[108:111], v[124:127], v[28:43]
  ds_read_b128 v[92:95], v20 offset:32768
  ds_read_b128 v[100:103], v24 offset:32768
  v_mfma_f32_32x32x16_bf16 v[44:59], v[108:111], v[128:131], v[44:59]
  ds_read_b128 v[96:99], v20 offset:36864
  ds_read_b128 v[104:107], v24 offset:36864
  v_mfma_f32_32x32x16_bf16 v[76:91], v[112:115], v[128:131], v[76:91]
  s_add_u32 m0, s62, 16384
  s_nop 0
  buffer_load_dwordx4 v16, s[56:59], s43 offen offset:0 lds
  v_mfma_f32_32x32x16_bf16 v[60:75], v[112:115], v[124:127], v[60:75]
  buffer_load_dwordx4 v17, s[56:59], s43 offen offset:1024 lds
  s_waitcnt lgkmcnt(2)
  v_mfma_f32_32x32x16_bf16 v[28:43], v[92:95], v[100:103], v[28:43]
  ds_read_b128 v[108:111], v21 offset:32768
  ds_read_b128 v[124:127], v25 offset:32768
  s_waitcnt lgkmcnt(2)
  v_mfma_f32_32x32x16_bf16 v[44:59], v[92:95], v[104:107], v[44:59]
  ds_read_b128 v[112:115], v21 offset:36864
  ds_read_b128 v[128:131], v25 offset:36864
  v_mfma_f32_32x32x16_bf16 v[76:91], v[96:99], v[104:107], v[76:91]
  buffer_load_dwordx4 v18, s[56:59], s43 offen offset:2048 lds
  v_mfma_f32_32x32x16_bf16 v[60:75], v[96:99], v[100:103], v[60:75]
  buffer_load_dwordx4 v19, s[56:59], s43 offen offset:3072 lds
  s_waitcnt lgkmcnt(2)
  v_mfma_f32_32x32x16_bf16 v[28:43], v[108:111], v[124:127], v[28:43]
  ds_read_b128 v[92:95], v22 offset:32768
  ds_read_b128 v[100:103], v26 offset:32768
  s_waitcnt lgkmcnt(2)
  v_mfma_f32_32x32x16_bf16 v[44:59], v[108:111], v[128:131], v[44:59]
  ds_read_b128 v[96:99], v22 offset:36864
  ds_read_b128 v[104:107], v26 offset:36864
  v_mfma_f32_32x32x16_bf16 v[76:91], v[112:115], v[128:131], v[76:91]
  s_add_u32 m0, s61, 16384
  s_nop 0
  buffer_load_dwordx4 v12, s[44:47], s43 offen offset:0 lds
  v_mfma_f32_32x32x16_bf16 v[60:75], v[112:115], v[124:127], v[60:75]
  buffer_load_dwordx4 v13, s[44:47], s43 offen offset:1024 lds
  s_waitcnt lgkmcnt(2)
  v_mfma_f32_32x32x16_bf16 v[28:43], v[92:95], v[100:103], v[28:43]
  ds_read_b128 v[108:111], v23 offset:32768
  ds_read_b128 v[124:127], v27 offset:32768
  s_waitcnt lgkmcnt(2)
  v_mfma_f32_32x32x16_bf16 v[44:59], v[92:95], v[104:107], v[44:59]
  ds_read_b128 v[112:115], v23 offset:36864
  ds_read_b128 v[128:131], v27 offset:36864
  v_mfma_f32_32x32x16_bf16 v[76:91], v[96:99], v[104:107], v[76:91]
  buffer_load_dwordx4 v14, s[44:47], s43 offen offset:2048 lds
  v_mfma_f32_32x32x16_bf16 v[60:75], v[96:99], v[100:103], v[60:75]
  buffer_load_dwordx4 v15, s[44:47], s43 offen offset:3072 lds
  s_add_u32 s43, s43, 128
  s_and_b32 s43, s43, 0x7ff
  s_waitcnt vmcnt(16) lgkmcnt(0)
  s_barrier
  v_mfma_f32_32x32x16_bf16 v[28:43], v[108:111], v[124:127], v[28:43]
  ds_read_b128 v[92:95], v20 offset:49152
  ds_read_b128 v[100:103], v24 offset:49152
  v_mfma_f32_32x32x16_bf16 v[44:59], v[108:111], v[128:131], v[44:59]
  ds_read_b128 v[96:99], v20 offset:53248
  ds_read_b128 v[104:107], v24 offset:53248
  v_mfma_f32_32x32x16_bf16 v[76:91], v[112:115], v[128:131], v[76:91]
  s_add_u32 m0, s62, 32768
  s_nop 0
  buffer_load_dwordx4 v16, s[56:59], s43 offen offset:0 lds
  v_mfma_f32_32x32x16_bf16 v[60:75], v[112:115], v[124:127], v[60:75]
  buffer_load_dwordx4 v17, s[56:59], s43 offen offset:1024 lds
  s_waitcnt lgkmcnt(2)
  v_mfma_f32_32x32x16_bf16 v[28:43], v[92:95], v[100:103], v[28:43]
  ds_read_b128 v[108:111], v21 offset:49152
  ds_read_b128 v[124:127], v25 offset:49152
  s_waitcnt lgkmcnt(2)
  v_mfma_f32_32x32x16_bf16 v[44:59], v[92:95], v[104:107], v[44:59]
  ds_read_b128 v[112:115], v21 offset:53248
  ds_read_b128 v[128:131], v25 offset:53248
  v_mfma_f32_32x32x16_bf16 v[76:91], v[96:99], v[104:107], v[76:91]
  buffer_load_dwordx4 v18, s[56:59], s43 offen offset:2048 lds
  v_mfma_f32_32x32x16_bf16 v[60:75], v[96:99], v[100:103], v[60:75]
  buffer_load_dwordx4 v19, s[56:59], s43 offen offset:3072 lds
  s_waitcnt lgkmcnt(2)
  v_mfma_f32_32x32x16_bf16 v[28:43], v[108:111], v[124:127], v[28:43]
  ds_read_b128 v[92:95], v22 offset:49152
  ds_read_b128 v[100:103], v26 offset:49152
  s_waitcnt lgkmcnt(2)
  v_mfma_f32_32x32x16_bf16 v[44:59], v[108:111], v[128:131], v[44:59]
  ds_read_b128 v[96:99], v22 offset:53248
  ds_read_b128 v[104:107], v26 offset:53248
  v_mfma_f32_32x32x16_bf16 v[76:91], v[112:115], v[128:131], v[76:91]
  s_add_u32 m0, s61, 32768
  s_nop 0
  buffer_load_dwordx4 v12, s[44:47], s43 offen offset:0 lds
  v_mfma_f32_32x32x16_bf16 v[60:75], v[112:115], v[124:127], v[60:75]
  buffer_load_dwordx4 v13, s[44:47], s43 offen offset:1024 lds
  s_waitcnt lgkmcnt(2)
  v_mfma_f32_32x32x16_bf16 v[28:43], v[92:95], v[100:103], v[28:43]
  ds_read_b128 v[108:111], v23 offset:49152
  ds_read_b128 v[124:127], v27 offset:49152
  s_waitcnt lgkmcnt(2)
  v_mfma_f32_32x32x16_bf16 v[44:59], v[92:95], v[104:107], v[44:59]
  ds_read_b128 v[112:115], v23 offset:53248
  ds_read_b128 v[128:131], v27 offset:53248
  v_mfma_f32_32x32x16_bf16 v[76:91], v[96:99], v[104:107], v[76:91]
  buffer_load_dwordx4 v14, s[44:47], s43 offen offset:2048 lds
  v_mfma_f32_32x32x16_bf16 v[60:75], v[96:99], v[100:103], v[60:75]
  buffer_load_dwordx4 v15, s[44:47], s43 offen offset:3072 lds
  s_add_u32 s43, s43, 128
  s_and_b32 s43, s43, 0x7ff
  s_waitcnt vmcnt(16) lgkmcnt(0)
  s_barrier
  v_mfma_f32_32x32x16_bf16 v[28:43], v[108:111], v[124:127], v[28:43]
  ds_read_b128 v[92:95], v20 offset:0
  ds_read_b128 v[100:103], v24 offset:0
  v_mfma_f32_32x32x16_bf16 v[44:59], v[108:111], v[128:131], v[44:59]
  ds_read_b128 v[96:99], v20 offset:4096
  ds_read_b128 v[104:107], v24 offset:4096
  v_mfma_f32_32x32x16_bf16 v[76:91], v[112:115], v[128:131], v[76:91]
  s_add_u32 m0, s62, 49152
  s_nop 0
  buffer_load_dwordx4 v16, s[56:59], s43 offen offset:0 lds
  v_mfma_f32_32x32x16_bf16 v[60:75], v[112:115], v[124:127], v[60:75]
  buffer_load_dwordx4 v17, s[56:59], s43 offen offset:1024 lds
  s_waitcnt lgkmcnt(2)
  v_mfma_f32_32x32x16_bf16 v[28:43], v[92:95], v[100:103], v[28:43]
  ds_read_b128 v[108:111], v21 offset:0
  ds_read_b128 v[124:127], v25 offset:0
  s_waitcnt lgkmcnt(2)
  v_mfma_f32_32x32x16_bf16 v[44:59], v[92:95], v[104:107], v[44:59]
  ds_read_b128 v[112:115], v21 offset:4096
  ds_read_b128 v[128:131], v25 offset:4096
  v_mfma_f32_32x32x16_bf16 v[76:91], v[96:99], v[104:107], v[76:91]
  buffer_load_dwordx4 v18, s[56:59], s43 offen offset:2048 lds
  v_mfma_f32_32x32x16_bf16 v[60:75], v[96:99], v[100:103], v[60:75]
  buffer_load_dwordx4 v19, s[56:59], s43 offen offset:3072 lds
  s_waitcnt lgkmcnt(2)
  v_mfma_f32_32x32x16_bf16 v[28:43], v[108:111], v[124:127], v[28:43]
  ds_read_b128 v[92:95], v22 offset:0
  ds_read_b128 v[100:103], v26 offset:0
  s_waitcnt lgkmcnt(2)
  v_mfma_f32_32x32x16_bf16 v[44:59], v[108:111], v[128:131], v[44:59]
  ds_read_b128 v[96:99], v22 offset:4096
  ds_read_b128 v[104:107], v26 offset:4096
  v_mfma_f32_32x32x16_bf16 v[76:91], v[112:115], v[128:131], v[76:91]
  s_add_u32 m0, s61, 49152
  s_nop 0
  buffer_load_dwordx4 v12, s[44:47], s43 offen offset:0 lds
  v_mfma_f32_32x32x16_bf16 v[60:75], v[112:115], v[124:127], v[60:75]
  buffer_load_dwordx4 v13, s[44:47], s43 offen offset:1024 lds
  s_waitcnt lgkmcnt(2)
  v_mfma_f32_32x32x16_bf16 v[28:43], v[92:95], v[100:103], v[28:43]
  ds_read_b128 v[108:111], v23 offset:0
  ds_read_b128 v[124:127], v27 offset:0
  s_waitcnt lgkmcnt(2)
  v_mfma_f32_32x32x16_bf16 v[44:59], v[92:95], v[104:107], v[44:59]
  ds_read_b128 v[112:115], v23 offset:4096
  ds_read_b128 v[128:131], v27 offset:4096
  v_mfma_f32_32x32x16_bf16 v[76:91], v[96:99], v[104:107], v[76:91]
  buffer_load_dwordx4 v14, s[44:47], s43 offen offset:2048 lds
  v_mfma_f32_32x32x16_bf16 v[60:75], v[96:99], v[100:103], v[60:75]
  buffer_load_dwordx4 v15, s[44:47], s43 offen offset:3072 lds
  s_add_u32 s43, s43, 128
  s_and_b32 s43, s43, 0x7ff
  s_waitcnt vmcnt(16) lgkmcnt(0)
  s_barrier
  v_mfma_f32_32x32x16_bf16 v[28:43], v[108:111], v[124:127], v[28:43]
  ds_read_b128 v[92:95], v20 offset:16384
  ds_read_b128 v[100:103], v24 offset:16384
  v_mfma_f32_32x32x16_bf16 v[44:59], v[108:111], v[128:131], v[44:59]
  ds_read_b128 v[96:99], v20 offset:20480
  ds_read_b128 v[104:107], v24 offset:20480
  v_mfma_f32_32x32x16_bf16 v[76:91], v[112:115], v[128:131], v[76:91]
  buffer_load_dword v217, v7, s[48:51], s36 offen sc1
  s_add_u32 m0, s76, 0
  s_nop 0
  buffer_load_dwordx4 v140, s[72:75], s63 offen offset:0 lds
  v_mfma_f32_32x32x16_bf16 v[60:75], v[112:115], v[124:127], v[60:75]
  buffer_load_dwordx4 v141, s[72:75], s63 offen offset:1024 lds
  s_waitcnt lgkmcnt(2)
  v_mfma_f32_32x32x16_bf16 v[28:43], v[92:95], v[100:103], v[28:43]
  ds_read_b128 v[108:111], v21 offset:16384
  ds_read_b128 v[124:127], v25 offset:16384
  s_waitcnt lgkmcnt(2)
  v_mfma_f32_32x32x16_bf16 v[44:59], v[92:95], v[104:107], v[44:59]
  ds_read_b128 v[112:115], v21 offset:20480
  ds_read_b128 v[128:131], v25 offset:20480
  v_mfma_f32_32x32x16_bf16 v[76:91], v[96:99], v[104:107], v[76:91]
  buffer_load_dwordx4 v142, s[72:75], s63 offen offset:2048 lds
  v_mfma_f32_32x32x16_bf16 v[60:75], v[96:99], v[100:103], v[60:75]
  buffer_load_dwordx4 v143, s[72:75], s63 offen offset:3072 lds
  s_add_u32 s63, s63, 128
  s_and_b32 s63, s63, 0x7ff
  s_waitcnt lgkmcnt(2)
  v_mfma_f32_32x32x16_bf16 v[28:43], v[108:111], v[124:127], v[28:43]
  ds_read_b128 v[92:95], v22 offset:16384
  ds_read_b128 v[100:103], v26 offset:16384
  s_waitcnt lgkmcnt(2)
  v_mfma_f32_32x32x16_bf16 v[44:59], v[108:111], v[128:131], v[44:59]
  ds_read_b128 v[96:99], v22 offset:20480
  ds_read_b128 v[104:107], v26 offset:20480
  v_mfma_f32_32x32x16_bf16 v[76:91], v[112:115], v[128:131], v[76:91]
  s_add_u32 m0, s76, 65536
  s_nop 0
  buffer_load_dwordx4 v140, s[72:75], s63 offen offset:0 lds
  v_mfma_f32_32x32x16_bf16 v[60:75], v[112:115], v[124:127], v[60:75]
  buffer_load_dwordx4 v141, s[72:75], s63 offen offset:1024 lds
  s_waitcnt lgkmcnt(2)
  v_mfma_f32_32x32x16_bf16 v[28:43], v[92:95], v[100:103], v[28:43]
  ds_read_b128 v[108:111], v23 offset:16384
  ds_read_b128 v[124:127], v27 offset:16384
  s_waitcnt lgkmcnt(2)
  v_mfma_f32_32x32x16_bf16 v[44:59], v[92:95], v[104:107], v[44:59]
  ds_read_b128 v[112:115], v23 offset:20480
  ds_read_b128 v[128:131], v27 offset:20480
  v_mfma_f32_32x32x16_bf16 v[76:91], v[96:99], v[104:107], v[76:91]
  buffer_load_dwordx4 v142, s[72:75], s63 offen offset:2048 lds
  v_mfma_f32_32x32x16_bf16 v[60:75], v[96:99], v[100:103], v[60:75]
  buffer_load_dwordx4 v143, s[72:75], s63 offen offset:3072 lds
  s_add_u32 s63, s63, 128
  s_and_b32 s63, s63, 0x7ff
  s_waitcnt vmcnt(17) lgkmcnt(0)
  s_barrier
  v_mfma_f32_32x32x16_bf16 v[28:43], v[108:111], v[124:127], v[28:43]
  ds_read_b128 v[92:95], v20 offset:32768
  ds_read_b128 v[100:103], v24 offset:32768
  v_mfma_f32_32x32x16_bf16 v[44:59], v[108:111], v[128:131], v[44:59]
  ds_read_b128 v[96:99], v20 offset:36864
  ds_read_b128 v[104:107], v24 offset:36864
  v_mfma_f32_32x32x16_bf16 v[76:91], v[112:115], v[128:131], v[76:91]
  s_add_u32 m0, s76, 16384
  s_nop 0
  buffer_load_dwordx4 v140, s[72:75], s63 offen offset:0 lds
  v_mfma_f32_32x32x16_bf16 v[60:75], v[112:115], v[124:127], v[60:75]
  buffer_load_dwordx4 v141, s[72:75], s63 offen offset:1024 lds
  s_waitcnt lgkmcnt(2)
  v_mfma_f32_32x32x16_bf16 v[28:43], v[92:95], v[100:103], v[28:43]
  ds_read_b128 v[108:111], v21 offset:32768
  ds_read_b128 v[124:127], v25 offset:32768
  s_waitcnt lgkmcnt(2)
  v_mfma_f32_32x32x16_bf16 v[44:59], v[92:95], v[104:107], v[44:59]
  ds_read_b128 v[112:115], v21 offset:36864
  ds_read_b128 v[128:131], v25 offset:36864
  v_mfma_f32_32x32x16_bf16 v[76:91], v[96:99], v[104:107], v[76:91]
  buffer_load_dwordx4 v142, s[72:75], s63 offen offset:2048 lds
  v_mfma_f32_32x32x16_bf16 v[60:75], v[96:99], v[100:103], v[60:75]
  buffer_load_dwordx4 v143, s[72:75], s63 offen offset:3072 lds
  s_add_u32 s63, s63, 128
  s_and_b32 s63, s63, 0x7ff
  s_waitcnt lgkmcnt(2)
  v_mfma_f32_32x32x16_bf16 v[28:43], v[108:111], v[124:127], v[28:43]
  ds_read_b128 v[92:95], v22 offset:32768
  ds_read_b128 v[100:103], v26 offset:32768
  s_waitcnt lgkmcnt(2)
  v_mfma_f32_32x32x16_bf16 v[44:59], v[108:111], v[128:131], v[44:59]
  ds_read_b128 v[96:99], v22 offset:36864
  ds_read_b128 v[104:107], v26 offset:36864
  v_mfma_f32_32x32x16_bf16 v[76:91], v[112:115], v[128:131], v[76:91]
  s_add_u32 m0, s76, 81920
  s_nop 0
  buffer_load_dwordx4 v140, s[72:75], s63 offen offset:0 lds
  v_mfma_f32_32x32x16_bf16 v[60:75], v[112:115], v[124:127], v[60:75]
  buffer_load_dwordx4 v141, s[72:75], s63 offen offset:1024 lds
  s_waitcnt lgkmcnt(2)
  v_mfma_f32_32x32x16_bf16 v[28:43], v[92:95], v[100:103], v[28:43]
  ds_read_b128 v[108:111], v23 offset:32768
  ds_read_b128 v[124:127], v27 offset:32768
  s_waitcnt lgkmcnt(2)
  v_mfma_f32_32x32x16_bf16 v[44:59], v[92:95], v[104:107], v[44:59]
  ds_read_b128 v[112:115], v23 offset:36864
  ds_read_b128 v[128:131], v27 offset:36864
  v_mfma_f32_32x32x16_bf16 v[76:91], v[96:99], v[104:107], v[76:91]
  buffer_load_dwordx4 v142, s[72:75], s63 offen offset:2048 lds
  v_mfma_f32_32x32x16_bf16 v[60:75], v[96:99], v[100:103], v[60:75]
  buffer_load_dwordx4 v143, s[72:75], s63 offen offset:3072 lds
  s_add_u32 s63, s63, 128
  s_and_b32 s63, s63, 0x7ff
  s_waitcnt vmcnt(17) lgkmcnt(0)
  s_barrier
  v_mfma_f32_32x32x16_bf16 v[28:43], v[108:111], v[124:127], v[28:43]
  ds_read_b128 v[92:95], v20 offset:49152
  ds_read_b128 v[100:103], v24 offset:49152
  v_mfma_f32_32x32x16_bf16 v[44:59], v[108:111], v[128:131], v[44:59]
  ds_read_b128 v[96:99], v20 offset:53248
  ds_read_b128 v[104:107], v24 offset:53248
  v_mfma_f32_32x32x16_bf16 v[76:91], v[112:115], v[128:131], v[76:91]
  s_add_u32 m0, s76, 32768
  s_nop 0
  buffer_load_dwordx4 v140, s[72:75], s63 offen offset:0 lds
  v_mfma_f32_32x32x16_bf16 v[60:75], v[112:115], v[124:127], v[60:75]
  buffer_load_dwordx4 v141, s[72:75], s63 offen offset:1024 lds
  s_waitcnt lgkmcnt(2)
  v_mfma_f32_32x32x16_bf16 v[28:43], v[92:95], v[100:103], v[28:43]
  ds_read_b128 v[108:111], v21 offset:49152
  ds_read_b128 v[124:127], v25 offset:49152
  s_waitcnt lgkmcnt(2)
  v_mfma_f32_32x32x16_bf16 v[44:59], v[92:95], v[104:107], v[44:59]
  ds_read_b128 v[112:115], v21 offset:53248
  ds_read_b128 v[128:131], v25 offset:53248
  v_mfma_f32_32x32x16_bf16 v[76:91], v[96:99], v[104:107], v[76:91]
  buffer_load_dwordx4 v142, s[72:75], s63 offen offset:2048 lds
  v_mfma_f32_32x32x16_bf16 v[60:75], v[96:99], v[100:103], v[60:75]
  buffer_load_dwordx4 v143, s[72:75], s63 offen offset:3072 lds
  s_add_u32 s63, s63, 128
  s_and_b32 s63, s63, 0x7ff
  s_waitcnt lgkmcnt(2)
  v_mfma_f32_32x32x16_bf16 v[28:43], v[108:111], v[124:127], v[28:43]
  ds_read_b128 v[92:95], v22 offset:49152
  ds_read_b128 v[100:103], v26 offset:49152
  s_waitcnt lgkmcnt(2)
  v_mfma_f32_32x32x16_bf16 v[44:59], v[108:111], v[128:131], v[44:59]
  ds_read_b128 v[96:99], v22 offset:53248
  ds_read_b128 v[104:107], v26 offset:53248
  v_mfma_f32_32x32x16_bf16 v[76:91], v[112:115], v[128:131], v[76:91]
  s_add_u32 m0, s76, 98304
  s_nop 0
  buffer_load_dwordx4 v140, s[72:75], s63 offen offset:0 lds
  v_mfma_f32_32x32x16_bf16 v[60:75], v[112:115], v[124:127], v[60:75]
  buffer_load_dwordx4 v141, s[72:75], s63 offen offset:1024 lds
  s_waitcnt lgkmcnt(2)
  v_mfma_f32_32x32x16_bf16 v[28:43], v[92:95], v[100:103], v[28:43]
  ds_read_b128 v[108:111], v23 offset:49152
  ds_read_b128 v[124:127], v27 offset:49152
  s_waitcnt lgkmcnt(2)
  v_mfma_f32_32x32x16_bf16 v[44:59], v[92:95], v[104:107], v[44:59]
  ds_read_b128 v[112:115], v23 offset:53248
  ds_read_b128 v[128:131], v27 offset:53248
  v_mfma_f32_32x32x16_bf16 v[76:91], v[96:99], v[104:107], v[76:91]
  buffer_load_dwordx4 v142, s[72:75], s63 offen offset:2048 lds
  v_mfma_f32_32x32x16_bf16 v[60:75], v[96:99], v[100:103], v[60:75]
  buffer_load_dwordx4 v143, s[72:75], s63 offen offset:3072 lds
  s_add_u32 s63, s63, 128
  s_and_b32 s63, s63, 0x7ff
  s_waitcnt lgkmcnt(2)
  v_mfma_f32_32x32x16_bf16 v[28:43], v[108:111], v[124:127], v[28:43]
  s_waitcnt lgkmcnt(0)
  v_mfma_f32_32x32x16_bf16 v[44:59], v[108:111], v[128:131], v[44:59]
  v_mfma_f32_32x32x16_bf16 v[76:91], v[112:115], v[128:131], v[76:91]
  v_mfma_f32_32x32x16_bf16 v[60:75], v[112:115], v[124:127], v[60:75]
  s_nop 7
  v_pk_fma_f32 v[12:13], v[10:11], v[28:29], v[30:31] op_sel:[0,0,0] op_sel_hi:[0,1,1]
  s_nop 0
  v_pk_fma_f32 v[14:15], v[10:11], v[44:45], v[46:47] op_sel:[0,0,0] op_sel_hi:[0,1,1]
  v_pk_fma_f32 v[12:13], v[10:11], v[44:45], v[12:13] op_sel:[1,0,0] op_sel_hi:[1,1,1] neg_lo:[1,0,0] neg_hi:[1,0,0]
  v_pk_fma_f32 v[14:15], v[10:11], v[28:29], v[14:15] op_sel:[1,0,0] op_sel_hi:[1,1,1]
  v_pk_fma_f32 v[16:17], v[10:11], v[12:13], v[32:33] op_sel:[0,0,0] op_sel_hi:[0,1,1]
  v_pk_fma_f32 v[18:19], v[10:11], v[14:15], v[48:49] op_sel:[0,0,0] op_sel_hi:[0,1,1]
  v_pk_fma_f32 v[16:17], v[10:11], v[14:15], v[16:17] op_sel:[1,0,0] op_sel_hi:[1,1,1] neg_lo:[1,0,0] neg_hi:[1,0,0]
  v_pk_fma_f32 v[18:19], v[10:11], v[12:13], v[18:19] op_sel:[1,0,0] op_sel_hi:[1,1,1]
  v_pk_fma_f32 v[12:13], v[10:11], v[16:17], v[34:35] op_sel:[0,0,0] op_sel_hi:[0,1,1]
  v_pk_fma_f32 v[14:15], v[10:11], v[18:19], v[50:51] op_sel:[0,0,0] op_sel_hi:[0,1,1]
  v_pk_fma_f32 v[12:13], v[10:11], v[18:19], v[12:13] op_sel:[1,0,0] op_sel_hi:[1,1,1] neg_lo:[1,0,0] neg_hi:[1,0,0]
  v_pk_fma_f32 v[14:15], v[10:11], v[16:17], v[14:15] op_sel:[1,0,0] op_sel_hi:[1,1,1]
  v_pk_fma_f32 v[16:17], v[10:11], v[12:13], v[36:37] op_sel:[0,0,0] op_sel_hi:[0,1,1]
  v_pk_fma_f32 v[18:19], v[10:11], v[14:15], v[52:53] op_sel:[0,0,0] op_sel_hi:[0,1,1]
  v_pk_fma_f32 v[16:17], v[10:11], v[14:15], v[16:17] op_sel:[1,0,0] op_sel_hi:[1,1,1] neg_lo:[1,0,0] neg_hi:[1,0,0]
  v_pk_fma_f32 v[18:19], v[10:11], v[12:13], v[18:19] op_sel:[1,0,0] op_sel_hi:[1,1,1]
  v_pk_fma_f32 v[12:13], v[10:11], v[16:17], v[38:39] op_sel:[0,0,0] op_sel_hi:[0,1,1]
  v_pk_fma_f32 v[14:15], v[10:11], v[18:19], v[54:55] op_sel:[0,0,0] op_sel_hi:[0,1,1]
  v_pk_fma_f32 v[12:13], v[10:11], v[18:19], v[12:13] op_sel:[1,0,0] op_sel_hi:[1,1,1] neg_lo:[1,0,0] neg_hi:[1,0,0]
  v_pk_fma_f32 v[14:15], v[10:11], v[16:17], v[14:15] op_sel:[1,0,0] op_sel_hi:[1,1,1]
  v_pk_fma_f32 v[16:17], v[10:11], v[12:13], v[40:41] op_sel:[0,0,0] op_sel_hi:[0,1,1]
  v_pk_fma_f32 v[18:19], v[10:11], v[14:15], v[56:57] op_sel:[0,0,0] op_sel_hi:[0,1,1]
  v_pk_fma_f32 v[16:17], v[10:11], v[14:15], v[16:17] op_sel:[1,0,0] op_sel_hi:[1,1,1] neg_lo:[1,0,0] neg_hi:[1,0,0]
  v_pk_fma_f32 v[18:19], v[10:11], v[12:13], v[18:19] op_sel:[1,0,0] op_sel_hi:[1,1,1]
  v_pk_fma_f32 v[12:13], v[10:11], v[16:17], v[42:43] op_sel:[0,0,0] op_sel_hi:[0,1,1]
  v_pk_fma_f32 v[14:15], v[10:11], v[18:19], v[58:59] op_sel:[0,0,0] op_sel_hi:[0,1,1]
  v_pk_fma_f32 v[12:13], v[10:11], v[18:19], v[12:13] op_sel:[1,0,0] op_sel_hi:[1,1,1] neg_lo:[1,0,0] neg_hi:[1,0,0]
  v_pk_fma_f32 v[14:15], v[10:11], v[16:17], v[14:15] op_sel:[1,0,0] op_sel_hi:[1,1,1]
  v_pk_fma_f32 v[16:17], v[10:11], v[12:13], v[60:61] op_sel:[0,0,0] op_sel_hi:[0,1,1]
  v_pk_fma_f32 v[18:19], v[10:11], v[14:15], v[76:77] op_sel:[0,0,0] op_sel_hi:[0,1,1]
  v_pk_fma_f32 v[16:17], v[10:11], v[14:15], v[16:17] op_sel:[1,0,0] op_sel_hi:[1,1,1] neg_lo:[1,0,0] neg_hi:[1,0,0]
  v_pk_fma_f32 v[18:19], v[10:11], v[12:13], v[18:19] op_sel:[1,0,0] op_sel_hi:[1,1,1]
  v_pk_fma_f32 v[12:13], v[10:11], v[16:17], v[62:63] op_sel:[0,0,0] op_sel_hi:[0,1,1]
  v_pk_fma_f32 v[14:15], v[10:11], v[18:19], v[78:79] op_sel:[0,0,0] op_sel_hi:[0,1,1]
  v_pk_fma_f32 v[12:13], v[10:11], v[18:19], v[12:13] op_sel:[1,0,0] op_sel_hi:[1,1,1] neg_lo:[1,0,0] neg_hi:[1,0,0]
  v_pk_fma_f32 v[14:15], v[10:11], v[16:17], v[14:15] op_sel:[1,0,0] op_sel_hi:[1,1,1]
  v_pk_fma_f32 v[16:17], v[10:11], v[12:13], v[64:65] op_sel:[0,0,0] op_sel_hi:[0,1,1]
  v_pk_fma_f32 v[18:19], v[10:11], v[14:15], v[80:81] op_sel:[0,0,0] op_sel_hi:[0,1,1]
  v_pk_fma_f32 v[16:17], v[10:11], v[14:15], v[16:17] op_sel:[1,0,0] op_sel_hi:[1,1,1] neg_lo:[1,0,0] neg_hi:[1,0,0]
  v_pk_fma_f32 v[18:19], v[10:11], v[12:13], v[18:19] op_sel:[1,0,0] op_sel_hi:[1,1,1]
  v_pk_fma_f32 v[12:13], v[10:11], v[16:17], v[66:67] op_sel:[0,0,0] op_sel_hi:[0,1,1]
  v_pk_fma_f32 v[14:15], v[10:11], v[18:19], v[82:83] op_sel:[0,0,0] op_sel_hi:[0,1,1]
  v_pk_fma_f32 v[12:13], v[10:11], v[18:19], v[12:13] op_sel:[1,0,0] op_sel_hi:[1,1,1] neg_lo:[1,0,0] neg_hi:[1,0,0]
  v_pk_fma_f32 v[14:15], v[10:11], v[16:17], v[14:15] op_sel:[1,0,0] op_sel_hi:[1,1,1]
  v_pk_fma_f32 v[16:17], v[10:11], v[12:13], v[68:69] op_sel:[0,0,0] op_sel_hi:[0,1,1]
  v_pk_fma_f32 v[18:19], v[10:11], v[14:15], v[84:85] op_sel:[0,0,0] op_sel_hi:[0,1,1]
  v_pk_fma_f32 v[16:17], v[10:11], v[14:15], v[16:17] op_sel:[1,0,0] op_sel_hi:[1,1,1] neg_lo:[1,0,0] neg_hi:[1,0,0]
  v_pk_fma_f32 v[18:19], v[10:11], v[12:13], v[18:19] op_sel:[1,0,0] op_sel_hi:[1,1,1]
  v_pk_fma_f32 v[12:13], v[10:11], v[16:17], v[70:71] op_sel:[0,0,0] op_sel_hi:[0,1,1]
  v_pk_fma_f32 v[14:15], v[10:11], v[18:19], v[86:87] op_sel:[0,0,0] op_sel_hi:[0,1,1]
  v_pk_fma_f32 v[12:13], v[10:11], v[18:19], v[12:13] op_sel:[1,0,0] op_sel_hi:[1,1,1] neg_lo:[1,0,0] neg_hi:[1,0,0]
  v_pk_fma_f32 v[14:15], v[10:11], v[16:17], v[14:15] op_sel:[1,0,0] op_sel_hi:[1,1,1]
  v_pk_fma_f32 v[16:17], v[10:11], v[12:13], v[72:73] op_sel:[0,0,0] op_sel_hi:[0,1,1]
  v_pk_fma_f32 v[18:19], v[10:11], v[14:15], v[88:89] op_sel:[0,0,0] op_sel_hi:[0,1,1]
  v_pk_fma_f32 v[16:17], v[10:11], v[14:15], v[16:17] op_sel:[1,0,0] op_sel_hi:[1,1,1] neg_lo:[1,0,0] neg_hi:[1,0,0]
  v_pk_fma_f32 v[18:19], v[10:11], v[12:13], v[18:19] op_sel:[1,0,0] op_sel_hi:[1,1,1]
  v_pk_fma_f32 v[12:13], v[10:11], v[16:17], v[74:75] op_sel:[0,0,0] op_sel_hi:[0,1,1]
  v_pk_fma_f32 v[14:15], v[10:11], v[18:19], v[90:91] op_sel:[0,0,0] op_sel_hi:[0,1,1]
  v_pk_fma_f32 v[12:13], v[10:11], v[18:19], v[12:13] op_sel:[1,0,0] op_sel_hi:[1,1,1] neg_lo:[1,0,0] neg_hi:[1,0,0]
  v_pk_fma_f32 v[14:15], v[10:11], v[16:17], v[14:15] op_sel:[1,0,0] op_sel_hi:[1,1,1]
  v_fma_f32 v16, v116, v12, v13
  v_fma_f32 v17, v116, v14, v15
  v_fma_f32 v16, -v117, v14, v16
  v_fma_f32 v17, v117, v12, v17
  v_mov_b32 v18, v16
  v_mov_b32 v19, v17
  s_nop 0
  v_permlane32_swap_b32 v16, v18
  v_permlane32_swap_b32 v17, v19
  v_fma_f32 v18, v122, v16, v18
  v_fma_f32 v19, v122, v17, v19
  v_fma_f32 v18, -v123, v17, v18
  v_fma_f32 v19, v123, v16, v19
  v_min_u32 v18, -2, v18
  v_min_u32 v19, -2, v19
  s_lshl_b32 s43, s38, 1
  s_lshr_b32 s44, s3, 1
  s_add_u32 s43, s43, s44
  s_sub_u32 s43, 31, s43
  s_lshl_b32 s43, s43, 9
  s_and_b32 s44, s3, 1
  s_lshl_b32 s44, s44, 8
  s_add_u32 s43, s43, s44
  v_and_b32 v9, 31, v4
  v_lshl_add_u32 v9, v9, 3, s43
  s_mov_b32 exec_hi, 0
  buffer_store_dwordx2 v[18:19], v9, s[88:91], 0 offen sc1
  s_mov_b64 exec, -1
  v_lshrrev_b32 v20, 5, v4
  v_lshl_add_u32 v9, v20, 13, v9
  v_add_u32 v9, 512, v9
  s_waitcnt vmcnt(25)
  v_cmp_ne_u32 vcc, 1, v217
  s_nop 0
  s_cbranch_vccz gated_mix__spectral_gfnet__ssm_conv_s5__prompt_kernel_skip14
  s_mov_b32 s43, 0
gated_mix__spectral_gfnet__ssm_conv_s5__prompt_kernel_poll15:
  s_sleep 2
  buffer_load_dword v217, v7, s[48:51], s36 offen sc1
  s_waitcnt vmcnt(0)
  v_cmp_ne_u32 vcc, 1, v217
  s_nop 0
  s_cbranch_vccz gated_mix__spectral_gfnet__ssm_conv_s5__prompt_kernel_pollout16
  s_add_u32 s43, s43, 1
  s_cmp_lt_u32 s43, 1048576
  s_cbranch_scc1 gated_mix__spectral_gfnet__ssm_conv_s5__prompt_kernel_poll15
gated_mix__spectral_gfnet__ssm_conv_s5__prompt_kernel_pollout16:
gated_mix__spectral_gfnet__ssm_conv_s5__prompt_kernel_skip14:
  s_barrier
  v_and_b32 v19, 3, v5
  v_lshlrev_b32 v18, 6, v19
  v_lshrrev_b32 v19, 2, v5
  v_lshl_or_b32 v18, v19, 4, v18
  v_lshl_or_b32 v18, v6, 12, v18
  s_mul_i32 s43, s84, 16384
  s_lshl_b32 s44, s3, 8
  s_add_u32 s43, s43, s44
  buffer_load_dwordx4 v[20:23], v18, s[64:67], s43 offen offset:0 sc1
  buffer_load_dwordx4 v[24:27], v18, s[64:67], s43 offen offset:1024 sc1
  buffer_load_dwordx4 v[92:95], v18, s[64:67], s43 offen offset:2048 sc1
  buffer_load_dwordx4 v[96:99], v18, s[64:67], s43 offen offset:3072 sc1
  v_lshlrev_b32 v18, 4, v4
  s_lshl_b32 s43, s84, 14
  s_lshl_b32 s44, s3, 12
  s_add_u32 s43, s43, s44
  buffer_load_dwordx4 v[100:103], v18, s[68:71], s43 offen offset:0 sc1
  buffer_load_dwordx4 v[104:107], v18, s[68:71], s43 offen offset:1024 sc1
  buffer_load_dwordx4 v[108:111], v18, s[68:71], s43 offen offset:2048 sc1
  buffer_load_dwordx4 v[112:115], v18, s[68:71], s43 offen offset:3072 sc1
  s_cmp_eq_u32 s79, 0
  s_cbranch_scc1 gated_mix__spectral_gfnet__ssm_conv_s5__prompt_kernel_skip17
  s_lshl_b32 s43, s84, 9
  s_add_u32 s43, s43, 4194304
  buffer_load_dwordx4 v[124:127], v18, s[68:71], s43 offen sc1
gated_mix__spectral_gfnet__ssm_conv_s5__prompt_kernel_skip17:
  s_add_u32 m0, s76, 49152
  s_nop 0
  buffer_load_dwordx4 v140, s[72:75], s63 offen offset:0 lds
  buffer_load_dwordx4 v141, s[72:75], s63 offen offset:1024 lds
  buffer_load_dwordx4 v142, s[72:75], s63 offen offset:2048 lds
  buffer_load_dwordx4 v143, s[72:75], s63 offen offset:3072 lds
  s_add_u32 s63, s63, 128
  s_and_b32 s63, s63, 0x7ff
  s_waitcnt vmcnt(33)
  ds_read_b128 a[0:3], v144 offset:0
  ds_read_b128 a[4:7], v145 offset:0
  ds_read_b128 a[8:11], v144 offset:2048
  ds_read_b128 a[12:15], v145 offset:2048
  s_waitcnt vmcnt(29)
  ds_read_b128 a[16:19], v146 offset:0
  ds_read_b128 a[20:23], v147 offset:0
  ds_read_b128 a[24:27], v146 offset:2048
  ds_read_b128 a[28:31], v147 offset:2048
  s_waitcnt vmcnt(25)
  ds_read_b128 a[32:35], v144 offset:16384
  ds_read_b128 a[36:39], v145 offset:16384
  ds_read_b128 a[40:43], v144 offset:18432
  ds_read_b128 a[44:47], v145 offset:18432
  s_waitcnt vmcnt(21)
  ds_read_b128 a[48:51], v146 offset:16384
  ds_read_b128 a[52:55], v147 offset:16384
  ds_read_b128 a[56:59], v146 offset:18432
  ds_read_b128 a[60:63], v147 offset:18432
  s_waitcnt vmcnt(17)
  ds_read_b128 a[64:67], v144 offset:32768
  ds_read_b128 a[68:71], v145 offset:32768
  ds_read_b128 a[72:75], v144 offset:34816
  ds_read_b128 a[76:79], v145 offset:34816
  s_waitcnt vmcnt(13)
  ds_read_b128 a[80:83], v146 offset:32768
  ds_read_b128 a[84:87], v147 offset:32768
  ds_read_b128 a[88:91], v146 offset:34816
  ds_read_b128 a[92:95], v147 offset:34816
  s_waitcnt lgkmcnt(15)
  s_add_u32 m0, s76, 0
  s_nop 0
  buffer_load_dwordx4 v140, s[72:75], s63 offen offset:0 lds
  buffer_load_dwordx4 v141, s[72:75], s63 offen offset:1024 lds
  buffer_load_dwordx4 v142, s[72:75], s63 offen offset:2048 lds
  buffer_load_dwordx4 v143, s[72:75], s63 offen offset:3072 lds
  s_add_u32 s63, s63, 128
  s_and_b32 s63, s63, 0x7ff
  s_waitcnt lgkmcnt(15)
  s_add_u32 m0, s76, 65536
  s_nop 0
  buffer_load_dwordx4 v140, s[72:75], s63 offen offset:0 lds
  buffer_load_dwordx4 v141, s[72:75], s63 offen offset:1024 lds
  buffer_load_dwordx4 v142, s[72:75], s63 offen offset:2048 lds
  buffer_load_dwordx4 v143, s[72:75], s63 offen offset:3072 lds
  s_add_u32 s63, s63, 128
  s_and_b32 s63, s63, 0x7ff
  v_pk_mul_f32 v[130:131], v[136:137], v[28:29] op_sel:[1,0] op_sel_hi:[1,1]
  v_pk_mul_f32 v[28:29], v[136:137], v[28:29] op_sel:[0,0] op_sel_hi:[0,1]
  v_pk_fma_f32 v[28:29], v[136:137], v[44:45], v[28:29] op_sel:[1,0,0] op_sel_hi:[1,1,1] neg_lo:[1,0,0] neg_hi:[1,0,0]
  v_pk_fma_f32 v[44:45], v[136:137], v[44:45], v[130:131] op_sel:[0,0,0] op_sel_hi:[0,1,1]
  v_pk_mul_f32 v[128:129], v[136:137], v[30:31] op_sel:[1,0] op_sel_hi:[1,1]
  v_pk_mul_f32 v[30:31], v[136:137], v[30:31] op_sel:[0,0] op_sel_hi:[0,1]
  v_pk_fma_f32 v[30:31], v[136:137], v[46:47], v[30:31] op_sel:[1,0,0] op_sel_hi:[1,1,1] neg_lo:[1,0,0] neg_hi:[1,0,0]
  v_pk_fma_f32 v[46:47], v[136:137], v[46:47], v[128:129] op_sel:[0,0,0] op_sel_hi:[0,1,1]
  v_pk_mul_f32 v[130:131], v[136:137], v[32:33] op_sel:[1,0] op_sel_hi:[1,1]
  v_pk_mul_f32 v[32:33], v[136:137], v[32:33] op_sel:[0,0] op_sel_hi:[0,1]
  v_pk_fma_f32 v[32:33], v[136:137], v[48:49], v[32:33] op_sel:[1,0,0] op_sel_hi:[1,1,1] neg_lo:[1,0,0] neg_hi:[1,0,0]
  v_pk_fma_f32 v[48:49], v[136:137], v[48:49], v[130:131] op_sel:[0,0,0] op_sel_hi:[0,1,1]
  v_pk_mul_f32 v[128:129], v[136:137], v[34:35] op_sel:[1,0] op_sel_hi:[1,1]
  v_pk_mul_f32 v[34:35], v[136:137], v[34:35] op_sel:[0,0] op_sel_hi:[0,1]
  v_pk_fma_f32 v[34:35], v[136:137], v[50:51], v[34:35] op_sel:[1,0,0] op_sel_hi:[1,1,1] neg_lo:[1,0,0] neg_hi:[1,0,0]
  v_pk_fma_f32 v[50:51], v[136:137], v[50:51], v[128:129] op_sel:[0,0,0] op_sel_hi:[0,1,1]
  v_pk_mul_f32 v[130:131], v[136:137], v[36:37] op_sel:[1,0] op_sel_hi:[1,1]
  v_pk_mul_f32 v[36:37], v[136:137], v[36:37] op_sel:[0,0] op_sel_hi:[0,1]
  v_pk_fma_f32 v[36:37], v[136:137], v[52:53], v[36:37] op_sel:[1,0,0] op_sel_hi:[1,1,1] neg_lo:[1,0,0] neg_hi:[1,0,0]
  v_pk_fma_f32 v[52:53], v[136:137], v[52:53], v[130:131] op_sel:[0,0,0] op_sel_hi:[0,1,1]
  v_pk_mul_f32 v[128:129], v[136:137], v[38:39] op_sel:[1,0] op_sel_hi:[1,1]
  v_pk_mul_f32 v[38:39], v[136:137], v[38:39] op_sel:[0,0] op_sel_hi:[0,1]
  v_pk_fma_f32 v[38:39], v[136:137], v[54:55], v[38:39] op_sel:[1,0,0] op_sel_hi:[1,1,1] neg_lo:[1,0,0] neg_hi:[1,0,0]
  v_pk_fma_f32 v[54:55], v[136:137], v[54:55], v[128:129] op_sel:[0,0,0] op_sel_hi:[0,1,1]
  v_pk_mul_f32 v[130:131], v[136:137], v[40:41] op_sel:[1,0] op_sel_hi:[1,1]
  v_pk_mul_f32 v[40:41], v[136:137], v[40:41] op_sel:[0,0] op_sel_hi:[0,1]
  v_pk_fma_f32 v[40:41], v[136:137], v[56:57], v[40:41] op_sel:[1,0,0] op_sel_hi:[1,1,1] neg_lo:[1,0,0] neg_hi:[1,0,0]
  v_pk_fma_f32 v[56:57], v[136:137], v[56:57], v[130:131] op_sel:[0,0,0] op_sel_hi:[0,1,1]
  v_pk_mul_f32 v[128:129], v[136:137], v[42:43] op_sel:[1,0] op_sel_hi:[1,1]
  v_pk_mul_f32 v[42:43], v[136:137], v[42:43] op_sel:[0,0] op_sel_hi:[0,1]
  v_pk_fma_f32 v[42:43], v[136:137], v[58:59], v[42:43] op_sel:[1,0,0] op_sel_hi:[1,1,1] neg_lo:[1,0,0] neg_hi:[1,0,0]
  v_pk_fma_f32 v[58:59], v[136:137], v[58:59], v[128:129] op_sel:[0,0,0] op_sel_hi:[0,1,1]
  v_pk_mul_f32 v[130:131], v[136:137], v[60:61] op_sel:[1,0] op_sel_hi:[1,1]
  v_pk_mul_f32 v[60:61], v[136:137], v[60:61] op_sel:[0,0] op_sel_hi:[0,1]
  v_pk_fma_f32 v[60:61], v[136:137], v[76:77], v[60:61] op_sel:[1,0,0] op_sel_hi:[1,1,1] neg_lo:[1,0,0] neg_hi:[1,0,0]
  v_pk_fma_f32 v[76:77], v[136:137], v[76:77], v[130:131] op_sel:[0,0,0] op_sel_hi:[0,1,1]
  v_pk_mul_f32 v[128:129], v[136:137], v[62:63] op_sel:[1,0] op_sel_hi:[1,1]
  v_pk_mul_f32 v[62:63], v[136:137], v[62:63] op_sel:[0,0] op_sel_hi:[0,1]
  v_pk_fma_f32 v[62:63], v[136:137], v[78:79], v[62:63] op_sel:[1,0,0] op_sel_hi:[1,1,1] neg_lo:[1,0,0] neg_hi:[1,0,0]
  v_pk_fma_f32 v[78:79], v[136:137], v[78:79], v[128:129] op_sel:[0,0,0] op_sel_hi:[0,1,1]
  v_pk_mul_f32 v[130:131], v[136:137], v[64:65] op_sel:[1,0] op_sel_hi:[1,1]
  v_pk_mul_f32 v[64:65], v[136:137], v[64:65] op_sel:[0,0] op_sel_hi:[0,1]
  v_pk_fma_f32 v[64:65], v[136:137], v[80:81], v[64:65] op_sel:[1,0,0] op_sel_hi:[1,1,1] neg_lo:[1,0,0] neg_hi:[1,0,0]
  v_pk_fma_f32 v[80:81], v[136:137], v[80:81], v[130:131] op_sel:[0,0,0] op_sel_hi:[0,1,1]
  v_pk_mul_f32 v[128:129], v[136:137], v[66:67] op_sel:[1,0] op_sel_hi:[1,1]
  v_pk_mul_f32 v[66:67], v[136:137], v[66:67] op_sel:[0,0] op_sel_hi:[0,1]
  v_pk_fma_f32 v[66:67], v[136:137], v[82:83], v[66:67] op_sel:[1,0,0] op_sel_hi:[1,1,1] neg_lo:[1,0,0] neg_hi:[1,0,0]
  v_pk_fma_f32 v[82:83], v[136:137], v[82:83], v[128:129] op_sel:[0,0,0] op_sel_hi:[0,1,1]
  v_pk_mul_f32 v[130:131], v[136:137], v[68:69] op_sel:[1,0] op_sel_hi:[1,1]
  v_pk_mul_f32 v[68:69], v[136:137], v[68:69] op_sel:[0,0] op_sel_hi:[0,1]
  v_pk_fma_f32 v[68:69], v[136:137], v[84:85], v[68:69] op_sel:[1,0,0] op_sel_hi:[1,1,1] neg_lo:[1,0,0] neg_hi:[1,0,0]
  v_pk_fma_f32 v[84:85], v[136:137], v[84:85], v[130:131] op_sel:[0,0,0] op_sel_hi:[0,1,1]
  v_pk_mul_f32 v[128:129], v[136:137], v[70:71] op_sel:[1,0] op_sel_hi:[1,1]
  v_pk_mul_f32 v[70:71], v[136:137], v[70:71] op_sel:[0,0] op_sel_hi:[0,1]
  v_pk_fma_f32 v[70:71], v[136:137], v[86:87], v[70:71] op_sel:[1,0,0] op_sel_hi:[1,1,1] neg_lo:[1,0,0] neg_hi:[1,0,0]
  v_pk_fma_f32 v[86:87], v[136:137], v[86:87], v[128:129] op_sel:[0,0,0] op_sel_hi:[0,1,1]
  v_pk_mul_f32 v[130:131], v[136:137], v[72:73] op_sel:[1,0] op_sel_hi:[1,1]
  v_pk_mul_f32 v[72:73], v[136:137], v[72:73] op_sel:[0,0] op_sel_hi:[0,1]
  v_pk_fma_f32 v[72:73], v[136:137], v[88:89], v[72:73] op_sel:[1,0,0] op_sel_hi:[1,1,1] neg_lo:[1,0,0] neg_hi:[1,0,0]
  v_pk_fma_f32 v[88:89], v[136:137], v[88:89], v[130:131] op_sel:[0,0,0] op_sel_hi:[0,1,1]
  v_pk_mul_f32 v[128:129], v[136:137], v[74:75] op_sel:[1,0] op_sel_hi:[1,1]
  v_pk_mul_f32 v[74:75], v[136:137], v[74:75] op_sel:[0,0] op_sel_hi:[0,1]
  v_pk_fma_f32 v[74:75], v[136:137], v[90:91], v[74:75] op_sel:[1,0,0] op_sel_hi:[1,1,1] neg_lo:[1,0,0] neg_hi:[1,0,0]
  v_pk_fma_f32 v[90:91], v[136:137], v[90:91], v[128:129] op_sel:[0,0,0] op_sel_hi:[0,1,1]
  s_lshl_b32 s44, s38, 1
  s_lshr_b32 s45, s3, 1
  s_add_u32 s44, s44, s45
  s_lshl_b32 s43, s44, 9
  s_and_b32 s44, s44, 3
  s_lshl_b32 s44, s44, 2
  v_xor_b32 v18, s44, v5
  v_lshlrev_b32 v18, 4, v18
  v_lshrrev_b32 v19, 1, v6
  v_lshl_or_b32 v18, v19, 14, v18
  v_and_b32 v19, 1, v6
  v_lshl_or_b32 v18, v19, 19, v18
  s_and_b32 s45, s3, 1
  s_lshl_b32 s45, s45, 8
  s_add_u32 s43, s43, s45
  s_lshl_b32 s45, s39, 15
  s_add_u32 s43, s43, s45
  v_add_u32 v118, 4096, v9
  s_mov_b32 s44, 0
gated_mix__spectral_gfnet__ssm_conv_s5__prompt_kernel_lb18:
  buffer_load_dwordx2 v[128:129], v9, s[88:91], 0 offen offset:0 sc1
  buffer_load_dwordx2 v[130:131], v9, s[88:91], 0 offen offset:512 sc1
  buffer_load_dwordx2 v[148:149], v9, s[88:91], 0 offen offset:1024 sc1
  buffer_load_dwordx2 v[150:151], v9, s[88:91], 0 offen offset:1536 sc1
  buffer_load_dwordx2 v[216:217], v9, s[88:91], 0 offen offset:2048 sc1
  buffer_load_dwordx2 v[218:219], v9, s[88:91], 0 offen offset:2560 sc1
  buffer_load_dwordx2 v[220:221], v9, s[88:91], 0 offen offset:3072 sc1
  buffer_load_dwordx2 v[222:223], v9, s[88:91], 0 offen offset:3584 sc1
  buffer_load_dwordx2 v[224:225], v118, s[88:91], 0 offen offset:0 sc1
  buffer_load_dwordx2 v[226:227], v118, s[88:91], 0 offen offset:512 sc1
  buffer_load_dwordx2 v[228:229], v118, s[88:91], 0 offen offset:1024 sc1
  buffer_load_dwordx2 v[230:231], v118, s[88:91], 0 offen offset:1536 sc1
  buffer_load_dwordx2 v[232:233], v118, s[88:91], 0 offen offset:2048 sc1
  buffer_load_dwordx2 v[234:235], v118, s[88:91], 0 offen offset:2560 sc1
  buffer_load_dwordx2 v[236:237], v118, s[88:91], 0 offen offset:3072 sc1
  buffer_load_dwordx2 v[238:239], v118, s[88:91], 0 offen offset:3584 sc1
  s_waitcnt vmcnt(15)
  v_max_u32 v19, v128, v129
  s_waitcnt vmcnt(14)
  v_max3_u32 v19, v19, v130, v131
  s_waitcnt vmcnt(13)
  v_max3_u32 v19, v19, v148, v149
  s_waitcnt vmcnt(12)
  v_max3_u32 v19, v19, v150, v151
  s_waitcnt vmcnt(11)
  v_max3_u32 v19, v19, v216, v217
  s_waitcnt vmcnt(10)
  v_max3_u32 v19, v19, v218, v219
  s_waitcnt vmcnt(9)
  v_max3_u32 v19, v19, v220, v221
  s_waitcnt vmcnt(8)
  v_max3_u32 v19, v19, v222, v223
  s_waitcnt vmcnt(7)
  v_max3_u32 v19, v19, v224, v225
  s_waitcnt vmcnt(6)
  v_max3_u32 v19, v19, v226, v227
  s_waitcnt vmcnt(5)
  v_max3_u32 v19, v19, v228, v229
  s_waitcnt vmcnt(4)
  v_max3_u32 v19, v19, v230, v231
  s_waitcnt vmcnt(3)
  v_max3_u32 v19, v19, v232, v233
  s_waitcnt vmcnt(2)
  v_max3_u32 v19, v19, v234, v235
  s_waitcnt vmcnt(1)
  v_max3_u32 v19, v19, v236, v237
  s_waitcnt vmcnt(0)
  v_max3_u32 v19, v19, v238, v239
  v_cmp_eq_u32 vcc, -1, v19
  s_nop 0
  s_cbranch_vccz gated_mix__spectral_gfnet__ssm_conv_s5__prompt_kernel_lbdone19
  s_add_u32 s44, s44, 1
  s_cmp_lt_u32 s44, 1048576
  s_cbranch_scc1 gated_mix__spectral_gfnet__ssm_conv_s5__prompt_kernel_lb18
gated_mix__spectral_gfnet__ssm_conv_s5__prompt_kernel_lbdone19:
  s_add_u32 s44, s34, 10485760
  s_addc_u32 s45, s35, 0
  s_mov_b32 s46, 8388608
  s_mov_b32 s47, 0x20000
  v_fma_f32 v236, v132, v238, v236
  v_fma_f32 v237, v132, v239, v237
  v_fma_f32 v236, -v133, v239, v236
  v_fma_f32 v237, v133, v238, v237
  v_fma_f32 v234, v132, v236, v234
  v_fma_f32 v235, v132, v237, v235
  v_fma_f32 v234, -v133, v237, v234
  v_fma_f32 v235, v133, v236, v235
  v_fma_f32 v232, v132, v234, v232
  v_fma_f32 v233, v132, v235, v233
  v_fma_f32 v232, -v133, v235, v232
  v_fma_f32 v233, v133, v234, v233
  v_fma_f32 v230, v132, v232, v230
  v_fma_f32 v231, v132, v233, v231
  v_fma_f32 v230, -v133, v233, v230
  v_fma_f32 v231, v133, v232, v231
  v_fma_f32 v228, v132, v230, v228
  v_fma_f32 v229, v132, v231, v229
  v_fma_f32 v228, -v133, v231, v228
  v_fma_f32 v229, v133, v230, v229
  v_fma_f32 v226, v132, v228, v226
  v_fma_f32 v227, v132, v229, v227
  v_fma_f32 v226, -v133, v229, v226
  v_fma_f32 v227, v133, v228, v227
  v_fma_f32 v224, v132, v226, v224
  v_fma_f32 v225, v132, v227, v225
  v_fma_f32 v224, -v133, v227, v224
  v_fma_f32 v225, v133, v226, v225
  v_fma_f32 v222, v132, v224, v222
  v_fma_f32 v223, v132, v225, v223
  v_fma_f32 v222, -v133, v225, v222
  v_fma_f32 v223, v133, v224, v223
  v_fma_f32 v220, v132, v222, v220
  v_fma_f32 v221, v132, v223, v221
  v_fma_f32 v220, -v133, v223, v220
  v_fma_f32 v221, v133, v222, v221
  v_fma_f32 v218, v132, v220, v218
  v_fma_f32 v219, v132, v221, v219
  v_fma_f32 v218, -v133, v221, v218
  v_fma_f32 v219, v133, v220, v219
  v_fma_f32 v216, v132, v218, v216
  v_fma_f32 v217, v132, v219, v217
  v_fma_f32 v216, -v133, v219, v216
  v_fma_f32 v217, v133, v218, v217
  v_fma_f32 v150, v132, v216, v150
  v_fma_f32 v151, v132, v217, v151
  v_fma_f32 v150, -v133, v217, v150
  v_fma_f32 v151, v133, v216, v151
  v_fma_f32 v148, v132, v150, v148
  v_fma_f32 v149, v132, v151, v149
  v_fma_f32 v148, -v133, v151, v148
  v_fma_f32 v149, v133, v150, v149
  v_fma_f32 v130, v132, v148, v130
  v_fma_f32 v131, v132, v149, v131
  v_fma_f32 v130, -v133, v149, v130
  v_fma_f32 v131, v133, v148, v131
  v_fma_f32 v128, v132, v130, v128
  v_fma_f32 v129, v132, v131, v129
  v_fma_f32 v128, -v133, v131, v128
  v_fma_f32 v129, v133, v130, v129
  v_mov_b32 v130, v128
  v_mov_b32 v131, v129
  s_nop 0
  v_permlane32_swap_b32 v128, v130
  v_permlane32_swap_b32 v129, v131
  v_fma_f32 v128, v134, v130, v128
  v_fma_f32 v129, v134, v131, v129
  v_fma_f32 v128, -v135, v131, v128
  v_fma_f32 v129, v135, v130, v129
  v_fma_f32 v16, v122, v128, v16
  v_fma_f32 v17, v122, v129, v17
  v_fma_f32 v16, -v123, v129, v16
  v_fma_f32 v17, v123, v128, v17
  s_mov_b32 exec_lo, 0
  v_mov_b32 v128, v16
  v_mov_b32 v129, v17
  s_mov_b64 exec, -1
  v_fma_f32 v12, v116, v128, v12
  v_fma_f32 v14, v116, v129, v14
  v_fma_f32 v12, -v117, v129, v12
  v_fma_f32 v14, v117, v128, v14
  v_mul_f32 v148, v136, v128
  v_mul_f32 v150, v136, v129
  v_fma_f32 v148, -v137, v129, v148
  v_fma_f32 v150, v137, v128, v150
  v_mul_f32 v149, v136, v12
  v_mul_f32 v151, v136, v14
  v_fma_f32 v149, -v137, v14, v149
  v_fma_f32 v151, v137, v12, v151
  v_pk_fma_f32 v[28:29], v[10:11], v[148:149], v[28:29] op_sel:[0,0,0] op_sel_hi:[0,1,1]
  v_pk_fma_f32 v[44:45], v[10:11], v[150:151], v[44:45] op_sel:[0,0,0] op_sel_hi:[0,1,1]
  v_pk_fma_f32 v[28:29], v[10:11], v[150:151], v[28:29] op_sel:[1,0,0] op_sel_hi:[1,1,1] neg_lo:[1,0,0] neg_hi:[1,0,0]
  v_pk_fma_f32 v[44:45], v[10:11], v[148:149], v[44:45] op_sel:[1,0,0] op_sel_hi:[1,1,1]
  v_cvt_pk_bf16_f32 v216, v28, v29
  v_cvt_pk_bf16_f32 v217, -v44, -v45
  v_pk_fma_f32 v[30:31], v[10:11], v[28:29], v[30:31] op_sel:[0,0,0] op_sel_hi:[0,1,1]
  v_pk_fma_f32 v[46:47], v[10:11], v[44:45], v[46:47] op_sel:[0,0,0] op_sel_hi:[0,1,1]
  v_pk_fma_f32 v[30:31], v[10:11], v[44:45], v[30:31] op_sel:[1,0,0] op_sel_hi:[1,1,1] neg_lo:[1,0,0] neg_hi:[1,0,0]
  v_pk_fma_f32 v[46:47], v[10:11], v[28:29], v[46:47] op_sel:[1,0,0] op_sel_hi:[1,1,1]
  v_cvt_pk_bf16_f32 v218, v30, v31
  v_cvt_pk_bf16_f32 v219, -v46, -v47
  v_pk_fma_f32 v[32:33], v[10:11], v[30:31], v[32:33] op_sel:[0,0,0] op_sel_hi:[0,1,1]
  v_pk_fma_f32 v[48:49], v[10:11], v[46:47], v[48:49] op_sel:[0,0,0] op_sel_hi:[0,1,1]
  v_pk_fma_f32 v[32:33], v[10:11], v[46:47], v[32:33] op_sel:[1,0,0] op_sel_hi:[1,1,1] neg_lo:[1,0,0] neg_hi:[1,0,0]
  v_pk_fma_f32 v[48:49], v[10:11], v[30:31], v[48:49] op_sel:[1,0,0] op_sel_hi:[1,1,1]
  v_permlane32_swap_b32 v216, v217
  v_permlane32_swap_b32 v218, v219
  s_nop 1
  v_permlane16_swap_b32 v216, v218
  v_permlane16_swap_b32 v217, v219
  buffer_store_dwordx4 v[216:219], v18, s[44:47], s43 offen sc1
  s_add_u32 s43, s43, 1048576
  v_cvt_pk_bf16_f32 v220, v32, v33
  v_cvt_pk_bf16_f32 v221, -v48, -v49
  v_pk_fma_f32 v[34:35], v[10:11], v[32:33], v[34:35] op_sel:[0,0,0] op_sel_hi:[0,1,1]
  v_pk_fma_f32 v[50:51], v[10:11], v[48:49], v[50:51] op_sel:[0,0,0] op_sel_hi:[0,1,1]
  v_pk_fma_f32 v[34:35], v[10:11], v[48:49], v[34:35] op_sel:[1,0,0] op_sel_hi:[1,1,1] neg_lo:[1,0,0] neg_hi:[1,0,0]
  v_pk_fma_f32 v[50:51], v[10:11], v[32:33], v[50:51] op_sel:[1,0,0] op_sel_hi:[1,1,1]
  v_cvt_pk_bf16_f32 v222, v34, v35
  v_cvt_pk_bf16_f32 v223, -v50, -v51
  v_pk_fma_f32 v[36:37], v[10:11], v[34:35], v[36:37] op_sel:[0,0,0] op_sel_hi:[0,1,1]
  v_pk_fma_f32 v[52:53], v[10:11], v[50:51], v[52:53] op_sel:[0,0,0] op_sel_hi:[0,1,1]
  v_pk_fma_f32 v[36:37], v[10:11], v[50:51], v[36:37] op_sel:[1,0,0] op_sel_hi:[1,1,1] neg_lo:[1,0,0] neg_hi:[1,0,0]
  v_pk_fma_f32 v[52:53], v[10:11], v[34:35], v[52:53] op_sel:[1,0,0] op_sel_hi:[1,1,1]
  v_permlane32_swap_b32 v220, v221
  v_permlane32_swap_b32 v222, v223
  s_nop 1
  v_permlane16_swap_b32 v220, v222
  v_permlane16_swap_b32 v221, v223
  buffer_store_dwordx4 v[220:223], v18, s[44:47], s43 offen sc1
  s_add_u32 s43, s43, 1048576
  v_cvt_pk_bf16_f32 v224, v36, v37
  v_cvt_pk_bf16_f32 v225, -v52, -v53
  v_pk_fma_f32 v[38:39], v[10:11], v[36:37], v[38:39] op_sel:[0,0,0] op_sel_hi:[0,1,1]
  v_pk_fma_f32 v[54:55], v[10:11], v[52:53], v[54:55] op_sel:[0,0,0] op_sel_hi:[0,1,1]
  v_pk_fma_f32 v[38:39], v[10:11], v[52:53], v[38:39] op_sel:[1,0,0] op_sel_hi:[1,1,1] neg_lo:[1,0,0] neg_hi:[1,0,0]
  v_pk_fma_f32 v[54:55], v[10:11], v[36:37], v[54:55] op_sel:[1,0,0] op_sel_hi:[1,1,1]
  v_cvt_pk_bf16_f32 v226, v38, v39
  v_cvt_pk_bf16_f32 v227, -v54, -v55
  v_pk_fma_f32 v[40:41], v[10:11], v[38:39], v[40:41] op_sel:[0,0,0] op_sel_hi:[0,1,1]
  v_pk_fma_f32 v[56:57], v[10:11], v[54:55], v[56:57] op_sel:[0,0,0] op_sel_hi:[0,1,1]
  v_pk_fma_f32 v[40:41], v[10:11], v[54:55], v[40:41] op_sel:[1,0,0] op_sel_hi:[1,1,1] neg_lo:[1,0,0] neg_hi:[1,0,0]
  v_pk_fma_f32 v[56:57], v[10:11], v[38:39], v[56:57] op_sel:[1,0,0] op_sel_hi:[1,1,1]
  v_permlane32_swap_b32 v224, v225
  v_permlane32_swap_b32 v226, v227
  s_nop 1
  v_permlane16_swap_b32 v224, v226
  v_permlane16_swap_b32 v225, v227
  buffer_store_dwordx4 v[224:227], v18, s[44:47], s43 offen sc1
  s_add_u32 s43, s43, 1048576
  v_cvt_pk_bf16_f32 v228, v40, v41
  v_cvt_pk_bf16_f32 v229, -v56, -v57
  v_pk_fma_f32 v[42:43], v[10:11], v[40:41], v[42:43] op_sel:[0,0,0] op_sel_hi:[0,1,1]
  v_pk_fma_f32 v[58:59], v[10:11], v[56:57], v[58:59] op_sel:[0,0,0] op_sel_hi:[0,1,1]
  v_pk_fma_f32 v[42:43], v[10:11], v[56:57], v[42:43] op_sel:[1,0,0] op_sel_hi:[1,1,1] neg_lo:[1,0,0] neg_hi:[1,0,0]
  v_pk_fma_f32 v[58:59], v[10:11], v[40:41], v[58:59] op_sel:[1,0,0] op_sel_hi:[1,1,1]
  v_cvt_pk_bf16_f32 v230, v42, v43
  v_cvt_pk_bf16_f32 v231, -v58, -v59
  v_pk_fma_f32 v[60:61], v[10:11], v[42:43], v[60:61] op_sel:[0,0,0] op_sel_hi:[0,1,1]
  v_pk_fma_f32 v[76:77], v[10:11], v[58:59], v[76:77] op_sel:[0,0,0] op_sel_hi:[0,1,1]
  v_pk_fma_f32 v[60:61], v[10:11], v[58:59], v[60:61] op_sel:[1,0,0] op_sel_hi:[1,1,1] neg_lo:[1,0,0] neg_hi:[1,0,0]
  v_pk_fma_f32 v[76:77], v[10:11], v[42:43], v[76:77] op_sel:[1,0,0] op_sel_hi:[1,1,1]
  v_permlane32_swap_b32 v228, v229
  v_permlane32_swap_b32 v230, v231
  s_nop 1
  v_permlane16_swap_b32 v228, v230
  v_permlane16_swap_b32 v229, v231
  buffer_store_dwordx4 v[228:231], v18, s[44:47], s43 offen sc1
  s_add_u32 s43, s43, 1048576
  v_cvt_pk_bf16_f32 v232, v60, v61
  v_cvt_pk_bf16_f32 v233, -v76, -v77
  v_pk_fma_f32 v[62:63], v[10:11], v[60:61], v[62:63] op_sel:[0,0,0] op_sel_hi:[0,1,1]
  v_pk_fma_f32 v[78:79], v[10:11], v[76:77], v[78:79] op_sel:[0,0,0] op_sel_hi:[0,1,1]
  v_pk_fma_f32 v[62:63], v[10:11], v[76:77], v[62:63] op_sel:[1,0,0] op_sel_hi:[1,1,1] neg_lo:[1,0,0] neg_hi:[1,0,0]
  v_pk_fma_f32 v[78:79], v[10:11], v[60:61], v[78:79] op_sel:[1,0,0] op_sel_hi:[1,1,1]
  v_cvt_pk_bf16_f32 v234, v62, v63
  v_cvt_pk_bf16_f32 v235, -v78, -v79
  v_pk_fma_f32 v[64:65], v[10:11], v[62:63], v[64:65] op_sel:[0,0,0] op_sel_hi:[0,1,1]
  v_pk_fma_f32 v[80:81], v[10:11], v[78:79], v[80:81] op_sel:[0,0,0] op_sel_hi:[0,1,1]
  v_pk_fma_f32 v[64:65], v[10:11], v[78:79], v[64:65] op_sel:[1,0,0] op_sel_hi:[1,1,1] neg_lo:[1,0,0] neg_hi:[1,0,0]
  v_pk_fma_f32 v[80:81], v[10:11], v[62:63], v[80:81] op_sel:[1,0,0] op_sel_hi:[1,1,1]
  v_permlane32_swap_b32 v232, v233
  v_permlane32_swap_b32 v234, v235
  s_nop 1
  v_permlane16_swap_b32 v232, v234
  v_permlane16_swap_b32 v233, v235
  buffer_store_dwordx4 v[232:235], v18, s[44:47], s43 offen sc1
  s_add_u32 s43, s43, 1048576
  v_cvt_pk_bf16_f32 v236, v64, v65
  v_cvt_pk_bf16_f32 v237, -v80, -v81
  v_pk_fma_f32 v[66:67], v[10:11], v[64:65], v[66:67] op_sel:[0,0,0] op_sel_hi:[0,1,1]
  v_pk_fma_f32 v[82:83], v[10:11], v[80:81], v[82:83] op_sel:[0,0,0] op_sel_hi:[0,1,1]
  v_pk_fma_f32 v[66:67], v[10:11], v[80:81], v[66:67] op_sel:[1,0,0] op_sel_hi:[1,1,1] neg_lo:[1,0,0] neg_hi:[1,0,0]
  v_pk_fma_f32 v[82:83], v[10:11], v[64:65], v[82:83] op_sel:[1,0,0] op_sel_hi:[1,1,1]
  v_cvt_pk_bf16_f32 v238, v66, v67
  v_cvt_pk_bf16_f32 v239, -v82, -v83
  v_pk_fma_f32 v[68:69], v[10:11], v[66:67], v[68:69] op_sel:[0,0,0] op_sel_hi:[0,1,1]
  v_pk_fma_f32 v[84:85], v[10:11], v[82:83], v[84:85] op_sel:[0,0,0] op_sel_hi:[0,1,1]
  v_pk_fma_f32 v[68:69], v[10:11], v[82:83], v[68:69] op_sel:[1,0,0] op_sel_hi:[1,1,1] neg_lo:[1,0,0] neg_hi:[1,0,0]
  v_pk_fma_f32 v[84:85], v[10:11], v[66:67], v[84:85] op_sel:[1,0,0] op_sel_hi:[1,1,1]
  v_permlane32_swap_b32 v236, v237
  v_permlane32_swap_b32 v238, v239
  s_nop 1
  v_permlane16_swap_b32 v236, v238
  v_permlane16_swap_b32 v237, v239
  buffer_store_dwordx4 v[236:239], v18, s[44:47], s43 offen sc1
  s_add_u32 s43, s43, 1048576
  v_cvt_pk_bf16_f32 v216, v68, v69
  v_cvt_pk_bf16_f32 v217, -v84, -v85
  v_pk_fma_f32 v[70:71], v[10:11], v[68:69], v[70:71] op_sel:[0,0,0] op_sel_hi:[0,1,1]
  v_pk_fma_f32 v[86:87], v[10:11], v[84:85], v[86:87] op_sel:[0,0,0] op_sel_hi:[0,1,1]
  v_pk_fma_f32 v[70:71], v[10:11], v[84:85], v[70:71] op_sel:[1,0,0] op_sel_hi:[1,1,1] neg_lo:[1,0,0] neg_hi:[1,0,0]
  v_pk_fma_f32 v[86:87], v[10:11], v[68:69], v[86:87] op_sel:[1,0,0] op_sel_hi:[1,1,1]
  v_cvt_pk_bf16_f32 v218, v70, v71
  v_cvt_pk_bf16_f32 v219, -v86, -v87
  v_pk_fma_f32 v[72:73], v[10:11], v[70:71], v[72:73] op_sel:[0,0,0] op_sel_hi:[0,1,1]
  v_pk_fma_f32 v[88:89], v[10:11], v[86:87], v[88:89] op_sel:[0,0,0] op_sel_hi:[0,1,1]
  v_pk_fma_f32 v[72:73], v[10:11], v[86:87], v[72:73] op_sel:[1,0,0] op_sel_hi:[1,1,1] neg_lo:[1,0,0] neg_hi:[1,0,0]
  v_pk_fma_f32 v[88:89], v[10:11], v[70:71], v[88:89] op_sel:[1,0,0] op_sel_hi:[1,1,1]
  v_permlane32_swap_b32 v216, v217
  v_permlane32_swap_b32 v218, v219
  s_nop 1
  v_permlane16_swap_b32 v216, v218
  v_permlane16_swap_b32 v217, v219
  buffer_store_dwordx4 v[216:219], v18, s[44:47], s43 offen sc1
  s_add_u32 s43, s43, 1048576
  v_cvt_pk_bf16_f32 v220, v72, v73
  v_cvt_pk_bf16_f32 v221, -v88, -v89
  v_pk_fma_f32 v[74:75], v[10:11], v[72:73], v[74:75] op_sel:[0,0,0] op_sel_hi:[0,1,1]
  v_pk_fma_f32 v[90:91], v[10:11], v[88:89], v[90:91] op_sel:[0,0,0] op_sel_hi:[0,1,1]
  v_pk_fma_f32 v[74:75], v[10:11], v[88:89], v[74:75] op_sel:[1,0,0] op_sel_hi:[1,1,1] neg_lo:[1,0,0] neg_hi:[1,0,0]
  v_pk_fma_f32 v[90:91], v[10:11], v[72:73], v[90:91] op_sel:[1,0,0] op_sel_hi:[1,1,1]
  v_cvt_pk_bf16_f32 v222, v74, v75
  v_cvt_pk_bf16_f32 v223, -v90, -v91
  v_permlane32_swap_b32 v220, v221
  s_nop 0
  v_permlane32_swap_b32 v222, v223
  s_nop 1
  v_permlane16_swap_b32 v220, v222
  v_permlane16_swap_b32 v221, v223
  buffer_store_dwordx4 v[220:223], v18, s[44:47], s43 offen sc1
  ds_read_b128 a[96:99], v144 offset:49152
  ds_read_b128 a[100:103], v145 offset:49152
  ds_read_b128 a[104:107], v144 offset:51200
  ds_read_b128 a[108:111], v145 offset:51200
  ds_read_b128 a[112:115], v144 offset:0
  ds_read_b128 a[116:119], v145 offset:0
  ds_read_b128 a[120:123], v144 offset:2048
  ds_read_b128 a[124:127], v145 offset:2048
  ds_read_b128 a[128:131], v146 offset:0
  ds_read_b128 a[132:135], v147 offset:0
  ds_read_b128 a[136:139], v146 offset:2048
  ds_read_b128 a[140:143], v147 offset:2048
  s_add_u32 s52, s34, 5242880
  s_addc_u32 s53, s35, 0
  s_mov_b32 s54, 4194304
  s_mov_b32 s55, 0x20000
  v_mov_b32 v12, v20
  v_mov_b32 v13, v24
  v_mov_b32 v14, v92
  v_mov_b32 v15, v96
  v_mov_b32 v16, v21
  v_mov_b32 v17, v25
  v_mov_b32 v18, v93
  v_mov_b32 v19, v97
  v_mov_b32 v28, v22
  v_mov_b32 v29, v26
  v_mov_b32 v30, v94
  v_mov_b32 v31, v98
  v_mov_b32 v32, v23
  v_mov_b32 v33, v27
  v_mov_b32 v34, v95
  v_mov_b32 v35, v99
  v_mfma_f32_16x16x32_bf16 v[36:39], v[12:15], v[152:155], 0
  v_mfma_f32_16x16x32_bf16 v[40:43], v[12:15], v[156:159], 0
  v_mfma_f32_16x16x32_bf16 v[44:47], v[16:19], v[152:155], 0
  v_mfma_f32_16x16x32_bf16 v[48:51], v[16:19], v[156:159], 0
  v_mfma_f32_16x16x32_bf16 v[52:55], v[28:31], v[152:155], 0
  v_mfma_f32_16x16x32_bf16 v[56:59], v[28:31], v[156:159], 0
  v_mfma_f32_16x16x32_bf16 v[60:63], v[32:35], v[152:155], 0
  v_mfma_f32_16x16x32_bf16 v[64:67], v[32:35], v[156:159], 0
  v_and_b32 v80, 7, v5
  v_lshlrev_b32 v10, 2, v6
  v_xor_b32 v80, v80, v10
  v_lshlrev_b32 v80, 4, v80
  v_lshl_or_b32 v80, v5, 10, v80
  s_lshl_b32 s43, s3, 8
  s_add_u32 s43, s43, 114688
  v_add_u32 v80, s43, v80
  v_xor_b32 v81, 16, v80
  v_xor_b32 v82, 32, v80
  v_xor_b32 v83, 48, v80
  v_cvt_pk_bf16_f32 v12, v36, v40
  v_cvt_pk_bf16_f32 v13, v37, v41
  v_cvt_pk_bf16_f32 v14, v38, v42
  v_cvt_pk_bf16_f32 v15, v39, v43
  ds_write_b128 v80, v[12:15]
  v_cvt_pk_bf16_f32 v16, v44, v48
  v_cvt_pk_bf16_f32 v17, v45, v49
  v_cvt_pk_bf16_f32 v18, v46, v50
  v_cvt_pk_bf16_f32 v19, v47, v51
  ds_write_b128 v81, v[16:19]
  v_cvt_pk_bf16_f32 v28, v52, v56
  v_cvt_pk_bf16_f32 v29, v53, v57
  v_cvt_pk_bf16_f32 v30, v54, v58
  v_cvt_pk_bf16_f32 v31, v55, v59
  ds_write_b128 v82, v[28:31]
  v_cvt_pk_bf16_f32 v32, v60, v64
  v_cvt_pk_bf16_f32 v33, v61, v65
  v_cvt_pk_bf16_f32 v34, v62, v66
  v_cvt_pk_bf16_f32 v35, v63, v67
  ds_write_b128 v83, v[32:35]
  s_and_b32 s43, s3, 1
  s_lshl_b32 s43, s43, 2
  v_xor_b32 v10, s43, v4
  s_lshl_b32 s43, s3, 12
  s_add_u32 s43, s43, 114688
  v_lshl_add_u32 v80, v10, 4, s43
  v_xor_b32 v81, 16, v80
  v_xor_b32 v82, 32, v80
  v_xor_b32 v83, 48, v80
  s_waitcnt vmcnt(0)
  s_waitcnt lgkmcnt(0)
  s_barrier
  ds_read_b128 v[12:15], v80 offset:0
  ds_read_b128 v[16:19], v81 offset:1024
  ds_read_b128 v[28:31], v82 offset:2048
  ds_read_b128 v[32:35], v83 offset:3072
  s_cmp_lg_u32 s3, 0
  s_cbranch_scc1 gated_mix__spectral_gfnet__ssm_conv_s5__prompt_kernel_skip20
  s_mov_b64 exec, 1
  buffer_store_dword v2, v8, s[48:51], s37 offen sc1
  s_mov_b64 exec, -1
gated_mix__spectral_gfnet__ssm_conv_s5__prompt_kernel_skip20:
  s_waitcnt lgkmcnt(3)
  v_mfma_f32_16x16x32_bf16 v[36:39], v[12:15], v[168:171], 0
  v_mfma_f32_16x16x32_bf16 v[40:43], v[12:15], v[172:175], 0
  s_add_u32 m0, s76, 16384
  s_nop 0
  buffer_load_dwordx4 v140, s[72:75], s63 offen offset:0 lds
  buffer_load_dwordx4 v141, s[72:75], s63 offen offset:1024 lds
  s_waitcnt lgkmcnt(2)
  v_mfma_f32_16x16x32_bf16 v[44:47], v[16:19], v[168:171], 0
  v_mfma_f32_16x16x32_bf16 v[48:51], v[16:19], v[172:175], 0
  buffer_load_dwordx4 v142, s[72:75], s63 offen offset:2048 lds
  buffer_load_dwordx4 v143, s[72:75], s63 offen offset:3072 lds
  s_add_u32 s63, s63, 128
  s_and_b32 s63, s63, 0x7ff
  s_waitcnt lgkmcnt(1)
  v_mfma_f32_16x16x32_bf16 v[52:55], v[28:31], v[168:171], 0
  v_mfma_f32_16x16x32_bf16 v[56:59], v[28:31], v[172:175], 0
  s_add_u32 m0, s76, 81920
  s_nop 0
  buffer_load_dwordx4 v140, s[72:75], s63 offen offset:0 lds
  buffer_load_dwordx4 v141, s[72:75], s63 offen offset:1024 lds
  s_waitcnt lgkmcnt(0)
  v_mfma_f32_16x16x32_bf16 v[60:63], v[32:35], v[168:171], 0
  v_mfma_f32_16x16x32_bf16 v[64:67], v[32:35], v[172:175], 0
  buffer_load_dwordx4 v142, s[72:75], s63 offen offset:2048 lds
  buffer_load_dwordx4 v143, s[72:75], s63 offen offset:3072 lds
  s_add_u32 s63, s63, 128
  s_and_b32 s63, s63, 0x7ff
  v_pk_mul_f32 v[68:69], v[36:37], v[176:177]
  v_pk_mul_f32 v[70:71], v[40:41], v[176:177]
  v_pk_fma_f32 v[68:69], v[40:41], v[180:181], v[68:69]
  v_pk_fma_f32 v[70:71], v[36:37], v[180:181], v[70:71] neg_lo:[0,1,0] neg_hi:[0,1,0]
  v_cvt_pk_bf16_f32 v12, v68, v70
  v_cvt_pk_bf16_f32 v13, v69, v71
  v_pk_mul_f32 v[68:69], v[38:39], v[178:179]
  v_pk_mul_f32 v[70:71], v[42:43], v[178:179]
  v_pk_fma_f32 v[68:69], v[42:43], v[182:183], v[68:69]
  v_pk_fma_f32 v[70:71], v[38:39], v[182:183], v[70:71] neg_lo:[0,1,0] neg_hi:[0,1,0]
  v_cvt_pk_bf16_f32 v14, v68, v70
  v_cvt_pk_bf16_f32 v15, v69, v71
  s_add_u32 m0, s76, 32768
  s_nop 0
  buffer_load_dwordx4 v140, s[72:75], s63 offen offset:0 lds
  buffer_load_dwordx4 v141, s[72:75], s63 offen offset:1024 lds
  v_pk_mul_f32 v[68:69], v[44:45], v[176:177]
  v_pk_mul_f32 v[70:71], v[48:49], v[176:177]
  v_pk_fma_f32 v[68:69], v[48:49], v[180:181], v[68:69]
  v_pk_fma_f32 v[70:71], v[44:45], v[180:181], v[70:71] neg_lo:[0,1,0] neg_hi:[0,1,0]
  v_cvt_pk_bf16_f32 v16, v68, v70
  v_cvt_pk_bf16_f32 v17, v69, v71
  v_pk_mul_f32 v[68:69], v[46:47], v[178:179]
  v_pk_mul_f32 v[70:71], v[50:51], v[178:179]
  v_pk_fma_f32 v[68:69], v[50:51], v[182:183], v[68:69]
  v_pk_fma_f32 v[70:71], v[46:47], v[182:183], v[70:71] neg_lo:[0,1,0] neg_hi:[0,1,0]
  v_cvt_pk_bf16_f32 v18, v68, v70
  v_cvt_pk_bf16_f32 v19, v69, v71
  buffer_load_dwordx4 v142, s[72:75], s63 offen offset:2048 lds
  buffer_load_dwordx4 v143, s[72:75], s63 offen offset:3072 lds
  s_add_u32 s63, s63, 128
  s_and_b32 s63, s63, 0x7ff
  v_pk_mul_f32 v[68:69], v[52:53], v[176:177]
  v_pk_mul_f32 v[70:71], v[56:57], v[176:177]
  v_pk_fma_f32 v[68:69], v[56:57], v[180:181], v[68:69]
  v_pk_fma_f32 v[70:71], v[52:53], v[180:181], v[70:71] neg_lo:[0,1,0] neg_hi:[0,1,0]
  v_cvt_pk_bf16_f32 v28, v68, v70
  v_cvt_pk_bf16_f32 v29, v69, v71
  v_pk_mul_f32 v[68:69], v[54:55], v[178:179]
  v_pk_mul_f32 v[70:71], v[58:59], v[178:179]
  v_pk_fma_f32 v[68:69], v[58:59], v[182:183], v[68:69]
  v_pk_fma_f32 v[70:71], v[54:55], v[182:183], v[70:71] neg_lo:[0,1,0] neg_hi:[0,1,0]
  v_cvt_pk_bf16_f32 v30, v68, v70
  v_cvt_pk_bf16_f32 v31, v69, v71
  s_add_u32 m0, s76, 98304
  s_nop 0
  buffer_load_dwordx4 v140, s[72:75], s63 offen offset:0 lds
  buffer_load_dwordx4 v141, s[72:75], s63 offen offset:1024 lds
  v_pk_mul_f32 v[68:69], v[60:61], v[176:177]
  v_pk_mul_f32 v[70:71], v[64:65], v[176:177]
  v_pk_fma_f32 v[68:69], v[64:65], v[180:181], v[68:69]
  v_pk_fma_f32 v[70:71], v[60:61], v[180:181], v[70:71] neg_lo:[0,1,0] neg_hi:[0,1,0]
  v_cvt_pk_bf16_f32 v32, v68, v70
  v_cvt_pk_bf16_f32 v33, v69, v71
  v_pk_mul_f32 v[68:69], v[62:63], v[178:179]
  v_pk_mul_f32 v[70:71], v[66:67], v[178:179]
  v_pk_fma_f32 v[68:69], v[66:67], v[182:183], v[68:69]
  v_pk_fma_f32 v[70:71], v[62:63], v[182:183], v[70:71] neg_lo:[0,1,0] neg_hi:[0,1,0]
  v_cvt_pk_bf16_f32 v34, v68, v70
  v_cvt_pk_bf16_f32 v35, v69, v71
  buffer_load_dwordx4 v142, s[72:75], s63 offen offset:2048 lds
  buffer_load_dwordx4 v143, s[72:75], s63 offen offset:3072 lds
  s_add_u32 s63, s63, 128
  s_and_b32 s63, s63, 0x7ff
  v_mfma_f32_16x16x32_bf16 v[36:39], v[200:203], v[12:15], 0
  v_mfma_f32_16x16x32_bf16 v[40:43], v[204:207], v[12:15], 0
  s_add_u32 m0, s76, 49152
  s_nop 0
  buffer_load_dwordx4 v140, s[72:75], s63 offen offset:0 lds
  buffer_load_dwordx4 v141, s[72:75], s63 offen offset:1024 lds
  v_mfma_f32_16x16x32_bf16 v[44:47], v[200:203], v[16:19], 0
  v_mfma_f32_16x16x32_bf16 v[48:51], v[204:207], v[16:19], 0
  buffer_load_dwordx4 v142, s[72:75], s63 offen offset:2048 lds
  buffer_load_dwordx4 v143, s[72:75], s63 offen offset:3072 lds
  s_add_u32 s63, s63, 128
  s_and_b32 s63, s63, 0x7ff
  v_mfma_f32_16x16x32_bf16 v[52:55], v[200:203], v[28:31], 0
  v_mfma_f32_16x16x32_bf16 v[56:59], v[204:207], v[28:31], 0
  s_add_u32 m0, s76, 0
  s_nop 0
  buffer_load_dwordx4 v140, s[72:75], s63 offen offset:0 lds
  buffer_load_dwordx4 v141, s[72:75], s63 offen offset:1024 lds
  v_mfma_f32_16x16x32_bf16 v[60:63], v[200:203], v[32:35], 0
  v_mfma_f32_16x16x32_bf16 v[64:67], v[204:207], v[32:35], 0
  buffer_load_dwordx4 v142, s[72:75], s63 offen offset:2048 lds
  buffer_load_dwordx4 v143, s[72:75], s63 offen offset:3072 lds
  s_add_u32 s63, s63, 128
  s_and_b32 s63, s63, 0x7ff
  s_cmp_eq_u32 s79, 0
  s_cbranch_scc1 gated_mix__spectral_gfnet__ssm_conv_s5__prompt_kernel_skip21
  v_lshlrev_b32 v72, 16, v124
  v_and_b32 v76, 0xffff0000, v124
  v_lshlrev_b32 v73, 16, v125
  v_and_b32 v77, 0xffff0000, v125
  v_lshlrev_b32 v74, 16, v126
  v_and_b32 v78, 0xffff0000, v126
  v_lshlrev_b32 v75, 16, v127
  v_and_b32 v79, 0xffff0000, v127
  v_pk_mul_f32 v[68:69], v[36:37], v[72:73]
  v_pk_mul_f32 v[70:71], v[40:41], v[72:73]
  v_pk_fma_f32 v[68:69], v[40:41], v[76:77], v[68:69] neg_lo:[0,1,0] neg_hi:[0,1,0]
  v_pk_fma_f32 v[70:71], v[36:37], v[76:77], v[70:71]
  v_cvt_pk_bf16_f32 v92, v68, v70
  v_cvt_pk_bf16_f32 v93, v69, v71
  v_pk_mul_f32 v[68:69], v[38:39], v[74:75]
  v_pk_mul_f32 v[70:71], v[42:43], v[74:75]
  v_pk_fma_f32 v[68:69], v[42:43], v[78:79], v[68:69] neg_lo:[0,1,0] neg_hi:[0,1,0]
  v_pk_fma_f32 v[70:71], v[38:39], v[78:79], v[70:71]
  v_cvt_pk_bf16_f32 v94, v68, v70
  v_cvt_pk_bf16_f32 v95, v69, v71
  s_nop 1
  v_mfma_f32_16x16x32_bf16 v[20:23], v[92:95], v[208:211], 0
  v_mfma_f32_16x16x32_bf16 v[24:27], v[92:95], v[212:215], 0
  s_nop 6
  v_pk_mul_f32 v[68:69], v[20:21], v[192:193]
  v_pk_mul_f32 v[70:71], v[24:25], v[192:193]
  v_pk_fma_f32 v[68:69], v[24:25], v[196:197], v[68:69] neg_lo:[0,1,0] neg_hi:[0,1,0]
  v_pk_fma_f32 v[70:71], v[20:21], v[196:197], v[70:71]
  v_cvt_pk_bf16_f32 v92, v68, v70
  v_cvt_pk_bf16_f32 v93, v69, v71
  v_pk_mul_f32 v[68:69], v[22:23], v[194:195]
  v_pk_mul_f32 v[70:71], v[26:27], v[194:195]
  v_pk_fma_f32 v[68:69], v[26:27], v[198:199], v[68:69] neg_lo:[0,1,0] neg_hi:[0,1,0]
  v_pk_fma_f32 v[70:71], v[22:23], v[198:199], v[70:71]
  v_cvt_pk_bf16_f32 v94, v68, v70
  v_cvt_pk_bf16_f32 v95, v69, v71
  s_nop 1
  v_mfma_f32_16x16x32_bf16 v[20:23], v[184:187], v[92:95], 0
  v_mfma_f32_16x16x32_bf16 v[24:27], v[188:191], v[92:95], 0
gated_mix__spectral_gfnet__ssm_conv_s5__prompt_kernel_skip21:
  v_lshlrev_b32 v72, 16, v100
  v_and_b32 v76, 0xffff0000, v100
  v_lshlrev_b32 v73, 16, v101
  v_and_b32 v77, 0xffff0000, v101
  v_lshlrev_b32 v74, 16, v102
  v_and_b32 v78, 0xffff0000, v102
  v_lshlrev_b32 v75, 16, v103
  v_and_b32 v79, 0xffff0000, v103
  v_pk_mul_f32 v[68:69], v[36:37], v[72:73]
  v_pk_mul_f32 v[70:71], v[40:41], v[72:73]
  v_pk_fma_f32 v[68:69], v[40:41], v[76:77], v[68:69] neg_lo:[0,1,0] neg_hi:[0,1,0]
  v_pk_fma_f32 v[70:71], v[36:37], v[76:77], v[70:71]
  v_cvt_pk_bf16_f32 v12, v68, v70
  v_cvt_pk_bf16_f32 v13, v69, v71
  v_pk_mul_f32 v[68:69], v[38:39], v[74:75]
  v_pk_mul_f32 v[70:71], v[42:43], v[74:75]
  v_pk_fma_f32 v[68:69], v[42:43], v[78:79], v[68:69] neg_lo:[0,1,0] neg_hi:[0,1,0]
  v_pk_fma_f32 v[70:71], v[38:39], v[78:79], v[70:71]
  v_cvt_pk_bf16_f32 v14, v68, v70
  v_cvt_pk_bf16_f32 v15, v69, v71
  s_add_u32 m0, s76, 65536
  s_nop 0
  buffer_load_dwordx4 v140, s[72:75], s63 offen offset:0 lds
  buffer_load_dwordx4 v141, s[72:75], s63 offen offset:1024 lds
  v_lshlrev_b32 v72, 16, v104
  v_and_b32 v76, 0xffff0000, v104
  v_lshlrev_b32 v73, 16, v105
  v_and_b32 v77, 0xffff0000, v105
  v_lshlrev_b32 v74, 16, v106
  v_and_b32 v78, 0xffff0000, v106
  v_lshlrev_b32 v75, 16, v107
  v_and_b32 v79, 0xffff0000, v107
  v_pk_mul_f32 v[68:69], v[44:45], v[72:73]
  v_pk_mul_f32 v[70:71], v[48:49], v[72:73]
  v_pk_fma_f32 v[68:69], v[48:49], v[76:77], v[68:69] neg_lo:[0,1,0] neg_hi:[0,1,0]
  v_pk_fma_f32 v[70:71], v[44:45], v[76:77], v[70:71]
  v_cvt_pk_bf16_f32 v16, v68, v70
  v_cvt_pk_bf16_f32 v17, v69, v71
  v_pk_mul_f32 v[68:69], v[46:47], v[74:75]
  v_pk_mul_f32 v[70:71], v[50:51], v[74:75]
  v_pk_fma_f32 v[68:69], v[50:51], v[78:79], v[68:69] neg_lo:[0,1,0] neg_hi:[0,1,0]
  v_pk_fma_f32 v[70:71], v[46:47], v[78:79], v[70:71]
  v_cvt_pk_bf16_f32 v18, v68, v70
  v_cvt_pk_bf16_f32 v19, v69, v71
  buffer_load_dwordx4 v142, s[72:75], s63 offen offset:2048 lds
  buffer_load_dwordx4 v143, s[72:75], s63 offen offset:3072 lds
  s_add_u32 s63, s63, 128
  s_and_b32 s63, s63, 0x7ff
  v_lshlrev_b32 v72, 16, v108
  v_and_b32 v76, 0xffff0000, v108
  v_lshlrev_b32 v73, 16, v109
  v_and_b32 v77, 0xffff0000, v109
  v_lshlrev_b32 v74, 16, v110
  v_and_b32 v78, 0xffff0000, v110
  v_lshlrev_b32 v75, 16, v111
  v_and_b32 v79, 0xffff0000, v111
  v_pk_mul_f32 v[68:69], v[52:53], v[72:73]
  v_pk_mul_f32 v[70:71], v[56:57], v[72:73]
  v_pk_fma_f32 v[68:69], v[56:57], v[76:77], v[68:69] neg_lo:[0,1,0] neg_hi:[0,1,0]
  v_pk_fma_f32 v[70:71], v[52:53], v[76:77], v[70:71]
  v_cvt_pk_bf16_f32 v28, v68, v70
  v_cvt_pk_bf16_f32 v29, v69, v71
  v_pk_mul_f32 v[68:69], v[54:55], v[74:75]
  v_pk_mul_f32 v[70:71], v[58:59], v[74:75]
  v_pk_fma_f32 v[68:69], v[58:59], v[78:79], v[68:69] neg_lo:[0,1,0] neg_hi:[0,1,0]
  v_pk_fma_f32 v[70:71], v[54:55], v[78:79], v[70:71]
  v_cvt_pk_bf16_f32 v30, v68, v70
  v_cvt_pk_bf16_f32 v31, v69, v71
  v_lshlrev_b32 v72, 16, v112
  v_and_b32 v76, 0xffff0000, v112
  v_lshlrev_b32 v73, 16, v113
  v_and_b32 v77, 0xffff0000, v113
  v_lshlrev_b32 v74, 16, v114
  v_and_b32 v78, 0xffff0000, v114
  v_lshlrev_b32 v75, 16, v115
  v_and_b32 v79, 0xffff0000, v115
  v_pk_mul_f32 v[68:69], v[60:61], v[72:73]
  v_pk_mul_f32 v[70:71], v[64:65], v[72:73]
  v_pk_fma_f32 v[68:69], v[64:65], v[76:77], v[68:69] neg_lo:[0,1,0] neg_hi:[0,1,0]
  v_pk_fma_f32 v[70:71], v[60:61], v[76:77], v[70:71]
  v_cvt_pk_bf16_f32 v32, v68, v70
  v_cvt_pk_bf16_f32 v33, v69, v71
  v_pk_mul_f32 v[68:69], v[62:63], v[74:75]
  v_pk_mul_f32 v[70:71], v[66:67], v[74:75]
  v_pk_fma_f32 v[68:69], v[66:67], v[78:79], v[68:69] neg_lo:[0,1,0] neg_hi:[0,1,0]
  v_pk_fma_f32 v[70:71], v[62:63], v[78:79], v[70:71]
  v_cvt_pk_bf16_f32 v34, v68, v70
  v_cvt_pk_bf16_f32 v35, v69, v71
  v_mfma_f32_16x16x32_bf16 v[36:39], v[12:15], v[208:211], 0
  v_mfma_f32_16x16x32_bf16 v[40:43], v[12:15], v[212:215], 0
  v_mfma_f32_16x16x32_bf16 v[44:47], v[16:19], v[208:211], 0
  v_mfma_f32_16x16x32_bf16 v[48:51], v[16:19], v[212:215], 0
  v_mfma_f32_16x16x32_bf16 v[52:55], v[28:31], v[208:211], 0
  v_mfma_f32_16x16x32_bf16 v[56:59], v[28:31], v[212:215], 0
  v_mfma_f32_16x16x32_bf16 v[60:63], v[32:35], v[208:211], 0
  v_mfma_f32_16x16x32_bf16 v[64:67], v[32:35], v[212:215], 0
  s_nop 0
  v_pk_mul_f32 v[68:69], v[36:37], v[192:193]
  v_pk_mul_f32 v[70:71], v[40:41], v[192:193]
  v_pk_fma_f32 v[68:69], v[40:41], v[196:197], v[68:69] neg_lo:[0,1,0] neg_hi:[0,1,0]
  v_pk_fma_f32 v[70:71], v[36:37], v[196:197], v[70:71]
  v_cvt_pk_bf16_f32 v12, v68, v70
  v_cvt_pk_bf16_f32 v13, v69, v71
  v_pk_mul_f32 v[68:69], v[38:39], v[194:195]
  v_pk_mul_f32 v[70:71], v[42:43], v[194:195]
  v_pk_fma_f32 v[68:69], v[42:43], v[198:199], v[68:69] neg_lo:[0,1,0] neg_hi:[0,1,0]
  v_pk_fma_f32 v[70:71], v[38:39], v[198:199], v[70:71]
  v_cvt_pk_bf16_f32 v14, v68, v70
  v_cvt_pk_bf16_f32 v15, v69, v71
  v_pk_mul_f32 v[68:69], v[44:45], v[192:193]
  v_pk_mul_f32 v[70:71], v[48:49], v[192:193]
  v_pk_fma_f32 v[68:69], v[48:49], v[196:197], v[68:69] neg_lo:[0,1,0] neg_hi:[0,1,0]
  v_pk_fma_f32 v[70:71], v[44:45], v[196:197], v[70:71]
  v_cvt_pk_bf16_f32 v16, v68, v70
  v_cvt_pk_bf16_f32 v17, v69, v71
  v_pk_mul_f32 v[68:69], v[46:47], v[194:195]
  v_pk_mul_f32 v[70:71], v[50:51], v[194:195]
  v_pk_fma_f32 v[68:69], v[50:51], v[198:199], v[68:69] neg_lo:[0,1,0] neg_hi:[0,1,0]
  v_pk_fma_f32 v[70:71], v[46:47], v[198:199], v[70:71]
  v_cvt_pk_bf16_f32 v18, v68, v70
  v_cvt_pk_bf16_f32 v19, v69, v71
  v_pk_mul_f32 v[68:69], v[52:53], v[192:193]
  v_pk_mul_f32 v[70:71], v[56:57], v[192:193]
  v_pk_fma_f32 v[68:69], v[56:57], v[196:197], v[68:69] neg_lo:[0,1,0] neg_hi:[0,1,0]
  v_pk_fma_f32 v[70:71], v[52:53], v[196:197], v[70:71]
  v_cvt_pk_bf16_f32 v28, v68, v70
  v_cvt_pk_bf16_f32 v29, v69, v71
  v_pk_mul_f32 v[68:69], v[54:55], v[194:195]
  v_pk_mul_f32 v[70:71], v[58:59], v[194:195]
  v_pk_fma_f32 v[68:69], v[58:59], v[198:199], v[68:69] neg_lo:[0,1,0] neg_hi:[0,1,0]
  v_pk_fma_f32 v[70:71], v[54:55], v[198:199], v[70:71]
  v_cvt_pk_bf16_f32 v30, v68, v70
  v_cvt_pk_bf16_f32 v31, v69, v71
  v_pk_mul_f32 v[68:69], v[60:61], v[192:193]
  v_pk_mul_f32 v[70:71], v[64:65], v[192:193]
  v_pk_fma_f32 v[68:69], v[64:65], v[196:197], v[68:69] neg_lo:[0,1,0] neg_hi:[0,1,0]
  v_pk_fma_f32 v[70:71], v[60:61], v[196:197], v[70:71]
  v_cvt_pk_bf16_f32 v32, v68, v70
  v_cvt_pk_bf16_f32 v33, v69, v71
  v_pk_mul_f32 v[68:69], v[62:63], v[194:195]
  v_pk_mul_f32 v[70:71], v[66:67], v[194:195]
  v_pk_fma_f32 v[68:69], v[66:67], v[198:199], v[68:69] neg_lo:[0,1,0] neg_hi:[0,1,0]
  v_pk_fma_f32 v[70:71], v[62:63], v[198:199], v[70:71]
  v_cvt_pk_bf16_f32 v34, v68, v70
  v_cvt_pk_bf16_f32 v35, v69, v71
  v_mfma_f32_16x16x32_bf16 v[36:39], v[184:187], v[12:15], 0
  v_mfma_f32_16x16x32_bf16 v[40:43], v[188:191], v[12:15], 0
  v_mfma_f32_16x16x32_bf16 v[44:47], v[184:187], v[16:19], 0
  v_mfma_f32_16x16x32_bf16 v[48:51], v[188:191], v[16:19], 0
  v_mfma_f32_16x16x32_bf16 v[52:55], v[184:187], v[28:31], 0
  v_mfma_f32_16x16x32_bf16 v[56:59], v[188:191], v[28:31], 0
  v_mfma_f32_16x16x32_bf16 v[60:63], v[184:187], v[32:35], 0
  v_mfma_f32_16x16x32_bf16 v[64:67], v[188:191], v[32:35], 0
  s_sub_u32 s43, s79, 1
  s_or_b32 s43, s43, s3
  s_cmp_lg_u32 s43, 0
  s_cbranch_scc1 gated_mix__spectral_gfnet__ssm_conv_s5__prompt_kernel_skip22
  v_mov_b32 v40, v24
  v_mov_b32 v41, v25
  v_mov_b32 v42, v26
  v_mov_b32 v43, v27
gated_mix__spectral_gfnet__ssm_conv_s5__prompt_kernel_skip22:
  v_lshlrev_b32 v10, 12, v6
  v_lshl_add_u32 v10, v5, 4, v10
  s_lshl_b32 s43, s3, 8
  s_add_u32 s43, s43, 147456
  v_add_u32 v10, s43, v10
  v_cvt_pk_bf16_f32 v12, v36, v40
  v_cvt_pk_bf16_f32 v13, v44, v48
  v_cvt_pk_bf16_f32 v14, v52, v56
  v_cvt_pk_bf16_f32 v15, v60, v64
  ds_write_b128 v10, v[12:15] offset:0
  v_cvt_pk_bf16_f32 v16, v37, v41
  v_cvt_pk_bf16_f32 v17, v45, v49
  v_cvt_pk_bf16_f32 v18, v53, v57
  v_cvt_pk_bf16_f32 v19, v61, v65
  ds_write_b128 v10, v[16:19] offset:1024
  v_cvt_pk_bf16_f32 v28, v38, v42
  v_cvt_pk_bf16_f32 v29, v46, v50
  v_cvt_pk_bf16_f32 v30, v54, v58
  v_cvt_pk_bf16_f32 v31, v62, v66
  ds_write_b128 v10, v[28:31] offset:2048
  v_cvt_pk_bf16_f32 v32, v39, v43
  v_cvt_pk_bf16_f32 v33, v47, v51
  v_cvt_pk_bf16_f32 v34, v55, v59
  v_cvt_pk_bf16_f32 v35, v63, v67
  ds_write_b128 v10, v[32:35] offset:3072
  s_lshl_b32 s43, s3, 12
  s_add_u32 s43, s43, 147456
  v_lshl_add_u32 v10, v4, 4, s43
  buffer_load_dword v9, v7, s[48:51], s37 offen sc1
  s_waitcnt lgkmcnt(0)
  s_barrier
  ds_read_b128 v[12:15], v10 offset:0
  ds_read_b128 v[16:19], v10 offset:1024
  ds_read_b128 v[28:31], v10 offset:2048
  ds_read_b128 v[32:35], v10 offset:3072
  s_waitcnt vmcnt(25)
  ds_read_b128 a[144:147], v144 offset:16384
  ds_read_b128 a[148:151], v145 offset:16384
  ds_read_b128 a[152:155], v144 offset:18432
  ds_read_b128 a[156:159], v145 offset:18432
  s_waitcnt vmcnt(21)
  ds_read_b128 a[160:163], v146 offset:16384
  ds_read_b128 a[164:167], v147 offset:16384
  ds_read_b128 a[168:171], v146 offset:18432
  ds_read_b128 a[172:175], v147 offset:18432
  s_waitcnt vmcnt(17)
  ds_read_b128 a[176:179], v144 offset:32768
  ds_read_b128 a[180:183], v145 offset:32768
  ds_read_b128 a[184:187], v144 offset:34816
  ds_read_b128 a[188:191], v145 offset:34816
  s_waitcnt vmcnt(13)
  ds_read_b128 a[192:195], v146 offset:32768
  ds_read_b128 a[196:199], v147 offset:32768
  ds_read_b128 a[200:203], v146 offset:34816
  ds_read_b128 a[204:207], v147 offset:34816
  s_waitcnt vmcnt(9)
  ds_read_b128 a[208:211], v144 offset:49152
  ds_read_b128 a[212:215], v145 offset:49152
  ds_read_b128 a[216:219], v144 offset:51200
  ds_read_b128 a[220:223], v145 offset:51200
  s_waitcnt vmcnt(5)
  ds_read_b128 a[224:227], v144 offset:0
  ds_read_b128 a[228:231], v145 offset:0
  ds_read_b128 a[232:235], v144 offset:2048
  ds_read_b128 a[236:239], v145 offset:2048
  s_waitcnt vmcnt(1)
  ds_read_b128 a[240:243], v146 offset:0
  ds_read_b128 a[244:247], v147 offset:0
  ds_read_b128 a[248:251], v146 offset:2048
  ds_read_b128 a[252:255], v147 offset:2048
  s_waitcnt lgkmcnt(15)
  v_mfma_f32_16x16x32_bf16 v[36:39], v[160:163], v[12:15], 0
  v_mfma_f32_16x16x32_bf16 v[40:43], v[164:167], v[12:15], 0
  s_waitcnt lgkmcnt(15)
  v_mfma_f32_16x16x32_bf16 v[44:47], v[160:163], v[16:19], 0
  v_mfma_f32_16x16x32_bf16 v[48:51], v[164:167], v[16:19], 0
  s_waitcnt lgkmcnt(15)
  v_mfma_f32_16x16x32_bf16 v[52:55], v[160:163], v[28:31], 0
  v_mfma_f32_16x16x32_bf16 v[56:59], v[164:167], v[28:31], 0
  s_waitcnt lgkmcnt(15)
  v_mfma_f32_16x16x32_bf16 v[60:63], v[160:163], v[32:35], 0
  v_mfma_f32_16x16x32_bf16 v[64:67], v[164:167], v[32:35], 0
  s_mov_b32 s43, 1048576
  v_mul_lo_u32 v10, v6, s43
  v_lshl_add_u32 v10, v5, 2, v10
  s_mul_i32 s56, s3, 65536
  s_lshl_b32 s43, s84, 6
  s_add_u32 s56, s56, s43
  v_cvt_pk_bf16_f32 v12, v36, v40
  v_cvt_pk_bf16_f32 v13, v37, v41
  v_cvt_pk_bf16_f32 v14, v38, v42
  v_cvt_pk_bf16_f32 v15, v39, v43
  v_cvt_pk_bf16_f32 v16, v44, v48
  v_cvt_pk_bf16_f32 v17, v45, v49
  v_cvt_pk_bf16_f32 v18, v46, v50
  v_cvt_pk_bf16_f32 v19, v47, v51
  v_cvt_pk_bf16_f32 v28, v52, v56
  v_cvt_pk_bf16_f32 v29, v53, v57
  v_cvt_pk_bf16_f32 v30, v54, v58
  v_cvt_pk_bf16_f32 v31, v55, v59
  v_cvt_pk_bf16_f32 v32, v60, v64
  v_cvt_pk_bf16_f32 v33, v61, v65
  v_cvt_pk_bf16_f32 v34, v62, v66
  v_cvt_pk_bf16_f32 v35, v63, v67
  s_lshr_b32 s58, s3, 1
  s_xor_b32 s58, s58, s3
  s_lshl_b32 s58, s58, 13
  s_lshl_b32 s43, s38, 19
  s_add_u32 s58, s58, s43
  v_lshl_add_u32 v20, v4, 4, s58
  v_add_u32 v21, 4096, v20
  s_lshl_b32 s43, s38, 15
  s_lshl_b32 s57, s3, 13
  v_and_b32 v22, 3, v4
  v_and_b32 v23, 2, v6
  v_xor_b32 v23, v23, v22
  v_lshlrev_b32 v22, 9, v22
  v_lshl_or_b32 v22, v23, 6, v22
  v_bfe_u32 v23, v4, 2, 2
  v_lshl_or_b32 v22, v23, 4, v22
  v_and_b32 v23, 1, v6
  v_lshl_or_b32 v22, v23, 3, v22
  s_and_b32 s58, s3, 1
  s_lshl_b32 s58, s58, 14
  v_add_u32 v24, s58, v22
  v_xor_b32 v25, 64, v24
  v_add_u32 v26, 0x10000, v24
  v_add_u32 v27, 0x10000, v25
  s_waitcnt vmcnt(0)
  v_cmp_ne_u32 vcc, 1, v9
  s_nop 0
  s_cbranch_vccz gated_mix__spectral_gfnet__ssm_conv_s5__prompt_kernel_skip23
  s_mov_b32 s58, 0
gated_mix__spectral_gfnet__ssm_conv_s5__prompt_kernel_poll24:
  s_sleep 2
  buffer_load_dword v9, v7, s[48:51], s37 offen sc1
  s_waitcnt vmcnt(0)
  v_cmp_ne_u32 vcc, 1, v9
  s_nop 0
  s_cbranch_vccz gated_mix__spectral_gfnet__ssm_conv_s5__prompt_kernel_pollout25
  s_add_u32 s58, s58, 1
  s_cmp_lt_u32 s58, 1048576
  s_cbranch_scc1 gated_mix__spectral_gfnet__ssm_conv_s5__prompt_kernel_poll24
gated_mix__spectral_gfnet__ssm_conv_s5__prompt_kernel_pollout25:
gated_mix__spectral_gfnet__ssm_conv_s5__prompt_kernel_skip23:
  s_waitcnt lgkmcnt(0)
  s_barrier
  s_add_u32 m0, s57, 0
  s_nop 0
  buffer_load_dwordx4 v20, s[44:47], s43 offen offset:0 sc1 lds
  buffer_load_dwordx4 v20, s[44:47], s43 offen offset:1024 sc1 lds
  buffer_load_dwordx4 v20, s[44:47], s43 offen offset:2048 sc1 lds
  buffer_load_dwordx4 v20, s[44:47], s43 offen offset:3072 sc1 lds
  s_add_u32 m0, s57, 4096
  s_nop 0
  buffer_load_dwordx4 v21, s[44:47], s43 offen offset:0 sc1 lds
  buffer_load_dwordx4 v21, s[44:47], s43 offen offset:1024 sc1 lds
  buffer_load_dwordx4 v21, s[44:47], s43 offen offset:2048 sc1 lds
  buffer_load_dwordx4 v21, s[44:47], s43 offen offset:3072 sc1 lds
  s_add_u32 s43, s43, 32768
  s_and_b32 s43, s43, 0x7ffff
  s_add_u32 m0, s57, 32768
  s_nop 0
  buffer_load_dwordx4 v20, s[44:47], s43 offen offset:0 sc1 lds
  buffer_load_dwordx4 v20, s[44:47], s43 offen offset:1024 sc1 lds
  buffer_load_dwordx4 v20, s[44:47], s43 offen offset:2048 sc1 lds
  buffer_load_dwordx4 v20, s[44:47], s43 offen offset:3072 sc1 lds
  s_add_u32 m0, s57, 36864
  s_nop 0
  buffer_load_dwordx4 v21, s[44:47], s43 offen offset:0 sc1 lds
  buffer_load_dwordx4 v21, s[44:47], s43 offen offset:1024 sc1 lds
  buffer_load_dwordx4 v21, s[44:47], s43 offen offset:2048 sc1 lds
  buffer_load_dwordx4 v21, s[44:47], s43 offen offset:3072 sc1 lds
  s_add_u32 s43, s43, 32768
  s_and_b32 s43, s43, 0x7ffff
  s_mov_b32 s60, s26
  s_mov_b32 s61, s27
  s_mov_b32 s62, 2048
  s_mov_b32 s63, 0x20000
  v_lshlrev_b32 v9, 4, v6
  s_lshl_b32 s58, s38, 9
  s_and_b32 s59, s3, 1
  s_lshl_b32 s59, s59, 8
  s_add_u32 s58, s58, s59
  buffer_load_dwordx4 v[36:39], v9, s[80:83], s58 offen offset:0 sc1
  buffer_load_dwordx4 v[40:43], v9, s[80:83], s58 offen offset:64 sc1
  buffer_load_dwordx4 v[44:47], v9, s[80:83], s58 offen offset:128 sc1
  buffer_load_dwordx4 v[48:51], v9, s[80:83], s58 offen offset:192 sc1
  v_lshlrev_b32 v9, 1, v5
  s_lshl_b32 s58, s39, 5
  s_lshr_b32 s59, s3, 1
  s_lshl_b32 s59, s59, 10
  s_add_u32 s58, s58, s59
  buffer_load_ushort v22, v9, s[60:63], s58 offen offset:0
  buffer_load_ushort v23, v9, s[60:63], s58 offen offset:512
  v_lshrrev_b32 v117, 1, v6
  v_lshlrev_b32 v117, 3, v117
  v_and_b32 v118, 1, v6
  v_lshl_add_u32 v117, v118, 1, v117
  v_cvt_f32_u32 v116, v117
  v_mul_u32_u24 v120, 0x8000, v118
  v_lshl_or_b32 v120, v120, 16, v120
  s_and_b32 s58, s3, 1
  s_lshl_b32 s58, s58, 6
  s_add_u32 s58, s58, 0
  v_add_u32 v117, s58, v5
  v_cvt_f32_u32 v9, v117
  v_mul_f32 v9, 0x3c000000, v9
  v_mul_f32 v11, v9, v116
  v_fmamk_f32 v117, v9, 0x0, v11
  v_cos_f32 v118, v117
  v_sin_f32 v119, v117
  s_nop 0
  v_cvt_pk_bf16_f32 v52, v118, -v119
  v_xor_b32 v84, v120, v52
  v_fmamk_f32 v117, v9, 0x3f800000, v11
  v_cos_f32 v118, v117
  v_sin_f32 v119, v117
  s_nop 0
  v_cvt_pk_bf16_f32 v53, v118, -v119
  v_cvt_pk_bf16_f32 v85, -v119, -v118
  v_xor_b32 v85, v120, v85
  v_fmamk_f32 v117, v9, 0x40800000, v11
  v_cos_f32 v118, v117
  v_sin_f32 v119, v117
  s_nop 0
  v_cvt_pk_bf16_f32 v54, v118, -v119
  v_xor_b32 v86, v120, v54
  v_fmamk_f32 v117, v9, 0x40a00000, v11
  v_cos_f32 v118, v117
  v_sin_f32 v119, v117
  s_nop 0
  v_cvt_pk_bf16_f32 v55, v118, -v119
  v_cvt_pk_bf16_f32 v87, -v119, -v118
  v_xor_b32 v87, v120, v87
  v_fmamk_f32 v117, v9, 0x41800000, v11
  v_cos_f32 v118, v117
  v_sin_f32 v119, v117
  s_nop 0
  v_cvt_pk_bf16_f32 v56, v118, -v119
  v_xor_b32 v88, v120, v56
  v_fmamk_f32 v117, v9, 0x41880000, v11
  v_cos_f32 v118, v117
  v_sin_f32 v119, v117
  s_nop 0
  v_cvt_pk_bf16_f32 v57, v118, -v119
  v_cvt_pk_bf16_f32 v89, -v119, -v118
  v_xor_b32 v89, v120, v89
  v_fmamk_f32 v117, v9, 0x41a00000, v11
  v_cos_f32 v118, v117
  v_sin_f32 v119, v117
  s_nop 0
  v_cvt_pk_bf16_f32 v58, v118, -v119
  v_xor_b32 v90, v120, v58
  v_fmamk_f32 v117, v9, 0x41a80000, v11
  v_cos_f32 v118, v117
  v_sin_f32 v119, v117
  s_nop 0
  v_cvt_pk_bf16_f32 v59, v118, -v119
  v_cvt_pk_bf16_f32 v91, -v119, -v118
  v_xor_b32 v91, v120, v91
  v_fmamk_f32 v117, v9, 0x42000000, v11
  v_cos_f32 v118, v117
  v_sin_f32 v119, v117
  s_nop 0
  v_cvt_pk_bf16_f32 v60, v118, -v119
  v_xor_b32 v92, v120, v60
  v_fmamk_f32 v117, v9, 0x42040000, v11
  v_cos_f32 v118, v117
  v_sin_f32 v119, v117
  s_nop 0
  v_cvt_pk_bf16_f32 v61, v118, -v119
  v_cvt_pk_bf16_f32 v93, -v119, -v118
  v_xor_b32 v93, v120, v93
  v_fmamk_f32 v117, v9, 0x42100000, v11
  v_cos_f32 v118, v117
  v_sin_f32 v119, v117
  s_nop 0
  v_cvt_pk_bf16_f32 v62, v118, -v119
  v_xor_b32 v94, v120, v62
  v_fmamk_f32 v117, v9, 0x42140000, v11
  v_cos_f32 v118, v117
  v_sin_f32 v119, v117
  s_nop 0
  v_cvt_pk_bf16_f32 v63, v118, -v119
  v_cvt_pk_bf16_f32 v95, -v119, -v118
  v_xor_b32 v95, v120, v95
  v_fmamk_f32 v117, v9, 0x42400000, v11
  v_cos_f32 v118, v117
  v_sin_f32 v119, v117
  s_nop 0
  v_cvt_pk_bf16_f32 v64, v118, -v119
  v_xor_b32 v96, v120, v64
  v_fmamk_f32 v117, v9, 0x42440000, v11
  v_cos_f32 v118, v117
  v_sin_f32 v119, v117
  s_nop 0
  v_cvt_pk_bf16_f32 v65, v118, -v119
  v_cvt_pk_bf16_f32 v97, -v119, -v118
  v_xor_b32 v97, v120, v97
  v_fmamk_f32 v117, v9, 0x42500000, v11
  v_cos_f32 v118, v117
  v_sin_f32 v119, v117
  s_nop 0
  v_cvt_pk_bf16_f32 v66, v118, -v119
  v_xor_b32 v98, v120, v66
  v_fmamk_f32 v117, v9, 0x42540000, v11
  v_cos_f32 v118, v117
  v_sin_f32 v119, v117
  s_nop 0
  v_cvt_pk_bf16_f32 v67, v118, -v119
  v_cvt_pk_bf16_f32 v99, -v119, -v118
  v_xor_b32 v99, v120, v99
  s_and_b32 s58, s3, 1
  s_lshl_b32 s58, s58, 6
  s_add_u32 s58, s58, 16
  v_add_u32 v117, s58, v5
  v_cvt_f32_u32 v9, v117
  v_mul_f32 v9, 0x3c000000, v9
  v_mul_f32 v11, v9, v116
  v_fmamk_f32 v117, v9, 0x0, v11
  v_cos_f32 v118, v117
  v_sin_f32 v119, v117
  s_nop 0
  v_cvt_pk_bf16_f32 v68, v118, -v119
  v_xor_b32 v100, v120, v68
  v_fmamk_f32 v117, v9, 0x3f800000, v11
  v_cos_f32 v118, v117
  v_sin_f32 v119, v117
  s_nop 0
  v_cvt_pk_bf16_f32 v69, v118, -v119
  v_cvt_pk_bf16_f32 v101, -v119, -v118
  v_xor_b32 v101, v120, v101
  v_fmamk_f32 v117, v9, 0x40800000, v11
  v_cos_f32 v118, v117
  v_sin_f32 v119, v117
  s_nop 0
  v_cvt_pk_bf16_f32 v70, v118, -v119
  v_xor_b32 v102, v120, v70
  v_fmamk_f32 v117, v9, 0x40a00000, v11
  v_cos_f32 v118, v117
  v_sin_f32 v119, v117
  s_nop 0
  v_cvt_pk_bf16_f32 v71, v118, -v119
  v_cvt_pk_bf16_f32 v103, -v119, -v118
  v_xor_b32 v103, v120, v103
  v_fmamk_f32 v117, v9, 0x41800000, v11
  v_cos_f32 v118, v117
  v_sin_f32 v119, v117
  s_nop 0
  v_cvt_pk_bf16_f32 v72, v118, -v119
  v_xor_b32 v104, v120, v72
  v_fmamk_f32 v117, v9, 0x41880000, v11
  v_cos_f32 v118, v117
  v_sin_f32 v119, v117
  s_nop 0
  v_cvt_pk_bf16_f32 v73, v118, -v119
  v_cvt_pk_bf16_f32 v105, -v119, -v118
  v_xor_b32 v105, v120, v105
  v_fmamk_f32 v117, v9, 0x41a00000, v11
  v_cos_f32 v118, v117
  v_sin_f32 v119, v117
  s_nop 0
  v_cvt_pk_bf16_f32 v74, v118, -v119
  v_xor_b32 v106, v120, v74
  v_fmamk_f32 v117, v9, 0x41a80000, v11
  v_cos_f32 v118, v117
  v_sin_f32 v119, v117
  s_nop 0
  v_cvt_pk_bf16_f32 v75, v118, -v119
  v_cvt_pk_bf16_f32 v107, -v119, -v118
  v_xor_b32 v107, v120, v107
  v_fmamk_f32 v117, v9, 0x42000000, v11
  v_cos_f32 v118, v117
  v_sin_f32 v119, v117
  s_nop 0
  v_cvt_pk_bf16_f32 v76, v118, -v119
  v_xor_b32 v108, v120, v76
  v_fmamk_f32 v117, v9, 0x42040000, v11
  v_cos_f32 v118, v117
  v_sin_f32 v119, v117
  s_nop 0
  v_cvt_pk_bf16_f32 v77, v118, -v119
  v_cvt_pk_bf16_f32 v109, -v119, -v118
  v_xor_b32 v109, v120, v109
  v_fmamk_f32 v117, v9, 0x42100000, v11
  v_cos_f32 v118, v117
  v_sin_f32 v119, v117
  s_nop 0
  v_cvt_pk_bf16_f32 v78, v118, -v119
  v_xor_b32 v110, v120, v78
  v_fmamk_f32 v117, v9, 0x42140000, v11
  v_cos_f32 v118, v117
  v_sin_f32 v119, v117
  s_nop 0
  v_cvt_pk_bf16_f32 v79, v118, -v119
  v_cvt_pk_bf16_f32 v111, -v119, -v118
  v_xor_b32 v111, v120, v111
  v_fmamk_f32 v117, v9, 0x42400000, v11
  v_cos_f32 v118, v117
  v_sin_f32 v119, v117
  s_nop 0
  v_cvt_pk_bf16_f32 v80, v118, -v119
  v_xor_b32 v112, v120, v80
  v_fmamk_f32 v117, v9, 0x42440000, v11
  v_cos_f32 v118, v117
  v_sin_f32 v119, v117
  s_nop 0
  v_cvt_pk_bf16_f32 v81, v118, -v119
  v_cvt_pk_bf16_f32 v113, -v119, -v118
  v_xor_b32 v113, v120, v113
  v_fmamk_f32 v117, v9, 0x42500000, v11
  v_cos_f32 v118, v117
  v_sin_f32 v119, v117
  s_nop 0
  v_cvt_pk_bf16_f32 v82, v118, -v119
  v_xor_b32 v114, v120, v82
  v_fmamk_f32 v117, v9, 0x42540000, v11
  v_cos_f32 v118, v117
  v_sin_f32 v119, v117
  s_nop 0
  v_cvt_pk_bf16_f32 v83, v118, -v119
  v_cvt_pk_bf16_f32 v115, -v119, -v118
  v_xor_b32 v115, v120, v115
  v_lshlrev_b32 v118, 31, v5
  v_or_b32 v118, 0x3f003f00, v118
  v_cmp_eq_u32 vcc, 0, v6
  s_nop 1
  v_cndmask_b32 v52, v52, v118, vcc
  v_cndmask_b32 v68, v68, v118, vcc
  v_cndmask_b32 v84, v84, v118, vcc
  v_cndmask_b32 v100, v100, v118, vcc
  s_add_u32 m0, s57, 65536
  s_nop 0
  buffer_load_dwordx4 v20, s[44:47], s43 offen offset:0 sc1 lds
  buffer_load_dwordx4 v20, s[44:47], s43 offen offset:1024 sc1 lds
  buffer_load_dwordx4 v20, s[44:47], s43 offen offset:2048 sc1 lds
  buffer_load_dwordx4 v20, s[44:47], s43 offen offset:3072 sc1 lds
  s_add_u32 m0, s57, 69632
  s_nop 0
  buffer_load_dwordx4 v21, s[44:47], s43 offen offset:0 sc1 lds
  buffer_load_dwordx4 v21, s[44:47], s43 offen offset:1024 sc1 lds
  buffer_load_dwordx4 v21, s[44:47], s43 offen offset:2048 sc1 lds
  buffer_load_dwordx4 v21, s[44:47], s43 offen offset:3072 sc1 lds
  s_add_u32 s43, s43, 32768
  s_and_b32 s43, s43, 0x7ffff
  buffer_store_dword v12, v10, s[52:55], s56 offen sc1
  s_add_u32 s56, s56, 262144
  buffer_store_dword v13, v10, s[52:55], s56 offen sc1
  s_add_u32 s56, s56, 262144
  buffer_store_dword v14, v10, s[52:55], s56 offen sc1
  s_add_u32 s56, s56, 262144
  buffer_store_dword v15, v10, s[52:55], s56 offen sc1
  s_sub_u32 s56, s56, 770048
  buffer_store_dword v16, v10, s[52:55], s56 offen sc1
  s_add_u32 s56, s56, 262144
  buffer_store_dword v17, v10, s[52:55], s56 offen sc1
  s_add_u32 s56, s56, 262144
  buffer_store_dword v18, v10, s[52:55], s56 offen sc1
  s_add_u32 s56, s56, 262144
  buffer_store_dword v19, v10, s[52:55], s56 offen sc1
  s_sub_u32 s56, s56, 770048
  buffer_store_dword v28, v10, s[52:55], s56 offen sc1
  s_add_u32 s56, s56, 262144
  buffer_store_dword v29, v10, s[52:55], s56 offen sc1
  s_add_u32 s56, s56, 262144
  buffer_store_dword v30, v10, s[52:55], s56 offen sc1
  s_add_u32 s56, s56, 262144
  buffer_store_dword v31, v10, s[52:55], s56 offen sc1
  s_sub_u32 s56, s56, 770048
  buffer_store_dword v32, v10, s[52:55], s56 offen sc1
  s_add_u32 s56, s56, 262144
  buffer_store_dword v33, v10, s[52:55], s56 offen sc1
  s_add_u32 s56, s56, 262144
  buffer_store_dword v34, v10, s[52:55], s56 offen sc1
  s_add_u32 s56, s56, 262144
  buffer_store_dword v35, v10, s[52:55], s56 offen sc1
  s_and_b32 s56, s3, 1
  s_lshl_b32 s56, s56, 13
  s_add_u32 s56, s56, 131072
  v_lshrrev_b32 v228, 2, v4
  v_lshlrev_b32 v228, 7, v228
  v_and_b32 v229, 3, v4
  v_lshl_or_b32 v228, v229, 3, v228
  v_add_u32 v228, s56, v228
  v_bfe_u32 v229, v4, 3, 2
  s_and_b32 s56, s3, 2
  v_xor_b32 v229, s56, v229
  v_lshl_add_u32 v10, v229, 5, v228
  v_xor_b32 v11, 32, v10
  ds_read_b64_tr_b16 v[14:15], v10 offset:0
  ds_read_b64_tr_b16 v[18:19], v10 offset:2048
  ds_read_b64_tr_b16 v[30:31], v10 offset:4096
  ds_read_b64_tr_b16 v[34:35], v10 offset:6144
  ds_read_b64_tr_b16 v[134:135], v11 offset:0
  ds_read_b64_tr_b16 v[138:139], v11 offset:2048
  ds_read_b64_tr_b16 v[142:143], v11 offset:4096
  ds_read_b64_tr_b16 v[146:147], v11 offset:6144
  s_waitcnt vmcnt(25)
  v_lshlrev_b32 v22, 16, v22
  s_waitcnt vmcnt(24)
  v_lshlrev_b32 v23, 16, v23
  s_waitcnt lgkmcnt(7)
  v_lshlrev_b32 v12, 16, v14
  v_and_b32 v13, 0xffff0000, v14
  v_lshlrev_b32 v14, 16, v15
  v_and_b32 v15, 0xffff0000, v15
  v_pk_mul_f32 v[12:13], v[22:23], v[12:13] op_sel:[0,0] op_sel_hi:[0,1]
  v_pk_mul_f32 v[14:15], v[22:23], v[14:15] op_sel:[0,0] op_sel_hi:[0,1]
  s_waitcnt lgkmcnt(6)
  v_lshlrev_b32 v16, 16, v18
  v_and_b32 v17, 0xffff0000, v18
  v_lshlrev_b32 v18, 16, v19
  v_and_b32 v19, 0xffff0000, v19
  v_pk_mul_f32 v[16:17], v[22:23], v[16:17] op_sel:[0,0] op_sel_hi:[0,1]
  v_pk_mul_f32 v[18:19], v[22:23], v[18:19] op_sel:[0,0] op_sel_hi:[0,1]
  s_waitcnt lgkmcnt(5)
  v_lshlrev_b32 v28, 16, v30
  v_and_b32 v29, 0xffff0000, v30
  v_lshlrev_b32 v30, 16, v31
  v_and_b32 v31, 0xffff0000, v31
  v_pk_mul_f32 v[28:29], v[22:23], v[28:29] op_sel:[0,0] op_sel_hi:[0,1]
  v_pk_mul_f32 v[30:31], v[22:23], v[30:31] op_sel:[0,0] op_sel_hi:[0,1]
  s_waitcnt lgkmcnt(4)
  v_lshlrev_b32 v32, 16, v34
  v_and_b32 v33, 0xffff0000, v34
  v_lshlrev_b32 v34, 16, v35
  v_and_b32 v35, 0xffff0000, v35
  v_pk_mul_f32 v[32:33], v[22:23], v[32:33] op_sel:[0,0] op_sel_hi:[0,1]
  v_pk_mul_f32 v[34:35], v[22:23], v[34:35] op_sel:[0,0] op_sel_hi:[0,1]
  s_waitcnt lgkmcnt(3)
  v_lshlrev_b32 v132, 16, v134
  v_and_b32 v133, 0xffff0000, v134
  v_lshlrev_b32 v134, 16, v135
  v_and_b32 v135, 0xffff0000, v135
  v_pk_mul_f32 v[132:133], v[22:23], v[132:133] op_sel:[1,0] op_sel_hi:[1,1]
  v_pk_mul_f32 v[134:135], v[22:23], v[134:135] op_sel:[1,0] op_sel_hi:[1,1]
  s_waitcnt lgkmcnt(2)
  v_lshlrev_b32 v136, 16, v138
  v_and_b32 v137, 0xffff0000, v138
  v_lshlrev_b32 v138, 16, v139
  v_and_b32 v139, 0xffff0000, v139
  v_pk_mul_f32 v[136:137], v[22:23], v[136:137] op_sel:[1,0] op_sel_hi:[1,1]
  v_pk_mul_f32 v[138:139], v[22:23], v[138:139] op_sel:[1,0] op_sel_hi:[1,1]
  s_waitcnt lgkmcnt(1)
  v_lshlrev_b32 v140, 16, v142
  v_and_b32 v141, 0xffff0000, v142
  v_lshlrev_b32 v142, 16, v143
  v_and_b32 v143, 0xffff0000, v143
  v_pk_mul_f32 v[140:141], v[22:23], v[140:141] op_sel:[1,0] op_sel_hi:[1,1]
  v_pk_mul_f32 v[142:143], v[22:23], v[142:143] op_sel:[1,0] op_sel_hi:[1,1]
  s_waitcnt lgkmcnt(0)
  v_lshlrev_b32 v144, 16, v146
  v_and_b32 v145, 0xffff0000, v146
  v_lshlrev_b32 v146, 16, v147
  v_and_b32 v147, 0xffff0000, v147
  v_pk_mul_f32 v[144:145], v[22:23], v[144:145] op_sel:[1,0] op_sel_hi:[1,1]
  v_pk_mul_f32 v[146:147], v[22:23], v[146:147] op_sel:[1,0] op_sel_hi:[1,1]
  s_barrier
  ds_read_b64_tr_b16 v[164:165], v24 offset:0
  ds_read_b64_tr_b16 v[166:167], v25 offset:0
  ds_read_b64_tr_b16 v[168:169], v24 offset:2048
  ds_read_b64_tr_b16 v[170:171], v25 offset:2048
  ds_read_b64_tr_b16 v[172:173], v24 offset:4096
  ds_read_b64_tr_b16 v[174:175], v25 offset:4096
  ds_read_b64_tr_b16 v[176:177], v24 offset:6144
  ds_read_b64_tr_b16 v[178:179], v25 offset:6144
  ds_read_b64_tr_b16 v[180:181], v24 offset:8192
  ds_read_b64_tr_b16 v[182:183], v25 offset:8192
  ds_read_b64_tr_b16 v[184:185], v24 offset:10240
  ds_read_b64_tr_b16 v[186:187], v25 offset:10240
  ds_read_b64_tr_b16 v[188:189], v24 offset:12288
  ds_read_b64_tr_b16 v[190:191], v25 offset:12288
  ds_read_b64_tr_b16 v[192:193], v24 offset:14336
  ds_read_b64_tr_b16 v[194:195], v25 offset:14336
  s_waitcnt lgkmcnt(14)
  v_mfma_f32_16x16x32_bf16 v[12:15], v[164:167], a[0:3], v[12:15]
  ds_read_b64_tr_b16 v[196:197], v24 offset:256
  ds_read_b64_tr_b16 v[198:199], v25 offset:256
  v_mfma_f32_16x16x32_bf16 v[132:135], v[164:167], a[8:11], v[132:135]
  ds_read_b64_tr_b16 v[200:201], v24 offset:2304
  ds_read_b64_tr_b16 v[202:203], v25 offset:2304
  s_waitcnt lgkmcnt(15)
  v_mfma_f32_16x16x32_bf16 v[16:19], v[168:171], a[0:3], v[16:19]
  ds_read_b64_tr_b16 v[204:205], v24 offset:4352
  ds_read_b64_tr_b16 v[206:207], v25 offset:4352
  v_mfma_f32_16x16x32_bf16 v[136:139], v[168:171], a[8:11], v[136:139]
  ds_read_b64_tr_b16 v[208:209], v24 offset:6400
  ds_read_b64_tr_b16 v[210:211], v25 offset:6400
  s_waitcnt lgkmcnt(15)
  v_mfma_f32_16x16x32_bf16 v[28:31], v[172:175], a[0:3], v[28:31]
  ds_read_b64_tr_b16 v[212:213], v24 offset:8448
  ds_read_b64_tr_b16 v[214:215], v25 offset:8448
  v_mfma_f32_16x16x32_bf16 v[140:143], v[172:175], a[8:11], v[140:143]
  ds_read_b64_tr_b16 v[216:217], v24 offset:10496
  ds_read_b64_tr_b16 v[218:219], v25 offset:10496
  s_waitcnt lgkmcnt(15)
  v_mfma_f32_16x16x32_bf16 v[32:35], v[176:179], a[0:3], v[32:35]
  ds_read_b64_tr_b16 v[220:221], v24 offset:12544
  ds_read_b64_tr_b16 v[222:223], v25 offset:12544
  v_mfma_f32_16x16x32_bf16 v[144:147], v[176:179], a[8:11], v[144:147]
  ds_read_b64_tr_b16 v[224:225], v24 offset:14592
  ds_read_b64_tr_b16 v[226:227], v25 offset:14592
  s_waitcnt lgkmcnt(15)
  v_mfma_f32_16x16x32_bf16 v[116:119], v[180:183], a[0:3], 0
  s_add_u32 m0, s57, 98304
  s_nop 0
  buffer_load_dwordx4 v20, s[44:47], s43 offen offset:0 sc1 lds
  v_mfma_f32_16x16x32_bf16 v[148:151], v[180:183], a[8:11], 0
  s_waitcnt lgkmcnt(15)
  v_mfma_f32_16x16x32_bf16 v[120:123], v[184:187], a[0:3], 0
  buffer_load_dwordx4 v20, s[44:47], s43 offen offset:1024 sc1 lds
  v_mfma_f32_16x16x32_bf16 v[152:155], v[184:187], a[8:11], 0
  s_waitcnt lgkmcnt(15)
  v_mfma_f32_16x16x32_bf16 v[124:127], v[188:191], a[0:3], 0
  buffer_load_dwordx4 v20, s[44:47], s43 offen offset:2048 sc1 lds
  v_mfma_f32_16x16x32_bf16 v[156:159], v[188:191], a[8:11], 0
  s_waitcnt lgkmcnt(15)
  v_mfma_f32_16x16x32_bf16 v[128:131], v[192:195], a[0:3], 0
  buffer_load_dwordx4 v20, s[44:47], s43 offen offset:3072 sc1 lds
  v_mfma_f32_16x16x32_bf16 v[160:163], v[192:195], a[8:11], 0
  s_waitcnt lgkmcnt(0)
  s_barrier
  v_mfma_f32_16x16x32_bf16 v[12:15], v[196:199], a[4:7], v[12:15]
  ds_read_b64_tr_b16 v[164:165], v24 offset:32768
  ds_read_b64_tr_b16 v[166:167], v25 offset:32768
  v_mfma_f32_16x16x32_bf16 v[132:135], v[196:199], a[12:15], v[132:135]
  ds_read_b64_tr_b16 v[168:169], v24 offset:34816
  ds_read_b64_tr_b16 v[170:171], v25 offset:34816
  v_mfma_f32_16x16x32_bf16 v[16:19], v[200:203], a[4:7], v[16:19]
  ds_read_b64_tr_b16 v[172:173], v24 offset:36864
  ds_read_b64_tr_b16 v[174:175], v25 offset:36864
  v_mfma_f32_16x16x32_bf16 v[136:139], v[200:203], a[12:15], v[136:139]
  ds_read_b64_tr_b16 v[176:177], v24 offset:38912
  ds_read_b64_tr_b16 v[178:179], v25 offset:38912
  v_mfma_f32_16x16x32_bf16 v[28:31], v[204:207], a[4:7], v[28:31]
  ds_read_b64_tr_b16 v[180:181], v24 offset:40960
  ds_read_b64_tr_b16 v[182:183], v25 offset:40960
  v_mfma_f32_16x16x32_bf16 v[140:143], v[204:207], a[12:15], v[140:143]
  ds_read_b64_tr_b16 v[184:185], v24 offset:43008
  ds_read_b64_tr_b16 v[186:187], v25 offset:43008
  v_mfma_f32_16x16x32_bf16 v[32:35], v[208:211], a[4:7], v[32:35]
  ds_read_b64_tr_b16 v[188:189], v24 offset:45056
  ds_read_b64_tr_b16 v[190:191], v25 offset:45056
  v_mfma_f32_16x16x32_bf16 v[144:147], v[208:211], a[12:15], v[144:147]
  ds_read_b64_tr_b16 v[192:193], v24 offset:47104
  ds_read_b64_tr_b16 v[194:195], v25 offset:47104
  v_mfma_f32_16x16x32_bf16 v[116:119], v[212:215], a[4:7], v[116:119]
  s_add_u32 m0, s57, 102400
  s_nop 0
  buffer_load_dwordx4 v21, s[44:47], s43 offen offset:0 sc1 lds
  v_mfma_f32_16x16x32_bf16 v[148:151], v[212:215], a[12:15], v[148:151]
  v_mfma_f32_16x16x32_bf16 v[120:123], v[216:219], a[4:7], v[120:123]
  buffer_load_dwordx4 v21, s[44:47], s43 offen offset:1024 sc1 lds
  v_mfma_f32_16x16x32_bf16 v[152:155], v[216:219], a[12:15], v[152:155]
  v_mfma_f32_16x16x32_bf16 v[124:127], v[220:223], a[4:7], v[124:127]
  buffer_load_dwordx4 v21, s[44:47], s43 offen offset:2048 sc1 lds
  v_mfma_f32_16x16x32_bf16 v[156:159], v[220:223], a[12:15], v[156:159]
  v_mfma_f32_16x16x32_bf16 v[128:131], v[224:227], a[4:7], v[128:131]
  buffer_load_dwordx4 v21, s[44:47], s43 offen offset:3072 sc1 lds
  s_add_u32 s43, s43, 32768
  s_and_b32 s43, s43, 0x7ffff
  v_mfma_f32_16x16x32_bf16 v[160:163], v[224:227], a[12:15], v[160:163]
  s_waitcnt lgkmcnt(14)
  v_mfma_f32_16x16x32_bf16 v[12:15], v[164:167], a[16:19], v[12:15]
  ds_read_b64_tr_b16 v[196:197], v24 offset:33024
  ds_read_b64_tr_b16 v[198:199], v25 offset:33024
  v_mfma_f32_16x16x32_bf16 v[132:135], v[164:167], a[24:27], v[132:135]
  ds_read_b64_tr_b16 v[200:201], v24 offset:35072
  ds_read_b64_tr_b16 v[202:203], v25 offset:35072
  s_waitcnt lgkmcnt(15)
  v_mfma_f32_16x16x32_bf16 v[16:19], v[168:171], a[16:19], v[16:19]
  ds_read_b64_tr_b16 v[204:205], v24 offset:37120
  ds_read_b64_tr_b16 v[206:207], v25 offset:37120
  v_mfma_f32_16x16x32_bf16 v[136:139], v[168:171], a[24:27], v[136:139]
  ds_read_b64_tr_b16 v[208:209], v24 offset:39168
  ds_read_b64_tr_b16 v[210:211], v25 offset:39168
  s_waitcnt lgkmcnt(15)
  v_mfma_f32_16x16x32_bf16 v[28:31], v[172:175], a[16:19], v[28:31]
  ds_read_b64_tr_b16 v[212:213], v24 offset:41216
  ds_read_b64_tr_b16 v[214:215], v25 offset:41216
  v_mfma_f32_16x16x32_bf16 v[140:143], v[172:175], a[24:27], v[140:143]
  ds_read_b64_tr_b16 v[216:217], v24 offset:43264
  ds_read_b64_tr_b16 v[218:219], v25 offset:43264
  s_waitcnt lgkmcnt(15)
  v_mfma_f32_16x16x32_bf16 v[32:35], v[176:179], a[16:19], v[32:35]
  ds_read_b64_tr_b16 v[220:221], v24 offset:45312
  ds_read_b64_tr_b16 v[222:223], v25 offset:45312
  v_mfma_f32_16x16x32_bf16 v[144:147], v[176:179], a[24:27], v[144:147]
  ds_read_b64_tr_b16 v[224:225], v24 offset:47360
  ds_read_b64_tr_b16 v[226:227], v25 offset:47360
  s_waitcnt lgkmcnt(15)
  v_mfma_f32_16x16x32_bf16 v[116:119], v[180:183], a[16:19], v[116:119]
  s_add_u32 m0, s57, 0
  s_nop 0
  buffer_load_dwordx4 v20, s[44:47], s43 offen offset:0 sc1 lds
  v_mfma_f32_16x16x32_bf16 v[148:151], v[180:183], a[24:27], v[148:151]
  s_waitcnt lgkmcnt(15)
  v_mfma_f32_16x16x32_bf16 v[120:123], v[184:187], a[16:19], v[120:123]
  buffer_load_dwordx4 v20, s[44:47], s43 offen offset:1024 sc1 lds
  v_mfma_f32_16x16x32_bf16 v[152:155], v[184:187], a[24:27], v[152:155]
  s_waitcnt lgkmcnt(15)
  v_mfma_f32_16x16x32_bf16 v[124:127], v[188:191], a[16:19], v[124:127]
  buffer_load_dwordx4 v20, s[44:47], s43 offen offset:2048 sc1 lds
  v_mfma_f32_16x16x32_bf16 v[156:159], v[188:191], a[24:27], v[156:159]
  s_waitcnt lgkmcnt(15)
  v_mfma_f32_16x16x32_bf16 v[128:131], v[192:195], a[16:19], v[128:131]
  buffer_load_dwordx4 v20, s[44:47], s43 offen offset:3072 sc1 lds
  v_mfma_f32_16x16x32_bf16 v[160:163], v[192:195], a[24:27], v[160:163]
  s_waitcnt vmcnt(28) lgkmcnt(0)
  s_barrier
  v_mfma_f32_16x16x32_bf16 v[12:15], v[196:199], a[20:23], v[12:15]
  ds_read_b64_tr_b16 v[164:165], v26 offset:0
  ds_read_b64_tr_b16 v[166:167], v27 offset:0
  v_mfma_f32_16x16x32_bf16 v[132:135], v[196:199], a[28:31], v[132:135]
  ds_read_b64_tr_b16 v[168:169], v26 offset:2048
  ds_read_b64_tr_b16 v[170:171], v27 offset:2048
  v_mfma_f32_16x16x32_bf16 v[16:19], v[200:203], a[20:23], v[16:19]
  ds_read_b64_tr_b16 v[172:173], v26 offset:4096
  ds_read_b64_tr_b16 v[174:175], v27 offset:4096
  v_mfma_f32_16x16x32_bf16 v[136:139], v[200:203], a[28:31], v[136:139]
  ds_read_b64_tr_b16 v[176:177], v26 offset:6144
  ds_read_b64_tr_b16 v[178:179], v27 offset:6144
  v_mfma_f32_16x16x32_bf16 v[28:31], v[204:207], a[20:23], v[28:31]
  ds_read_b64_tr_b16 v[180:181], v26 offset:8192
  ds_read_b64_tr_b16 v[182:183], v27 offset:8192
  v_mfma_f32_16x16x32_bf16 v[140:143], v[204:207], a[28:31], v[140:143]
  ds_read_b64_tr_b16 v[184:185], v26 offset:10240
  ds_read_b64_tr_b16 v[186:187], v27 offset:10240
  v_mfma_f32_16x16x32_bf16 v[32:35], v[208:211], a[20:23], v[32:35]
  ds_read_b64_tr_b16 v[188:189], v26 offset:12288
  ds_read_b64_tr_b16 v[190:191], v27 offset:12288
  v_mfma_f32_16x16x32_bf16 v[144:147], v[208:211], a[28:31], v[144:147]
  ds_read_b64_tr_b16 v[192:193], v26 offset:14336
  ds_read_b64_tr_b16 v[194:195], v27 offset:14336
  v_mfma_f32_16x16x32_bf16 v[116:119], v[212:215], a[20:23], v[116:119]
  s_add_u32 m0, s57, 4096
  s_nop 0
  buffer_load_dwordx4 v21, s[44:47], s43 offen offset:0 sc1 lds
  v_mfma_f32_16x16x32_bf16 v[148:151], v[212:215], a[28:31], v[148:151]
  v_mfma_f32_16x16x32_bf16 v[120:123], v[216:219], a[20:23], v[120:123]
  buffer_load_dwordx4 v21, s[44:47], s43 offen offset:1024 sc1 lds
  v_mfma_f32_16x16x32_bf16 v[152:155], v[216:219], a[28:31], v[152:155]
  v_mfma_f32_16x16x32_bf16 v[124:127], v[220:223], a[20:23], v[124:127]
  buffer_load_dwordx4 v21, s[44:47], s43 offen offset:2048 sc1 lds
  v_mfma_f32_16x16x32_bf16 v[156:159], v[220:223], a[28:31], v[156:159]
  v_mfma_f32_16x16x32_bf16 v[128:131], v[224:227], a[20:23], v[128:131]
  buffer_load_dwordx4 v21, s[44:47], s43 offen offset:3072 sc1 lds
  s_add_u32 s43, s43, 32768
  s_and_b32 s43, s43, 0x7ffff
  v_mfma_f32_16x16x32_bf16 v[160:163], v[224:227], a[28:31], v[160:163]
  s_waitcnt lgkmcnt(14)
  v_mfma_f32_16x16x32_bf16 v[12:15], v[164:167], a[32:35], v[12:15]
  ds_read_b64_tr_b16 v[196:197], v26 offset:256
  ds_read_b64_tr_b16 v[198:199], v27 offset:256
  v_mfma_f32_16x16x32_bf16 v[132:135], v[164:167], a[40:43], v[132:135]
  ds_read_b64_tr_b16 v[200:201], v26 offset:2304
  ds_read_b64_tr_b16 v[202:203], v27 offset:2304
  s_waitcnt lgkmcnt(15)
  v_mfma_f32_16x16x32_bf16 v[16:19], v[168:171], a[32:35], v[16:19]
  ds_read_b64_tr_b16 v[204:205], v26 offset:4352
  ds_read_b64_tr_b16 v[206:207], v27 offset:4352
  v_mfma_f32_16x16x32_bf16 v[136:139], v[168:171], a[40:43], v[136:139]
  ds_read_b64_tr_b16 v[208:209], v26 offset:6400
  ds_read_b64_tr_b16 v[210:211], v27 offset:6400
  s_waitcnt lgkmcnt(15)
  v_mfma_f32_16x16x32_bf16 v[28:31], v[172:175], a[32:35], v[28:31]
  ds_read_b64_tr_b16 v[212:213], v26 offset:8448
  ds_read_b64_tr_b16 v[214:215], v27 offset:8448
  v_mfma_f32_16x16x32_bf16 v[140:143], v[172:175], a[40:43], v[140:143]
  ds_read_b64_tr_b16 v[216:217], v26 offset:10496
  ds_read_b64_tr_b16 v[218:219], v27 offset:10496
  s_waitcnt lgkmcnt(15)
  v_mfma_f32_16x16x32_bf16 v[32:35], v[176:179], a[32:35], v[32:35]
  ds_read_b64_tr_b16 v[220:221], v26 offset:12544
  ds_read_b64_tr_b16 v[222:223], v27 offset:12544
  v_mfma_f32_16x16x32_bf16 v[144:147], v[176:179], a[40:43], v[144:147]
  ds_read_b64_tr_b16 v[224:225], v26 offset:14592
  ds_read_b64_tr_b16 v[226:227], v27 offset:14592
  s_waitcnt lgkmcnt(15)
  v_mfma_f32_16x16x32_bf16 v[116:119], v[180:183], a[32:35], v[116:119]
  s_add_u32 m0, s57, 32768
  s_nop 0
  buffer_load_dwordx4 v20, s[44:47], s43 offen offset:0 sc1 lds
  v_mfma_f32_16x16x32_bf16 v[148:151], v[180:183], a[40:43], v[148:151]
  s_waitcnt lgkmcnt(15)
  v_mfma_f32_16x16x32_bf16 v[120:123], v[184:187], a[32:35], v[120:123]
  buffer_load_dwordx4 v20, s[44:47], s43 offen offset:1024 sc1 lds
  v_mfma_f32_16x16x32_bf16 v[152:155], v[184:187], a[40:43], v[152:155]
  s_waitcnt lgkmcnt(15)
  v_mfma_f32_16x16x32_bf16 v[124:127], v[188:191], a[32:35], v[124:127]
  buffer_load_dwordx4 v20, s[44:47], s43 offen offset:2048 sc1 lds
  v_mfma_f32_16x16x32_bf16 v[156:159], v[188:191], a[40:43], v[156:159]
  s_waitcnt lgkmcnt(15)
  v_mfma_f32_16x16x32_bf16 v[128:131], v[192:195], a[32:35], v[128:131]
  buffer_load_dwordx4 v20, s[44:47], s43 offen offset:3072 sc1 lds
  v_mfma_f32_16x16x32_bf16 v[160:163], v[192:195], a[40:43], v[160:163]
  s_waitcnt vmcnt(12) lgkmcnt(0)
  s_barrier
  v_mfma_f32_16x16x32_bf16 v[12:15], v[196:199], a[36:39], v[12:15]
  ds_read_b64_tr_b16 v[164:165], v26 offset:32768
  ds_read_b64_tr_b16 v[166:167], v27 offset:32768
  v_mfma_f32_16x16x32_bf16 v[132:135], v[196:199], a[44:47], v[132:135]
  ds_read_b64_tr_b16 v[168:169], v26 offset:34816
  ds_read_b64_tr_b16 v[170:171], v27 offset:34816
  v_mfma_f32_16x16x32_bf16 v[16:19], v[200:203], a[36:39], v[16:19]
  ds_read_b64_tr_b16 v[172:173], v26 offset:36864
  ds_read_b64_tr_b16 v[174:175], v27 offset:36864
  v_mfma_f32_16x16x32_bf16 v[136:139], v[200:203], a[44:47], v[136:139]
  ds_read_b64_tr_b16 v[176:177], v26 offset:38912
  ds_read_b64_tr_b16 v[178:179], v27 offset:38912
  v_mfma_f32_16x16x32_bf16 v[28:31], v[204:207], a[36:39], v[28:31]
  ds_read_b64_tr_b16 v[180:181], v26 offset:40960
  ds_read_b64_tr_b16 v[182:183], v27 offset:40960
  v_mfma_f32_16x16x32_bf16 v[140:143], v[204:207], a[44:47], v[140:143]
  ds_read_b64_tr_b16 v[184:185], v26 offset:43008
  ds_read_b64_tr_b16 v[186:187], v27 offset:43008
  v_mfma_f32_16x16x32_bf16 v[32:35], v[208:211], a[36:39], v[32:35]
  ds_read_b64_tr_b16 v[188:189], v26 offset:45056
  ds_read_b64_tr_b16 v[190:191], v27 offset:45056
  v_mfma_f32_16x16x32_bf16 v[144:147], v[208:211], a[44:47], v[144:147]
  ds_read_b64_tr_b16 v[192:193], v26 offset:47104
  ds_read_b64_tr_b16 v[194:195], v27 offset:47104
  v_mfma_f32_16x16x32_bf16 v[116:119], v[212:215], a[36:39], v[116:119]
  s_add_u32 m0, s57, 36864
  s_nop 0
  buffer_load_dwordx4 v21, s[44:47], s43 offen offset:0 sc1 lds
  v_mfma_f32_16x16x32_bf16 v[148:151], v[212:215], a[44:47], v[148:151]
  v_mfma_f32_16x16x32_bf16 v[120:123], v[216:219], a[36:39], v[120:123]
  buffer_load_dwordx4 v21, s[44:47], s43 offen offset:1024 sc1 lds
  v_mfma_f32_16x16x32_bf16 v[152:155], v[216:219], a[44:47], v[152:155]
  v_mfma_f32_16x16x32_bf16 v[124:127], v[220:223], a[36:39], v[124:127]
  buffer_load_dwordx4 v21, s[44:47], s43 offen offset:2048 sc1 lds
  v_mfma_f32_16x16x32_bf16 v[156:159], v[220:223], a[44:47], v[156:159]
  v_mfma_f32_16x16x32_bf16 v[128:131], v[224:227], a[36:39], v[128:131]
  buffer_load_dwordx4 v21, s[44:47], s43 offen offset:3072 sc1 lds
  s_add_u32 s43, s43, 32768
  s_and_b32 s43, s43, 0x7ffff
  v_mfma_f32_16x16x32_bf16 v[160:163], v[224:227], a[44:47], v[160:163]
  s_waitcnt lgkmcnt(14)
  v_mfma_f32_16x16x32_bf16 v[12:15], v[164:167], a[48:51], v[12:15]
  ds_read_b64_tr_b16 v[196:197], v26 offset:33024
  ds_read_b64_tr_b16 v[198:199], v27 offset:33024
  v_mfma_f32_16x16x32_bf16 v[132:135], v[164:167], a[56:59], v[132:135]
  ds_read_b64_tr_b16 v[200:201], v26 offset:35072
  ds_read_b64_tr_b16 v[202:203], v27 offset:35072
  s_waitcnt lgkmcnt(15)
  v_mfma_f32_16x16x32_bf16 v[16:19], v[168:171], a[48:51], v[16:19]
  ds_read_b64_tr_b16 v[204:205], v26 offset:37120
  ds_read_b64_tr_b16 v[206:207], v27 offset:37120
  v_mfma_f32_16x16x32_bf16 v[136:139], v[168:171], a[56:59], v[136:139]
  ds_read_b64_tr_b16 v[208:209], v26 offset:39168
  ds_read_b64_tr_b16 v[210:211], v27 offset:39168
  s_waitcnt lgkmcnt(15)
  v_mfma_f32_16x16x32_bf16 v[28:31], v[172:175], a[48:51], v[28:31]
  ds_read_b64_tr_b16 v[212:213], v26 offset:41216
  ds_read_b64_tr_b16 v[214:215], v27 offset:41216
  v_mfma_f32_16x16x32_bf16 v[140:143], v[172:175], a[56:59], v[140:143]
  ds_read_b64_tr_b16 v[216:217], v26 offset:43264
  ds_read_b64_tr_b16 v[218:219], v27 offset:43264
  s_waitcnt lgkmcnt(15)
  v_mfma_f32_16x16x32_bf16 v[32:35], v[176:179], a[48:51], v[32:35]
  ds_read_b64_tr_b16 v[220:221], v26 offset:45312
  ds_read_b64_tr_b16 v[222:223], v27 offset:45312
  v_mfma_f32_16x16x32_bf16 v[144:147], v[176:179], a[56:59], v[144:147]
  ds_read_b64_tr_b16 v[224:225], v26 offset:47360
  ds_read_b64_tr_b16 v[226:227], v27 offset:47360
  s_waitcnt lgkmcnt(15)
  v_mfma_f32_16x16x32_bf16 v[116:119], v[180:183], a[48:51], v[116:119]
  s_add_u32 m0, s57, 65536
  s_nop 0
  buffer_load_dwordx4 v20, s[44:47], s43 offen offset:0 sc1 lds
  v_mfma_f32_16x16x32_bf16 v[148:151], v[180:183], a[56:59], v[148:151]
  s_waitcnt lgkmcnt(15)
  v_mfma_f32_16x16x32_bf16 v[120:123], v[184:187], a[48:51], v[120:123]
  buffer_load_dwordx4 v20, s[44:47], s43 offen offset:1024 sc1 lds
  v_mfma_f32_16x16x32_bf16 v[152:155], v[184:187], a[56:59], v[152:155]
  s_waitcnt lgkmcnt(15)
  v_mfma_f32_16x16x32_bf16 v[124:127], v[188:191], a[48:51], v[124:127]
  buffer_load_dwordx4 v20, s[44:47], s43 offen offset:2048 sc1 lds
  v_mfma_f32_16x16x32_bf16 v[156:159], v[188:191], a[56:59], v[156:159]
  s_waitcnt lgkmcnt(15)
  v_mfma_f32_16x16x32_bf16 v[128:131], v[192:195], a[48:51], v[128:131]
  buffer_load_dwordx4 v20, s[44:47], s43 offen offset:3072 sc1 lds
  v_mfma_f32_16x16x32_bf16 v[160:163], v[192:195], a[56:59], v[160:163]
  s_waitcnt vmcnt(12) lgkmcnt(0)
  s_barrier
  v_mfma_f32_16x16x32_bf16 v[12:15], v[196:199], a[52:55], v[12:15]
  ds_read_b64_tr_b16 v[164:165], v24 offset:0
  ds_read_b64_tr_b16 v[166:167], v25 offset:0
  v_mfma_f32_16x16x32_bf16 v[132:135], v[196:199], a[60:63], v[132:135]
  ds_read_b64_tr_b16 v[168:169], v24 offset:2048
  ds_read_b64_tr_b16 v[170:171], v25 offset:2048
  v_mfma_f32_16x16x32_bf16 v[16:19], v[200:203], a[52:55], v[16:19]
  ds_read_b64_tr_b16 v[172:173], v24 offset:4096
  ds_read_b64_tr_b16 v[174:175], v25 offset:4096
  v_mfma_f32_16x16x32_bf16 v[136:139], v[200:203], a[60:63], v[136:139]
  ds_read_b64_tr_b16 v[176:177], v24 offset:6144
  ds_read_b64_tr_b16 v[178:179], v25 offset:6144
  v_mfma_f32_16x16x32_bf16 v[28:31], v[204:207], a[52:55], v[28:31]
  ds_read_b64_tr_b16 v[180:181], v24 offset:8192
  ds_read_b64_tr_b16 v[182:183], v25 offset:8192
  v_mfma_f32_16x16x32_bf16 v[140:143], v[204:207], a[60:63], v[140:143]
  ds_read_b64_tr_b16 v[184:185], v24 offset:10240
  ds_read_b64_tr_b16 v[186:187], v25 offset:10240
  v_mfma_f32_16x16x32_bf16 v[32:35], v[208:211], a[52:55], v[32:35]
  ds_read_b64_tr_b16 v[188:189], v24 offset:12288
  ds_read_b64_tr_b16 v[190:191], v25 offset:12288
  v_mfma_f32_16x16x32_bf16 v[144:147], v[208:211], a[60:63], v[144:147]
  ds_read_b64_tr_b16 v[192:193], v24 offset:14336
  ds_read_b64_tr_b16 v[194:195], v25 offset:14336
  v_mfma_f32_16x16x32_bf16 v[116:119], v[212:215], a[52:55], v[116:119]
  s_add_u32 m0, s57, 69632
  s_nop 0
  buffer_load_dwordx4 v21, s[44:47], s43 offen offset:0 sc1 lds
  v_mfma_f32_16x16x32_bf16 v[148:151], v[212:215], a[60:63], v[148:151]
  s_cmp_lg_u32 s3, 0
  s_cbranch_scc1 gated_mix__spectral_gfnet__ssm_conv_s5__prompt_kernel_skip26
  s_mov_b64 exec, 1
  buffer_store_dword v2, v8, s[48:51], s42 offen sc1
  s_mov_b64 exec, -1
gated_mix__spectral_gfnet__ssm_conv_s5__prompt_kernel_skip26:
  v_mfma_f32_16x16x32_bf16 v[120:123], v[216:219], a[52:55], v[120:123]
  buffer_load_dwordx4 v21, s[44:47], s43 offen offset:1024 sc1 lds
  v_mfma_f32_16x16x32_bf16 v[152:155], v[216:219], a[60:63], v[152:155]
  v_mfma_f32_16x16x32_bf16 v[124:127], v[220:223], a[52:55], v[124:127]
  buffer_load_dwordx4 v21, s[44:47], s43 offen offset:2048 sc1 lds
  v_mfma_f32_16x16x32_bf16 v[156:159], v[220:223], a[60:63], v[156:159]
  v_mfma_f32_16x16x32_bf16 v[128:131], v[224:227], a[52:55], v[128:131]
  buffer_load_dwordx4 v21, s[44:47], s43 offen offset:3072 sc1 lds
  s_add_u32 s43, s43, 32768
  s_and_b32 s43, s43, 0x7ffff
  v_mfma_f32_16x16x32_bf16 v[160:163], v[224:227], a[60:63], v[160:163]
  s_waitcnt lgkmcnt(14)
  v_mfma_f32_16x16x32_bf16 v[12:15], v[164:167], a[64:67], v[12:15]
  ds_read_b64_tr_b16 v[196:197], v24 offset:256
  ds_read_b64_tr_b16 v[198:199], v25 offset:256
  v_mfma_f32_16x16x32_bf16 v[132:135], v[164:167], a[72:75], v[132:135]
  ds_read_b64_tr_b16 v[200:201], v24 offset:2304
  ds_read_b64_tr_b16 v[202:203], v25 offset:2304
  s_waitcnt lgkmcnt(15)
  v_mfma_f32_16x16x32_bf16 v[16:19], v[168:171], a[64:67], v[16:19]
  ds_read_b64_tr_b16 v[204:205], v24 offset:4352
  ds_read_b64_tr_b16 v[206:207], v25 offset:4352
  v_mfma_f32_16x16x32_bf16 v[136:139], v[168:171], a[72:75], v[136:139]
  ds_read_b64_tr_b16 v[208:209], v24 offset:6400
  ds_read_b64_tr_b16 v[210:211], v25 offset:6400
  s_waitcnt lgkmcnt(15)
  v_mfma_f32_16x16x32_bf16 v[28:31], v[172:175], a[64:67], v[28:31]
  ds_read_b64_tr_b16 v[212:213], v24 offset:8448
  ds_read_b64_tr_b16 v[214:215], v25 offset:8448
  v_mfma_f32_16x16x32_bf16 v[140:143], v[172:175], a[72:75], v[140:143]
  ds_read_b64_tr_b16 v[216:217], v24 offset:10496
  ds_read_b64_tr_b16 v[218:219], v25 offset:10496
  s_waitcnt lgkmcnt(15)
  v_mfma_f32_16x16x32_bf16 v[32:35], v[176:179], a[64:67], v[32:35]
  ds_read_b64_tr_b16 v[220:221], v24 offset:12544
  ds_read_b64_tr_b16 v[222:223], v25 offset:12544
  v_mfma_f32_16x16x32_bf16 v[144:147], v[176:179], a[72:75], v[144:147]
  ds_read_b64_tr_b16 v[224:225], v24 offset:14592
  ds_read_b64_tr_b16 v[226:227], v25 offset:14592
  s_waitcnt lgkmcnt(15)
  v_mfma_f32_16x16x32_bf16 v[116:119], v[180:183], a[64:67], v[116:119]
  s_add_u32 m0, s57, 98304
  s_nop 0
  buffer_load_dwordx4 v20, s[44:47], s43 offen offset:0 sc1 lds
  v_mfma_f32_16x16x32_bf16 v[148:151], v[180:183], a[72:75], v[148:151]
  s_waitcnt lgkmcnt(15)
  v_mfma_f32_16x16x32_bf16 v[120:123], v[184:187], a[64:67], v[120:123]
  buffer_load_dwordx4 v20, s[44:47], s43 offen offset:1024 sc1 lds
  v_mfma_f32_16x16x32_bf16 v[152:155], v[184:187], a[72:75], v[152:155]
  s_waitcnt lgkmcnt(15)
  v_mfma_f32_16x16x32_bf16 v[124:127], v[188:191], a[64:67], v[124:127]
  buffer_load_dwordx4 v20, s[44:47], s43 offen offset:2048 sc1 lds
  v_mfma_f32_16x16x32_bf16 v[156:159], v[188:191], a[72:75], v[156:159]
  s_waitcnt lgkmcnt(15)
  v_mfma_f32_16x16x32_bf16 v[128:131], v[192:195], a[64:67], v[128:131]
  buffer_load_dwordx4 v20, s[44:47], s43 offen offset:3072 sc1 lds
  v_mfma_f32_16x16x32_bf16 v[160:163], v[192:195], a[72:75], v[160:163]
  s_waitcnt vmcnt(12) lgkmcnt(0)
  s_barrier
  v_mfma_f32_16x16x32_bf16 v[12:15], v[196:199], a[68:71], v[12:15]
  ds_read_b64_tr_b16 v[164:165], v24 offset:32768
  ds_read_b64_tr_b16 v[166:167], v25 offset:32768
  v_mfma_f32_16x16x32_bf16 v[132:135], v[196:199], a[76:79], v[132:135]
  ds_read_b64_tr_b16 v[168:169], v24 offset:34816
  ds_read_b64_tr_b16 v[170:171], v25 offset:34816
  v_mfma_f32_16x16x32_bf16 v[16:19], v[200:203], a[68:71], v[16:19]
  ds_read_b64_tr_b16 v[172:173], v24 offset:36864
  ds_read_b64_tr_b16 v[174:175], v25 offset:36864
  v_mfma_f32_16x16x32_bf16 v[136:139], v[200:203], a[76:79], v[136:139]
  ds_read_b64_tr_b16 v[176:177], v24 offset:38912
  ds_read_b64_tr_b16 v[178:179], v25 offset:38912
  v_mfma_f32_16x16x32_bf16 v[28:31], v[204:207], a[68:71], v[28:31]
  ds_read_b64_tr_b16 v[180:181], v24 offset:40960
  ds_read_b64_tr_b16 v[182:183], v25 offset:40960
  v_mfma_f32_16x16x32_bf16 v[140:143], v[204:207], a[76:79], v[140:143]
  ds_read_b64_tr_b16 v[184:185], v24 offset:43008
  ds_read_b64_tr_b16 v[186:187], v25 offset:43008
  v_mfma_f32_16x16x32_bf16 v[32:35], v[208:211], a[68:71], v[32:35]
  ds_read_b64_tr_b16 v[188:189], v24 offset:45056
  ds_read_b64_tr_b16 v[190:191], v25 offset:45056
  v_mfma_f32_16x16x32_bf16 v[144:147], v[208:211], a[76:79], v[144:147]
  ds_read_b64_tr_b16 v[192:193], v24 offset:47104
  ds_read_b64_tr_b16 v[194:195], v25 offset:47104
  v_mfma_f32_16x16x32_bf16 v[116:119], v[212:215], a[68:71], v[116:119]
  s_add_u32 m0, s57, 102400
  s_nop 0
  buffer_load_dwordx4 v21, s[44:47], s43 offen offset:0 sc1 lds
  v_mfma_f32_16x16x32_bf16 v[148:151], v[212:215], a[76:79], v[148:151]
  v_mfma_f32_16x16x32_bf16 v[120:123], v[216:219], a[68:71], v[120:123]
  buffer_load_dwordx4 v21, s[44:47], s43 offen offset:1024 sc1 lds
  v_mfma_f32_16x16x32_bf16 v[152:155], v[216:219], a[76:79], v[152:155]
  v_mfma_f32_16x16x32_bf16 v[124:127], v[220:223], a[68:71], v[124:127]
  buffer_load_dwordx4 v21, s[44:47], s43 offen offset:2048 sc1 lds
  v_mfma_f32_16x16x32_bf16 v[156:159], v[220:223], a[76:79], v[156:159]
  v_mfma_f32_16x16x32_bf16 v[128:131], v[224:227], a[68:71], v[128:131]
  buffer_load_dwordx4 v21, s[44:47], s43 offen offset:3072 sc1 lds
  s_add_u32 s43, s43, 32768
  s_and_b32 s43, s43, 0x7ffff
  v_mfma_f32_16x16x32_bf16 v[160:163], v[224:227], a[76:79], v[160:163]
  s_waitcnt lgkmcnt(14)
  v_mfma_f32_16x16x32_bf16 v[12:15], v[164:167], a[80:83], v[12:15]
  ds_read_b64_tr_b16 v[196:197], v24 offset:33024
  ds_read_b64_tr_b16 v[198:199], v25 offset:33024
  v_mfma_f32_16x16x32_bf16 v[132:135], v[164:167], a[88:91], v[132:135]
  ds_read_b64_tr_b16 v[200:201], v24 offset:35072
  ds_read_b64_tr_b16 v[202:203], v25 offset:35072
  s_waitcnt lgkmcnt(15)
  v_mfma_f32_16x16x32_bf16 v[16:19], v[168:171], a[80:83], v[16:19]
  ds_read_b64_tr_b16 v[204:205], v24 offset:37120
  ds_read_b64_tr_b16 v[206:207], v25 offset:37120
  v_mfma_f32_16x16x32_bf16 v[136:139], v[168:171], a[88:91], v[136:139]
  ds_read_b64_tr_b16 v[208:209], v24 offset:39168
  ds_read_b64_tr_b16 v[210:211], v25 offset:39168
  s_waitcnt lgkmcnt(15)
  v_mfma_f32_16x16x32_bf16 v[28:31], v[172:175], a[80:83], v[28:31]
  ds_read_b64_tr_b16 v[212:213], v24 offset:41216
  ds_read_b64_tr_b16 v[214:215], v25 offset:41216
  v_mfma_f32_16x16x32_bf16 v[140:143], v[172:175], a[88:91], v[140:143]
  ds_read_b64_tr_b16 v[216:217], v24 offset:43264
  ds_read_b64_tr_b16 v[218:219], v25 offset:43264
  s_waitcnt lgkmcnt(15)
  v_mfma_f32_16x16x32_bf16 v[32:35], v[176:179], a[80:83], v[32:35]
  ds_read_b64_tr_b16 v[220:221], v24 offset:45312
  ds_read_b64_tr_b16 v[222:223], v25 offset:45312
  v_mfma_f32_16x16x32_bf16 v[144:147], v[176:179], a[88:91], v[144:147]
  ds_read_b64_tr_b16 v[224:225], v24 offset:47360
  ds_read_b64_tr_b16 v[226:227], v25 offset:47360
  s_waitcnt lgkmcnt(15)
  v_mfma_f32_16x16x32_bf16 v[116:119], v[180:183], a[80:83], v[116:119]
  s_add_u32 m0, s57, 0
  s_nop 0
  buffer_load_dwordx4 v20, s[44:47], s43 offen offset:0 sc1 lds
  v_mfma_f32_16x16x32_bf16 v[148:151], v[180:183], a[88:91], v[148:151]
  s_waitcnt lgkmcnt(15)
  v_mfma_f32_16x16x32_bf16 v[120:123], v[184:187], a[80:83], v[120:123]
  buffer_load_dwordx4 v20, s[44:47], s43 offen offset:1024 sc1 lds
  v_mfma_f32_16x16x32_bf16 v[152:155], v[184:187], a[88:91], v[152:155]
  s_waitcnt lgkmcnt(15)
  v_mfma_f32_16x16x32_bf16 v[124:127], v[188:191], a[80:83], v[124:127]
  buffer_load_dwordx4 v20, s[44:47], s43 offen offset:2048 sc1 lds
  v_mfma_f32_16x16x32_bf16 v[156:159], v[188:191], a[88:91], v[156:159]
  s_waitcnt lgkmcnt(15)
  v_mfma_f32_16x16x32_bf16 v[128:131], v[192:195], a[80:83], v[128:131]
  buffer_load_dwordx4 v20, s[44:47], s43 offen offset:3072 sc1 lds
  v_mfma_f32_16x16x32_bf16 v[160:163], v[192:195], a[88:91], v[160:163]
  s_waitcnt vmcnt(12) lgkmcnt(0)
  s_barrier
  v_mfma_f32_16x16x32_bf16 v[12:15], v[196:199], a[84:87], v[12:15]
  ds_read_b64_tr_b16 v[164:165], v26 offset:0
  ds_read_b64_tr_b16 v[166:167], v27 offset:0
  v_mfma_f32_16x16x32_bf16 v[132:135], v[196:199], a[92:95], v[132:135]
  ds_read_b64_tr_b16 v[168:169], v26 offset:2048
  ds_read_b64_tr_b16 v[170:171], v27 offset:2048
  v_mfma_f32_16x16x32_bf16 v[16:19], v[200:203], a[84:87], v[16:19]
  ds_read_b64_tr_b16 v[172:173], v26 offset:4096
  ds_read_b64_tr_b16 v[174:175], v27 offset:4096
  v_mfma_f32_16x16x32_bf16 v[136:139], v[200:203], a[92:95], v[136:139]
  ds_read_b64_tr_b16 v[176:177], v26 offset:6144
  ds_read_b64_tr_b16 v[178:179], v27 offset:6144
  v_mfma_f32_16x16x32_bf16 v[28:31], v[204:207], a[84:87], v[28:31]
  ds_read_b64_tr_b16 v[180:181], v26 offset:8192
  ds_read_b64_tr_b16 v[182:183], v27 offset:8192
  v_mfma_f32_16x16x32_bf16 v[140:143], v[204:207], a[92:95], v[140:143]
  ds_read_b64_tr_b16 v[184:185], v26 offset:10240
  ds_read_b64_tr_b16 v[186:187], v27 offset:10240
  v_mfma_f32_16x16x32_bf16 v[32:35], v[208:211], a[84:87], v[32:35]
  ds_read_b64_tr_b16 v[188:189], v26 offset:12288
  ds_read_b64_tr_b16 v[190:191], v27 offset:12288
  v_mfma_f32_16x16x32_bf16 v[144:147], v[208:211], a[92:95], v[144:147]
  ds_read_b64_tr_b16 v[192:193], v26 offset:14336
  ds_read_b64_tr_b16 v[194:195], v27 offset:14336
  v_mfma_f32_16x16x32_bf16 v[116:119], v[212:215], a[84:87], v[116:119]
  s_add_u32 m0, s57, 4096
  s_nop 0
  buffer_load_dwordx4 v21, s[44:47], s43 offen offset:0 sc1 lds
  v_mfma_f32_16x16x32_bf16 v[148:151], v[212:215], a[92:95], v[148:151]
  v_mfma_f32_16x16x32_bf16 v[120:123], v[216:219], a[84:87], v[120:123]
  buffer_load_dwordx4 v21, s[44:47], s43 offen offset:1024 sc1 lds
  v_mfma_f32_16x16x32_bf16 v[152:155], v[216:219], a[92:95], v[152:155]
  v_mfma_f32_16x16x32_bf16 v[124:127], v[220:223], a[84:87], v[124:127]
  buffer_load_dwordx4 v21, s[44:47], s43 offen offset:2048 sc1 lds
  v_mfma_f32_16x16x32_bf16 v[156:159], v[220:223], a[92:95], v[156:159]
  v_mfma_f32_16x16x32_bf16 v[128:131], v[224:227], a[84:87], v[128:131]
  buffer_load_dwordx4 v21, s[44:47], s43 offen offset:3072 sc1 lds
  s_add_u32 s43, s43, 32768
  s_and_b32 s43, s43, 0x7ffff
  v_mfma_f32_16x16x32_bf16 v[160:163], v[224:227], a[92:95], v[160:163]
  s_waitcnt lgkmcnt(14)
  v_mfma_f32_16x16x32_bf16 v[12:15], v[164:167], a[96:99], v[12:15]
  ds_read_b64_tr_b16 v[196:197], v26 offset:256
  ds_read_b64_tr_b16 v[198:199], v27 offset:256
  v_mfma_f32_16x16x32_bf16 v[132:135], v[164:167], a[104:107], v[132:135]
  ds_read_b64_tr_b16 v[200:201], v26 offset:2304
  ds_read_b64_tr_b16 v[202:203], v27 offset:2304
  s_waitcnt lgkmcnt(15)
  v_mfma_f32_16x16x32_bf16 v[16:19], v[168:171], a[96:99], v[16:19]
  ds_read_b64_tr_b16 v[204:205], v26 offset:4352
  ds_read_b64_tr_b16 v[206:207], v27 offset:4352
  v_mfma_f32_16x16x32_bf16 v[136:139], v[168:171], a[104:107], v[136:139]
  ds_read_b64_tr_b16 v[208:209], v26 offset:6400
  ds_read_b64_tr_b16 v[210:211], v27 offset:6400
  s_waitcnt lgkmcnt(15)
  v_mfma_f32_16x16x32_bf16 v[28:31], v[172:175], a[96:99], v[28:31]
  ds_read_b64_tr_b16 v[212:213], v26 offset:8448
  ds_read_b64_tr_b16 v[214:215], v27 offset:8448
  v_mfma_f32_16x16x32_bf16 v[140:143], v[172:175], a[104:107], v[140:143]
  ds_read_b64_tr_b16 v[216:217], v26 offset:10496
  ds_read_b64_tr_b16 v[218:219], v27 offset:10496
  s_waitcnt lgkmcnt(15)
  v_mfma_f32_16x16x32_bf16 v[32:35], v[176:179], a[96:99], v[32:35]
  ds_read_b64_tr_b16 v[220:221], v26 offset:12544
  ds_read_b64_tr_b16 v[222:223], v27 offset:12544
  v_mfma_f32_16x16x32_bf16 v[144:147], v[176:179], a[104:107], v[144:147]
  ds_read_b64_tr_b16 v[224:225], v26 offset:14592
  ds_read_b64_tr_b16 v[226:227], v27 offset:14592
  s_waitcnt lgkmcnt(15)
  v_mfma_f32_16x16x32_bf16 v[116:119], v[180:183], a[96:99], v[116:119]
  s_add_u32 m0, s57, 32768
  s_nop 0
  buffer_load_dwordx4 v20, s[44:47], s43 offen offset:0 sc1 lds
  v_mfma_f32_16x16x32_bf16 v[148:151], v[180:183], a[104:107], v[148:151]
  s_waitcnt lgkmcnt(15)
  v_mfma_f32_16x16x32_bf16 v[120:123], v[184:187], a[96:99], v[120:123]
  buffer_load_dwordx4 v20, s[44:47], s43 offen offset:1024 sc1 lds
  v_mfma_f32_16x16x32_bf16 v[152:155], v[184:187], a[104:107], v[152:155]
  s_waitcnt lgkmcnt(15)
  v_mfma_f32_16x16x32_bf16 v[124:127], v[188:191], a[96:99], v[124:127]
  buffer_load_dwordx4 v20, s[44:47], s43 offen offset:2048 sc1 lds
  v_mfma_f32_16x16x32_bf16 v[156:159], v[188:191], a[104:107], v[156:159]
  s_waitcnt lgkmcnt(15)
  v_mfma_f32_16x16x32_bf16 v[128:131], v[192:195], a[96:99], v[128:131]
  buffer_load_dwordx4 v20, s[44:47], s43 offen offset:3072 sc1 lds
  v_mfma_f32_16x16x32_bf16 v[160:163], v[192:195], a[104:107], v[160:163]
  s_waitcnt vmcnt(12) lgkmcnt(0)
  s_barrier
  v_mfma_f32_16x16x32_bf16 v[12:15], v[196:199], a[100:103], v[12:15]
  ds_read_b64_tr_b16 v[164:165], v26 offset:32768
  ds_read_b64_tr_b16 v[166:167], v27 offset:32768
  v_mfma_f32_16x16x32_bf16 v[132:135], v[196:199], a[108:111], v[132:135]
  ds_read_b64_tr_b16 v[168:169], v26 offset:34816
  ds_read_b64_tr_b16 v[170:171], v27 offset:34816
  v_mfma_f32_16x16x32_bf16 v[16:19], v[200:203], a[100:103], v[16:19]
  ds_read_b64_tr_b16 v[172:173], v26 offset:36864
  ds_read_b64_tr_b16 v[174:175], v27 offset:36864
  v_mfma_f32_16x16x32_bf16 v[136:139], v[200:203], a[108:111], v[136:139]
  ds_read_b64_tr_b16 v[176:177], v26 offset:38912
  ds_read_b64_tr_b16 v[178:179], v27 offset:38912
  v_mfma_f32_16x16x32_bf16 v[28:31], v[204:207], a[100:103], v[28:31]
  ds_read_b64_tr_b16 v[180:181], v26 offset:40960
  ds_read_b64_tr_b16 v[182:183], v27 offset:40960
  v_mfma_f32_16x16x32_bf16 v[140:143], v[204:207], a[108:111], v[140:143]
  ds_read_b64_tr_b16 v[184:185], v26 offset:43008
  ds_read_b64_tr_b16 v[186:187], v27 offset:43008
  v_mfma_f32_16x16x32_bf16 v[32:35], v[208:211], a[100:103], v[32:35]
  ds_read_b64_tr_b16 v[188:189], v26 offset:45056
  ds_read_b64_tr_b16 v[190:191], v27 offset:45056
  v_mfma_f32_16x16x32_bf16 v[144:147], v[208:211], a[108:111], v[144:147]
  ds_read_b64_tr_b16 v[192:193], v26 offset:47104
  ds_read_b64_tr_b16 v[194:195], v27 offset:47104
  v_mfma_f32_16x16x32_bf16 v[116:119], v[212:215], a[100:103], v[116:119]
  s_add_u32 m0, s57, 36864
  s_nop 0
  buffer_load_dwordx4 v21, s[44:47], s43 offen offset:0 sc1 lds
  v_mfma_f32_16x16x32_bf16 v[148:151], v[212:215], a[108:111], v[148:151]
  v_mfma_f32_16x16x32_bf16 v[120:123], v[216:219], a[100:103], v[120:123]
  buffer_load_dwordx4 v21, s[44:47], s43 offen offset:1024 sc1 lds
  v_mfma_f32_16x16x32_bf16 v[152:155], v[216:219], a[108:111], v[152:155]
  v_mfma_f32_16x16x32_bf16 v[124:127], v[220:223], a[100:103], v[124:127]
  buffer_load_dwordx4 v21, s[44:47], s43 offen offset:2048 sc1 lds
  v_mfma_f32_16x16x32_bf16 v[156:159], v[220:223], a[108:111], v[156:159]
  v_mfma_f32_16x16x32_bf16 v[128:131], v[224:227], a[100:103], v[128:131]
  buffer_load_dwordx4 v21, s[44:47], s43 offen offset:3072 sc1 lds
  s_add_u32 s43, s43, 32768
  s_and_b32 s43, s43, 0x7ffff
  v_mfma_f32_16x16x32_bf16 v[160:163], v[224:227], a[108:111], v[160:163]
  s_waitcnt lgkmcnt(14)
  v_mfma_f32_16x16x32_bf16 v[12:15], v[164:167], a[112:115], v[12:15]
  ds_read_b64_tr_b16 v[196:197], v26 offset:33024
  ds_read_b64_tr_b16 v[198:199], v27 offset:33024
  v_mfma_f32_16x16x32_bf16 v[132:135], v[164:167], a[120:123], v[132:135]
  ds_read_b64_tr_b16 v[200:201], v26 offset:35072
  ds_read_b64_tr_b16 v[202:203], v27 offset:35072
  s_waitcnt lgkmcnt(15)
  v_mfma_f32_16x16x32_bf16 v[16:19], v[168:171], a[112:115], v[16:19]
  ds_read_b64_tr_b16 v[204:205], v26 offset:37120
  ds_read_b64_tr_b16 v[206:207], v27 offset:37120
  v_mfma_f32_16x16x32_bf16 v[136:139], v[168:171], a[120:123], v[136:139]
  ds_read_b64_tr_b16 v[208:209], v26 offset:39168
  ds_read_b64_tr_b16 v[210:211], v27 offset:39168
  s_waitcnt lgkmcnt(15)
  v_mfma_f32_16x16x32_bf16 v[28:31], v[172:175], a[112:115], v[28:31]
  ds_read_b64_tr_b16 v[212:213], v26 offset:41216
  ds_read_b64_tr_b16 v[214:215], v27 offset:41216
  v_mfma_f32_16x16x32_bf16 v[140:143], v[172:175], a[120:123], v[140:143]
  ds_read_b64_tr_b16 v[216:217], v26 offset:43264
  ds_read_b64_tr_b16 v[218:219], v27 offset:43264
  s_waitcnt lgkmcnt(15)
  v_mfma_f32_16x16x32_bf16 v[32:35], v[176:179], a[112:115], v[32:35]
  ds_read_b64_tr_b16 v[220:221], v26 offset:45312
  ds_read_b64_tr_b16 v[222:223], v27 offset:45312
  v_mfma_f32_16x16x32_bf16 v[144:147], v[176:179], a[120:123], v[144:147]
  ds_read_b64_tr_b16 v[224:225], v26 offset:47360
  ds_read_b64_tr_b16 v[226:227], v27 offset:47360
  s_waitcnt lgkmcnt(15)
  v_mfma_f32_16x16x32_bf16 v[116:119], v[180:183], a[112:115], v[116:119]
  s_add_u32 m0, s57, 65536
  s_nop 0
  buffer_load_dwordx4 v20, s[44:47], s43 offen offset:0 sc1 lds
  v_mfma_f32_16x16x32_bf16 v[148:151], v[180:183], a[120:123], v[148:151]
  s_waitcnt lgkmcnt(15)
  v_mfma_f32_16x16x32_bf16 v[120:123], v[184:187], a[112:115], v[120:123]
  buffer_load_dwordx4 v20, s[44:47], s43 offen offset:1024 sc1 lds
  v_mfma_f32_16x16x32_bf16 v[152:155], v[184:187], a[120:123], v[152:155]
  s_waitcnt lgkmcnt(15)
  v_mfma_f32_16x16x32_bf16 v[124:127], v[188:191], a[112:115], v[124:127]
  buffer_load_dwordx4 v20, s[44:47], s43 offen offset:2048 sc1 lds
  v_mfma_f32_16x16x32_bf16 v[156:159], v[188:191], a[120:123], v[156:159]
  s_waitcnt lgkmcnt(15)
  v_mfma_f32_16x16x32_bf16 v[128:131], v[192:195], a[112:115], v[128:131]
  buffer_load_dwordx4 v20, s[44:47], s43 offen offset:3072 sc1 lds
  v_mfma_f32_16x16x32_bf16 v[160:163], v[192:195], a[120:123], v[160:163]
  s_waitcnt vmcnt(12) lgkmcnt(0)
  s_barrier
  v_mfma_f32_16x16x32_bf16 v[12:15], v[196:199], a[116:119], v[12:15]
  ds_read_b64_tr_b16 v[164:165], v24 offset:0
  ds_read_b64_tr_b16 v[166:167], v25 offset:0
  v_mfma_f32_16x16x32_bf16 v[132:135], v[196:199], a[124:127], v[132:135]
  ds_read_b64_tr_b16 v[168:169], v24 offset:2048
  ds_read_b64_tr_b16 v[170:171], v25 offset:2048
  v_mfma_f32_16x16x32_bf16 v[16:19], v[200:203], a[116:119], v[16:19]
  ds_read_b64_tr_b16 v[172:173], v24 offset:4096
  ds_read_b64_tr_b16 v[174:175], v25 offset:4096
  v_mfma_f32_16x16x32_bf16 v[136:139], v[200:203], a[124:127], v[136:139]
  ds_read_b64_tr_b16 v[176:177], v24 offset:6144
  ds_read_b64_tr_b16 v[178:179], v25 offset:6144
  v_mfma_f32_16x16x32_bf16 v[28:31], v[204:207], a[116:119], v[28:31]
  ds_read_b64_tr_b16 v[180:181], v24 offset:8192
  ds_read_b64_tr_b16 v[182:183], v25 offset:8192
  v_mfma_f32_16x16x32_bf16 v[140:143], v[204:207], a[124:127], v[140:143]
  ds_read_b64_tr_b16 v[184:185], v24 offset:10240
  ds_read_b64_tr_b16 v[186:187], v25 offset:10240
  v_mfma_f32_16x16x32_bf16 v[32:35], v[208:211], a[116:119], v[32:35]
  ds_read_b64_tr_b16 v[188:189], v24 offset:12288
  ds_read_b64_tr_b16 v[190:191], v25 offset:12288
  v_mfma_f32_16x16x32_bf16 v[144:147], v[208:211], a[124:127], v[144:147]
  ds_read_b64_tr_b16 v[192:193], v24 offset:14336
  ds_read_b64_tr_b16 v[194:195], v25 offset:14336
  v_mfma_f32_16x16x32_bf16 v[116:119], v[212:215], a[116:119], v[116:119]
  s_add_u32 m0, s57, 69632
  s_nop 0
  buffer_load_dwordx4 v21, s[44:47], s43 offen offset:0 sc1 lds
  v_mfma_f32_16x16x32_bf16 v[148:151], v[212:215], a[124:127], v[148:151]
  v_mfma_f32_16x16x32_bf16 v[120:123], v[216:219], a[116:119], v[120:123]
  buffer_load_dwordx4 v21, s[44:47], s43 offen offset:1024 sc1 lds
  v_mfma_f32_16x16x32_bf16 v[152:155], v[216:219], a[124:127], v[152:155]
  v_mfma_f32_16x16x32_bf16 v[124:127], v[220:223], a[116:119], v[124:127]
  buffer_load_dwordx4 v21, s[44:47], s43 offen offset:2048 sc1 lds
  v_mfma_f32_16x16x32_bf16 v[156:159], v[220:223], a[124:127], v[156:159]
  v_mfma_f32_16x16x32_bf16 v[128:131], v[224:227], a[116:119], v[128:131]
  buffer_load_dwordx4 v21, s[44:47], s43 offen offset:3072 sc1 lds
  s_add_u32 s43, s43, 32768
  s_and_b32 s43, s43, 0x7ffff
  v_mfma_f32_16x16x32_bf16 v[160:163], v[224:227], a[124:127], v[160:163]
  s_waitcnt lgkmcnt(14)
  v_mfma_f32_16x16x32_bf16 v[12:15], v[164:167], a[128:131], v[12:15]
  ds_read_b64_tr_b16 v[196:197], v24 offset:256
  ds_read_b64_tr_b16 v[198:199], v25 offset:256
  v_mfma_f32_16x16x32_bf16 v[132:135], v[164:167], a[136:139], v[132:135]
  ds_read_b64_tr_b16 v[200:201], v24 offset:2304
  ds_read_b64_tr_b16 v[202:203], v25 offset:2304
  s_waitcnt lgkmcnt(15)
  v_mfma_f32_16x16x32_bf16 v[16:19], v[168:171], a[128:131], v[16:19]
  ds_read_b64_tr_b16 v[204:205], v24 offset:4352
  ds_read_b64_tr_b16 v[206:207], v25 offset:4352
  v_mfma_f32_16x16x32_bf16 v[136:139], v[168:171], a[136:139], v[136:139]
  ds_read_b64_tr_b16 v[208:209], v24 offset:6400
  ds_read_b64_tr_b16 v[210:211], v25 offset:6400
  s_waitcnt lgkmcnt(15)
  v_mfma_f32_16x16x32_bf16 v[28:31], v[172:175], a[128:131], v[28:31]
  ds_read_b64_tr_b16 v[212:213], v24 offset:8448
  ds_read_b64_tr_b16 v[214:215], v25 offset:8448
  v_mfma_f32_16x16x32_bf16 v[140:143], v[172:175], a[136:139], v[140:143]
  ds_read_b64_tr_b16 v[216:217], v24 offset:10496
  ds_read_b64_tr_b16 v[218:219], v25 offset:10496
  s_waitcnt lgkmcnt(15)
  v_mfma_f32_16x16x32_bf16 v[32:35], v[176:179], a[128:131], v[32:35]
  ds_read_b64_tr_b16 v[220:221], v24 offset:12544
  ds_read_b64_tr_b16 v[222:223], v25 offset:12544
  v_mfma_f32_16x16x32_bf16 v[144:147], v[176:179], a[136:139], v[144:147]
  ds_read_b64_tr_b16 v[224:225], v24 offset:14592
  ds_read_b64_tr_b16 v[226:227], v25 offset:14592
  s_waitcnt lgkmcnt(15)
  v_mfma_f32_16x16x32_bf16 v[116:119], v[180:183], a[128:131], v[116:119]
  s_add_u32 m0, s57, 98304
  s_nop 0
  buffer_load_dwordx4 v20, s[44:47], s43 offen offset:0 sc1 lds
  v_mfma_f32_16x16x32_bf16 v[148:151], v[180:183], a[136:139], v[148:151]
  s_waitcnt lgkmcnt(15)
  v_mfma_f32_16x16x32_bf16 v[120:123], v[184:187], a[128:131], v[120:123]
  buffer_load_dwordx4 v20, s[44:47], s43 offen offset:1024 sc1 lds
  v_mfma_f32_16x16x32_bf16 v[152:155], v[184:187], a[136:139], v[152:155]
  s_waitcnt lgkmcnt(15)
  v_mfma_f32_16x16x32_bf16 v[124:127], v[188:191], a[128:131], v[124:127]
  buffer_load_dwordx4 v20, s[44:47], s43 offen offset:2048 sc1 lds
  v_mfma_f32_16x16x32_bf16 v[156:159], v[188:191], a[136:139], v[156:159]
  s_waitcnt lgkmcnt(15)
  v_mfma_f32_16x16x32_bf16 v[128:131], v[192:195], a[128:131], v[128:131]
  buffer_load_dwordx4 v20, s[44:47], s43 offen offset:3072 sc1 lds
  v_mfma_f32_16x16x32_bf16 v[160:163], v[192:195], a[136:139], v[160:163]
  s_waitcnt vmcnt(12) lgkmcnt(0)
  s_barrier
  v_mfma_f32_16x16x32_bf16 v[12:15], v[196:199], a[132:135], v[12:15]
  ds_read_b64_tr_b16 v[164:165], v24 offset:32768
  ds_read_b64_tr_b16 v[166:167], v25 offset:32768
  v_mfma_f32_16x16x32_bf16 v[132:135], v[196:199], a[140:143], v[132:135]
  ds_read_b64_tr_b16 v[168:169], v24 offset:34816
  ds_read_b64_tr_b16 v[170:171], v25 offset:34816
  v_mfma_f32_16x16x32_bf16 v[16:19], v[200:203], a[132:135], v[16:19]
  ds_read_b64_tr_b16 v[172:173], v24 offset:36864
  ds_read_b64_tr_b16 v[174:175], v25 offset:36864
  v_mfma_f32_16x16x32_bf16 v[136:139], v[200:203], a[140:143], v[136:139]
  ds_read_b64_tr_b16 v[176:177], v24 offset:38912
  ds_read_b64_tr_b16 v[178:179], v25 offset:38912
  v_mfma_f32_16x16x32_bf16 v[28:31], v[204:207], a[132:135], v[28:31]
  ds_read_b64_tr_b16 v[180:181], v24 offset:40960
  ds_read_b64_tr_b16 v[182:183], v25 offset:40960
  v_mfma_f32_16x16x32_bf16 v[140:143], v[204:207], a[140:143], v[140:143]
  ds_read_b64_tr_b16 v[184:185], v24 offset:43008
  ds_read_b64_tr_b16 v[186:187], v25 offset:43008
  v_mfma_f32_16x16x32_bf16 v[32:35], v[208:211], a[132:135], v[32:35]
  ds_read_b64_tr_b16 v[188:189], v24 offset:45056
  ds_read_b64_tr_b16 v[190:191], v25 offset:45056
  v_mfma_f32_16x16x32_bf16 v[144:147], v[208:211], a[140:143], v[144:147]
  ds_read_b64_tr_b16 v[192:193], v24 offset:47104
  ds_read_b64_tr_b16 v[194:195], v25 offset:47104
  v_mfma_f32_16x16x32_bf16 v[116:119], v[212:215], a[132:135], v[116:119]
  s_add_u32 m0, s57, 102400
  s_nop 0
  buffer_load_dwordx4 v21, s[44:47], s43 offen offset:0 sc1 lds
  v_mfma_f32_16x16x32_bf16 v[148:151], v[212:215], a[140:143], v[148:151]
  v_mfma_f32_16x16x32_bf16 v[120:123], v[216:219], a[132:135], v[120:123]
  buffer_load_dwordx4 v21, s[44:47], s43 offen offset:1024 sc1 lds
  v_mfma_f32_16x16x32_bf16 v[152:155], v[216:219], a[140:143], v[152:155]
  v_mfma_f32_16x16x32_bf16 v[124:127], v[220:223], a[132:135], v[124:127]
  buffer_load_dwordx4 v21, s[44:47], s43 offen offset:2048 sc1 lds
  v_mfma_f32_16x16x32_bf16 v[156:159], v[220:223], a[140:143], v[156:159]
  v_mfma_f32_16x16x32_bf16 v[128:131], v[224:227], a[132:135], v[128:131]
  buffer_load_dwordx4 v21, s[44:47], s43 offen offset:3072 sc1 lds
  s_add_u32 s43, s43, 32768
  s_and_b32 s43, s43, 0x7ffff
  v_mfma_f32_16x16x32_bf16 v[160:163], v[224:227], a[140:143], v[160:163]
  s_waitcnt lgkmcnt(14)
  v_mfma_f32_16x16x32_bf16 v[12:15], v[164:167], a[144:147], v[12:15]
  ds_read_b64_tr_b16 v[196:197], v24 offset:33024
  ds_read_b64_tr_b16 v[198:199], v25 offset:33024
  v_mfma_f32_16x16x32_bf16 v[132:135], v[164:167], a[152:155], v[132:135]
  ds_read_b64_tr_b16 v[200:201], v24 offset:35072
  ds_read_b64_tr_b16 v[202:203], v25 offset:35072
  s_waitcnt lgkmcnt(15)
  v_mfma_f32_16x16x32_bf16 v[16:19], v[168:171], a[144:147], v[16:19]
  ds_read_b64_tr_b16 v[204:205], v24 offset:37120
  ds_read_b64_tr_b16 v[206:207], v25 offset:37120
  v_mfma_f32_16x16x32_bf16 v[136:139], v[168:171], a[152:155], v[136:139]
  ds_read_b64_tr_b16 v[208:209], v24 offset:39168
  ds_read_b64_tr_b16 v[210:211], v25 offset:39168
  s_waitcnt lgkmcnt(15)
  v_mfma_f32_16x16x32_bf16 v[28:31], v[172:175], a[144:147], v[28:31]
  ds_read_b64_tr_b16 v[212:213], v24 offset:41216
  ds_read_b64_tr_b16 v[214:215], v25 offset:41216
  v_mfma_f32_16x16x32_bf16 v[140:143], v[172:175], a[152:155], v[140:143]
  ds_read_b64_tr_b16 v[216:217], v24 offset:43264
  ds_read_b64_tr_b16 v[218:219], v25 offset:43264
  s_waitcnt lgkmcnt(15)
  v_mfma_f32_16x16x32_bf16 v[32:35], v[176:179], a[144:147], v[32:35]
  ds_read_b64_tr_b16 v[220:221], v24 offset:45312
  ds_read_b64_tr_b16 v[222:223], v25 offset:45312
  v_mfma_f32_16x16x32_bf16 v[144:147], v[176:179], a[152:155], v[144:147]
  ds_read_b64_tr_b16 v[224:225], v24 offset:47360
  ds_read_b64_tr_b16 v[226:227], v25 offset:47360
  s_waitcnt lgkmcnt(15)
  v_mfma_f32_16x16x32_bf16 v[116:119], v[180:183], a[144:147], v[116:119]
  s_add_u32 m0, s57, 0
  s_nop 0
  buffer_load_dwordx4 v20, s[44:47], s43 offen offset:0 sc1 lds
  v_mfma_f32_16x16x32_bf16 v[148:151], v[180:183], a[152:155], v[148:151]
  s_waitcnt lgkmcnt(15)
  v_mfma_f32_16x16x32_bf16 v[120:123], v[184:187], a[144:147], v[120:123]
  buffer_load_dwordx4 v20, s[44:47], s43 offen offset:1024 sc1 lds
  v_mfma_f32_16x16x32_bf16 v[152:155], v[184:187], a[152:155], v[152:155]
  s_waitcnt lgkmcnt(15)
  v_mfma_f32_16x16x32_bf16 v[124:127], v[188:191], a[144:147], v[124:127]
  buffer_load_dwordx4 v20, s[44:47], s43 offen offset:2048 sc1 lds
  v_mfma_f32_16x16x32_bf16 v[156:159], v[188:191], a[152:155], v[156:159]
  s_waitcnt lgkmcnt(15)
  v_mfma_f32_16x16x32_bf16 v[128:131], v[192:195], a[144:147], v[128:131]
  buffer_load_dwordx4 v20, s[44:47], s43 offen offset:3072 sc1 lds
  v_mfma_f32_16x16x32_bf16 v[160:163], v[192:195], a[152:155], v[160:163]
  s_waitcnt vmcnt(12) lgkmcnt(0)
  s_barrier
  v_mfma_f32_16x16x32_bf16 v[12:15], v[196:199], a[148:151], v[12:15]
  ds_read_b64_tr_b16 v[164:165], v26 offset:0
  ds_read_b64_tr_b16 v[166:167], v27 offset:0
  v_mfma_f32_16x16x32_bf16 v[132:135], v[196:199], a[156:159], v[132:135]
  ds_read_b64_tr_b16 v[168:169], v26 offset:2048
  ds_read_b64_tr_b16 v[170:171], v27 offset:2048
  v_mfma_f32_16x16x32_bf16 v[16:19], v[200:203], a[148:151], v[16:19]
  ds_read_b64_tr_b16 v[172:173], v26 offset:4096
  ds_read_b64_tr_b16 v[174:175], v27 offset:4096
  v_mfma_f32_16x16x32_bf16 v[136:139], v[200:203], a[156:159], v[136:139]
  ds_read_b64_tr_b16 v[176:177], v26 offset:6144
  ds_read_b64_tr_b16 v[178:179], v27 offset:6144
  v_mfma_f32_16x16x32_bf16 v[28:31], v[204:207], a[148:151], v[28:31]
  ds_read_b64_tr_b16 v[180:181], v26 offset:8192
  ds_read_b64_tr_b16 v[182:183], v27 offset:8192
  v_mfma_f32_16x16x32_bf16 v[140:143], v[204:207], a[156:159], v[140:143]
  ds_read_b64_tr_b16 v[184:185], v26 offset:10240
  ds_read_b64_tr_b16 v[186:187], v27 offset:10240
  v_mfma_f32_16x16x32_bf16 v[32:35], v[208:211], a[148:151], v[32:35]
  ds_read_b64_tr_b16 v[188:189], v26 offset:12288
  ds_read_b64_tr_b16 v[190:191], v27 offset:12288
  v_mfma_f32_16x16x32_bf16 v[144:147], v[208:211], a[156:159], v[144:147]
  ds_read_b64_tr_b16 v[192:193], v26 offset:14336
  ds_read_b64_tr_b16 v[194:195], v27 offset:14336
  v_mfma_f32_16x16x32_bf16 v[116:119], v[212:215], a[148:151], v[116:119]
  s_add_u32 m0, s57, 4096
  s_nop 0
  buffer_load_dwordx4 v21, s[44:47], s43 offen offset:0 sc1 lds
  v_mfma_f32_16x16x32_bf16 v[148:151], v[212:215], a[156:159], v[148:151]
  v_mfma_f32_16x16x32_bf16 v[120:123], v[216:219], a[148:151], v[120:123]
  buffer_load_dwordx4 v21, s[44:47], s43 offen offset:1024 sc1 lds
  v_mfma_f32_16x16x32_bf16 v[152:155], v[216:219], a[156:159], v[152:155]
  v_mfma_f32_16x16x32_bf16 v[124:127], v[220:223], a[148:151], v[124:127]
  buffer_load_dwordx4 v21, s[44:47], s43 offen offset:2048 sc1 lds
  v_mfma_f32_16x16x32_bf16 v[156:159], v[220:223], a[156:159], v[156:159]
  v_mfma_f32_16x16x32_bf16 v[128:131], v[224:227], a[148:151], v[128:131]
  buffer_load_dwordx4 v21, s[44:47], s43 offen offset:3072 sc1 lds
  s_add_u32 s43, s43, 32768
  s_and_b32 s43, s43, 0x7ffff
  v_mfma_f32_16x16x32_bf16 v[160:163], v[224:227], a[156:159], v[160:163]
  s_waitcnt lgkmcnt(14)
  v_mfma_f32_16x16x32_bf16 v[12:15], v[164:167], a[160:163], v[12:15]
  ds_read_b64_tr_b16 v[196:197], v26 offset:256
  ds_read_b64_tr_b16 v[198:199], v27 offset:256
  v_mfma_f32_16x16x32_bf16 v[132:135], v[164:167], a[168:171], v[132:135]
  ds_read_b64_tr_b16 v[200:201], v26 offset:2304
  ds_read_b64_tr_b16 v[202:203], v27 offset:2304
  s_waitcnt lgkmcnt(15)
  v_mfma_f32_16x16x32_bf16 v[16:19], v[168:171], a[160:163], v[16:19]
  ds_read_b64_tr_b16 v[204:205], v26 offset:4352
  ds_read_b64_tr_b16 v[206:207], v27 offset:4352
  v_mfma_f32_16x16x32_bf16 v[136:139], v[168:171], a[168:171], v[136:139]
  ds_read_b64_tr_b16 v[208:209], v26 offset:6400
  ds_read_b64_tr_b16 v[210:211], v27 offset:6400
  s_waitcnt lgkmcnt(15)
  v_mfma_f32_16x16x32_bf16 v[28:31], v[172:175], a[160:163], v[28:31]
  ds_read_b64_tr_b16 v[212:213], v26 offset:8448
  ds_read_b64_tr_b16 v[214:215], v27 offset:8448
  v_mfma_f32_16x16x32_bf16 v[140:143], v[172:175], a[168:171], v[140:143]
  ds_read_b64_tr_b16 v[216:217], v26 offset:10496
  ds_read_b64_tr_b16 v[218:219], v27 offset:10496
  s_waitcnt lgkmcnt(15)
  v_mfma_f32_16x16x32_bf16 v[32:35], v[176:179], a[160:163], v[32:35]
  ds_read_b64_tr_b16 v[220:221], v26 offset:12544
  ds_read_b64_tr_b16 v[222:223], v27 offset:12544
  v_mfma_f32_16x16x32_bf16 v[144:147], v[176:179], a[168:171], v[144:147]
  ds_read_b64_tr_b16 v[224:225], v26 offset:14592
  ds_read_b64_tr_b16 v[226:227], v27 offset:14592
  s_waitcnt lgkmcnt(15)
  v_mfma_f32_16x16x32_bf16 v[116:119], v[180:183], a[160:163], v[116:119]
  s_add_u32 m0, s57, 32768
  s_nop 0
  buffer_load_dwordx4 v20, s[44:47], s43 offen offset:0 sc1 lds
  v_mfma_f32_16x16x32_bf16 v[148:151], v[180:183], a[168:171], v[148:151]
  s_waitcnt lgkmcnt(15)
  v_mfma_f32_16x16x32_bf16 v[120:123], v[184:187], a[160:163], v[120:123]
  buffer_load_dwordx4 v20, s[44:47], s43 offen offset:1024 sc1 lds
  v_mfma_f32_16x16x32_bf16 v[152:155], v[184:187], a[168:171], v[152:155]
  s_waitcnt lgkmcnt(15)
  v_mfma_f32_16x16x32_bf16 v[124:127], v[188:191], a[160:163], v[124:127]
  buffer_load_dwordx4 v20, s[44:47], s43 offen offset:2048 sc1 lds
  v_mfma_f32_16x16x32_bf16 v[156:159], v[188:191], a[168:171], v[156:159]
  s_waitcnt lgkmcnt(15)
  v_mfma_f32_16x16x32_bf16 v[128:131], v[192:195], a[160:163], v[128:131]
  buffer_load_dwordx4 v20, s[44:47], s43 offen offset:3072 sc1 lds
  v_mfma_f32_16x16x32_bf16 v[160:163], v[192:195], a[168:171], v[160:163]
  s_waitcnt vmcnt(12) lgkmcnt(0)
  s_barrier
  v_mfma_f32_16x16x32_bf16 v[12:15], v[196:199], a[164:167], v[12:15]
  ds_read_b64_tr_b16 v[164:165], v26 offset:32768
  ds_read_b64_tr_b16 v[166:167], v27 offset:32768
  v_mfma_f32_16x16x32_bf16 v[132:135], v[196:199], a[172:175], v[132:135]
  ds_read_b64_tr_b16 v[168:169], v26 offset:34816
  ds_read_b64_tr_b16 v[170:171], v27 offset:34816
  v_mfma_f32_16x16x32_bf16 v[16:19], v[200:203], a[164:167], v[16:19]
  ds_read_b64_tr_b16 v[172:173], v26 offset:36864
  ds_read_b64_tr_b16 v[174:175], v27 offset:36864
  v_mfma_f32_16x16x32_bf16 v[136:139], v[200:203], a[172:175], v[136:139]
  ds_read_b64_tr_b16 v[176:177], v26 offset:38912
  ds_read_b64_tr_b16 v[178:179], v27 offset:38912
  v_mfma_f32_16x16x32_bf16 v[28:31], v[204:207], a[164:167], v[28:31]
  ds_read_b64_tr_b16 v[180:181], v26 offset:40960
  ds_read_b64_tr_b16 v[182:183], v27 offset:40960
  v_mfma_f32_16x16x32_bf16 v[140:143], v[204:207], a[172:175], v[140:143]
  ds_read_b64_tr_b16 v[184:185], v26 offset:43008
  ds_read_b64_tr_b16 v[186:187], v27 offset:43008
  v_mfma_f32_16x16x32_bf16 v[32:35], v[208:211], a[164:167], v[32:35]
  ds_read_b64_tr_b16 v[188:189], v26 offset:45056
  ds_read_b64_tr_b16 v[190:191], v27 offset:45056
  v_mfma_f32_16x16x32_bf16 v[144:147], v[208:211], a[172:175], v[144:147]
  ds_read_b64_tr_b16 v[192:193], v26 offset:47104
  ds_read_b64_tr_b16 v[194:195], v27 offset:47104
  v_mfma_f32_16x16x32_bf16 v[116:119], v[212:215], a[164:167], v[116:119]
  s_add_u32 m0, s57, 36864
  s_nop 0
  buffer_load_dwordx4 v21, s[44:47], s43 offen offset:0 sc1 lds
  v_mfma_f32_16x16x32_bf16 v[148:151], v[212:215], a[172:175], v[148:151]
  buffer_load_dword v9, v7, s[48:51], s42 offen sc1
  v_mfma_f32_16x16x32_bf16 v[120:123], v[216:219], a[164:167], v[120:123]
  buffer_load_dwordx4 v21, s[44:47], s43 offen offset:1024 sc1 lds
  v_mfma_f32_16x16x32_bf16 v[152:155], v[216:219], a[172:175], v[152:155]
  v_mfma_f32_16x16x32_bf16 v[124:127], v[220:223], a[164:167], v[124:127]
  buffer_load_dwordx4 v21, s[44:47], s43 offen offset:2048 sc1 lds
  v_mfma_f32_16x16x32_bf16 v[156:159], v[220:223], a[172:175], v[156:159]
  v_mfma_f32_16x16x32_bf16 v[128:131], v[224:227], a[164:167], v[128:131]
  buffer_load_dwordx4 v21, s[44:47], s43 offen offset:3072 sc1 lds
  s_add_u32 s43, s43, 32768
  s_and_b32 s43, s43, 0x7ffff
  v_mfma_f32_16x16x32_bf16 v[160:163], v[224:227], a[172:175], v[160:163]
  s_waitcnt lgkmcnt(14)
  v_mfma_f32_16x16x32_bf16 v[12:15], v[164:167], a[176:179], v[12:15]
  ds_read_b64_tr_b16 v[196:197], v26 offset:33024
  ds_read_b64_tr_b16 v[198:199], v27 offset:33024
  v_mfma_f32_16x16x32_bf16 v[132:135], v[164:167], a[184:187], v[132:135]
  ds_read_b64_tr_b16 v[200:201], v26 offset:35072
  ds_read_b64_tr_b16 v[202:203], v27 offset:35072
  s_waitcnt lgkmcnt(15)
  v_mfma_f32_16x16x32_bf16 v[16:19], v[168:171], a[176:179], v[16:19]
  ds_read_b64_tr_b16 v[204:205], v26 offset:37120
  ds_read_b64_tr_b16 v[206:207], v27 offset:37120
  v_mfma_f32_16x16x32_bf16 v[136:139], v[168:171], a[184:187], v[136:139]
  ds_read_b64_tr_b16 v[208:209], v26 offset:39168
  ds_read_b64_tr_b16 v[210:211], v27 offset:39168
  s_waitcnt lgkmcnt(15)
  v_mfma_f32_16x16x32_bf16 v[28:31], v[172:175], a[176:179], v[28:31]
  ds_read_b64_tr_b16 v[212:213], v26 offset:41216
  ds_read_b64_tr_b16 v[214:215], v27 offset:41216
  v_mfma_f32_16x16x32_bf16 v[140:143], v[172:175], a[184:187], v[140:143]
  ds_read_b64_tr_b16 v[216:217], v26 offset:43264
  ds_read_b64_tr_b16 v[218:219], v27 offset:43264
  s_waitcnt lgkmcnt(15)
  v_mfma_f32_16x16x32_bf16 v[32:35], v[176:179], a[176:179], v[32:35]
  ds_read_b64_tr_b16 v[220:221], v26 offset:45312
  ds_read_b64_tr_b16 v[222:223], v27 offset:45312
  v_mfma_f32_16x16x32_bf16 v[144:147], v[176:179], a[184:187], v[144:147]
  ds_read_b64_tr_b16 v[224:225], v26 offset:47360
  ds_read_b64_tr_b16 v[226:227], v27 offset:47360
  s_waitcnt lgkmcnt(15)
  v_mfma_f32_16x16x32_bf16 v[116:119], v[180:183], a[176:179], v[116:119]
  s_add_u32 m0, s57, 65536
  s_nop 0
  buffer_load_dwordx4 v20, s[44:47], s43 offen offset:0 sc1 lds
  v_mfma_f32_16x16x32_bf16 v[148:151], v[180:183], a[184:187], v[148:151]
  s_waitcnt lgkmcnt(15)
  v_mfma_f32_16x16x32_bf16 v[120:123], v[184:187], a[176:179], v[120:123]
  buffer_load_dwordx4 v20, s[44:47], s43 offen offset:1024 sc1 lds
  v_mfma_f32_16x16x32_bf16 v[152:155], v[184:187], a[184:187], v[152:155]
  s_waitcnt lgkmcnt(15)
  v_mfma_f32_16x16x32_bf16 v[124:127], v[188:191], a[176:179], v[124:127]
  buffer_load_dwordx4 v20, s[44:47], s43 offen offset:2048 sc1 lds
  v_mfma_f32_16x16x32_bf16 v[156:159], v[188:191], a[184:187], v[156:159]
  s_waitcnt lgkmcnt(15)
  v_mfma_f32_16x16x32_bf16 v[128:131], v[192:195], a[176:179], v[128:131]
  buffer_load_dwordx4 v20, s[44:47], s43 offen offset:3072 sc1 lds
  v_mfma_f32_16x16x32_bf16 v[160:163], v[192:195], a[184:187], v[160:163]
  s_waitcnt vmcnt(13) lgkmcnt(0)
  s_barrier
  v_mfma_f32_16x16x32_bf16 v[12:15], v[196:199], a[180:183], v[12:15]
  ds_read_b64_tr_b16 v[164:165], v24 offset:0
  ds_read_b64_tr_b16 v[166:167], v25 offset:0
  v_mfma_f32_16x16x32_bf16 v[132:135], v[196:199], a[188:191], v[132:135]
  ds_read_b64_tr_b16 v[168:169], v24 offset:2048
  ds_read_b64_tr_b16 v[170:171], v25 offset:2048
  v_mfma_f32_16x16x32_bf16 v[16:19], v[200:203], a[180:183], v[16:19]
  ds_read_b64_tr_b16 v[172:173], v24 offset:4096
  ds_read_b64_tr_b16 v[174:175], v25 offset:4096
  v_mfma_f32_16x16x32_bf16 v[136:139], v[200:203], a[188:191], v[136:139]
  ds_read_b64_tr_b16 v[176:177], v24 offset:6144
  ds_read_b64_tr_b16 v[178:179], v25 offset:6144
  v_mfma_f32_16x16x32_bf16 v[28:31], v[204:207], a[180:183], v[28:31]
  ds_read_b64_tr_b16 v[180:181], v24 offset:8192
  ds_read_b64_tr_b16 v[182:183], v25 offset:8192
  v_mfma_f32_16x16x32_bf16 v[140:143], v[204:207], a[188:191], v[140:143]
  ds_read_b64_tr_b16 v[184:185], v24 offset:10240
  ds_read_b64_tr_b16 v[186:187], v25 offset:10240
  v_mfma_f32_16x16x32_bf16 v[32:35], v[208:211], a[180:183], v[32:35]
  ds_read_b64_tr_b16 v[188:189], v24 offset:12288
  ds_read_b64_tr_b16 v[190:191], v25 offset:12288
  v_mfma_f32_16x16x32_bf16 v[144:147], v[208:211], a[188:191], v[144:147]
  ds_read_b64_tr_b16 v[192:193], v24 offset:14336
  ds_read_b64_tr_b16 v[194:195], v25 offset:14336
  v_mfma_f32_16x16x32_bf16 v[116:119], v[212:215], a[180:183], v[116:119]
  s_add_u32 m0, s57, 69632
  s_nop 0
  buffer_load_dwordx4 v21, s[44:47], s43 offen offset:0 sc1 lds
  v_mfma_f32_16x16x32_bf16 v[148:151], v[212:215], a[188:191], v[148:151]
  v_mfma_f32_16x16x32_bf16 v[120:123], v[216:219], a[180:183], v[120:123]
  buffer_load_dwordx4 v21, s[44:47], s43 offen offset:1024 sc1 lds
  v_mfma_f32_16x16x32_bf16 v[152:155], v[216:219], a[188:191], v[152:155]
  v_mfma_f32_16x16x32_bf16 v[124:127], v[220:223], a[180:183], v[124:127]
  buffer_load_dwordx4 v21, s[44:47], s43 offen offset:2048 sc1 lds
  v_mfma_f32_16x16x32_bf16 v[156:159], v[220:223], a[188:191], v[156:159]
  v_mfma_f32_16x16x32_bf16 v[128:131], v[224:227], a[180:183], v[128:131]
  buffer_load_dwordx4 v21, s[44:47], s43 offen offset:3072 sc1 lds
  s_add_u32 s43, s43, 32768
  s_and_b32 s43, s43, 0x7ffff
  v_mfma_f32_16x16x32_bf16 v[160:163], v[224:227], a[188:191], v[160:163]
  s_waitcnt lgkmcnt(14)
  v_mfma_f32_16x16x32_bf16 v[12:15], v[164:167], a[192:195], v[12:15]
  ds_read_b64_tr_b16 v[196:197], v24 offset:256
  ds_read_b64_tr_b16 v[198:199], v25 offset:256
  v_mfma_f32_16x16x32_bf16 v[132:135], v[164:167], a[200:203], v[132:135]
  ds_read_b64_tr_b16 v[200:201], v24 offset:2304
  ds_read_b64_tr_b16 v[202:203], v25 offset:2304
  s_waitcnt lgkmcnt(15)
  v_mfma_f32_16x16x32_bf16 v[16:19], v[168:171], a[192:195], v[16:19]
  ds_read_b64_tr_b16 v[204:205], v24 offset:4352
  ds_read_b64_tr_b16 v[206:207], v25 offset:4352
  v_mfma_f32_16x16x32_bf16 v[136:139], v[168:171], a[200:203], v[136:139]
  ds_read_b64_tr_b16 v[208:209], v24 offset:6400
  ds_read_b64_tr_b16 v[210:211], v25 offset:6400
  s_waitcnt lgkmcnt(15)
  v_mfma_f32_16x16x32_bf16 v[28:31], v[172:175], a[192:195], v[28:31]
  ds_read_b64_tr_b16 v[212:213], v24 offset:8448
  ds_read_b64_tr_b16 v[214:215], v25 offset:8448
  v_mfma_f32_16x16x32_bf16 v[140:143], v[172:175], a[200:203], v[140:143]
  ds_read_b64_tr_b16 v[216:217], v24 offset:10496
  ds_read_b64_tr_b16 v[218:219], v25 offset:10496
  s_waitcnt lgkmcnt(15)
  v_mfma_f32_16x16x32_bf16 v[32:35], v[176:179], a[192:195], v[32:35]
  ds_read_b64_tr_b16 v[220:221], v24 offset:12544
  ds_read_b64_tr_b16 v[222:223], v25 offset:12544
  v_mfma_f32_16x16x32_bf16 v[144:147], v[176:179], a[200:203], v[144:147]
  ds_read_b64_tr_b16 v[224:225], v24 offset:14592
  ds_read_b64_tr_b16 v[226:227], v25 offset:14592
  s_waitcnt lgkmcnt(15)
  v_mfma_f32_16x16x32_bf16 v[116:119], v[180:183], a[192:195], v[116:119]
  s_add_u32 m0, s57, 98304
  s_nop 0
  buffer_load_dwordx4 v20, s[44:47], s43 offen offset:0 sc1 lds
  v_mfma_f32_16x16x32_bf16 v[148:151], v[180:183], a[200:203], v[148:151]
  s_waitcnt lgkmcnt(15)
  v_mfma_f32_16x16x32_bf16 v[120:123], v[184:187], a[192:195], v[120:123]
  buffer_load_dwordx4 v20, s[44:47], s43 offen offset:1024 sc1 lds
  v_mfma_f32_16x16x32_bf16 v[152:155], v[184:187], a[200:203], v[152:155]
  s_waitcnt lgkmcnt(15)
  v_mfma_f32_16x16x32_bf16 v[124:127], v[188:191], a[192:195], v[124:127]
  buffer_load_dwordx4 v20, s[44:47], s43 offen offset:2048 sc1 lds
  v_mfma_f32_16x16x32_bf16 v[156:159], v[188:191], a[200:203], v[156:159]
  s_waitcnt lgkmcnt(15)
  v_mfma_f32_16x16x32_bf16 v[128:131], v[192:195], a[192:195], v[128:131]
  buffer_load_dwordx4 v20, s[44:47], s43 offen offset:3072 sc1 lds
  v_mfma_f32_16x16x32_bf16 v[160:163], v[192:195], a[200:203], v[160:163]
  s_waitcnt vmcnt(15)
  v_cmp_ne_u32 vcc, 1, v9
  s_nop 0
  s_cbranch_vccz gated_mix__spectral_gfnet__ssm_conv_s5__prompt_kernel_skip27
  s_mov_b32 s56, 0
gated_mix__spectral_gfnet__ssm_conv_s5__prompt_kernel_poll28:
  s_sleep 2
  buffer_load_dword v9, v7, s[48:51], s42 offen sc1
  s_waitcnt vmcnt(0)
  v_cmp_ne_u32 vcc, 1, v9
  s_nop 0
  s_cbranch_vccz gated_mix__spectral_gfnet__ssm_conv_s5__prompt_kernel_pollout29
  s_add_u32 s56, s56, 1
  s_cmp_lt_u32 s56, 1048576
  s_cbranch_scc1 gated_mix__spectral_gfnet__ssm_conv_s5__prompt_kernel_poll28
gated_mix__spectral_gfnet__ssm_conv_s5__prompt_kernel_pollout29:
gated_mix__spectral_gfnet__ssm_conv_s5__prompt_kernel_skip27:
  s_waitcnt vmcnt(12) lgkmcnt(0)
  s_barrier
  v_mfma_f32_16x16x32_bf16 v[12:15], v[196:199], a[196:199], v[12:15]
  ds_read_b64_tr_b16 v[164:165], v24 offset:32768
  ds_read_b64_tr_b16 v[166:167], v25 offset:32768
  v_mfma_f32_16x16x32_bf16 v[132:135], v[196:199], a[204:207], v[132:135]
  ds_read_b64_tr_b16 v[168:169], v24 offset:34816
  ds_read_b64_tr_b16 v[170:171], v25 offset:34816
  v_mfma_f32_16x16x32_bf16 v[16:19], v[200:203], a[196:199], v[16:19]
  ds_read_b64_tr_b16 v[172:173], v24 offset:36864
  ds_read_b64_tr_b16 v[174:175], v25 offset:36864
  v_mfma_f32_16x16x32_bf16 v[136:139], v[200:203], a[204:207], v[136:139]
  ds_read_b64_tr_b16 v[176:177], v24 offset:38912
  ds_read_b64_tr_b16 v[178:179], v25 offset:38912
  v_mfma_f32_16x16x32_bf16 v[28:31], v[204:207], a[196:199], v[28:31]
  ds_read_b64_tr_b16 v[180:181], v24 offset:40960
  ds_read_b64_tr_b16 v[182:183], v25 offset:40960
  v_mfma_f32_16x16x32_bf16 v[140:143], v[204:207], a[204:207], v[140:143]
  ds_read_b64_tr_b16 v[184:185], v24 offset:43008
  ds_read_b64_tr_b16 v[186:187], v25 offset:43008
  v_mfma_f32_16x16x32_bf16 v[32:35], v[208:211], a[196:199], v[32:35]
  ds_read_b64_tr_b16 v[188:189], v24 offset:45056
  ds_read_b64_tr_b16 v[190:191], v25 offset:45056
  v_mfma_f32_16x16x32_bf16 v[144:147], v[208:211], a[204:207], v[144:147]
  ds_read_b64_tr_b16 v[192:193], v24 offset:47104
  ds_read_b64_tr_b16 v[194:195], v25 offset:47104
  v_mfma_f32_16x16x32_bf16 v[116:119], v[212:215], a[196:199], v[116:119]
  s_add_u32 m0, s57, 102400
  s_nop 0
  buffer_load_dwordx4 v21, s[44:47], s43 offen offset:0 sc1 lds
  v_mfma_f32_16x16x32_bf16 v[148:151], v[212:215], a[204:207], v[148:151]
  v_mfma_f32_16x16x32_bf16 v[120:123], v[216:219], a[196:199], v[120:123]
  buffer_load_dwordx4 v21, s[44:47], s43 offen offset:1024 sc1 lds
  v_mfma_f32_16x16x32_bf16 v[152:155], v[216:219], a[204:207], v[152:155]
  v_mfma_f32_16x16x32_bf16 v[124:127], v[220:223], a[196:199], v[124:127]
  buffer_load_dwordx4 v21, s[44:47], s43 offen offset:2048 sc1 lds
  v_mfma_f32_16x16x32_bf16 v[156:159], v[220:223], a[204:207], v[156:159]
  v_mfma_f32_16x16x32_bf16 v[128:131], v[224:227], a[196:199], v[128:131]
  buffer_load_dwordx4 v21, s[44:47], s43 offen offset:3072 sc1 lds
  s_add_u32 s43, s43, 32768
  s_and_b32 s43, s43, 0x7ffff
  v_mfma_f32_16x16x32_bf16 v[160:163], v[224:227], a[204:207], v[160:163]
  s_waitcnt lgkmcnt(14)
  v_mfma_f32_16x16x32_bf16 v[12:15], v[164:167], a[208:211], v[12:15]
  ds_read_b64_tr_b16 v[196:197], v24 offset:33024
  ds_read_b64_tr_b16 v[198:199], v25 offset:33024
  v_mfma_f32_16x16x32_bf16 v[132:135], v[164:167], a[216:219], v[132:135]
  ds_read_b64_tr_b16 v[200:201], v24 offset:35072
  ds_read_b64_tr_b16 v[202:203], v25 offset:35072
  s_waitcnt lgkmcnt(15)
  v_mfma_f32_16x16x32_bf16 v[16:19], v[168:171], a[208:211], v[16:19]
  ds_read_b64_tr_b16 v[204:205], v24 offset:37120
  ds_read_b64_tr_b16 v[206:207], v25 offset:37120
  v_mfma_f32_16x16x32_bf16 v[136:139], v[168:171], a[216:219], v[136:139]
  ds_read_b64_tr_b16 v[208:209], v24 offset:39168
  ds_read_b64_tr_b16 v[210:211], v25 offset:39168
  s_waitcnt lgkmcnt(15)
  v_mfma_f32_16x16x32_bf16 v[28:31], v[172:175], a[208:211], v[28:31]
  ds_read_b64_tr_b16 v[212:213], v24 offset:41216
  ds_read_b64_tr_b16 v[214:215], v25 offset:41216
  v_mfma_f32_16x16x32_bf16 v[140:143], v[172:175], a[216:219], v[140:143]
  ds_read_b64_tr_b16 v[216:217], v24 offset:43264
  ds_read_b64_tr_b16 v[218:219], v25 offset:43264
  s_waitcnt lgkmcnt(15)
  v_mfma_f32_16x16x32_bf16 v[32:35], v[176:179], a[208:211], v[32:35]
  ds_read_b64_tr_b16 v[220:221], v24 offset:45312
  ds_read_b64_tr_b16 v[222:223], v25 offset:45312
  v_mfma_f32_16x16x32_bf16 v[144:147], v[176:179], a[216:219], v[144:147]
  ds_read_b64_tr_b16 v[224:225], v24 offset:47360
  ds_read_b64_tr_b16 v[226:227], v25 offset:47360
  s_waitcnt lgkmcnt(15)
  v_mfma_f32_16x16x32_bf16 v[116:119], v[180:183], a[208:211], v[116:119]
  v_lshrrev_b32 v9, 2, v4
  v_lshlrev_b32 v9, 8, v9
  v_and_b32 v10, 3, v4
  v_lshl_or_b32 v9, v10, 4, v9
  s_lshl_b32 s56, s38, 4
  s_add_u32 s56, s56, s39
  s_mul_i32 s56, s56, 16384
  s_lshl_b32 s58, s3, 12
  s_add_u32 s56, s56, s58
  buffer_load_dwordx4 v[228:231], v9, s[52:55], s56 offen offset:0 sc1
  buffer_load_dwordx4 v[232:235], v9, s[52:55], s56 offen offset:64 sc1
  buffer_load_dwordx4 v[236:239], v9, s[52:55], s56 offen offset:128 sc1
  buffer_load_dwordx4 v[240:243], v9, s[52:55], s56 offen offset:192 sc1
  v_mfma_f32_16x16x32_bf16 v[148:151], v[180:183], a[216:219], v[148:151]
  s_waitcnt lgkmcnt(15)
  v_mfma_f32_16x16x32_bf16 v[120:123], v[184:187], a[208:211], v[120:123]
  v_mfma_f32_16x16x32_bf16 v[152:155], v[184:187], a[216:219], v[152:155]
  s_waitcnt lgkmcnt(15)
  v_mfma_f32_16x16x32_bf16 v[124:127], v[188:191], a[208:211], v[124:127]
  v_mfma_f32_16x16x32_bf16 v[156:159], v[188:191], a[216:219], v[156:159]
  s_waitcnt lgkmcnt(15)
  v_mfma_f32_16x16x32_bf16 v[128:131], v[192:195], a[208:211], v[128:131]
  v_mfma_f32_16x16x32_bf16 v[160:163], v[192:195], a[216:219], v[160:163]
  s_waitcnt vmcnt(12) lgkmcnt(0)
  s_barrier
  v_mfma_f32_16x16x32_bf16 v[12:15], v[196:199], a[212:215], v[12:15]
  ds_read_b64_tr_b16 v[164:165], v26 offset:0
  ds_read_b64_tr_b16 v[166:167], v27 offset:0
  v_mfma_f32_16x16x32_bf16 v[132:135], v[196:199], a[220:223], v[132:135]
  ds_read_b64_tr_b16 v[168:169], v26 offset:2048
  ds_read_b64_tr_b16 v[170:171], v27 offset:2048
  v_mfma_f32_16x16x32_bf16 v[16:19], v[200:203], a[212:215], v[16:19]
  ds_read_b64_tr_b16 v[172:173], v26 offset:4096
  ds_read_b64_tr_b16 v[174:175], v27 offset:4096
  v_mfma_f32_16x16x32_bf16 v[136:139], v[200:203], a[220:223], v[136:139]
  ds_read_b64_tr_b16 v[176:177], v26 offset:6144
  ds_read_b64_tr_b16 v[178:179], v27 offset:6144
  v_mfma_f32_16x16x32_bf16 v[28:31], v[204:207], a[212:215], v[28:31]
  ds_read_b64_tr_b16 v[180:181], v26 offset:8192
  ds_read_b64_tr_b16 v[182:183], v27 offset:8192
  v_mfma_f32_16x16x32_bf16 v[140:143], v[204:207], a[220:223], v[140:143]
  ds_read_b64_tr_b16 v[184:185], v26 offset:10240
  ds_read_b64_tr_b16 v[186:187], v27 offset:10240
  v_mfma_f32_16x16x32_bf16 v[32:35], v[208:211], a[212:215], v[32:35]
  ds_read_b64_tr_b16 v[188:189], v26 offset:12288
  ds_read_b64_tr_b16 v[190:191], v27 offset:12288
  v_mfma_f32_16x16x32_bf16 v[144:147], v[208:211], a[220:223], v[144:147]
  ds_read_b64_tr_b16 v[192:193], v26 offset:14336
  ds_read_b64_tr_b16 v[194:195], v27 offset:14336
  v_mfma_f32_16x16x32_bf16 v[116:119], v[212:215], a[212:215], v[116:119]
  v_mfma_f32_16x16x32_bf16 v[148:151], v[212:215], a[220:223], v[148:151]
  v_mfma_f32_16x16x32_bf16 v[120:123], v[216:219], a[212:215], v[120:123]
  v_mfma_f32_16x16x32_bf16 v[152:155], v[216:219], a[220:223], v[152:155]
  v_mfma_f32_16x16x32_bf16 v[124:127], v[220:223], a[212:215], v[124:127]
  v_mfma_f32_16x16x32_bf16 v[156:159], v[220:223], a[220:223], v[156:159]
  v_mfma_f32_16x16x32_bf16 v[128:131], v[224:227], a[212:215], v[128:131]
  v_mfma_f32_16x16x32_bf16 v[160:163], v[224:227], a[220:223], v[160:163]
  s_waitcnt lgkmcnt(14)
  v_mfma_f32_16x16x32_bf16 v[12:15], v[164:167], a[224:227], v[12:15]
  ds_read_b64_tr_b16 v[196:197], v26 offset:256
  ds_read_b64_tr_b16 v[198:199], v27 offset:256
  v_mfma_f32_16x16x32_bf16 v[132:135], v[164:167], a[232:235], v[132:135]
  ds_read_b64_tr_b16 v[200:201], v26 offset:2304
  ds_read_b64_tr_b16 v[202:203], v27 offset:2304
  s_waitcnt lgkmcnt(15)
  v_mfma_f32_16x16x32_bf16 v[16:19], v[168:171], a[224:227], v[16:19]
  ds_read_b64_tr_b16 v[204:205], v26 offset:4352
  ds_read_b64_tr_b16 v[206:207], v27 offset:4352
  v_mfma_f32_16x16x32_bf16 v[136:139], v[168:171], a[232:235], v[136:139]
  ds_read_b64_tr_b16 v[208:209], v26 offset:6400
  ds_read_b64_tr_b16 v[210:211], v27 offset:6400
  s_waitcnt lgkmcnt(15)
  v_mfma_f32_16x16x32_bf16 v[28:31], v[172:175], a[224:227], v[28:31]
  ds_read_b64_tr_b16 v[212:213], v26 offset:8448
  ds_read_b64_tr_b16 v[214:215], v27 offset:8448
  v_mfma_f32_16x16x32_bf16 v[140:143], v[172:175], a[232:235], v[140:143]
  ds_read_b64_tr_b16 v[216:217], v26 offset:10496
  ds_read_b64_tr_b16 v[218:219], v27 offset:10496
  s_waitcnt lgkmcnt(15)
  v_mfma_f32_16x16x32_bf16 v[32:35], v[176:179], a[224:227], v[32:35]
  ds_read_b64_tr_b16 v[220:221], v26 offset:12544
  ds_read_b64_tr_b16 v[222:223], v27 offset:12544
  v_mfma_f32_16x16x32_bf16 v[144:147], v[176:179], a[232:235], v[144:147]
  ds_read_b64_tr_b16 v[224:225], v26 offset:14592
  ds_read_b64_tr_b16 v[226:227], v27 offset:14592
  s_waitcnt lgkmcnt(15)
  v_mfma_f32_16x16x32_bf16 v[116:119], v[180:183], a[224:227], v[116:119]
  v_mfma_f32_16x16x32_bf16 v[148:151], v[180:183], a[232:235], v[148:151]
  s_waitcnt lgkmcnt(15)
  v_mfma_f32_16x16x32_bf16 v[120:123], v[184:187], a[224:227], v[120:123]
  v_mfma_f32_16x16x32_bf16 v[152:155], v[184:187], a[232:235], v[152:155]
  s_waitcnt lgkmcnt(15)
  v_mfma_f32_16x16x32_bf16 v[124:127], v[188:191], a[224:227], v[124:127]
  v_mfma_f32_16x16x32_bf16 v[156:159], v[188:191], a[232:235], v[156:159]
  s_waitcnt lgkmcnt(15)
  v_mfma_f32_16x16x32_bf16 v[128:131], v[192:195], a[224:227], v[128:131]
  v_mfma_f32_16x16x32_bf16 v[160:163], v[192:195], a[232:235], v[160:163]
  s_waitcnt vmcnt(4) lgkmcnt(0)
  s_barrier
  v_mfma_f32_16x16x32_bf16 v[12:15], v[196:199], a[228:231], v[12:15]
  ds_read_b64_tr_b16 v[164:165], v26 offset:32768
  ds_read_b64_tr_b16 v[166:167], v27 offset:32768
  v_mfma_f32_16x16x32_bf16 v[132:135], v[196:199], a[236:239], v[132:135]
  ds_read_b64_tr_b16 v[168:169], v26 offset:34816
  ds_read_b64_tr_b16 v[170:171], v27 offset:34816
  v_mfma_f32_16x16x32_bf16 v[16:19], v[200:203], a[228:231], v[16:19]
  ds_read_b64_tr_b16 v[172:173], v26 offset:36864
  ds_read_b64_tr_b16 v[174:175], v27 offset:36864
  v_mfma_f32_16x16x32_bf16 v[136:139], v[200:203], a[236:239], v[136:139]
  ds_read_b64_tr_b16 v[176:177], v26 offset:38912
  ds_read_b64_tr_b16 v[178:179], v27 offset:38912
  v_mfma_f32_16x16x32_bf16 v[28:31], v[204:207], a[228:231], v[28:31]
  ds_read_b64_tr_b16 v[180:181], v26 offset:40960
  ds_read_b64_tr_b16 v[182:183], v27 offset:40960
  v_mfma_f32_16x16x32_bf16 v[140:143], v[204:207], a[236:239], v[140:143]
  ds_read_b64_tr_b16 v[184:185], v26 offset:43008
  ds_read_b64_tr_b16 v[186:187], v27 offset:43008
  v_mfma_f32_16x16x32_bf16 v[32:35], v[208:211], a[228:231], v[32:35]
  ds_read_b64_tr_b16 v[188:189], v26 offset:45056
  ds_read_b64_tr_b16 v[190:191], v27 offset:45056
  v_mfma_f32_16x16x32_bf16 v[144:147], v[208:211], a[236:239], v[144:147]
  ds_read_b64_tr_b16 v[192:193], v26 offset:47104
  ds_read_b64_tr_b16 v[194:195], v27 offset:47104
  v_mfma_f32_16x16x32_bf16 v[116:119], v[212:215], a[228:231], v[116:119]
  v_mfma_f32_16x16x32_bf16 v[148:151], v[212:215], a[236:239], v[148:151]
  v_mfma_f32_16x16x32_bf16 v[120:123], v[216:219], a[228:231], v[120:123]
  v_mfma_f32_16x16x32_bf16 v[152:155], v[216:219], a[236:239], v[152:155]
  v_mfma_f32_16x16x32_bf16 v[124:127], v[220:223], a[228:231], v[124:127]
  v_mfma_f32_16x16x32_bf16 v[156:159], v[220:223], a[236:239], v[156:159]
  v_mfma_f32_16x16x32_bf16 v[128:131], v[224:227], a[228:231], v[128:131]
  v_mfma_f32_16x16x32_bf16 v[160:163], v[224:227], a[236:239], v[160:163]
  s_waitcnt lgkmcnt(14)
  v_mfma_f32_16x16x32_bf16 v[12:15], v[164:167], a[240:243], v[12:15]
  ds_read_b64_tr_b16 v[196:197], v26 offset:33024
  ds_read_b64_tr_b16 v[198:199], v27 offset:33024
  v_mfma_f32_16x16x32_bf16 v[132:135], v[164:167], a[248:251], v[132:135]
  ds_read_b64_tr_b16 v[200:201], v26 offset:35072
  ds_read_b64_tr_b16 v[202:203], v27 offset:35072
  s_waitcnt lgkmcnt(15)
  v_mfma_f32_16x16x32_bf16 v[16:19], v[168:171], a[240:243], v[16:19]
  ds_read_b64_tr_b16 v[204:205], v26 offset:37120
  ds_read_b64_tr_b16 v[206:207], v27 offset:37120
  v_mfma_f32_16x16x32_bf16 v[136:139], v[168:171], a[248:251], v[136:139]
  ds_read_b64_tr_b16 v[208:209], v26 offset:39168
  ds_read_b64_tr_b16 v[210:211], v27 offset:39168
  s_waitcnt lgkmcnt(15)
  v_mfma_f32_16x16x32_bf16 v[28:31], v[172:175], a[240:243], v[28:31]
  ds_read_b64_tr_b16 v[212:213], v26 offset:41216
  ds_read_b64_tr_b16 v[214:215], v27 offset:41216
  v_mfma_f32_16x16x32_bf16 v[140:143], v[172:175], a[248:251], v[140:143]
  ds_read_b64_tr_b16 v[216:217], v26 offset:43264
  ds_read_b64_tr_b16 v[218:219], v27 offset:43264
  s_waitcnt lgkmcnt(15)
  v_mfma_f32_16x16x32_bf16 v[32:35], v[176:179], a[240:243], v[32:35]
  ds_read_b64_tr_b16 v[220:221], v26 offset:45312
  ds_read_b64_tr_b16 v[222:223], v27 offset:45312
  v_mfma_f32_16x16x32_bf16 v[144:147], v[176:179], a[248:251], v[144:147]
  ds_read_b64_tr_b16 v[224:225], v26 offset:47360
  ds_read_b64_tr_b16 v[226:227], v27 offset:47360
  s_waitcnt lgkmcnt(15)
  v_mfma_f32_16x16x32_bf16 v[116:119], v[180:183], a[240:243], v[116:119]
  v_mfma_f32_16x16x32_bf16 v[148:151], v[180:183], a[248:251], v[148:151]
  s_waitcnt lgkmcnt(15)
  v_mfma_f32_16x16x32_bf16 v[120:123], v[184:187], a[240:243], v[120:123]
  v_mfma_f32_16x16x32_bf16 v[152:155], v[184:187], a[248:251], v[152:155]
  s_waitcnt lgkmcnt(15)
  v_mfma_f32_16x16x32_bf16 v[124:127], v[188:191], a[240:243], v[124:127]
  v_mfma_f32_16x16x32_bf16 v[156:159], v[188:191], a[248:251], v[156:159]
  s_waitcnt lgkmcnt(15)
  v_mfma_f32_16x16x32_bf16 v[128:131], v[192:195], a[240:243], v[128:131]
  v_mfma_f32_16x16x32_bf16 v[160:163], v[192:195], a[248:251], v[160:163]
  s_waitcnt lgkmcnt(14)
  v_mfma_f32_16x16x32_bf16 v[12:15], v[196:199], a[244:247], v[12:15]
  v_mfma_f32_16x16x32_bf16 v[132:135], v[196:199], a[252:255], v[132:135]
  s_waitcnt lgkmcnt(12)
  v_mfma_f32_16x16x32_bf16 v[16:19], v[200:203], a[244:247], v[16:19]
  v_mfma_f32_16x16x32_bf16 v[136:139], v[200:203], a[252:255], v[136:139]
  s_waitcnt lgkmcnt(10)
  v_mfma_f32_16x16x32_bf16 v[28:31], v[204:207], a[244:247], v[28:31]
  v_mfma_f32_16x16x32_bf16 v[140:143], v[204:207], a[252:255], v[140:143]
  s_waitcnt lgkmcnt(8)
  v_mfma_f32_16x16x32_bf16 v[32:35], v[208:211], a[244:247], v[32:35]
  v_mfma_f32_16x16x32_bf16 v[144:147], v[208:211], a[252:255], v[144:147]
  s_waitcnt lgkmcnt(6)
  v_mfma_f32_16x16x32_bf16 v[116:119], v[212:215], a[244:247], v[116:119]
  v_mfma_f32_16x16x32_bf16 v[148:151], v[212:215], a[252:255], v[148:151]
  s_waitcnt lgkmcnt(4)
  v_mfma_f32_16x16x32_bf16 v[120:123], v[216:219], a[244:247], v[120:123]
  v_mfma_f32_16x16x32_bf16 v[152:155], v[216:219], a[252:255], v[152:155]
  s_waitcnt lgkmcnt(2)
  v_mfma_f32_16x16x32_bf16 v[124:127], v[220:223], a[244:247], v[124:127]
  v_mfma_f32_16x16x32_bf16 v[156:159], v[220:223], a[252:255], v[156:159]
  s_waitcnt lgkmcnt(0)
  v_mfma_f32_16x16x32_bf16 v[128:131], v[224:227], a[244:247], v[128:131]
  v_mfma_f32_16x16x32_bf16 v[160:163], v[224:227], a[252:255], v[160:163]
  s_mov_b32 s56, s30
  s_mov_b32 s57, s31
  s_mov_b32 s58, 8388608
  s_mov_b32 s59, 0x20000
  s_lshl_b32 s43, s3, 13
  s_add_u32 s43, s43, 0
  v_lshl_add_u32 v9, v4, 4, s43
  ds_write_b128 v9, v[116:119] offset:0
  ds_write_b128 v9, v[120:123] offset:1024
  ds_write_b128 v9, v[124:127] offset:2048
  ds_write_b128 v9, v[128:131] offset:3072
  ds_write_b128 v9, v[148:151] offset:4096
  ds_write_b128 v9, v[152:155] offset:5120
  ds_write_b128 v9, v[156:159] offset:6144
  ds_write_b128 v9, v[160:163] offset:7168
  s_waitcnt vmcnt(3)
  v_lshlrev_b32 v20, 16, v228
  v_and_b32 v24, 0xffff0000, v228
  v_lshlrev_b32 v21, 16, v229
  v_and_b32 v25, 0xffff0000, v229
  v_lshlrev_b32 v22, 16, v230
  v_and_b32 v26, 0xffff0000, v230
  v_lshlrev_b32 v23, 16, v231
  v_and_b32 v27, 0xffff0000, v231
  s_waitcnt vmcnt(2)
  v_lshlrev_b32 v164, 16, v232
  v_and_b32 v168, 0xffff0000, v232
  v_lshlrev_b32 v165, 16, v233
  v_and_b32 v169, 0xffff0000, v233
  v_lshlrev_b32 v166, 16, v234
  v_and_b32 v170, 0xffff0000, v234
  v_lshlrev_b32 v167, 16, v235
  v_and_b32 v171, 0xffff0000, v235
  s_waitcnt vmcnt(1)
  v_lshlrev_b32 v172, 16, v236
  v_and_b32 v176, 0xffff0000, v236
  v_lshlrev_b32 v173, 16, v237
  v_and_b32 v177, 0xffff0000, v237
  v_lshlrev_b32 v174, 16, v238
  v_and_b32 v178, 0xffff0000, v238
  v_lshlrev_b32 v175, 16, v239
  v_and_b32 v179, 0xffff0000, v239
  s_waitcnt vmcnt(0)
  v_lshlrev_b32 v180, 16, v240
  v_and_b32 v184, 0xffff0000, v240
  v_lshlrev_b32 v181, 16, v241
  v_and_b32 v185, 0xffff0000, v241
  v_lshlrev_b32 v182, 16, v242
  v_and_b32 v186, 0xffff0000, v242
  v_lshlrev_b32 v183, 16, v243
  v_and_b32 v187, 0xffff0000, v243
  v_pk_add_f32 v[188:189], v[20:21], v[172:173]
  v_pk_add_f32 v[196:197], v[20:21], v[172:173] neg_lo:[0,1] neg_hi:[0,1]
  v_pk_add_f32 v[204:205], v[164:165], v[180:181]
  v_pk_add_f32 v[192:193], v[24:25], v[176:177]
  v_pk_add_f32 v[200:201], v[24:25], v[176:177] neg_lo:[0,1] neg_hi:[0,1]
  v_pk_add_f32 v[208:209], v[168:169], v[184:185]
  v_pk_add_f32 v[212:213], v[184:185], v[168:169] neg_lo:[0,1] neg_hi:[0,1]
  v_pk_add_f32 v[216:217], v[164:165], v[180:181] neg_lo:[0,1] neg_hi:[0,1]
  v_pk_add_f32 v[190:191], v[22:23], v[174:175]
  v_pk_add_f32 v[198:199], v[22:23], v[174:175] neg_lo:[0,1] neg_hi:[0,1]
  v_pk_add_f32 v[206:207], v[166:167], v[182:183]
  v_pk_add_f32 v[194:195], v[26:27], v[178:179]
  v_pk_add_f32 v[202:203], v[26:27], v[178:179] neg_lo:[0,1] neg_hi:[0,1]
  v_pk_add_f32 v[210:211], v[170:171], v[186:187]
  v_pk_add_f32 v[214:215], v[186:187], v[170:171] neg_lo:[0,1] neg_hi:[0,1]
  v_pk_add_f32 v[218:219], v[166:167], v[182:183] neg_lo:[0,1] neg_hi:[0,1]
  s_cmp_lg_u32 s3, 0
  s_cbranch_scc1 gated_mix__spectral_gfnet__ssm_conv_s5__prompt_kernel_skip30
  s_mov_b64 exec, 15
  v_mul_f32 v204, 2.0, v164
  v_mul_f32 v208, 2.0, v180
  v_mul_f32 v212, -2.0, v168
  v_mul_f32 v216, -2.0, v184
  v_mul_f32 v205, 2.0, v165
  v_mul_f32 v209, 2.0, v181
  v_mul_f32 v213, -2.0, v169
  v_mul_f32 v217, -2.0, v185
  v_mul_f32 v206, 2.0, v166
  v_mul_f32 v210, 2.0, v182
  v_mul_f32 v214, -2.0, v170
  v_mul_f32 v218, -2.0, v186
  v_mul_f32 v207, 2.0, v167
  v_mul_f32 v211, 2.0, v183
  v_mul_f32 v215, -2.0, v171
  v_mul_f32 v219, -2.0, v187
  s_mov_b64 exec, -1
gated_mix__spectral_gfnet__ssm_conv_s5__prompt_kernel_skip30:
  s_lshl_b32 s60, s3, 10
  s_add_u32 s60, s60, 32768
  v_lshl_add_u32 v11, v4, 4, s60
  v_pk_add_f32 v[20:21], v[188:189], v[204:205]
  v_cvt_pk_bf16_f32 v228, v20, v21
  v_pk_add_f32 v[22:23], v[190:191], v[206:207]
  v_cvt_pk_bf16_f32 v229, v22, v23
  v_pk_add_f32 v[24:25], v[192:193], v[208:209]
  v_cvt_pk_bf16_f32 v230, v24, v25
  v_pk_add_f32 v[26:27], v[194:195], v[210:211]
  v_cvt_pk_bf16_f32 v231, v26, v27
  ds_write_b128 v11, v[228:231] offset:0
  v_pk_add_f32 v[164:165], v[196:197], v[212:213]
  v_cvt_pk_bf16_f32 v232, v164, v165
  v_pk_add_f32 v[166:167], v[198:199], v[214:215]
  v_cvt_pk_bf16_f32 v233, v166, v167
  v_pk_add_f32 v[168:169], v[200:201], v[216:217]
  v_cvt_pk_bf16_f32 v234, v168, v169
  v_pk_add_f32 v[170:171], v[202:203], v[218:219]
  v_cvt_pk_bf16_f32 v235, v170, v171
  ds_write_b128 v11, v[232:235] offset:4096
  v_pk_add_f32 v[172:173], v[188:189], v[204:205] neg_lo:[0,1] neg_hi:[0,1]
  v_cvt_pk_bf16_f32 v236, v172, v173
  v_pk_add_f32 v[174:175], v[190:191], v[206:207] neg_lo:[0,1] neg_hi:[0,1]
  v_cvt_pk_bf16_f32 v237, v174, v175
  v_pk_add_f32 v[176:177], v[192:193], v[208:209] neg_lo:[0,1] neg_hi:[0,1]
  v_cvt_pk_bf16_f32 v238, v176, v177
  v_pk_add_f32 v[178:179], v[194:195], v[210:211] neg_lo:[0,1] neg_hi:[0,1]
  v_cvt_pk_bf16_f32 v239, v178, v179
  ds_write_b128 v11, v[236:239] offset:8192
  v_pk_add_f32 v[180:181], v[196:197], v[212:213] neg_lo:[0,1] neg_hi:[0,1]
  v_cvt_pk_bf16_f32 v240, v180, v181
  v_pk_add_f32 v[182:183], v[198:199], v[214:215] neg_lo:[0,1] neg_hi:[0,1]
  v_cvt_pk_bf16_f32 v241, v182, v183
  v_pk_add_f32 v[184:185], v[200:201], v[216:217] neg_lo:[0,1] neg_hi:[0,1]
  v_cvt_pk_bf16_f32 v242, v184, v185
  v_pk_add_f32 v[186:187], v[202:203], v[218:219] neg_lo:[0,1] neg_hi:[0,1]
  v_cvt_pk_bf16_f32 v243, v186, v187
  ds_write_b128 v11, v[240:243] offset:12288
  v_xor_b32 v9, 0x2000, v9
  v_lshrrev_b32 v11, 5, v4
  v_lshlrev_b32 v11, 9, v11
  v_bfe_u32 v10, v4, 3, 2
  v_lshl_or_b32 v11, v10, 6, v11
  v_and_b32 v10, 3, v4
  v_lshl_or_b32 v11, v10, 4, v11
  v_bfe_u32 v10, v4, 2, 1
  v_lshl_or_b32 v11, v10, 3, v11
  s_lshr_b32 s43, s3, 1
  s_lshl_b32 s43, s43, 13
  s_add_u32 s43, s43, 32768
  v_add_u32 v11, s43, v11
  s_waitcnt lgkmcnt(0)
  s_barrier
  ds_read_b64_tr_b16 v[188:189], v11 offset:0
  ds_read_b64_tr_b16 v[190:191], v11 offset:256
  ds_read_b64_tr_b16 v[192:193], v11 offset:1024
  ds_read_b64_tr_b16 v[194:195], v11 offset:1280
  ds_read_b64_tr_b16 v[196:197], v11 offset:2048
  ds_read_b64_tr_b16 v[198:199], v11 offset:2304
  ds_read_b64_tr_b16 v[200:201], v11 offset:3072
  ds_read_b64_tr_b16 v[202:203], v11 offset:3328
  ds_read_b64_tr_b16 v[204:205], v11 offset:4096
  ds_read_b64_tr_b16 v[206:207], v11 offset:4352
  ds_read_b64_tr_b16 v[208:209], v11 offset:5120
  ds_read_b64_tr_b16 v[210:211], v11 offset:5376
  ds_read_b64_tr_b16 v[212:213], v11 offset:6144
  ds_read_b64_tr_b16 v[214:215], v11 offset:6400
  ds_read_b64_tr_b16 v[216:217], v11 offset:7168
  ds_read_b64_tr_b16 v[218:219], v11 offset:7424
  ds_read_b128 v[20:23], v9 offset:0
  ds_read_b128 v[172:175], v9 offset:4096
  ds_read_b128 v[24:27], v9 offset:1024
  ds_read_b128 v[176:179], v9 offset:5120
  ds_read_b128 v[164:167], v9 offset:2048
  ds_read_b128 v[180:183], v9 offset:6144
  ds_read_b128 v[168:171], v9 offset:3072
  ds_read_b128 v[184:187], v9 offset:7168
  v_lshlrev_b32 v220, 18, v6
  v_lshl_or_b32 v220, v5, 2, v220
  s_and_b32 s60, s3, 1
  s_lshl_b32 s60, s60, 22
  s_lshl_b32 s43, s38, 12
  s_add_u32 s60, s60, s43
  s_lshl_b32 s43, s39, 6
  s_add_u32 s60, s60, s43
  s_lshr_b32 s43, s3, 1
  s_lshl_b32 s43, s43, 11
  s_add_u32 s60, s60, s43
  s_waitcnt lgkmcnt(15)
  v_mfma_f32_16x16x32_bf16 v[116:119], v[52:55], v[188:191], 0
  s_waitcnt lgkmcnt(14)
  v_mfma_f32_16x16x32_bf16 v[148:151], v[52:55], v[204:207], 0
  v_mfma_f32_16x16x32_bf16 v[116:119], v[56:59], v[192:195], v[116:119]
  s_waitcnt lgkmcnt(12)
  v_mfma_f32_16x16x32_bf16 v[148:151], v[56:59], v[208:211], v[148:151]
  v_mfma_f32_16x16x32_bf16 v[116:119], v[60:63], v[196:199], v[116:119]
  s_waitcnt lgkmcnt(10)
  v_mfma_f32_16x16x32_bf16 v[148:151], v[60:63], v[212:215], v[148:151]
  v_mfma_f32_16x16x32_bf16 v[116:119], v[64:67], v[200:203], v[116:119]
  s_waitcnt lgkmcnt(8)
  v_mfma_f32_16x16x32_bf16 v[148:151], v[64:67], v[216:219], v[148:151]
  v_mfma_f32_16x16x32_bf16 v[120:123], v[68:71], v[188:191], 0
  v_mfma_f32_16x16x32_bf16 v[152:155], v[68:71], v[204:207], 0
  v_mfma_f32_16x16x32_bf16 v[120:123], v[72:75], v[192:195], v[120:123]
  v_mfma_f32_16x16x32_bf16 v[152:155], v[72:75], v[208:211], v[152:155]
  v_mfma_f32_16x16x32_bf16 v[120:123], v[76:79], v[196:199], v[120:123]
  v_mfma_f32_16x16x32_bf16 v[152:155], v[76:79], v[212:215], v[152:155]
  v_mfma_f32_16x16x32_bf16 v[120:123], v[80:83], v[200:203], v[120:123]
  v_mfma_f32_16x16x32_bf16 v[152:155], v[80:83], v[216:219], v[152:155]
  v_sub_f32 v224, 1.0, v36
  v_sub_f32 v225, 1.0, v37
  v_cvt_pk_bf16_f32 v225, v224, v225
  v_lshlrev_b32 v224, 16, v225
  v_and_b32 v225, 0xffff0000, v225
  v_sub_f32 v226, 1.0, v38
  v_sub_f32 v227, 1.0, v39
  v_cvt_pk_bf16_f32 v227, v226, v227
  v_lshlrev_b32 v226, 16, v227
  v_and_b32 v227, 0xffff0000, v227
  s_waitcnt lgkmcnt(7)
  v_pk_add_f32 v[12:13], v[12:13], v[20:21]
  v_pk_mul_f32 v[12:13], v[224:225], v[12:13]
  v_pk_add_f32 v[14:15], v[14:15], v[22:23]
  v_pk_mul_f32 v[14:15], v[226:227], v[14:15]
  s_waitcnt lgkmcnt(6)
  v_pk_add_f32 v[132:133], v[132:133], v[172:173]
  v_pk_mul_f32 v[132:133], v[224:225], v[132:133]
  v_pk_add_f32 v[134:135], v[134:135], v[174:175]
  v_pk_mul_f32 v[134:135], v[226:227], v[134:135]
  v_pk_fma_f32 v[12:13], v[36:37], v[116:117], v[12:13]
  v_pk_fma_f32 v[14:15], v[38:39], v[118:119], v[14:15]
  v_pk_fma_f32 v[132:133], v[36:37], v[148:149], v[132:133]
  v_pk_fma_f32 v[134:135], v[38:39], v[150:151], v[134:135]
  buffer_store_dword v12, v220, s[56:59], s60 offen offset:0
  buffer_store_dword v132, v220, s[56:59], s60 offen offset:1024
  s_add_u32 s60, s60, 65536
  buffer_store_dword v13, v220, s[56:59], s60 offen offset:0
  buffer_store_dword v133, v220, s[56:59], s60 offen offset:1024
  s_add_u32 s60, s60, 65536
  buffer_store_dword v14, v220, s[56:59], s60 offen offset:0
  buffer_store_dword v134, v220, s[56:59], s60 offen offset:1024
  s_add_u32 s60, s60, 65536
  buffer_store_dword v15, v220, s[56:59], s60 offen offset:0
  buffer_store_dword v135, v220, s[56:59], s60 offen offset:1024
  s_add_u32 s60, s60, 851968
  v_mfma_f32_16x16x32_bf16 v[124:127], v[84:87], v[188:191], 0
  v_mfma_f32_16x16x32_bf16 v[156:159], v[84:87], v[204:207], 0
  v_mfma_f32_16x16x32_bf16 v[124:127], v[88:91], v[192:195], v[124:127]
  v_mfma_f32_16x16x32_bf16 v[156:159], v[88:91], v[208:211], v[156:159]
  v_mfma_f32_16x16x32_bf16 v[124:127], v[92:95], v[196:199], v[124:127]
  v_mfma_f32_16x16x32_bf16 v[156:159], v[92:95], v[212:215], v[156:159]
  v_mfma_f32_16x16x32_bf16 v[124:127], v[96:99], v[200:203], v[124:127]
  v_mfma_f32_16x16x32_bf16 v[156:159], v[96:99], v[216:219], v[156:159]
  v_sub_f32 v224, 1.0, v40
  v_sub_f32 v225, 1.0, v41
  v_cvt_pk_bf16_f32 v225, v224, v225
  v_lshlrev_b32 v224, 16, v225
  v_and_b32 v225, 0xffff0000, v225
  v_sub_f32 v226, 1.0, v42
  v_sub_f32 v227, 1.0, v43
  v_cvt_pk_bf16_f32 v227, v226, v227
  v_lshlrev_b32 v226, 16, v227
  v_and_b32 v227, 0xffff0000, v227
  s_waitcnt lgkmcnt(5)
  v_pk_add_f32 v[16:17], v[16:17], v[24:25]
  v_pk_mul_f32 v[16:17], v[224:225], v[16:17]
  v_pk_add_f32 v[18:19], v[18:19], v[26:27]
  v_pk_mul_f32 v[18:19], v[226:227], v[18:19]
  s_waitcnt lgkmcnt(4)
  v_pk_add_f32 v[136:137], v[136:137], v[176:177]
  v_pk_mul_f32 v[136:137], v[224:225], v[136:137]
  v_pk_add_f32 v[138:139], v[138:139], v[178:179]
  v_pk_mul_f32 v[138:139], v[226:227], v[138:139]
  v_pk_fma_f32 v[16:17], v[40:41], v[120:121], v[16:17]
  v_pk_fma_f32 v[18:19], v[42:43], v[122:123], v[18:19]
  v_pk_fma_f32 v[136:137], v[40:41], v[152:153], v[136:137]
  v_pk_fma_f32 v[138:139], v[42:43], v[154:155], v[138:139]
  buffer_store_dword v16, v220, s[56:59], s60 offen offset:0
  buffer_store_dword v136, v220, s[56:59], s60 offen offset:1024
  s_add_u32 s60, s60, 65536
  buffer_store_dword v17, v220, s[56:59], s60 offen offset:0
  buffer_store_dword v137, v220, s[56:59], s60 offen offset:1024
  s_add_u32 s60, s60, 65536
  buffer_store_dword v18, v220, s[56:59], s60 offen offset:0
  buffer_store_dword v138, v220, s[56:59], s60 offen offset:1024
  s_add_u32 s60, s60, 65536
  buffer_store_dword v19, v220, s[56:59], s60 offen offset:0
  buffer_store_dword v139, v220, s[56:59], s60 offen offset:1024
  s_add_u32 s60, s60, 851968
  v_mfma_f32_16x16x32_bf16 v[128:131], v[100:103], v[188:191], 0
  v_mfma_f32_16x16x32_bf16 v[160:163], v[100:103], v[204:207], 0
  v_mfma_f32_16x16x32_bf16 v[128:131], v[104:107], v[192:195], v[128:131]
  v_mfma_f32_16x16x32_bf16 v[160:163], v[104:107], v[208:211], v[160:163]
  v_mfma_f32_16x16x32_bf16 v[128:131], v[108:111], v[196:199], v[128:131]
  v_mfma_f32_16x16x32_bf16 v[160:163], v[108:111], v[212:215], v[160:163]
  v_mfma_f32_16x16x32_bf16 v[128:131], v[112:115], v[200:203], v[128:131]
  v_mfma_f32_16x16x32_bf16 v[160:163], v[112:115], v[216:219], v[160:163]
  v_sub_f32 v224, 1.0, v44
  v_sub_f32 v225, 1.0, v45
  v_cvt_pk_bf16_f32 v225, v224, v225
  v_lshlrev_b32 v224, 16, v225
  v_and_b32 v225, 0xffff0000, v225
  v_sub_f32 v226, 1.0, v46
  v_sub_f32 v227, 1.0, v47
  v_cvt_pk_bf16_f32 v227, v226, v227
  v_lshlrev_b32 v226, 16, v227
  v_and_b32 v227, 0xffff0000, v227
  s_waitcnt lgkmcnt(3)
  v_pk_add_f32 v[28:29], v[28:29], v[164:165]
  v_pk_mul_f32 v[28:29], v[224:225], v[28:29]
  v_pk_add_f32 v[30:31], v[30:31], v[166:167]
  v_pk_mul_f32 v[30:31], v[226:227], v[30:31]
  s_waitcnt lgkmcnt(2)
  v_pk_add_f32 v[140:141], v[140:141], v[180:181]
  v_pk_mul_f32 v[140:141], v[224:225], v[140:141]
  v_pk_add_f32 v[142:143], v[142:143], v[182:183]
  v_pk_mul_f32 v[142:143], v[226:227], v[142:143]
  v_pk_fma_f32 v[28:29], v[44:45], v[124:125], v[28:29]
  v_pk_fma_f32 v[30:31], v[46:47], v[126:127], v[30:31]
  v_pk_fma_f32 v[140:141], v[44:45], v[156:157], v[140:141]
  v_pk_fma_f32 v[142:143], v[46:47], v[158:159], v[142:143]
  buffer_store_dword v28, v220, s[56:59], s60 offen offset:0
  buffer_store_dword v140, v220, s[56:59], s60 offen offset:1024
  s_add_u32 s60, s60, 65536
  buffer_store_dword v29, v220, s[56:59], s60 offen offset:0
  buffer_store_dword v141, v220, s[56:59], s60 offen offset:1024
  s_add_u32 s60, s60, 65536
  buffer_store_dword v30, v220, s[56:59], s60 offen offset:0
  buffer_store_dword v142, v220, s[56:59], s60 offen offset:1024
  s_add_u32 s60, s60, 65536
  buffer_store_dword v31, v220, s[56:59], s60 offen offset:0
  buffer_store_dword v143, v220, s[56:59], s60 offen offset:1024
  s_add_u32 s60, s60, 851968
  v_sub_f32 v224, 1.0, v48
  v_sub_f32 v225, 1.0, v49
  v_cvt_pk_bf16_f32 v225, v224, v225
  v_lshlrev_b32 v224, 16, v225
  v_and_b32 v225, 0xffff0000, v225
  v_sub_f32 v226, 1.0, v50
  v_sub_f32 v227, 1.0, v51
  v_cvt_pk_bf16_f32 v227, v226, v227
  v_lshlrev_b32 v226, 16, v227
  v_and_b32 v227, 0xffff0000, v227
  s_waitcnt lgkmcnt(1)
  v_pk_add_f32 v[32:33], v[32:33], v[168:169]
  v_pk_mul_f32 v[32:33], v[224:225], v[32:33]
  v_pk_add_f32 v[34:35], v[34:35], v[170:171]
  v_pk_mul_f32 v[34:35], v[226:227], v[34:35]
  s_waitcnt lgkmcnt(0)
  v_pk_add_f32 v[144:145], v[144:145], v[184:185]
  v_pk_mul_f32 v[144:145], v[224:225], v[144:145]
  v_pk_add_f32 v[146:147], v[146:147], v[186:187]
  v_pk_mul_f32 v[146:147], v[226:227], v[146:147]
  v_pk_fma_f32 v[32:33], v[48:49], v[128:129], v[32:33]
  v_pk_fma_f32 v[34:35], v[50:51], v[130:131], v[34:35]
  v_pk_fma_f32 v[144:145], v[48:49], v[160:161], v[144:145]
  v_pk_fma_f32 v[146:147], v[50:51], v[162:163], v[146:147]
  buffer_store_dword v32, v220, s[56:59], s60 offen offset:0
  buffer_store_dword v144, v220, s[56:59], s60 offen offset:1024
  s_add_u32 s60, s60, 65536
  buffer_store_dword v33, v220, s[56:59], s60 offen offset:0
  buffer_store_dword v145, v220, s[56:59], s60 offen offset:1024
  s_add_u32 s60, s60, 65536
  buffer_store_dword v34, v220, s[56:59], s60 offen offset:0
  buffer_store_dword v146, v220, s[56:59], s60 offen offset:1024
  s_add_u32 s60, s60, 65536
  buffer_store_dword v35, v220, s[56:59], s60 offen offset:0
  buffer_store_dword v147, v220, s[56:59], s60 offen offset:1024
gated_mix__spectral_gfnet__ssm_conv_s5__prompt_kernel_end:
  s_endpgm
.section .rodata,"a"
.p2align 6
.amdhsa_kernel gated_mix__spectral_gfnet__ssm_conv_s5__prompt_kernel
  .amdhsa_next_free_vgpr 500
  .amdhsa_next_free_sgpr 102
  .amdhsa_accum_offset 244
  .amdhsa_group_segment_fixed_size 0
  .amdhsa_kernarg_size 128
  .amdhsa_user_sgpr_count 2
  .amdhsa_user_sgpr_kernarg_segment_ptr 1
  .amdhsa_system_sgpr_workgroup_id_x 1
  .amdhsa_float_denorm_mode_32 3
.end_amdhsa_kernel
```

```asm
; @launch grid=(256,1,1) block=(256,1,1) lds=163840
.amdgcn_target "amdgcn-amd-amdhsa--gfx950"
.text
.p2align 8
.globl gated_mix__spectral_gfnet__ssm_conv_s5__prompt_kernel
.type gated_mix__spectral_gfnet__ssm_conv_s5__prompt_kernel,@function
gated_mix__spectral_gfnet__ssm_conv_s5__prompt_kernel:
  s_cmp_ge_u32 s2, 256
  s_cbranch_scc1 gated_mix__spectral_gfnet__ssm_conv_s5__prompt_kernel_end
  s_load_dwordx16 s[4:19], s[0:1], 0
  s_load_dwordx16 s[20:35], s[0:1], 64
  s_getpc_b64 s[36:37]
gated_mix__spectral_gfnet__ssm_conv_s5__prompt_kernel_pc1:
  s_lshr_b32 s3, s2, 3
  s_mul_i32 s3, s3, 1280
  s_add_u32 s3, s3, 0
  v_min_u32 v2, 9, v0
  v_lshl_add_u32 v2, v2, 7, s3
  v_min_u32 v2, gated_mix__spectral_gfnet__ssm_conv_s5__prompt_kernel_end-gated_mix__spectral_gfnet__ssm_conv_s5__prompt_kernel_pc1, v2
  v_mov_b32 v3, s37
  v_add_co_u32 v2, vcc, s36, v2
  s_nop 1
  v_addc_co_u32 v3, vcc, 0, v3, vcc
  v_lshrrev_b32 v4, 6, v0
  s_nop 0
  v_readfirstlane_b32 s3, v4
  v_and_b32 v4, 63, v0
  v_and_b32 v5, 15, v0
  v_bfe_u32 v6, v0, 4, 2
  s_and_b32 s36, s2, 7
  s_lshr_b32 s37, s2, 3
  s_and_b32 s41, s37, 3
  s_lshr_b32 s37, s37, 2
  s_lshl_b32 s40, s36, 3
  s_add_u32 s40, s40, s37
  s_and_b32 s38, s36, 3
  s_lshl_b32 s38, s38, 2
  s_add_u32 s38, s38, s41
  s_lshr_b32 s39, s36, 2
  s_lshl_b32 s39, s39, 3
  s_add_u32 s39, s39, s37
  s_cmp_lg_u32 s3, 0
  s_cbranch_scc1 gated_mix__spectral_gfnet__ssm_conv_s5__prompt_kernel_skip2
  global_load_dword v1, v[2:3], off
gated_mix__spectral_gfnet__ssm_conv_s5__prompt_kernel_skip2:
  s_waitcnt lgkmcnt(0)
  s_mov_b32 s44, s4
  s_mov_b32 s45, s5
  s_mov_b32 s46, 4194304
  s_mov_b32 s47, 0x20000
  s_add_u32 s48, s34, 20316160
  s_addc_u32 s49, s35, 0
  s_mov_b32 s50, 40960
  s_mov_b32 s51, 0x20000
  s_mov_b32 s52, s32
  s_mov_b32 s53, s33
  s_mov_b32 s54, 256
  s_mov_b32 s55, 0x20000
  v_mov_b32 v2, 0
  v_lshlrev_b32 v3, 4, v0
  s_cmp_lg_u32 s2, 0
  s_cbranch_scc1 gated_mix__spectral_gfnet__ssm_conv_s5__prompt_kernel_skip3
  buffer_store_dword v2, v3, s[48:51], 0 offen sc1
gated_mix__spectral_gfnet__ssm_conv_s5__prompt_kernel_skip3:
  v_bfe_u32 v8, v4, 1, 2
  v_xor_b32 v8, v8, v6
  v_lshlrev_b32 v7, 9, v8
  v_and_b32 v8, 1, v4
  v_lshl_or_b32 v7, v8, 4, v7
  v_lshrrev_b32 v8, 3, v4
  v_lshl_or_b32 v7, v8, 15, v7
  s_lshl_b32 s10, s38, 11
  s_lshl_b32 m0, s39, 5
  s_add_u32 s10, s10, m0
  s_lshl_b32 m0, s3, 20
  s_add_u32 s10, s10, m0
  s_lshl_b32 m0, s3, 12
  s_add_u32 m0, m0, 131072
  s_nop 0
  buffer_load_dwordx4 v7, s[44:47], s10 offen offset:0 lds
  s_add_u32 s10, s10, 261120
  buffer_load_dwordx4 v7, s[44:47], s10 offen offset:1024 lds
  s_add_u32 s10, s10, 261120
  buffer_load_dwordx4 v7, s[44:47], s10 offen offset:2048 lds
  s_add_u32 s10, s10, 261120
  buffer_load_dwordx4 v7, s[44:47], s10 offen offset:3072 lds
  s_bitcmp1_b32 s3, 0
  s_cselect_b32 s56, s18, s16
  s_cselect_b32 s57, s19, s17
  s_mov_b32 s58, 2097152
  s_mov_b32 s59, 0x20000
  v_lshrrev_b32 v24, 5, v4
  v_lshlrev_b32 v24, 5, v24
  v_bfe_u32 v25, v4, 3, 1
  v_lshl_or_b32 v24, v25, 4, v24
  v_bfe_u32 v25, v4, 4, 1
  v_or_b32 v24, v24, v25
  v_lshlrev_b32 v24, 11, v24
  v_lshrrev_b32 v25, 3, v4
  v_lshlrev_b32 v25, 11, v25
  v_and_b32 v26, 7, v4
  v_xor_b32 v26, v26, v6
  v_lshlrev_b32 v26, 4, v26
  v_or_b32 v24, v24, v26
  v_or_b32 v25, v25, v26
  v_xor_b32 v8, 0, v24
  v_add_u32 v8, 0, v8
  v_xor_b32 v12, 0, v25
  v_add_u32 v12, 0, v12
  v_xor_b32 v9, 64, v24
  v_add_u32 v9, 3072, v9
  v_xor_b32 v13, 64, v25
  v_add_u32 v13, 15360, v13
  v_xor_b32 v10, 0, v24
  v_add_u32 v10, 6144, v10
  v_xor_b32 v14, 0, v25
  v_add_u32 v14, 30720, v14
  v_xor_b32 v11, 64, v24
  v_add_u32 v11, 9216, v11
  v_xor_b32 v15, 64, v25
  v_add_u32 v15, 46080, v15
  s_lshl_b32 s10, s38, 18
  s_lshr_b32 s18, s3, 1
  s_lshl_b32 s16, s18, 17
  s_add_u32 s10, s10, s16
  s_lshl_b32 s11, s39, 17
  s_lshl_b32 s16, s18, 16
  s_add_u32 s11, s11, s16
  s_and_b32 s18, s3, 1
  s_lshl_b32 s18, s18, 14
  s_add_u32 s10, s10, s18
  s_lshl_b32 s18, s3, 12
  s_add_u32 s16, s18, 0
  s_add_u32 s17, s18, 65536
  v_and_b32 v24, 31, v4
  v_lshlrev_b32 v24, 7, v24
  v_bfe_u32 v25, v4, 1, 3
  v_lshrrev_b32 v26, 5, v4
  v_xor_b32 v25, v25, v26
  v_lshl_or_b32 v24, v25, 4, v24
  s_lshr_b32 s18, s3, 1
  s_lshl_b32 s18, s18, 13
  s_add_u32 s18, s18, 0
  v_add_u32 v25, s18, v24
  s_and_b32 s18, s3, 1
  s_lshl_b32 s18, s18, 13
  s_add_u32 s18, s18, 65536
  v_add_u32 v26, s18, v24
  v_xor_b32 v16, 0, v25
  v_xor_b32 v20, 0, v26
  v_xor_b32 v17, 32, v25
  v_xor_b32 v21, 32, v26
  v_xor_b32 v18, 64, v25
  v_xor_b32 v22, 64, v26
  v_xor_b32 v19, 96, v25
  v_xor_b32 v23, 96, v26
  v_add_u32 v8, s10, v8
  v_add_u32 v12, s11, v12
  v_add_u32 v9, s10, v9
  v_add_u32 v13, s11, v13
  v_add_u32 v10, s10, v10
  v_add_u32 v14, s11, v14
  v_add_u32 v11, s10, v11
  v_add_u32 v15, s11, v15
  s_add_u32 s10, s38, s39
  s_and_b32 s10, s10, 15
  s_lshl_b32 s10, s10, 7
  s_and_b32 s4, s2, 7
  s_lshl_b32 s4, s4, 9
  s_lshr_b32 s5, s2, 3
  s_lshl_b32 s5, s5, 4
  s_add_u32 s4, s4, s5
  v_mov_b32 v24, s4
  s_lshl_b32 s4, s2, 7
  v_mov_b32 v25, s4
  s_mov_b32 s4, 4096
  s_mov_b32 s5, 8192
  v_mov_b32 v7, 1
  s_lshl_b32 s18, s3, 4
  v_add_u32 v62, s18, v5
  v_cvt_f32_u32 v26, v62
  v_mul_f32 v26, 0x3c000000, v26
  v_cmp_eq_u32 vcc, 0, v62
  s_nop 1
  v_cndmask_b32 v27, v26, 0.5, vcc
  v_mov_b32 v60, 0x3e800000
  v_cndmask_b32 v60, v60, 0, vcc
  v_lshrrev_b32 v62, 1, v6
  v_lshlrev_b32 v62, 4, v62
  v_and_b32 v63, 1, v6
  v_lshl_add_u32 v62, v63, 2, v62
  v_cvt_f32_u32 v61, v62
  v_fma_f32 v60, v61, v27, v60
  v_mul_f32 v61, v61, v26
  v_fmamk_f32 v62, v26, 0x0, v61
  v_fmamk_f32 v63, v26, 0x3f800000, v61
  v_cos_f32 v62, v62
  v_cos_f32 v63, v63
  s_nop 0
  v_cvt_pk_bf16_f32 v28, v62, v63
  v_fmamk_f32 v62, v26, 0x40000000, v61
  v_fmamk_f32 v63, v26, 0x40400000, v61
  v_cos_f32 v62, v62
  v_cos_f32 v63, v63
  s_nop 0
  v_cvt_pk_bf16_f32 v29, v62, v63
  v_fmamk_f32 v62, v26, 0x41000000, v61
  v_fmamk_f32 v63, v26, 0x41100000, v61
  v_cos_f32 v62, v62
  v_cos_f32 v63, v63
  s_nop 0
  v_cvt_pk_bf16_f32 v30, v62, v63
  v_fmamk_f32 v62, v26, 0x41200000, v61
  v_fmamk_f32 v63, v26, 0x41300000, v61
  v_cos_f32 v62, v62
  v_cos_f32 v63, v63
  s_nop 0
  v_cvt_pk_bf16_f32 v31, v62, v63
  v_fmamk_f32 v62, v26, 0x42000000, v61
  v_fmamk_f32 v63, v26, 0x42040000, v61
  v_cos_f32 v62, v62
  v_cos_f32 v63, v63
  s_nop 0
  v_cvt_pk_bf16_f32 v32, v62, v63
  v_fmamk_f32 v62, v26, 0x42080000, v61
  v_fmamk_f32 v63, v26, 0x420c0000, v61
  v_cos_f32 v62, v62
  v_cos_f32 v63, v63
  s_nop 0
  v_cvt_pk_bf16_f32 v33, v62, v63
  v_fmamk_f32 v62, v26, 0x42200000, v61
  v_fmamk_f32 v63, v26, 0x42240000, v61
  v_cos_f32 v62, v62
  v_cos_f32 v63, v63
  s_nop 0
  v_cvt_pk_bf16_f32 v34, v62, v63
  v_fmamk_f32 v62, v26, 0x42280000, v61
  v_fmamk_f32 v63, v26, 0x422c0000, v61
  v_cos_f32 v62, v62
  v_cos_f32 v63, v63
  s_nop 0
  v_cvt_pk_bf16_f32 v35, v62, v63
  v_fmamk_f32 v62, v26, 0x42800000, v61
  v_fmamk_f32 v63, v26, 0x42820000, v61
  v_cos_f32 v62, v62
  v_cos_f32 v63, v63
  s_nop 0
  v_cvt_pk_bf16_f32 v36, v62, v63
  v_fmamk_f32 v62, v26, 0x42840000, v61
  v_fmamk_f32 v63, v26, 0x42860000, v61
  v_cos_f32 v62, v62
  v_cos_f32 v63, v63
  s_nop 0
  v_cvt_pk_bf16_f32 v37, v62, v63
  v_fmamk_f32 v62, v26, 0x42900000, v61
  v_fmamk_f32 v63, v26, 0x42920000, v61
  v_cos_f32 v62, v62
  v_cos_f32 v63, v63
  s_nop 0
  v_cvt_pk_bf16_f32 v38, v62, v63
  v_fmamk_f32 v62, v26, 0x42940000, v61
  v_fmamk_f32 v63, v26, 0x42960000, v61
  v_cos_f32 v62, v62
  v_cos_f32 v63, v63
  s_nop 0
  v_cvt_pk_bf16_f32 v39, v62, v63
  v_fmamk_f32 v62, v26, 0x42c00000, v61
  v_fmamk_f32 v63, v26, 0x42c20000, v61
  v_cos_f32 v62, v62
  v_cos_f32 v63, v63
  s_nop 0
  v_cvt_pk_bf16_f32 v40, v62, v63
  v_fmamk_f32 v62, v26, 0x42c40000, v61
  v_fmamk_f32 v63, v26, 0x42c60000, v61
  v_cos_f32 v62, v62
  v_cos_f32 v63, v63
  s_nop 0
  v_cvt_pk_bf16_f32 v41, v62, v63
  v_fmamk_f32 v62, v26, 0x42d00000, v61
  v_fmamk_f32 v63, v26, 0x42d20000, v61
  v_cos_f32 v62, v62
  v_cos_f32 v63, v63
  s_nop 0
  v_cvt_pk_bf16_f32 v42, v62, v63
  v_fmamk_f32 v62, v26, 0x42d40000, v61
  v_fmamk_f32 v63, v26, 0x42d60000, v61
  v_cos_f32 v62, v62
  v_cos_f32 v63, v63
  s_nop 0
  v_cvt_pk_bf16_f32 v43, v62, v63
  v_fmamk_f32 v62, v27, 0x0, v60
  v_fmamk_f32 v63, v27, 0x3f800000, v60
  v_cos_f32 v62, v62
  v_cos_f32 v63, v63
  s_nop 0
  v_cvt_pk_bf16_f32 v44, v62, v63
  v_fmamk_f32 v62, v27, 0x40000000, v60
  v_fmamk_f32 v63, v27, 0x40400000, v60
  v_cos_f32 v62, v62
  v_cos_f32 v63, v63
  s_nop 0
  v_cvt_pk_bf16_f32 v45, v62, v63
  v_fmamk_f32 v62, v27, 0x41000000, v60
  v_fmamk_f32 v63, v27, 0x41100000, v60
  v_cos_f32 v62, v62
  v_cos_f32 v63, v63
  s_nop 0
  v_cvt_pk_bf16_f32 v46, v62, v63
  v_fmamk_f32 v62, v27, 0x41200000, v60
  v_fmamk_f32 v63, v27, 0x41300000, v60
  v_cos_f32 v62, v62
  v_cos_f32 v63, v63
  s_nop 0
  v_cvt_pk_bf16_f32 v47, v62, v63
  v_fmamk_f32 v62, v27, 0x42000000, v60
  v_fmamk_f32 v63, v27, 0x42040000, v60
  v_cos_f32 v62, v62
  v_cos_f32 v63, v63
  s_nop 0
  v_cvt_pk_bf16_f32 v48, v62, v63
  v_fmamk_f32 v62, v27, 0x42080000, v60
  v_fmamk_f32 v63, v27, 0x420c0000, v60
  v_cos_f32 v62, v62
  v_cos_f32 v63, v63
  s_nop 0
  v_cvt_pk_bf16_f32 v49, v62, v63
  v_fmamk_f32 v62, v27, 0x42200000, v60
  v_fmamk_f32 v63, v27, 0x42240000, v60
  v_cos_f32 v62, v62
  v_cos_f32 v63, v63
  s_nop 0
  v_cvt_pk_bf16_f32 v50, v62, v63
  v_fmamk_f32 v62, v27, 0x42280000, v60
  v_fmamk_f32 v63, v27, 0x422c0000, v60
  v_cos_f32 v62, v62
  v_cos_f32 v63, v63
  s_nop 0
  v_cvt_pk_bf16_f32 v51, v62, v63
  v_fmamk_f32 v62, v27, 0x42800000, v60
  v_fmamk_f32 v63, v27, 0x42820000, v60
  v_cos_f32 v62, v62
  v_cos_f32 v63, v63
  s_nop 0
  v_cvt_pk_bf16_f32 v52, v62, v63
  v_fmamk_f32 v62, v27, 0x42840000, v60
  v_fmamk_f32 v63, v27, 0x42860000, v60
  v_cos_f32 v62, v62
  v_cos_f32 v63, v63
  s_nop 0
  v_cvt_pk_bf16_f32 v53, v62, v63
  v_fmamk_f32 v62, v27, 0x42900000, v60
  v_fmamk_f32 v63, v27, 0x42920000, v60
  v_cos_f32 v62, v62
  v_cos_f32 v63, v63
  s_nop 0
  v_cvt_pk_bf16_f32 v54, v62, v63
  v_fmamk_f32 v62, v27, 0x42940000, v60
  v_fmamk_f32 v63, v27, 0x42960000, v60
  v_cos_f32 v62, v62
  v_cos_f32 v63, v63
  s_nop 0
  v_cvt_pk_bf16_f32 v55, v62, v63
  v_fmamk_f32 v62, v27, 0x42c00000, v60
  v_fmamk_f32 v63, v27, 0x42c20000, v60
  v_cos_f32 v62, v62
  v_cos_f32 v63, v63
  s_nop 0
  v_cvt_pk_bf16_f32 v56, v62, v63
  v_fmamk_f32 v62, v27, 0x42c40000, v60
  v_fmamk_f32 v63, v27, 0x42c60000, v60
  v_cos_f32 v62, v62
  v_cos_f32 v63, v63
  s_nop 0
  v_cvt_pk_bf16_f32 v57, v62, v63
  v_fmamk_f32 v62, v27, 0x42d00000, v60
  v_fmamk_f32 v63, v27, 0x42d20000, v60
  v_cos_f32 v62, v62
  v_cos_f32 v63, v63
  s_nop 0
  v_cvt_pk_bf16_f32 v58, v62, v63
  v_fmamk_f32 v62, v27, 0x42d40000, v60
  v_fmamk_f32 v63, v27, 0x42d60000, v60
  v_cos_f32 v62, v62
  v_cos_f32 v63, v63
  s_nop 0
  v_cvt_pk_bf16_f32 v59, v62, v63
  s_add_u32 m0, s17, 0
  s_nop 0
  buffer_load_dwordx4 v12, s[56:59], s10 offen offset:0 lds
  buffer_load_dwordx4 v13, s[56:59], s10 offen offset:1024 lds
  buffer_load_dwordx4 v14, s[56:59], s10 offen offset:2048 lds
  buffer_load_dwordx4 v15, s[56:59], s10 offen offset:3072 lds
  s_add_u32 m0, s16, 0
  s_nop 0
  buffer_load_dwordx4 v8, s[44:47], s10 offen offset:0 lds
  buffer_load_dwordx4 v9, s[44:47], s10 offen offset:1024 lds
  buffer_load_dwordx4 v10, s[44:47], s10 offen offset:2048 lds
  buffer_load_dwordx4 v11, s[44:47], s10 offen offset:3072 lds
  s_add_u32 s10, s10, 128
  s_and_b32 s10, s10, 0x7ff
  s_mov_b32 s60, s28
  s_mov_b32 s61, s29
  s_mov_b32 s62, 2048
  s_mov_b32 s63, 0x20000
  v_lshlrev_b32 v26, 4, v4
  s_lshl_b32 s18, s2, 14
  s_lshl_b32 s19, s3, 12
  s_add_u32 s18, s18, s19
  buffer_load_dwordx4 v[60:63], v26, s[44:47], s18 offen offset:0
  buffer_load_dwordx4 v[64:67], v26, s[44:47], s18 offen offset:1024
  buffer_load_dwordx4 v[68:71], v26, s[44:47], s18 offen offset:2048
  buffer_load_dwordx4 v[72:75], v26, s[44:47], s18 offen offset:3072
  buffer_load_dwordx4 v[76:79], v26, s[60:63], 0 offen offset:0
  buffer_load_dwordx4 v[80:83], v26, s[60:63], 0 offen offset:1024
  s_mov_b32 s60, s12
  s_mov_b32 s61, s13
  s_mov_b32 s62, 2048
  s_mov_b32 s63, 0x20000
  s_mov_b32 s64, s14
  s_mov_b32 s65, s15
  s_mov_b32 s66, 2048
  s_mov_b32 s67, 0x20000
  s_mov_b32 s68, s24
  s_mov_b32 s69, s25
  s_mov_b32 s70, 2048
  s_mov_b32 s71, 0x20000
  s_mov_b32 s72, s26
  s_mov_b32 s73, s27
  s_mov_b32 s74, 2048
  s_mov_b32 s75, 0x20000
  v_and_b32 v26, 31, v4
  v_lshlrev_b32 v26, 1, v26
  s_lshl_b32 s12, s39, 7
  s_and_b32 s13, s3, 1
  s_lshl_b32 s13, s13, 6
  s_add_u32 s12, s12, s13
  buffer_load_ushort v84, v26, s[60:63], s12 offen
  buffer_load_ushort v85, v26, s[64:67], s12 offen
  buffer_load_ushort v86, v26, s[68:71], s12 offen
  v_lshlrev_b32 v87, 1, v5
  s_lshl_b32 s12, s39, 5
  s_lshr_b32 s13, s3, 1
  s_lshl_b32 s13, s13, 10
  s_add_u32 s12, s12, s13
  buffer_load_short_d16_hi v26, v87, s[72:75], s12 offen offset:0
  buffer_load_short_d16_hi v27, v87, s[72:75], s12 offen offset:512
  s_mov_b32 s12, s34
  s_mov_b32 s13, s35
  s_mov_b32 s14, 4194304
  s_mov_b32 s15, 0x20000
  v_bfe_u32 v87, v4, 2, 3
  v_lshrrev_b32 v92, 5, v4
  v_lshl_or_b32 v87, v92, 4, v87
  v_lshlrev_b32 v87, 7, v87
  v_and_b32 v92, 3, v4
  v_lshl_or_b32 v87, v92, 3, v87
  v_add_u32 v87, 131072, v87
  v_bfe_u32 v92, v4, 3, 2
  v_xor_b32 v88, 0, v92
  v_lshl_add_u32 v88, v88, 5, v87
  v_xor_b32 v89, 1, v92
  v_lshl_add_u32 v89, v89, 5, v87
  v_xor_b32 v90, 2, v92
  v_lshl_add_u32 v90, v90, 5, v87
  v_xor_b32 v91, 3, v92
  v_lshl_add_u32 v91, v91, 5, v87
  s_waitcnt vmcnt(19)
  s_barrier
  s_or_b32 m0, s3, s2
  s_cmp_lg_u32 m0, 0
  s_cbranch_scc1 gated_mix__spectral_gfnet__ssm_conv_s5__prompt_kernel_skip4
  s_mov_b64 exec, 1
  buffer_store_dword v7, v2, s[52:55], 0 offen sc1
  s_mov_b64 exec, -1
gated_mix__spectral_gfnet__ssm_conv_s5__prompt_kernel_skip4:
  ds_read_b64_tr_b16 v[128:129], v88 offset:0
  ds_read_b64_tr_b16 v[130:131], v88 offset:1024
  ds_read_b64_tr_b16 v[132:133], v88 offset:4096
  ds_read_b64_tr_b16 v[134:135], v88 offset:5120
  ds_read_b64_tr_b16 v[136:137], v88 offset:8192
  ds_read_b64_tr_b16 v[138:139], v88 offset:9216
  ds_read_b64_tr_b16 v[140:141], v88 offset:12288
  ds_read_b64_tr_b16 v[142:143], v88 offset:13312
  ds_read_b64_tr_b16 v[160:161], v90 offset:0
  ds_read_b64_tr_b16 v[162:163], v90 offset:1024
  ds_read_b64_tr_b16 v[164:165], v90 offset:4096
  ds_read_b64_tr_b16 v[166:167], v90 offset:5120
  ds_read_b64_tr_b16 v[168:169], v90 offset:8192
  ds_read_b64_tr_b16 v[170:171], v90 offset:9216
  ds_read_b64_tr_b16 v[172:173], v90 offset:12288
  ds_read_b64_tr_b16 v[174:175], v90 offset:13312
  ds_read_b64_tr_b16 v[144:145], v89 offset:0
  ds_read_b64_tr_b16 v[146:147], v89 offset:1024
  ds_read_b64_tr_b16 v[148:149], v89 offset:4096
  ds_read_b64_tr_b16 v[150:151], v89 offset:5120
  ds_read_b64_tr_b16 v[152:153], v89 offset:8192
  ds_read_b64_tr_b16 v[154:155], v89 offset:9216
  ds_read_b64_tr_b16 v[156:157], v89 offset:12288
  ds_read_b64_tr_b16 v[158:159], v89 offset:13312
  s_waitcnt lgkmcnt(15)
  v_mfma_f32_16x16x32_bf16 v[96:99], v[28:31], v[128:131], 0
  v_mfma_f32_16x16x32_bf16 v[100:103], v[44:47], v[128:131], 0
  s_waitcnt lgkmcnt(15)
  v_mfma_f32_16x16x32_bf16 v[96:99], v[32:35], v[132:135], v[96:99]
  v_mfma_f32_16x16x32_bf16 v[100:103], v[48:51], v[132:135], v[100:103]
  s_add_u32 m0, s17, 16384
  s_nop 0
  buffer_load_dwordx4 v12, s[56:59], s10 offen offset:0 lds
  s_waitcnt lgkmcnt(15)
  v_mfma_f32_16x16x32_bf16 v[96:99], v[36:39], v[136:139], v[96:99]
  v_mfma_f32_16x16x32_bf16 v[100:103], v[52:55], v[136:139], v[100:103]
  s_waitcnt lgkmcnt(15)
  v_mfma_f32_16x16x32_bf16 v[96:99], v[40:43], v[140:143], v[96:99]
  v_mfma_f32_16x16x32_bf16 v[100:103], v[56:59], v[140:143], v[100:103]
  buffer_load_dwordx4 v13, s[56:59], s10 offen offset:1024 lds
  ds_read_b64_tr_b16 v[176:177], v91 offset:0
  ds_read_b64_tr_b16 v[178:179], v91 offset:1024
  ds_read_b64_tr_b16 v[180:181], v91 offset:4096
  ds_read_b64_tr_b16 v[182:183], v91 offset:5120
  ds_read_b64_tr_b16 v[184:185], v91 offset:8192
  ds_read_b64_tr_b16 v[186:187], v91 offset:9216
  ds_read_b64_tr_b16 v[188:189], v91 offset:12288
  ds_read_b64_tr_b16 v[190:191], v91 offset:13312
  s_waitcnt lgkmcnt(15)
  v_mfma_f32_16x16x32_bf16 v[112:115], v[28:31], v[160:163], 0
  v_mfma_f32_16x16x32_bf16 v[116:119], v[44:47], v[160:163], 0
  s_waitcnt lgkmcnt(15)
  v_mfma_f32_16x16x32_bf16 v[112:115], v[32:35], v[164:167], v[112:115]
  v_mfma_f32_16x16x32_bf16 v[116:119], v[48:51], v[164:167], v[116:119]
  buffer_load_dwordx4 v14, s[56:59], s10 offen offset:2048 lds
  s_waitcnt lgkmcnt(15)
  v_mfma_f32_16x16x32_bf16 v[112:115], v[36:39], v[168:171], v[112:115]
  v_mfma_f32_16x16x32_bf16 v[116:119], v[52:55], v[168:171], v[116:119]
  s_waitcnt lgkmcnt(15)
  v_mfma_f32_16x16x32_bf16 v[112:115], v[40:43], v[172:175], v[112:115]
  v_mfma_f32_16x16x32_bf16 v[116:119], v[56:59], v[172:175], v[116:119]
  buffer_load_dwordx4 v15, s[56:59], s10 offen offset:3072 lds
  s_waitcnt lgkmcnt(14)
  v_mfma_f32_16x16x32_bf16 v[104:107], v[28:31], v[144:147], 0
  v_mfma_f32_16x16x32_bf16 v[108:111], v[44:47], v[144:147], 0
  s_waitcnt lgkmcnt(12)
  v_mfma_f32_16x16x32_bf16 v[104:107], v[32:35], v[148:151], v[104:107]
  v_mfma_f32_16x16x32_bf16 v[108:111], v[48:51], v[148:151], v[108:111]
  s_add_u32 m0, s16, 16384
  s_nop 0
  buffer_load_dwordx4 v8, s[44:47], s10 offen offset:0 lds
  s_waitcnt lgkmcnt(10)
  v_mfma_f32_16x16x32_bf16 v[104:107], v[36:39], v[152:155], v[104:107]
  v_mfma_f32_16x16x32_bf16 v[108:111], v[52:55], v[152:155], v[108:111]
  s_waitcnt lgkmcnt(8)
  v_mfma_f32_16x16x32_bf16 v[104:107], v[40:43], v[156:159], v[104:107]
  v_mfma_f32_16x16x32_bf16 v[108:111], v[56:59], v[156:159], v[108:111]
  buffer_load_dwordx4 v9, s[44:47], s10 offen offset:1024 lds
  s_waitcnt lgkmcnt(6)
  v_mfma_f32_16x16x32_bf16 v[120:123], v[28:31], v[176:179], 0
  v_mfma_f32_16x16x32_bf16 v[124:127], v[44:47], v[176:179], 0
  s_waitcnt lgkmcnt(4)
  v_mfma_f32_16x16x32_bf16 v[120:123], v[32:35], v[180:183], v[120:123]
  v_mfma_f32_16x16x32_bf16 v[124:127], v[48:51], v[180:183], v[124:127]
  buffer_load_dwordx4 v10, s[44:47], s10 offen offset:2048 lds
  s_waitcnt lgkmcnt(2)
  v_mfma_f32_16x16x32_bf16 v[120:123], v[36:39], v[184:187], v[120:123]
  v_mfma_f32_16x16x32_bf16 v[124:127], v[52:55], v[184:187], v[124:127]
  s_waitcnt lgkmcnt(0)
  v_mfma_f32_16x16x32_bf16 v[120:123], v[40:43], v[188:191], v[120:123]
  v_mfma_f32_16x16x32_bf16 v[124:127], v[56:59], v[188:191], v[124:127]
  buffer_load_dwordx4 v11, s[44:47], s10 offen offset:3072 lds
  s_add_u32 s10, s10, 128
  s_and_b32 s10, s10, 0x7ff
  v_pk_add_f32 v[128:129], v[96:97], v[112:113]
  v_pk_add_f32 v[160:161], v[96:97], v[112:113] neg_lo:[0,1] neg_hi:[0,1]
  v_pk_add_f32 v[130:131], v[98:99], v[114:115]
  v_pk_add_f32 v[162:163], v[98:99], v[114:115] neg_lo:[0,1] neg_hi:[0,1]
  v_pk_add_f32 v[132:133], v[100:101], v[116:117]
  v_pk_add_f32 v[164:165], v[100:101], v[116:117] neg_lo:[0,1] neg_hi:[0,1]
  v_pk_add_f32 v[134:135], v[102:103], v[118:119]
  v_pk_add_f32 v[166:167], v[102:103], v[118:119] neg_lo:[0,1] neg_hi:[0,1]
  v_pk_add_f32 v[136:137], v[104:105], v[120:121]
  v_pk_add_f32 v[168:169], v[104:105], v[120:121] neg_lo:[0,1] neg_hi:[0,1]
  v_pk_add_f32 v[138:139], v[106:107], v[122:123]
  v_pk_add_f32 v[170:171], v[106:107], v[122:123] neg_lo:[0,1] neg_hi:[0,1]
  v_pk_add_f32 v[140:141], v[108:109], v[124:125]
  v_pk_add_f32 v[172:173], v[108:109], v[124:125] neg_lo:[0,1] neg_hi:[0,1]
  v_pk_add_f32 v[142:143], v[110:111], v[126:127]
  v_pk_add_f32 v[174:175], v[110:111], v[126:127] neg_lo:[0,1] neg_hi:[0,1]
  v_pk_add_f32 v[96:97], v[128:129], v[136:137]
  v_pk_add_f32 v[112:113], v[128:129], v[136:137] neg_lo:[0,1] neg_hi:[0,1]
  v_pk_add_f32 v[100:101], v[132:133], v[140:141]
  v_pk_add_f32 v[116:117], v[132:133], v[140:141] neg_lo:[0,1] neg_hi:[0,1]
  v_pk_add_f32 v[104:105], v[160:161], v[172:173]
  v_pk_add_f32 v[108:109], v[164:165], v[168:169] neg_lo:[0,1] neg_hi:[0,1]
  v_pk_add_f32 v[120:121], v[160:161], v[172:173] neg_lo:[0,1] neg_hi:[0,1]
  v_pk_add_f32 v[124:125], v[164:165], v[168:169]
  v_pk_add_f32 v[98:99], v[130:131], v[138:139]
  v_pk_add_f32 v[114:115], v[130:131], v[138:139] neg_lo:[0,1] neg_hi:[0,1]
  v_pk_add_f32 v[102:103], v[134:135], v[142:143]
  v_pk_add_f32 v[118:119], v[134:135], v[142:143] neg_lo:[0,1] neg_hi:[0,1]
  v_pk_add_f32 v[106:107], v[162:163], v[174:175]
  v_pk_add_f32 v[110:111], v[166:167], v[170:171] neg_lo:[0,1] neg_hi:[0,1]
  v_pk_add_f32 v[122:123], v[162:163], v[174:175] neg_lo:[0,1] neg_hi:[0,1]
  v_pk_add_f32 v[126:127], v[166:167], v[170:171]
  v_cmp_gt_u32 vcc, 16, v0
  s_nop 1
  v_cndmask_b32 v104, v104, v160, vcc
  v_cndmask_b32 v108, v108, -v168, vcc
  v_cndmask_b32 v120, v120, v164, vcc
  v_cndmask_b32 v124, v124, -v172, vcc
  v_cvt_pk_bf16_f32 v192, v96, v100
  v_cvt_pk_bf16_f32 v193, v104, v108
  v_cvt_pk_bf16_f32 v194, v112, v116
  v_cvt_pk_bf16_f32 v195, v120, v124
  v_cvt_pk_bf16_f32 v196, v97, v101
  v_cvt_pk_bf16_f32 v197, v105, v109
  v_cvt_pk_bf16_f32 v198, v113, v117
  v_cvt_pk_bf16_f32 v199, v121, v125
  v_cvt_pk_bf16_f32 v200, v98, v102
  v_cvt_pk_bf16_f32 v201, v106, v110
  v_cvt_pk_bf16_f32 v202, v114, v118
  v_cvt_pk_bf16_f32 v203, v122, v126
  v_cvt_pk_bf16_f32 v204, v99, v103
  v_cvt_pk_bf16_f32 v205, v107, v111
  v_cvt_pk_bf16_f32 v206, v115, v119
  v_cvt_pk_bf16_f32 v207, v123, v127
  s_mov_b32 s18, 262144
  v_mul_lo_u32 v87, v6, s18
  v_lshl_add_u32 v87, v5, 2, v87
  s_mul_i32 s18, s3, 1048576
  s_lshl_b32 s19, s38, 10
  s_add_u32 s18, s18, s19
  s_lshl_b32 s19, s39, 6
  s_add_u32 s18, s18, s19
  s_and_b32 s19, s3, 1
  s_lshl_b32 s19, s19, 13
  s_add_u32 s19, s19, 131072
  v_lshrrev_b32 v46, 2, v4
  v_lshlrev_b32 v46, 7, v46
  v_and_b32 v47, 3, v4
  v_lshl_or_b32 v46, v47, 3, v46
  v_add_u32 v46, s19, v46
  v_bfe_u32 v47, v4, 3, 2
  s_and_b32 s19, s3, 2
  v_xor_b32 v47, s19, v47
  v_lshl_add_u32 v44, v47, 5, v46
  v_xor_b32 v45, 32, v44
  ds_read_b64_tr_b16 v[28:29], v44 offset:0
  ds_read_b64_tr_b16 v[30:31], v44 offset:2048
  ds_read_b64_tr_b16 v[32:33], v44 offset:4096
  ds_read_b64_tr_b16 v[34:35], v44 offset:6144
  ds_read_b64_tr_b16 v[36:37], v45 offset:0
  ds_read_b64_tr_b16 v[38:39], v45 offset:2048
  ds_read_b64_tr_b16 v[40:41], v45 offset:4096
  ds_read_b64_tr_b16 v[42:43], v45 offset:6144
  s_add_u32 s24, s34, 19922944
  s_addc_u32 s25, s35, 0
  s_mov_b32 s26, 8192
  s_mov_b32 s27, 0x20000
  s_lshl_b32 s19, s39, 14
  s_add_u32 s62, s19, 19988480
  s_add_u32 s60, s34, s62
  s_addc_u32 s61, s35, 0
  s_mov_b32 s62, 8192
  s_mov_b32 s63, 0x20000
  s_bitcmp1_b32 s3, 0
  s_cselect_b32 s64, s22, s20
  s_cselect_b32 s65, s23, s21
  s_mov_b32 s66, 2097152
  s_mov_b32 s67, 0x20000
  s_mov_b32 s20, s6
  s_mov_b32 s21, s7
  s_mov_b32 s22, 2101248
  s_mov_b32 s23, 0x20000
  s_mov_b32 s68, s8
  s_mov_b32 s69, s9
  s_mov_b32 s70, 2101248
  s_mov_b32 s71, 0x20000
  buffer_store_dword v192, v87, s[12:15], s18 offen sc1
  s_add_u32 s18, s18, 16384
  s_add_u32 m0, s17, 32768
  s_nop 0
  buffer_load_dwordx4 v12, s[56:59], s10 offen offset:0 lds
  buffer_store_dword v193, v87, s[12:15], s18 offen sc1
  s_add_u32 s18, s18, 16384
  buffer_load_dwordx4 v13, s[56:59], s10 offen offset:1024 lds
  buffer_store_dword v194, v87, s[12:15], s18 offen sc1
  s_add_u32 s18, s18, 16384
  buffer_load_dwordx4 v14, s[56:59], s10 offen offset:2048 lds
  buffer_store_dword v195, v87, s[12:15], s18 offen sc1
  s_add_u32 s18, s18, 16384
  buffer_load_dwordx4 v15, s[56:59], s10 offen offset:3072 lds
  buffer_store_dword v196, v87, s[12:15], s18 offen sc1
  s_add_u32 s18, s18, 16384
  s_add_u32 m0, s16, 32768
  s_nop 0
  buffer_load_dwordx4 v8, s[44:47], s10 offen offset:0 lds
  buffer_store_dword v197, v87, s[12:15], s18 offen sc1
  s_add_u32 s18, s18, 16384
  buffer_load_dwordx4 v9, s[44:47], s10 offen offset:1024 lds
  buffer_store_dword v198, v87, s[12:15], s18 offen sc1
  s_add_u32 s18, s18, 16384
  buffer_load_dwordx4 v10, s[44:47], s10 offen offset:2048 lds
  buffer_store_dword v199, v87, s[12:15], s18 offen sc1
  s_add_u32 s18, s18, 16384
  buffer_load_dwordx4 v11, s[44:47], s10 offen offset:3072 lds
  s_add_u32 s10, s10, 128
  s_and_b32 s10, s10, 0x7ff
  buffer_store_dword v200, v87, s[12:15], s18 offen sc1
  s_add_u32 s18, s18, 16384
  s_add_u32 m0, s17, 49152
  s_nop 0
  buffer_load_dwordx4 v12, s[56:59], s10 offen offset:0 lds
  buffer_store_dword v201, v87, s[12:15], s18 offen sc1
  s_add_u32 s18, s18, 16384
  buffer_load_dwordx4 v13, s[56:59], s10 offen offset:1024 lds
  buffer_store_dword v202, v87, s[12:15], s18 offen sc1
  s_add_u32 s18, s18, 16384
  buffer_load_dwordx4 v14, s[56:59], s10 offen offset:2048 lds
  buffer_store_dword v203, v87, s[12:15], s18 offen sc1
  s_add_u32 s18, s18, 16384
  buffer_load_dwordx4 v15, s[56:59], s10 offen offset:3072 lds
  buffer_store_dword v204, v87, s[12:15], s18 offen sc1
  s_add_u32 s18, s18, 16384
  s_add_u32 m0, s16, 49152
  s_nop 0
  buffer_load_dwordx4 v8, s[44:47], s10 offen offset:0 lds
  buffer_store_dword v205, v87, s[12:15], s18 offen sc1
  s_add_u32 s18, s18, 16384
  buffer_load_dwordx4 v9, s[44:47], s10 offen offset:1024 lds
  buffer_store_dword v206, v87, s[12:15], s18 offen sc1
  s_add_u32 s18, s18, 16384
  buffer_load_dwordx4 v10, s[44:47], s10 offen offset:2048 lds
  buffer_store_dword v207, v87, s[12:15], s18 offen sc1
  s_sub_u32 s19, 15, s38
  buffer_load_dwordx4 v11, s[44:47], s10 offen offset:3072 lds
  s_add_u32 s10, s10, 128
  s_and_b32 s10, s10, 0x7ff
  s_waitcnt vmcnt(51)
  s_barrier
  ds_read_b128 v[136:139], v16 offset:0
  ds_read_b128 v[144:147], v20 offset:0
  ds_read_b128 v[140:143], v16 offset:4096
  ds_read_b128 v[148:151], v20 offset:4096
  s_waitcnt lgkmcnt(2)
  v_mfma_f32_32x32x16_bf16 v[44:59], v[136:139], v[144:147], 0
  ds_read_b128 v[152:155], v17 offset:0
  ds_read_b128 v[160:163], v21 offset:0
  s_lshl_b32 s19, s19, 9
  v_lshl_add_u32 v168, v0, 2, s19
  v_mov_b32 v169, -1
  s_waitcnt lgkmcnt(2)
  v_mfma_f32_32x32x16_bf16 v[88:103], v[136:139], v[148:151], 0
  ds_read_b128 v[156:159], v17 offset:4096
  ds_read_b128 v[164:167], v21 offset:4096
  s_cmp_ge_u32 s3, 2
  s_cbranch_scc1 gated_mix__spectral_gfnet__ssm_conv_s5__prompt_kernel_skip5
  buffer_store_dword v169, v168, s[60:63], 0 offen sc1
gated_mix__spectral_gfnet__ssm_conv_s5__prompt_kernel_skip5:
  v_mfma_f32_32x32x16_bf16 v[120:135], v[140:143], v[148:151], 0
  s_cmp_lg_u32 s3, 0
  s_cbranch_scc1 gated_mix__spectral_gfnet__ssm_conv_s5__prompt_kernel_skip6
  s_mov_b64 exec, 1
  buffer_store_dword v2, v25, s[48:51], s5 offen sc1
  buffer_store_dword v2, v24, s[48:51], s4 offen sc1
  s_mov_b64 exec, -1
gated_mix__spectral_gfnet__ssm_conv_s5__prompt_kernel_skip6:
  v_mfma_f32_32x32x16_bf16 v[104:119], v[140:143], v[144:147], 0
  v_mov_b32 v168, 0
  v_mov_b32 v169, 0
  s_waitcnt vmcnt(46)
  v_dot2c_f32_bf16 v168, v60, v76
  s_waitcnt lgkmcnt(2)
  v_mfma_f32_32x32x16_bf16 v[44:59], v[152:155], v[160:163], v[44:59]
  ds_read_b128 v[136:139], v18 offset:0
  ds_read_b128 v[144:147], v22 offset:0
  v_dot2c_f32_bf16 v169, v68, v76
  v_dot2c_f32_bf16 v168, v61, v77
  v_dot2c_f32_bf16 v169, v69, v77
  s_waitcnt lgkmcnt(2)
  v_mfma_f32_32x32x16_bf16 v[88:103], v[152:155], v[164:167], v[88:103]
  ds_read_b128 v[140:143], v18 offset:4096
  ds_read_b128 v[148:151], v22 offset:4096
  v_dot2c_f32_bf16 v168, v62, v78
  v_dot2c_f32_bf16 v169, v70, v78
  v_dot2c_f32_bf16 v168, v63, v79
  v_mfma_f32_32x32x16_bf16 v[120:135], v[156:159], v[164:167], v[120:135]
  v_dot2c_f32_bf16 v169, v71, v79
  s_waitcnt vmcnt(45)
  v_dot2c_f32_bf16 v168, v64, v80
  v_dot2c_f32_bf16 v169, v72, v80
  v_mfma_f32_32x32x16_bf16 v[104:119], v[156:159], v[160:163], v[104:119]
  v_dot2c_f32_bf16 v168, v65, v81
  v_dot2c_f32_bf16 v169, v73, v81
  v_dot2c_f32_bf16 v168, v66, v82
  s_waitcnt lgkmcnt(2)
  v_mfma_f32_32x32x16_bf16 v[44:59], v[136:139], v[144:147], v[44:59]
  ds_read_b128 v[152:155], v19 offset:0
  ds_read_b128 v[160:163], v23 offset:0
  v_dot2c_f32_bf16 v169, v74, v82
  v_dot2c_f32_bf16 v168, v67, v83
  v_dot2c_f32_bf16 v169, v75, v83
  s_waitcnt lgkmcnt(2)
  v_mfma_f32_32x32x16_bf16 v[88:103], v[136:139], v[148:151], v[88:103]
  ds_read_b128 v[156:159], v19 offset:4096
  ds_read_b128 v[164:167], v23 offset:4096
  v_permlane32_swap_b32 v168, v169
  v_add_f32 v168, v168, v169
  v_mov_b32 v169, v168
  v_mfma_f32_32x32x16_bf16 v[120:135], v[140:143], v[148:151], v[120:135]
  s_nop 0
  v_permlane16_swap_b32 v168, v169
  v_add_f32 v168, v168, v169
  s_nop 1
  v_add_f32 v168, v168, v168 row_ror:8 row_mask:0xf bank_mask:0xf
  v_mfma_f32_32x32x16_bf16 v[104:119], v[140:143], v[144:147], v[104:119]
  s_nop 0
  v_add_f32 v168, v168, v168 row_ror:4 row_mask:0xf bank_mask:0xf
  s_nop 1
  v_add_f32 v168, v168, v168 row_ror:2 row_mask:0xf bank_mask:0xf
  s_nop 1
  v_add_f32 v168, v168, v168 row_ror:1 row_mask:0xf bank_mask:0xf
  s_waitcnt vmcnt(32) lgkmcnt(0)
  s_barrier
  v_mfma_f32_32x32x16_bf16 v[44:59], v[152:155], v[160:163], v[44:59]
  ds_read_b128 v[136:139], v16 offset:16384
  ds_read_b128 v[144:147], v20 offset:16384
  v_cvt_pk_bf16_f32 v168, v168, v168
  v_and_b32 v168, 0xffff0000, v168
  v_mul_f32 v168, 0xbfb8aa3b, v168
  v_mfma_f32_32x32x16_bf16 v[88:103], v[152:155], v[164:167], v[88:103]
  ds_read_b128 v[140:143], v16 offset:20480
  ds_read_b128 v[148:151], v20 offset:20480
  v_exp_f32 v168, v168
  s_nop 0
  v_add_f32 v168, 1.0, v168
  v_rcp_f32 v168, v168
  v_mfma_f32_32x32x16_bf16 v[120:135], v[156:159], v[164:167], v[120:135]
  s_add_u32 m0, s17, 0
  s_nop 0
  buffer_load_dwordx4 v12, s[56:59], s10 offen offset:0 lds
  v_cvt_pk_bf16_f32 v168, v168, v168
  v_and_b32 v168, 0xffff0000, v168
  s_and_b32 s6, s2, 1
  v_mfma_f32_32x32x16_bf16 v[104:119], v[156:159], v[160:163], v[104:119]
  buffer_load_dwordx4 v13, s[56:59], s10 offen offset:1024 lds
  s_lshl_b32 s6, s6, 2
  s_add_u32 s6, s6, s3
  s_lshl_b32 s6, s6, 10
  s_waitcnt lgkmcnt(2)
  v_mfma_f32_32x32x16_bf16 v[44:59], v[136:139], v[144:147], v[44:59]
  ds_read_b128 v[152:155], v17 offset:16384
  ds_read_b128 v[160:163], v21 offset:16384
  s_lshr_b32 s7, s2, 1
  s_lshl_b32 s7, s7, 2
  s_add_u32 s6, s6, s7
  s_waitcnt lgkmcnt(2)
  v_mfma_f32_32x32x16_bf16 v[88:103], v[136:139], v[148:151], v[88:103]
  ds_read_b128 v[156:159], v17 offset:20480
  ds_read_b128 v[164:167], v21 offset:20480
  v_lshrrev_b32 v170, 5, v4
  v_lshlrev_b32 v170, 9, v170
  s_mov_b32 exec_lo, 1
  s_mov_b32 exec_hi, 1
  buffer_store_dword v168, v170, s[24:27], s6 offen sc1
  s_mov_b64 exec, -1
  v_mfma_f32_32x32x16_bf16 v[120:135], v[140:143], v[148:151], v[120:135]
  buffer_load_dwordx4 v14, s[56:59], s10 offen offset:2048 lds
  v_lshlrev_b32 v84, 16, v84
  v_lshlrev_b32 v85, 16, v85
  v_lshlrev_b32 v86, 16, v86
  v_mfma_f32_32x32x16_bf16 v[104:119], v[140:143], v[144:147], v[104:119]
  buffer_load_dwordx4 v15, s[56:59], s10 offen offset:3072 lds
  v_mul_f32 v86, 0x3fb8aa3b, v86
  v_exp_f32 v86, v86
  s_nop 0
  v_cvt_pk_bf16_f32 v86, v86, v86
  s_waitcnt lgkmcnt(2)
  v_mfma_f32_32x32x16_bf16 v[44:59], v[152:155], v[160:163], v[44:59]
  ds_read_b128 v[136:139], v18 offset:16384
  ds_read_b128 v[144:147], v22 offset:16384
  v_and_b32 v86, 0xffff0000, v86
  v_mul_f32 v72, v86, v84
  v_mul_f32 v73, v86, v85
  s_waitcnt lgkmcnt(2)
  v_mfma_f32_32x32x16_bf16 v[88:103], v[152:155], v[164:167], v[88:103]
  ds_read_b128 v[140:143], v18 offset:20480
  ds_read_b128 v[148:151], v22 offset:20480
  v_mul_f32 v72, 0x3fb8aa3b, v72
  v_mul_f32 v73, 0.15915494, v73
  v_exp_f32 v72, v72
  v_mfma_f32_32x32x16_bf16 v[120:135], v[156:159], v[164:167], v[120:135]
  s_add_u32 m0, s16, 0
  s_nop 0
  buffer_load_dwordx4 v8, s[44:47], s10 offen offset:0 lds
  v_rndne_f32 v74, v73
  v_sub_f32 v73, v73, v74
  v_cos_f32 v74, v73
  v_mfma_f32_32x32x16_bf16 v[104:119], v[156:159], v[160:163], v[104:119]
  buffer_load_dwordx4 v9, s[44:47], s10 offen offset:1024 lds
  v_sin_f32 v75, v73
  v_mul_f32 v60, v72, v74
  v_mul_f32 v61, v72, v75
  s_waitcnt lgkmcnt(2)
  v_mfma_f32_32x32x16_bf16 v[44:59], v[136:139], v[144:147], v[44:59]
  ds_read_b128 v[152:155], v19 offset:16384
  ds_read_b128 v[160:163], v23 offset:16384
  v_mul_f32 v72, v84, v84
  v_fma_f32 v72, v85, v85, v72
  v_rcp_f32 v72, v72
  s_waitcnt lgkmcnt(2)
  v_mfma_f32_32x32x16_bf16 v[88:103], v[136:139], v[148:151], v[88:103]
  ds_read_b128 v[156:159], v19 offset:20480
  ds_read_b128 v[164:167], v23 offset:20480
  v_add_f32 v73, -1.0, v60
  v_add_f32 v72, v72, v72
  v_mul_f32 v74, v73, v84
  v_mfma_f32_32x32x16_bf16 v[120:135], v[140:143], v[148:151], v[120:135]
  buffer_load_dwordx4 v10, s[44:47], s10 offen offset:2048 lds
  v_fma_f32 v74, v61, v85, v74
  v_mul_f32 v75, v61, v84
  v_fma_f32 v75, -v73, v85, v75
  v_mfma_f32_32x32x16_bf16 v[104:119], v[140:143], v[144:147], v[104:119]
  buffer_load_dwordx4 v11, s[44:47], s10 offen offset:3072 lds
  s_add_u32 s10, s10, 128
  s_and_b32 s10, s10, 0x7ff
  v_mul_f32 v70, v74, v72
  v_mul_f32 v71, v75, v72
  v_mul_f32 v72, v61, v61
  s_waitcnt vmcnt(25) lgkmcnt(0)
  s_barrier
  v_mfma_f32_32x32x16_bf16 v[44:59], v[152:155], v[160:163], v[44:59]
  ds_read_b128 v[136:139], v16 offset:32768
  ds_read_b128 v[144:147], v20 offset:32768
  v_mul_f32 v63, v60, v61
  v_fma_f32 v62, v60, v60, -v72
  v_add_f32 v63, v63, v63
  v_mfma_f32_32x32x16_bf16 v[88:103], v[152:155], v[164:167], v[88:103]
  ds_read_b128 v[140:143], v16 offset:36864
  ds_read_b128 v[148:151], v20 offset:36864
  v_mul_f32 v72, v63, v63
  v_mul_f32 v63, v62, v63
  v_fma_f32 v62, v62, v62, -v72
  v_mfma_f32_32x32x16_bf16 v[120:135], v[156:159], v[164:167], v[120:135]
  s_add_u32 m0, s17, 16384
  s_nop 0
  buffer_load_dwordx4 v12, s[56:59], s10 offen offset:0 lds
  v_add_f32 v63, v63, v63
  v_mul_f32 v72, v63, v63
  v_mul_f32 v63, v62, v63
  v_mfma_f32_32x32x16_bf16 v[104:119], v[156:159], v[160:163], v[104:119]
  buffer_load_dwordx4 v13, s[56:59], s10 offen offset:1024 lds
  v_fma_f32 v62, v62, v62, -v72
  v_add_f32 v63, v63, v63
  v_mul_f32 v72, v63, v63
  s_waitcnt lgkmcnt(2)
  v_mfma_f32_32x32x16_bf16 v[44:59], v[136:139], v[144:147], v[44:59]
  ds_read_b128 v[152:155], v17 offset:32768
  ds_read_b128 v[160:163], v21 offset:32768
  v_mul_f32 v63, v62, v63
  v_fma_f32 v62, v62, v62, -v72
  v_add_f32 v63, v63, v63
  s_waitcnt lgkmcnt(2)
  v_mfma_f32_32x32x16_bf16 v[88:103], v[136:139], v[148:151], v[88:103]
  ds_read_b128 v[156:159], v17 offset:36864
  ds_read_b128 v[164:167], v21 offset:36864
  v_mul_f32 v72, v63, v63
  v_mul_f32 v65, v62, v63
  v_fma_f32 v64, v62, v62, -v72
  v_mfma_f32_32x32x16_bf16 v[120:135], v[140:143], v[148:151], v[120:135]
  buffer_load_dwordx4 v14, s[56:59], s10 offen offset:2048 lds
  v_add_f32 v65, v65, v65
  v_mul_f32 v72, v65, v65
  v_mul_f32 v67, v64, v65
  v_mfma_f32_32x32x16_bf16 v[104:119], v[140:143], v[144:147], v[104:119]
  buffer_load_dwordx4 v15, s[56:59], s10 offen offset:3072 lds
  v_fma_f32 v66, v64, v64, -v72
  v_add_f32 v67, v67, v67
  v_mul_f32 v72, v67, v67
  s_waitcnt lgkmcnt(2)
  v_mfma_f32_32x32x16_bf16 v[44:59], v[152:155], v[160:163], v[44:59]
  ds_read_b128 v[136:139], v18 offset:32768
  ds_read_b128 v[144:147], v22 offset:32768
  v_mul_f32 v77, v66, v67
  v_fma_f32 v76, v66, v66, -v72
  v_add_f32 v77, v77, v77
  s_waitcnt lgkmcnt(2)
  v_mfma_f32_32x32x16_bf16 v[88:103], v[152:155], v[164:167], v[88:103]
  ds_read_b128 v[140:143], v18 offset:36864
  ds_read_b128 v[148:151], v22 offset:36864
  v_mul_f32 v72, v77, v77
  v_mul_f32 v69, v76, v77
  v_fma_f32 v68, v76, v76, -v72
  v_mfma_f32_32x32x16_bf16 v[120:135], v[156:159], v[164:167], v[120:135]
  s_add_u32 m0, s16, 16384
  s_nop 0
  buffer_load_dwordx4 v8, s[44:47], s10 offen offset:0 lds
  v_add_f32 v69, v69, v69
  v_mul_f32 v72, v69, v69
  v_mul_f32 v69, v68, v69
  v_mfma_f32_32x32x16_bf16 v[104:119], v[156:159], v[160:163], v[104:119]
  buffer_load_dwordx4 v9, s[44:47], s10 offen offset:1024 lds
  v_fma_f32 v68, v68, v68, -v72
  v_add_f32 v69, v69, v69
  v_mul_f32 v72, v69, v69
  s_waitcnt lgkmcnt(2)
  v_mfma_f32_32x32x16_bf16 v[44:59], v[136:139], v[144:147], v[44:59]
  ds_read_b128 v[152:155], v19 offset:32768
  ds_read_b128 v[160:163], v23 offset:32768
  v_mul_f32 v69, v68, v69
  v_fma_f32 v68, v68, v68, -v72
  v_add_f32 v69, v69, v69
  s_waitcnt lgkmcnt(2)
  v_mfma_f32_32x32x16_bf16 v[88:103], v[136:139], v[148:151], v[88:103]
  ds_read_b128 v[156:159], v19 offset:36864
  ds_read_b128 v[164:167], v23 offset:36864
  s_lshl_b32 s6, s3, 8
  s_add_u32 s6, s6, 147584
  v_lshl_add_u32 v72, v5, 3, s6
  v_mfma_f32_32x32x16_bf16 v[120:135], v[140:143], v[148:151], v[120:135]
  buffer_load_dwordx4 v10, s[44:47], s10 offen offset:2048 lds
  v_lshl_add_u32 v72, v6, 10, v72
  s_sub_u32 s6, 15, s38
  s_lshl_b32 s6, s6, 9
  v_mfma_f32_32x32x16_bf16 v[104:119], v[140:143], v[144:147], v[104:119]
  buffer_load_dwordx4 v11, s[44:47], s10 offen offset:3072 lds
  s_add_u32 s10, s10, 128
  s_and_b32 s10, s10, 0x7ff
  s_and_b32 s7, s3, 1
  s_lshl_b32 s7, s7, 8
  s_add_u32 s6, s6, s7
  s_waitcnt vmcnt(17) lgkmcnt(0)
  s_barrier
  v_mfma_f32_32x32x16_bf16 v[44:59], v[152:155], v[160:163], v[44:59]
  ds_read_b128 v[136:139], v16 offset:49152
  ds_read_b128 v[144:147], v20 offset:49152
  v_and_b32 v73, 31, v4
  v_lshl_add_u32 v73, v73, 3, s6
  s_lshl_b32 s7, s38, 1
  v_mfma_f32_32x32x16_bf16 v[88:103], v[152:155], v[164:167], v[88:103]
  ds_read_b128 v[140:143], v16 offset:53248
  ds_read_b128 v[148:151], v20 offset:53248
  s_lshr_b32 s8, s3, 1
  s_add_u32 s7, s7, s8
  s_lshl_b32 s6, s7, 9
  v_mfma_f32_32x32x16_bf16 v[120:135], v[156:159], v[164:167], v[120:135]
  s_add_u32 m0, s17, 32768
  s_nop 0
  buffer_load_dwordx4 v12, s[56:59], s10 offen offset:0 lds
  s_and_b32 s7, s7, 3
  s_lshl_b32 s7, s7, 2
  v_xor_b32 v74, s7, v5
  v_mfma_f32_32x32x16_bf16 v[104:119], v[156:159], v[160:163], v[104:119]
  buffer_load_dwordx4 v13, s[56:59], s10 offen offset:1024 lds
  v_lshlrev_b32 v74, 4, v74
  v_lshrrev_b32 v75, 1, v6
  v_lshl_or_b32 v74, v75, 14, v74
  s_waitcnt lgkmcnt(2)
  v_mfma_f32_32x32x16_bf16 v[44:59], v[136:139], v[144:147], v[44:59]
  ds_read_b128 v[152:155], v17 offset:49152
  ds_read_b128 v[160:163], v21 offset:49152
  v_and_b32 v75, 1, v6
  v_lshl_or_b32 v74, v75, 19, v74
  s_and_b32 s8, s3, 1
  s_waitcnt lgkmcnt(2)
  v_mfma_f32_32x32x16_bf16 v[88:103], v[136:139], v[148:151], v[88:103]
  ds_read_b128 v[156:159], v17 offset:53248
  ds_read_b128 v[164:167], v21 offset:53248
  s_lshl_b32 s8, s8, 8
  s_add_u32 s6, s6, s8
  s_lshl_b32 s8, s39, 15
  v_mfma_f32_32x32x16_bf16 v[120:135], v[140:143], v[148:151], v[120:135]
  buffer_load_dwordx4 v14, s[56:59], s10 offen offset:2048 lds
  s_add_u32 s6, s6, s8
  v_and_b32 v78, 7, v4
  v_xor_b32 v78, v78, v6
  v_mfma_f32_32x32x16_bf16 v[104:119], v[140:143], v[144:147], v[104:119]
  buffer_load_dwordx4 v15, s[56:59], s10 offen offset:3072 lds
  v_and_b32 v79, 4, v78
  v_lshlrev_b32 v80, 4, v79
  v_and_b32 v79, 1, v78
  s_waitcnt lgkmcnt(2)
  v_mfma_f32_32x32x16_bf16 v[44:59], v[152:155], v[160:163], v[44:59]
  ds_read_b128 v[136:139], v18 offset:49152
  ds_read_b128 v[144:147], v22 offset:49152
  v_lshl_or_b32 v80, v79, 5, v80
  v_bfe_u32 v79, v78, 1, 1
  v_lshl_or_b32 v80, v79, 4, v80
  s_waitcnt lgkmcnt(2)
  v_mfma_f32_32x32x16_bf16 v[88:103], v[152:155], v[164:167], v[88:103]
  ds_read_b128 v[140:143], v18 offset:53248
  ds_read_b128 v[148:151], v22 offset:53248
  v_lshrrev_b32 v79, 3, v4
  v_lshl_or_b32 v80, v79, 11, v80
  s_lshr_b32 s9, s3, 1
  v_mfma_f32_32x32x16_bf16 v[120:135], v[156:159], v[164:167], v[120:135]
  s_add_u32 m0, s16, 32768
  s_nop 0
  buffer_load_dwordx4 v8, s[44:47], s10 offen offset:0 lds
  s_lshl_b32 s9, s9, 20
  s_lshl_b32 s7, s39, 15
  s_add_u32 s9, s9, s7
  v_mfma_f32_32x32x16_bf16 v[104:119], v[156:159], v[160:163], v[104:119]
  buffer_load_dwordx4 v9, s[44:47], s10 offen offset:1024 lds
  v_add_u32 v80, s9, v80
  v_xor_b32 v81, 64, v80
  v_add_u32 v81, 15360, v81
  s_waitcnt lgkmcnt(2)
  v_mfma_f32_32x32x16_bf16 v[44:59], v[136:139], v[144:147], v[44:59]
  ds_read_b128 v[152:155], v19 offset:49152
  ds_read_b128 v[160:163], v23 offset:49152
  v_add_u32 v82, 522240, v80
  v_add_u32 v83, 522240, v81
  s_lshl_b32 s7, s38, 7
  s_waitcnt lgkmcnt(2)
  v_mfma_f32_32x32x16_bf16 v[88:103], v[136:139], v[148:151], v[88:103]
  ds_read_b128 v[156:159], v19 offset:53248
  ds_read_b128 v[164:167], v23 offset:53248
  s_lshl_b32 s8, s3, 12
  v_lshrrev_b32 v78, 1, v5
  v_xor_b32 v78, v78, v6
  v_mfma_f32_32x32x16_bf16 v[120:135], v[140:143], v[148:151], v[120:135]
  buffer_load_dwordx4 v10, s[44:47], s10 offen offset:2048 lds
  v_lshlrev_b32 v78, 4, v78
  v_lshl_or_b32 v78, v5, 7, v78
  v_add_u32 v84, s8, v78
  v_mfma_f32_32x32x16_bf16 v[104:119], v[140:143], v[144:147], v[104:119]
  buffer_load_dwordx4 v11, s[44:47], s10 offen offset:3072 lds
  s_add_u32 s10, s10, 128
  s_and_b32 s10, s10, 0x7ff
  v_xor_b32 v85, 64, v84
  v_add_u32 v86, 0x10000, v84
  v_add_u32 v87, 0x10000, v85
  s_waitcnt vmcnt(16) lgkmcnt(0)
  s_barrier
  v_mfma_f32_32x32x16_bf16 v[44:59], v[152:155], v[160:163], v[44:59]
  ds_read_b128 v[136:139], v16 offset:0
  ds_read_b128 v[144:147], v20 offset:0
  s_lshl_b32 s28, s40, 2
  s_add_u32 s28, s28, s41
  s_cmp_eq_u32 s28, 3
  s_cselect_b32 s9, 1, s41
  s_cselect_b32 s18, 64, s40
  v_mfma_f32_32x32x16_bf16 v[88:103], v[152:155], v[164:167], v[88:103]
  ds_read_b128 v[140:143], v16 offset:4096
  ds_read_b128 v[148:151], v20 offset:4096
  buffer_load_dword v240, v2, s[52:55], 0 offen sc1
  s_and_b32 s19, s28, 0xfd
  s_cmp_eq_u32 s19, 0
  s_cselect_b32 s19, 1, 0
  v_mfma_f32_32x32x16_bf16 v[120:135], v[156:159], v[164:167], v[120:135]
  s_add_u32 m0, s17, 49152
  s_nop 0
  buffer_load_dwordx4 v12, s[56:59], s10 offen offset:0 lds
  s_lshl_b32 s72, s3, 9
  s_add_u32 s72, s72, s18
  s_lshr_b32 s33, s3, 1
  v_mfma_f32_32x32x16_bf16 v[104:119], v[156:159], v[160:163], v[104:119]
  buffer_load_dwordx4 v13, s[56:59], s10 offen offset:1024 lds
  s_and_b32 s33, s33, s19
  s_mul_i32 s33, s33, 960
  s_sub_u32 s72, s72, s33
  s_waitcnt lgkmcnt(2)
  v_mfma_f32_32x32x16_bf16 v[44:59], v[136:139], v[144:147], v[44:59]
  ds_read_b128 v[152:155], v17 offset:0
  ds_read_b128 v[160:163], v21 offset:0
  s_add_u32 s74, s72, 128
  s_add_u32 s76, s72, 256
  s_add_u32 s78, s72, 384
  s_waitcnt lgkmcnt(2)
  v_mfma_f32_32x32x16_bf16 v[88:103], v[136:139], v[148:151], v[88:103]
  ds_read_b128 v[156:159], v17 offset:4096
  ds_read_b128 v[164:167], v21 offset:4096
  s_sub_u32 s73, 2048, s72
  s_and_b32 s73, s73, 2047
  s_sub_u32 s75, 2048, s74
  v_mfma_f32_32x32x16_bf16 v[120:135], v[140:143], v[148:151], v[120:135]
  buffer_load_dwordx4 v14, s[56:59], s10 offen offset:2048 lds
  s_and_b32 s75, s75, 2047
  s_sub_u32 s77, 2048, s76
  s_and_b32 s77, s77, 2047
  v_mfma_f32_32x32x16_bf16 v[104:119], v[140:143], v[144:147], v[104:119]
  buffer_load_dwordx4 v15, s[56:59], s10 offen offset:3072 lds
  s_sub_u32 s79, 2048, s78
  s_and_b32 s79, s79, 2047
  s_cmp_eq_u32 s3, 0
  s_cselect_b32 s36, s19, 0
  s_waitcnt lgkmcnt(2)
  v_mfma_f32_32x32x16_bf16 v[44:59], v[152:155], v[160:163], v[44:59]
  ds_read_b128 v[136:139], v18 offset:0
  ds_read_b128 v[144:147], v22 offset:0
  s_cmp_eq_u32 s36, 1
  s_cselect_b32 s73, 1024, s73
  s_mul_i32 s72, s72, 1026
  s_waitcnt lgkmcnt(2)
  v_mfma_f32_32x32x16_bf16 v[88:103], v[152:155], v[164:167], v[88:103]
  ds_read_b128 v[140:143], v18 offset:4096
  ds_read_b128 v[148:151], v22 offset:4096
  s_mul_i32 s73, s73, 1026
  s_mul_i32 s74, s74, 1026
  s_mul_i32 s75, s75, 1026
  v_mfma_f32_32x32x16_bf16 v[120:135], v[156:159], v[164:167], v[120:135]
  s_add_u32 m0, s16, 49152
  s_nop 0
  buffer_load_dwordx4 v8, s[44:47], s10 offen offset:0 lds
  s_mul_i32 s76, s76, 1026
  s_mul_i32 s77, s77, 1026
  s_mul_i32 s78, s78, 1026
  v_mfma_f32_32x32x16_bf16 v[104:119], v[156:159], v[160:163], v[104:119]
  buffer_load_dwordx4 v9, s[44:47], s10 offen offset:1024 lds
  s_mul_i32 s79, s79, 1026
  v_lshlrev_b32 v75, 4, v4
  s_lshl_b32 s29, s3, 12
  s_waitcnt lgkmcnt(2)
  v_mfma_f32_32x32x16_bf16 v[44:59], v[136:139], v[144:147], v[44:59]
  ds_read_b128 v[152:155], v19 offset:0
  ds_read_b128 v[160:163], v23 offset:0
  v_cvt_f32_u32 v169, v5
  v_cvt_f32_u32 v170, v6
  v_mul_f32 v170, 4.0, v170
  s_waitcnt lgkmcnt(2)
  v_mfma_f32_32x32x16_bf16 v[88:103], v[136:139], v[148:151], v[88:103]
  ds_read_b128 v[156:159], v19 offset:4096
  ds_read_b128 v[164:167], v23 offset:4096
  v_cvt_f32_u32 v174, s9
  v_cvt_f32_u32 v175, s18
  v_cvt_f32_u32 v176, s19
  v_mfma_f32_32x32x16_bf16 v[120:135], v[140:143], v[148:151], v[120:135]
  buffer_load_dwordx4 v10, s[44:47], s10 offen offset:2048 lds
  v_mul_f32 v176, 0xc4700000, v176
  v_cmp_lt_u32 vcc, 7, v5
  s_nop 1
  v_cndmask_b32 v173, 0, v176, vcc
  v_mfma_f32_32x32x16_bf16 v[104:119], v[140:143], v[144:147], v[104:119]
  buffer_load_dwordx4 v11, s[44:47], s10 offen offset:3072 lds
  s_add_u32 s10, s10, 128
  s_and_b32 s10, s10, 0x7ff
  v_add_f32 v173, v173, v175
  v_fmamk_f32 v171, v169, 0x43000000, v173
  v_mul_f32 v171, 0x3a000000, v171
  s_waitcnt vmcnt(17) lgkmcnt(0)
  s_barrier
  v_mfma_f32_32x32x16_bf16 v[44:59], v[152:155], v[160:163], v[44:59]
  ds_read_b128 v[136:139], v16 offset:16384
  ds_read_b128 v[144:147], v20 offset:16384
  v_mul_f32 v172, v171, v170
  v_fmamk_f32 v78, v171, 0x0, v172
  v_cos_f32 v79, v78
  v_mfma_f32_32x32x16_bf16 v[88:103], v[152:155], v[164:167], v[88:103]
  ds_read_b128 v[140:143], v16 offset:20480
  ds_read_b128 v[148:151], v20 offset:20480
  v_sin_f32 v168, v78
  s_nop 0
  v_cvt_pk_bf16_f32 v180, v79, v168
  v_cvt_pk_bf16_f32 v184, -v168, v79
  v_mfma_f32_32x32x16_bf16 v[120:135], v[156:159], v[164:167], v[120:135]
  s_add_u32 m0, s17, 0
  s_nop 0
  buffer_load_dwordx4 v12, s[56:59], s10 offen offset:0 lds
  v_fmamk_f32 v78, v171, 0x3f800000, v172
  v_cos_f32 v79, v78
  v_sin_f32 v168, v78
  v_mfma_f32_32x32x16_bf16 v[104:119], v[156:159], v[160:163], v[104:119]
  buffer_load_dwordx4 v13, s[56:59], s10 offen offset:1024 lds
  v_cvt_pk_bf16_f32 v181, v79, v168
  v_cvt_pk_bf16_f32 v185, -v168, v79
  v_fmamk_f32 v78, v171, 0x40000000, v172
  s_waitcnt lgkmcnt(2)
  v_mfma_f32_32x32x16_bf16 v[44:59], v[136:139], v[144:147], v[44:59]
  ds_read_b128 v[152:155], v17 offset:16384
  ds_read_b128 v[160:163], v21 offset:16384
  v_cos_f32 v79, v78
  v_sin_f32 v168, v78
  s_nop 0
  v_cvt_pk_bf16_f32 v182, v79, v168
  s_waitcnt lgkmcnt(2)
  v_mfma_f32_32x32x16_bf16 v[88:103], v[136:139], v[148:151], v[88:103]
  ds_read_b128 v[156:159], v17 offset:20480
  ds_read_b128 v[164:167], v21 offset:20480
  v_cvt_pk_bf16_f32 v186, -v168, v79
  v_fmamk_f32 v78, v171, 0x40400000, v172
  v_cos_f32 v79, v78
  v_mfma_f32_32x32x16_bf16 v[120:135], v[140:143], v[148:151], v[120:135]
  buffer_load_dwordx4 v14, s[56:59], s10 offen offset:2048 lds
  v_sin_f32 v168, v78
  s_nop 0
  v_cvt_pk_bf16_f32 v183, v79, v168
  v_cvt_pk_bf16_f32 v187, -v168, v79
  v_mfma_f32_32x32x16_bf16 v[104:119], v[140:143], v[144:147], v[104:119]
  buffer_load_dwordx4 v15, s[56:59], s10 offen offset:3072 lds
  v_cmp_lt_u32 vcc, 1, v6
  s_nop 1
  v_cndmask_b32 v173, 0, v176, vcc
  v_add_f32 v173, v173, v175
  s_waitcnt lgkmcnt(2)
  v_mfma_f32_32x32x16_bf16 v[44:59], v[152:155], v[160:163], v[44:59]
  ds_read_b128 v[136:139], v18 offset:16384
  ds_read_b128 v[144:147], v22 offset:16384
  v_fmamk_f32 v173, v170, 0x43000000, v173
  v_mul_f32 v172, v173, v169
  v_mul_f32 v172, 0x3a000000, v172
  s_waitcnt lgkmcnt(2)
  v_mfma_f32_32x32x16_bf16 v[88:103], v[152:155], v[164:167], v[88:103]
  ds_read_b128 v[140:143], v18 offset:20480
  ds_read_b128 v[148:151], v22 offset:20480
  v_mul_f32 v171, 0x3d800000, v169
  v_fmamk_f32 v78, v171, 0x0, v172
  v_cos_f32 v79, v78
  v_mfma_f32_32x32x16_bf16 v[120:135], v[156:159], v[164:167], v[120:135]
  s_add_u32 m0, s16, 0
  s_nop 0
  buffer_load_dwordx4 v8, s[44:47], s10 offen offset:0 lds
  v_sin_f32 v168, v78
  s_nop 0
  v_cvt_pk_bf16_f32 v188, v79, -v168
  v_cvt_pk_bf16_f32 v192, v168, v79
  v_mfma_f32_32x32x16_bf16 v[104:119], v[156:159], v[160:163], v[104:119]
  buffer_load_dwordx4 v9, s[44:47], s10 offen offset:1024 lds
  v_fmamk_f32 v78, v171, 0x3f800000, v172
  v_cos_f32 v79, v78
  v_sin_f32 v168, v78
  s_waitcnt lgkmcnt(2)
  v_mfma_f32_32x32x16_bf16 v[44:59], v[136:139], v[144:147], v[44:59]
  ds_read_b128 v[152:155], v19 offset:16384
  ds_read_b128 v[160:163], v23 offset:16384
  v_cvt_pk_bf16_f32 v189, v79, -v168
  v_cvt_pk_bf16_f32 v193, v168, v79
  v_fmamk_f32 v78, v171, 0x40000000, v172
  s_waitcnt lgkmcnt(2)
  v_mfma_f32_32x32x16_bf16 v[88:103], v[136:139], v[148:151], v[88:103]
  ds_read_b128 v[156:159], v19 offset:20480
  ds_read_b128 v[164:167], v23 offset:20480
  v_cos_f32 v79, v78
  v_sin_f32 v168, v78
  s_nop 0
  v_cvt_pk_bf16_f32 v190, v79, -v168
  v_mfma_f32_32x32x16_bf16 v[120:135], v[140:143], v[148:151], v[120:135]
  buffer_load_dwordx4 v10, s[44:47], s10 offen offset:2048 lds
  v_cvt_pk_bf16_f32 v194, v168, v79
  v_fmamk_f32 v78, v171, 0x40400000, v172
  v_cos_f32 v79, v78
  v_mfma_f32_32x32x16_bf16 v[104:119], v[140:143], v[144:147], v[104:119]
  buffer_load_dwordx4 v11, s[44:47], s10 offen offset:3072 lds
  s_add_u32 s10, s10, 128
  s_and_b32 s10, s10, 0x7ff
  v_sin_f32 v168, v78
  s_nop 0
  v_cvt_pk_bf16_f32 v191, v79, -v168
  v_cvt_pk_bf16_f32 v195, v168, v79
  s_waitcnt vmcnt(17) lgkmcnt(0)
  s_barrier
  v_mfma_f32_32x32x16_bf16 v[44:59], v[152:155], v[160:163], v[44:59]
  ds_read_b128 v[136:139], v16 offset:32768
  ds_read_b128 v[144:147], v20 offset:32768
  s_cmp_eq_u32 s19, 0
  s_cbranch_scc1 gated_mix__spectral_gfnet__ssm_conv_s5__prompt_kernel_skip7
  v_cmp_lt_u32 vcc, 7, v5
  s_nop 1
  v_cndmask_b32 v78, 0, 16, vcc
  v_and_b32 v180, 0xffff, v180
  v_lshlrev_b32 v180, v78, v180
  v_and_b32 v181, 0xffff, v181
  v_lshlrev_b32 v181, v78, v181
  v_and_b32 v182, 0xffff, v182
  v_lshlrev_b32 v182, v78, v182
  v_and_b32 v183, 0xffff, v183
  v_lshlrev_b32 v183, v78, v183
  v_and_b32 v184, 0xffff, v184
  v_lshlrev_b32 v184, v78, v184
  v_and_b32 v185, 0xffff, v185
  v_lshlrev_b32 v185, v78, v185
  v_and_b32 v186, 0xffff, v186
  v_lshlrev_b32 v186, v78, v186
  v_and_b32 v187, 0xffff, v187
  v_lshlrev_b32 v187, v78, v187
  v_cmp_eq_u32 vcc, 0, v5
  v_mov_b32 v79, 0x3f80
  s_nop 0
  v_cndmask_b32 v184, v184, v79, vcc
  v_mov_b32 v79, 0xbf80
  v_cndmask_b32 v185, v185, v79, vcc
  v_mov_b32 v79, 0x3f80
  v_cndmask_b32 v186, v186, v79, vcc
  v_mov_b32 v79, 0xbf80
  v_cndmask_b32 v187, v187, v79, vcc
  v_cmp_lt_u32 vcc, 1, v6
  v_lshlrev_b32 v79, 16, v188
  v_and_b32 v168, 0xffff0000, v188
  v_add_f32 v79, v79, v79
  v_add_f32 v168, v168, v168
  v_cvt_pk_bf16_f32 v79, v79, v168
  v_cndmask_b32 v188, v79, 0, vcc
  v_cndmask_b32 v192, 0, v79, vcc
  v_lshlrev_b32 v79, 16, v189
  v_and_b32 v168, 0xffff0000, v189
  v_add_f32 v79, v79, v79
  v_add_f32 v168, v168, v168
  v_cvt_pk_bf16_f32 v79, v79, v168
  v_cndmask_b32 v189, v79, 0, vcc
  v_cndmask_b32 v193, 0, v79, vcc
  v_lshlrev_b32 v79, 16, v190
  v_and_b32 v168, 0xffff0000, v190
  v_add_f32 v79, v79, v79
  v_add_f32 v168, v168, v168
  v_cvt_pk_bf16_f32 v79, v79, v168
  v_cndmask_b32 v190, v79, 0, vcc
  v_cndmask_b32 v194, 0, v79, vcc
  v_lshlrev_b32 v79, 16, v191
  v_and_b32 v168, 0xffff0000, v191
  v_add_f32 v79, v79, v79
  v_add_f32 v168, v168, v168
  v_cvt_pk_bf16_f32 v79, v79, v168
  v_cndmask_b32 v191, v79, 0, vcc
  v_cndmask_b32 v195, 0, v79, vcc
  v_lshlrev_b32 v79, 31, v5
  v_or_b32 v79, 0x3f803f80, v79
  v_cmp_eq_u32 vcc, 0, v6
  s_nop 1
  v_cndmask_b32 v188, v188, v79, vcc
gated_mix__spectral_gfnet__ssm_conv_s5__prompt_kernel_skip7:
  v_mfma_f32_32x32x16_bf16 v[88:103], v[152:155], v[164:167], v[88:103]
  ds_read_b128 v[140:143], v16 offset:36864
  ds_read_b128 v[148:151], v20 offset:36864
  v_fma_f32 v173, v169, 4.0, v174
  v_mul_f32 v171, 0x3c800000, v173
  v_mul_f32 v172, v171, v170
  v_mfma_f32_32x32x16_bf16 v[120:135], v[156:159], v[164:167], v[120:135]
  s_add_u32 m0, s17, 16384
  s_nop 0
  buffer_load_dwordx4 v12, s[56:59], s10 offen offset:0 lds
  v_fmamk_f32 v78, v171, 0x0, v172
  v_cos_f32 v79, v78
  v_sin_f32 v168, v78
  v_mfma_f32_32x32x16_bf16 v[104:119], v[156:159], v[160:163], v[104:119]
  buffer_load_dwordx4 v13, s[56:59], s10 offen offset:1024 lds
  v_cvt_pk_bf16_f32 v176, v79, v168
  v_cvt_pk_bf16_f32 v196, -v168, v79
  v_fmamk_f32 v78, v171, 0x3f800000, v172
  s_waitcnt lgkmcnt(2)
  v_mfma_f32_32x32x16_bf16 v[44:59], v[136:139], v[144:147], v[44:59]
  ds_read_b128 v[152:155], v17 offset:32768
  ds_read_b128 v[160:163], v21 offset:32768
  v_cos_f32 v79, v78
  v_sin_f32 v168, v78
  s_nop 0
  v_cvt_pk_bf16_f32 v177, v79, v168
  s_waitcnt lgkmcnt(2)
  v_mfma_f32_32x32x16_bf16 v[88:103], v[136:139], v[148:151], v[88:103]
  ds_read_b128 v[156:159], v17 offset:36864
  ds_read_b128 v[164:167], v21 offset:36864
  v_cvt_pk_bf16_f32 v197, -v168, v79
  v_fmamk_f32 v78, v171, 0x40000000, v172
  v_cos_f32 v79, v78
  v_mfma_f32_32x32x16_bf16 v[120:135], v[140:143], v[148:151], v[120:135]
  buffer_load_dwordx4 v14, s[56:59], s10 offen offset:2048 lds
  v_sin_f32 v168, v78
  s_nop 0
  v_cvt_pk_bf16_f32 v178, v79, v168
  v_cvt_pk_bf16_f32 v198, -v168, v79
  v_mfma_f32_32x32x16_bf16 v[104:119], v[140:143], v[144:147], v[104:119]
  buffer_load_dwordx4 v15, s[56:59], s10 offen offset:3072 lds
  v_fmamk_f32 v78, v171, 0x40400000, v172
  v_cos_f32 v79, v78
  v_sin_f32 v168, v78
  s_waitcnt lgkmcnt(2)
  v_mfma_f32_32x32x16_bf16 v[44:59], v[152:155], v[160:163], v[44:59]
  ds_read_b128 v[136:139], v18 offset:32768
  ds_read_b128 v[144:147], v22 offset:32768
  v_cvt_pk_bf16_f32 v179, v79, v168
  v_cvt_pk_bf16_f32 v199, -v168, v79
  v_mul_f32 v171, 0x3d800000, v171
  s_waitcnt lgkmcnt(2)
  v_mfma_f32_32x32x16_bf16 v[88:103], v[152:155], v[164:167], v[88:103]
  ds_read_b128 v[140:143], v18 offset:36864
  ds_read_b128 v[148:151], v22 offset:36864
  v_mul_f32 v172, 0x3d800000, v172
  v_fmamk_f32 v78, v171, 0x0, v172
  v_cos_f32 v200, v78
  v_mfma_f32_32x32x16_bf16 v[120:135], v[156:159], v[164:167], v[120:135]
  s_add_u32 m0, s16, 16384
  s_nop 0
  buffer_load_dwordx4 v8, s[44:47], s10 offen offset:0 lds
  v_sin_f32 v204, v78
  v_fmamk_f32 v78, v171, 0x3f800000, v172
  v_cos_f32 v201, v78
  v_mfma_f32_32x32x16_bf16 v[104:119], v[156:159], v[160:163], v[104:119]
  buffer_load_dwordx4 v9, s[44:47], s10 offen offset:1024 lds
  v_sin_f32 v205, v78
  v_fmamk_f32 v78, v171, 0x40000000, v172
  v_cos_f32 v202, v78
  s_waitcnt lgkmcnt(2)
  v_mfma_f32_32x32x16_bf16 v[44:59], v[136:139], v[144:147], v[44:59]
  ds_read_b128 v[152:155], v19 offset:32768
  ds_read_b128 v[160:163], v23 offset:32768
  v_sin_f32 v206, v78
  v_fmamk_f32 v78, v171, 0x40400000, v172
  v_cos_f32 v203, v78
  s_waitcnt lgkmcnt(2)
  v_mfma_f32_32x32x16_bf16 v[88:103], v[136:139], v[148:151], v[88:103]
  ds_read_b128 v[156:159], v19 offset:36864
  ds_read_b128 v[164:167], v23 offset:36864
  v_sin_f32 v207, v78
  v_fma_f32 v173, v170, 4.0, v174
  v_mul_f32 v172, v173, v169
  v_mfma_f32_32x32x16_bf16 v[120:135], v[140:143], v[148:151], v[120:135]
  buffer_load_dwordx4 v10, s[44:47], s10 offen offset:2048 lds
  v_mul_f32 v172, 0x3c800000, v172
  v_mul_f32 v171, 0x3d800000, v169
  v_fmamk_f32 v78, v171, 0x0, v172
  v_mfma_f32_32x32x16_bf16 v[104:119], v[140:143], v[144:147], v[104:119]
  buffer_load_dwordx4 v11, s[44:47], s10 offen offset:3072 lds
  s_add_u32 s10, s10, 128
  s_and_b32 s10, s10, 0x7ff
  v_cos_f32 v79, v78
  v_sin_f32 v168, v78
  s_nop 0
  v_cvt_pk_bf16_f32 v208, v79, -v168
  s_waitcnt vmcnt(16) lgkmcnt(0)
  s_barrier
  v_mfma_f32_32x32x16_bf16 v[44:59], v[152:155], v[160:163], v[44:59]
  ds_read_b128 v[136:139], v16 offset:49152
  ds_read_b128 v[144:147], v20 offset:49152
  v_cvt_pk_bf16_f32 v212, v168, v79
  v_fmamk_f32 v78, v171, 0x3f800000, v172
  v_cos_f32 v79, v78
  v_mfma_f32_32x32x16_bf16 v[88:103], v[152:155], v[164:167], v[88:103]
  ds_read_b128 v[140:143], v16 offset:53248
  ds_read_b128 v[148:151], v20 offset:53248
  v_cmp_ne_u32 vcc, 1, v240
  s_nop 0
  s_cbranch_vccz gated_mix__spectral_gfnet__ssm_conv_s5__prompt_kernel_skip8
  s_mov_b32 s37, 0
gated_mix__spectral_gfnet__ssm_conv_s5__prompt_kernel_poll9:
  s_sleep 2
  buffer_load_dword v240, v2, s[52:55], 0 offen sc1
  s_waitcnt vmcnt(0)
  v_cmp_ne_u32 vcc, 1, v240
  s_nop 0
  s_cbranch_vccz gated_mix__spectral_gfnet__ssm_conv_s5__prompt_kernel_pollout10
  s_add_u32 s37, s37, 1
  s_cmp_lt_u32 s37, 1048576
  s_cbranch_scc1 gated_mix__spectral_gfnet__ssm_conv_s5__prompt_kernel_poll9
gated_mix__spectral_gfnet__ssm_conv_s5__prompt_kernel_pollout10:
gated_mix__spectral_gfnet__ssm_conv_s5__prompt_kernel_skip8:
  s_cmp_lg_u32 s3, 0
  s_cbranch_scc1 gated_mix__spectral_gfnet__ssm_conv_s5__prompt_kernel_skip11
  s_mov_b64 exec, 1
  buffer_store_dword v7, v24, s[48:51], 0 offen sc1
  s_mov_b64 exec, -1
gated_mix__spectral_gfnet__ssm_conv_s5__prompt_kernel_skip11:
  v_sin_f32 v168, v78
  s_nop 0
  v_cvt_pk_bf16_f32 v209, v79, -v168
  v_cvt_pk_bf16_f32 v213, v168, v79
  v_mfma_f32_32x32x16_bf16 v[120:135], v[156:159], v[164:167], v[120:135]
  s_add_u32 m0, s17, 32768
  s_nop 0
  buffer_load_dwordx4 v12, s[56:59], s10 offen offset:0 lds
  v_fmamk_f32 v78, v171, 0x40000000, v172
  v_cos_f32 v79, v78
  v_sin_f32 v168, v78
  v_mfma_f32_32x32x16_bf16 v[104:119], v[156:159], v[160:163], v[104:119]
  buffer_load_dwordx4 v13, s[56:59], s10 offen offset:1024 lds
  v_cvt_pk_bf16_f32 v210, v79, -v168
  v_cvt_pk_bf16_f32 v214, v168, v79
  v_fmamk_f32 v78, v171, 0x40400000, v172
  s_waitcnt lgkmcnt(2)
  v_mfma_f32_32x32x16_bf16 v[44:59], v[136:139], v[144:147], v[44:59]
  ds_read_b128 v[152:155], v17 offset:49152
  ds_read_b128 v[160:163], v21 offset:49152
  v_cos_f32 v79, v78
  v_sin_f32 v168, v78
  s_nop 0
  v_cvt_pk_bf16_f32 v211, v79, -v168
  s_waitcnt lgkmcnt(2)
  v_mfma_f32_32x32x16_bf16 v[88:103], v[136:139], v[148:151], v[88:103]
  ds_read_b128 v[156:159], v17 offset:53248
  ds_read_b128 v[164:167], v21 offset:53248
  v_cvt_pk_bf16_f32 v215, v168, v79
  v_mul_f32 v171, 0x3d800000, v171
  v_mul_f32 v172, 0x3d800000, v172
  v_mfma_f32_32x32x16_bf16 v[120:135], v[140:143], v[148:151], v[120:135]
  buffer_load_dwordx4 v14, s[56:59], s10 offen offset:2048 lds
  v_fmamk_f32 v78, v171, 0x0, v172
  v_cos_f32 v216, v78
  v_sin_f32 v220, v78
  v_mfma_f32_32x32x16_bf16 v[104:119], v[140:143], v[144:147], v[104:119]
  buffer_load_dwordx4 v15, s[56:59], s10 offen offset:3072 lds
  v_fmamk_f32 v78, v171, 0x3f800000, v172
  v_cos_f32 v217, v78
  v_sin_f32 v221, v78
  s_waitcnt lgkmcnt(2)
  v_mfma_f32_32x32x16_bf16 v[44:59], v[152:155], v[160:163], v[44:59]
  ds_read_b128 v[136:139], v18 offset:49152
  ds_read_b128 v[144:147], v22 offset:49152
  v_fmamk_f32 v78, v171, 0x40000000, v172
  v_cos_f32 v218, v78
  v_sin_f32 v222, v78
  s_waitcnt lgkmcnt(2)
  v_mfma_f32_32x32x16_bf16 v[88:103], v[152:155], v[164:167], v[88:103]
  ds_read_b128 v[140:143], v18 offset:53248
  ds_read_b128 v[148:151], v22 offset:53248
  v_fmamk_f32 v78, v171, 0x40400000, v172
  v_cos_f32 v219, v78
  v_sin_f32 v223, v78
  v_mfma_f32_32x32x16_bf16 v[120:135], v[156:159], v[164:167], v[120:135]
  s_add_u32 m0, s16, 32768
  s_nop 0
  buffer_load_dwordx4 v8, s[44:47], s10 offen offset:0 lds
  v_mul_f32 v216, 0x35800000, v216
  v_mul_f32 v217, 0x35800000, v217
  v_mul_f32 v218, 0x35800000, v218
  v_mfma_f32_32x32x16_bf16 v[104:119], v[156:159], v[160:163], v[104:119]
  buffer_load_dwordx4 v9, s[44:47], s10 offen offset:1024 lds
  v_mul_f32 v219, 0x35800000, v219
  v_mul_f32 v220, 0x35800000, v220
  v_mul_f32 v221, 0x35800000, v221
  s_waitcnt lgkmcnt(2)
  v_mfma_f32_32x32x16_bf16 v[44:59], v[136:139], v[144:147], v[44:59]
  ds_read_b128 v[152:155], v19 offset:49152
  ds_read_b128 v[160:163], v23 offset:49152
  v_mul_f32 v222, 0x35800000, v222
  v_mul_f32 v223, 0x35800000, v223
  v_xor_b32 v173, 3, v5
  s_waitcnt lgkmcnt(2)
  v_mfma_f32_32x32x16_bf16 v[88:103], v[136:139], v[148:151], v[88:103]
  ds_read_b128 v[156:159], v19 offset:53248
  ds_read_b128 v[164:167], v23 offset:53248
  v_cmp_lt_u32 vcc, 7, v5
  s_nop 1
  v_cndmask_b32 v173, v5, v173, vcc
  v_cvt_f32_u32 v171, v173
  v_mfma_f32_32x32x16_bf16 v[120:135], v[140:143], v[148:151], v[120:135]
  buffer_load_dwordx4 v10, s[44:47], s10 offen offset:2048 lds
  v_mul_f32 v171, 0x3d800000, v171
  v_mul_f32 v172, v171, v170
  v_fmamk_f32 v78, v171, 0x0, v172
  v_mfma_f32_32x32x16_bf16 v[104:119], v[140:143], v[144:147], v[104:119]
  buffer_load_dwordx4 v11, s[44:47], s10 offen offset:3072 lds
  s_add_u32 s10, s10, 128
  s_and_b32 s10, s10, 0x7ff
  v_cos_f32 v79, v78
  v_sin_f32 v168, v78
  s_nop 0
  v_cvt_pk_bf16_f32 v224, v79, v168
  s_waitcnt vmcnt(16) lgkmcnt(0)
  s_barrier
  v_mfma_f32_32x32x16_bf16 v[44:59], v[152:155], v[160:163], v[44:59]
  ds_read_b128 v[136:139], v16 offset:0
  ds_read_b128 v[144:147], v20 offset:0
  v_cvt_pk_bf16_f32 v228, -v168, v79
  v_fmamk_f32 v78, v171, 0x3f800000, v172
  v_cos_f32 v79, v78
  v_mfma_f32_32x32x16_bf16 v[88:103], v[152:155], v[164:167], v[88:103]
  ds_read_b128 v[140:143], v16 offset:4096
  ds_read_b128 v[148:151], v20 offset:4096
  v_sin_f32 v168, v78
  s_nop 0
  v_cvt_pk_bf16_f32 v225, v79, v168
  v_cvt_pk_bf16_f32 v229, -v168, v79
  v_mfma_f32_32x32x16_bf16 v[120:135], v[156:159], v[164:167], v[120:135]
  s_add_u32 m0, s17, 49152
  s_nop 0
  buffer_load_dwordx4 v12, s[56:59], s10 offen offset:0 lds
  v_fmamk_f32 v78, v171, 0x40000000, v172
  v_cos_f32 v79, v78
  v_sin_f32 v168, v78
  v_mfma_f32_32x32x16_bf16 v[104:119], v[156:159], v[160:163], v[104:119]
  buffer_load_dwordx4 v13, s[56:59], s10 offen offset:1024 lds
  v_cvt_pk_bf16_f32 v226, v79, v168
  v_cvt_pk_bf16_f32 v230, -v168, v79
  v_fmamk_f32 v78, v171, 0x40400000, v172
  s_waitcnt lgkmcnt(2)
  v_mfma_f32_32x32x16_bf16 v[44:59], v[136:139], v[144:147], v[44:59]
  ds_read_b128 v[152:155], v17 offset:0
  ds_read_b128 v[160:163], v21 offset:0
  v_cos_f32 v79, v78
  v_sin_f32 v168, v78
  s_nop 0
  v_cvt_pk_bf16_f32 v227, v79, v168
  s_waitcnt lgkmcnt(2)
  v_mfma_f32_32x32x16_bf16 v[88:103], v[136:139], v[148:151], v[88:103]
  ds_read_b128 v[156:159], v17 offset:4096
  ds_read_b128 v[164:167], v21 offset:4096
  v_cvt_pk_bf16_f32 v231, -v168, v79
  v_mul_f32 v171, 0x3d800000, v169
  v_add_f32 v173, 0x40400000, v170
  v_mfma_f32_32x32x16_bf16 v[120:135], v[140:143], v[148:151], v[120:135]
  buffer_load_dwordx4 v14, s[56:59], s10 offen offset:2048 lds
  v_cmp_lt_u32 vcc, 1, v6
  s_nop 1
  v_cndmask_b32 v173, v170, v173, vcc
  v_mul_f32 v172, v171, v173
  v_mfma_f32_32x32x16_bf16 v[104:119], v[140:143], v[144:147], v[104:119]
  buffer_load_dwordx4 v15, s[56:59], s10 offen offset:3072 lds
  v_cndmask_b32 v171, v171, -v171, vcc
  v_fmamk_f32 v78, v171, 0x0, v172
  v_cos_f32 v79, v78
  s_waitcnt lgkmcnt(2)
  v_mfma_f32_32x32x16_bf16 v[44:59], v[152:155], v[160:163], v[44:59]
  ds_read_b128 v[136:139], v18 offset:0
  ds_read_b128 v[144:147], v22 offset:0
  v_sin_f32 v168, v78
  s_nop 0
  v_cvt_pk_bf16_f32 v232, v79, -v168
  v_cvt_pk_bf16_f32 v236, v168, v79
  s_waitcnt lgkmcnt(2)
  v_mfma_f32_32x32x16_bf16 v[88:103], v[152:155], v[164:167], v[88:103]
  ds_read_b128 v[140:143], v18 offset:4096
  ds_read_b128 v[148:151], v22 offset:4096
  v_fmamk_f32 v78, v171, 0x3f800000, v172
  v_cos_f32 v79, v78
  v_sin_f32 v168, v78
  v_mfma_f32_32x32x16_bf16 v[120:135], v[156:159], v[164:167], v[120:135]
  s_add_u32 m0, s16, 49152
  s_nop 0
  buffer_load_dwordx4 v8, s[44:47], s10 offen offset:0 lds
  v_cvt_pk_bf16_f32 v233, v79, -v168
  v_cvt_pk_bf16_f32 v237, v168, v79
  v_fmamk_f32 v78, v171, 0x40000000, v172
  v_mfma_f32_32x32x16_bf16 v[104:119], v[156:159], v[160:163], v[104:119]
  buffer_load_dwordx4 v9, s[44:47], s10 offen offset:1024 lds
  v_cos_f32 v79, v78
  v_sin_f32 v168, v78
  s_nop 0
  v_cvt_pk_bf16_f32 v234, v79, -v168
  s_waitcnt lgkmcnt(2)
  v_mfma_f32_32x32x16_bf16 v[44:59], v[136:139], v[144:147], v[44:59]
  ds_read_b128 v[152:155], v19 offset:0
  ds_read_b128 v[160:163], v23 offset:0
  v_cvt_pk_bf16_f32 v238, v168, v79
  v_fmamk_f32 v78, v171, 0x40400000, v172
  v_cos_f32 v79, v78
  s_waitcnt lgkmcnt(2)
  v_mfma_f32_32x32x16_bf16 v[88:103], v[136:139], v[148:151], v[88:103]
  ds_read_b128 v[156:159], v19 offset:4096
  ds_read_b128 v[164:167], v23 offset:4096
  v_sin_f32 v168, v78
  s_nop 0
  v_cvt_pk_bf16_f32 v235, v79, -v168
  v_cvt_pk_bf16_f32 v239, v168, v79
  v_mfma_f32_32x32x16_bf16 v[120:135], v[140:143], v[148:151], v[120:135]
  buffer_load_dwordx4 v10, s[44:47], s10 offen offset:2048 lds
  v_mfma_f32_32x32x16_bf16 v[104:119], v[140:143], v[144:147], v[104:119]
  buffer_load_dwordx4 v11, s[44:47], s10 offen offset:3072 lds
  s_add_u32 s10, s10, 128
  s_and_b32 s10, s10, 0x7ff
  s_waitcnt vmcnt(16) lgkmcnt(0)
  s_barrier
  v_mfma_f32_32x32x16_bf16 v[44:59], v[152:155], v[160:163], v[44:59]
  ds_read_b128 v[136:139], v16 offset:16384
  ds_read_b128 v[144:147], v20 offset:16384
  v_mfma_f32_32x32x16_bf16 v[88:103], v[152:155], v[164:167], v[88:103]
  ds_read_b128 v[140:143], v16 offset:20480
  ds_read_b128 v[148:151], v20 offset:20480
  v_mfma_f32_32x32x16_bf16 v[120:135], v[156:159], v[164:167], v[120:135]
  s_add_u32 m0, s17, 0
  s_nop 0
  buffer_load_dwordx4 v12, s[56:59], s10 offen offset:0 lds
  v_mfma_f32_32x32x16_bf16 v[104:119], v[156:159], v[160:163], v[104:119]
  buffer_load_dwordx4 v13, s[56:59], s10 offen offset:1024 lds
  s_waitcnt lgkmcnt(2)
  v_mfma_f32_32x32x16_bf16 v[44:59], v[136:139], v[144:147], v[44:59]
  ds_read_b128 v[152:155], v17 offset:16384
  ds_read_b128 v[160:163], v21 offset:16384
  s_waitcnt lgkmcnt(2)
  v_mfma_f32_32x32x16_bf16 v[88:103], v[136:139], v[148:151], v[88:103]
  ds_read_b128 v[156:159], v17 offset:20480
  ds_read_b128 v[164:167], v21 offset:20480
  v_mfma_f32_32x32x16_bf16 v[120:135], v[140:143], v[148:151], v[120:135]
  buffer_load_dwordx4 v14, s[56:59], s10 offen offset:2048 lds
  v_mfma_f32_32x32x16_bf16 v[104:119], v[140:143], v[144:147], v[104:119]
  buffer_load_dwordx4 v15, s[56:59], s10 offen offset:3072 lds
  s_waitcnt lgkmcnt(2)
  v_mfma_f32_32x32x16_bf16 v[44:59], v[152:155], v[160:163], v[44:59]
  ds_read_b128 v[136:139], v18 offset:16384
  ds_read_b128 v[144:147], v22 offset:16384
  s_waitcnt lgkmcnt(2)
  v_mfma_f32_32x32x16_bf16 v[88:103], v[152:155], v[164:167], v[88:103]
  ds_read_b128 v[140:143], v18 offset:20480
  ds_read_b128 v[148:151], v22 offset:20480
  v_mfma_f32_32x32x16_bf16 v[120:135], v[156:159], v[164:167], v[120:135]
  s_add_u32 m0, s16, 0
  s_nop 0
  buffer_load_dwordx4 v8, s[44:47], s10 offen offset:0 lds
  v_mfma_f32_32x32x16_bf16 v[104:119], v[156:159], v[160:163], v[104:119]
  buffer_load_dwordx4 v9, s[44:47], s10 offen offset:1024 lds
  s_waitcnt lgkmcnt(2)
  v_mfma_f32_32x32x16_bf16 v[44:59], v[136:139], v[144:147], v[44:59]
  ds_read_b128 v[152:155], v19 offset:16384
  ds_read_b128 v[160:163], v23 offset:16384
  s_waitcnt lgkmcnt(2)
  v_mfma_f32_32x32x16_bf16 v[88:103], v[136:139], v[148:151], v[88:103]
  ds_read_b128 v[156:159], v19 offset:20480
  ds_read_b128 v[164:167], v23 offset:20480
  v_mfma_f32_32x32x16_bf16 v[120:135], v[140:143], v[148:151], v[120:135]
  buffer_load_dwordx4 v10, s[44:47], s10 offen offset:2048 lds
  v_mfma_f32_32x32x16_bf16 v[104:119], v[140:143], v[144:147], v[104:119]
  buffer_load_dwordx4 v11, s[44:47], s10 offen offset:3072 lds
  s_add_u32 s10, s10, 128
  s_and_b32 s10, s10, 0x7ff
  s_waitcnt vmcnt(16) lgkmcnt(0)
  s_barrier
  v_mfma_f32_32x32x16_bf16 v[44:59], v[152:155], v[160:163], v[44:59]
  ds_read_b128 v[136:139], v16 offset:32768
  ds_read_b128 v[144:147], v20 offset:32768
  v_mfma_f32_32x32x16_bf16 v[88:103], v[152:155], v[164:167], v[88:103]
  ds_read_b128 v[140:143], v16 offset:36864
  ds_read_b128 v[148:151], v20 offset:36864
  v_mfma_f32_32x32x16_bf16 v[120:135], v[156:159], v[164:167], v[120:135]
  s_add_u32 m0, s17, 16384
  s_nop 0
  buffer_load_dwordx4 v12, s[56:59], s10 offen offset:0 lds
  v_mfma_f32_32x32x16_bf16 v[104:119], v[156:159], v[160:163], v[104:119]
  buffer_load_dwordx4 v13, s[56:59], s10 offen offset:1024 lds
  s_waitcnt lgkmcnt(2)
  v_mfma_f32_32x32x16_bf16 v[44:59], v[136:139], v[144:147], v[44:59]
  ds_read_b128 v[152:155], v17 offset:32768
  ds_read_b128 v[160:163], v21 offset:32768
  s_waitcnt lgkmcnt(2)
  v_mfma_f32_32x32x16_bf16 v[88:103], v[136:139], v[148:151], v[88:103]
  ds_read_b128 v[156:159], v17 offset:36864
  ds_read_b128 v[164:167], v21 offset:36864
  v_mfma_f32_32x32x16_bf16 v[120:135], v[140:143], v[148:151], v[120:135]
  buffer_load_dwordx4 v14, s[56:59], s10 offen offset:2048 lds
  v_mfma_f32_32x32x16_bf16 v[104:119], v[140:143], v[144:147], v[104:119]
  buffer_load_dwordx4 v15, s[56:59], s10 offen offset:3072 lds
  s_waitcnt lgkmcnt(2)
  v_mfma_f32_32x32x16_bf16 v[44:59], v[152:155], v[160:163], v[44:59]
  ds_read_b128 v[136:139], v18 offset:32768
  ds_read_b128 v[144:147], v22 offset:32768
  s_waitcnt lgkmcnt(2)
  v_mfma_f32_32x32x16_bf16 v[88:103], v[152:155], v[164:167], v[88:103]
  ds_read_b128 v[140:143], v18 offset:36864
  ds_read_b128 v[148:151], v22 offset:36864
  v_mfma_f32_32x32x16_bf16 v[120:135], v[156:159], v[164:167], v[120:135]
  s_add_u32 m0, s16, 16384
  s_nop 0
  buffer_load_dwordx4 v8, s[44:47], s10 offen offset:0 lds
  v_mfma_f32_32x32x16_bf16 v[104:119], v[156:159], v[160:163], v[104:119]
  buffer_load_dwordx4 v9, s[44:47], s10 offen offset:1024 lds
  s_waitcnt lgkmcnt(2)
  v_mfma_f32_32x32x16_bf16 v[44:59], v[136:139], v[144:147], v[44:59]
  ds_read_b128 v[152:155], v19 offset:32768
  ds_read_b128 v[160:163], v23 offset:32768
  s_waitcnt lgkmcnt(2)
  v_mfma_f32_32x32x16_bf16 v[88:103], v[136:139], v[148:151], v[88:103]
  ds_read_b128 v[156:159], v19 offset:36864
  ds_read_b128 v[164:167], v23 offset:36864
  v_mfma_f32_32x32x16_bf16 v[120:135], v[140:143], v[148:151], v[120:135]
  buffer_load_dwordx4 v10, s[44:47], s10 offen offset:2048 lds
  v_mfma_f32_32x32x16_bf16 v[104:119], v[140:143], v[144:147], v[104:119]
  buffer_load_dwordx4 v11, s[44:47], s10 offen offset:3072 lds
  s_add_u32 s10, s10, 128
  s_and_b32 s10, s10, 0x7ff
  s_waitcnt vmcnt(16) lgkmcnt(0)
  s_barrier
  v_mfma_f32_32x32x16_bf16 v[44:59], v[152:155], v[160:163], v[44:59]
  ds_read_b128 v[136:139], v16 offset:49152
  ds_read_b128 v[144:147], v20 offset:49152
  v_mfma_f32_32x32x16_bf16 v[88:103], v[152:155], v[164:167], v[88:103]
  ds_read_b128 v[140:143], v16 offset:53248
  ds_read_b128 v[148:151], v20 offset:53248
  v_mfma_f32_32x32x16_bf16 v[120:135], v[156:159], v[164:167], v[120:135]
  s_add_u32 m0, s17, 32768
  s_nop 0
  buffer_load_dwordx4 v12, s[56:59], s10 offen offset:0 lds
  v_mfma_f32_32x32x16_bf16 v[104:119], v[156:159], v[160:163], v[104:119]
  buffer_load_dwordx4 v13, s[56:59], s10 offen offset:1024 lds
  s_waitcnt lgkmcnt(2)
  v_mfma_f32_32x32x16_bf16 v[44:59], v[136:139], v[144:147], v[44:59]
  ds_read_b128 v[152:155], v17 offset:49152
  ds_read_b128 v[160:163], v21 offset:49152
  s_waitcnt lgkmcnt(2)
  v_mfma_f32_32x32x16_bf16 v[88:103], v[136:139], v[148:151], v[88:103]
  ds_read_b128 v[156:159], v17 offset:53248
  ds_read_b128 v[164:167], v21 offset:53248
  v_mfma_f32_32x32x16_bf16 v[120:135], v[140:143], v[148:151], v[120:135]
  buffer_load_dwordx4 v14, s[56:59], s10 offen offset:2048 lds
  v_mfma_f32_32x32x16_bf16 v[104:119], v[140:143], v[144:147], v[104:119]
  buffer_load_dwordx4 v15, s[56:59], s10 offen offset:3072 lds
  s_waitcnt lgkmcnt(2)
  v_mfma_f32_32x32x16_bf16 v[44:59], v[152:155], v[160:163], v[44:59]
  ds_read_b128 v[136:139], v18 offset:49152
  ds_read_b128 v[144:147], v22 offset:49152
  s_waitcnt lgkmcnt(2)
  v_mfma_f32_32x32x16_bf16 v[88:103], v[152:155], v[164:167], v[88:103]
  ds_read_b128 v[140:143], v18 offset:53248
  ds_read_b128 v[148:151], v22 offset:53248
  v_mfma_f32_32x32x16_bf16 v[120:135], v[156:159], v[164:167], v[120:135]
  s_add_u32 m0, s16, 32768
  s_nop 0
  buffer_load_dwordx4 v8, s[44:47], s10 offen offset:0 lds
  v_mfma_f32_32x32x16_bf16 v[104:119], v[156:159], v[160:163], v[104:119]
  buffer_load_dwordx4 v9, s[44:47], s10 offen offset:1024 lds
  s_waitcnt lgkmcnt(2)
  v_mfma_f32_32x32x16_bf16 v[44:59], v[136:139], v[144:147], v[44:59]
  ds_read_b128 v[152:155], v19 offset:49152
  ds_read_b128 v[160:163], v23 offset:49152
  s_waitcnt lgkmcnt(2)
  v_mfma_f32_32x32x16_bf16 v[88:103], v[136:139], v[148:151], v[88:103]
  ds_read_b128 v[156:159], v19 offset:53248
  ds_read_b128 v[164:167], v23 offset:53248
  v_mfma_f32_32x32x16_bf16 v[120:135], v[140:143], v[148:151], v[120:135]
  buffer_load_dwordx4 v10, s[44:47], s10 offen offset:2048 lds
  v_mfma_f32_32x32x16_bf16 v[104:119], v[140:143], v[144:147], v[104:119]
  buffer_load_dwordx4 v11, s[44:47], s10 offen offset:3072 lds
  s_add_u32 s10, s10, 128
  s_and_b32 s10, s10, 0x7ff
  s_waitcnt vmcnt(16) lgkmcnt(0)
  s_barrier
  v_mfma_f32_32x32x16_bf16 v[44:59], v[152:155], v[160:163], v[44:59]
  ds_read_b128 v[136:139], v16 offset:0
  ds_read_b128 v[144:147], v20 offset:0
  v_mfma_f32_32x32x16_bf16 v[88:103], v[152:155], v[164:167], v[88:103]
  ds_read_b128 v[140:143], v16 offset:4096
  ds_read_b128 v[148:151], v20 offset:4096
  v_mfma_f32_32x32x16_bf16 v[120:135], v[156:159], v[164:167], v[120:135]
  s_add_u32 m0, s17, 49152
  s_nop 0
  buffer_load_dwordx4 v12, s[56:59], s10 offen offset:0 lds
  v_mfma_f32_32x32x16_bf16 v[104:119], v[156:159], v[160:163], v[104:119]
  buffer_load_dwordx4 v13, s[56:59], s10 offen offset:1024 lds
  s_waitcnt lgkmcnt(2)
  v_mfma_f32_32x32x16_bf16 v[44:59], v[136:139], v[144:147], v[44:59]
  ds_read_b128 v[152:155], v17 offset:0
  ds_read_b128 v[160:163], v21 offset:0
  s_waitcnt lgkmcnt(2)
  v_mfma_f32_32x32x16_bf16 v[88:103], v[136:139], v[148:151], v[88:103]
  ds_read_b128 v[156:159], v17 offset:4096
  ds_read_b128 v[164:167], v21 offset:4096
  v_mfma_f32_32x32x16_bf16 v[120:135], v[140:143], v[148:151], v[120:135]
  buffer_load_dwordx4 v14, s[56:59], s10 offen offset:2048 lds
  v_mfma_f32_32x32x16_bf16 v[104:119], v[140:143], v[144:147], v[104:119]
  buffer_load_dwordx4 v15, s[56:59], s10 offen offset:3072 lds
  s_waitcnt lgkmcnt(2)
  v_mfma_f32_32x32x16_bf16 v[44:59], v[152:155], v[160:163], v[44:59]
  ds_read_b128 v[136:139], v18 offset:0
  ds_read_b128 v[144:147], v22 offset:0
  s_waitcnt lgkmcnt(2)
  v_mfma_f32_32x32x16_bf16 v[88:103], v[152:155], v[164:167], v[88:103]
  ds_read_b128 v[140:143], v18 offset:4096
  ds_read_b128 v[148:151], v22 offset:4096
  v_mfma_f32_32x32x16_bf16 v[120:135], v[156:159], v[164:167], v[120:135]
  s_add_u32 m0, s16, 49152
  s_nop 0
  buffer_load_dwordx4 v8, s[44:47], s10 offen offset:0 lds
  v_mfma_f32_32x32x16_bf16 v[104:119], v[156:159], v[160:163], v[104:119]
  buffer_load_dwordx4 v9, s[44:47], s10 offen offset:1024 lds
  s_waitcnt lgkmcnt(2)
  v_mfma_f32_32x32x16_bf16 v[44:59], v[136:139], v[144:147], v[44:59]
  ds_read_b128 v[152:155], v19 offset:0
  ds_read_b128 v[160:163], v23 offset:0
  s_waitcnt lgkmcnt(2)
  v_mfma_f32_32x32x16_bf16 v[88:103], v[136:139], v[148:151], v[88:103]
  ds_read_b128 v[156:159], v19 offset:4096
  ds_read_b128 v[164:167], v23 offset:4096
  v_mfma_f32_32x32x16_bf16 v[120:135], v[140:143], v[148:151], v[120:135]
  buffer_load_dwordx4 v10, s[44:47], s10 offen offset:2048 lds
  v_mfma_f32_32x32x16_bf16 v[104:119], v[140:143], v[144:147], v[104:119]
  buffer_load_dwordx4 v11, s[44:47], s10 offen offset:3072 lds
  s_add_u32 s10, s10, 128
  s_and_b32 s10, s10, 0x7ff
  s_waitcnt vmcnt(16) lgkmcnt(0)
  s_barrier
  v_mfma_f32_32x32x16_bf16 v[44:59], v[152:155], v[160:163], v[44:59]
  ds_read_b128 v[136:139], v16 offset:16384
  ds_read_b128 v[144:147], v20 offset:16384
  v_mfma_f32_32x32x16_bf16 v[88:103], v[152:155], v[164:167], v[88:103]
  ds_read_b128 v[140:143], v16 offset:20480
  ds_read_b128 v[148:151], v20 offset:20480
  v_mfma_f32_32x32x16_bf16 v[120:135], v[156:159], v[164:167], v[120:135]
  buffer_load_dword v241, v3, s[48:51], 0 offen sc1
  v_mov_b32 v78, 2130706432
  v_writelane_b32 v78, s72, 0
  v_writelane_b32 v78, s73, 1
  v_writelane_b32 v78, s74, 2
  v_writelane_b32 v78, s75, 3
  v_writelane_b32 v78, s76, 4
  v_writelane_b32 v78, s77, 5
  v_writelane_b32 v78, s78, 6
  v_writelane_b32 v78, s79, 7
  v_and_b32 v78, -16, v78
  s_mov_b64 exec, 255
  buffer_load_dwordx4 v[168:171], v78, s[20:23], 0 offen offset:1024
  buffer_load_dwordx4 v[172:175], v78, s[68:71], 0 offen offset:1024
  s_mov_b64 exec, -1
  s_and_b32 s32, s72, -16
  s_add_u32 m0, s29, 0
  s_nop 0
  buffer_load_dwordx4 v75, s[20:23], s32 offen lds
  v_mfma_f32_32x32x16_bf16 v[104:119], v[156:159], v[160:163], v[104:119]
  s_add_u32 m0, s29, 1024
  s_nop 0
  buffer_load_dwordx4 v75, s[68:71], s32 offen lds
  s_waitcnt lgkmcnt(2)
  v_mfma_f32_32x32x16_bf16 v[44:59], v[136:139], v[144:147], v[44:59]
  ds_read_b128 v[152:155], v17 offset:16384
  ds_read_b128 v[160:163], v21 offset:16384
  s_waitcnt lgkmcnt(2)
  v_mfma_f32_32x32x16_bf16 v[88:103], v[136:139], v[148:151], v[88:103]
  ds_read_b128 v[156:159], v17 offset:20480
  ds_read_b128 v[164:167], v21 offset:20480
  v_mfma_f32_32x32x16_bf16 v[120:135], v[140:143], v[148:151], v[120:135]
  s_and_b32 s32, s73, -16
  s_add_u32 m0, s29, 2048
  s_nop 0
  buffer_load_dwordx4 v75, s[20:23], s32 offen lds
  v_mfma_f32_32x32x16_bf16 v[104:119], v[140:143], v[144:147], v[104:119]
  s_add_u32 m0, s29, 3072
  s_nop 0
  buffer_load_dwordx4 v75, s[68:71], s32 offen lds
  s_waitcnt lgkmcnt(2)
  v_mfma_f32_32x32x16_bf16 v[44:59], v[152:155], v[160:163], v[44:59]
  ds_read_b128 v[136:139], v18 offset:16384
  ds_read_b128 v[144:147], v22 offset:16384
  s_waitcnt lgkmcnt(2)
  v_mfma_f32_32x32x16_bf16 v[88:103], v[152:155], v[164:167], v[88:103]
  ds_read_b128 v[140:143], v18 offset:20480
  ds_read_b128 v[148:151], v22 offset:20480
  v_mfma_f32_32x32x16_bf16 v[120:135], v[156:159], v[164:167], v[120:135]
  s_and_b32 s32, s74, -16
  s_add_u32 m0, s29, 65536
  s_nop 0
  buffer_load_dwordx4 v75, s[20:23], s32 offen lds
  v_mfma_f32_32x32x16_bf16 v[104:119], v[156:159], v[160:163], v[104:119]
  s_add_u32 m0, s29, 66560
  s_nop 0
  buffer_load_dwordx4 v75, s[68:71], s32 offen lds
  s_waitcnt lgkmcnt(2)
  v_mfma_f32_32x32x16_bf16 v[44:59], v[136:139], v[144:147], v[44:59]
  ds_read_b128 v[152:155], v19 offset:16384
  ds_read_b128 v[160:163], v23 offset:16384
  s_waitcnt lgkmcnt(2)
  v_mfma_f32_32x32x16_bf16 v[88:103], v[136:139], v[148:151], v[88:103]
  ds_read_b128 v[156:159], v19 offset:20480
  ds_read_b128 v[164:167], v23 offset:20480
  v_mfma_f32_32x32x16_bf16 v[120:135], v[140:143], v[148:151], v[120:135]
  s_and_b32 s32, s75, -16
  s_add_u32 m0, s29, 67584
  s_nop 0
  buffer_load_dwordx4 v75, s[20:23], s32 offen lds
  v_mfma_f32_32x32x16_bf16 v[104:119], v[140:143], v[144:147], v[104:119]
  s_add_u32 m0, s29, 68608
  s_nop 0
  buffer_load_dwordx4 v75, s[68:71], s32 offen lds
  s_waitcnt vmcnt(19) lgkmcnt(0)
  s_barrier
  v_mfma_f32_32x32x16_bf16 v[44:59], v[152:155], v[160:163], v[44:59]
  ds_read_b128 v[136:139], v16 offset:32768
  ds_read_b128 v[144:147], v20 offset:32768
  v_mfma_f32_32x32x16_bf16 v[88:103], v[152:155], v[164:167], v[88:103]
  ds_read_b128 v[140:143], v16 offset:36864
  ds_read_b128 v[148:151], v20 offset:36864
  v_mfma_f32_32x32x16_bf16 v[120:135], v[156:159], v[164:167], v[120:135]
  s_and_b32 s32, s76, -16
  s_add_u32 m0, s29, 16384
  s_nop 0
  buffer_load_dwordx4 v75, s[20:23], s32 offen lds
  v_mfma_f32_32x32x16_bf16 v[104:119], v[156:159], v[160:163], v[104:119]
  s_add_u32 m0, s29, 17408
  s_nop 0
  buffer_load_dwordx4 v75, s[68:71], s32 offen lds
  s_waitcnt lgkmcnt(2)
  v_mfma_f32_32x32x16_bf16 v[44:59], v[136:139], v[144:147], v[44:59]
  ds_read_b128 v[152:155], v17 offset:32768
  ds_read_b128 v[160:163], v21 offset:32768
  s_waitcnt lgkmcnt(2)
  v_mfma_f32_32x32x16_bf16 v[88:103], v[136:139], v[148:151], v[88:103]
  ds_read_b128 v[156:159], v17 offset:36864
  ds_read_b128 v[164:167], v21 offset:36864
  v_mfma_f32_32x32x16_bf16 v[120:135], v[140:143], v[148:151], v[120:135]
  s_and_b32 s32, s77, -16
  s_add_u32 m0, s29, 18432
  s_nop 0
  buffer_load_dwordx4 v75, s[20:23], s32 offen lds
  v_mfma_f32_32x32x16_bf16 v[104:119], v[140:143], v[144:147], v[104:119]
  s_add_u32 m0, s29, 19456
  s_nop 0
  buffer_load_dwordx4 v75, s[68:71], s32 offen lds
  s_waitcnt lgkmcnt(2)
  v_mfma_f32_32x32x16_bf16 v[44:59], v[152:155], v[160:163], v[44:59]
  ds_read_b128 v[136:139], v18 offset:32768
  ds_read_b128 v[144:147], v22 offset:32768
  s_waitcnt lgkmcnt(2)
  v_mfma_f32_32x32x16_bf16 v[88:103], v[152:155], v[164:167], v[88:103]
  ds_read_b128 v[140:143], v18 offset:36864
  ds_read_b128 v[148:151], v22 offset:36864
  v_mfma_f32_32x32x16_bf16 v[120:135], v[156:159], v[164:167], v[120:135]
  s_and_b32 s32, s78, -16
  s_add_u32 m0, s29, 81920
  s_nop 0
  buffer_load_dwordx4 v75, s[20:23], s32 offen lds
  v_mfma_f32_32x32x16_bf16 v[104:119], v[156:159], v[160:163], v[104:119]
  s_add_u32 m0, s29, 82944
  s_nop 0
  buffer_load_dwordx4 v75, s[68:71], s32 offen lds
  s_waitcnt lgkmcnt(2)
  v_mfma_f32_32x32x16_bf16 v[44:59], v[136:139], v[144:147], v[44:59]
  ds_read_b128 v[152:155], v19 offset:32768
  ds_read_b128 v[160:163], v23 offset:32768
  s_waitcnt lgkmcnt(2)
  v_mfma_f32_32x32x16_bf16 v[88:103], v[136:139], v[148:151], v[88:103]
  ds_read_b128 v[156:159], v19 offset:36864
  ds_read_b128 v[164:167], v23 offset:36864
  v_mfma_f32_32x32x16_bf16 v[120:135], v[140:143], v[148:151], v[120:135]
  s_and_b32 s32, s79, -16
  s_add_u32 m0, s29, 83968
  s_nop 0
  buffer_load_dwordx4 v75, s[20:23], s32 offen lds
  v_mfma_f32_32x32x16_bf16 v[104:119], v[140:143], v[144:147], v[104:119]
  s_add_u32 m0, s29, 84992
  s_nop 0
  buffer_load_dwordx4 v75, s[68:71], s32 offen lds
  s_waitcnt vmcnt(19) lgkmcnt(0)
  s_barrier
  v_mfma_f32_32x32x16_bf16 v[44:59], v[152:155], v[160:163], v[44:59]
  ds_read_b128 v[136:139], v16 offset:49152
  ds_read_b128 v[144:147], v20 offset:49152
  v_mfma_f32_32x32x16_bf16 v[88:103], v[152:155], v[164:167], v[88:103]
  ds_read_b128 v[140:143], v16 offset:53248
  ds_read_b128 v[148:151], v20 offset:53248
  v_mfma_f32_32x32x16_bf16 v[120:135], v[156:159], v[164:167], v[120:135]
  s_add_u32 m0, s8, 32768
  s_nop 0
  buffer_load_dwordx4 v80, s[64:67], s7 offen offset:0 lds
  v_mfma_f32_32x32x16_bf16 v[104:119], v[156:159], v[160:163], v[104:119]
  buffer_load_dwordx4 v81, s[64:67], s7 offen offset:1024 lds
  s_waitcnt lgkmcnt(2)
  v_mfma_f32_32x32x16_bf16 v[44:59], v[136:139], v[144:147], v[44:59]
  ds_read_b128 v[152:155], v17 offset:49152
  ds_read_b128 v[160:163], v21 offset:49152
  s_waitcnt lgkmcnt(2)
  v_mfma_f32_32x32x16_bf16 v[88:103], v[136:139], v[148:151], v[88:103]
  ds_read_b128 v[156:159], v17 offset:53248
  ds_read_b128 v[164:167], v21 offset:53248
  v_mfma_f32_32x32x16_bf16 v[120:135], v[140:143], v[148:151], v[120:135]
  buffer_load_dwordx4 v82, s[64:67], s7 offen offset:2048 lds
  v_mfma_f32_32x32x16_bf16 v[104:119], v[140:143], v[144:147], v[104:119]
  buffer_load_dwordx4 v83, s[64:67], s7 offen offset:3072 lds
  s_add_u32 s7, s7, 128
  s_and_b32 s7, s7, 0x7ff
  s_waitcnt lgkmcnt(2)
  v_mfma_f32_32x32x16_bf16 v[44:59], v[152:155], v[160:163], v[44:59]
  ds_read_b128 v[136:139], v18 offset:49152
  ds_read_b128 v[144:147], v22 offset:49152
  s_waitcnt lgkmcnt(2)
  v_mfma_f32_32x32x16_bf16 v[88:103], v[152:155], v[164:167], v[88:103]
  ds_read_b128 v[140:143], v18 offset:53248
  ds_read_b128 v[148:151], v22 offset:53248
  v_mfma_f32_32x32x16_bf16 v[120:135], v[156:159], v[164:167], v[120:135]
  s_add_u32 m0, s8, 98304
  s_nop 0
  buffer_load_dwordx4 v80, s[64:67], s7 offen offset:0 lds
  v_mfma_f32_32x32x16_bf16 v[104:119], v[156:159], v[160:163], v[104:119]
  buffer_load_dwordx4 v81, s[64:67], s7 offen offset:1024 lds
  s_waitcnt lgkmcnt(2)
  v_mfma_f32_32x32x16_bf16 v[44:59], v[136:139], v[144:147], v[44:59]
  ds_read_b128 v[152:155], v19 offset:49152
  ds_read_b128 v[160:163], v23 offset:49152
  s_waitcnt lgkmcnt(2)
  v_mfma_f32_32x32x16_bf16 v[88:103], v[136:139], v[148:151], v[88:103]
  ds_read_b128 v[156:159], v19 offset:53248
  ds_read_b128 v[164:167], v23 offset:53248
  v_mfma_f32_32x32x16_bf16 v[120:135], v[140:143], v[148:151], v[120:135]
  buffer_load_dwordx4 v82, s[64:67], s7 offen offset:2048 lds
  v_mfma_f32_32x32x16_bf16 v[104:119], v[140:143], v[144:147], v[104:119]
  buffer_load_dwordx4 v83, s[64:67], s7 offen offset:3072 lds
  s_add_u32 s7, s7, 128
  s_and_b32 s7, s7, 0x7ff
  s_waitcnt lgkmcnt(2)
  v_mfma_f32_32x32x16_bf16 v[44:59], v[152:155], v[160:163], v[44:59]
  s_waitcnt lgkmcnt(0)
  v_mfma_f32_32x32x16_bf16 v[88:103], v[152:155], v[164:167], v[88:103]
  v_mfma_f32_32x32x16_bf16 v[120:135], v[156:159], v[164:167], v[120:135]
  v_mfma_f32_32x32x16_bf16 v[104:119], v[156:159], v[160:163], v[104:119]
  s_nop 7
  v_pk_fma_f32 v[8:9], v[60:61], v[44:45], v[46:47] op_sel:[0,0,0] op_sel_hi:[0,1,1]
  s_nop 0
  v_pk_fma_f32 v[10:11], v[60:61], v[88:89], v[90:91] op_sel:[0,0,0] op_sel_hi:[0,1,1]
  v_pk_fma_f32 v[8:9], v[60:61], v[88:89], v[8:9] op_sel:[1,0,0] op_sel_hi:[1,1,1] neg_lo:[1,0,0] neg_hi:[1,0,0]
  v_pk_fma_f32 v[10:11], v[60:61], v[44:45], v[10:11] op_sel:[1,0,0] op_sel_hi:[1,1,1]
  v_pk_fma_f32 v[12:13], v[60:61], v[8:9], v[48:49] op_sel:[0,0,0] op_sel_hi:[0,1,1]
  v_pk_fma_f32 v[14:15], v[60:61], v[10:11], v[92:93] op_sel:[0,0,0] op_sel_hi:[0,1,1]
  v_pk_fma_f32 v[12:13], v[60:61], v[10:11], v[12:13] op_sel:[1,0,0] op_sel_hi:[1,1,1] neg_lo:[1,0,0] neg_hi:[1,0,0]
  v_pk_fma_f32 v[14:15], v[60:61], v[8:9], v[14:15] op_sel:[1,0,0] op_sel_hi:[1,1,1]
  v_pk_fma_f32 v[8:9], v[60:61], v[12:13], v[50:51] op_sel:[0,0,0] op_sel_hi:[0,1,1]
  v_pk_fma_f32 v[10:11], v[60:61], v[14:15], v[94:95] op_sel:[0,0,0] op_sel_hi:[0,1,1]
  v_pk_fma_f32 v[8:9], v[60:61], v[14:15], v[8:9] op_sel:[1,0,0] op_sel_hi:[1,1,1] neg_lo:[1,0,0] neg_hi:[1,0,0]
  v_pk_fma_f32 v[10:11], v[60:61], v[12:13], v[10:11] op_sel:[1,0,0] op_sel_hi:[1,1,1]
  v_pk_fma_f32 v[12:13], v[60:61], v[8:9], v[52:53] op_sel:[0,0,0] op_sel_hi:[0,1,1]
  v_pk_fma_f32 v[14:15], v[60:61], v[10:11], v[96:97] op_sel:[0,0,0] op_sel_hi:[0,1,1]
  v_pk_fma_f32 v[12:13], v[60:61], v[10:11], v[12:13] op_sel:[1,0,0] op_sel_hi:[1,1,1] neg_lo:[1,0,0] neg_hi:[1,0,0]
  v_pk_fma_f32 v[14:15], v[60:61], v[8:9], v[14:15] op_sel:[1,0,0] op_sel_hi:[1,1,1]
  v_pk_fma_f32 v[8:9], v[60:61], v[12:13], v[54:55] op_sel:[0,0,0] op_sel_hi:[0,1,1]
  v_pk_fma_f32 v[10:11], v[60:61], v[14:15], v[98:99] op_sel:[0,0,0] op_sel_hi:[0,1,1]
  v_pk_fma_f32 v[8:9], v[60:61], v[14:15], v[8:9] op_sel:[1,0,0] op_sel_hi:[1,1,1] neg_lo:[1,0,0] neg_hi:[1,0,0]
  v_pk_fma_f32 v[10:11], v[60:61], v[12:13], v[10:11] op_sel:[1,0,0] op_sel_hi:[1,1,1]
  v_pk_fma_f32 v[12:13], v[60:61], v[8:9], v[56:57] op_sel:[0,0,0] op_sel_hi:[0,1,1]
  v_pk_fma_f32 v[14:15], v[60:61], v[10:11], v[100:101] op_sel:[0,0,0] op_sel_hi:[0,1,1]
  v_pk_fma_f32 v[12:13], v[60:61], v[10:11], v[12:13] op_sel:[1,0,0] op_sel_hi:[1,1,1] neg_lo:[1,0,0] neg_hi:[1,0,0]
  v_pk_fma_f32 v[14:15], v[60:61], v[8:9], v[14:15] op_sel:[1,0,0] op_sel_hi:[1,1,1]
  v_pk_fma_f32 v[8:9], v[60:61], v[12:13], v[58:59] op_sel:[0,0,0] op_sel_hi:[0,1,1]
  v_pk_fma_f32 v[10:11], v[60:61], v[14:15], v[102:103] op_sel:[0,0,0] op_sel_hi:[0,1,1]
  v_pk_fma_f32 v[8:9], v[60:61], v[14:15], v[8:9] op_sel:[1,0,0] op_sel_hi:[1,1,1] neg_lo:[1,0,0] neg_hi:[1,0,0]
  v_pk_fma_f32 v[10:11], v[60:61], v[12:13], v[10:11] op_sel:[1,0,0] op_sel_hi:[1,1,1]
  v_pk_fma_f32 v[12:13], v[60:61], v[8:9], v[104:105] op_sel:[0,0,0] op_sel_hi:[0,1,1]
  v_pk_fma_f32 v[14:15], v[60:61], v[10:11], v[120:121] op_sel:[0,0,0] op_sel_hi:[0,1,1]
  v_pk_fma_f32 v[12:13], v[60:61], v[10:11], v[12:13] op_sel:[1,0,0] op_sel_hi:[1,1,1] neg_lo:[1,0,0] neg_hi:[1,0,0]
  v_pk_fma_f32 v[14:15], v[60:61], v[8:9], v[14:15] op_sel:[1,0,0] op_sel_hi:[1,1,1]
  v_pk_fma_f32 v[8:9], v[60:61], v[12:13], v[106:107] op_sel:[0,0,0] op_sel_hi:[0,1,1]
  v_pk_fma_f32 v[10:11], v[60:61], v[14:15], v[122:123] op_sel:[0,0,0] op_sel_hi:[0,1,1]
  v_pk_fma_f32 v[8:9], v[60:61], v[14:15], v[8:9] op_sel:[1,0,0] op_sel_hi:[1,1,1] neg_lo:[1,0,0] neg_hi:[1,0,0]
  v_pk_fma_f32 v[10:11], v[60:61], v[12:13], v[10:11] op_sel:[1,0,0] op_sel_hi:[1,1,1]
  v_pk_fma_f32 v[12:13], v[60:61], v[8:9], v[108:109] op_sel:[0,0,0] op_sel_hi:[0,1,1]
  v_pk_fma_f32 v[14:15], v[60:61], v[10:11], v[124:125] op_sel:[0,0,0] op_sel_hi:[0,1,1]
  v_pk_fma_f32 v[12:13], v[60:61], v[10:11], v[12:13] op_sel:[1,0,0] op_sel_hi:[1,1,1] neg_lo:[1,0,0] neg_hi:[1,0,0]
  v_pk_fma_f32 v[14:15], v[60:61], v[8:9], v[14:15] op_sel:[1,0,0] op_sel_hi:[1,1,1]
  v_pk_fma_f32 v[8:9], v[60:61], v[12:13], v[110:111] op_sel:[0,0,0] op_sel_hi:[0,1,1]
  v_pk_fma_f32 v[10:11], v[60:61], v[14:15], v[126:127] op_sel:[0,0,0] op_sel_hi:[0,1,1]
  v_pk_fma_f32 v[8:9], v[60:61], v[14:15], v[8:9] op_sel:[1,0,0] op_sel_hi:[1,1,1] neg_lo:[1,0,0] neg_hi:[1,0,0]
  v_pk_fma_f32 v[10:11], v[60:61], v[12:13], v[10:11] op_sel:[1,0,0] op_sel_hi:[1,1,1]
  v_pk_fma_f32 v[12:13], v[60:61], v[8:9], v[112:113] op_sel:[0,0,0] op_sel_hi:[0,1,1]
  v_pk_fma_f32 v[14:15], v[60:61], v[10:11], v[128:129] op_sel:[0,0,0] op_sel_hi:[0,1,1]
  v_pk_fma_f32 v[12:13], v[60:61], v[10:11], v[12:13] op_sel:[1,0,0] op_sel_hi:[1,1,1] neg_lo:[1,0,0] neg_hi:[1,0,0]
  v_pk_fma_f32 v[14:15], v[60:61], v[8:9], v[14:15] op_sel:[1,0,0] op_sel_hi:[1,1,1]
  v_pk_fma_f32 v[8:9], v[60:61], v[12:13], v[114:115] op_sel:[0,0,0] op_sel_hi:[0,1,1]
  v_pk_fma_f32 v[10:11], v[60:61], v[14:15], v[130:131] op_sel:[0,0,0] op_sel_hi:[0,1,1]
  v_pk_fma_f32 v[8:9], v[60:61], v[14:15], v[8:9] op_sel:[1,0,0] op_sel_hi:[1,1,1] neg_lo:[1,0,0] neg_hi:[1,0,0]
  v_pk_fma_f32 v[10:11], v[60:61], v[12:13], v[10:11] op_sel:[1,0,0] op_sel_hi:[1,1,1]
  v_pk_fma_f32 v[12:13], v[60:61], v[8:9], v[116:117] op_sel:[0,0,0] op_sel_hi:[0,1,1]
  v_pk_fma_f32 v[14:15], v[60:61], v[10:11], v[132:133] op_sel:[0,0,0] op_sel_hi:[0,1,1]
  v_pk_fma_f32 v[12:13], v[60:61], v[10:11], v[12:13] op_sel:[1,0,0] op_sel_hi:[1,1,1] neg_lo:[1,0,0] neg_hi:[1,0,0]
  v_pk_fma_f32 v[14:15], v[60:61], v[8:9], v[14:15] op_sel:[1,0,0] op_sel_hi:[1,1,1]
  v_pk_fma_f32 v[8:9], v[60:61], v[12:13], v[118:119] op_sel:[0,0,0] op_sel_hi:[0,1,1]
  v_pk_fma_f32 v[10:11], v[60:61], v[14:15], v[134:135] op_sel:[0,0,0] op_sel_hi:[0,1,1]
  v_pk_fma_f32 v[8:9], v[60:61], v[14:15], v[8:9] op_sel:[1,0,0] op_sel_hi:[1,1,1] neg_lo:[1,0,0] neg_hi:[1,0,0]
  v_pk_fma_f32 v[10:11], v[60:61], v[12:13], v[10:11] op_sel:[1,0,0] op_sel_hi:[1,1,1]
  v_fma_f32 v12, v62, v8, v9
  v_fma_f32 v13, v62, v10, v11
  v_fma_f32 v12, -v63, v10, v12
  v_fma_f32 v13, v63, v8, v13
  v_mov_b32 v14, v12
  v_mov_b32 v15, v13
  s_nop 0
  v_permlane32_swap_b32 v12, v14
  v_permlane32_swap_b32 v13, v15
  v_fma_f32 v14, v64, v12, v14
  v_fma_f32 v15, v64, v13, v15
  v_fma_f32 v14, -v65, v13, v14
  v_fma_f32 v15, v65, v12, v15
  ds_write_b64 v72, v[14:15]
  s_waitcnt vmcnt(26)
  v_cmp_ne_u32 vcc, 1, v241
  s_nop 0
  s_cbranch_vccz gated_mix__spectral_gfnet__ssm_conv_s5__prompt_kernel_skip12
  s_mov_b32 s10, 0
gated_mix__spectral_gfnet__ssm_conv_s5__prompt_kernel_poll13:
  s_sleep 2
  buffer_load_dword v241, v3, s[48:51], 0 offen sc1
  s_waitcnt vmcnt(0)
  v_cmp_ne_u32 vcc, 1, v241
  s_nop 0
  s_cbranch_vccz gated_mix__spectral_gfnet__ssm_conv_s5__prompt_kernel_pollout14
  s_add_u32 s10, s10, 1
  s_cmp_lt_u32 s10, 1048576
  s_cbranch_scc1 gated_mix__spectral_gfnet__ssm_conv_s5__prompt_kernel_poll13
gated_mix__spectral_gfnet__ssm_conv_s5__prompt_kernel_pollout14:
gated_mix__spectral_gfnet__ssm_conv_s5__prompt_kernel_skip12:
  s_waitcnt lgkmcnt(0)
  s_barrier
  v_and_b32 v72, 0xfffffdff, v72
  ds_read_b64 v[16:17], v72
  s_cmp_lt_u32 s3, 2
  s_cbranch_scc1 gated_mix__spectral_gfnet__ssm_conv_s5__prompt_kernel_skip15
  s_waitcnt lgkmcnt(0)
  v_fma_f32 v14, v66, v16, v14
  s_waitcnt lgkmcnt(0)
  v_fma_f32 v15, v66, v17, v15
  s_waitcnt lgkmcnt(0)
  v_fma_f32 v14, -v67, v17, v14
  s_waitcnt lgkmcnt(0)
  v_fma_f32 v15, v67, v16, v15
  v_min_u32 v14, -2, v14
  v_min_u32 v15, -2, v15
  s_mov_b32 exec_hi, 0
  buffer_store_dwordx2 v[14:15], v73, s[60:63], 0 offen sc1
  s_mov_b64 exec, -1
gated_mix__spectral_gfnet__ssm_conv_s5__prompt_kernel_skip15:
  v_lshrrev_b32 v18, 5, v4
  v_lshl_add_u32 v73, v18, 12, v73
  v_add_u32 v73, 512, v73
  s_add_u32 m0, s8, 49152
  s_nop 0
  buffer_load_dwordx4 v80, s[64:67], s7 offen offset:0 lds
  buffer_load_dwordx4 v81, s[64:67], s7 offen offset:1024 lds
  buffer_load_dwordx4 v82, s[64:67], s7 offen offset:2048 lds
  buffer_load_dwordx4 v83, s[64:67], s7 offen offset:3072 lds
  s_add_u32 s7, s7, 128
  s_and_b32 s7, s7, 0x7ff
  s_add_u32 m0, s8, 114688
  s_nop 0
  buffer_load_dwordx4 v80, s[64:67], s7 offen offset:0 lds
  buffer_load_dwordx4 v81, s[64:67], s7 offen offset:1024 lds
  buffer_load_dwordx4 v82, s[64:67], s7 offen offset:2048 lds
  buffer_load_dwordx4 v83, s[64:67], s7 offen offset:3072 lds
  s_add_u32 s7, s7, 128
  s_and_b32 s7, s7, 0x7ff
  v_and_b32 v15, 3, v5
  v_lshlrev_b32 v14, 6, v15
  v_lshrrev_b32 v15, 2, v5
  v_lshl_or_b32 v14, v15, 4, v14
  v_lshl_or_b32 v14, v6, 12, v14
  s_mul_i32 s10, s28, 16384
  s_lshl_b32 s11, s3, 8
  s_add_u32 s10, s10, s11
  buffer_load_dwordx4 v[20:23], v14, s[12:15], s10 offen offset:0 sc1
  buffer_load_dwordx4 v[136:139], v14, s[12:15], s10 offen offset:1024 sc1
  buffer_load_dwordx4 v[140:143], v14, s[12:15], s10 offen offset:2048 sc1
  buffer_load_dwordx4 v[144:147], v14, s[12:15], s10 offen offset:3072 sc1
  s_lshl_b32 s10, s3, 8
  s_add_u32 s10, s10, 147456
  v_lshl_add_u32 v14, v4, 11, s10
  s_mov_b64 exec, 255
  s_waitcnt vmcnt(37)
  ds_write_b128 v14, v[168:171]
  s_waitcnt vmcnt(36)
  ds_write_b128 v14, v[172:175] offset:1024
  s_mov_b64 exec, -1
  s_waitcnt vmcnt(16)
  ds_read_b128 a[0:3], v84 offset:32768
  ds_read_b128 a[4:7], v85 offset:32768
  ds_read_b128 a[8:11], v84 offset:34816
  ds_read_b128 a[12:15], v85 offset:34816
  s_waitcnt vmcnt(12)
  ds_read_b128 a[16:19], v86 offset:32768
  ds_read_b128 a[20:23], v87 offset:32768
  ds_read_b128 a[24:27], v86 offset:34816
  ds_read_b128 a[28:31], v87 offset:34816
  v_pk_mul_f32 v[150:151], v[70:71], v[44:45] op_sel:[1,0] op_sel_hi:[1,1]
  v_pk_mul_f32 v[44:45], v[70:71], v[44:45] op_sel:[0,0] op_sel_hi:[0,1]
  v_pk_fma_f32 v[44:45], v[70:71], v[88:89], v[44:45] op_sel:[1,0,0] op_sel_hi:[1,1,1] neg_lo:[1,0,0] neg_hi:[1,0,0]
  v_pk_fma_f32 v[88:89], v[70:71], v[88:89], v[150:151] op_sel:[0,0,0] op_sel_hi:[0,1,1]
  v_pk_mul_f32 v[148:149], v[70:71], v[46:47] op_sel:[1,0] op_sel_hi:[1,1]
  v_pk_mul_f32 v[46:47], v[70:71], v[46:47] op_sel:[0,0] op_sel_hi:[0,1]
  v_pk_fma_f32 v[46:47], v[70:71], v[90:91], v[46:47] op_sel:[1,0,0] op_sel_hi:[1,1,1] neg_lo:[1,0,0] neg_hi:[1,0,0]
  v_pk_fma_f32 v[90:91], v[70:71], v[90:91], v[148:149] op_sel:[0,0,0] op_sel_hi:[0,1,1]
  s_waitcnt lgkmcnt(4)
  s_add_u32 m0, s8, 32768
  s_nop 0
  buffer_load_dwordx4 v80, s[64:67], s7 offen offset:0 lds
  v_pk_mul_f32 v[150:151], v[70:71], v[48:49] op_sel:[1,0] op_sel_hi:[1,1]
  v_pk_mul_f32 v[48:49], v[70:71], v[48:49] op_sel:[0,0] op_sel_hi:[0,1]
  v_pk_fma_f32 v[48:49], v[70:71], v[92:93], v[48:49] op_sel:[1,0,0] op_sel_hi:[1,1,1] neg_lo:[1,0,0] neg_hi:[1,0,0]
  v_pk_fma_f32 v[92:93], v[70:71], v[92:93], v[150:151] op_sel:[0,0,0] op_sel_hi:[0,1,1]
  v_pk_mul_f32 v[148:149], v[70:71], v[50:51] op_sel:[1,0] op_sel_hi:[1,1]
  v_pk_mul_f32 v[50:51], v[70:71], v[50:51] op_sel:[0,0] op_sel_hi:[0,1]
  v_pk_fma_f32 v[50:51], v[70:71], v[94:95], v[50:51] op_sel:[1,0,0] op_sel_hi:[1,1,1] neg_lo:[1,0,0] neg_hi:[1,0,0]
  v_pk_fma_f32 v[94:95], v[70:71], v[94:95], v[148:149] op_sel:[0,0,0] op_sel_hi:[0,1,1]
  buffer_load_dwordx4 v81, s[64:67], s7 offen offset:1024 lds
  v_pk_mul_f32 v[150:151], v[70:71], v[52:53] op_sel:[1,0] op_sel_hi:[1,1]
  v_pk_mul_f32 v[52:53], v[70:71], v[52:53] op_sel:[0,0] op_sel_hi:[0,1]
  v_pk_fma_f32 v[52:53], v[70:71], v[96:97], v[52:53] op_sel:[1,0,0] op_sel_hi:[1,1,1] neg_lo:[1,0,0] neg_hi:[1,0,0]
  v_pk_fma_f32 v[96:97], v[70:71], v[96:97], v[150:151] op_sel:[0,0,0] op_sel_hi:[0,1,1]
  v_pk_mul_f32 v[148:149], v[70:71], v[54:55] op_sel:[1,0] op_sel_hi:[1,1]
  v_pk_mul_f32 v[54:55], v[70:71], v[54:55] op_sel:[0,0] op_sel_hi:[0,1]
  v_pk_fma_f32 v[54:55], v[70:71], v[98:99], v[54:55] op_sel:[1,0,0] op_sel_hi:[1,1,1] neg_lo:[1,0,0] neg_hi:[1,0,0]
  v_pk_fma_f32 v[98:99], v[70:71], v[98:99], v[148:149] op_sel:[0,0,0] op_sel_hi:[0,1,1]
  buffer_load_dwordx4 v82, s[64:67], s7 offen offset:2048 lds
  v_pk_mul_f32 v[150:151], v[70:71], v[56:57] op_sel:[1,0] op_sel_hi:[1,1]
  v_pk_mul_f32 v[56:57], v[70:71], v[56:57] op_sel:[0,0] op_sel_hi:[0,1]
  v_pk_fma_f32 v[56:57], v[70:71], v[100:101], v[56:57] op_sel:[1,0,0] op_sel_hi:[1,1,1] neg_lo:[1,0,0] neg_hi:[1,0,0]
  v_pk_fma_f32 v[100:101], v[70:71], v[100:101], v[150:151] op_sel:[0,0,0] op_sel_hi:[0,1,1]
  v_pk_mul_f32 v[148:149], v[70:71], v[58:59] op_sel:[1,0] op_sel_hi:[1,1]
  v_pk_mul_f32 v[58:59], v[70:71], v[58:59] op_sel:[0,0] op_sel_hi:[0,1]
  v_pk_fma_f32 v[58:59], v[70:71], v[102:103], v[58:59] op_sel:[1,0,0] op_sel_hi:[1,1,1] neg_lo:[1,0,0] neg_hi:[1,0,0]
  v_pk_fma_f32 v[102:103], v[70:71], v[102:103], v[148:149] op_sel:[0,0,0] op_sel_hi:[0,1,1]
  buffer_load_dwordx4 v83, s[64:67], s7 offen offset:3072 lds
  s_add_u32 s7, s7, 128
  s_and_b32 s7, s7, 0x7ff
  v_pk_mul_f32 v[150:151], v[70:71], v[104:105] op_sel:[1,0] op_sel_hi:[1,1]
  v_pk_mul_f32 v[104:105], v[70:71], v[104:105] op_sel:[0,0] op_sel_hi:[0,1]
  v_pk_fma_f32 v[104:105], v[70:71], v[120:121], v[104:105] op_sel:[1,0,0] op_sel_hi:[1,1,1] neg_lo:[1,0,0] neg_hi:[1,0,0]
  v_pk_fma_f32 v[120:121], v[70:71], v[120:121], v[150:151] op_sel:[0,0,0] op_sel_hi:[0,1,1]
  v_pk_mul_f32 v[148:149], v[70:71], v[106:107] op_sel:[1,0] op_sel_hi:[1,1]
  v_pk_mul_f32 v[106:107], v[70:71], v[106:107] op_sel:[0,0] op_sel_hi:[0,1]
  v_pk_fma_f32 v[106:107], v[70:71], v[122:123], v[106:107] op_sel:[1,0,0] op_sel_hi:[1,1,1] neg_lo:[1,0,0] neg_hi:[1,0,0]
  v_pk_fma_f32 v[122:123], v[70:71], v[122:123], v[148:149] op_sel:[0,0,0] op_sel_hi:[0,1,1]
  v_pk_mul_f32 v[150:151], v[70:71], v[108:109] op_sel:[1,0] op_sel_hi:[1,1]
  v_pk_mul_f32 v[108:109], v[70:71], v[108:109] op_sel:[0,0] op_sel_hi:[0,1]
  v_pk_fma_f32 v[108:109], v[70:71], v[124:125], v[108:109] op_sel:[1,0,0] op_sel_hi:[1,1,1] neg_lo:[1,0,0] neg_hi:[1,0,0]
  v_pk_fma_f32 v[124:125], v[70:71], v[124:125], v[150:151] op_sel:[0,0,0] op_sel_hi:[0,1,1]
  v_pk_mul_f32 v[148:149], v[70:71], v[110:111] op_sel:[1,0] op_sel_hi:[1,1]
  v_pk_mul_f32 v[110:111], v[70:71], v[110:111] op_sel:[0,0] op_sel_hi:[0,1]
  v_pk_fma_f32 v[110:111], v[70:71], v[126:127], v[110:111] op_sel:[1,0,0] op_sel_hi:[1,1,1] neg_lo:[1,0,0] neg_hi:[1,0,0]
  v_pk_fma_f32 v[126:127], v[70:71], v[126:127], v[148:149] op_sel:[0,0,0] op_sel_hi:[0,1,1]
  v_pk_mul_f32 v[150:151], v[70:71], v[112:113] op_sel:[1,0] op_sel_hi:[1,1]
  v_pk_mul_f32 v[112:113], v[70:71], v[112:113] op_sel:[0,0] op_sel_hi:[0,1]
  v_pk_fma_f32 v[112:113], v[70:71], v[128:129], v[112:113] op_sel:[1,0,0] op_sel_hi:[1,1,1] neg_lo:[1,0,0] neg_hi:[1,0,0]
  v_pk_fma_f32 v[128:129], v[70:71], v[128:129], v[150:151] op_sel:[0,0,0] op_sel_hi:[0,1,1]
  v_pk_mul_f32 v[148:149], v[70:71], v[114:115] op_sel:[1,0] op_sel_hi:[1,1]
  v_pk_mul_f32 v[114:115], v[70:71], v[114:115] op_sel:[0,0] op_sel_hi:[0,1]
  v_pk_fma_f32 v[114:115], v[70:71], v[130:131], v[114:115] op_sel:[1,0,0] op_sel_hi:[1,1,1] neg_lo:[1,0,0] neg_hi:[1,0,0]
  v_pk_fma_f32 v[130:131], v[70:71], v[130:131], v[148:149] op_sel:[0,0,0] op_sel_hi:[0,1,1]
  v_pk_mul_f32 v[150:151], v[70:71], v[116:117] op_sel:[1,0] op_sel_hi:[1,1]
  v_pk_mul_f32 v[116:117], v[70:71], v[116:117] op_sel:[0,0] op_sel_hi:[0,1]
  v_pk_fma_f32 v[116:117], v[70:71], v[132:133], v[116:117] op_sel:[1,0,0] op_sel_hi:[1,1,1] neg_lo:[1,0,0] neg_hi:[1,0,0]
  v_pk_fma_f32 v[132:133], v[70:71], v[132:133], v[150:151] op_sel:[0,0,0] op_sel_hi:[0,1,1]
  v_pk_mul_f32 v[148:149], v[70:71], v[118:119] op_sel:[1,0] op_sel_hi:[1,1]
  v_pk_mul_f32 v[118:119], v[70:71], v[118:119] op_sel:[0,0] op_sel_hi:[0,1]
  v_pk_fma_f32 v[118:119], v[70:71], v[134:135], v[118:119] op_sel:[1,0,0] op_sel_hi:[1,1,1] neg_lo:[1,0,0] neg_hi:[1,0,0]
  v_pk_fma_f32 v[134:135], v[70:71], v[134:135], v[148:149] op_sel:[0,0,0] op_sel_hi:[0,1,1]
  buffer_load_dwordx2 v[14:15], v73, s[60:63], 0 offen offset:0 sc1
  buffer_load_dwordx2 v[18:19], v73, s[60:63], 0 offen offset:512 sc1
  buffer_load_dwordx2 v[78:79], v73, s[60:63], 0 offen offset:1024 sc1
  buffer_load_dwordx2 v[148:149], v73, s[60:63], 0 offen offset:1536 sc1
  buffer_load_dwordx2 v[150:151], v73, s[60:63], 0 offen offset:2048 sc1
  buffer_load_dwordx2 v[152:153], v73, s[60:63], 0 offen offset:2560 sc1
  buffer_load_dwordx2 v[154:155], v73, s[60:63], 0 offen offset:3072 sc1
  buffer_load_dwordx2 v[156:157], v73, s[60:63], 0 offen offset:3584 sc1
  s_waitcnt vmcnt(20)
  ds_read_b128 a[32:35], v84 offset:49152
  ds_read_b128 a[36:39], v85 offset:49152
  ds_read_b128 a[40:43], v84 offset:51200
  ds_read_b128 a[44:47], v85 offset:51200
  s_waitcnt vmcnt(16)
  ds_read_b128 a[48:51], v86 offset:49152
  ds_read_b128 a[52:55], v87 offset:49152
  ds_read_b128 a[56:59], v86 offset:51200
  ds_read_b128 a[60:63], v87 offset:51200
  s_waitcnt vmcnt(7)
  v_max_u32 v72, v14, v15
  s_waitcnt vmcnt(6)
  v_max3_u32 v72, v72, v18, v19
  s_waitcnt vmcnt(5)
  v_max3_u32 v72, v72, v78, v79
  s_waitcnt vmcnt(4)
  v_max3_u32 v72, v72, v148, v149
  s_waitcnt vmcnt(3)
  v_max3_u32 v72, v72, v150, v151
  s_waitcnt vmcnt(2)
  v_max3_u32 v72, v72, v152, v153
  s_waitcnt vmcnt(1)
  v_max3_u32 v72, v72, v154, v155
  s_waitcnt vmcnt(0)
  v_max3_u32 v72, v72, v156, v157
  v_cmp_eq_u32 vcc, -1, v72
  s_nop 0
  s_cbranch_vccz gated_mix__spectral_gfnet__ssm_conv_s5__prompt_kernel_skip16
  s_mov_b32 s10, 0
gated_mix__spectral_gfnet__ssm_conv_s5__prompt_kernel_lb17:
  buffer_load_dwordx2 v[14:15], v73, s[60:63], 0 offen offset:0 sc1
  buffer_load_dwordx2 v[18:19], v73, s[60:63], 0 offen offset:512 sc1
  buffer_load_dwordx2 v[78:79], v73, s[60:63], 0 offen offset:1024 sc1
  buffer_load_dwordx2 v[148:149], v73, s[60:63], 0 offen offset:1536 sc1
  buffer_load_dwordx2 v[150:151], v73, s[60:63], 0 offen offset:2048 sc1
  buffer_load_dwordx2 v[152:153], v73, s[60:63], 0 offen offset:2560 sc1
  buffer_load_dwordx2 v[154:155], v73, s[60:63], 0 offen offset:3072 sc1
  buffer_load_dwordx2 v[156:157], v73, s[60:63], 0 offen offset:3584 sc1
  s_waitcnt vmcnt(0)
  v_max_u32 v72, v14, v15
  v_max3_u32 v72, v72, v18, v19
  v_max3_u32 v72, v72, v78, v79
  v_max3_u32 v72, v72, v148, v149
  v_max3_u32 v72, v72, v150, v151
  v_max3_u32 v72, v72, v152, v153
  v_max3_u32 v72, v72, v154, v155
  v_max3_u32 v72, v72, v156, v157
  v_cmp_eq_u32 vcc, -1, v72
  s_nop 0
  s_cbranch_vccz gated_mix__spectral_gfnet__ssm_conv_s5__prompt_kernel_lbout18
  s_add_u32 s10, s10, 1
  s_cmp_lt_u32 s10, 1048576
  s_cbranch_scc1 gated_mix__spectral_gfnet__ssm_conv_s5__prompt_kernel_lb17
gated_mix__spectral_gfnet__ssm_conv_s5__prompt_kernel_lbout18:
gated_mix__spectral_gfnet__ssm_conv_s5__prompt_kernel_skip16:
  ds_read_b128 a[64:67], v84 offset:32768
  ds_read_b128 a[68:71], v85 offset:32768
  ds_read_b128 a[72:75], v84 offset:34816
  ds_read_b128 a[76:79], v85 offset:34816
  s_add_u32 s12, s34, 10485760
  s_addc_u32 s13, s35, 0
  s_mov_b32 s14, 8388608
  s_mov_b32 s15, 0x20000
  v_fma_f32 v154, v76, v156, v154
  v_fma_f32 v155, v76, v157, v155
  v_fma_f32 v154, -v77, v157, v154
  v_fma_f32 v155, v77, v156, v155
  v_fma_f32 v152, v76, v154, v152
  v_fma_f32 v153, v76, v155, v153
  v_fma_f32 v152, -v77, v155, v152
  v_fma_f32 v153, v77, v154, v153
  v_fma_f32 v150, v76, v152, v150
  v_fma_f32 v151, v76, v153, v151
  v_fma_f32 v150, -v77, v153, v150
  v_fma_f32 v151, v77, v152, v151
  v_fma_f32 v148, v76, v150, v148
  v_fma_f32 v149, v76, v151, v149
  v_fma_f32 v148, -v77, v151, v148
  v_fma_f32 v149, v77, v150, v149
  v_fma_f32 v78, v76, v148, v78
  v_fma_f32 v79, v76, v149, v79
  v_fma_f32 v78, -v77, v149, v78
  v_fma_f32 v79, v77, v148, v79
  v_fma_f32 v18, v76, v78, v18
  v_fma_f32 v19, v76, v79, v19
  v_fma_f32 v18, -v77, v79, v18
  v_fma_f32 v19, v77, v78, v19
  v_fma_f32 v14, v76, v18, v14
  v_fma_f32 v15, v76, v19, v15
  v_fma_f32 v14, -v77, v19, v14
  v_fma_f32 v15, v77, v18, v15
  v_mov_b32 v18, v14
  v_mov_b32 v19, v15
  s_nop 0
  v_permlane32_swap_b32 v14, v18
  v_permlane32_swap_b32 v15, v19
  v_fma_f32 v14, v68, v18, v14
  v_fma_f32 v15, v68, v19, v15
  v_fma_f32 v14, -v69, v19, v14
  v_fma_f32 v15, v69, v18, v15
  s_cmp_lt_u32 s3, 2
  s_cbranch_scc1 gated_mix__spectral_gfnet__ssm_conv_s5__prompt_kernel_skip19
  v_fma_f32 v16, v66, v14, v16
  v_fma_f32 v17, v66, v15, v17
  v_fma_f32 v16, -v67, v15, v16
  v_fma_f32 v17, v67, v14, v17
  v_mov_b32 v14, v16
  v_mov_b32 v15, v17
gated_mix__spectral_gfnet__ssm_conv_s5__prompt_kernel_skip19:
  v_fma_f32 v12, v64, v14, v12
  v_fma_f32 v13, v64, v15, v13
  v_fma_f32 v12, -v65, v15, v12
  v_fma_f32 v13, v65, v14, v13
  s_mov_b32 exec_lo, 0
  v_mov_b32 v14, v12
  v_mov_b32 v15, v13
  s_mov_b64 exec, -1
  v_fma_f32 v8, v62, v14, v8
  v_fma_f32 v10, v62, v15, v10
  v_fma_f32 v8, -v63, v15, v8
  v_fma_f32 v10, v63, v14, v10
  v_mul_f32 v78, v70, v14
  v_mul_f32 v148, v70, v15
  v_fma_f32 v78, -v71, v15, v78
  v_fma_f32 v148, v71, v14, v148
  v_mul_f32 v79, v70, v8
  v_mul_f32 v149, v70, v10
  v_fma_f32 v79, -v71, v10, v79
  v_fma_f32 v149, v71, v8, v149
  v_pk_fma_f32 v[44:45], v[60:61], v[78:79], v[44:45] op_sel:[0,0,0] op_sel_hi:[0,1,1]
  v_pk_fma_f32 v[88:89], v[60:61], v[148:149], v[88:89] op_sel:[0,0,0] op_sel_hi:[0,1,1]
  v_pk_fma_f32 v[44:45], v[60:61], v[148:149], v[44:45] op_sel:[1,0,0] op_sel_hi:[1,1,1] neg_lo:[1,0,0] neg_hi:[1,0,0]
  v_pk_fma_f32 v[88:89], v[60:61], v[78:79], v[88:89] op_sel:[1,0,0] op_sel_hi:[1,1,1]
  v_cvt_pk_bf16_f32 v160, v44, v45
  v_cvt_pk_bf16_f32 v161, -v88, -v89
  v_pk_fma_f32 v[46:47], v[60:61], v[44:45], v[46:47] op_sel:[0,0,0] op_sel_hi:[0,1,1]
  v_pk_fma_f32 v[90:91], v[60:61], v[88:89], v[90:91] op_sel:[0,0,0] op_sel_hi:[0,1,1]
  v_pk_fma_f32 v[46:47], v[60:61], v[88:89], v[46:47] op_sel:[1,0,0] op_sel_hi:[1,1,1] neg_lo:[1,0,0] neg_hi:[1,0,0]
  v_pk_fma_f32 v[90:91], v[60:61], v[44:45], v[90:91] op_sel:[1,0,0] op_sel_hi:[1,1,1]
  v_cvt_pk_bf16_f32 v162, v46, v47
  v_cvt_pk_bf16_f32 v163, -v90, -v91
  v_pk_fma_f32 v[48:49], v[60:61], v[46:47], v[48:49] op_sel:[0,0,0] op_sel_hi:[0,1,1]
  v_pk_fma_f32 v[92:93], v[60:61], v[90:91], v[92:93] op_sel:[0,0,0] op_sel_hi:[0,1,1]
  v_pk_fma_f32 v[48:49], v[60:61], v[90:91], v[48:49] op_sel:[1,0,0] op_sel_hi:[1,1,1] neg_lo:[1,0,0] neg_hi:[1,0,0]
  v_pk_fma_f32 v[92:93], v[60:61], v[46:47], v[92:93] op_sel:[1,0,0] op_sel_hi:[1,1,1]
  v_permlane32_swap_b32 v160, v161
  v_permlane32_swap_b32 v162, v163
  s_nop 1
  v_permlane16_swap_b32 v160, v162
  v_permlane16_swap_b32 v161, v163
  buffer_store_dwordx4 v[160:163], v74, s[12:15], s6 offen sc1
  s_add_u32 s6, s6, 1048576
  s_waitcnt lgkmcnt(12)
  s_add_u32 m0, s8, 98304
  s_nop 0
  buffer_load_dwordx4 v80, s[64:67], s7 offen offset:0 lds
  buffer_load_dwordx4 v81, s[64:67], s7 offen offset:1024 lds
  v_cvt_pk_bf16_f32 v164, v48, v49
  v_cvt_pk_bf16_f32 v165, -v92, -v93
  v_pk_fma_f32 v[50:51], v[60:61], v[48:49], v[50:51] op_sel:[0,0,0] op_sel_hi:[0,1,1]
  v_pk_fma_f32 v[94:95], v[60:61], v[92:93], v[94:95] op_sel:[0,0,0] op_sel_hi:[0,1,1]
  v_pk_fma_f32 v[50:51], v[60:61], v[92:93], v[50:51] op_sel:[1,0,0] op_sel_hi:[1,1,1] neg_lo:[1,0,0] neg_hi:[1,0,0]
  v_pk_fma_f32 v[94:95], v[60:61], v[48:49], v[94:95] op_sel:[1,0,0] op_sel_hi:[1,1,1]
  v_cvt_pk_bf16_f32 v166, v50, v51
  v_cvt_pk_bf16_f32 v167, -v94, -v95
  v_pk_fma_f32 v[52:53], v[60:61], v[50:51], v[52:53] op_sel:[0,0,0] op_sel_hi:[0,1,1]
  v_pk_fma_f32 v[96:97], v[60:61], v[94:95], v[96:97] op_sel:[0,0,0] op_sel_hi:[0,1,1]
  v_pk_fma_f32 v[52:53], v[60:61], v[94:95], v[52:53] op_sel:[1,0,0] op_sel_hi:[1,1,1] neg_lo:[1,0,0] neg_hi:[1,0,0]
  v_pk_fma_f32 v[96:97], v[60:61], v[50:51], v[96:97] op_sel:[1,0,0] op_sel_hi:[1,1,1]
  v_permlane32_swap_b32 v164, v165
  v_permlane32_swap_b32 v166, v167
  s_nop 1
  v_permlane16_swap_b32 v164, v166
  v_permlane16_swap_b32 v165, v167
  buffer_store_dwordx4 v[164:167], v74, s[12:15], s6 offen sc1
  s_add_u32 s6, s6, 1048576
  buffer_load_dwordx4 v82, s[64:67], s7 offen offset:2048 lds
  buffer_load_dwordx4 v83, s[64:67], s7 offen offset:3072 lds
  s_add_u32 s7, s7, 128
  s_and_b32 s7, s7, 0x7ff
  v_cvt_pk_bf16_f32 v168, v52, v53
  v_cvt_pk_bf16_f32 v169, -v96, -v97
  v_pk_fma_f32 v[54:55], v[60:61], v[52:53], v[54:55] op_sel:[0,0,0] op_sel_hi:[0,1,1]
  v_pk_fma_f32 v[98:99], v[60:61], v[96:97], v[98:99] op_sel:[0,0,0] op_sel_hi:[0,1,1]
  v_pk_fma_f32 v[54:55], v[60:61], v[96:97], v[54:55] op_sel:[1,0,0] op_sel_hi:[1,1,1] neg_lo:[1,0,0] neg_hi:[1,0,0]
  v_pk_fma_f32 v[98:99], v[60:61], v[52:53], v[98:99] op_sel:[1,0,0] op_sel_hi:[1,1,1]
  v_cvt_pk_bf16_f32 v170, v54, v55
  v_cvt_pk_bf16_f32 v171, -v98, -v99
  v_pk_fma_f32 v[56:57], v[60:61], v[54:55], v[56:57] op_sel:[0,0,0] op_sel_hi:[0,1,1]
  v_pk_fma_f32 v[100:101], v[60:61], v[98:99], v[100:101] op_sel:[0,0,0] op_sel_hi:[0,1,1]
  v_pk_fma_f32 v[56:57], v[60:61], v[98:99], v[56:57] op_sel:[1,0,0] op_sel_hi:[1,1,1] neg_lo:[1,0,0] neg_hi:[1,0,0]
  v_pk_fma_f32 v[100:101], v[60:61], v[54:55], v[100:101] op_sel:[1,0,0] op_sel_hi:[1,1,1]
  v_permlane32_swap_b32 v168, v169
  v_permlane32_swap_b32 v170, v171
  s_nop 1
  v_permlane16_swap_b32 v168, v170
  v_permlane16_swap_b32 v169, v171
  buffer_store_dwordx4 v[168:171], v74, s[12:15], s6 offen sc1
  s_add_u32 s6, s6, 1048576
  s_waitcnt lgkmcnt(8)
  s_add_u32 m0, s8, 49152
  s_nop 0
  buffer_load_dwordx4 v80, s[64:67], s7 offen offset:0 lds
  buffer_load_dwordx4 v81, s[64:67], s7 offen offset:1024 lds
  v_cvt_pk_bf16_f32 v160, v56, v57
  v_cvt_pk_bf16_f32 v161, -v100, -v101
  v_pk_fma_f32 v[58:59], v[60:61], v[56:57], v[58:59] op_sel:[0,0,0] op_sel_hi:[0,1,1]
  v_pk_fma_f32 v[102:103], v[60:61], v[100:101], v[102:103] op_sel:[0,0,0] op_sel_hi:[0,1,1]
  v_pk_fma_f32 v[58:59], v[60:61], v[100:101], v[58:59] op_sel:[1,0,0] op_sel_hi:[1,1,1] neg_lo:[1,0,0] neg_hi:[1,0,0]
  v_pk_fma_f32 v[102:103], v[60:61], v[56:57], v[102:103] op_sel:[1,0,0] op_sel_hi:[1,1,1]
  v_cvt_pk_bf16_f32 v162, v58, v59
  v_cvt_pk_bf16_f32 v163, -v102, -v103
  v_pk_fma_f32 v[104:105], v[60:61], v[58:59], v[104:105] op_sel:[0,0,0] op_sel_hi:[0,1,1]
  v_pk_fma_f32 v[120:121], v[60:61], v[102:103], v[120:121] op_sel:[0,0,0] op_sel_hi:[0,1,1]
  v_pk_fma_f32 v[104:105], v[60:61], v[102:103], v[104:105] op_sel:[1,0,0] op_sel_hi:[1,1,1] neg_lo:[1,0,0] neg_hi:[1,0,0]
  v_pk_fma_f32 v[120:121], v[60:61], v[58:59], v[120:121] op_sel:[1,0,0] op_sel_hi:[1,1,1]
  v_permlane32_swap_b32 v160, v161
  v_permlane32_swap_b32 v162, v163
  s_nop 1
  v_permlane16_swap_b32 v160, v162
  v_permlane16_swap_b32 v161, v163
  buffer_store_dwordx4 v[160:163], v74, s[12:15], s6 offen sc1
  s_add_u32 s6, s6, 1048576
  buffer_load_dwordx4 v82, s[64:67], s7 offen offset:2048 lds
  buffer_load_dwordx4 v83, s[64:67], s7 offen offset:3072 lds
  s_add_u32 s7, s7, 128
  s_and_b32 s7, s7, 0x7ff
  v_cvt_pk_bf16_f32 v164, v104, v105
  v_cvt_pk_bf16_f32 v165, -v120, -v121
  v_pk_fma_f32 v[106:107], v[60:61], v[104:105], v[106:107] op_sel:[0,0,0] op_sel_hi:[0,1,1]
  v_pk_fma_f32 v[122:123], v[60:61], v[120:121], v[122:123] op_sel:[0,0,0] op_sel_hi:[0,1,1]
  v_pk_fma_f32 v[106:107], v[60:61], v[120:121], v[106:107] op_sel:[1,0,0] op_sel_hi:[1,1,1] neg_lo:[1,0,0] neg_hi:[1,0,0]
  v_pk_fma_f32 v[122:123], v[60:61], v[104:105], v[122:123] op_sel:[1,0,0] op_sel_hi:[1,1,1]
  v_cvt_pk_bf16_f32 v166, v106, v107
  v_cvt_pk_bf16_f32 v167, -v122, -v123
  v_pk_fma_f32 v[108:109], v[60:61], v[106:107], v[108:109] op_sel:[0,0,0] op_sel_hi:[0,1,1]
  v_pk_fma_f32 v[124:125], v[60:61], v[122:123], v[124:125] op_sel:[0,0,0] op_sel_hi:[0,1,1]
  v_pk_fma_f32 v[108:109], v[60:61], v[122:123], v[108:109] op_sel:[1,0,0] op_sel_hi:[1,1,1] neg_lo:[1,0,0] neg_hi:[1,0,0]
  v_pk_fma_f32 v[124:125], v[60:61], v[106:107], v[124:125] op_sel:[1,0,0] op_sel_hi:[1,1,1]
  v_permlane32_swap_b32 v164, v165
  v_permlane32_swap_b32 v166, v167
  s_nop 1
  v_permlane16_swap_b32 v164, v166
  v_permlane16_swap_b32 v165, v167
  buffer_store_dwordx4 v[164:167], v74, s[12:15], s6 offen sc1
  s_add_u32 s6, s6, 1048576
  s_waitcnt lgkmcnt(4)
  s_add_u32 m0, s8, 114688
  s_nop 0
  buffer_load_dwordx4 v80, s[64:67], s7 offen offset:0 lds
  buffer_load_dwordx4 v81, s[64:67], s7 offen offset:1024 lds
  v_cvt_pk_bf16_f32 v168, v108, v109
  v_cvt_pk_bf16_f32 v169, -v124, -v125
  v_pk_fma_f32 v[110:111], v[60:61], v[108:109], v[110:111] op_sel:[0,0,0] op_sel_hi:[0,1,1]
  v_pk_fma_f32 v[126:127], v[60:61], v[124:125], v[126:127] op_sel:[0,0,0] op_sel_hi:[0,1,1]
  v_pk_fma_f32 v[110:111], v[60:61], v[124:125], v[110:111] op_sel:[1,0,0] op_sel_hi:[1,1,1] neg_lo:[1,0,0] neg_hi:[1,0,0]
  v_pk_fma_f32 v[126:127], v[60:61], v[108:109], v[126:127] op_sel:[1,0,0] op_sel_hi:[1,1,1]
  v_cvt_pk_bf16_f32 v170, v110, v111
  v_cvt_pk_bf16_f32 v171, -v126, -v127
  v_pk_fma_f32 v[112:113], v[60:61], v[110:111], v[112:113] op_sel:[0,0,0] op_sel_hi:[0,1,1]
  v_pk_fma_f32 v[128:129], v[60:61], v[126:127], v[128:129] op_sel:[0,0,0] op_sel_hi:[0,1,1]
  v_pk_fma_f32 v[112:113], v[60:61], v[126:127], v[112:113] op_sel:[1,0,0] op_sel_hi:[1,1,1] neg_lo:[1,0,0] neg_hi:[1,0,0]
  v_pk_fma_f32 v[128:129], v[60:61], v[110:111], v[128:129] op_sel:[1,0,0] op_sel_hi:[1,1,1]
  v_permlane32_swap_b32 v168, v169
  v_permlane32_swap_b32 v170, v171
  s_nop 1
  v_permlane16_swap_b32 v168, v170
  v_permlane16_swap_b32 v169, v171
  buffer_store_dwordx4 v[168:171], v74, s[12:15], s6 offen sc1
  s_add_u32 s6, s6, 1048576
  buffer_load_dwordx4 v82, s[64:67], s7 offen offset:2048 lds
  buffer_load_dwordx4 v83, s[64:67], s7 offen offset:3072 lds
  s_add_u32 s7, s7, 128
  s_and_b32 s7, s7, 0x7ff
  v_cvt_pk_bf16_f32 v160, v112, v113
  v_cvt_pk_bf16_f32 v161, -v128, -v129
  v_pk_fma_f32 v[114:115], v[60:61], v[112:113], v[114:115] op_sel:[0,0,0] op_sel_hi:[0,1,1]
  v_pk_fma_f32 v[130:131], v[60:61], v[128:129], v[130:131] op_sel:[0,0,0] op_sel_hi:[0,1,1]
  v_pk_fma_f32 v[114:115], v[60:61], v[128:129], v[114:115] op_sel:[1,0,0] op_sel_hi:[1,1,1] neg_lo:[1,0,0] neg_hi:[1,0,0]
  v_pk_fma_f32 v[130:131], v[60:61], v[112:113], v[130:131] op_sel:[1,0,0] op_sel_hi:[1,1,1]
  v_cvt_pk_bf16_f32 v162, v114, v115
  v_cvt_pk_bf16_f32 v163, -v130, -v131
  v_pk_fma_f32 v[116:117], v[60:61], v[114:115], v[116:117] op_sel:[0,0,0] op_sel_hi:[0,1,1]
  v_pk_fma_f32 v[132:133], v[60:61], v[130:131], v[132:133] op_sel:[0,0,0] op_sel_hi:[0,1,1]
  v_pk_fma_f32 v[116:117], v[60:61], v[130:131], v[116:117] op_sel:[1,0,0] op_sel_hi:[1,1,1] neg_lo:[1,0,0] neg_hi:[1,0,0]
  v_pk_fma_f32 v[132:133], v[60:61], v[114:115], v[132:133] op_sel:[1,0,0] op_sel_hi:[1,1,1]
  v_permlane32_swap_b32 v160, v161
  v_permlane32_swap_b32 v162, v163
  s_nop 1
  v_permlane16_swap_b32 v160, v162
  v_permlane16_swap_b32 v161, v163
  buffer_store_dwordx4 v[160:163], v74, s[12:15], s6 offen sc1
  s_add_u32 s6, s6, 1048576
  s_waitcnt lgkmcnt(0)
  s_add_u32 m0, s8, 32768
  s_nop 0
  buffer_load_dwordx4 v80, s[64:67], s7 offen offset:0 lds
  buffer_load_dwordx4 v81, s[64:67], s7 offen offset:1024 lds
  v_cvt_pk_bf16_f32 v164, v116, v117
  v_cvt_pk_bf16_f32 v165, -v132, -v133
  v_pk_fma_f32 v[118:119], v[60:61], v[116:117], v[118:119] op_sel:[0,0,0] op_sel_hi:[0,1,1]
  v_pk_fma_f32 v[134:135], v[60:61], v[132:133], v[134:135] op_sel:[0,0,0] op_sel_hi:[0,1,1]
  v_pk_fma_f32 v[118:119], v[60:61], v[132:133], v[118:119] op_sel:[1,0,0] op_sel_hi:[1,1,1] neg_lo:[1,0,0] neg_hi:[1,0,0]
  v_pk_fma_f32 v[134:135], v[60:61], v[116:117], v[134:135] op_sel:[1,0,0] op_sel_hi:[1,1,1]
  v_cvt_pk_bf16_f32 v166, v118, v119
  v_cvt_pk_bf16_f32 v167, -v134, -v135
  v_permlane32_swap_b32 v164, v165
  s_nop 0
  v_permlane32_swap_b32 v166, v167
  s_nop 1
  v_permlane16_swap_b32 v164, v166
  v_permlane16_swap_b32 v165, v167
  buffer_store_dwordx4 v[164:167], v74, s[12:15], s6 offen sc1
  buffer_load_dwordx4 v82, s[64:67], s7 offen offset:2048 lds
  buffer_load_dwordx4 v83, s[64:67], s7 offen offset:3072 lds
  s_add_u32 s7, s7, 128
  s_and_b32 s7, s7, 0x7ff
  v_lshlrev_b32 v8, 7, v0
  s_lshr_b32 s11, s3, 1
  s_xor_b32 s11, s11, s3
  s_lshl_b32 s11, s11, 13
  s_lshl_b32 s6, s38, 19
  s_add_u32 s11, s11, s6
  v_lshl_add_u32 v10, v4, 4, s11
  v_add_u32 v11, 4096, v10
  s_lshl_b32 s6, s38, 15
  s_lshl_b32 s10, s3, 13
  v_and_b32 v16, 3, v4
  v_and_b32 v17, 2, v6
  v_xor_b32 v17, v17, v16
  v_lshlrev_b32 v16, 9, v16
  v_lshl_or_b32 v16, v17, 6, v16
  v_bfe_u32 v17, v4, 2, 2
  v_lshl_or_b32 v16, v17, 4, v16
  v_and_b32 v17, 1, v6
  v_lshl_or_b32 v16, v17, 3, v16
  s_and_b32 s11, s3, 1
  s_lshl_b32 s11, s11, 14
  v_add_u32 v12, s11, v16
  v_xor_b32 v13, 64, v12
  v_add_u32 v14, 0x10000, v12
  v_add_u32 v15, 0x10000, v13
  v_mov_b32 v16, v20
  v_mov_b32 v17, v136
  v_mov_b32 v18, v140
  v_mov_b32 v19, v144
  v_mov_b32 v44, v21
  v_mov_b32 v45, v137
  v_mov_b32 v46, v141
  v_mov_b32 v47, v145
  v_mov_b32 v48, v22
  v_mov_b32 v49, v138
  v_mov_b32 v50, v142
  v_mov_b32 v51, v146
  v_mov_b32 v52, v23
  v_mov_b32 v53, v139
  v_mov_b32 v54, v143
  v_mov_b32 v55, v147
  v_mfma_f32_16x16x32_bf16 v[56:59], v[16:19], v[180:183], 0
  v_mfma_f32_16x16x32_bf16 v[60:63], v[16:19], v[184:187], 0
  v_mfma_f32_16x16x32_bf16 v[64:67], v[44:47], v[180:183], 0
  v_mfma_f32_16x16x32_bf16 v[68:71], v[44:47], v[184:187], 0
  v_mfma_f32_16x16x32_bf16 v[72:75], v[48:51], v[180:183], 0
  v_mfma_f32_16x16x32_bf16 v[76:79], v[48:51], v[184:187], 0
  v_mfma_f32_16x16x32_bf16 v[88:91], v[52:55], v[180:183], 0
  v_mfma_f32_16x16x32_bf16 v[92:95], v[52:55], v[184:187], 0
  v_and_b32 v104, 7, v5
  v_lshlrev_b32 v100, 2, v6
  v_xor_b32 v104, v104, v100
  v_lshlrev_b32 v104, 4, v104
  v_lshl_or_b32 v104, v5, 10, v104
  s_lshl_b32 s11, s3, 8
  s_add_u32 s11, s11, 131072
  v_add_u32 v104, s11, v104
  v_xor_b32 v105, 16, v104
  v_xor_b32 v106, 32, v104
  v_xor_b32 v107, 48, v104
  v_cvt_pk_bf16_f32 v16, v56, v60
  v_cvt_pk_bf16_f32 v17, v57, v61
  v_cvt_pk_bf16_f32 v18, v58, v62
  v_cvt_pk_bf16_f32 v19, v59, v63
  ds_write_b128 v104, v[16:19]
  v_cvt_pk_bf16_f32 v44, v64, v68
  v_cvt_pk_bf16_f32 v45, v65, v69
  v_cvt_pk_bf16_f32 v46, v66, v70
  v_cvt_pk_bf16_f32 v47, v67, v71
  ds_write_b128 v105, v[44:47]
  v_cvt_pk_bf16_f32 v48, v72, v76
  v_cvt_pk_bf16_f32 v49, v73, v77
  v_cvt_pk_bf16_f32 v50, v74, v78
  v_cvt_pk_bf16_f32 v51, v75, v79
  ds_write_b128 v106, v[48:51]
  v_cvt_pk_bf16_f32 v52, v88, v92
  v_cvt_pk_bf16_f32 v53, v89, v93
  v_cvt_pk_bf16_f32 v54, v90, v94
  v_cvt_pk_bf16_f32 v55, v91, v95
  ds_write_b128 v107, v[52:55]
  s_and_b32 s11, s3, 1
  s_lshl_b32 s11, s11, 2
  v_xor_b32 v100, s11, v4
  s_lshl_b32 s11, s3, 12
  s_add_u32 s11, s11, 131072
  v_lshl_add_u32 v104, v100, 4, s11
  v_xor_b32 v105, 16, v104
  v_xor_b32 v106, 32, v104
  v_xor_b32 v107, 48, v104
  v_lshlrev_b32 v101, 8, v6
  v_lshl_add_u32 v101, v5, 2, v101
  v_add_u32 v101, s9, v101
  v_sub_u32 v103, 832, v101
  v_cmp_lt_u32 s[16:17], 1, v6
  s_nop 1
  v_cndmask_b32 v101, v101, v103, s[16:17]
  v_lshlrev_b32 v101, 1, v101
  v_lshrrev_b32 v102, 1, v6
  v_lshlrev_b32 v102, 31, v102
  s_and_b32 s20, s72, 15
  s_and_b32 s21, s73, 15
  s_add_u32 s21, s21, 2048
  s_cmp_eq_u32 s36, 1
  s_cselect_b32 s21, s20, s21
  v_mov_b32 v153, s20
  v_mov_b32 v103, s21
  v_cndmask_b32 v103, v153, v103, s[16:17]
  v_add_u32 v103, v103, v101
  v_add_u32 v152, 384, v103
  v_and_b32 v153, 1024, v152
  v_cmp_ne_u32 vcc, 0, v153
  s_lshl_b32 s22, s3, 8
  s_add_u32 s22, s22, 146432
  v_add_u32 v153, s22, v152
  s_add_u32 s22, s29, 0
  v_add_u32 v103, s22, v103
  v_add_u32 v152, s22, v152
  v_cndmask_b32 v152, v152, v153, vcc
  ds_read_u16_d16_hi v108, v103 offset:0
  ds_read_u16_d16_hi v112, v103 offset:1024
  ds_read_u16_d16_hi v109, v103 offset:128
  ds_read_u16_d16_hi v113, v103 offset:1152
  ds_read_u16_d16_hi v110, v103 offset:256
  ds_read_u16_d16_hi v114, v103 offset:1280
  ds_read_u16_d16_hi v111, v152 offset:0
  ds_read_u16_d16_hi v115, v152 offset:1024
  s_cmp_lg_u32 s9, 0
  s_cbranch_scc1 gated_mix__spectral_gfnet__ssm_conv_s5__prompt_kernel_skip20
  s_add_u32 s21, s21, s22
  s_lshl_b32 s22, s3, 8
  s_add_u32 s22, s22, 147456
  s_add_u32 s20, s20, s22
  v_mov_b32 v153, s21
  v_mov_b32 v103, s20
  v_cndmask_b32 v153, v153, v103, s[16:17]
  ds_read_u16_d16_hi v103, v153
  ds_read_u16_d16_hi v152, v153 offset:1024
  s_mov_b32 exec_lo, 1
  s_mov_b32 exec_hi, 0
  s_waitcnt lgkmcnt(1)
  v_add_f32 v108, v108, v103
  s_waitcnt lgkmcnt(0)
  v_sub_f32 v112, v112, v152
  s_waitcnt lgkmcnt(7)
  v_mul_f32 v108, 0.5, v108
  s_waitcnt lgkmcnt(6)
  v_mul_f32 v112, 0.5, v112
  s_mov_b32 exec_lo, 0
  s_mov_b32 exec_hi, 1
  s_waitcnt lgkmcnt(1)
  v_add_f32 v111, v111, v103
  s_waitcnt lgkmcnt(0)
  v_sub_f32 v115, v115, v152
  s_waitcnt lgkmcnt(1)
  v_mul_f32 v111, 0.5, v111
  s_waitcnt lgkmcnt(0)
  v_mul_f32 v115, 0.5, v115
  s_mov_b64 exec, -1
gated_mix__spectral_gfnet__ssm_conv_s5__prompt_kernel_skip20:
  s_and_b32 s20, s74, 15
  s_and_b32 s21, s75, 15
  s_add_u32 s21, s21, 2048
  v_mov_b32 v153, s20
  v_mov_b32 v103, s21
  v_cndmask_b32 v103, v153, v103, s[16:17]
  v_add_u32 v103, v103, v101
  v_add_u32 v152, 384, v103
  v_and_b32 v153, 1024, v152
  v_cmp_ne_u32 vcc, 0, v153
  s_lshl_b32 s22, s3, 8
  s_add_u32 s22, s22, 150528
  v_add_u32 v153, s22, v152
  s_add_u32 s22, s29, 65536
  v_add_u32 v103, s22, v103
  v_add_u32 v152, s22, v152
  v_cndmask_b32 v152, v152, v153, vcc
  ds_read_u16_d16_hi v116, v103 offset:0
  ds_read_u16_d16_hi v120, v103 offset:1024
  ds_read_u16_d16_hi v117, v103 offset:128
  ds_read_u16_d16_hi v121, v103 offset:1152
  ds_read_u16_d16_hi v118, v103 offset:256
  ds_read_u16_d16_hi v122, v103 offset:1280
  ds_read_u16_d16_hi v119, v152 offset:0
  ds_read_u16_d16_hi v123, v152 offset:1024
  s_cmp_lg_u32 s9, 0
  s_cbranch_scc1 gated_mix__spectral_gfnet__ssm_conv_s5__prompt_kernel_skip21
  s_add_u32 s21, s21, s22
  s_lshl_b32 s22, s3, 8
  s_add_u32 s22, s22, 151552
  s_add_u32 s20, s20, s22
  v_mov_b32 v153, s21
  v_mov_b32 v103, s20
  v_cndmask_b32 v153, v153, v103, s[16:17]
  ds_read_u16_d16_hi v103, v153
  ds_read_u16_d16_hi v152, v153 offset:1024
  s_mov_b32 exec_lo, 1
  s_mov_b32 exec_hi, 0
  s_waitcnt lgkmcnt(1)
  v_add_f32 v116, v116, v103
  s_waitcnt lgkmcnt(0)
  v_sub_f32 v120, v120, v152
  s_waitcnt lgkmcnt(7)
  v_mul_f32 v116, 0.5, v116
  s_waitcnt lgkmcnt(6)
  v_mul_f32 v120, 0.5, v120
  s_mov_b32 exec_lo, 0
  s_mov_b32 exec_hi, 1
  s_waitcnt lgkmcnt(1)
  v_add_f32 v119, v119, v103
  s_waitcnt lgkmcnt(0)
  v_sub_f32 v123, v123, v152
  s_waitcnt lgkmcnt(1)
  v_mul_f32 v119, 0.5, v119
  s_waitcnt lgkmcnt(0)
  v_mul_f32 v123, 0.5, v123
  s_mov_b64 exec, -1
gated_mix__spectral_gfnet__ssm_conv_s5__prompt_kernel_skip21:
  s_and_b32 s20, s76, 15
  s_and_b32 s21, s77, 15
  s_add_u32 s21, s21, 2048
  v_mov_b32 v153, s20
  v_mov_b32 v103, s21
  v_cndmask_b32 v103, v153, v103, s[16:17]
  v_add_u32 v103, v103, v101
  v_add_u32 v152, 384, v103
  v_and_b32 v153, 1024, v152
  v_cmp_ne_u32 vcc, 0, v153
  s_lshl_b32 s22, s3, 8
  s_add_u32 s22, s22, 154624
  v_add_u32 v153, s22, v152
  s_add_u32 s22, s29, 16384
  v_add_u32 v103, s22, v103
  v_add_u32 v152, s22, v152
  v_cndmask_b32 v152, v152, v153, vcc
  ds_read_u16_d16_hi v124, v103 offset:0
  ds_read_u16_d16_hi v128, v103 offset:1024
  ds_read_u16_d16_hi v125, v103 offset:128
  ds_read_u16_d16_hi v129, v103 offset:1152
  ds_read_u16_d16_hi v126, v103 offset:256
  ds_read_u16_d16_hi v130, v103 offset:1280
  ds_read_u16_d16_hi v127, v152 offset:0
  ds_read_u16_d16_hi v131, v152 offset:1024
  s_cmp_lg_u32 s9, 0
  s_cbranch_scc1 gated_mix__spectral_gfnet__ssm_conv_s5__prompt_kernel_skip22
  s_add_u32 s21, s21, s22
  s_lshl_b32 s22, s3, 8
  s_add_u32 s22, s22, 155648
  s_add_u32 s20, s20, s22
  v_mov_b32 v153, s21
  v_mov_b32 v103, s20
  v_cndmask_b32 v153, v153, v103, s[16:17]
  ds_read_u16_d16_hi v103, v153
  ds_read_u16_d16_hi v152, v153 offset:1024
  s_mov_b32 exec_lo, 1
  s_mov_b32 exec_hi, 0
  s_waitcnt lgkmcnt(1)
  v_add_f32 v124, v124, v103
  s_waitcnt lgkmcnt(0)
  v_sub_f32 v128, v128, v152
  s_waitcnt lgkmcnt(7)
  v_mul_f32 v124, 0.5, v124
  s_waitcnt lgkmcnt(6)
  v_mul_f32 v128, 0.5, v128
  s_mov_b32 exec_lo, 0
  s_mov_b32 exec_hi, 1
  s_waitcnt lgkmcnt(1)
  v_add_f32 v127, v127, v103
  s_waitcnt lgkmcnt(0)
  v_sub_f32 v131, v131, v152
  s_waitcnt lgkmcnt(1)
  v_mul_f32 v127, 0.5, v127
  s_waitcnt lgkmcnt(0)
  v_mul_f32 v131, 0.5, v131
  s_mov_b64 exec, -1
gated_mix__spectral_gfnet__ssm_conv_s5__prompt_kernel_skip22:
  s_and_b32 s20, s78, 15
  s_and_b32 s21, s79, 15
  s_add_u32 s21, s21, 2048
  v_mov_b32 v153, s20
  v_mov_b32 v103, s21
  v_cndmask_b32 v103, v153, v103, s[16:17]
  v_add_u32 v103, v103, v101
  v_add_u32 v152, 384, v103
  v_and_b32 v153, 1024, v152
  v_cmp_ne_u32 vcc, 0, v153
  s_lshl_b32 s22, s3, 8
  s_add_u32 s22, s22, 158720
  v_add_u32 v153, s22, v152
  s_add_u32 s22, s29, 81920
  v_add_u32 v103, s22, v103
  v_add_u32 v152, s22, v152
  v_cndmask_b32 v152, v152, v153, vcc
  ds_read_u16_d16_hi v132, v103 offset:0
  ds_read_u16_d16_hi v148, v103 offset:1024
  ds_read_u16_d16_hi v133, v103 offset:128
  ds_read_u16_d16_hi v149, v103 offset:1152
  ds_read_u16_d16_hi v134, v103 offset:256
  ds_read_u16_d16_hi v150, v103 offset:1280
  ds_read_u16_d16_hi v135, v152 offset:0
  ds_read_u16_d16_hi v151, v152 offset:1024
  s_cmp_lg_u32 s9, 0
  s_cbranch_scc1 gated_mix__spectral_gfnet__ssm_conv_s5__prompt_kernel_skip23
  s_add_u32 s21, s21, s22
  s_lshl_b32 s22, s3, 8
  s_add_u32 s22, s22, 159744
  s_add_u32 s20, s20, s22
  v_mov_b32 v153, s21
  v_mov_b32 v103, s20
  v_cndmask_b32 v153, v153, v103, s[16:17]
  ds_read_u16_d16_hi v103, v153
  ds_read_u16_d16_hi v152, v153 offset:1024
  s_mov_b32 exec_lo, 1
  s_mov_b32 exec_hi, 0
  s_waitcnt lgkmcnt(1)
  v_add_f32 v132, v132, v103
  s_waitcnt lgkmcnt(0)
  v_sub_f32 v148, v148, v152
  s_waitcnt lgkmcnt(7)
  v_mul_f32 v132, 0.5, v132
  s_waitcnt lgkmcnt(6)
  v_mul_f32 v148, 0.5, v148
  s_mov_b32 exec_lo, 0
  s_mov_b32 exec_hi, 1
  s_waitcnt lgkmcnt(1)
  v_add_f32 v135, v135, v103
  s_waitcnt lgkmcnt(0)
  v_sub_f32 v151, v151, v152
  s_waitcnt lgkmcnt(1)
  v_mul_f32 v135, 0.5, v135
  s_waitcnt lgkmcnt(0)
  v_mul_f32 v151, 0.5, v151
  s_mov_b64 exec, -1
gated_mix__spectral_gfnet__ssm_conv_s5__prompt_kernel_skip23:
  s_cmp_eq_u32 s19, 0
  s_cbranch_scc1 gated_mix__spectral_gfnet__ssm_conv_s5__prompt_kernel_skip24
  s_and_b32 s20, s72, 15
  s_and_b32 s21, s73, 15
  s_add_u32 s21, s21, 2048
  s_mov_b32 s20, s21
  v_mov_b32 v153, s20
  v_mov_b32 v103, s21
  v_cndmask_b32 v103, v153, v103, s[16:17]
  v_add_u32 v103, v103, v101
  v_add_u32 v152, 384, v103
  v_and_b32 v153, 1024, v152
  v_cmp_ne_u32 vcc, 0, v153
  s_lshl_b32 s22, s3, 8
  s_add_u32 s22, s22, 146432
  v_add_u32 v153, s22, v152
  s_add_u32 s22, s29, 0
  v_add_u32 v103, s22, v103
  v_add_u32 v152, s22, v152
  v_cndmask_b32 v152, v152, v153, vcc
  ds_read_u16_d16_hi v20, v103 offset:0
  ds_read_u16_d16_hi v136, v103 offset:1024
  ds_read_u16_d16_hi v21, v103 offset:128
  ds_read_u16_d16_hi v137, v103 offset:1152
  ds_read_u16_d16_hi v22, v103 offset:256
  ds_read_u16_d16_hi v138, v103 offset:1280
  ds_read_u16_d16_hi v23, v152 offset:0
  ds_read_u16_d16_hi v139, v152 offset:1024
  s_cmp_lg_u32 s9, 0
  s_cbranch_scc1 gated_mix__spectral_gfnet__ssm_conv_s5__prompt_kernel_skip25
  s_add_u32 s21, s21, s22
  s_lshl_b32 s22, s3, 8
  s_add_u32 s22, s22, 147456
  s_add_u32 s20, s20, s22
  v_mov_b32 v153, s21
  v_mov_b32 v103, s20
  v_cndmask_b32 v153, v153, v103, s[16:17]
  ds_read_u16_d16_hi v103, v153
  ds_read_u16_d16_hi v152, v153 offset:1024
  s_mov_b32 exec_lo, 1
  s_mov_b32 exec_hi, 0
  s_waitcnt lgkmcnt(1)
  v_add_f32 v20, v20, v103
  s_waitcnt lgkmcnt(0)
  v_sub_f32 v136, v136, v152
  s_waitcnt lgkmcnt(0)
  v_mul_f32 v20, 0.5, v20
  s_waitcnt lgkmcnt(0)
  v_mul_f32 v136, 0.5, v136
  s_mov_b32 exec_lo, 0
  s_mov_b32 exec_hi, 1
  s_waitcnt lgkmcnt(0)
  v_add_f32 v23, v23, v103
  s_waitcnt lgkmcnt(0)
  v_sub_f32 v139, v139, v152
  s_waitcnt lgkmcnt(0)
  v_mul_f32 v23, 0.5, v23
  s_waitcnt lgkmcnt(0)
  v_mul_f32 v139, 0.5, v139
  s_mov_b64 exec, -1
gated_mix__spectral_gfnet__ssm_conv_s5__prompt_kernel_skip25:
  s_waitcnt lgkmcnt(0)
  v_xor_b32 v136, v102, v136
  s_waitcnt lgkmcnt(0)
  v_xor_b32 v137, v102, v137
  s_waitcnt lgkmcnt(0)
  v_xor_b32 v138, v102, v138
  s_waitcnt lgkmcnt(0)
  v_xor_b32 v139, v102, v139
gated_mix__spectral_gfnet__ssm_conv_s5__prompt_kernel_skip24:
  s_waitcnt lgkmcnt(15)
  v_xor_b32 v112, v102, v112
  s_waitcnt lgkmcnt(15)
  v_xor_b32 v113, v102, v113
  s_waitcnt lgkmcnt(15)
  v_xor_b32 v114, v102, v114
  s_waitcnt lgkmcnt(15)
  v_xor_b32 v115, v102, v115
  s_waitcnt lgkmcnt(15)
  v_xor_b32 v120, v102, v120
  s_waitcnt lgkmcnt(15)
  v_xor_b32 v121, v102, v121
  s_waitcnt lgkmcnt(15)
  v_xor_b32 v122, v102, v122
  s_waitcnt lgkmcnt(15)
  v_xor_b32 v123, v102, v123
  s_waitcnt lgkmcnt(14)
  v_xor_b32 v128, v102, v128
  s_waitcnt lgkmcnt(12)
  v_xor_b32 v129, v102, v129
  s_waitcnt lgkmcnt(10)
  v_xor_b32 v130, v102, v130
  s_waitcnt lgkmcnt(8)
  v_xor_b32 v131, v102, v131
  s_waitcnt lgkmcnt(6)
  v_xor_b32 v148, v102, v148
  s_waitcnt lgkmcnt(4)
  v_xor_b32 v149, v102, v149
  s_waitcnt lgkmcnt(2)
  v_xor_b32 v150, v102, v150
  s_waitcnt lgkmcnt(0)
  v_xor_b32 v151, v102, v151
  s_waitcnt vmcnt(2)
  s_waitcnt lgkmcnt(0)
  s_barrier
  ds_read_b128 v[16:19], v104 offset:0
  ds_read_b128 v[44:47], v105 offset:1024
  ds_read_b128 v[48:51], v106 offset:2048
  ds_read_b128 v[52:55], v107 offset:3072
  s_cmp_lg_u32 s3, 0
  s_cbranch_scc1 gated_mix__spectral_gfnet__ssm_conv_s5__prompt_kernel_skip26
  s_mov_b64 exec, 1
  buffer_store_dword v7, v25, s[48:51], s5 offen sc1
  s_mov_b64 exec, -1
gated_mix__spectral_gfnet__ssm_conv_s5__prompt_kernel_skip26:
  ds_read_b128 a[80:83], v86 offset:32768
  ds_read_b128 a[84:87], v87 offset:32768
  ds_read_b128 a[88:91], v86 offset:34816
  ds_read_b128 a[92:95], v87 offset:34816
  ds_read_b128 a[96:99], v84 offset:49152
  ds_read_b128 a[100:103], v85 offset:49152
  ds_read_b128 a[104:107], v84 offset:51200
  ds_read_b128 a[108:111], v85 offset:51200
  ds_read_b128 a[112:115], v86 offset:49152
  ds_read_b128 a[116:119], v87 offset:49152
  ds_read_b128 a[120:123], v86 offset:51200
  ds_read_b128 a[124:127], v87 offset:51200
  s_waitcnt vmcnt(0)
  ds_read_b128 a[128:131], v84 offset:32768
  ds_read_b128 a[132:135], v85 offset:32768
  ds_read_b128 a[136:139], v84 offset:34816
  ds_read_b128 a[140:143], v85 offset:34816
  s_waitcnt lgkmcnt(15)
  v_mfma_f32_16x16x32_bf16 v[56:59], v[16:19], v[176:179], 0
  v_mfma_f32_16x16x32_bf16 v[60:63], v[16:19], v[196:199], 0
  s_add_u32 m0, s8, 16384
  s_nop 0
  buffer_load_dwordx4 v80, s[64:67], s7 offen offset:0 lds
  buffer_load_dwordx4 v81, s[64:67], s7 offen offset:1024 lds
  s_waitcnt lgkmcnt(15)
  v_mfma_f32_16x16x32_bf16 v[64:67], v[44:47], v[176:179], 0
  v_mfma_f32_16x16x32_bf16 v[68:71], v[44:47], v[196:199], 0
  buffer_load_dwordx4 v82, s[64:67], s7 offen offset:2048 lds
  buffer_load_dwordx4 v83, s[64:67], s7 offen offset:3072 lds
  s_add_u32 s7, s7, 128
  s_and_b32 s7, s7, 0x7ff
  s_waitcnt lgkmcnt(15)
  v_mfma_f32_16x16x32_bf16 v[72:75], v[48:51], v[176:179], 0
  v_mfma_f32_16x16x32_bf16 v[76:79], v[48:51], v[196:199], 0
  s_waitcnt lgkmcnt(0)
  s_add_u32 m0, s8, 32768
  s_nop 0
  buffer_load_dwordx4 v80, s[64:67], s7 offen offset:0 lds
  buffer_load_dwordx4 v81, s[64:67], s7 offen offset:1024 lds
  v_mfma_f32_16x16x32_bf16 v[88:91], v[52:55], v[176:179], 0
  v_mfma_f32_16x16x32_bf16 v[92:95], v[52:55], v[196:199], 0
  buffer_load_dwordx4 v82, s[64:67], s7 offen offset:2048 lds
  buffer_load_dwordx4 v83, s[64:67], s7 offen offset:3072 lds
  s_add_u32 s7, s7, 128
  s_and_b32 s7, s7, 0x7ff
  v_pk_mul_f32 v[96:97], v[56:57], v[200:201]
  v_pk_mul_f32 v[98:99], v[60:61], v[200:201]
  v_pk_fma_f32 v[96:97], v[60:61], v[204:205], v[96:97]
  v_pk_fma_f32 v[98:99], v[56:57], v[204:205], v[98:99] neg_lo:[0,1,0] neg_hi:[0,1,0]
  v_cvt_pk_bf16_f32 v16, v96, v98
  v_cvt_pk_bf16_f32 v17, v97, v99
  v_pk_mul_f32 v[96:97], v[58:59], v[202:203]
  v_pk_mul_f32 v[98:99], v[62:63], v[202:203]
  v_pk_fma_f32 v[96:97], v[62:63], v[206:207], v[96:97]
  v_pk_fma_f32 v[98:99], v[58:59], v[206:207], v[98:99] neg_lo:[0,1,0] neg_hi:[0,1,0]
  v_cvt_pk_bf16_f32 v18, v96, v98
  v_cvt_pk_bf16_f32 v19, v97, v99
  s_add_u32 m0, s8, 49152
  s_nop 0
  buffer_load_dwordx4 v80, s[64:67], s7 offen offset:0 lds
  buffer_load_dwordx4 v81, s[64:67], s7 offen offset:1024 lds
  v_pk_mul_f32 v[96:97], v[64:65], v[200:201]
  v_pk_mul_f32 v[98:99], v[68:69], v[200:201]
  v_pk_fma_f32 v[96:97], v[68:69], v[204:205], v[96:97]
  v_pk_fma_f32 v[98:99], v[64:65], v[204:205], v[98:99] neg_lo:[0,1,0] neg_hi:[0,1,0]
  v_cvt_pk_bf16_f32 v44, v96, v98
  v_cvt_pk_bf16_f32 v45, v97, v99
  v_pk_mul_f32 v[96:97], v[66:67], v[202:203]
  v_pk_mul_f32 v[98:99], v[70:71], v[202:203]
  v_pk_fma_f32 v[96:97], v[70:71], v[206:207], v[96:97]
  v_pk_fma_f32 v[98:99], v[66:67], v[206:207], v[98:99] neg_lo:[0,1,0] neg_hi:[0,1,0]
  v_cvt_pk_bf16_f32 v46, v96, v98
  v_cvt_pk_bf16_f32 v47, v97, v99
  buffer_load_dwordx4 v82, s[64:67], s7 offen offset:2048 lds
  buffer_load_dwordx4 v83, s[64:67], s7 offen offset:3072 lds
  s_add_u32 s7, s7, 128
  s_and_b32 s7, s7, 0x7ff
  v_pk_mul_f32 v[96:97], v[72:73], v[200:201]
  v_pk_mul_f32 v[98:99], v[76:77], v[200:201]
  v_pk_fma_f32 v[96:97], v[76:77], v[204:205], v[96:97]
  v_pk_fma_f32 v[98:99], v[72:73], v[204:205], v[98:99] neg_lo:[0,1,0] neg_hi:[0,1,0]
  v_cvt_pk_bf16_f32 v48, v96, v98
  v_cvt_pk_bf16_f32 v49, v97, v99
  v_pk_mul_f32 v[96:97], v[74:75], v[202:203]
  v_pk_mul_f32 v[98:99], v[78:79], v[202:203]
  v_pk_fma_f32 v[96:97], v[78:79], v[206:207], v[96:97]
  v_pk_fma_f32 v[98:99], v[74:75], v[206:207], v[98:99] neg_lo:[0,1,0] neg_hi:[0,1,0]
  v_cvt_pk_bf16_f32 v50, v96, v98
  v_cvt_pk_bf16_f32 v51, v97, v99
  s_add_u32 m0, s8, 65536
  s_nop 0
  buffer_load_dwordx4 v80, s[64:67], s7 offen offset:0 lds
  buffer_load_dwordx4 v81, s[64:67], s7 offen offset:1024 lds
  v_pk_mul_f32 v[96:97], v[88:89], v[200:201]
  v_pk_mul_f32 v[98:99], v[92:93], v[200:201]
  v_pk_fma_f32 v[96:97], v[92:93], v[204:205], v[96:97]
  v_pk_fma_f32 v[98:99], v[88:89], v[204:205], v[98:99] neg_lo:[0,1,0] neg_hi:[0,1,0]
  v_cvt_pk_bf16_f32 v52, v96, v98
  v_cvt_pk_bf16_f32 v53, v97, v99
  v_pk_mul_f32 v[96:97], v[90:91], v[202:203]
  v_pk_mul_f32 v[98:99], v[94:95], v[202:203]
  v_pk_fma_f32 v[96:97], v[94:95], v[206:207], v[96:97]
  v_pk_fma_f32 v[98:99], v[90:91], v[206:207], v[98:99] neg_lo:[0,1,0] neg_hi:[0,1,0]
  v_cvt_pk_bf16_f32 v54, v96, v98
  v_cvt_pk_bf16_f32 v55, v97, v99
  buffer_load_dwordx4 v82, s[64:67], s7 offen offset:2048 lds
  buffer_load_dwordx4 v83, s[64:67], s7 offen offset:3072 lds
  s_add_u32 s7, s7, 128
  s_and_b32 s7, s7, 0x7ff
  v_mfma_f32_16x16x32_bf16 v[56:59], v[224:227], v[16:19], 0
  v_mfma_f32_16x16x32_bf16 v[60:63], v[228:231], v[16:19], 0
  s_add_u32 m0, s8, 81920
  s_nop 0
  buffer_load_dwordx4 v80, s[64:67], s7 offen offset:0 lds
  buffer_load_dwordx4 v81, s[64:67], s7 offen offset:1024 lds
  v_mfma_f32_16x16x32_bf16 v[64:67], v[224:227], v[44:47], 0
  v_mfma_f32_16x16x32_bf16 v[68:71], v[228:231], v[44:47], 0
  buffer_load_dwordx4 v82, s[64:67], s7 offen offset:2048 lds
  buffer_load_dwordx4 v83, s[64:67], s7 offen offset:3072 lds
  s_add_u32 s7, s7, 128
  s_and_b32 s7, s7, 0x7ff
  v_mfma_f32_16x16x32_bf16 v[72:75], v[224:227], v[48:51], 0
  v_mfma_f32_16x16x32_bf16 v[76:79], v[228:231], v[48:51], 0
  s_add_u32 m0, s8, 98304
  s_nop 0
  buffer_load_dwordx4 v80, s[64:67], s7 offen offset:0 lds
  buffer_load_dwordx4 v81, s[64:67], s7 offen offset:1024 lds
  v_mfma_f32_16x16x32_bf16 v[88:91], v[224:227], v[52:55], 0
  v_mfma_f32_16x16x32_bf16 v[92:95], v[228:231], v[52:55], 0
  buffer_load_dwordx4 v82, s[64:67], s7 offen offset:2048 lds
  buffer_load_dwordx4 v83, s[64:67], s7 offen offset:3072 lds
  s_add_u32 s7, s7, 128
  s_and_b32 s7, s7, 0x7ff
  s_cmp_eq_u32 s19, 0
  s_cbranch_scc1 gated_mix__spectral_gfnet__ssm_conv_s5__prompt_kernel_skip27
  v_pk_mul_f32 v[96:97], v[56:57], v[20:21]
  v_pk_mul_f32 v[98:99], v[60:61], v[20:21]
  v_pk_fma_f32 v[96:97], v[60:61], v[136:137], v[96:97] neg_lo:[0,1,0] neg_hi:[0,1,0]
  v_pk_fma_f32 v[98:99], v[56:57], v[136:137], v[98:99]
  v_cvt_pk_bf16_f32 v140, v96, v98
  v_cvt_pk_bf16_f32 v141, v97, v99
  v_pk_mul_f32 v[96:97], v[58:59], v[22:23]
  v_pk_mul_f32 v[98:99], v[62:63], v[22:23]
  v_pk_fma_f32 v[96:97], v[62:63], v[138:139], v[96:97] neg_lo:[0,1,0] neg_hi:[0,1,0]
  v_pk_fma_f32 v[98:99], v[58:59], v[138:139], v[98:99]
  v_cvt_pk_bf16_f32 v142, v96, v98
  v_cvt_pk_bf16_f32 v143, v97, v99
  s_nop 1
  v_mfma_f32_16x16x32_bf16 v[20:23], v[140:143], v[232:235], 0
  v_mfma_f32_16x16x32_bf16 v[136:139], v[140:143], v[236:239], 0
  s_nop 6
  v_pk_mul_f32 v[96:97], v[20:21], v[216:217]
  v_pk_mul_f32 v[98:99], v[136:137], v[216:217]
  v_pk_fma_f32 v[96:97], v[136:137], v[220:221], v[96:97] neg_lo:[0,1,0] neg_hi:[0,1,0]
  v_pk_fma_f32 v[98:99], v[20:21], v[220:221], v[98:99]
  v_cvt_pk_bf16_f32 v140, v96, v98
  v_cvt_pk_bf16_f32 v141, v97, v99
  v_pk_mul_f32 v[96:97], v[22:23], v[218:219]
  v_pk_mul_f32 v[98:99], v[138:139], v[218:219]
  v_pk_fma_f32 v[96:97], v[138:139], v[222:223], v[96:97] neg_lo:[0,1,0] neg_hi:[0,1,0]
  v_pk_fma_f32 v[98:99], v[22:23], v[222:223], v[98:99]
  v_cvt_pk_bf16_f32 v142, v96, v98
  v_cvt_pk_bf16_f32 v143, v97, v99
  s_nop 1
  v_mfma_f32_16x16x32_bf16 v[20:23], v[208:211], v[140:143], 0
  v_mfma_f32_16x16x32_bf16 v[136:139], v[212:215], v[140:143], 0
gated_mix__spectral_gfnet__ssm_conv_s5__prompt_kernel_skip27:
  v_pk_mul_f32 v[96:97], v[56:57], v[108:109]
  v_pk_mul_f32 v[98:99], v[60:61], v[108:109]
  v_pk_fma_f32 v[96:97], v[60:61], v[112:113], v[96:97] neg_lo:[0,1,0] neg_hi:[0,1,0]
  v_pk_fma_f32 v[98:99], v[56:57], v[112:113], v[98:99]
  v_cvt_pk_bf16_f32 v16, v96, v98
  v_cvt_pk_bf16_f32 v17, v97, v99
  v_pk_mul_f32 v[96:97], v[58:59], v[110:111]
  v_pk_mul_f32 v[98:99], v[62:63], v[110:111]
  v_pk_fma_f32 v[96:97], v[62:63], v[114:115], v[96:97] neg_lo:[0,1,0] neg_hi:[0,1,0]
  v_pk_fma_f32 v[98:99], v[58:59], v[114:115], v[98:99]
  v_cvt_pk_bf16_f32 v18, v96, v98
  v_cvt_pk_bf16_f32 v19, v97, v99
  s_add_u32 m0, s8, 114688
  s_nop 0
  buffer_load_dwordx4 v80, s[64:67], s7 offen offset:0 lds
  buffer_load_dwordx4 v81, s[64:67], s7 offen offset:1024 lds
  v_pk_mul_f32 v[96:97], v[64:65], v[116:117]
  v_pk_mul_f32 v[98:99], v[68:69], v[116:117]
  v_pk_fma_f32 v[96:97], v[68:69], v[120:121], v[96:97] neg_lo:[0,1,0] neg_hi:[0,1,0]
  v_pk_fma_f32 v[98:99], v[64:65], v[120:121], v[98:99]
  v_cvt_pk_bf16_f32 v44, v96, v98
  v_cvt_pk_bf16_f32 v45, v97, v99
  v_pk_mul_f32 v[96:97], v[66:67], v[118:119]
  v_pk_mul_f32 v[98:99], v[70:71], v[118:119]
  v_pk_fma_f32 v[96:97], v[70:71], v[122:123], v[96:97] neg_lo:[0,1,0] neg_hi:[0,1,0]
  v_pk_fma_f32 v[98:99], v[66:67], v[122:123], v[98:99]
  v_cvt_pk_bf16_f32 v46, v96, v98
  v_cvt_pk_bf16_f32 v47, v97, v99
  buffer_load_dwordx4 v82, s[64:67], s7 offen offset:2048 lds
  buffer_load_dwordx4 v83, s[64:67], s7 offen offset:3072 lds
  s_add_u32 s7, s7, 128
  s_and_b32 s7, s7, 0x7ff
  buffer_load_dword v9, v8, s[48:51], s5 offen sc1
  v_pk_mul_f32 v[96:97], v[72:73], v[124:125]
  v_pk_mul_f32 v[98:99], v[76:77], v[124:125]
  v_pk_fma_f32 v[96:97], v[76:77], v[128:129], v[96:97] neg_lo:[0,1,0] neg_hi:[0,1,0]
  v_pk_fma_f32 v[98:99], v[72:73], v[128:129], v[98:99]
  v_cvt_pk_bf16_f32 v48, v96, v98
  v_cvt_pk_bf16_f32 v49, v97, v99
  v_pk_mul_f32 v[96:97], v[74:75], v[126:127]
  v_pk_mul_f32 v[98:99], v[78:79], v[126:127]
  v_pk_fma_f32 v[96:97], v[78:79], v[130:131], v[96:97] neg_lo:[0,1,0] neg_hi:[0,1,0]
  v_pk_fma_f32 v[98:99], v[74:75], v[130:131], v[98:99]
  v_cvt_pk_bf16_f32 v50, v96, v98
  v_cvt_pk_bf16_f32 v51, v97, v99
  v_pk_mul_f32 v[96:97], v[88:89], v[132:133]
  v_pk_mul_f32 v[98:99], v[92:93], v[132:133]
  v_pk_fma_f32 v[96:97], v[92:93], v[148:149], v[96:97] neg_lo:[0,1,0] neg_hi:[0,1,0]
  v_pk_fma_f32 v[98:99], v[88:89], v[148:149], v[98:99]
  v_cvt_pk_bf16_f32 v52, v96, v98
  v_cvt_pk_bf16_f32 v53, v97, v99
  v_pk_mul_f32 v[96:97], v[90:91], v[134:135]
  v_pk_mul_f32 v[98:99], v[94:95], v[134:135]
  v_pk_fma_f32 v[96:97], v[94:95], v[150:151], v[96:97] neg_lo:[0,1,0] neg_hi:[0,1,0]
  v_pk_fma_f32 v[98:99], v[90:91], v[150:151], v[98:99]
  v_cvt_pk_bf16_f32 v54, v96, v98
  v_cvt_pk_bf16_f32 v55, v97, v99
  v_mfma_f32_16x16x32_bf16 v[56:59], v[16:19], v[232:235], 0
  v_mfma_f32_16x16x32_bf16 v[60:63], v[16:19], v[236:239], 0
  v_mfma_f32_16x16x32_bf16 v[64:67], v[44:47], v[232:235], 0
  v_mfma_f32_16x16x32_bf16 v[68:71], v[44:47], v[236:239], 0
  v_mfma_f32_16x16x32_bf16 v[72:75], v[48:51], v[232:235], 0
  v_mfma_f32_16x16x32_bf16 v[76:79], v[48:51], v[236:239], 0
  v_mfma_f32_16x16x32_bf16 v[88:91], v[52:55], v[232:235], 0
  v_mfma_f32_16x16x32_bf16 v[92:95], v[52:55], v[236:239], 0
  s_nop 0
  v_pk_mul_f32 v[96:97], v[56:57], v[216:217]
  v_pk_mul_f32 v[98:99], v[60:61], v[216:217]
  v_pk_fma_f32 v[96:97], v[60:61], v[220:221], v[96:97] neg_lo:[0,1,0] neg_hi:[0,1,0]
  v_pk_fma_f32 v[98:99], v[56:57], v[220:221], v[98:99]
  v_cvt_pk_bf16_f32 v16, v96, v98
  v_cvt_pk_bf16_f32 v17, v97, v99
  v_pk_mul_f32 v[96:97], v[58:59], v[218:219]
  v_pk_mul_f32 v[98:99], v[62:63], v[218:219]
  v_pk_fma_f32 v[96:97], v[62:63], v[222:223], v[96:97] neg_lo:[0,1,0] neg_hi:[0,1,0]
  v_pk_fma_f32 v[98:99], v[58:59], v[222:223], v[98:99]
  v_cvt_pk_bf16_f32 v18, v96, v98
  v_cvt_pk_bf16_f32 v19, v97, v99
  v_pk_mul_f32 v[96:97], v[64:65], v[216:217]
  v_pk_mul_f32 v[98:99], v[68:69], v[216:217]
  v_pk_fma_f32 v[96:97], v[68:69], v[220:221], v[96:97] neg_lo:[0,1,0] neg_hi:[0,1,0]
  v_pk_fma_f32 v[98:99], v[64:65], v[220:221], v[98:99]
  v_cvt_pk_bf16_f32 v44, v96, v98
  v_cvt_pk_bf16_f32 v45, v97, v99
  v_pk_mul_f32 v[96:97], v[66:67], v[218:219]
  v_pk_mul_f32 v[98:99], v[70:71], v[218:219]
  v_pk_fma_f32 v[96:97], v[70:71], v[222:223], v[96:97] neg_lo:[0,1,0] neg_hi:[0,1,0]
  v_pk_fma_f32 v[98:99], v[66:67], v[222:223], v[98:99]
  v_cvt_pk_bf16_f32 v46, v96, v98
  v_cvt_pk_bf16_f32 v47, v97, v99
  v_pk_mul_f32 v[96:97], v[72:73], v[216:217]
  v_pk_mul_f32 v[98:99], v[76:77], v[216:217]
  v_pk_fma_f32 v[96:97], v[76:77], v[220:221], v[96:97] neg_lo:[0,1,0] neg_hi:[0,1,0]
  v_pk_fma_f32 v[98:99], v[72:73], v[220:221], v[98:99]
  v_cvt_pk_bf16_f32 v48, v96, v98
  v_cvt_pk_bf16_f32 v49, v97, v99
  v_pk_mul_f32 v[96:97], v[74:75], v[218:219]
  v_pk_mul_f32 v[98:99], v[78:79], v[218:219]
  v_pk_fma_f32 v[96:97], v[78:79], v[222:223], v[96:97] neg_lo:[0,1,0] neg_hi:[0,1,0]
  v_pk_fma_f32 v[98:99], v[74:75], v[222:223], v[98:99]
  v_cvt_pk_bf16_f32 v50, v96, v98
  v_cvt_pk_bf16_f32 v51, v97, v99
  v_pk_mul_f32 v[96:97], v[88:89], v[216:217]
  v_pk_mul_f32 v[98:99], v[92:93], v[216:217]
  v_pk_fma_f32 v[96:97], v[92:93], v[220:221], v[96:97] neg_lo:[0,1,0] neg_hi:[0,1,0]
  v_pk_fma_f32 v[98:99], v[88:89], v[220:221], v[98:99]
  v_cvt_pk_bf16_f32 v52, v96, v98
  v_cvt_pk_bf16_f32 v53, v97, v99
  v_pk_mul_f32 v[96:97], v[90:91], v[218:219]
  v_pk_mul_f32 v[98:99], v[94:95], v[218:219]
  v_pk_fma_f32 v[96:97], v[94:95], v[222:223], v[96:97] neg_lo:[0,1,0] neg_hi:[0,1,0]
  v_pk_fma_f32 v[98:99], v[90:91], v[222:223], v[98:99]
  v_cvt_pk_bf16_f32 v54, v96, v98
  v_cvt_pk_bf16_f32 v55, v97, v99
  v_mfma_f32_16x16x32_bf16 v[56:59], v[208:211], v[16:19], 0
  v_mfma_f32_16x16x32_bf16 v[60:63], v[212:215], v[16:19], 0
  v_mfma_f32_16x16x32_bf16 v[64:67], v[208:211], v[44:47], 0
  v_mfma_f32_16x16x32_bf16 v[68:71], v[212:215], v[44:47], 0
  v_mfma_f32_16x16x32_bf16 v[72:75], v[208:211], v[48:51], 0
  v_mfma_f32_16x16x32_bf16 v[76:79], v[212:215], v[48:51], 0
  v_mfma_f32_16x16x32_bf16 v[88:91], v[208:211], v[52:55], 0
  v_mfma_f32_16x16x32_bf16 v[92:95], v[212:215], v[52:55], 0
  s_sub_u32 s11, s19, 1
  s_or_b32 s11, s11, s3
  s_cmp_lg_u32 s11, 0
  s_cbranch_scc1 gated_mix__spectral_gfnet__ssm_conv_s5__prompt_kernel_skip28
  v_mov_b32 v60, v136
  v_mov_b32 v61, v137
  v_mov_b32 v62, v138
  v_mov_b32 v63, v139
gated_mix__spectral_gfnet__ssm_conv_s5__prompt_kernel_skip28:
  v_lshlrev_b32 v100, 12, v6
  v_lshl_add_u32 v100, v5, 4, v100
  s_lshl_b32 s11, s3, 8
  s_add_u32 s11, s11, 147456
  v_add_u32 v100, s11, v100
  v_cvt_pk_bf16_f32 v16, v56, v60
  v_cvt_pk_bf16_f32 v17, v64, v68
  v_cvt_pk_bf16_f32 v18, v72, v76
  v_cvt_pk_bf16_f32 v19, v88, v92
  ds_write_b128 v100, v[16:19] offset:0
  v_cvt_pk_bf16_f32 v44, v57, v61
  v_cvt_pk_bf16_f32 v45, v65, v69
  v_cvt_pk_bf16_f32 v46, v73, v77
  v_cvt_pk_bf16_f32 v47, v89, v93
  ds_write_b128 v100, v[44:47] offset:1024
  v_cvt_pk_bf16_f32 v48, v58, v62
  v_cvt_pk_bf16_f32 v49, v66, v70
  v_cvt_pk_bf16_f32 v50, v74, v78
  v_cvt_pk_bf16_f32 v51, v90, v94
  ds_write_b128 v100, v[48:51] offset:2048
  v_cvt_pk_bf16_f32 v52, v59, v63
  v_cvt_pk_bf16_f32 v53, v67, v71
  v_cvt_pk_bf16_f32 v54, v75, v79
  v_cvt_pk_bf16_f32 v55, v91, v95
  ds_write_b128 v100, v[52:55] offset:3072
  s_lshl_b32 s11, s3, 12
  s_add_u32 s11, s11, 147456
  v_lshl_add_u32 v100, v4, 4, s11
  s_waitcnt vmcnt(25)
  ds_read_b128 a[144:147], v84 offset:16384
  ds_read_b128 a[148:151], v85 offset:16384
  ds_read_b128 a[152:155], v84 offset:18432
  ds_read_b128 a[156:159], v85 offset:18432
  s_waitcnt vmcnt(21)
  ds_read_b128 a[160:163], v84 offset:32768
  ds_read_b128 a[164:167], v85 offset:32768
  ds_read_b128 a[168:171], v84 offset:34816
  ds_read_b128 a[172:175], v85 offset:34816
  s_waitcnt vmcnt(17)
  ds_read_b128 a[176:179], v84 offset:49152
  ds_read_b128 a[180:183], v85 offset:49152
  ds_read_b128 a[184:187], v84 offset:51200
  ds_read_b128 a[188:191], v85 offset:51200
  s_waitcnt vmcnt(13)
  ds_read_b128 a[192:195], v86 offset:0
  ds_read_b128 a[196:199], v87 offset:0
  ds_read_b128 a[200:203], v86 offset:2048
  ds_read_b128 a[204:207], v87 offset:2048
  s_waitcnt vmcnt(9)
  ds_read_b128 a[208:211], v86 offset:16384
  ds_read_b128 a[212:215], v87 offset:16384
  ds_read_b128 a[216:219], v86 offset:18432
  ds_read_b128 a[220:223], v87 offset:18432
  s_waitcnt vmcnt(5)
  ds_read_b128 a[224:227], v86 offset:32768
  ds_read_b128 a[228:231], v87 offset:32768
  ds_read_b128 a[232:235], v86 offset:34816
  ds_read_b128 a[236:239], v87 offset:34816
  s_waitcnt vmcnt(1)
  ds_read_b128 a[240:243], v86 offset:49152
  ds_read_b128 a[244:247], v87 offset:49152
  ds_read_b128 a[248:251], v86 offset:51200
  ds_read_b128 a[252:255], v87 offset:51200
  s_waitcnt vmcnt(0)
  v_cmp_ne_u32 vcc, 1, v9
  s_nop 0
  s_cbranch_vccz gated_mix__spectral_gfnet__ssm_conv_s5__prompt_kernel_skip29
  s_mov_b32 s7, 0
gated_mix__spectral_gfnet__ssm_conv_s5__prompt_kernel_poll30:
  s_sleep 2
  buffer_load_dword v9, v8, s[48:51], s5 offen sc1
  s_waitcnt vmcnt(0)
  v_cmp_ne_u32 vcc, 1, v9
  s_nop 0
  s_cbranch_vccz gated_mix__spectral_gfnet__ssm_conv_s5__prompt_kernel_pollout31
  s_add_u32 s7, s7, 1
  s_cmp_lt_u32 s7, 1048576
  s_cbranch_scc1 gated_mix__spectral_gfnet__ssm_conv_s5__prompt_kernel_poll30
gated_mix__spectral_gfnet__ssm_conv_s5__prompt_kernel_pollout31:
gated_mix__spectral_gfnet__ssm_conv_s5__prompt_kernel_skip29:
  s_waitcnt lgkmcnt(0)
  s_barrier
  ds_read_b128 v[16:19], v100 offset:0
  ds_read_b128 v[44:47], v100 offset:1024
  ds_read_b128 v[48:51], v100 offset:2048
  ds_read_b128 v[52:55], v100 offset:3072
  s_add_u32 m0, s10, 0
  s_nop 0
  buffer_load_dwordx4 v10, s[12:15], s6 offen offset:0 sc1 lds
  buffer_load_dwordx4 v10, s[12:15], s6 offen offset:1024 sc1 lds
  buffer_load_dwordx4 v10, s[12:15], s6 offen offset:2048 sc1 lds
  buffer_load_dwordx4 v10, s[12:15], s6 offen offset:3072 sc1 lds
  s_add_u32 m0, s10, 4096
  s_nop 0
  buffer_load_dwordx4 v11, s[12:15], s6 offen offset:0 sc1 lds
  buffer_load_dwordx4 v11, s[12:15], s6 offen offset:1024 sc1 lds
  buffer_load_dwordx4 v11, s[12:15], s6 offen offset:2048 sc1 lds
  buffer_load_dwordx4 v11, s[12:15], s6 offen offset:3072 sc1 lds
  s_add_u32 s6, s6, 32768
  s_and_b32 s6, s6, 0x7ffff
  s_waitcnt lgkmcnt(3)
  v_mfma_f32_16x16x32_bf16 v[56:59], v[188:191], v[16:19], 0
  v_mfma_f32_16x16x32_bf16 v[60:63], v[192:195], v[16:19], 0
  s_add_u32 m0, s10, 32768
  s_nop 0
  buffer_load_dwordx4 v10, s[12:15], s6 offen offset:0 sc1 lds
  buffer_load_dwordx4 v10, s[12:15], s6 offen offset:1024 sc1 lds
  s_waitcnt lgkmcnt(2)
  v_mfma_f32_16x16x32_bf16 v[64:67], v[188:191], v[44:47], 0
  v_mfma_f32_16x16x32_bf16 v[68:71], v[192:195], v[44:47], 0
  buffer_load_dwordx4 v10, s[12:15], s6 offen offset:2048 sc1 lds
  buffer_load_dwordx4 v10, s[12:15], s6 offen offset:3072 sc1 lds
  s_waitcnt lgkmcnt(1)
  v_mfma_f32_16x16x32_bf16 v[72:75], v[188:191], v[48:51], 0
  v_mfma_f32_16x16x32_bf16 v[76:79], v[192:195], v[48:51], 0
  s_add_u32 m0, s10, 36864
  s_nop 0
  buffer_load_dwordx4 v11, s[12:15], s6 offen offset:0 sc1 lds
  buffer_load_dwordx4 v11, s[12:15], s6 offen offset:1024 sc1 lds
  s_waitcnt lgkmcnt(0)
  v_mfma_f32_16x16x32_bf16 v[88:91], v[188:191], v[52:55], 0
  v_mfma_f32_16x16x32_bf16 v[92:95], v[192:195], v[52:55], 0
  buffer_load_dwordx4 v11, s[12:15], s6 offen offset:2048 sc1 lds
  buffer_load_dwordx4 v11, s[12:15], s6 offen offset:3072 sc1 lds
  s_add_u32 s6, s6, 32768
  s_and_b32 s6, s6, 0x7ffff
  s_mov_b32 s11, 1048576
  v_mul_lo_u32 v100, v6, s11
  v_lshl_add_u32 v100, v5, 2, v100
  s_mul_i32 s7, s3, 65536
  s_lshr_b32 s11, s40, 4
  s_lshl_b32 s11, s11, 12
  s_add_u32 s7, s7, s11
  s_lshl_b32 s11, s41, 10
  s_add_u32 s7, s7, s11
  s_and_b32 s11, s40, 15
  s_lshl_b32 s11, s11, 6
  s_add_u32 s7, s7, s11
  v_cvt_pk_bf16_f32 v16, v56, v60
  v_cvt_pk_bf16_f32 v17, v57, v61
  v_cvt_pk_bf16_f32 v18, v58, v62
  v_cvt_pk_bf16_f32 v19, v59, v63
  s_add_u32 m0, s10, 65536
  s_nop 0
  buffer_load_dwordx4 v10, s[12:15], s6 offen offset:0 sc1 lds
  buffer_load_dwordx4 v10, s[12:15], s6 offen offset:1024 sc1 lds
  v_cvt_pk_bf16_f32 v44, v64, v68
  v_cvt_pk_bf16_f32 v45, v65, v69
  v_cvt_pk_bf16_f32 v46, v66, v70
  v_cvt_pk_bf16_f32 v47, v67, v71
  buffer_load_dwordx4 v10, s[12:15], s6 offen offset:2048 sc1 lds
  buffer_load_dwordx4 v10, s[12:15], s6 offen offset:3072 sc1 lds
  v_cvt_pk_bf16_f32 v48, v72, v76
  v_cvt_pk_bf16_f32 v49, v73, v77
  v_cvt_pk_bf16_f32 v50, v74, v78
  v_cvt_pk_bf16_f32 v51, v75, v79
  s_add_u32 m0, s10, 69632
  s_nop 0
  buffer_load_dwordx4 v11, s[12:15], s6 offen offset:0 sc1 lds
  buffer_load_dwordx4 v11, s[12:15], s6 offen offset:1024 sc1 lds
  v_cvt_pk_bf16_f32 v52, v88, v92
  v_cvt_pk_bf16_f32 v53, v89, v93
  v_cvt_pk_bf16_f32 v54, v90, v94
  v_cvt_pk_bf16_f32 v55, v91, v95
  buffer_load_dwordx4 v11, s[12:15], s6 offen offset:2048 sc1 lds
  buffer_load_dwordx4 v11, s[12:15], s6 offen offset:3072 sc1 lds
  s_add_u32 s6, s6, 32768
  s_and_b32 s6, s6, 0x7ffff
  v_lshlrev_b32 v20, 16, v28
  v_and_b32 v21, 0xffff0000, v28
  v_lshlrev_b32 v22, 16, v29
  v_and_b32 v23, 0xffff0000, v29
  v_pk_mul_f32 v[20:21], v[26:27], v[20:21] op_sel:[0,0] op_sel_hi:[0,1]
  v_pk_mul_f32 v[22:23], v[26:27], v[22:23] op_sel:[0,0] op_sel_hi:[0,1]
  v_lshlrev_b32 v56, 16, v30
  v_and_b32 v57, 0xffff0000, v30
  v_lshlrev_b32 v58, 16, v31
  v_and_b32 v59, 0xffff0000, v31
  v_pk_mul_f32 v[56:57], v[26:27], v[56:57] op_sel:[0,0] op_sel_hi:[0,1]
  v_pk_mul_f32 v[58:59], v[26:27], v[58:59] op_sel:[0,0] op_sel_hi:[0,1]
  v_lshlrev_b32 v60, 16, v32
  v_and_b32 v61, 0xffff0000, v32
  v_lshlrev_b32 v62, 16, v33
  v_and_b32 v63, 0xffff0000, v33
  v_pk_mul_f32 v[60:61], v[26:27], v[60:61] op_sel:[0,0] op_sel_hi:[0,1]
  v_pk_mul_f32 v[62:63], v[26:27], v[62:63] op_sel:[0,0] op_sel_hi:[0,1]
  v_lshlrev_b32 v64, 16, v34
  v_and_b32 v65, 0xffff0000, v34
  v_lshlrev_b32 v66, 16, v35
  v_and_b32 v67, 0xffff0000, v35
  v_pk_mul_f32 v[64:65], v[26:27], v[64:65] op_sel:[0,0] op_sel_hi:[0,1]
  v_pk_mul_f32 v[66:67], v[26:27], v[66:67] op_sel:[0,0] op_sel_hi:[0,1]
  v_lshlrev_b32 v84, 16, v36
  v_and_b32 v85, 0xffff0000, v36
  v_lshlrev_b32 v86, 16, v37
  v_and_b32 v87, 0xffff0000, v37
  v_pk_mul_f32 v[84:85], v[26:27], v[84:85] op_sel:[1,0] op_sel_hi:[1,1]
  v_pk_mul_f32 v[86:87], v[26:27], v[86:87] op_sel:[1,0] op_sel_hi:[1,1]
  v_lshlrev_b32 v88, 16, v38
  v_and_b32 v89, 0xffff0000, v38
  v_lshlrev_b32 v90, 16, v39
  v_and_b32 v91, 0xffff0000, v39
  v_pk_mul_f32 v[88:89], v[26:27], v[88:89] op_sel:[1,0] op_sel_hi:[1,1]
  v_pk_mul_f32 v[90:91], v[26:27], v[90:91] op_sel:[1,0] op_sel_hi:[1,1]
  v_lshlrev_b32 v92, 16, v40
  v_and_b32 v93, 0xffff0000, v40
  v_lshlrev_b32 v94, 16, v41
  v_and_b32 v95, 0xffff0000, v41
  v_pk_mul_f32 v[92:93], v[26:27], v[92:93] op_sel:[1,0] op_sel_hi:[1,1]
  v_pk_mul_f32 v[94:95], v[26:27], v[94:95] op_sel:[1,0] op_sel_hi:[1,1]
  v_lshlrev_b32 v96, 16, v42
  v_and_b32 v97, 0xffff0000, v42
  v_lshlrev_b32 v98, 16, v43
  v_and_b32 v99, 0xffff0000, v43
  v_pk_mul_f32 v[96:97], v[26:27], v[96:97] op_sel:[1,0] op_sel_hi:[1,1]
  v_pk_mul_f32 v[98:99], v[26:27], v[98:99] op_sel:[1,0] op_sel_hi:[1,1]
  s_add_u32 s20, s34, 5242880
  s_addc_u32 s21, s35, 0
  s_mov_b32 s22, 4194304
  s_mov_b32 s23, 0x20000
  s_mov_b32 s44, s30
  s_mov_b32 s45, s31
  s_mov_b32 s46, 8388608
  s_mov_b32 s47, 0x20000
  s_waitcnt vmcnt(16)
  s_barrier
  ds_read_b64_tr_b16 v[120:121], v12 offset:0
  ds_read_b64_tr_b16 v[122:123], v13 offset:0
  ds_read_b64_tr_b16 v[124:125], v12 offset:2048
  ds_read_b64_tr_b16 v[126:127], v13 offset:2048
  ds_read_b64_tr_b16 v[128:129], v12 offset:4096
  ds_read_b64_tr_b16 v[130:131], v13 offset:4096
  ds_read_b64_tr_b16 v[132:133], v12 offset:6144
  ds_read_b64_tr_b16 v[134:135], v13 offset:6144
  ds_read_b64_tr_b16 v[136:137], v12 offset:8192
  ds_read_b64_tr_b16 v[138:139], v13 offset:8192
  ds_read_b64_tr_b16 v[140:141], v12 offset:10240
  ds_read_b64_tr_b16 v[142:143], v13 offset:10240
  ds_read_b64_tr_b16 v[144:145], v12 offset:12288
  ds_read_b64_tr_b16 v[146:147], v13 offset:12288
  ds_read_b64_tr_b16 v[148:149], v12 offset:14336
  ds_read_b64_tr_b16 v[150:151], v13 offset:14336
  s_waitcnt lgkmcnt(0)
  v_mfma_f32_16x16x32_bf16 v[20:23], v[120:123], a[0:3], v[20:23]
  ds_read_b64_tr_b16 v[152:153], v12 offset:256
  ds_read_b64_tr_b16 v[154:155], v13 offset:256
  buffer_store_dword v16, v100, s[20:23], s7 offen sc1
  s_add_u32 s7, s7, 262144
  v_mfma_f32_16x16x32_bf16 v[84:87], v[120:123], a[8:11], v[84:87]
  ds_read_b64_tr_b16 v[156:157], v12 offset:2304
  ds_read_b64_tr_b16 v[158:159], v13 offset:2304
  buffer_store_dword v17, v100, s[20:23], s7 offen sc1
  s_add_u32 s7, s7, 262144
  v_mfma_f32_16x16x32_bf16 v[56:59], v[124:127], a[0:3], v[56:59]
  ds_read_b64_tr_b16 v[160:161], v12 offset:4352
  ds_read_b64_tr_b16 v[162:163], v13 offset:4352
  buffer_store_dword v18, v100, s[20:23], s7 offen sc1
  s_add_u32 s7, s7, 262144
  v_mfma_f32_16x16x32_bf16 v[88:91], v[124:127], a[8:11], v[88:91]
  ds_read_b64_tr_b16 v[164:165], v12 offset:6400
  ds_read_b64_tr_b16 v[166:167], v13 offset:6400
  buffer_store_dword v19, v100, s[20:23], s7 offen sc1
  s_sub_u32 s7, s7, 770048
  v_mfma_f32_16x16x32_bf16 v[60:63], v[128:131], a[0:3], v[60:63]
  ds_read_b64_tr_b16 v[168:169], v12 offset:8448
  ds_read_b64_tr_b16 v[170:171], v13 offset:8448
  buffer_store_dword v44, v100, s[20:23], s7 offen sc1
  s_add_u32 s7, s7, 262144
  v_mfma_f32_16x16x32_bf16 v[92:95], v[128:131], a[8:11], v[92:95]
  ds_read_b64_tr_b16 v[172:173], v12 offset:10496
  ds_read_b64_tr_b16 v[174:175], v13 offset:10496
  buffer_store_dword v45, v100, s[20:23], s7 offen sc1
  s_add_u32 s7, s7, 262144
  v_mfma_f32_16x16x32_bf16 v[64:67], v[132:135], a[0:3], v[64:67]
  ds_read_b64_tr_b16 v[176:177], v12 offset:12544
  ds_read_b64_tr_b16 v[178:179], v13 offset:12544
  buffer_store_dword v46, v100, s[20:23], s7 offen sc1
  s_add_u32 s7, s7, 262144
  v_mfma_f32_16x16x32_bf16 v[96:99], v[132:135], a[8:11], v[96:99]
  ds_read_b64_tr_b16 v[180:181], v12 offset:14592
  ds_read_b64_tr_b16 v[182:183], v13 offset:14592
  buffer_store_dword v47, v100, s[20:23], s7 offen sc1
  s_sub_u32 s7, s7, 770048
  v_mfma_f32_16x16x32_bf16 v[68:71], v[136:139], a[0:3], 0
  s_add_u32 m0, s10, 98304
  s_nop 0
  buffer_load_dwordx4 v10, s[12:15], s6 offen offset:0 sc1 lds
  buffer_store_dword v48, v100, s[20:23], s7 offen sc1
  s_add_u32 s7, s7, 262144
  v_mfma_f32_16x16x32_bf16 v[104:107], v[136:139], a[8:11], 0
  buffer_store_dword v49, v100, s[20:23], s7 offen sc1
  s_add_u32 s7, s7, 262144
  v_mfma_f32_16x16x32_bf16 v[72:75], v[140:143], a[0:3], 0
  buffer_load_dwordx4 v10, s[12:15], s6 offen offset:1024 sc1 lds
  buffer_store_dword v50, v100, s[20:23], s7 offen sc1
  s_add_u32 s7, s7, 262144
  v_mfma_f32_16x16x32_bf16 v[108:111], v[140:143], a[8:11], 0
  buffer_store_dword v51, v100, s[20:23], s7 offen sc1
  s_sub_u32 s7, s7, 770048
  v_mfma_f32_16x16x32_bf16 v[76:79], v[144:147], a[0:3], 0
  buffer_load_dwordx4 v10, s[12:15], s6 offen offset:2048 sc1 lds
  buffer_store_dword v52, v100, s[20:23], s7 offen sc1
  s_add_u32 s7, s7, 262144
  v_mfma_f32_16x16x32_bf16 v[112:115], v[144:147], a[8:11], 0
  buffer_store_dword v53, v100, s[20:23], s7 offen sc1
  s_add_u32 s7, s7, 262144
  v_mfma_f32_16x16x32_bf16 v[80:83], v[148:151], a[0:3], 0
  buffer_load_dwordx4 v10, s[12:15], s6 offen offset:3072 sc1 lds
  buffer_store_dword v54, v100, s[20:23], s7 offen sc1
  s_add_u32 s7, s7, 262144
  v_mfma_f32_16x16x32_bf16 v[116:119], v[148:151], a[8:11], 0
  buffer_store_dword v55, v100, s[20:23], s7 offen sc1
  s_waitcnt vmcnt(28) lgkmcnt(0)
  s_barrier
  v_mfma_f32_16x16x32_bf16 v[20:23], v[152:155], a[4:7], v[20:23]
  ds_read_b64_tr_b16 v[120:121], v12 offset:32768
  ds_read_b64_tr_b16 v[122:123], v13 offset:32768
  v_mfma_f32_16x16x32_bf16 v[84:87], v[152:155], a[12:15], v[84:87]
  ds_read_b64_tr_b16 v[124:125], v12 offset:34816
  ds_read_b64_tr_b16 v[126:127], v13 offset:34816
  v_mfma_f32_16x16x32_bf16 v[56:59], v[156:159], a[4:7], v[56:59]
  ds_read_b64_tr_b16 v[128:129], v12 offset:36864
  ds_read_b64_tr_b16 v[130:131], v13 offset:36864
  v_mfma_f32_16x16x32_bf16 v[88:91], v[156:159], a[12:15], v[88:91]
  ds_read_b64_tr_b16 v[132:133], v12 offset:38912
  ds_read_b64_tr_b16 v[134:135], v13 offset:38912
  v_mfma_f32_16x16x32_bf16 v[60:63], v[160:163], a[4:7], v[60:63]
  ds_read_b64_tr_b16 v[136:137], v12 offset:40960
  ds_read_b64_tr_b16 v[138:139], v13 offset:40960
  v_mfma_f32_16x16x32_bf16 v[92:95], v[160:163], a[12:15], v[92:95]
  ds_read_b64_tr_b16 v[140:141], v12 offset:43008
  ds_read_b64_tr_b16 v[142:143], v13 offset:43008
  v_mfma_f32_16x16x32_bf16 v[64:67], v[164:167], a[4:7], v[64:67]
  ds_read_b64_tr_b16 v[144:145], v12 offset:45056
  ds_read_b64_tr_b16 v[146:147], v13 offset:45056
  v_mfma_f32_16x16x32_bf16 v[96:99], v[164:167], a[12:15], v[96:99]
  ds_read_b64_tr_b16 v[148:149], v12 offset:47104
  ds_read_b64_tr_b16 v[150:151], v13 offset:47104
  v_mfma_f32_16x16x32_bf16 v[68:71], v[168:171], a[4:7], v[68:71]
  s_add_u32 m0, s10, 102400
  s_nop 0
  buffer_load_dwordx4 v11, s[12:15], s6 offen offset:0 sc1 lds
  v_mfma_f32_16x16x32_bf16 v[104:107], v[168:171], a[12:15], v[104:107]
  v_mfma_f32_16x16x32_bf16 v[72:75], v[172:175], a[4:7], v[72:75]
  buffer_load_dwordx4 v11, s[12:15], s6 offen offset:1024 sc1 lds
  v_mfma_f32_16x16x32_bf16 v[108:111], v[172:175], a[12:15], v[108:111]
  v_mfma_f32_16x16x32_bf16 v[76:79], v[176:179], a[4:7], v[76:79]
  buffer_load_dwordx4 v11, s[12:15], s6 offen offset:2048 sc1 lds
  v_mfma_f32_16x16x32_bf16 v[112:115], v[176:179], a[12:15], v[112:115]
  v_mfma_f32_16x16x32_bf16 v[80:83], v[180:183], a[4:7], v[80:83]
  buffer_load_dwordx4 v11, s[12:15], s6 offen offset:3072 sc1 lds
  s_add_u32 s6, s6, 32768
  s_and_b32 s6, s6, 0x7ffff
  v_mfma_f32_16x16x32_bf16 v[116:119], v[180:183], a[12:15], v[116:119]
  s_waitcnt lgkmcnt(0)
  v_mfma_f32_16x16x32_bf16 v[20:23], v[120:123], a[16:19], v[20:23]
  ds_read_b64_tr_b16 v[152:153], v12 offset:33024
  ds_read_b64_tr_b16 v[154:155], v13 offset:33024
  v_mfma_f32_16x16x32_bf16 v[84:87], v[120:123], a[24:27], v[84:87]
  ds_read_b64_tr_b16 v[156:157], v12 offset:35072
  ds_read_b64_tr_b16 v[158:159], v13 offset:35072
  v_mfma_f32_16x16x32_bf16 v[56:59], v[124:127], a[16:19], v[56:59]
  ds_read_b64_tr_b16 v[160:161], v12 offset:37120
  ds_read_b64_tr_b16 v[162:163], v13 offset:37120
  v_mfma_f32_16x16x32_bf16 v[88:91], v[124:127], a[24:27], v[88:91]
  ds_read_b64_tr_b16 v[164:165], v12 offset:39168
  ds_read_b64_tr_b16 v[166:167], v13 offset:39168
  v_mfma_f32_16x16x32_bf16 v[60:63], v[128:131], a[16:19], v[60:63]
  ds_read_b64_tr_b16 v[168:169], v12 offset:41216
  ds_read_b64_tr_b16 v[170:171], v13 offset:41216
  v_mfma_f32_16x16x32_bf16 v[92:95], v[128:131], a[24:27], v[92:95]
  ds_read_b64_tr_b16 v[172:173], v12 offset:43264
  ds_read_b64_tr_b16 v[174:175], v13 offset:43264
  v_mfma_f32_16x16x32_bf16 v[64:67], v[132:135], a[16:19], v[64:67]
  ds_read_b64_tr_b16 v[176:177], v12 offset:45312
  ds_read_b64_tr_b16 v[178:179], v13 offset:45312
  v_mfma_f32_16x16x32_bf16 v[96:99], v[132:135], a[24:27], v[96:99]
  ds_read_b64_tr_b16 v[180:181], v12 offset:47360
  ds_read_b64_tr_b16 v[182:183], v13 offset:47360
  v_mfma_f32_16x16x32_bf16 v[68:71], v[136:139], a[16:19], v[68:71]
  s_add_u32 m0, s10, 0
  s_nop 0
  buffer_load_dwordx4 v10, s[12:15], s6 offen offset:0 sc1 lds
  v_lshrrev_b32 v27, 1, v6
  v_lshlrev_b32 v27, 3, v27
  v_mfma_f32_16x16x32_bf16 v[104:107], v[136:139], a[24:27], v[104:107]
  v_and_b32 v101, 1, v6
  v_lshl_add_u32 v27, v101, 1, v27
  v_mfma_f32_16x16x32_bf16 v[72:75], v[140:143], a[16:19], v[72:75]
  buffer_load_dwordx4 v10, s[12:15], s6 offen offset:1024 sc1 lds
  v_cvt_f32_u32 v26, v27
  s_and_b32 s8, s3, 1
  v_mfma_f32_16x16x32_bf16 v[108:111], v[140:143], a[24:27], v[108:111]
  s_lshl_b32 s8, s8, 6
  s_add_u32 s8, s8, 0
  v_mfma_f32_16x16x32_bf16 v[76:79], v[144:147], a[16:19], v[76:79]
  buffer_load_dwordx4 v10, s[12:15], s6 offen offset:2048 sc1 lds
  v_add_u32 v27, s8, v5
  v_cvt_f32_u32 v8, v27
  v_mfma_f32_16x16x32_bf16 v[112:115], v[144:147], a[24:27], v[112:115]
  v_mul_f32 v8, 0x3c000000, v8
  v_mul_f32 v9, v8, v26
  v_mfma_f32_16x16x32_bf16 v[80:83], v[148:151], a[16:19], v[80:83]
  buffer_load_dwordx4 v10, s[12:15], s6 offen offset:3072 sc1 lds
  v_fmamk_f32 v27, v8, 0x0, v9
  v_cos_f32 v101, v27
  v_mfma_f32_16x16x32_bf16 v[116:119], v[148:151], a[24:27], v[116:119]
  v_sin_f32 v102, v27
  s_nop 0
  v_cvt_pk_bf16_f32 v28, v101, -v102
  s_waitcnt vmcnt(28) lgkmcnt(0)
  s_barrier
  v_mfma_f32_16x16x32_bf16 v[20:23], v[152:155], a[20:23], v[20:23]
  ds_read_b64_tr_b16 v[120:121], v14 offset:0
  ds_read_b64_tr_b16 v[122:123], v15 offset:0
  v_mfma_f32_16x16x32_bf16 v[84:87], v[152:155], a[28:31], v[84:87]
  ds_read_b64_tr_b16 v[124:125], v14 offset:2048
  ds_read_b64_tr_b16 v[126:127], v15 offset:2048
  v_mfma_f32_16x16x32_bf16 v[56:59], v[156:159], a[20:23], v[56:59]
  ds_read_b64_tr_b16 v[128:129], v14 offset:4096
  ds_read_b64_tr_b16 v[130:131], v15 offset:4096
  v_mfma_f32_16x16x32_bf16 v[88:91], v[156:159], a[28:31], v[88:91]
  ds_read_b64_tr_b16 v[132:133], v14 offset:6144
  ds_read_b64_tr_b16 v[134:135], v15 offset:6144
  v_mfma_f32_16x16x32_bf16 v[60:63], v[160:163], a[20:23], v[60:63]
  ds_read_b64_tr_b16 v[136:137], v14 offset:8192
  ds_read_b64_tr_b16 v[138:139], v15 offset:8192
  v_mfma_f32_16x16x32_bf16 v[92:95], v[160:163], a[28:31], v[92:95]
  ds_read_b64_tr_b16 v[140:141], v14 offset:10240
  ds_read_b64_tr_b16 v[142:143], v15 offset:10240
  v_mfma_f32_16x16x32_bf16 v[64:67], v[164:167], a[20:23], v[64:67]
  ds_read_b64_tr_b16 v[144:145], v14 offset:12288
  ds_read_b64_tr_b16 v[146:147], v15 offset:12288
  v_mfma_f32_16x16x32_bf16 v[96:99], v[164:167], a[28:31], v[96:99]
  ds_read_b64_tr_b16 v[148:149], v14 offset:14336
  ds_read_b64_tr_b16 v[150:151], v15 offset:14336
  v_mfma_f32_16x16x32_bf16 v[68:71], v[168:171], a[20:23], v[68:71]
  s_add_u32 m0, s10, 4096
  s_nop 0
  buffer_load_dwordx4 v11, s[12:15], s6 offen offset:0 sc1 lds
  v_fmamk_f32 v27, v8, 0x3f800000, v9
  v_cos_f32 v101, v27
  v_mfma_f32_16x16x32_bf16 v[104:107], v[168:171], a[28:31], v[104:107]
  v_sin_f32 v102, v27
  s_nop 0
  v_cvt_pk_bf16_f32 v29, v101, -v102
  v_mfma_f32_16x16x32_bf16 v[72:75], v[172:175], a[20:23], v[72:75]
  buffer_load_dwordx4 v11, s[12:15], s6 offen offset:1024 sc1 lds
  v_fmamk_f32 v27, v8, 0x40800000, v9
  v_cos_f32 v101, v27
  v_mfma_f32_16x16x32_bf16 v[108:111], v[172:175], a[28:31], v[108:111]
  v_sin_f32 v102, v27
  s_nop 0
  v_cvt_pk_bf16_f32 v30, v101, -v102
  v_mfma_f32_16x16x32_bf16 v[76:79], v[176:179], a[20:23], v[76:79]
  buffer_load_dwordx4 v11, s[12:15], s6 offen offset:2048 sc1 lds
  v_fmamk_f32 v27, v8, 0x40a00000, v9
  v_cos_f32 v101, v27
  v_mfma_f32_16x16x32_bf16 v[112:115], v[176:179], a[28:31], v[112:115]
  v_sin_f32 v102, v27
  s_nop 0
  v_cvt_pk_bf16_f32 v31, v101, -v102
  v_mfma_f32_16x16x32_bf16 v[80:83], v[180:183], a[20:23], v[80:83]
  buffer_load_dwordx4 v11, s[12:15], s6 offen offset:3072 sc1 lds
  s_add_u32 s6, s6, 32768
  s_and_b32 s6, s6, 0x7ffff
  v_fmamk_f32 v27, v8, 0x41800000, v9
  v_cos_f32 v101, v27
  v_mfma_f32_16x16x32_bf16 v[116:119], v[180:183], a[28:31], v[116:119]
  v_sin_f32 v102, v27
  s_nop 0
  v_cvt_pk_bf16_f32 v32, v101, -v102
  s_waitcnt lgkmcnt(0)
  v_mfma_f32_16x16x32_bf16 v[20:23], v[120:123], a[32:35], v[20:23]
  ds_read_b64_tr_b16 v[152:153], v14 offset:256
  ds_read_b64_tr_b16 v[154:155], v15 offset:256
  v_mfma_f32_16x16x32_bf16 v[84:87], v[120:123], a[40:43], v[84:87]
  ds_read_b64_tr_b16 v[156:157], v14 offset:2304
  ds_read_b64_tr_b16 v[158:159], v15 offset:2304
  v_mfma_f32_16x16x32_bf16 v[56:59], v[124:127], a[32:35], v[56:59]
  ds_read_b64_tr_b16 v[160:161], v14 offset:4352
  ds_read_b64_tr_b16 v[162:163], v15 offset:4352
  v_mfma_f32_16x16x32_bf16 v[88:91], v[124:127], a[40:43], v[88:91]
  ds_read_b64_tr_b16 v[164:165], v14 offset:6400
  ds_read_b64_tr_b16 v[166:167], v15 offset:6400
  v_mfma_f32_16x16x32_bf16 v[60:63], v[128:131], a[32:35], v[60:63]
  ds_read_b64_tr_b16 v[168:169], v14 offset:8448
  ds_read_b64_tr_b16 v[170:171], v15 offset:8448
  v_mfma_f32_16x16x32_bf16 v[92:95], v[128:131], a[40:43], v[92:95]
  ds_read_b64_tr_b16 v[172:173], v14 offset:10496
  ds_read_b64_tr_b16 v[174:175], v15 offset:10496
  v_mfma_f32_16x16x32_bf16 v[64:67], v[132:135], a[32:35], v[64:67]
  ds_read_b64_tr_b16 v[176:177], v14 offset:12544
  ds_read_b64_tr_b16 v[178:179], v15 offset:12544
  v_mfma_f32_16x16x32_bf16 v[96:99], v[132:135], a[40:43], v[96:99]
  ds_read_b64_tr_b16 v[180:181], v14 offset:14592
  ds_read_b64_tr_b16 v[182:183], v15 offset:14592
  v_mfma_f32_16x16x32_bf16 v[68:71], v[136:139], a[32:35], v[68:71]
  s_add_u32 m0, s10, 32768
  s_nop 0
  buffer_load_dwordx4 v10, s[12:15], s6 offen offset:0 sc1 lds
  v_fmamk_f32 v27, v8, 0x41880000, v9
  v_cos_f32 v101, v27
  v_mfma_f32_16x16x32_bf16 v[104:107], v[136:139], a[40:43], v[104:107]
  v_sin_f32 v102, v27
  s_nop 0
  v_cvt_pk_bf16_f32 v33, v101, -v102
  v_mfma_f32_16x16x32_bf16 v[72:75], v[140:143], a[32:35], v[72:75]
  buffer_load_dwordx4 v10, s[12:15], s6 offen offset:1024 sc1 lds
  v_fmamk_f32 v27, v8, 0x41a00000, v9
  v_cos_f32 v101, v27
  v_mfma_f32_16x16x32_bf16 v[108:111], v[140:143], a[40:43], v[108:111]
  v_sin_f32 v102, v27
  s_nop 0
  v_cvt_pk_bf16_f32 v34, v101, -v102
  v_mfma_f32_16x16x32_bf16 v[76:79], v[144:147], a[32:35], v[76:79]
  buffer_load_dwordx4 v10, s[12:15], s6 offen offset:2048 sc1 lds
  v_fmamk_f32 v27, v8, 0x41a80000, v9
  v_cos_f32 v101, v27
  v_mfma_f32_16x16x32_bf16 v[112:115], v[144:147], a[40:43], v[112:115]
  v_sin_f32 v102, v27
  s_nop 0
  v_cvt_pk_bf16_f32 v35, v101, -v102
  v_mfma_f32_16x16x32_bf16 v[80:83], v[148:151], a[32:35], v[80:83]
  buffer_load_dwordx4 v10, s[12:15], s6 offen offset:3072 sc1 lds
  v_fmamk_f32 v27, v8, 0x42000000, v9
  v_cos_f32 v101, v27
  v_mfma_f32_16x16x32_bf16 v[116:119], v[148:151], a[40:43], v[116:119]
  v_sin_f32 v102, v27
  s_nop 0
  v_cvt_pk_bf16_f32 v36, v101, -v102
  s_waitcnt vmcnt(12) lgkmcnt(0)
  s_barrier
  v_mfma_f32_16x16x32_bf16 v[20:23], v[152:155], a[36:39], v[20:23]
  ds_read_b64_tr_b16 v[120:121], v14 offset:32768
  ds_read_b64_tr_b16 v[122:123], v15 offset:32768
  v_mfma_f32_16x16x32_bf16 v[84:87], v[152:155], a[44:47], v[84:87]
  ds_read_b64_tr_b16 v[124:125], v14 offset:34816
  ds_read_b64_tr_b16 v[126:127], v15 offset:34816
  v_mfma_f32_16x16x32_bf16 v[56:59], v[156:159], a[36:39], v[56:59]
  ds_read_b64_tr_b16 v[128:129], v14 offset:36864
  ds_read_b64_tr_b16 v[130:131], v15 offset:36864
  v_mfma_f32_16x16x32_bf16 v[88:91], v[156:159], a[44:47], v[88:91]
  ds_read_b64_tr_b16 v[132:133], v14 offset:38912
  ds_read_b64_tr_b16 v[134:135], v15 offset:38912
  v_mfma_f32_16x16x32_bf16 v[60:63], v[160:163], a[36:39], v[60:63]
  ds_read_b64_tr_b16 v[136:137], v14 offset:40960
  ds_read_b64_tr_b16 v[138:139], v15 offset:40960
  v_mfma_f32_16x16x32_bf16 v[92:95], v[160:163], a[44:47], v[92:95]
  ds_read_b64_tr_b16 v[140:141], v14 offset:43008
  ds_read_b64_tr_b16 v[142:143], v15 offset:43008
  v_mfma_f32_16x16x32_bf16 v[64:67], v[164:167], a[36:39], v[64:67]
  ds_read_b64_tr_b16 v[144:145], v14 offset:45056
  ds_read_b64_tr_b16 v[146:147], v15 offset:45056
  v_mfma_f32_16x16x32_bf16 v[96:99], v[164:167], a[44:47], v[96:99]
  ds_read_b64_tr_b16 v[148:149], v14 offset:47104
  ds_read_b64_tr_b16 v[150:151], v15 offset:47104
  v_mfma_f32_16x16x32_bf16 v[68:71], v[168:171], a[36:39], v[68:71]
  s_add_u32 m0, s10, 36864
  s_nop 0
  buffer_load_dwordx4 v11, s[12:15], s6 offen offset:0 sc1 lds
  v_fmamk_f32 v27, v8, 0x42040000, v9
  v_cos_f32 v101, v27
  v_mfma_f32_16x16x32_bf16 v[104:107], v[168:171], a[44:47], v[104:107]
  v_sin_f32 v102, v27
  s_nop 0
  v_cvt_pk_bf16_f32 v37, v101, -v102
  v_mfma_f32_16x16x32_bf16 v[72:75], v[172:175], a[36:39], v[72:75]
  buffer_load_dwordx4 v11, s[12:15], s6 offen offset:1024 sc1 lds
  v_fmamk_f32 v27, v8, 0x42100000, v9
  v_cos_f32 v101, v27
  v_mfma_f32_16x16x32_bf16 v[108:111], v[172:175], a[44:47], v[108:111]
  v_sin_f32 v102, v27
  s_nop 0
  v_cvt_pk_bf16_f32 v38, v101, -v102
  v_mfma_f32_16x16x32_bf16 v[76:79], v[176:179], a[36:39], v[76:79]
  buffer_load_dwordx4 v11, s[12:15], s6 offen offset:2048 sc1 lds
  v_fmamk_f32 v27, v8, 0x42140000, v9
  v_cos_f32 v101, v27
  v_mfma_f32_16x16x32_bf16 v[112:115], v[176:179], a[44:47], v[112:115]
  v_sin_f32 v102, v27
  s_nop 0
  v_cvt_pk_bf16_f32 v39, v101, -v102
  v_mfma_f32_16x16x32_bf16 v[80:83], v[180:183], a[36:39], v[80:83]
  buffer_load_dwordx4 v11, s[12:15], s6 offen offset:3072 sc1 lds
  s_add_u32 s6, s6, 32768
  s_and_b32 s6, s6, 0x7ffff
  v_fmamk_f32 v27, v8, 0x42400000, v9
  v_cos_f32 v101, v27
  v_mfma_f32_16x16x32_bf16 v[116:119], v[180:183], a[44:47], v[116:119]
  v_sin_f32 v102, v27
  s_nop 0
  v_cvt_pk_bf16_f32 v40, v101, -v102
  s_waitcnt lgkmcnt(0)
  v_mfma_f32_16x16x32_bf16 v[20:23], v[120:123], a[48:51], v[20:23]
  ds_read_b64_tr_b16 v[152:153], v14 offset:33024
  ds_read_b64_tr_b16 v[154:155], v15 offset:33024
  v_mfma_f32_16x16x32_bf16 v[84:87], v[120:123], a[56:59], v[84:87]
  ds_read_b64_tr_b16 v[156:157], v14 offset:35072
  ds_read_b64_tr_b16 v[158:159], v15 offset:35072
  v_mfma_f32_16x16x32_bf16 v[56:59], v[124:127], a[48:51], v[56:59]
  ds_read_b64_tr_b16 v[160:161], v14 offset:37120
  ds_read_b64_tr_b16 v[162:163], v15 offset:37120
  v_mfma_f32_16x16x32_bf16 v[88:91], v[124:127], a[56:59], v[88:91]
  ds_read_b64_tr_b16 v[164:165], v14 offset:39168
  ds_read_b64_tr_b16 v[166:167], v15 offset:39168
  v_mfma_f32_16x16x32_bf16 v[60:63], v[128:131], a[48:51], v[60:63]
  ds_read_b64_tr_b16 v[168:169], v14 offset:41216
  ds_read_b64_tr_b16 v[170:171], v15 offset:41216
  v_mfma_f32_16x16x32_bf16 v[92:95], v[128:131], a[56:59], v[92:95]
  ds_read_b64_tr_b16 v[172:173], v14 offset:43264
  ds_read_b64_tr_b16 v[174:175], v15 offset:43264
  v_mfma_f32_16x16x32_bf16 v[64:67], v[132:135], a[48:51], v[64:67]
  ds_read_b64_tr_b16 v[176:177], v14 offset:45312
  ds_read_b64_tr_b16 v[178:179], v15 offset:45312
  v_mfma_f32_16x16x32_bf16 v[96:99], v[132:135], a[56:59], v[96:99]
  ds_read_b64_tr_b16 v[180:181], v14 offset:47360
  ds_read_b64_tr_b16 v[182:183], v15 offset:47360
  v_mfma_f32_16x16x32_bf16 v[68:71], v[136:139], a[48:51], v[68:71]
  s_add_u32 m0, s10, 65536
  s_nop 0
  buffer_load_dwordx4 v10, s[12:15], s6 offen offset:0 sc1 lds
  v_fmamk_f32 v27, v8, 0x42440000, v9
  v_cos_f32 v101, v27
  v_mfma_f32_16x16x32_bf16 v[104:107], v[136:139], a[56:59], v[104:107]
  v_sin_f32 v102, v27
  s_nop 0
  v_cvt_pk_bf16_f32 v41, v101, -v102
  v_mfma_f32_16x16x32_bf16 v[72:75], v[140:143], a[48:51], v[72:75]
  buffer_load_dwordx4 v10, s[12:15], s6 offen offset:1024 sc1 lds
  v_fmamk_f32 v27, v8, 0x42500000, v9
  v_cos_f32 v101, v27
  v_mfma_f32_16x16x32_bf16 v[108:111], v[140:143], a[56:59], v[108:111]
  v_sin_f32 v102, v27
  s_nop 0
  v_cvt_pk_bf16_f32 v42, v101, -v102
  v_mfma_f32_16x16x32_bf16 v[76:79], v[144:147], a[48:51], v[76:79]
  buffer_load_dwordx4 v10, s[12:15], s6 offen offset:2048 sc1 lds
  v_fmamk_f32 v27, v8, 0x42540000, v9
  v_cos_f32 v101, v27
  v_mfma_f32_16x16x32_bf16 v[112:115], v[144:147], a[56:59], v[112:115]
  v_sin_f32 v102, v27
  s_nop 0
  v_cvt_pk_bf16_f32 v43, v101, -v102
  v_mfma_f32_16x16x32_bf16 v[80:83], v[148:151], a[48:51], v[80:83]
  buffer_load_dwordx4 v10, s[12:15], s6 offen offset:3072 sc1 lds
  s_and_b32 s8, s3, 1
  s_lshl_b32 s8, s8, 6
  v_mfma_f32_16x16x32_bf16 v[116:119], v[148:151], a[56:59], v[116:119]
  s_add_u32 s8, s8, 16
  v_add_u32 v27, s8, v5
  s_waitcnt vmcnt(12) lgkmcnt(0)
  s_barrier
  v_mfma_f32_16x16x32_bf16 v[20:23], v[152:155], a[52:55], v[20:23]
  ds_read_b64_tr_b16 v[120:121], v12 offset:0
  ds_read_b64_tr_b16 v[122:123], v13 offset:0
  v_mfma_f32_16x16x32_bf16 v[84:87], v[152:155], a[60:63], v[84:87]
  ds_read_b64_tr_b16 v[124:125], v12 offset:2048
  ds_read_b64_tr_b16 v[126:127], v13 offset:2048
  v_mfma_f32_16x16x32_bf16 v[56:59], v[156:159], a[52:55], v[56:59]
  ds_read_b64_tr_b16 v[128:129], v12 offset:4096
  ds_read_b64_tr_b16 v[130:131], v13 offset:4096
  v_mfma_f32_16x16x32_bf16 v[88:91], v[156:159], a[60:63], v[88:91]
  ds_read_b64_tr_b16 v[132:133], v12 offset:6144
  ds_read_b64_tr_b16 v[134:135], v13 offset:6144
  v_mfma_f32_16x16x32_bf16 v[60:63], v[160:163], a[52:55], v[60:63]
  ds_read_b64_tr_b16 v[136:137], v12 offset:8192
  ds_read_b64_tr_b16 v[138:139], v13 offset:8192
  v_mfma_f32_16x16x32_bf16 v[92:95], v[160:163], a[60:63], v[92:95]
  ds_read_b64_tr_b16 v[140:141], v12 offset:10240
  ds_read_b64_tr_b16 v[142:143], v13 offset:10240
  v_mfma_f32_16x16x32_bf16 v[64:67], v[164:167], a[52:55], v[64:67]
  ds_read_b64_tr_b16 v[144:145], v12 offset:12288
  ds_read_b64_tr_b16 v[146:147], v13 offset:12288
  v_mfma_f32_16x16x32_bf16 v[96:99], v[164:167], a[60:63], v[96:99]
  ds_read_b64_tr_b16 v[148:149], v12 offset:14336
  ds_read_b64_tr_b16 v[150:151], v13 offset:14336
  v_mfma_f32_16x16x32_bf16 v[68:71], v[168:171], a[52:55], v[68:71]
  s_add_u32 m0, s10, 69632
  s_nop 0
  buffer_load_dwordx4 v11, s[12:15], s6 offen offset:0 sc1 lds
  v_cvt_f32_u32 v8, v27
  v_mul_f32 v8, 0x3c000000, v8
  v_mfma_f32_16x16x32_bf16 v[104:107], v[168:171], a[60:63], v[104:107]
  s_cmp_lg_u32 s3, 0
  s_cbranch_scc1 gated_mix__spectral_gfnet__ssm_conv_s5__prompt_kernel_skip32
  s_mov_b64 exec, 1
  buffer_store_dword v7, v24, s[48:51], s4 offen sc1
  s_mov_b64 exec, -1
gated_mix__spectral_gfnet__ssm_conv_s5__prompt_kernel_skip32:
  v_mul_f32 v9, v8, v26
  v_fmamk_f32 v27, v8, 0x0, v9
  v_mfma_f32_16x16x32_bf16 v[72:75], v[172:175], a[52:55], v[72:75]
  buffer_load_dwordx4 v11, s[12:15], s6 offen offset:1024 sc1 lds
  v_cos_f32 v101, v27
  v_sin_f32 v102, v27
  v_mfma_f32_16x16x32_bf16 v[108:111], v[172:175], a[60:63], v[108:111]
  v_cvt_pk_bf16_f32 v184, v101, -v102
  v_fmamk_f32 v27, v8, 0x3f800000, v9
  v_mfma_f32_16x16x32_bf16 v[76:79], v[176:179], a[52:55], v[76:79]
  buffer_load_dwordx4 v11, s[12:15], s6 offen offset:2048 sc1 lds
  v_cos_f32 v101, v27
  v_sin_f32 v102, v27
  v_mfma_f32_16x16x32_bf16 v[112:115], v[176:179], a[60:63], v[112:115]
  v_cvt_pk_bf16_f32 v185, v101, -v102
  v_fmamk_f32 v27, v8, 0x40800000, v9
  v_mfma_f32_16x16x32_bf16 v[80:83], v[180:183], a[52:55], v[80:83]
  buffer_load_dwordx4 v11, s[12:15], s6 offen offset:3072 sc1 lds
  s_add_u32 s6, s6, 32768
  s_and_b32 s6, s6, 0x7ffff
  v_cos_f32 v101, v27
  v_sin_f32 v102, v27
  v_mfma_f32_16x16x32_bf16 v[116:119], v[180:183], a[60:63], v[116:119]
  v_cvt_pk_bf16_f32 v186, v101, -v102
  v_fmamk_f32 v27, v8, 0x40a00000, v9
  s_waitcnt lgkmcnt(0)
  v_mfma_f32_16x16x32_bf16 v[20:23], v[120:123], a[64:67], v[20:23]
  ds_read_b64_tr_b16 v[152:153], v12 offset:256
  ds_read_b64_tr_b16 v[154:155], v13 offset:256
  v_mfma_f32_16x16x32_bf16 v[84:87], v[120:123], a[72:75], v[84:87]
  ds_read_b64_tr_b16 v[156:157], v12 offset:2304
  ds_read_b64_tr_b16 v[158:159], v13 offset:2304
  v_mfma_f32_16x16x32_bf16 v[56:59], v[124:127], a[64:67], v[56:59]
  ds_read_b64_tr_b16 v[160:161], v12 offset:4352
  ds_read_b64_tr_b16 v[162:163], v13 offset:4352
  v_mfma_f32_16x16x32_bf16 v[88:91], v[124:127], a[72:75], v[88:91]
  ds_read_b64_tr_b16 v[164:165], v12 offset:6400
  ds_read_b64_tr_b16 v[166:167], v13 offset:6400
  v_mfma_f32_16x16x32_bf16 v[60:63], v[128:131], a[64:67], v[60:63]
  ds_read_b64_tr_b16 v[168:169], v12 offset:8448
  ds_read_b64_tr_b16 v[170:171], v13 offset:8448
  v_mfma_f32_16x16x32_bf16 v[92:95], v[128:131], a[72:75], v[92:95]
  ds_read_b64_tr_b16 v[172:173], v12 offset:10496
  ds_read_b64_tr_b16 v[174:175], v13 offset:10496
  v_mfma_f32_16x16x32_bf16 v[64:67], v[132:135], a[64:67], v[64:67]
  ds_read_b64_tr_b16 v[176:177], v12 offset:12544
  ds_read_b64_tr_b16 v[178:179], v13 offset:12544
  v_mfma_f32_16x16x32_bf16 v[96:99], v[132:135], a[72:75], v[96:99]
  ds_read_b64_tr_b16 v[180:181], v12 offset:14592
  ds_read_b64_tr_b16 v[182:183], v13 offset:14592
  v_mfma_f32_16x16x32_bf16 v[68:71], v[136:139], a[64:67], v[68:71]
  s_add_u32 m0, s10, 98304
  s_nop 0
  buffer_load_dwordx4 v10, s[12:15], s6 offen offset:0 sc1 lds
  v_cos_f32 v101, v27
  v_sin_f32 v102, v27
  v_mfma_f32_16x16x32_bf16 v[104:107], v[136:139], a[72:75], v[104:107]
  v_cvt_pk_bf16_f32 v187, v101, -v102
  v_fmamk_f32 v27, v8, 0x41800000, v9
  v_mfma_f32_16x16x32_bf16 v[72:75], v[140:143], a[64:67], v[72:75]
  buffer_load_dwordx4 v10, s[12:15], s6 offen offset:1024 sc1 lds
  v_cos_f32 v101, v27
  v_sin_f32 v102, v27
  v_mfma_f32_16x16x32_bf16 v[108:111], v[140:143], a[72:75], v[108:111]
  v_cvt_pk_bf16_f32 v188, v101, -v102
  v_fmamk_f32 v27, v8, 0x41880000, v9
  v_mfma_f32_16x16x32_bf16 v[76:79], v[144:147], a[64:67], v[76:79]
  buffer_load_dwordx4 v10, s[12:15], s6 offen offset:2048 sc1 lds
  v_cos_f32 v101, v27
  v_sin_f32 v102, v27
  v_mfma_f32_16x16x32_bf16 v[112:115], v[144:147], a[72:75], v[112:115]
  v_cvt_pk_bf16_f32 v189, v101, -v102
  v_fmamk_f32 v27, v8, 0x41a00000, v9
  v_mfma_f32_16x16x32_bf16 v[80:83], v[148:151], a[64:67], v[80:83]
  buffer_load_dwordx4 v10, s[12:15], s6 offen offset:3072 sc1 lds
  v_cos_f32 v101, v27
  v_sin_f32 v102, v27
  v_mfma_f32_16x16x32_bf16 v[116:119], v[148:151], a[72:75], v[116:119]
  v_cvt_pk_bf16_f32 v190, v101, -v102
  v_fmamk_f32 v27, v8, 0x41a80000, v9
  s_waitcnt vmcnt(12) lgkmcnt(0)
  s_barrier
  v_mfma_f32_16x16x32_bf16 v[20:23], v[152:155], a[68:71], v[20:23]
  ds_read_b64_tr_b16 v[120:121], v12 offset:32768
  ds_read_b64_tr_b16 v[122:123], v13 offset:32768
  v_mfma_f32_16x16x32_bf16 v[84:87], v[152:155], a[76:79], v[84:87]
  ds_read_b64_tr_b16 v[124:125], v12 offset:34816
  ds_read_b64_tr_b16 v[126:127], v13 offset:34816
  v_mfma_f32_16x16x32_bf16 v[56:59], v[156:159], a[68:71], v[56:59]
  ds_read_b64_tr_b16 v[128:129], v12 offset:36864
  ds_read_b64_tr_b16 v[130:131], v13 offset:36864
  v_mfma_f32_16x16x32_bf16 v[88:91], v[156:159], a[76:79], v[88:91]
  ds_read_b64_tr_b16 v[132:133], v12 offset:38912
  ds_read_b64_tr_b16 v[134:135], v13 offset:38912
  v_mfma_f32_16x16x32_bf16 v[60:63], v[160:163], a[68:71], v[60:63]
  ds_read_b64_tr_b16 v[136:137], v12 offset:40960
  ds_read_b64_tr_b16 v[138:139], v13 offset:40960
  v_mfma_f32_16x16x32_bf16 v[92:95], v[160:163], a[76:79], v[92:95]
  ds_read_b64_tr_b16 v[140:141], v12 offset:43008
  ds_read_b64_tr_b16 v[142:143], v13 offset:43008
  v_mfma_f32_16x16x32_bf16 v[64:67], v[164:167], a[68:71], v[64:67]
  ds_read_b64_tr_b16 v[144:145], v12 offset:45056
  ds_read_b64_tr_b16 v[146:147], v13 offset:45056
  v_mfma_f32_16x16x32_bf16 v[96:99], v[164:167], a[76:79], v[96:99]
  ds_read_b64_tr_b16 v[148:149], v12 offset:47104
  ds_read_b64_tr_b16 v[150:151], v13 offset:47104
  v_mfma_f32_16x16x32_bf16 v[68:71], v[168:171], a[68:71], v[68:71]
  s_add_u32 m0, s10, 102400
  s_nop 0
  buffer_load_dwordx4 v11, s[12:15], s6 offen offset:0 sc1 lds
  v_cos_f32 v101, v27
  v_sin_f32 v102, v27
  v_mfma_f32_16x16x32_bf16 v[104:107], v[168:171], a[76:79], v[104:107]
  v_cvt_pk_bf16_f32 v191, v101, -v102
  v_fmamk_f32 v27, v8, 0x42000000, v9
  v_mfma_f32_16x16x32_bf16 v[72:75], v[172:175], a[68:71], v[72:75]
  buffer_load_dwordx4 v11, s[12:15], s6 offen offset:1024 sc1 lds
  v_cos_f32 v101, v27
  v_sin_f32 v102, v27
  v_mfma_f32_16x16x32_bf16 v[108:111], v[172:175], a[76:79], v[108:111]
  v_cvt_pk_bf16_f32 v192, v101, -v102
  v_fmamk_f32 v27, v8, 0x42040000, v9
  v_mfma_f32_16x16x32_bf16 v[76:79], v[176:179], a[68:71], v[76:79]
  buffer_load_dwordx4 v11, s[12:15], s6 offen offset:2048 sc1 lds
  v_cos_f32 v101, v27
  v_sin_f32 v102, v27
  v_mfma_f32_16x16x32_bf16 v[112:115], v[176:179], a[76:79], v[112:115]
  v_cvt_pk_bf16_f32 v193, v101, -v102
  v_fmamk_f32 v27, v8, 0x42100000, v9
  v_mfma_f32_16x16x32_bf16 v[80:83], v[180:183], a[68:71], v[80:83]
  buffer_load_dwordx4 v11, s[12:15], s6 offen offset:3072 sc1 lds
  s_add_u32 s6, s6, 32768
  s_and_b32 s6, s6, 0x7ffff
  v_cos_f32 v101, v27
  v_sin_f32 v102, v27
  v_mfma_f32_16x16x32_bf16 v[116:119], v[180:183], a[76:79], v[116:119]
  v_cvt_pk_bf16_f32 v194, v101, -v102
  v_fmamk_f32 v27, v8, 0x42140000, v9
  s_waitcnt lgkmcnt(0)
  v_mfma_f32_16x16x32_bf16 v[20:23], v[120:123], a[80:83], v[20:23]
  ds_read_b64_tr_b16 v[152:153], v12 offset:33024
  ds_read_b64_tr_b16 v[154:155], v13 offset:33024
  v_mfma_f32_16x16x32_bf16 v[84:87], v[120:123], a[88:91], v[84:87]
  ds_read_b64_tr_b16 v[156:157], v12 offset:35072
  ds_read_b64_tr_b16 v[158:159], v13 offset:35072
  v_mfma_f32_16x16x32_bf16 v[56:59], v[124:127], a[80:83], v[56:59]
  ds_read_b64_tr_b16 v[160:161], v12 offset:37120
  ds_read_b64_tr_b16 v[162:163], v13 offset:37120
  v_mfma_f32_16x16x32_bf16 v[88:91], v[124:127], a[88:91], v[88:91]
  ds_read_b64_tr_b16 v[164:165], v12 offset:39168
  ds_read_b64_tr_b16 v[166:167], v13 offset:39168
  v_mfma_f32_16x16x32_bf16 v[60:63], v[128:131], a[80:83], v[60:63]
  ds_read_b64_tr_b16 v[168:169], v12 offset:41216
  ds_read_b64_tr_b16 v[170:171], v13 offset:41216
  v_mfma_f32_16x16x32_bf16 v[92:95], v[128:131], a[88:91], v[92:95]
  ds_read_b64_tr_b16 v[172:173], v12 offset:43264
  ds_read_b64_tr_b16 v[174:175], v13 offset:43264
  v_mfma_f32_16x16x32_bf16 v[64:67], v[132:135], a[80:83], v[64:67]
  ds_read_b64_tr_b16 v[176:177], v12 offset:45312
  ds_read_b64_tr_b16 v[178:179], v13 offset:45312
  v_mfma_f32_16x16x32_bf16 v[96:99], v[132:135], a[88:91], v[96:99]
  ds_read_b64_tr_b16 v[180:181], v12 offset:47360
  ds_read_b64_tr_b16 v[182:183], v13 offset:47360
  v_mfma_f32_16x16x32_bf16 v[68:71], v[136:139], a[80:83], v[68:71]
  s_add_u32 m0, s10, 0
  s_nop 0
  buffer_load_dwordx4 v10, s[12:15], s6 offen offset:0 sc1 lds
  v_cos_f32 v101, v27
  v_sin_f32 v102, v27
  v_mfma_f32_16x16x32_bf16 v[104:107], v[136:139], a[88:91], v[104:107]
  v_cvt_pk_bf16_f32 v195, v101, -v102
  v_fmamk_f32 v27, v8, 0x42400000, v9
  v_mfma_f32_16x16x32_bf16 v[72:75], v[140:143], a[80:83], v[72:75]
  buffer_load_dwordx4 v10, s[12:15], s6 offen offset:1024 sc1 lds
  v_cos_f32 v101, v27
  v_sin_f32 v102, v27
  v_mfma_f32_16x16x32_bf16 v[108:111], v[140:143], a[88:91], v[108:111]
  v_cvt_pk_bf16_f32 v196, v101, -v102
  v_fmamk_f32 v27, v8, 0x42440000, v9
  v_mfma_f32_16x16x32_bf16 v[76:79], v[144:147], a[80:83], v[76:79]
  buffer_load_dwordx4 v10, s[12:15], s6 offen offset:2048 sc1 lds
  v_cos_f32 v101, v27
  v_sin_f32 v102, v27
  v_mfma_f32_16x16x32_bf16 v[112:115], v[144:147], a[88:91], v[112:115]
  v_cvt_pk_bf16_f32 v197, v101, -v102
  v_fmamk_f32 v27, v8, 0x42500000, v9
  v_mfma_f32_16x16x32_bf16 v[80:83], v[148:151], a[80:83], v[80:83]
  buffer_load_dwordx4 v10, s[12:15], s6 offen offset:3072 sc1 lds
  v_cos_f32 v101, v27
  v_sin_f32 v102, v27
  v_mfma_f32_16x16x32_bf16 v[116:119], v[148:151], a[88:91], v[116:119]
  v_cvt_pk_bf16_f32 v198, v101, -v102
  v_fmamk_f32 v27, v8, 0x42540000, v9
  s_waitcnt vmcnt(12) lgkmcnt(0)
  s_barrier
  v_mfma_f32_16x16x32_bf16 v[20:23], v[152:155], a[84:87], v[20:23]
  ds_read_b64_tr_b16 v[120:121], v14 offset:0
  ds_read_b64_tr_b16 v[122:123], v15 offset:0
  v_mfma_f32_16x16x32_bf16 v[84:87], v[152:155], a[92:95], v[84:87]
  ds_read_b64_tr_b16 v[124:125], v14 offset:2048
  ds_read_b64_tr_b16 v[126:127], v15 offset:2048
  v_mfma_f32_16x16x32_bf16 v[56:59], v[156:159], a[84:87], v[56:59]
  ds_read_b64_tr_b16 v[128:129], v14 offset:4096
  ds_read_b64_tr_b16 v[130:131], v15 offset:4096
  v_mfma_f32_16x16x32_bf16 v[88:91], v[156:159], a[92:95], v[88:91]
  ds_read_b64_tr_b16 v[132:133], v14 offset:6144
  ds_read_b64_tr_b16 v[134:135], v15 offset:6144
  v_mfma_f32_16x16x32_bf16 v[60:63], v[160:163], a[84:87], v[60:63]
  ds_read_b64_tr_b16 v[136:137], v14 offset:8192
  ds_read_b64_tr_b16 v[138:139], v15 offset:8192
  v_mfma_f32_16x16x32_bf16 v[92:95], v[160:163], a[92:95], v[92:95]
  ds_read_b64_tr_b16 v[140:141], v14 offset:10240
  ds_read_b64_tr_b16 v[142:143], v15 offset:10240
  v_mfma_f32_16x16x32_bf16 v[64:67], v[164:167], a[84:87], v[64:67]
  ds_read_b64_tr_b16 v[144:145], v14 offset:12288
  ds_read_b64_tr_b16 v[146:147], v15 offset:12288
  v_mfma_f32_16x16x32_bf16 v[96:99], v[164:167], a[92:95], v[96:99]
  ds_read_b64_tr_b16 v[148:149], v14 offset:14336
  ds_read_b64_tr_b16 v[150:151], v15 offset:14336
  v_mfma_f32_16x16x32_bf16 v[68:71], v[168:171], a[84:87], v[68:71]
  s_add_u32 m0, s10, 4096
  s_nop 0
  buffer_load_dwordx4 v11, s[12:15], s6 offen offset:0 sc1 lds
  v_cos_f32 v101, v27
  v_sin_f32 v102, v27
  v_mfma_f32_16x16x32_bf16 v[104:107], v[168:171], a[92:95], v[104:107]
  v_cvt_pk_bf16_f32 v199, v101, -v102
  v_lshlrev_b32 v101, 31, v5
  v_mfma_f32_16x16x32_bf16 v[72:75], v[172:175], a[84:87], v[72:75]
  buffer_load_dwordx4 v11, s[12:15], s6 offen offset:1024 sc1 lds
  v_or_b32 v101, 0x3f003f00, v101
  v_cmp_eq_u32 vcc, 0, v6
  v_mfma_f32_16x16x32_bf16 v[108:111], v[172:175], a[92:95], v[108:111]
  s_nop 0
  v_cndmask_b32 v28, v28, v101, vcc
  v_cndmask_b32 v184, v184, v101, vcc
  v_mfma_f32_16x16x32_bf16 v[76:79], v[176:179], a[84:87], v[76:79]
  buffer_load_dwordx4 v11, s[12:15], s6 offen offset:2048 sc1 lds
  s_lshl_b32 s11, s3, 13
  s_add_u32 s11, s11, 0
  v_mfma_f32_16x16x32_bf16 v[112:115], v[176:179], a[92:95], v[112:115]
  v_lshl_add_u32 v8, v4, 4, s11
  v_lshrrev_b32 v9, 5, v4
  v_mfma_f32_16x16x32_bf16 v[80:83], v[180:183], a[84:87], v[80:83]
  buffer_load_dwordx4 v11, s[12:15], s6 offen offset:3072 sc1 lds
  s_add_u32 s6, s6, 32768
  s_and_b32 s6, s6, 0x7ffff
  v_lshlrev_b32 v9, 9, v9
  v_bfe_u32 v27, v4, 3, 2
  v_mfma_f32_16x16x32_bf16 v[116:119], v[180:183], a[92:95], v[116:119]
  v_lshl_or_b32 v9, v27, 6, v9
  v_and_b32 v27, 3, v4
  s_waitcnt lgkmcnt(0)
  v_mfma_f32_16x16x32_bf16 v[20:23], v[120:123], a[96:99], v[20:23]
  ds_read_b64_tr_b16 v[152:153], v14 offset:256
  ds_read_b64_tr_b16 v[154:155], v15 offset:256
  v_mfma_f32_16x16x32_bf16 v[84:87], v[120:123], a[104:107], v[84:87]
  ds_read_b64_tr_b16 v[156:157], v14 offset:2304
  ds_read_b64_tr_b16 v[158:159], v15 offset:2304
  v_mfma_f32_16x16x32_bf16 v[56:59], v[124:127], a[96:99], v[56:59]
  ds_read_b64_tr_b16 v[160:161], v14 offset:4352
  ds_read_b64_tr_b16 v[162:163], v15 offset:4352
  v_mfma_f32_16x16x32_bf16 v[88:91], v[124:127], a[104:107], v[88:91]
  ds_read_b64_tr_b16 v[164:165], v14 offset:6400
  ds_read_b64_tr_b16 v[166:167], v15 offset:6400
  v_mfma_f32_16x16x32_bf16 v[60:63], v[128:131], a[96:99], v[60:63]
  ds_read_b64_tr_b16 v[168:169], v14 offset:8448
  ds_read_b64_tr_b16 v[170:171], v15 offset:8448
  v_mfma_f32_16x16x32_bf16 v[92:95], v[128:131], a[104:107], v[92:95]
  ds_read_b64_tr_b16 v[172:173], v14 offset:10496
  ds_read_b64_tr_b16 v[174:175], v15 offset:10496
  v_mfma_f32_16x16x32_bf16 v[64:67], v[132:135], a[96:99], v[64:67]
  ds_read_b64_tr_b16 v[176:177], v14 offset:12544
  ds_read_b64_tr_b16 v[178:179], v15 offset:12544
  v_mfma_f32_16x16x32_bf16 v[96:99], v[132:135], a[104:107], v[96:99]
  ds_read_b64_tr_b16 v[180:181], v14 offset:14592
  ds_read_b64_tr_b16 v[182:183], v15 offset:14592
  v_mfma_f32_16x16x32_bf16 v[68:71], v[136:139], a[96:99], v[68:71]
  s_add_u32 m0, s10, 32768
  s_nop 0
  buffer_load_dwordx4 v10, s[12:15], s6 offen offset:0 sc1 lds
  v_lshl_or_b32 v9, v27, 4, v9
  v_bfe_u32 v27, v4, 2, 1
  v_mfma_f32_16x16x32_bf16 v[104:107], v[136:139], a[104:107], v[104:107]
  v_lshl_or_b32 v9, v27, 3, v9
  s_lshr_b32 s11, s3, 1
  v_mfma_f32_16x16x32_bf16 v[72:75], v[140:143], a[96:99], v[72:75]
  buffer_load_dwordx4 v10, s[12:15], s6 offen offset:1024 sc1 lds
  s_lshl_b32 s11, s11, 13
  s_add_u32 s11, s11, 131072
  v_mfma_f32_16x16x32_bf16 v[108:111], v[140:143], a[104:107], v[108:111]
  v_add_u32 v9, s11, v9
  v_lshlrev_b32 v26, 18, v6
  v_mfma_f32_16x16x32_bf16 v[76:79], v[144:147], a[96:99], v[76:79]
  buffer_load_dwordx4 v10, s[12:15], s6 offen offset:2048 sc1 lds
  v_lshl_or_b32 v26, v5, 2, v26
  s_and_b32 s8, s3, 1
  v_mfma_f32_16x16x32_bf16 v[112:115], v[144:147], a[104:107], v[112:115]
  s_lshl_b32 s8, s8, 22
  s_lshl_b32 s11, s38, 12
  v_mfma_f32_16x16x32_bf16 v[80:83], v[148:151], a[96:99], v[80:83]
  buffer_load_dwordx4 v10, s[12:15], s6 offen offset:3072 sc1 lds
  s_add_u32 s8, s8, s11
  s_lshl_b32 s11, s39, 6
  v_mfma_f32_16x16x32_bf16 v[116:119], v[148:151], a[104:107], v[116:119]
  s_add_u32 s8, s8, s11
  s_lshr_b32 s11, s3, 1
  s_waitcnt vmcnt(12) lgkmcnt(0)
  s_barrier
  v_mfma_f32_16x16x32_bf16 v[20:23], v[152:155], a[100:103], v[20:23]
  ds_read_b64_tr_b16 v[120:121], v14 offset:32768
  ds_read_b64_tr_b16 v[122:123], v15 offset:32768
  v_mfma_f32_16x16x32_bf16 v[84:87], v[152:155], a[108:111], v[84:87]
  ds_read_b64_tr_b16 v[124:125], v14 offset:34816
  ds_read_b64_tr_b16 v[126:127], v15 offset:34816
  v_mfma_f32_16x16x32_bf16 v[56:59], v[156:159], a[100:103], v[56:59]
  ds_read_b64_tr_b16 v[128:129], v14 offset:36864
  ds_read_b64_tr_b16 v[130:131], v15 offset:36864
  v_mfma_f32_16x16x32_bf16 v[88:91], v[156:159], a[108:111], v[88:91]
  ds_read_b64_tr_b16 v[132:133], v14 offset:38912
  ds_read_b64_tr_b16 v[134:135], v15 offset:38912
  v_mfma_f32_16x16x32_bf16 v[60:63], v[160:163], a[100:103], v[60:63]
  ds_read_b64_tr_b16 v[136:137], v14 offset:40960
  ds_read_b64_tr_b16 v[138:139], v15 offset:40960
  v_mfma_f32_16x16x32_bf16 v[92:95], v[160:163], a[108:111], v[92:95]
  ds_read_b64_tr_b16 v[140:141], v14 offset:43008
  ds_read_b64_tr_b16 v[142:143], v15 offset:43008
  v_mfma_f32_16x16x32_bf16 v[64:67], v[164:167], a[100:103], v[64:67]
  ds_read_b64_tr_b16 v[144:145], v14 offset:45056
  ds_read_b64_tr_b16 v[146:147], v15 offset:45056
  v_mfma_f32_16x16x32_bf16 v[96:99], v[164:167], a[108:111], v[96:99]
  ds_read_b64_tr_b16 v[148:149], v14 offset:47104
  ds_read_b64_tr_b16 v[150:151], v15 offset:47104
  v_mfma_f32_16x16x32_bf16 v[68:71], v[168:171], a[100:103], v[68:71]
  s_add_u32 m0, s10, 36864
  s_nop 0
  buffer_load_dwordx4 v11, s[12:15], s6 offen offset:0 sc1 lds
  s_lshl_b32 s11, s11, 11
  s_add_u32 s8, s8, s11
  v_mfma_f32_16x16x32_bf16 v[104:107], v[168:171], a[108:111], v[104:107]
  v_mfma_f32_16x16x32_bf16 v[72:75], v[172:175], a[100:103], v[72:75]
  buffer_load_dwordx4 v11, s[12:15], s6 offen offset:1024 sc1 lds
  v_mfma_f32_16x16x32_bf16 v[108:111], v[172:175], a[108:111], v[108:111]
  v_mfma_f32_16x16x32_bf16 v[76:79], v[176:179], a[100:103], v[76:79]
  buffer_load_dwordx4 v11, s[12:15], s6 offen offset:2048 sc1 lds
  v_mfma_f32_16x16x32_bf16 v[112:115], v[176:179], a[108:111], v[112:115]
  v_mfma_f32_16x16x32_bf16 v[80:83], v[180:183], a[100:103], v[80:83]
  buffer_load_dwordx4 v11, s[12:15], s6 offen offset:3072 sc1 lds
  s_add_u32 s6, s6, 32768
  s_and_b32 s6, s6, 0x7ffff
  v_mfma_f32_16x16x32_bf16 v[116:119], v[180:183], a[108:111], v[116:119]
  s_waitcnt lgkmcnt(0)
  v_mfma_f32_16x16x32_bf16 v[20:23], v[120:123], a[112:115], v[20:23]
  ds_read_b64_tr_b16 v[152:153], v14 offset:33024
  ds_read_b64_tr_b16 v[154:155], v15 offset:33024
  v_mfma_f32_16x16x32_bf16 v[84:87], v[120:123], a[120:123], v[84:87]
  ds_read_b64_tr_b16 v[156:157], v14 offset:35072
  ds_read_b64_tr_b16 v[158:159], v15 offset:35072
  v_mfma_f32_16x16x32_bf16 v[56:59], v[124:127], a[112:115], v[56:59]
  ds_read_b64_tr_b16 v[160:161], v14 offset:37120
  ds_read_b64_tr_b16 v[162:163], v15 offset:37120
  v_mfma_f32_16x16x32_bf16 v[88:91], v[124:127], a[120:123], v[88:91]
  ds_read_b64_tr_b16 v[164:165], v14 offset:39168
  ds_read_b64_tr_b16 v[166:167], v15 offset:39168
  v_mfma_f32_16x16x32_bf16 v[60:63], v[128:131], a[112:115], v[60:63]
  ds_read_b64_tr_b16 v[168:169], v14 offset:41216
  ds_read_b64_tr_b16 v[170:171], v15 offset:41216
  v_mfma_f32_16x16x32_bf16 v[92:95], v[128:131], a[120:123], v[92:95]
  ds_read_b64_tr_b16 v[172:173], v14 offset:43264
  ds_read_b64_tr_b16 v[174:175], v15 offset:43264
  v_mfma_f32_16x16x32_bf16 v[64:67], v[132:135], a[112:115], v[64:67]
  ds_read_b64_tr_b16 v[176:177], v14 offset:45312
  ds_read_b64_tr_b16 v[178:179], v15 offset:45312
  v_mfma_f32_16x16x32_bf16 v[96:99], v[132:135], a[120:123], v[96:99]
  ds_read_b64_tr_b16 v[180:181], v14 offset:47360
  ds_read_b64_tr_b16 v[182:183], v15 offset:47360
  v_mfma_f32_16x16x32_bf16 v[68:71], v[136:139], a[112:115], v[68:71]
  s_add_u32 m0, s10, 65536
  s_nop 0
  buffer_load_dwordx4 v10, s[12:15], s6 offen offset:0 sc1 lds
  v_mfma_f32_16x16x32_bf16 v[104:107], v[136:139], a[120:123], v[104:107]
  v_mfma_f32_16x16x32_bf16 v[72:75], v[140:143], a[112:115], v[72:75]
  buffer_load_dwordx4 v10, s[12:15], s6 offen offset:1024 sc1 lds
  v_mfma_f32_16x16x32_bf16 v[108:111], v[140:143], a[120:123], v[108:111]
  v_mfma_f32_16x16x32_bf16 v[76:79], v[144:147], a[112:115], v[76:79]
  buffer_load_dwordx4 v10, s[12:15], s6 offen offset:2048 sc1 lds
  v_mfma_f32_16x16x32_bf16 v[112:115], v[144:147], a[120:123], v[112:115]
  v_mfma_f32_16x16x32_bf16 v[80:83], v[148:151], a[112:115], v[80:83]
  buffer_load_dwordx4 v10, s[12:15], s6 offen offset:3072 sc1 lds
  v_mfma_f32_16x16x32_bf16 v[116:119], v[148:151], a[120:123], v[116:119]
  s_waitcnt vmcnt(12) lgkmcnt(0)
  s_barrier
  v_mfma_f32_16x16x32_bf16 v[20:23], v[152:155], a[116:119], v[20:23]
  ds_read_b64_tr_b16 v[120:121], v12 offset:0
  ds_read_b64_tr_b16 v[122:123], v13 offset:0
  v_mfma_f32_16x16x32_bf16 v[84:87], v[152:155], a[124:127], v[84:87]
  ds_read_b64_tr_b16 v[124:125], v12 offset:2048
  ds_read_b64_tr_b16 v[126:127], v13 offset:2048
  v_mfma_f32_16x16x32_bf16 v[56:59], v[156:159], a[116:119], v[56:59]
  ds_read_b64_tr_b16 v[128:129], v12 offset:4096
  ds_read_b64_tr_b16 v[130:131], v13 offset:4096
  v_mfma_f32_16x16x32_bf16 v[88:91], v[156:159], a[124:127], v[88:91]
  ds_read_b64_tr_b16 v[132:133], v12 offset:6144
  ds_read_b64_tr_b16 v[134:135], v13 offset:6144
  v_mfma_f32_16x16x32_bf16 v[60:63], v[160:163], a[116:119], v[60:63]
  ds_read_b64_tr_b16 v[136:137], v12 offset:8192
  ds_read_b64_tr_b16 v[138:139], v13 offset:8192
  v_mfma_f32_16x16x32_bf16 v[92:95], v[160:163], a[124:127], v[92:95]
  ds_read_b64_tr_b16 v[140:141], v12 offset:10240
  ds_read_b64_tr_b16 v[142:143], v13 offset:10240
  v_mfma_f32_16x16x32_bf16 v[64:67], v[164:167], a[116:119], v[64:67]
  ds_read_b64_tr_b16 v[144:145], v12 offset:12288
  ds_read_b64_tr_b16 v[146:147], v13 offset:12288
  v_mfma_f32_16x16x32_bf16 v[96:99], v[164:167], a[124:127], v[96:99]
  ds_read_b64_tr_b16 v[148:149], v12 offset:14336
  ds_read_b64_tr_b16 v[150:151], v13 offset:14336
  v_mfma_f32_16x16x32_bf16 v[68:71], v[168:171], a[116:119], v[68:71]
  s_add_u32 m0, s10, 69632
  s_nop 0
  buffer_load_dwordx4 v11, s[12:15], s6 offen offset:0 sc1 lds
  v_mfma_f32_16x16x32_bf16 v[104:107], v[168:171], a[124:127], v[104:107]
  v_mfma_f32_16x16x32_bf16 v[72:75], v[172:175], a[116:119], v[72:75]
  buffer_load_dwordx4 v11, s[12:15], s6 offen offset:1024 sc1 lds
  v_mfma_f32_16x16x32_bf16 v[108:111], v[172:175], a[124:127], v[108:111]
  v_mfma_f32_16x16x32_bf16 v[76:79], v[176:179], a[116:119], v[76:79]
  buffer_load_dwordx4 v11, s[12:15], s6 offen offset:2048 sc1 lds
  v_mfma_f32_16x16x32_bf16 v[112:115], v[176:179], a[124:127], v[112:115]
  v_mfma_f32_16x16x32_bf16 v[80:83], v[180:183], a[116:119], v[80:83]
  buffer_load_dwordx4 v11, s[12:15], s6 offen offset:3072 sc1 lds
  s_add_u32 s6, s6, 32768
  s_and_b32 s6, s6, 0x7ffff
  v_mfma_f32_16x16x32_bf16 v[116:119], v[180:183], a[124:127], v[116:119]
  s_waitcnt lgkmcnt(0)
  v_mfma_f32_16x16x32_bf16 v[20:23], v[120:123], a[128:131], v[20:23]
  ds_read_b64_tr_b16 v[152:153], v12 offset:256
  ds_read_b64_tr_b16 v[154:155], v13 offset:256
  v_mfma_f32_16x16x32_bf16 v[84:87], v[120:123], a[136:139], v[84:87]
  ds_read_b64_tr_b16 v[156:157], v12 offset:2304
  ds_read_b64_tr_b16 v[158:159], v13 offset:2304
  v_mfma_f32_16x16x32_bf16 v[56:59], v[124:127], a[128:131], v[56:59]
  ds_read_b64_tr_b16 v[160:161], v12 offset:4352
  ds_read_b64_tr_b16 v[162:163], v13 offset:4352
  v_mfma_f32_16x16x32_bf16 v[88:91], v[124:127], a[136:139], v[88:91]
  ds_read_b64_tr_b16 v[164:165], v12 offset:6400
  ds_read_b64_tr_b16 v[166:167], v13 offset:6400
  v_mfma_f32_16x16x32_bf16 v[60:63], v[128:131], a[128:131], v[60:63]
  ds_read_b64_tr_b16 v[168:169], v12 offset:8448
  ds_read_b64_tr_b16 v[170:171], v13 offset:8448
  v_mfma_f32_16x16x32_bf16 v[92:95], v[128:131], a[136:139], v[92:95]
  ds_read_b64_tr_b16 v[172:173], v12 offset:10496
  ds_read_b64_tr_b16 v[174:175], v13 offset:10496
  v_mfma_f32_16x16x32_bf16 v[64:67], v[132:135], a[128:131], v[64:67]
  ds_read_b64_tr_b16 v[176:177], v12 offset:12544
  ds_read_b64_tr_b16 v[178:179], v13 offset:12544
  v_mfma_f32_16x16x32_bf16 v[96:99], v[132:135], a[136:139], v[96:99]
  ds_read_b64_tr_b16 v[180:181], v12 offset:14592
  ds_read_b64_tr_b16 v[182:183], v13 offset:14592
  v_mfma_f32_16x16x32_bf16 v[68:71], v[136:139], a[128:131], v[68:71]
  s_add_u32 m0, s10, 98304
  s_nop 0
  buffer_load_dwordx4 v10, s[12:15], s6 offen offset:0 sc1 lds
  v_mfma_f32_16x16x32_bf16 v[104:107], v[136:139], a[136:139], v[104:107]
  v_mfma_f32_16x16x32_bf16 v[72:75], v[140:143], a[128:131], v[72:75]
  buffer_load_dwordx4 v10, s[12:15], s6 offen offset:1024 sc1 lds
  v_mfma_f32_16x16x32_bf16 v[108:111], v[140:143], a[136:139], v[108:111]
  v_mfma_f32_16x16x32_bf16 v[76:79], v[144:147], a[128:131], v[76:79]
  buffer_load_dwordx4 v10, s[12:15], s6 offen offset:2048 sc1 lds
  v_mfma_f32_16x16x32_bf16 v[112:115], v[144:147], a[136:139], v[112:115]
  v_mfma_f32_16x16x32_bf16 v[80:83], v[148:151], a[128:131], v[80:83]
  buffer_load_dwordx4 v10, s[12:15], s6 offen offset:3072 sc1 lds
  v_mfma_f32_16x16x32_bf16 v[116:119], v[148:151], a[136:139], v[116:119]
  s_waitcnt vmcnt(12) lgkmcnt(0)
  s_barrier
  v_mfma_f32_16x16x32_bf16 v[20:23], v[152:155], a[132:135], v[20:23]
  ds_read_b64_tr_b16 v[120:121], v12 offset:32768
  ds_read_b64_tr_b16 v[122:123], v13 offset:32768
  v_mfma_f32_16x16x32_bf16 v[84:87], v[152:155], a[140:143], v[84:87]
  ds_read_b64_tr_b16 v[124:125], v12 offset:34816
  ds_read_b64_tr_b16 v[126:127], v13 offset:34816
  v_mfma_f32_16x16x32_bf16 v[56:59], v[156:159], a[132:135], v[56:59]
  ds_read_b64_tr_b16 v[128:129], v12 offset:36864
  ds_read_b64_tr_b16 v[130:131], v13 offset:36864
  v_mfma_f32_16x16x32_bf16 v[88:91], v[156:159], a[140:143], v[88:91]
  ds_read_b64_tr_b16 v[132:133], v12 offset:38912
  ds_read_b64_tr_b16 v[134:135], v13 offset:38912
  v_mfma_f32_16x16x32_bf16 v[60:63], v[160:163], a[132:135], v[60:63]
  ds_read_b64_tr_b16 v[136:137], v12 offset:40960
  ds_read_b64_tr_b16 v[138:139], v13 offset:40960
  v_mfma_f32_16x16x32_bf16 v[92:95], v[160:163], a[140:143], v[92:95]
  ds_read_b64_tr_b16 v[140:141], v12 offset:43008
  ds_read_b64_tr_b16 v[142:143], v13 offset:43008
  v_mfma_f32_16x16x32_bf16 v[64:67], v[164:167], a[132:135], v[64:67]
  ds_read_b64_tr_b16 v[144:145], v12 offset:45056
  ds_read_b64_tr_b16 v[146:147], v13 offset:45056
  v_mfma_f32_16x16x32_bf16 v[96:99], v[164:167], a[140:143], v[96:99]
  ds_read_b64_tr_b16 v[148:149], v12 offset:47104
  ds_read_b64_tr_b16 v[150:151], v13 offset:47104
  v_mfma_f32_16x16x32_bf16 v[68:71], v[168:171], a[132:135], v[68:71]
  s_add_u32 m0, s10, 102400
  s_nop 0
  buffer_load_dwordx4 v11, s[12:15], s6 offen offset:0 sc1 lds
  v_mfma_f32_16x16x32_bf16 v[104:107], v[168:171], a[140:143], v[104:107]
  buffer_load_dword v103, v3, s[48:51], s4 offen sc1
  v_mfma_f32_16x16x32_bf16 v[72:75], v[172:175], a[132:135], v[72:75]
  buffer_load_dwordx4 v11, s[12:15], s6 offen offset:1024 sc1 lds
  v_mfma_f32_16x16x32_bf16 v[108:111], v[172:175], a[140:143], v[108:111]
  v_mfma_f32_16x16x32_bf16 v[76:79], v[176:179], a[132:135], v[76:79]
  buffer_load_dwordx4 v11, s[12:15], s6 offen offset:2048 sc1 lds
  v_mfma_f32_16x16x32_bf16 v[112:115], v[176:179], a[140:143], v[112:115]
  v_mfma_f32_16x16x32_bf16 v[80:83], v[180:183], a[132:135], v[80:83]
  buffer_load_dwordx4 v11, s[12:15], s6 offen offset:3072 sc1 lds
  s_add_u32 s6, s6, 32768
  s_and_b32 s6, s6, 0x7ffff
  v_mfma_f32_16x16x32_bf16 v[116:119], v[180:183], a[140:143], v[116:119]
  s_waitcnt lgkmcnt(0)
  v_mfma_f32_16x16x32_bf16 v[20:23], v[120:123], a[144:147], v[20:23]
  ds_read_b64_tr_b16 v[152:153], v12 offset:33024
  ds_read_b64_tr_b16 v[154:155], v13 offset:33024
  v_mfma_f32_16x16x32_bf16 v[84:87], v[120:123], a[152:155], v[84:87]
  ds_read_b64_tr_b16 v[156:157], v12 offset:35072
  ds_read_b64_tr_b16 v[158:159], v13 offset:35072
  v_mfma_f32_16x16x32_bf16 v[56:59], v[124:127], a[144:147], v[56:59]
  ds_read_b64_tr_b16 v[160:161], v12 offset:37120
  ds_read_b64_tr_b16 v[162:163], v13 offset:37120
  v_mfma_f32_16x16x32_bf16 v[88:91], v[124:127], a[152:155], v[88:91]
  ds_read_b64_tr_b16 v[164:165], v12 offset:39168
  ds_read_b64_tr_b16 v[166:167], v13 offset:39168
  v_mfma_f32_16x16x32_bf16 v[60:63], v[128:131], a[144:147], v[60:63]
  ds_read_b64_tr_b16 v[168:169], v12 offset:41216
  ds_read_b64_tr_b16 v[170:171], v13 offset:41216
  v_mfma_f32_16x16x32_bf16 v[92:95], v[128:131], a[152:155], v[92:95]
  ds_read_b64_tr_b16 v[172:173], v12 offset:43264
  ds_read_b64_tr_b16 v[174:175], v13 offset:43264
  v_mfma_f32_16x16x32_bf16 v[64:67], v[132:135], a[144:147], v[64:67]
  ds_read_b64_tr_b16 v[176:177], v12 offset:45312
  ds_read_b64_tr_b16 v[178:179], v13 offset:45312
  v_mfma_f32_16x16x32_bf16 v[96:99], v[132:135], a[152:155], v[96:99]
  ds_read_b64_tr_b16 v[180:181], v12 offset:47360
  ds_read_b64_tr_b16 v[182:183], v13 offset:47360
  v_mfma_f32_16x16x32_bf16 v[68:71], v[136:139], a[144:147], v[68:71]
  s_add_u32 m0, s10, 0
  s_nop 0
  buffer_load_dwordx4 v10, s[12:15], s6 offen offset:0 sc1 lds
  v_mfma_f32_16x16x32_bf16 v[104:107], v[136:139], a[152:155], v[104:107]
  v_mfma_f32_16x16x32_bf16 v[72:75], v[140:143], a[144:147], v[72:75]
  buffer_load_dwordx4 v10, s[12:15], s6 offen offset:1024 sc1 lds
  v_mfma_f32_16x16x32_bf16 v[108:111], v[140:143], a[152:155], v[108:111]
  v_mfma_f32_16x16x32_bf16 v[76:79], v[144:147], a[144:147], v[76:79]
  buffer_load_dwordx4 v10, s[12:15], s6 offen offset:2048 sc1 lds
  v_mfma_f32_16x16x32_bf16 v[112:115], v[144:147], a[152:155], v[112:115]
  v_mfma_f32_16x16x32_bf16 v[80:83], v[148:151], a[144:147], v[80:83]
  buffer_load_dwordx4 v10, s[12:15], s6 offen offset:3072 sc1 lds
  v_mfma_f32_16x16x32_bf16 v[116:119], v[148:151], a[152:155], v[116:119]
  s_waitcnt vmcnt(13) lgkmcnt(0)
  s_barrier
  v_mfma_f32_16x16x32_bf16 v[20:23], v[152:155], a[148:151], v[20:23]
  ds_read_b64_tr_b16 v[120:121], v14 offset:0
  ds_read_b64_tr_b16 v[122:123], v15 offset:0
  v_mfma_f32_16x16x32_bf16 v[84:87], v[152:155], a[156:159], v[84:87]
  ds_read_b64_tr_b16 v[124:125], v14 offset:2048
  ds_read_b64_tr_b16 v[126:127], v15 offset:2048
  v_mfma_f32_16x16x32_bf16 v[56:59], v[156:159], a[148:151], v[56:59]
  ds_read_b64_tr_b16 v[128:129], v14 offset:4096
  ds_read_b64_tr_b16 v[130:131], v15 offset:4096
  v_mfma_f32_16x16x32_bf16 v[88:91], v[156:159], a[156:159], v[88:91]
  ds_read_b64_tr_b16 v[132:133], v14 offset:6144
  ds_read_b64_tr_b16 v[134:135], v15 offset:6144
  v_mfma_f32_16x16x32_bf16 v[60:63], v[160:163], a[148:151], v[60:63]
  ds_read_b64_tr_b16 v[136:137], v14 offset:8192
  ds_read_b64_tr_b16 v[138:139], v15 offset:8192
  v_mfma_f32_16x16x32_bf16 v[92:95], v[160:163], a[156:159], v[92:95]
  ds_read_b64_tr_b16 v[140:141], v14 offset:10240
  ds_read_b64_tr_b16 v[142:143], v15 offset:10240
  v_mfma_f32_16x16x32_bf16 v[64:67], v[164:167], a[148:151], v[64:67]
  ds_read_b64_tr_b16 v[144:145], v14 offset:12288
  ds_read_b64_tr_b16 v[146:147], v15 offset:12288
  v_mfma_f32_16x16x32_bf16 v[96:99], v[164:167], a[156:159], v[96:99]
  ds_read_b64_tr_b16 v[148:149], v14 offset:14336
  ds_read_b64_tr_b16 v[150:151], v15 offset:14336
  v_mfma_f32_16x16x32_bf16 v[68:71], v[168:171], a[148:151], v[68:71]
  s_add_u32 m0, s10, 4096
  s_nop 0
  buffer_load_dwordx4 v11, s[12:15], s6 offen offset:0 sc1 lds
  v_mfma_f32_16x16x32_bf16 v[104:107], v[168:171], a[156:159], v[104:107]
  v_mfma_f32_16x16x32_bf16 v[72:75], v[172:175], a[148:151], v[72:75]
  buffer_load_dwordx4 v11, s[12:15], s6 offen offset:1024 sc1 lds
  v_mfma_f32_16x16x32_bf16 v[108:111], v[172:175], a[156:159], v[108:111]
  v_mfma_f32_16x16x32_bf16 v[76:79], v[176:179], a[148:151], v[76:79]
  buffer_load_dwordx4 v11, s[12:15], s6 offen offset:2048 sc1 lds
  v_mfma_f32_16x16x32_bf16 v[112:115], v[176:179], a[156:159], v[112:115]
  v_mfma_f32_16x16x32_bf16 v[80:83], v[180:183], a[148:151], v[80:83]
  buffer_load_dwordx4 v11, s[12:15], s6 offen offset:3072 sc1 lds
  s_add_u32 s6, s6, 32768
  s_and_b32 s6, s6, 0x7ffff
  v_mfma_f32_16x16x32_bf16 v[116:119], v[180:183], a[156:159], v[116:119]
  s_waitcnt lgkmcnt(0)
  v_mfma_f32_16x16x32_bf16 v[20:23], v[120:123], a[160:163], v[20:23]
  ds_read_b64_tr_b16 v[152:153], v14 offset:256
  ds_read_b64_tr_b16 v[154:155], v15 offset:256
  v_mfma_f32_16x16x32_bf16 v[84:87], v[120:123], a[168:171], v[84:87]
  ds_read_b64_tr_b16 v[156:157], v14 offset:2304
  ds_read_b64_tr_b16 v[158:159], v15 offset:2304
  v_mfma_f32_16x16x32_bf16 v[56:59], v[124:127], a[160:163], v[56:59]
  ds_read_b64_tr_b16 v[160:161], v14 offset:4352
  ds_read_b64_tr_b16 v[162:163], v15 offset:4352
  v_mfma_f32_16x16x32_bf16 v[88:91], v[124:127], a[168:171], v[88:91]
  ds_read_b64_tr_b16 v[164:165], v14 offset:6400
  ds_read_b64_tr_b16 v[166:167], v15 offset:6400
  v_mfma_f32_16x16x32_bf16 v[60:63], v[128:131], a[160:163], v[60:63]
  ds_read_b64_tr_b16 v[168:169], v14 offset:8448
  ds_read_b64_tr_b16 v[170:171], v15 offset:8448
  v_mfma_f32_16x16x32_bf16 v[92:95], v[128:131], a[168:171], v[92:95]
  ds_read_b64_tr_b16 v[172:173], v14 offset:10496
  ds_read_b64_tr_b16 v[174:175], v15 offset:10496
  v_mfma_f32_16x16x32_bf16 v[64:67], v[132:135], a[160:163], v[64:67]
  ds_read_b64_tr_b16 v[176:177], v14 offset:12544
  ds_read_b64_tr_b16 v[178:179], v15 offset:12544
  v_mfma_f32_16x16x32_bf16 v[96:99], v[132:135], a[168:171], v[96:99]
  ds_read_b64_tr_b16 v[180:181], v14 offset:14592
  ds_read_b64_tr_b16 v[182:183], v15 offset:14592
  v_mfma_f32_16x16x32_bf16 v[68:71], v[136:139], a[160:163], v[68:71]
  s_add_u32 m0, s10, 32768
  s_nop 0
  buffer_load_dwordx4 v10, s[12:15], s6 offen offset:0 sc1 lds
  v_mfma_f32_16x16x32_bf16 v[104:107], v[136:139], a[168:171], v[104:107]
  v_mfma_f32_16x16x32_bf16 v[72:75], v[140:143], a[160:163], v[72:75]
  buffer_load_dwordx4 v10, s[12:15], s6 offen offset:1024 sc1 lds
  v_mfma_f32_16x16x32_bf16 v[108:111], v[140:143], a[168:171], v[108:111]
  v_mfma_f32_16x16x32_bf16 v[76:79], v[144:147], a[160:163], v[76:79]
  buffer_load_dwordx4 v10, s[12:15], s6 offen offset:2048 sc1 lds
  v_mfma_f32_16x16x32_bf16 v[112:115], v[144:147], a[168:171], v[112:115]
  v_mfma_f32_16x16x32_bf16 v[80:83], v[148:151], a[160:163], v[80:83]
  buffer_load_dwordx4 v10, s[12:15], s6 offen offset:3072 sc1 lds
  v_mfma_f32_16x16x32_bf16 v[116:119], v[148:151], a[168:171], v[116:119]
  s_waitcnt vmcnt(15)
  v_cmp_ne_u32 vcc, 1, v103
  s_nop 0
  s_cbranch_vccz gated_mix__spectral_gfnet__ssm_conv_s5__prompt_kernel_skip33
  s_mov_b32 s7, 0
gated_mix__spectral_gfnet__ssm_conv_s5__prompt_kernel_poll34:
  s_sleep 2
  buffer_load_dword v103, v3, s[48:51], s4 offen sc1
  s_waitcnt vmcnt(0)
  v_cmp_ne_u32 vcc, 1, v103
  s_nop 0
  s_cbranch_vccz gated_mix__spectral_gfnet__ssm_conv_s5__prompt_kernel_pollout35
  s_add_u32 s7, s7, 1
  s_cmp_lt_u32 s7, 1048576
  s_cbranch_scc1 gated_mix__spectral_gfnet__ssm_conv_s5__prompt_kernel_poll34
gated_mix__spectral_gfnet__ssm_conv_s5__prompt_kernel_pollout35:
gated_mix__spectral_gfnet__ssm_conv_s5__prompt_kernel_skip33:
  s_waitcnt vmcnt(12) lgkmcnt(0)
  s_barrier
  v_mfma_f32_16x16x32_bf16 v[20:23], v[152:155], a[164:167], v[20:23]
  ds_read_b64_tr_b16 v[120:121], v14 offset:32768
  ds_read_b64_tr_b16 v[122:123], v15 offset:32768
  v_mfma_f32_16x16x32_bf16 v[84:87], v[152:155], a[172:175], v[84:87]
  ds_read_b64_tr_b16 v[124:125], v14 offset:34816
  ds_read_b64_tr_b16 v[126:127], v15 offset:34816
  v_mfma_f32_16x16x32_bf16 v[56:59], v[156:159], a[164:167], v[56:59]
  ds_read_b64_tr_b16 v[128:129], v14 offset:36864
  ds_read_b64_tr_b16 v[130:131], v15 offset:36864
  v_mfma_f32_16x16x32_bf16 v[88:91], v[156:159], a[172:175], v[88:91]
  ds_read_b64_tr_b16 v[132:133], v14 offset:38912
  ds_read_b64_tr_b16 v[134:135], v15 offset:38912
  v_mfma_f32_16x16x32_bf16 v[60:63], v[160:163], a[164:167], v[60:63]
  ds_read_b64_tr_b16 v[136:137], v14 offset:40960
  ds_read_b64_tr_b16 v[138:139], v15 offset:40960
  v_mfma_f32_16x16x32_bf16 v[92:95], v[160:163], a[172:175], v[92:95]
  ds_read_b64_tr_b16 v[140:141], v14 offset:43008
  ds_read_b64_tr_b16 v[142:143], v15 offset:43008
  v_mfma_f32_16x16x32_bf16 v[64:67], v[164:167], a[164:167], v[64:67]
  ds_read_b64_tr_b16 v[144:145], v14 offset:45056
  ds_read_b64_tr_b16 v[146:147], v15 offset:45056
  v_mfma_f32_16x16x32_bf16 v[96:99], v[164:167], a[172:175], v[96:99]
  ds_read_b64_tr_b16 v[148:149], v14 offset:47104
  ds_read_b64_tr_b16 v[150:151], v15 offset:47104
  v_mfma_f32_16x16x32_bf16 v[68:71], v[168:171], a[164:167], v[68:71]
  s_add_u32 m0, s10, 36864
  s_nop 0
  buffer_load_dwordx4 v11, s[12:15], s6 offen offset:0 sc1 lds
  v_mfma_f32_16x16x32_bf16 v[104:107], v[168:171], a[172:175], v[104:107]
  v_lshlrev_b32 v27, 4, v4
  s_lshl_b32 s7, s38, 4
  s_add_u32 s7, s7, s39
  s_mul_i32 s7, s7, 16384
  s_lshl_b32 s11, s3, 12
  s_add_u32 s7, s7, s11
  buffer_load_dwordx4 v[16:19], v27, s[20:23], s7 offen offset:0 sc1
  buffer_load_dwordx4 v[44:47], v27, s[20:23], s7 offen offset:1024 sc1
  buffer_load_dwordx4 v[48:51], v27, s[20:23], s7 offen offset:2048 sc1
  buffer_load_dwordx4 v[52:55], v27, s[20:23], s7 offen offset:3072 sc1
  v_mfma_f32_16x16x32_bf16 v[72:75], v[172:175], a[164:167], v[72:75]
  buffer_load_dwordx4 v11, s[12:15], s6 offen offset:1024 sc1 lds
  v_mfma_f32_16x16x32_bf16 v[108:111], v[172:175], a[172:175], v[108:111]
  v_mfma_f32_16x16x32_bf16 v[76:79], v[176:179], a[164:167], v[76:79]
  buffer_load_dwordx4 v11, s[12:15], s6 offen offset:2048 sc1 lds
  v_mfma_f32_16x16x32_bf16 v[112:115], v[176:179], a[172:175], v[112:115]
  v_mfma_f32_16x16x32_bf16 v[80:83], v[180:183], a[164:167], v[80:83]
  buffer_load_dwordx4 v11, s[12:15], s6 offen offset:3072 sc1 lds
  s_add_u32 s6, s6, 32768
  s_and_b32 s6, s6, 0x7ffff
  v_mfma_f32_16x16x32_bf16 v[116:119], v[180:183], a[172:175], v[116:119]
  s_waitcnt lgkmcnt(0)
  v_mfma_f32_16x16x32_bf16 v[20:23], v[120:123], a[176:179], v[20:23]
  ds_read_b64_tr_b16 v[152:153], v14 offset:33024
  ds_read_b64_tr_b16 v[154:155], v15 offset:33024
  v_mfma_f32_16x16x32_bf16 v[84:87], v[120:123], a[184:187], v[84:87]
  ds_read_b64_tr_b16 v[156:157], v14 offset:35072
  ds_read_b64_tr_b16 v[158:159], v15 offset:35072
  v_mfma_f32_16x16x32_bf16 v[56:59], v[124:127], a[176:179], v[56:59]
  ds_read_b64_tr_b16 v[160:161], v14 offset:37120
  ds_read_b64_tr_b16 v[162:163], v15 offset:37120
  v_mfma_f32_16x16x32_bf16 v[88:91], v[124:127], a[184:187], v[88:91]
  ds_read_b64_tr_b16 v[164:165], v14 offset:39168
  ds_read_b64_tr_b16 v[166:167], v15 offset:39168
  v_mfma_f32_16x16x32_bf16 v[60:63], v[128:131], a[176:179], v[60:63]
  ds_read_b64_tr_b16 v[168:169], v14 offset:41216
  ds_read_b64_tr_b16 v[170:171], v15 offset:41216
  v_mfma_f32_16x16x32_bf16 v[92:95], v[128:131], a[184:187], v[92:95]
  ds_read_b64_tr_b16 v[172:173], v14 offset:43264
  ds_read_b64_tr_b16 v[174:175], v15 offset:43264
  v_mfma_f32_16x16x32_bf16 v[64:67], v[132:135], a[176:179], v[64:67]
  ds_read_b64_tr_b16 v[176:177], v14 offset:45312
  ds_read_b64_tr_b16 v[178:179], v15 offset:45312
  v_mfma_f32_16x16x32_bf16 v[96:99], v[132:135], a[184:187], v[96:99]
  ds_read_b64_tr_b16 v[180:181], v14 offset:47360
  ds_read_b64_tr_b16 v[182:183], v15 offset:47360
  v_mfma_f32_16x16x32_bf16 v[68:71], v[136:139], a[176:179], v[68:71]
  s_add_u32 m0, s10, 65536
  s_nop 0
  buffer_load_dwordx4 v10, s[12:15], s6 offen offset:0 sc1 lds
  v_mfma_f32_16x16x32_bf16 v[104:107], v[136:139], a[184:187], v[104:107]
  v_mfma_f32_16x16x32_bf16 v[72:75], v[140:143], a[176:179], v[72:75]
  buffer_load_dwordx4 v10, s[12:15], s6 offen offset:1024 sc1 lds
  v_mfma_f32_16x16x32_bf16 v[108:111], v[140:143], a[184:187], v[108:111]
  v_mfma_f32_16x16x32_bf16 v[76:79], v[144:147], a[176:179], v[76:79]
  buffer_load_dwordx4 v10, s[12:15], s6 offen offset:2048 sc1 lds
  v_mfma_f32_16x16x32_bf16 v[112:115], v[144:147], a[184:187], v[112:115]
  v_mfma_f32_16x16x32_bf16 v[80:83], v[148:151], a[176:179], v[80:83]
  buffer_load_dwordx4 v10, s[12:15], s6 offen offset:3072 sc1 lds
  v_mfma_f32_16x16x32_bf16 v[116:119], v[148:151], a[184:187], v[116:119]
  s_waitcnt vmcnt(16) lgkmcnt(0)
  s_barrier
  v_mfma_f32_16x16x32_bf16 v[20:23], v[152:155], a[180:183], v[20:23]
  ds_read_b64_tr_b16 v[120:121], v12 offset:0
  ds_read_b64_tr_b16 v[122:123], v13 offset:0
  v_mfma_f32_16x16x32_bf16 v[84:87], v[152:155], a[188:191], v[84:87]
  ds_read_b64_tr_b16 v[124:125], v12 offset:2048
  ds_read_b64_tr_b16 v[126:127], v13 offset:2048
  v_mfma_f32_16x16x32_bf16 v[56:59], v[156:159], a[180:183], v[56:59]
  ds_read_b64_tr_b16 v[128:129], v12 offset:4096
  ds_read_b64_tr_b16 v[130:131], v13 offset:4096
  v_mfma_f32_16x16x32_bf16 v[88:91], v[156:159], a[188:191], v[88:91]
  ds_read_b64_tr_b16 v[132:133], v12 offset:6144
  ds_read_b64_tr_b16 v[134:135], v13 offset:6144
  v_mfma_f32_16x16x32_bf16 v[60:63], v[160:163], a[180:183], v[60:63]
  ds_read_b64_tr_b16 v[136:137], v12 offset:8192
  ds_read_b64_tr_b16 v[138:139], v13 offset:8192
  v_mfma_f32_16x16x32_bf16 v[92:95], v[160:163], a[188:191], v[92:95]
  ds_read_b64_tr_b16 v[140:141], v12 offset:10240
  ds_read_b64_tr_b16 v[142:143], v13 offset:10240
  v_mfma_f32_16x16x32_bf16 v[64:67], v[164:167], a[180:183], v[64:67]
  ds_read_b64_tr_b16 v[144:145], v12 offset:12288
  ds_read_b64_tr_b16 v[146:147], v13 offset:12288
  v_mfma_f32_16x16x32_bf16 v[96:99], v[164:167], a[188:191], v[96:99]
  ds_read_b64_tr_b16 v[148:149], v12 offset:14336
  ds_read_b64_tr_b16 v[150:151], v13 offset:14336
  v_mfma_f32_16x16x32_bf16 v[68:71], v[168:171], a[180:183], v[68:71]
  s_add_u32 m0, s10, 69632
  s_nop 0
  buffer_load_dwordx4 v11, s[12:15], s6 offen offset:0 sc1 lds
  v_mfma_f32_16x16x32_bf16 v[104:107], v[168:171], a[188:191], v[104:107]
  v_mfma_f32_16x16x32_bf16 v[72:75], v[172:175], a[180:183], v[72:75]
  buffer_load_dwordx4 v11, s[12:15], s6 offen offset:1024 sc1 lds
  v_mfma_f32_16x16x32_bf16 v[108:111], v[172:175], a[188:191], v[108:111]
  v_mfma_f32_16x16x32_bf16 v[76:79], v[176:179], a[180:183], v[76:79]
  buffer_load_dwordx4 v11, s[12:15], s6 offen offset:2048 sc1 lds
  v_mfma_f32_16x16x32_bf16 v[112:115], v[176:179], a[188:191], v[112:115]
  v_mfma_f32_16x16x32_bf16 v[80:83], v[180:183], a[180:183], v[80:83]
  buffer_load_dwordx4 v11, s[12:15], s6 offen offset:3072 sc1 lds
  s_add_u32 s6, s6, 32768
  s_and_b32 s6, s6, 0x7ffff
  v_mfma_f32_16x16x32_bf16 v[116:119], v[180:183], a[188:191], v[116:119]
  s_waitcnt lgkmcnt(0)
  v_mfma_f32_16x16x32_bf16 v[20:23], v[120:123], a[192:195], v[20:23]
  ds_read_b64_tr_b16 v[152:153], v12 offset:256
  ds_read_b64_tr_b16 v[154:155], v13 offset:256
  v_mfma_f32_16x16x32_bf16 v[84:87], v[120:123], a[200:203], v[84:87]
  ds_read_b64_tr_b16 v[156:157], v12 offset:2304
  ds_read_b64_tr_b16 v[158:159], v13 offset:2304
  v_mfma_f32_16x16x32_bf16 v[56:59], v[124:127], a[192:195], v[56:59]
  ds_read_b64_tr_b16 v[160:161], v12 offset:4352
  ds_read_b64_tr_b16 v[162:163], v13 offset:4352
  v_mfma_f32_16x16x32_bf16 v[88:91], v[124:127], a[200:203], v[88:91]
  ds_read_b64_tr_b16 v[164:165], v12 offset:6400
  ds_read_b64_tr_b16 v[166:167], v13 offset:6400
  v_mfma_f32_16x16x32_bf16 v[60:63], v[128:131], a[192:195], v[60:63]
  ds_read_b64_tr_b16 v[168:169], v12 offset:8448
  ds_read_b64_tr_b16 v[170:171], v13 offset:8448
  v_mfma_f32_16x16x32_bf16 v[92:95], v[128:131], a[200:203], v[92:95]
  ds_read_b64_tr_b16 v[172:173], v12 offset:10496
  ds_read_b64_tr_b16 v[174:175], v13 offset:10496
  v_mfma_f32_16x16x32_bf16 v[64:67], v[132:135], a[192:195], v[64:67]
  ds_read_b64_tr_b16 v[176:177], v12 offset:12544
  ds_read_b64_tr_b16 v[178:179], v13 offset:12544
  v_mfma_f32_16x16x32_bf16 v[96:99], v[132:135], a[200:203], v[96:99]
  ds_read_b64_tr_b16 v[180:181], v12 offset:14592
  ds_read_b64_tr_b16 v[182:183], v13 offset:14592
  v_mfma_f32_16x16x32_bf16 v[68:71], v[136:139], a[192:195], v[68:71]
  s_add_u32 m0, s10, 98304
  s_nop 0
  buffer_load_dwordx4 v10, s[12:15], s6 offen offset:0 sc1 lds
  v_mfma_f32_16x16x32_bf16 v[104:107], v[136:139], a[200:203], v[104:107]
  v_mfma_f32_16x16x32_bf16 v[72:75], v[140:143], a[192:195], v[72:75]
  buffer_load_dwordx4 v10, s[12:15], s6 offen offset:1024 sc1 lds
  v_mfma_f32_16x16x32_bf16 v[108:111], v[140:143], a[200:203], v[108:111]
  v_mfma_f32_16x16x32_bf16 v[76:79], v[144:147], a[192:195], v[76:79]
  buffer_load_dwordx4 v10, s[12:15], s6 offen offset:2048 sc1 lds
  v_mfma_f32_16x16x32_bf16 v[112:115], v[144:147], a[200:203], v[112:115]
  v_mfma_f32_16x16x32_bf16 v[80:83], v[148:151], a[192:195], v[80:83]
  buffer_load_dwordx4 v10, s[12:15], s6 offen offset:3072 sc1 lds
  v_mfma_f32_16x16x32_bf16 v[116:119], v[148:151], a[200:203], v[116:119]
  s_waitcnt vmcnt(12) lgkmcnt(0)
  s_barrier
  v_mfma_f32_16x16x32_bf16 v[20:23], v[152:155], a[196:199], v[20:23]
  ds_read_b64_tr_b16 v[120:121], v12 offset:32768
  ds_read_b64_tr_b16 v[122:123], v13 offset:32768
  v_mfma_f32_16x16x32_bf16 v[84:87], v[152:155], a[204:207], v[84:87]
  ds_read_b64_tr_b16 v[124:125], v12 offset:34816
  ds_read_b64_tr_b16 v[126:127], v13 offset:34816
  v_mfma_f32_16x16x32_bf16 v[56:59], v[156:159], a[196:199], v[56:59]
  ds_read_b64_tr_b16 v[128:129], v12 offset:36864
  ds_read_b64_tr_b16 v[130:131], v13 offset:36864
  v_mfma_f32_16x16x32_bf16 v[88:91], v[156:159], a[204:207], v[88:91]
  ds_read_b64_tr_b16 v[132:133], v12 offset:38912
  ds_read_b64_tr_b16 v[134:135], v13 offset:38912
  v_mfma_f32_16x16x32_bf16 v[60:63], v[160:163], a[196:199], v[60:63]
  ds_read_b64_tr_b16 v[136:137], v12 offset:40960
  ds_read_b64_tr_b16 v[138:139], v13 offset:40960
  v_mfma_f32_16x16x32_bf16 v[92:95], v[160:163], a[204:207], v[92:95]
  ds_read_b64_tr_b16 v[140:141], v12 offset:43008
  ds_read_b64_tr_b16 v[142:143], v13 offset:43008
  v_mfma_f32_16x16x32_bf16 v[64:67], v[164:167], a[196:199], v[64:67]
  ds_read_b64_tr_b16 v[144:145], v12 offset:45056
  ds_read_b64_tr_b16 v[146:147], v13 offset:45056
  v_mfma_f32_16x16x32_bf16 v[96:99], v[164:167], a[204:207], v[96:99]
  ds_read_b64_tr_b16 v[148:149], v12 offset:47104
  ds_read_b64_tr_b16 v[150:151], v13 offset:47104
  v_mfma_f32_16x16x32_bf16 v[68:71], v[168:171], a[196:199], v[68:71]
  s_add_u32 m0, s10, 102400
  s_nop 0
  buffer_load_dwordx4 v11, s[12:15], s6 offen offset:0 sc1 lds
  v_mfma_f32_16x16x32_bf16 v[104:107], v[168:171], a[204:207], v[104:107]
  v_mfma_f32_16x16x32_bf16 v[72:75], v[172:175], a[196:199], v[72:75]
  buffer_load_dwordx4 v11, s[12:15], s6 offen offset:1024 sc1 lds
  v_mfma_f32_16x16x32_bf16 v[108:111], v[172:175], a[204:207], v[108:111]
  v_mfma_f32_16x16x32_bf16 v[76:79], v[176:179], a[196:199], v[76:79]
  buffer_load_dwordx4 v11, s[12:15], s6 offen offset:2048 sc1 lds
  v_mfma_f32_16x16x32_bf16 v[112:115], v[176:179], a[204:207], v[112:115]
  v_mfma_f32_16x16x32_bf16 v[80:83], v[180:183], a[196:199], v[80:83]
  buffer_load_dwordx4 v11, s[12:15], s6 offen offset:3072 sc1 lds
  s_add_u32 s6, s6, 32768
  s_and_b32 s6, s6, 0x7ffff
  v_mfma_f32_16x16x32_bf16 v[116:119], v[180:183], a[204:207], v[116:119]
  s_waitcnt lgkmcnt(0)
  v_mfma_f32_16x16x32_bf16 v[20:23], v[120:123], a[208:211], v[20:23]
  ds_read_b64_tr_b16 v[152:153], v12 offset:33024
  ds_read_b64_tr_b16 v[154:155], v13 offset:33024
  v_mfma_f32_16x16x32_bf16 v[84:87], v[120:123], a[216:219], v[84:87]
  ds_read_b64_tr_b16 v[156:157], v12 offset:35072
  ds_read_b64_tr_b16 v[158:159], v13 offset:35072
  v_mfma_f32_16x16x32_bf16 v[56:59], v[124:127], a[208:211], v[56:59]
  ds_read_b64_tr_b16 v[160:161], v12 offset:37120
  ds_read_b64_tr_b16 v[162:163], v13 offset:37120
  v_mfma_f32_16x16x32_bf16 v[88:91], v[124:127], a[216:219], v[88:91]
  ds_read_b64_tr_b16 v[164:165], v12 offset:39168
  ds_read_b64_tr_b16 v[166:167], v13 offset:39168
  v_mfma_f32_16x16x32_bf16 v[60:63], v[128:131], a[208:211], v[60:63]
  ds_read_b64_tr_b16 v[168:169], v12 offset:41216
  ds_read_b64_tr_b16 v[170:171], v13 offset:41216
  v_mfma_f32_16x16x32_bf16 v[92:95], v[128:131], a[216:219], v[92:95]
  ds_read_b64_tr_b16 v[172:173], v12 offset:43264
  ds_read_b64_tr_b16 v[174:175], v13 offset:43264
  v_mfma_f32_16x16x32_bf16 v[64:67], v[132:135], a[208:211], v[64:67]
  ds_read_b64_tr_b16 v[176:177], v12 offset:45312
  ds_read_b64_tr_b16 v[178:179], v13 offset:45312
  s_lshl_b32 s7, s3, 10
  s_add_u32 s7, s7, 131072
  v_lshl_add_u32 v27, v4, 4, s7
  v_lshlrev_b32 v100, 16, v16
  v_mfma_f32_16x16x32_bf16 v[96:99], v[132:135], a[216:219], v[96:99]
  ds_read_b64_tr_b16 v[180:181], v12 offset:47360
  ds_read_b64_tr_b16 v[182:183], v13 offset:47360
  v_and_b32 v102, 0xffff0000, v16
  v_lshlrev_b32 v101, 16, v17
  v_and_b32 v103, 0xffff0000, v17
  v_lshlrev_b32 v200, 16, v44
  v_mfma_f32_16x16x32_bf16 v[68:71], v[136:139], a[208:211], v[68:71]
  v_and_b32 v202, 0xffff0000, v44
  v_lshlrev_b32 v201, 16, v45
  v_and_b32 v203, 0xffff0000, v45
  v_lshlrev_b32 v204, 16, v48
  v_mfma_f32_16x16x32_bf16 v[104:107], v[136:139], a[216:219], v[104:107]
  v_and_b32 v206, 0xffff0000, v48
  v_lshlrev_b32 v205, 16, v49
  v_and_b32 v207, 0xffff0000, v49
  v_lshlrev_b32 v208, 16, v52
  v_mfma_f32_16x16x32_bf16 v[72:75], v[140:143], a[208:211], v[72:75]
  v_and_b32 v210, 0xffff0000, v52
  v_lshlrev_b32 v209, 16, v53
  v_and_b32 v211, 0xffff0000, v53
  v_pk_add_f32 v[212:213], v[100:101], v[204:205]
  v_mfma_f32_16x16x32_bf16 v[108:111], v[140:143], a[216:219], v[108:111]
  v_pk_add_f32 v[216:217], v[100:101], v[204:205] neg_lo:[0,1] neg_hi:[0,1]
  v_pk_add_f32 v[220:221], v[200:201], v[208:209]
  v_pk_add_f32 v[214:215], v[102:103], v[206:207]
  v_pk_add_f32 v[218:219], v[102:103], v[206:207] neg_lo:[0,1] neg_hi:[0,1]
  v_mfma_f32_16x16x32_bf16 v[76:79], v[144:147], a[208:211], v[76:79]
  v_pk_add_f32 v[222:223], v[202:203], v[210:211]
  v_pk_add_f32 v[224:225], v[210:211], v[202:203] neg_lo:[0,1] neg_hi:[0,1]
  v_pk_add_f32 v[226:227], v[200:201], v[208:209] neg_lo:[0,1] neg_hi:[0,1]
  s_cmp_lg_u32 s3, 0
  s_cbranch_scc1 gated_mix__spectral_gfnet__ssm_conv_s5__prompt_kernel_skip36
  s_mov_b64 exec, 15
  v_pk_add_f32 v[220:221], v[200:201], v[200:201]
  v_pk_add_f32 v[222:223], v[208:209], v[208:209]
  v_pk_add_f32 v[224:225], v[202:203], v[202:203] neg_lo:[1,1] neg_hi:[1,1]
  v_pk_add_f32 v[226:227], v[210:211], v[210:211] neg_lo:[1,1] neg_hi:[1,1]
  s_mov_b64 exec, -1
gated_mix__spectral_gfnet__ssm_conv_s5__prompt_kernel_skip36:
  v_mfma_f32_16x16x32_bf16 v[112:115], v[144:147], a[216:219], v[112:115]
  v_pk_add_f32 v[100:101], v[212:213], v[220:221]
  v_cvt_pk_bf16_f32 v228, v100, v101
  v_pk_add_f32 v[102:103], v[214:215], v[222:223]
  v_cvt_pk_bf16_f32 v229, v102, v103
  v_mfma_f32_16x16x32_bf16 v[80:83], v[148:151], a[208:211], v[80:83]
  v_pk_add_f32 v[200:201], v[216:217], v[224:225]
  v_cvt_pk_bf16_f32 v230, v200, v201
  v_pk_add_f32 v[202:203], v[218:219], v[226:227]
  v_cvt_pk_bf16_f32 v231, v202, v203
  v_mfma_f32_16x16x32_bf16 v[116:119], v[148:151], a[216:219], v[116:119]
  v_pk_add_f32 v[204:205], v[212:213], v[220:221] neg_lo:[0,1] neg_hi:[0,1]
  v_cvt_pk_bf16_f32 v232, v204, v205
  v_pk_add_f32 v[206:207], v[214:215], v[222:223] neg_lo:[0,1] neg_hi:[0,1]
  v_cvt_pk_bf16_f32 v233, v206, v207
  s_waitcnt vmcnt(8) lgkmcnt(0)
  s_barrier
  v_mfma_f32_16x16x32_bf16 v[20:23], v[152:155], a[212:215], v[20:23]
  ds_read_b64_tr_b16 v[120:121], v14 offset:0
  ds_read_b64_tr_b16 v[122:123], v15 offset:0
  v_mfma_f32_16x16x32_bf16 v[84:87], v[152:155], a[220:223], v[84:87]
  ds_read_b64_tr_b16 v[124:125], v14 offset:2048
  ds_read_b64_tr_b16 v[126:127], v15 offset:2048
  v_mfma_f32_16x16x32_bf16 v[56:59], v[156:159], a[212:215], v[56:59]
  ds_read_b64_tr_b16 v[128:129], v14 offset:4096
  ds_read_b64_tr_b16 v[130:131], v15 offset:4096
  v_mfma_f32_16x16x32_bf16 v[88:91], v[156:159], a[220:223], v[88:91]
  ds_read_b64_tr_b16 v[132:133], v14 offset:6144
  ds_read_b64_tr_b16 v[134:135], v15 offset:6144
  v_mfma_f32_16x16x32_bf16 v[60:63], v[160:163], a[212:215], v[60:63]
  ds_read_b64_tr_b16 v[136:137], v14 offset:8192
  ds_read_b64_tr_b16 v[138:139], v15 offset:8192
  v_mfma_f32_16x16x32_bf16 v[92:95], v[160:163], a[220:223], v[92:95]
  ds_read_b64_tr_b16 v[140:141], v14 offset:10240
  ds_read_b64_tr_b16 v[142:143], v15 offset:10240
  v_mfma_f32_16x16x32_bf16 v[64:67], v[164:167], a[212:215], v[64:67]
  ds_read_b64_tr_b16 v[144:145], v14 offset:12288
  ds_read_b64_tr_b16 v[146:147], v15 offset:12288
  v_pk_add_f32 v[208:209], v[216:217], v[224:225] neg_lo:[0,1] neg_hi:[0,1]
  v_cvt_pk_bf16_f32 v234, v208, v209
  v_pk_add_f32 v[210:211], v[218:219], v[226:227] neg_lo:[0,1] neg_hi:[0,1]
  v_cvt_pk_bf16_f32 v235, v210, v211
  v_mfma_f32_16x16x32_bf16 v[96:99], v[164:167], a[220:223], v[96:99]
  ds_read_b64_tr_b16 v[148:149], v14 offset:14336
  ds_read_b64_tr_b16 v[150:151], v15 offset:14336
  v_lshlrev_b32 v100, 16, v18
  v_and_b32 v102, 0xffff0000, v18
  v_lshlrev_b32 v101, 16, v19
  v_and_b32 v103, 0xffff0000, v19
  v_mfma_f32_16x16x32_bf16 v[68:71], v[168:171], a[212:215], v[68:71]
  v_lshlrev_b32 v200, 16, v46
  v_and_b32 v202, 0xffff0000, v46
  v_lshlrev_b32 v201, 16, v47
  v_and_b32 v203, 0xffff0000, v47
  v_mfma_f32_16x16x32_bf16 v[104:107], v[168:171], a[220:223], v[104:107]
  v_lshlrev_b32 v204, 16, v50
  v_and_b32 v206, 0xffff0000, v50
  v_lshlrev_b32 v205, 16, v51
  v_and_b32 v207, 0xffff0000, v51
  v_mfma_f32_16x16x32_bf16 v[72:75], v[172:175], a[212:215], v[72:75]
  v_lshlrev_b32 v208, 16, v54
  v_and_b32 v210, 0xffff0000, v54
  v_lshlrev_b32 v209, 16, v55
  v_and_b32 v211, 0xffff0000, v55
  v_mfma_f32_16x16x32_bf16 v[108:111], v[172:175], a[220:223], v[108:111]
  v_pk_add_f32 v[212:213], v[100:101], v[204:205]
  v_pk_add_f32 v[216:217], v[100:101], v[204:205] neg_lo:[0,1] neg_hi:[0,1]
  v_pk_add_f32 v[220:221], v[200:201], v[208:209]
  v_pk_add_f32 v[214:215], v[102:103], v[206:207]
  v_mfma_f32_16x16x32_bf16 v[76:79], v[176:179], a[212:215], v[76:79]
  v_pk_add_f32 v[218:219], v[102:103], v[206:207] neg_lo:[0,1] neg_hi:[0,1]
  v_pk_add_f32 v[222:223], v[202:203], v[210:211]
  v_pk_add_f32 v[224:225], v[210:211], v[202:203] neg_lo:[0,1] neg_hi:[0,1]
  v_pk_add_f32 v[226:227], v[200:201], v[208:209] neg_lo:[0,1] neg_hi:[0,1]
  v_mfma_f32_16x16x32_bf16 v[112:115], v[176:179], a[220:223], v[112:115]
  s_cmp_lg_u32 s3, 0
  s_cbranch_scc1 gated_mix__spectral_gfnet__ssm_conv_s5__prompt_kernel_skip37
  s_mov_b64 exec, 15
  v_pk_add_f32 v[220:221], v[200:201], v[200:201]
  v_pk_add_f32 v[222:223], v[208:209], v[208:209]
  v_pk_add_f32 v[224:225], v[202:203], v[202:203] neg_lo:[1,1] neg_hi:[1,1]
  v_pk_add_f32 v[226:227], v[210:211], v[210:211] neg_lo:[1,1] neg_hi:[1,1]
  s_mov_b64 exec, -1
gated_mix__spectral_gfnet__ssm_conv_s5__prompt_kernel_skip37:
  v_mfma_f32_16x16x32_bf16 v[80:83], v[180:183], a[212:215], v[80:83]
  v_pk_add_f32 v[100:101], v[212:213], v[220:221]
  v_cvt_pk_bf16_f32 v17, v100, v101
  v_pk_add_f32 v[102:103], v[214:215], v[222:223]
  v_cvt_pk_bf16_f32 v19, v102, v103
  v_mfma_f32_16x16x32_bf16 v[116:119], v[180:183], a[220:223], v[116:119]
  v_pk_add_f32 v[200:201], v[216:217], v[224:225]
  v_cvt_pk_bf16_f32 v45, v200, v201
  v_pk_add_f32 v[202:203], v[218:219], v[226:227]
  v_cvt_pk_bf16_f32 v47, v202, v203
  s_waitcnt lgkmcnt(0)
  v_mfma_f32_16x16x32_bf16 v[20:23], v[120:123], a[224:227], v[20:23]
  ds_read_b64_tr_b16 v[152:153], v14 offset:256
  ds_read_b64_tr_b16 v[154:155], v15 offset:256
  v_mfma_f32_16x16x32_bf16 v[84:87], v[120:123], a[232:235], v[84:87]
  ds_read_b64_tr_b16 v[156:157], v14 offset:2304
  ds_read_b64_tr_b16 v[158:159], v15 offset:2304
  v_mfma_f32_16x16x32_bf16 v[56:59], v[124:127], a[224:227], v[56:59]
  ds_read_b64_tr_b16 v[160:161], v14 offset:4352
  ds_read_b64_tr_b16 v[162:163], v15 offset:4352
  v_mfma_f32_16x16x32_bf16 v[88:91], v[124:127], a[232:235], v[88:91]
  ds_read_b64_tr_b16 v[164:165], v14 offset:6400
  ds_read_b64_tr_b16 v[166:167], v15 offset:6400
  v_mfma_f32_16x16x32_bf16 v[60:63], v[128:131], a[224:227], v[60:63]
  ds_read_b64_tr_b16 v[168:169], v14 offset:8448
  ds_read_b64_tr_b16 v[170:171], v15 offset:8448
  v_mfma_f32_16x16x32_bf16 v[92:95], v[128:131], a[232:235], v[92:95]
  ds_read_b64_tr_b16 v[172:173], v14 offset:10496
  ds_read_b64_tr_b16 v[174:175], v15 offset:10496
  v_mfma_f32_16x16x32_bf16 v[64:67], v[132:135], a[224:227], v[64:67]
  ds_read_b64_tr_b16 v[176:177], v14 offset:12544
  ds_read_b64_tr_b16 v[178:179], v15 offset:12544
  v_pk_add_f32 v[204:205], v[212:213], v[220:221] neg_lo:[0,1] neg_hi:[0,1]
  v_cvt_pk_bf16_f32 v49, v204, v205
  v_pk_add_f32 v[206:207], v[214:215], v[222:223] neg_lo:[0,1] neg_hi:[0,1]
  v_cvt_pk_bf16_f32 v51, v206, v207
  v_mfma_f32_16x16x32_bf16 v[96:99], v[132:135], a[232:235], v[96:99]
  ds_read_b64_tr_b16 v[180:181], v14 offset:14592
  ds_read_b64_tr_b16 v[182:183], v15 offset:14592
  v_pk_add_f32 v[208:209], v[216:217], v[224:225] neg_lo:[0,1] neg_hi:[0,1]
  v_cvt_pk_bf16_f32 v53, v208, v209
  v_pk_add_f32 v[210:211], v[218:219], v[226:227] neg_lo:[0,1] neg_hi:[0,1]
  v_cvt_pk_bf16_f32 v55, v210, v211
  v_mfma_f32_16x16x32_bf16 v[68:71], v[136:139], a[224:227], v[68:71]
  v_mov_b32 v16, v228
  v_mov_b32 v18, v229
  ds_write_b128 v27, v[16:19] offset:0
  v_mov_b32 v44, v230
  v_mfma_f32_16x16x32_bf16 v[104:107], v[136:139], a[232:235], v[104:107]
  v_mov_b32 v46, v231
  ds_write_b128 v27, v[44:47] offset:4096
  v_mov_b32 v48, v232
  v_mov_b32 v50, v233
  v_mfma_f32_16x16x32_bf16 v[72:75], v[140:143], a[224:227], v[72:75]
  ds_write_b128 v27, v[48:51] offset:8192
  v_mov_b32 v52, v234
  v_mov_b32 v54, v235
  ds_write_b128 v27, v[52:55] offset:12288
  v_mfma_f32_16x16x32_bf16 v[108:111], v[140:143], a[232:235], v[108:111]
  v_mfma_f32_16x16x32_bf16 v[76:79], v[144:147], a[224:227], v[76:79]
  v_mfma_f32_16x16x32_bf16 v[112:115], v[144:147], a[232:235], v[112:115]
  v_mfma_f32_16x16x32_bf16 v[80:83], v[148:151], a[224:227], v[80:83]
  v_mfma_f32_16x16x32_bf16 v[116:119], v[148:151], a[232:235], v[116:119]
  s_waitcnt lgkmcnt(0)
  s_waitcnt vmcnt(0)
  s_barrier
  v_mfma_f32_16x16x32_bf16 v[20:23], v[152:155], a[228:231], v[20:23]
  ds_read_b64_tr_b16 v[120:121], v14 offset:32768
  ds_read_b64_tr_b16 v[122:123], v15 offset:32768
  v_mfma_f32_16x16x32_bf16 v[84:87], v[152:155], a[236:239], v[84:87]
  ds_read_b64_tr_b16 v[124:125], v14 offset:34816
  ds_read_b64_tr_b16 v[126:127], v15 offset:34816
  v_mfma_f32_16x16x32_bf16 v[56:59], v[156:159], a[228:231], v[56:59]
  ds_read_b64_tr_b16 v[128:129], v14 offset:36864
  ds_read_b64_tr_b16 v[130:131], v15 offset:36864
  v_mfma_f32_16x16x32_bf16 v[88:91], v[156:159], a[236:239], v[88:91]
  ds_read_b64_tr_b16 v[132:133], v14 offset:38912
  ds_read_b64_tr_b16 v[134:135], v15 offset:38912
  v_mfma_f32_16x16x32_bf16 v[60:63], v[160:163], a[228:231], v[60:63]
  ds_read_b64_tr_b16 v[136:137], v14 offset:40960
  ds_read_b64_tr_b16 v[138:139], v15 offset:40960
  v_mfma_f32_16x16x32_bf16 v[92:95], v[160:163], a[236:239], v[92:95]
  ds_read_b64_tr_b16 v[140:141], v14 offset:43008
  ds_read_b64_tr_b16 v[142:143], v15 offset:43008
  v_mfma_f32_16x16x32_bf16 v[64:67], v[164:167], a[228:231], v[64:67]
  ds_read_b64_tr_b16 v[144:145], v14 offset:45056
  ds_read_b64_tr_b16 v[146:147], v15 offset:45056
  v_mfma_f32_16x16x32_bf16 v[96:99], v[164:167], a[236:239], v[96:99]
  ds_read_b64_tr_b16 v[148:149], v14 offset:47104
  ds_read_b64_tr_b16 v[150:151], v15 offset:47104
  v_mfma_f32_16x16x32_bf16 v[68:71], v[168:171], a[228:231], v[68:71]
  v_mfma_f32_16x16x32_bf16 v[104:107], v[168:171], a[236:239], v[104:107]
  v_lshlrev_b32 v27, 4, v6
  s_lshl_b32 s7, s38, 9
  s_and_b32 s11, s3, 1
  s_lshl_b32 s11, s11, 8
  s_add_u32 s7, s7, s11
  buffer_load_dwordx4 v[16:19], v27, s[24:27], s7 offen offset:0 sc1
  buffer_load_dwordx4 v[44:47], v27, s[24:27], s7 offen offset:64 sc1
  buffer_load_dwordx4 v[48:51], v27, s[24:27], s7 offen offset:128 sc1
  buffer_load_dwordx4 v[52:55], v27, s[24:27], s7 offen offset:192 sc1
  v_and_b32 v228, 1, v6
  v_mul_u32_u24 v228, 0x8000, v228
  v_lshl_or_b32 v228, v228, 16, v228
  v_xor_b32 v229, 0x80000000, v228
  v_mfma_f32_16x16x32_bf16 v[72:75], v[172:175], a[228:231], v[72:75]
  v_xor_b32 v100, v228, v28
  v_alignbit_b32 v101, v29, v29, 16
  v_xor_b32 v101, v229, v101
  v_xor_b32 v102, v228, v30
  v_mfma_f32_16x16x32_bf16 v[108:111], v[172:175], a[236:239], v[108:111]
  v_alignbit_b32 v103, v31, v31, 16
  v_xor_b32 v103, v229, v103
  v_xor_b32 v200, v228, v32
  v_alignbit_b32 v201, v33, v33, 16
  v_mfma_f32_16x16x32_bf16 v[76:79], v[176:179], a[228:231], v[76:79]
  v_xor_b32 v201, v229, v201
  v_xor_b32 v202, v228, v34
  v_alignbit_b32 v203, v35, v35, 16
  v_xor_b32 v203, v229, v203
  v_mfma_f32_16x16x32_bf16 v[112:115], v[176:179], a[236:239], v[112:115]
  v_xor_b32 v204, v228, v36
  v_alignbit_b32 v205, v37, v37, 16
  v_xor_b32 v205, v229, v205
  v_xor_b32 v206, v228, v38
  v_mfma_f32_16x16x32_bf16 v[80:83], v[180:183], a[228:231], v[80:83]
  v_alignbit_b32 v207, v39, v39, 16
  v_xor_b32 v207, v229, v207
  v_xor_b32 v208, v228, v40
  v_alignbit_b32 v209, v41, v41, 16
  v_mfma_f32_16x16x32_bf16 v[116:119], v[180:183], a[236:239], v[116:119]
  v_xor_b32 v209, v229, v209
  v_xor_b32 v210, v228, v42
  v_alignbit_b32 v211, v43, v43, 16
  v_xor_b32 v211, v229, v211
  s_waitcnt lgkmcnt(0)
  v_mfma_f32_16x16x32_bf16 v[20:23], v[120:123], a[240:243], v[20:23]
  ds_read_b64_tr_b16 v[152:153], v14 offset:33024
  ds_read_b64_tr_b16 v[154:155], v15 offset:33024
  v_mfma_f32_16x16x32_bf16 v[84:87], v[120:123], a[248:251], v[84:87]
  ds_read_b64_tr_b16 v[156:157], v14 offset:35072
  ds_read_b64_tr_b16 v[158:159], v15 offset:35072
  v_mfma_f32_16x16x32_bf16 v[56:59], v[124:127], a[240:243], v[56:59]
  ds_read_b64_tr_b16 v[160:161], v14 offset:37120
  ds_read_b64_tr_b16 v[162:163], v15 offset:37120
  v_mfma_f32_16x16x32_bf16 v[88:91], v[124:127], a[248:251], v[88:91]
  ds_read_b64_tr_b16 v[164:165], v14 offset:39168
  ds_read_b64_tr_b16 v[166:167], v15 offset:39168
  v_mfma_f32_16x16x32_bf16 v[60:63], v[128:131], a[240:243], v[60:63]
  ds_read_b64_tr_b16 v[168:169], v14 offset:41216
  ds_read_b64_tr_b16 v[170:171], v15 offset:41216
  v_mfma_f32_16x16x32_bf16 v[92:95], v[128:131], a[248:251], v[92:95]
  ds_read_b64_tr_b16 v[172:173], v14 offset:43264
  ds_read_b64_tr_b16 v[174:175], v15 offset:43264
  v_mfma_f32_16x16x32_bf16 v[64:67], v[132:135], a[240:243], v[64:67]
  ds_read_b64_tr_b16 v[176:177], v14 offset:45312
  ds_read_b64_tr_b16 v[178:179], v15 offset:45312
  v_mfma_f32_16x16x32_bf16 v[96:99], v[132:135], a[248:251], v[96:99]
  ds_read_b64_tr_b16 v[180:181], v14 offset:47360
  ds_read_b64_tr_b16 v[182:183], v15 offset:47360
  v_mfma_f32_16x16x32_bf16 v[68:71], v[136:139], a[240:243], v[68:71]
  v_xor_b32 v212, v228, v184
  v_alignbit_b32 v213, v185, v185, 16
  v_xor_b32 v213, v229, v213
  v_xor_b32 v214, v228, v186
  v_mfma_f32_16x16x32_bf16 v[104:107], v[136:139], a[248:251], v[104:107]
  v_alignbit_b32 v215, v187, v187, 16
  v_xor_b32 v215, v229, v215
  v_xor_b32 v216, v228, v188
  v_alignbit_b32 v217, v189, v189, 16
  v_mfma_f32_16x16x32_bf16 v[72:75], v[140:143], a[240:243], v[72:75]
  v_xor_b32 v217, v229, v217
  v_xor_b32 v218, v228, v190
  v_alignbit_b32 v219, v191, v191, 16
  v_xor_b32 v219, v229, v219
  v_mfma_f32_16x16x32_bf16 v[108:111], v[140:143], a[248:251], v[108:111]
  v_xor_b32 v220, v228, v192
  v_alignbit_b32 v221, v193, v193, 16
  v_xor_b32 v221, v229, v221
  v_xor_b32 v222, v228, v194
  v_mfma_f32_16x16x32_bf16 v[76:79], v[144:147], a[240:243], v[76:79]
  v_alignbit_b32 v223, v195, v195, 16
  v_xor_b32 v223, v229, v223
  v_xor_b32 v224, v228, v196
  v_alignbit_b32 v225, v197, v197, 16
  v_mfma_f32_16x16x32_bf16 v[112:115], v[144:147], a[248:251], v[112:115]
  v_xor_b32 v225, v229, v225
  v_xor_b32 v226, v228, v198
  v_alignbit_b32 v227, v199, v199, 16
  v_xor_b32 v227, v229, v227
  v_mfma_f32_16x16x32_bf16 v[80:83], v[148:151], a[240:243], v[80:83]
  v_mfma_f32_16x16x32_bf16 v[116:119], v[148:151], a[248:251], v[116:119]
  s_waitcnt lgkmcnt(0)
  v_mfma_f32_16x16x32_bf16 v[68:71], v[168:171], a[244:247], v[68:71]
  ds_read_b64_tr_b16 v[120:121], v9 offset:0
  ds_read_b64_tr_b16 v[122:123], v9 offset:256
  v_mfma_f32_16x16x32_bf16 v[104:107], v[168:171], a[252:255], v[104:107]
  ds_read_b64_tr_b16 v[136:137], v9 offset:4096
  ds_read_b64_tr_b16 v[138:139], v9 offset:4352
  v_mfma_f32_16x16x32_bf16 v[72:75], v[172:175], a[244:247], v[72:75]
  ds_read_b64_tr_b16 v[124:125], v9 offset:1024
  ds_read_b64_tr_b16 v[126:127], v9 offset:1280
  v_mfma_f32_16x16x32_bf16 v[108:111], v[172:175], a[252:255], v[108:111]
  ds_read_b64_tr_b16 v[140:141], v9 offset:5120
  ds_read_b64_tr_b16 v[142:143], v9 offset:5376
  v_mfma_f32_16x16x32_bf16 v[76:79], v[176:179], a[244:247], v[76:79]
  ds_read_b64_tr_b16 v[128:129], v9 offset:2048
  ds_read_b64_tr_b16 v[130:131], v9 offset:2304
  v_mfma_f32_16x16x32_bf16 v[112:115], v[176:179], a[252:255], v[112:115]
  ds_read_b64_tr_b16 v[144:145], v9 offset:6144
  ds_read_b64_tr_b16 v[146:147], v9 offset:6400
  v_mfma_f32_16x16x32_bf16 v[80:83], v[180:183], a[244:247], v[80:83]
  ds_read_b64_tr_b16 v[132:133], v9 offset:3072
  ds_read_b64_tr_b16 v[134:135], v9 offset:3328
  v_mfma_f32_16x16x32_bf16 v[116:119], v[180:183], a[252:255], v[116:119]
  ds_read_b64_tr_b16 v[148:149], v9 offset:7168
  ds_read_b64_tr_b16 v[150:151], v9 offset:7424
  v_mfma_f32_16x16x32_bf16 v[20:23], v[152:155], a[244:247], v[20:23]
  v_mfma_f32_16x16x32_bf16 v[84:87], v[152:155], a[252:255], v[84:87]
  v_mfma_f32_16x16x32_bf16 v[56:59], v[156:159], a[244:247], v[56:59]
  v_mfma_f32_16x16x32_bf16 v[88:91], v[156:159], a[252:255], v[88:91]
  v_mfma_f32_16x16x32_bf16 v[60:63], v[160:163], a[244:247], v[60:63]
  v_mfma_f32_16x16x32_bf16 v[92:95], v[160:163], a[252:255], v[92:95]
  v_mfma_f32_16x16x32_bf16 v[64:67], v[164:167], a[244:247], v[64:67]
  v_mfma_f32_16x16x32_bf16 v[96:99], v[164:167], a[252:255], v[96:99]
  s_waitcnt lgkmcnt(14)
  v_mfma_f32_16x16x32_bf16 v[152:155], v[28:31], v[120:123], 0
  ds_write_b128 v8, v[68:71] offset:0
  s_waitcnt lgkmcnt(13)
  v_mfma_f32_16x16x32_bf16 v[168:171], v[28:31], v[136:139], 0
  ds_write_b128 v8, v[104:107] offset:4096
  s_waitcnt lgkmcnt(12)
  v_mfma_f32_16x16x32_bf16 v[152:155], v[32:35], v[124:127], v[152:155]
  ds_write_b128 v8, v[72:75] offset:1024
  s_waitcnt lgkmcnt(11)
  v_mfma_f32_16x16x32_bf16 v[168:171], v[32:35], v[140:143], v[168:171]
  ds_write_b128 v8, v[108:111] offset:5120
  s_waitcnt lgkmcnt(10)
  v_mfma_f32_16x16x32_bf16 v[152:155], v[36:39], v[128:131], v[152:155]
  ds_write_b128 v8, v[76:79] offset:2048
  s_waitcnt lgkmcnt(9)
  v_mfma_f32_16x16x32_bf16 v[168:171], v[36:39], v[144:147], v[168:171]
  ds_write_b128 v8, v[112:115] offset:6144
  s_waitcnt lgkmcnt(8)
  v_mfma_f32_16x16x32_bf16 v[152:155], v[40:43], v[132:135], v[152:155]
  ds_write_b128 v8, v[80:83] offset:3072
  s_waitcnt lgkmcnt(7)
  v_mfma_f32_16x16x32_bf16 v[168:171], v[40:43], v[148:151], v[168:171]
  ds_write_b128 v8, v[116:119] offset:7168
  v_mfma_f32_16x16x32_bf16 v[156:159], v[184:187], v[120:123], 0
  v_mfma_f32_16x16x32_bf16 v[172:175], v[184:187], v[136:139], 0
  v_mfma_f32_16x16x32_bf16 v[156:159], v[188:191], v[124:127], v[156:159]
  v_mfma_f32_16x16x32_bf16 v[172:175], v[188:191], v[140:143], v[172:175]
  v_mfma_f32_16x16x32_bf16 v[156:159], v[192:195], v[128:131], v[156:159]
  v_mfma_f32_16x16x32_bf16 v[172:175], v[192:195], v[144:147], v[172:175]
  v_mfma_f32_16x16x32_bf16 v[156:159], v[196:199], v[132:135], v[156:159]
  v_mfma_f32_16x16x32_bf16 v[172:175], v[196:199], v[148:151], v[172:175]
  v_xor_b32 v8, 0x2000, v8
  s_waitcnt lgkmcnt(0)
  s_barrier
  v_mfma_f32_16x16x32_bf16 v[160:163], v[100:103], v[120:123], 0
  ds_read_b128 v[68:71], v8 offset:0
  v_mfma_f32_16x16x32_bf16 v[176:179], v[100:103], v[136:139], 0
  ds_read_b128 v[104:107], v8 offset:4096
  v_mfma_f32_16x16x32_bf16 v[160:163], v[200:203], v[124:127], v[160:163]
  ds_read_b128 v[72:75], v8 offset:1024
  v_mfma_f32_16x16x32_bf16 v[176:179], v[200:203], v[140:143], v[176:179]
  ds_read_b128 v[108:111], v8 offset:5120
  v_mfma_f32_16x16x32_bf16 v[160:163], v[204:207], v[128:131], v[160:163]
  ds_read_b128 v[76:79], v8 offset:2048
  v_mfma_f32_16x16x32_bf16 v[176:179], v[204:207], v[144:147], v[176:179]
  ds_read_b128 v[112:115], v8 offset:6144
  v_mfma_f32_16x16x32_bf16 v[160:163], v[208:211], v[132:135], v[160:163]
  ds_read_b128 v[80:83], v8 offset:3072
  v_mfma_f32_16x16x32_bf16 v[176:179], v[208:211], v[148:151], v[176:179]
  ds_read_b128 v[116:119], v8 offset:7168
  s_waitcnt vmcnt(3)
  v_sub_f32 v12, 1.0, v16
  v_sub_f32 v13, 1.0, v17
  v_cvt_pk_bf16_f32 v13, v12, v13
  v_lshlrev_b32 v12, 16, v13
  v_and_b32 v13, 0xffff0000, v13
  v_sub_f32 v14, 1.0, v18
  v_sub_f32 v15, 1.0, v19
  v_cvt_pk_bf16_f32 v15, v14, v15
  v_lshlrev_b32 v14, 16, v15
  v_and_b32 v15, 0xffff0000, v15
  s_waitcnt lgkmcnt(7)
  v_pk_add_f32 v[20:21], v[20:21], v[68:69]
  v_pk_mul_f32 v[152:153], v[16:17], v[152:153]
  v_pk_fma_f32 v[20:21], v[12:13], v[20:21], v[152:153]
  s_waitcnt lgkmcnt(6)
  v_pk_add_f32 v[84:85], v[84:85], v[104:105]
  v_pk_mul_f32 v[168:169], v[16:17], v[168:169]
  v_pk_fma_f32 v[84:85], v[12:13], v[84:85], v[168:169]
  buffer_store_dword v20, v26, s[44:47], s8 offen offset:0
  buffer_store_dword v84, v26, s[44:47], s8 offen offset:1024
  s_add_u32 s8, s8, 65536
  buffer_store_dword v21, v26, s[44:47], s8 offen offset:0
  buffer_store_dword v85, v26, s[44:47], s8 offen offset:1024
  s_add_u32 s8, s8, 65536
  v_pk_add_f32 v[22:23], v[22:23], v[70:71]
  v_pk_mul_f32 v[154:155], v[18:19], v[154:155]
  v_pk_fma_f32 v[22:23], v[14:15], v[22:23], v[154:155]
  v_pk_add_f32 v[86:87], v[86:87], v[106:107]
  v_pk_mul_f32 v[170:171], v[18:19], v[170:171]
  v_pk_fma_f32 v[86:87], v[14:15], v[86:87], v[170:171]
  buffer_store_dword v22, v26, s[44:47], s8 offen offset:0
  buffer_store_dword v86, v26, s[44:47], s8 offen offset:1024
  s_add_u32 s8, s8, 65536
  buffer_store_dword v23, v26, s[44:47], s8 offen offset:0
  buffer_store_dword v87, v26, s[44:47], s8 offen offset:1024
  s_add_u32 s8, s8, 851968
  v_mfma_f32_16x16x32_bf16 v[164:167], v[212:215], v[120:123], 0
  v_mfma_f32_16x16x32_bf16 v[180:183], v[212:215], v[136:139], 0
  v_mfma_f32_16x16x32_bf16 v[164:167], v[216:219], v[124:127], v[164:167]
  v_mfma_f32_16x16x32_bf16 v[180:183], v[216:219], v[140:143], v[180:183]
  v_mfma_f32_16x16x32_bf16 v[164:167], v[220:223], v[128:131], v[164:167]
  v_mfma_f32_16x16x32_bf16 v[180:183], v[220:223], v[144:147], v[180:183]
  v_mfma_f32_16x16x32_bf16 v[164:167], v[224:227], v[132:135], v[164:167]
  v_mfma_f32_16x16x32_bf16 v[180:183], v[224:227], v[148:151], v[180:183]
  s_waitcnt vmcnt(10)
  v_sub_f32 v12, 1.0, v44
  v_sub_f32 v13, 1.0, v45
  v_cvt_pk_bf16_f32 v13, v12, v13
  v_lshlrev_b32 v12, 16, v13
  v_and_b32 v13, 0xffff0000, v13
  v_sub_f32 v14, 1.0, v46
  v_sub_f32 v15, 1.0, v47
  v_cvt_pk_bf16_f32 v15, v14, v15
  v_lshlrev_b32 v14, 16, v15
  v_and_b32 v15, 0xffff0000, v15
  s_waitcnt lgkmcnt(5)
  v_pk_add_f32 v[56:57], v[56:57], v[72:73]
  v_pk_mul_f32 v[156:157], v[44:45], v[156:157]
  v_pk_fma_f32 v[56:57], v[12:13], v[56:57], v[156:157]
  s_waitcnt lgkmcnt(4)
  v_pk_add_f32 v[88:89], v[88:89], v[108:109]
  v_pk_mul_f32 v[172:173], v[44:45], v[172:173]
  v_pk_fma_f32 v[88:89], v[12:13], v[88:89], v[172:173]
  buffer_store_dword v56, v26, s[44:47], s8 offen offset:0
  buffer_store_dword v88, v26, s[44:47], s8 offen offset:1024
  s_add_u32 s8, s8, 65536
  buffer_store_dword v57, v26, s[44:47], s8 offen offset:0
  buffer_store_dword v89, v26, s[44:47], s8 offen offset:1024
  s_add_u32 s8, s8, 65536
  v_pk_add_f32 v[58:59], v[58:59], v[74:75]
  v_pk_mul_f32 v[158:159], v[46:47], v[158:159]
  v_pk_fma_f32 v[58:59], v[14:15], v[58:59], v[158:159]
  v_pk_add_f32 v[90:91], v[90:91], v[110:111]
  v_pk_mul_f32 v[174:175], v[46:47], v[174:175]
  v_pk_fma_f32 v[90:91], v[14:15], v[90:91], v[174:175]
  buffer_store_dword v58, v26, s[44:47], s8 offen offset:0
  buffer_store_dword v90, v26, s[44:47], s8 offen offset:1024
  s_add_u32 s8, s8, 65536
  buffer_store_dword v59, v26, s[44:47], s8 offen offset:0
  buffer_store_dword v91, v26, s[44:47], s8 offen offset:1024
  s_add_u32 s8, s8, 851968
  s_waitcnt vmcnt(17)
  v_sub_f32 v12, 1.0, v48
  v_sub_f32 v13, 1.0, v49
  v_cvt_pk_bf16_f32 v13, v12, v13
  v_lshlrev_b32 v12, 16, v13
  v_and_b32 v13, 0xffff0000, v13
  v_sub_f32 v14, 1.0, v50
  v_sub_f32 v15, 1.0, v51
  v_cvt_pk_bf16_f32 v15, v14, v15
  v_lshlrev_b32 v14, 16, v15
  v_and_b32 v15, 0xffff0000, v15
  s_waitcnt lgkmcnt(3)
  v_pk_add_f32 v[60:61], v[60:61], v[76:77]
  v_pk_mul_f32 v[160:161], v[48:49], v[160:161]
  v_pk_fma_f32 v[60:61], v[12:13], v[60:61], v[160:161]
  s_waitcnt lgkmcnt(2)
  v_pk_add_f32 v[92:93], v[92:93], v[112:113]
  v_pk_mul_f32 v[176:177], v[48:49], v[176:177]
  v_pk_fma_f32 v[92:93], v[12:13], v[92:93], v[176:177]
  buffer_store_dword v60, v26, s[44:47], s8 offen offset:0
  buffer_store_dword v92, v26, s[44:47], s8 offen offset:1024
  s_add_u32 s8, s8, 65536
  buffer_store_dword v61, v26, s[44:47], s8 offen offset:0
  buffer_store_dword v93, v26, s[44:47], s8 offen offset:1024
  s_add_u32 s8, s8, 65536
  v_pk_add_f32 v[62:63], v[62:63], v[78:79]
  v_pk_mul_f32 v[162:163], v[50:51], v[162:163]
  v_pk_fma_f32 v[62:63], v[14:15], v[62:63], v[162:163]
  v_pk_add_f32 v[94:95], v[94:95], v[114:115]
  v_pk_mul_f32 v[178:179], v[50:51], v[178:179]
  v_pk_fma_f32 v[94:95], v[14:15], v[94:95], v[178:179]
  buffer_store_dword v62, v26, s[44:47], s8 offen offset:0
  buffer_store_dword v94, v26, s[44:47], s8 offen offset:1024
  s_add_u32 s8, s8, 65536
  buffer_store_dword v63, v26, s[44:47], s8 offen offset:0
  buffer_store_dword v95, v26, s[44:47], s8 offen offset:1024
  s_add_u32 s8, s8, 851968
  s_waitcnt vmcnt(24)
  v_sub_f32 v12, 1.0, v52
  v_sub_f32 v13, 1.0, v53
  v_cvt_pk_bf16_f32 v13, v12, v13
  v_lshlrev_b32 v12, 16, v13
  v_and_b32 v13, 0xffff0000, v13
  v_sub_f32 v14, 1.0, v54
  v_sub_f32 v15, 1.0, v55
  v_cvt_pk_bf16_f32 v15, v14, v15
  v_lshlrev_b32 v14, 16, v15
  v_and_b32 v15, 0xffff0000, v15
  s_waitcnt lgkmcnt(1)
  v_pk_add_f32 v[64:65], v[64:65], v[80:81]
  v_pk_mul_f32 v[164:165], v[52:53], v[164:165]
  v_pk_fma_f32 v[64:65], v[12:13], v[64:65], v[164:165]
  s_waitcnt lgkmcnt(0)
  v_pk_add_f32 v[96:97], v[96:97], v[116:117]
  v_pk_mul_f32 v[180:181], v[52:53], v[180:181]
  v_pk_fma_f32 v[96:97], v[12:13], v[96:97], v[180:181]
  buffer_store_dword v64, v26, s[44:47], s8 offen offset:0
  buffer_store_dword v96, v26, s[44:47], s8 offen offset:1024
  s_add_u32 s8, s8, 65536
  buffer_store_dword v65, v26, s[44:47], s8 offen offset:0
  buffer_store_dword v97, v26, s[44:47], s8 offen offset:1024
  s_add_u32 s8, s8, 65536
  v_pk_add_f32 v[66:67], v[66:67], v[82:83]
  v_pk_mul_f32 v[166:167], v[54:55], v[166:167]
  v_pk_fma_f32 v[66:67], v[14:15], v[66:67], v[166:167]
  v_pk_add_f32 v[98:99], v[98:99], v[118:119]
  v_pk_mul_f32 v[182:183], v[54:55], v[182:183]
  v_pk_fma_f32 v[98:99], v[14:15], v[98:99], v[182:183]
  buffer_store_dword v66, v26, s[44:47], s8 offen offset:0
  buffer_store_dword v98, v26, s[44:47], s8 offen offset:1024
  s_add_u32 s8, s8, 65536
  buffer_store_dword v67, v26, s[44:47], s8 offen offset:0
  buffer_store_dword v99, v26, s[44:47], s8 offen offset:1024
gated_mix__spectral_gfnet__ssm_conv_s5__prompt_kernel_end:
  s_endpgm
.section .rodata,"a"
.p2align 6
.amdhsa_kernel gated_mix__spectral_gfnet__ssm_conv_s5__prompt_kernel
  .amdhsa_next_free_vgpr 500
  .amdhsa_next_free_sgpr 102
  .amdhsa_accum_offset 244
  .amdhsa_group_segment_fixed_size 0
  .amdhsa_kernarg_size 128
  .amdhsa_user_sgpr_count 2
  .amdhsa_user_sgpr_kernarg_segment_ptr 1
  .amdhsa_system_sgpr_workgroup_id_x 1
  .amdhsa_float_denorm_mode_32 3
.end_amdhsa_kernel
```

```asm
; @launch grid=(256,1,1) block=(256,1,1) lds=163840
.amdgcn_target "amdgcn-amd-amdhsa--gfx950"
.text
.p2align 8
.globl gated_mix__spectral_gfnet__ssm_conv_s5__prompt_kernel
.type gated_mix__spectral_gfnet__ssm_conv_s5__prompt_kernel,@function
gated_mix__spectral_gfnet__ssm_conv_s5__prompt_kernel:
  s_cmp_ge_u32 s2, 256
  s_cbranch_scc1 gated_mix__spectral_gfnet__ssm_conv_s5__prompt_kernel_end
  s_load_dwordx16 s[4:19], s[0:1], 0
  s_load_dwordx16 s[20:35], s[0:1], 64
  s_getpc_b64 s[36:37]
gated_mix__spectral_gfnet__ssm_conv_s5__prompt_kernel_pc1:
  s_lshr_b32 s3, s2, 3
  s_mul_i32 s3, s3, 1280
  s_add_u32 s3, s3, 0
  v_min_u32 v2, 9, v0
  v_lshl_add_u32 v2, v2, 7, s3
  v_min_u32 v2, gated_mix__spectral_gfnet__ssm_conv_s5__prompt_kernel_end-gated_mix__spectral_gfnet__ssm_conv_s5__prompt_kernel_pc1, v2
  v_mov_b32 v3, s37
  v_add_co_u32 v2, vcc, s36, v2
  s_nop 1
  v_addc_co_u32 v3, vcc, 0, v3, vcc
  v_lshrrev_b32 v4, 6, v0
  s_nop 0
  v_readfirstlane_b32 s3, v4
  v_and_b32 v4, 63, v0
  v_and_b32 v5, 15, v0
  v_bfe_u32 v6, v0, 4, 2
  s_and_b32 s36, s2, 7
  s_lshr_b32 s37, s2, 3
  s_and_b32 s41, s37, 3
  s_lshr_b32 s37, s37, 2
  s_lshl_b32 s40, s36, 3
  s_add_u32 s40, s40, s37
  s_and_b32 s38, s36, 3
  s_lshl_b32 s38, s38, 2
  s_add_u32 s38, s38, s41
  s_lshr_b32 s39, s36, 2
  s_lshl_b32 s39, s39, 3
  s_add_u32 s39, s39, s37
  s_and_b32 s42, s36, 1
  s_lshl_b32 s42, s42, 3
  s_add_u32 s42, s42, s37
  s_lshr_b32 s43, s36, 1
  s_lshl_b32 s43, s43, 2
  s_add_u32 s43, s43, s41
  s_cmp_lg_u32 s3, 0
  s_cbranch_scc1 gated_mix__spectral_gfnet__ssm_conv_s5__prompt_kernel_skip2
  global_load_dword v1, v[2:3], off
gated_mix__spectral_gfnet__ssm_conv_s5__prompt_kernel_skip2:
  s_waitcnt lgkmcnt(0)
  s_mov_b32 s44, s4
  s_mov_b32 s45, s5
  s_mov_b32 s46, 4194304
  s_mov_b32 s47, 0x20000
  v_bfe_u32 v3, v4, 1, 2
  v_xor_b32 v3, v3, v6
  v_lshlrev_b32 v2, 9, v3
  v_and_b32 v3, 1, v4
  v_lshl_or_b32 v2, v3, 4, v2
  v_lshrrev_b32 v3, 3, v4
  v_lshl_or_b32 v2, v3, 15, v2
  s_lshl_b32 s4, s42, 11
  s_lshl_b32 m0, s43, 5
  s_add_u32 s4, s4, m0
  s_lshl_b32 m0, s3, 20
  s_add_u32 s4, s4, m0
  s_lshl_b32 m0, s3, 12
  s_add_u32 m0, m0, 131072
  s_nop 0
  buffer_load_dwordx4 v2, s[44:47], s4 offen offset:0 lds
  s_add_u32 s4, s4, 261120
  buffer_load_dwordx4 v2, s[44:47], s4 offen offset:1024 lds
  s_add_u32 s4, s4, 261120
  buffer_load_dwordx4 v2, s[44:47], s4 offen offset:2048 lds
  s_add_u32 s4, s4, 261120
  buffer_load_dwordx4 v2, s[44:47], s4 offen offset:3072 lds
  s_add_u32 s48, s34, 20316160
  s_addc_u32 s49, s35, 0
  s_mov_b32 s50, 40960
  s_mov_b32 s51, 0x20000
  s_mov_b32 s52, s32
  s_mov_b32 s53, s33
  s_mov_b32 s54, 256
  s_mov_b32 s55, 0x20000
  v_mov_b32 v2, 0
  v_lshlrev_b32 v3, 4, v0
  s_cmp_lg_u32 s2, 0
  s_cbranch_scc1 gated_mix__spectral_gfnet__ssm_conv_s5__prompt_kernel_skip3
  buffer_store_dword v2, v3, s[48:51], 0 offen sc1
gated_mix__spectral_gfnet__ssm_conv_s5__prompt_kernel_skip3:
  s_bitcmp1_b32 s3, 0
  s_cselect_b32 s56, s18, s16
  s_cselect_b32 s57, s19, s17
  s_mov_b32 s58, 2097152
  s_mov_b32 s59, 0x20000
  v_lshrrev_b32 v24, 5, v4
  v_lshlrev_b32 v24, 5, v24
  v_bfe_u32 v25, v4, 3, 1
  v_lshl_or_b32 v24, v25, 4, v24
  v_bfe_u32 v25, v4, 4, 1
  v_or_b32 v24, v24, v25
  v_lshlrev_b32 v24, 11, v24
  v_lshrrev_b32 v25, 3, v4
  v_lshlrev_b32 v25, 11, v25
  v_and_b32 v26, 7, v4
  v_xor_b32 v26, v26, v6
  v_lshlrev_b32 v26, 4, v26
  v_or_b32 v24, v24, v26
  v_or_b32 v25, v25, v26
  v_xor_b32 v8, 0, v24
  v_add_u32 v8, 0, v8
  v_xor_b32 v12, 0, v25
  v_add_u32 v12, 0, v12
  v_xor_b32 v9, 64, v24
  v_add_u32 v9, 3072, v9
  v_xor_b32 v13, 64, v25
  v_add_u32 v13, 15360, v13
  v_xor_b32 v10, 0, v24
  v_add_u32 v10, 6144, v10
  v_xor_b32 v14, 0, v25
  v_add_u32 v14, 30720, v14
  v_xor_b32 v11, 64, v24
  v_add_u32 v11, 9216, v11
  v_xor_b32 v15, 64, v25
  v_add_u32 v15, 46080, v15
  s_lshl_b32 s10, s38, 18
  s_lshr_b32 s18, s3, 1
  s_lshl_b32 s16, s18, 17
  s_add_u32 s10, s10, s16
  s_lshl_b32 s11, s39, 17
  s_lshl_b32 s16, s18, 16
  s_add_u32 s11, s11, s16
  s_and_b32 s18, s3, 1
  s_lshl_b32 s18, s18, 14
  s_add_u32 s10, s10, s18
  s_lshl_b32 s18, s3, 12
  s_add_u32 s16, s18, 0
  s_add_u32 s17, s18, 65536
  v_and_b32 v24, 31, v4
  v_lshlrev_b32 v24, 7, v24
  v_bfe_u32 v25, v4, 1, 3
  v_lshrrev_b32 v26, 5, v4
  v_xor_b32 v25, v25, v26
  v_lshl_or_b32 v24, v25, 4, v24
  s_lshr_b32 s18, s3, 1
  s_lshl_b32 s18, s18, 13
  s_add_u32 s18, s18, 0
  v_add_u32 v25, s18, v24
  s_and_b32 s18, s3, 1
  s_lshl_b32 s18, s18, 13
  s_add_u32 s18, s18, 65536
  v_add_u32 v26, s18, v24
  v_xor_b32 v16, 0, v25
  v_xor_b32 v20, 0, v26
  v_xor_b32 v17, 32, v25
  v_xor_b32 v21, 32, v26
  v_xor_b32 v18, 64, v25
  v_xor_b32 v22, 64, v26
  v_xor_b32 v19, 96, v25
  v_xor_b32 v23, 96, v26
  v_add_u32 v8, s10, v8
  v_add_u32 v12, s11, v12
  v_add_u32 v9, s10, v9
  v_add_u32 v13, s11, v13
  v_add_u32 v10, s10, v10
  v_add_u32 v14, s11, v14
  v_add_u32 v11, s10, v11
  v_add_u32 v15, s11, v15
  s_add_u32 s10, s38, 0
  s_mul_i32 s10, s10, 1
  s_and_b32 s10, s10, 15
  s_lshl_b32 s10, s10, 7
  s_and_b32 s4, s2, 7
  s_lshl_b32 s4, s4, 9
  s_lshr_b32 s5, s2, 3
  s_lshl_b32 s5, s5, 4
  s_add_u32 s4, s4, s5
  v_mov_b32 v24, s4
  s_lshl_b32 s4, s2, 7
  v_mov_b32 v25, s4
  s_mov_b32 s4, 4096
  s_mov_b32 s5, 8192
  v_mov_b32 v7, 1
  s_mov_b32 s60, s28
  s_mov_b32 s61, s29
  s_mov_b32 s62, 2048
  s_mov_b32 s63, 0x20000
  s_mov_b32 s64, s12
  s_mov_b32 s65, s13
  s_mov_b32 s66, 2048
  s_mov_b32 s67, 0x20000
  s_mov_b32 s68, s14
  s_mov_b32 s69, s15
  s_mov_b32 s70, 2048
  s_mov_b32 s71, 0x20000
  s_mov_b32 s72, s24
  s_mov_b32 s73, s25
  s_mov_b32 s74, 2048
  s_mov_b32 s75, 0x20000
  s_mov_b32 s76, s26
  s_mov_b32 s77, s27
  s_mov_b32 s78, 2048
  s_mov_b32 s79, 0x20000
  s_lshl_b32 s15, s40, 2
  s_add_u32 s15, s15, s41
  s_cmp_eq_u32 s15, 3
  s_cselect_b32 s12, 1, s41
  s_cselect_b32 s13, 64, s40
  s_and_b32 s14, s15, 0xfd
  s_cmp_eq_u32 s14, 0
  s_cselect_b32 s14, 1, 0
  s_lshl_b32 s18, s38, 4
  s_add_u32 s18, s18, s39
  s_and_b32 s19, s42, 7
  s_lshl_b32 s19, s19, 1
  s_lshr_b32 s24, s42, 3
  s_add_u32 s19, s19, s24
  s_lshl_b32 s26, s3, 4
  v_add_u32 v108, s26, v5
  v_cvt_f32_u32 v104, v108
  v_mul_f32 v104, 0x3c000000, v104
  v_lshrrev_b32 v106, 1, v6
  v_lshlrev_b32 v106, 4, v106
  v_and_b32 v107, 1, v6
  v_lshl_add_u32 v106, v107, 2, v106
  v_cvt_f32_u32 v105, v106
  v_mul_f32 v105, v105, v104
  v_cmp_eq_u32 vcc, 0, v108
  v_fmamk_f32 v88, v104, 0x0, v105
  v_fmamk_f32 v89, v104, 0x3f800000, v105
  v_fmamk_f32 v90, v104, 0x40000000, v105
  v_fmamk_f32 v91, v104, 0x40400000, v105
  v_fmamk_f32 v92, v104, 0x41000000, v105
  v_fmamk_f32 v93, v104, 0x41100000, v105
  v_fmamk_f32 v94, v104, 0x41200000, v105
  v_fmamk_f32 v95, v104, 0x41300000, v105
  v_cos_f32 v96, v88
  v_cos_f32 v97, v89
  v_cos_f32 v98, v90
  v_cos_f32 v99, v91
  v_cos_f32 v100, v92
  v_cos_f32 v101, v93
  v_cos_f32 v102, v94
  v_cos_f32 v103, v95
  v_sin_f32 v88, v88
  v_sin_f32 v89, v89
  v_sin_f32 v90, v90
  v_sin_f32 v91, v91
  v_sin_f32 v92, v92
  v_sin_f32 v93, v93
  v_sin_f32 v94, v94
  v_sin_f32 v95, v95
  v_mov_b32 v105, 0x80008000
  v_bfe_i32 v107, v5, 0, 1
  v_bfe_i32 v106, v5, 1, 1
  v_cmp_ne_u32 s[28:29], 0, v107
  v_and_b32 v107, v105, v107
  v_and_b32 v106, v105, v106
  v_xor_b32 v108, v106, v107
  v_mov_b32 v104, 0xbf803f80
  v_cvt_pk_bf16_f32 v56, v96, v97
  v_cvt_pk_bf16_f32 v72, -v88, -v89
  v_cndmask_b32 v72, v72, v104, vcc
  v_cvt_pk_bf16_f32 v57, v98, v99
  v_cvt_pk_bf16_f32 v73, -v90, -v91
  v_cndmask_b32 v73, v73, v104, vcc
  v_cvt_pk_bf16_f32 v58, v100, v101
  v_cvt_pk_bf16_f32 v74, -v92, -v93
  v_cndmask_b32 v74, v74, v104, vcc
  v_cvt_pk_bf16_f32 v59, v102, v103
  v_cvt_pk_bf16_f32 v75, -v94, -v95
  v_cndmask_b32 v75, v75, v104, vcc
  v_cndmask_b32 v60, v56, v72, s[28:29]
  v_cndmask_b32 v76, v72, v56, s[28:29]
  v_xor_b32 v64, v107, v56
  v_xor_b32 v80, v107, v72
  v_xor_b32 v68, v108, v60
  v_xor_b32 v84, v106, v76
  v_xor_b32 v60, v106, v60
  v_xor_b32 v76, v108, v76
  v_cndmask_b32 v61, v57, v73, s[28:29]
  v_cndmask_b32 v77, v73, v57, s[28:29]
  v_xor_b32 v65, v107, v57
  v_xor_b32 v81, v107, v73
  v_xor_b32 v69, v108, v61
  v_xor_b32 v85, v106, v77
  v_xor_b32 v61, v106, v61
  v_xor_b32 v77, v108, v77
  v_cndmask_b32 v62, v58, v74, s[28:29]
  v_cndmask_b32 v78, v74, v58, s[28:29]
  v_xor_b32 v66, v107, v58
  v_xor_b32 v82, v107, v74
  v_xor_b32 v70, v108, v62
  v_xor_b32 v86, v106, v78
  v_xor_b32 v62, v106, v62
  v_xor_b32 v78, v108, v78
  v_cndmask_b32 v63, v59, v75, s[28:29]
  v_cndmask_b32 v79, v75, v59, s[28:29]
  v_xor_b32 v67, v107, v59
  v_xor_b32 v83, v107, v75
  v_xor_b32 v71, v108, v63
  v_xor_b32 v87, v106, v79
  v_xor_b32 v63, v106, v63
  v_xor_b32 v79, v108, v79
  v_cvt_f32_u32 v91, v5
  v_cvt_f32_u32 v92, v6
  v_mul_f32 v92, 4.0, v92
  v_cvt_f32_u32 v96, s12
  v_cvt_f32_u32 v97, s13
  v_cvt_f32_u32 v98, s14
  v_mul_f32 v98, 0xc4700000, v98
  v_cmp_lt_u32 vcc, 7, v5
  s_nop 1
  v_cndmask_b32 v95, 0, v98, vcc
  v_add_f32 v95, v95, v97
  v_fmamk_f32 v93, v91, 0x43000000, v95
  v_mul_f32 v93, 0x3a000000, v93
  v_mul_f32 v94, v93, v92
  v_fmamk_f32 v108, v93, 0x0, v94
  v_fmamk_f32 v109, v93, 0x3f800000, v94
  v_fmamk_f32 v110, v93, 0x40000000, v94
  v_fmamk_f32 v111, v93, 0x40400000, v94
  v_cos_f32 v112, v108
  v_cos_f32 v113, v109
  v_cos_f32 v114, v110
  v_cos_f32 v115, v111
  v_sin_f32 v108, v108
  v_sin_f32 v109, v109
  v_sin_f32 v110, v110
  v_sin_f32 v111, v111
  v_cvt_pk_bf16_f32 v100, v112, v108
  v_cvt_pk_bf16_f32 v104, -v108, v112
  v_cvt_pk_bf16_f32 v101, v113, v109
  v_cvt_pk_bf16_f32 v105, -v109, v113
  v_cvt_pk_bf16_f32 v102, v114, v110
  v_cvt_pk_bf16_f32 v106, -v110, v114
  v_cvt_pk_bf16_f32 v103, v115, v111
  v_cvt_pk_bf16_f32 v107, -v111, v115
  v_cmp_lt_u32 vcc, 1, v6
  s_nop 1
  v_cndmask_b32 v95, 0, v98, vcc
  v_add_f32 v95, v95, v97
  v_fmamk_f32 v95, v92, 0x43000000, v95
  v_mul_f32 v94, v95, v91
  v_mul_f32 v94, 0x3a000000, v94
  v_mul_f32 v93, 0x3d800000, v91
  v_fmamk_f32 v116, v93, 0x0, v94
  v_fmamk_f32 v117, v93, 0x3f800000, v94
  v_fmamk_f32 v118, v93, 0x40000000, v94
  v_fmamk_f32 v119, v93, 0x40400000, v94
  v_cos_f32 v120, v116
  v_cos_f32 v121, v117
  v_cos_f32 v122, v118
  v_cos_f32 v123, v119
  v_sin_f32 v116, v116
  v_sin_f32 v117, v117
  v_sin_f32 v118, v118
  v_sin_f32 v119, v119
  v_cvt_pk_bf16_f32 v108, v120, -v116
  v_cvt_pk_bf16_f32 v112, v116, v120
  v_cvt_pk_bf16_f32 v109, v121, -v117
  v_cvt_pk_bf16_f32 v113, v117, v121
  s_add_u32 m0, s17, 0
  s_nop 0
  buffer_load_dwordx4 v12, s[56:59], s10 offen offset:0 lds
  v_cvt_pk_bf16_f32 v110, v122, -v118
  v_cvt_pk_bf16_f32 v114, v118, v122
  v_cvt_pk_bf16_f32 v111, v123, -v119
  v_cvt_pk_bf16_f32 v115, v119, v123
  s_cmp_eq_u32 s14, 0
  s_cbranch_scc1 gated_mix__spectral_gfnet__ssm_conv_s5__prompt_kernel_skip4
  v_cmp_lt_u32 vcc, 7, v5
  s_nop 1
  v_cndmask_b32 v88, 0, 16, vcc
  v_and_b32 v100, 0xffff, v100
  v_lshlrev_b32 v100, v88, v100
  v_and_b32 v101, 0xffff, v101
  v_lshlrev_b32 v101, v88, v101
  v_and_b32 v102, 0xffff, v102
  v_lshlrev_b32 v102, v88, v102
  v_and_b32 v103, 0xffff, v103
  v_lshlrev_b32 v103, v88, v103
  v_and_b32 v104, 0xffff, v104
  v_lshlrev_b32 v104, v88, v104
  v_and_b32 v105, 0xffff, v105
  v_lshlrev_b32 v105, v88, v105
  v_and_b32 v106, 0xffff, v106
  v_lshlrev_b32 v106, v88, v106
  v_and_b32 v107, 0xffff, v107
  v_lshlrev_b32 v107, v88, v107
  v_cmp_eq_u32 vcc, 0, v5
  v_mov_b32 v89, 0x3f80
  s_nop 0
  v_cndmask_b32 v104, v104, v89, vcc
  v_mov_b32 v89, 0xbf80
  v_cndmask_b32 v105, v105, v89, vcc
  v_mov_b32 v89, 0x3f80
  v_cndmask_b32 v106, v106, v89, vcc
  v_mov_b32 v89, 0xbf80
  v_cndmask_b32 v107, v107, v89, vcc
  v_cmp_lt_u32 vcc, 1, v6
  v_lshlrev_b32 v89, 16, v108
  v_and_b32 v90, 0xffff0000, v108
  v_add_f32 v89, v89, v89
  v_add_f32 v90, v90, v90
  v_cvt_pk_bf16_f32 v89, v89, v90
  v_cndmask_b32 v108, v89, 0, vcc
  v_cndmask_b32 v112, 0, v89, vcc
  v_lshlrev_b32 v89, 16, v109
  v_and_b32 v90, 0xffff0000, v109
  v_add_f32 v89, v89, v89
  v_add_f32 v90, v90, v90
  v_cvt_pk_bf16_f32 v89, v89, v90
  v_cndmask_b32 v109, v89, 0, vcc
  v_cndmask_b32 v113, 0, v89, vcc
  v_lshlrev_b32 v89, 16, v110
  v_and_b32 v90, 0xffff0000, v110
  v_add_f32 v89, v89, v89
  v_add_f32 v90, v90, v90
  v_cvt_pk_bf16_f32 v89, v89, v90
  v_cndmask_b32 v110, v89, 0, vcc
  v_cndmask_b32 v114, 0, v89, vcc
  v_lshlrev_b32 v89, 16, v111
  v_and_b32 v90, 0xffff0000, v111
  v_add_f32 v89, v89, v89
  v_add_f32 v90, v90, v90
  v_cvt_pk_bf16_f32 v89, v89, v90
  v_cndmask_b32 v111, v89, 0, vcc
  v_cndmask_b32 v115, 0, v89, vcc
  v_lshlrev_b32 v89, 31, v5
  v_or_b32 v89, 0x3f803f80, v89
  v_cmp_eq_u32 vcc, 0, v6
  s_nop 1
  v_cndmask_b32 v108, v108, v89, vcc
gated_mix__spectral_gfnet__ssm_conv_s5__prompt_kernel_skip4:
  v_fma_f32 v95, v91, 4.0, v96
  v_mul_f32 v93, 0x3c800000, v95
  v_mul_f32 v94, v93, v92
  v_fmamk_f32 v124, v93, 0x0, v94
  v_fmamk_f32 v125, v93, 0x3f800000, v94
  v_fmamk_f32 v126, v93, 0x40000000, v94
  v_fmamk_f32 v127, v93, 0x40400000, v94
  v_cos_f32 v128, v124
  v_cos_f32 v129, v125
  v_cos_f32 v130, v126
  v_cos_f32 v131, v127
  buffer_load_dwordx4 v13, s[56:59], s10 offen offset:1024 lds
  v_sin_f32 v124, v124
  v_sin_f32 v125, v125
  v_sin_f32 v126, v126
  v_sin_f32 v127, v127
  v_cvt_pk_bf16_f32 v116, v128, v124
  v_cvt_pk_bf16_f32 v120, -v124, v128
  v_cvt_pk_bf16_f32 v117, v129, v125
  v_cvt_pk_bf16_f32 v121, -v125, v129
  v_cvt_pk_bf16_f32 v118, v130, v126
  v_cvt_pk_bf16_f32 v122, -v126, v130
  v_cvt_pk_bf16_f32 v119, v131, v127
  v_cvt_pk_bf16_f32 v123, -v127, v131
  v_mul_f32 v93, 0x3d800000, v93
  v_mul_f32 v94, 0x3d800000, v94
  v_fmamk_f32 v88, v93, 0x0, v94
  v_cos_f32 v124, v88
  buffer_load_dwordx4 v14, s[56:59], s10 offen offset:2048 lds
  v_sin_f32 v128, v88
  v_fmamk_f32 v88, v93, 0x3f800000, v94
  v_cos_f32 v125, v88
  v_sin_f32 v129, v88
  v_fmamk_f32 v88, v93, 0x40000000, v94
  v_cos_f32 v126, v88
  v_sin_f32 v130, v88
  v_fmamk_f32 v88, v93, 0x40400000, v94
  v_cos_f32 v127, v88
  v_sin_f32 v131, v88
  v_fma_f32 v95, v92, 4.0, v96
  v_mul_f32 v94, v95, v91
  v_mul_f32 v94, 0x3c800000, v94
  buffer_load_dwordx4 v15, s[56:59], s10 offen offset:3072 lds
  v_mul_f32 v93, 0x3d800000, v91
  v_fmamk_f32 v140, v93, 0x0, v94
  v_fmamk_f32 v141, v93, 0x3f800000, v94
  v_fmamk_f32 v142, v93, 0x40000000, v94
  v_fmamk_f32 v143, v93, 0x40400000, v94
  v_cos_f32 v144, v140
  v_cos_f32 v145, v141
  v_cos_f32 v146, v142
  v_cos_f32 v147, v143
  v_sin_f32 v140, v140
  v_sin_f32 v141, v141
  v_sin_f32 v142, v142
  v_sin_f32 v143, v143
  s_add_u32 m0, s16, 0
  s_nop 0
  buffer_load_dwordx4 v8, s[44:47], s10 offen offset:0 lds
  v_cvt_pk_bf16_f32 v132, v144, -v140
  v_cvt_pk_bf16_f32 v136, v140, v144
  v_cvt_pk_bf16_f32 v133, v145, -v141
  v_cvt_pk_bf16_f32 v137, v141, v145
  v_cvt_pk_bf16_f32 v134, v146, -v142
  v_cvt_pk_bf16_f32 v138, v142, v146
  v_cvt_pk_bf16_f32 v135, v147, -v143
  v_cvt_pk_bf16_f32 v139, v143, v147
  v_mul_f32 v93, 0x3d800000, v93
  v_mul_f32 v94, 0x3d800000, v94
  v_fmamk_f32 v88, v93, 0x0, v94
  v_cos_f32 v140, v88
  v_sin_f32 v144, v88
  v_fmamk_f32 v88, v93, 0x3f800000, v94
  v_cos_f32 v141, v88
  v_sin_f32 v145, v88
  buffer_load_dwordx4 v9, s[44:47], s10 offen offset:1024 lds
  v_fmamk_f32 v88, v93, 0x40000000, v94
  v_cos_f32 v142, v88
  v_sin_f32 v146, v88
  v_fmamk_f32 v88, v93, 0x40400000, v94
  v_cos_f32 v143, v88
  v_sin_f32 v147, v88
  v_mul_f32 v140, 0x35800000, v140
  v_mul_f32 v141, 0x35800000, v141
  v_mul_f32 v142, 0x35800000, v142
  v_mul_f32 v143, 0x35800000, v143
  v_mul_f32 v144, 0x35800000, v144
  v_mul_f32 v145, 0x35800000, v145
  v_mul_f32 v146, 0x35800000, v146
  v_mul_f32 v147, 0x35800000, v147
  v_xor_b32 v95, 3, v5
  v_cmp_lt_u32 vcc, 7, v5
  buffer_load_dwordx4 v10, s[44:47], s10 offen offset:2048 lds
  s_nop 0
  v_cndmask_b32 v95, v5, v95, vcc
  v_cvt_f32_u32 v93, v95
  v_mul_f32 v93, 0x3d800000, v93
  v_mul_f32 v94, v93, v92
  v_fmamk_f32 v156, v93, 0x0, v94
  v_fmamk_f32 v157, v93, 0x3f800000, v94
  v_fmamk_f32 v158, v93, 0x40000000, v94
  v_fmamk_f32 v159, v93, 0x40400000, v94
  v_cos_f32 v160, v156
  v_cos_f32 v161, v157
  v_cos_f32 v162, v158
  v_cos_f32 v163, v159
  v_sin_f32 v156, v156
  v_sin_f32 v157, v157
  buffer_load_dwordx4 v11, s[44:47], s10 offen offset:3072 lds
  s_add_u32 s10, s10, 128
  s_and_b32 s10, s10, 0x7ff
  v_sin_f32 v158, v158
  v_sin_f32 v159, v159
  v_cvt_pk_bf16_f32 v148, v160, v156
  v_cvt_pk_bf16_f32 v152, -v156, v160
  v_cvt_pk_bf16_f32 v149, v161, v157
  v_cvt_pk_bf16_f32 v153, -v157, v161
  v_cvt_pk_bf16_f32 v150, v162, v158
  v_cvt_pk_bf16_f32 v154, -v158, v162
  v_cvt_pk_bf16_f32 v151, v163, v159
  v_cvt_pk_bf16_f32 v155, -v159, v163
  v_mul_f32 v93, 0x3d800000, v91
  v_add_f32 v95, 0x40400000, v92
  v_cmp_lt_u32 vcc, 1, v6
  s_nop 1
  v_cndmask_b32 v95, v92, v95, vcc
  v_mul_f32 v94, v93, v95
  v_cndmask_b32 v93, v93, -v93, vcc
  v_fmamk_f32 v164, v93, 0x0, v94
  v_fmamk_f32 v165, v93, 0x3f800000, v94
  v_lshlrev_b32 v26, 4, v4
  s_lshl_b32 s24, s18, 14
  s_lshl_b32 s25, s3, 12
  s_add_u32 s24, s24, s25
  buffer_load_dwordx4 v[28:31], v26, s[44:47], s24 offen offset:0
  v_fmamk_f32 v166, v93, 0x40000000, v94
  v_fmamk_f32 v167, v93, 0x40400000, v94
  v_cos_f32 v168, v164
  v_cos_f32 v169, v165
  v_cos_f32 v170, v166
  v_cos_f32 v171, v167
  v_sin_f32 v164, v164
  v_sin_f32 v165, v165
  v_sin_f32 v166, v166
  v_sin_f32 v167, v167
  v_cvt_pk_bf16_f32 v156, v168, -v164
  v_cvt_pk_bf16_f32 v160, v164, v168
  buffer_load_dwordx4 v[32:35], v26, s[44:47], s24 offen offset:1024
  v_cvt_pk_bf16_f32 v157, v169, -v165
  v_cvt_pk_bf16_f32 v161, v165, v169
  v_cvt_pk_bf16_f32 v158, v170, -v166
  v_cvt_pk_bf16_f32 v162, v166, v170
  v_cvt_pk_bf16_f32 v159, v171, -v167
  v_cvt_pk_bf16_f32 v163, v167, v171
  v_accvgpr_write_b32 a224, v148
  v_accvgpr_write_b32 a225, v149
  v_accvgpr_write_b32 a226, v150
  v_accvgpr_write_b32 a227, v151
  v_accvgpr_write_b32 a228, v152
  v_accvgpr_write_b32 a229, v153
  v_accvgpr_write_b32 a230, v154
  v_accvgpr_write_b32 a231, v155
  v_accvgpr_write_b32 a232, v156
  v_accvgpr_write_b32 a233, v157
  v_accvgpr_write_b32 a234, v158
  v_accvgpr_write_b32 a235, v159
  v_accvgpr_write_b32 a236, v160
  v_accvgpr_write_b32 a237, v161
  buffer_load_dwordx4 v[36:39], v26, s[44:47], s24 offen offset:2048
  v_accvgpr_write_b32 a238, v162
  v_accvgpr_write_b32 a239, v163
  v_accvgpr_write_b32 a240, v132
  v_accvgpr_write_b32 a241, v133
  v_accvgpr_write_b32 a242, v134
  v_accvgpr_write_b32 a243, v135
  v_accvgpr_write_b32 a244, v136
  v_accvgpr_write_b32 a245, v137
  v_accvgpr_write_b32 a246, v138
  v_accvgpr_write_b32 a247, v139
  v_accvgpr_write_b32 a248, v108
  v_accvgpr_write_b32 a249, v109
  v_accvgpr_write_b32 a250, v110
  v_accvgpr_write_b32 a251, v111
  v_accvgpr_write_b32 a252, v112
  v_accvgpr_write_b32 a253, v113
  v_accvgpr_write_b32 a254, v114
  v_accvgpr_write_b32 a255, v115
  buffer_load_dwordx4 v[40:43], v26, s[44:47], s24 offen offset:3072
  buffer_load_dwordx4 v[44:47], v26, s[60:63], 0 offen offset:0
  buffer_load_dwordx4 v[48:51], v26, s[60:63], 0 offen offset:1024
  v_and_b32 v26, 31, v4
  v_lshlrev_b32 v26, 1, v26
  s_lshl_b32 s24, s39, 7
  s_and_b32 s25, s3, 1
  s_lshl_b32 s25, s25, 6
  s_add_u32 s24, s24, s25
  buffer_load_ushort v52, v26, s[64:67], s24 offen
  buffer_load_ushort v53, v26, s[68:71], s24 offen
  buffer_load_ushort v54, v26, s[72:75], s24 offen
  v_lshlrev_b32 v55, 1, v5
  s_lshl_b32 s24, s43, 5
  s_lshr_b32 s25, s3, 1
  s_lshl_b32 s25, s25, 10
  s_add_u32 s24, s24, s25
  buffer_load_short_d16_hi v26, v55, s[76:79], s24 offen offset:0
  buffer_load_short_d16_hi v27, v55, s[76:79], s24 offen offset:512
  s_add_u32 m0, s17, 16384
  s_nop 0
  buffer_load_dwordx4 v12, s[56:59], s10 offen offset:0 lds
  buffer_load_dwordx4 v13, s[56:59], s10 offen offset:1024 lds
  buffer_load_dwordx4 v14, s[56:59], s10 offen offset:2048 lds
  buffer_load_dwordx4 v15, s[56:59], s10 offen offset:3072 lds
  s_add_u32 m0, s16, 16384
  s_nop 0
  buffer_load_dwordx4 v8, s[44:47], s10 offen offset:0 lds
  buffer_load_dwordx4 v9, s[44:47], s10 offen offset:1024 lds
  buffer_load_dwordx4 v10, s[44:47], s10 offen offset:2048 lds
  buffer_load_dwordx4 v11, s[44:47], s10 offen offset:3072 lds
  s_add_u32 s10, s10, 128
  s_and_b32 s10, s10, 0x7ff
  s_mov_b32 s24, s34
  s_mov_b32 s25, s35
  s_mov_b32 s26, 4194304
  s_mov_b32 s27, 0x20000
  s_waitcnt vmcnt(27)
  s_barrier
  v_bfe_u32 v55, v4, 2, 3
  v_lshrrev_b32 v92, 5, v4
  v_lshl_or_b32 v55, v92, 4, v55
  v_lshlrev_b32 v55, 7, v55
  v_and_b32 v92, 3, v4
  v_lshl_or_b32 v55, v92, 3, v55
  v_add_u32 v55, 131072, v55
  v_bfe_u32 v92, v4, 3, 2
  v_xor_b32 v88, 0, v92
  v_lshl_add_u32 v88, v88, 5, v55
  v_xor_b32 v89, 1, v92
  v_lshl_add_u32 v89, v89, 5, v55
  v_xor_b32 v90, 2, v92
  v_lshl_add_u32 v90, v90, 5, v55
  v_xor_b32 v91, 3, v92
  v_lshl_add_u32 v91, v91, 5, v55
  ds_read_b64_tr_b16 v[160:161], v88 offset:0
  ds_read_b64_tr_b16 v[162:163], v88 offset:1024
  ds_read_b64_tr_b16 v[164:165], v88 offset:4096
  ds_read_b64_tr_b16 v[166:167], v88 offset:5120
  ds_read_b64_tr_b16 v[168:169], v88 offset:8192
  ds_read_b64_tr_b16 v[170:171], v88 offset:9216
  ds_read_b64_tr_b16 v[172:173], v88 offset:12288
  ds_read_b64_tr_b16 v[174:175], v88 offset:13312
  ds_read_b64_tr_b16 v[176:177], v90 offset:0
  ds_read_b64_tr_b16 v[178:179], v90 offset:1024
  ds_read_b64_tr_b16 v[180:181], v90 offset:4096
  ds_read_b64_tr_b16 v[182:183], v90 offset:5120
  ds_read_b64_tr_b16 v[184:185], v90 offset:8192
  ds_read_b64_tr_b16 v[186:187], v90 offset:9216
  ds_read_b64_tr_b16 v[188:189], v90 offset:12288
  ds_read_b64_tr_b16 v[190:191], v90 offset:13312
  ds_read_b64_tr_b16 v[192:193], v89 offset:0
  ds_read_b64_tr_b16 v[194:195], v89 offset:1024
  ds_read_b64_tr_b16 v[196:197], v89 offset:4096
  ds_read_b64_tr_b16 v[198:199], v89 offset:5120
  ds_read_b64_tr_b16 v[200:201], v89 offset:8192
  ds_read_b64_tr_b16 v[202:203], v89 offset:9216
  ds_read_b64_tr_b16 v[204:205], v89 offset:12288
  ds_read_b64_tr_b16 v[206:207], v89 offset:13312
  s_waitcnt lgkmcnt(15)
  v_mfma_f32_16x16x32_bf16 v[96:99], v[56:59], v[160:163], 0
  v_mfma_f32_16x16x32_bf16 v[108:111], v[72:75], v[160:163], 0
  s_waitcnt lgkmcnt(15)
  v_mfma_f32_16x16x32_bf16 v[96:99], v[60:63], v[164:167], v[96:99]
  v_mfma_f32_16x16x32_bf16 v[108:111], v[76:79], v[164:167], v[108:111]
  s_waitcnt lgkmcnt(15)
  v_mfma_f32_16x16x32_bf16 v[96:99], v[64:67], v[168:171], v[96:99]
  v_mfma_f32_16x16x32_bf16 v[108:111], v[80:83], v[168:171], v[108:111]
  s_waitcnt lgkmcnt(15)
  v_mfma_f32_16x16x32_bf16 v[96:99], v[68:71], v[172:175], v[96:99]
  v_mfma_f32_16x16x32_bf16 v[108:111], v[84:87], v[172:175], v[108:111]
  ds_read_b64_tr_b16 v[160:161], v91 offset:0
  ds_read_b64_tr_b16 v[162:163], v91 offset:1024
  ds_read_b64_tr_b16 v[164:165], v91 offset:4096
  s_add_u32 m0, s17, 32768
  s_nop 0
  buffer_load_dwordx4 v12, s[56:59], s10 offen offset:0 lds
  ds_read_b64_tr_b16 v[166:167], v91 offset:5120
  ds_read_b64_tr_b16 v[168:169], v91 offset:8192
  ds_read_b64_tr_b16 v[170:171], v91 offset:9216
  ds_read_b64_tr_b16 v[172:173], v91 offset:12288
  ds_read_b64_tr_b16 v[174:175], v91 offset:13312
  s_waitcnt lgkmcnt(15)
  v_mfma_f32_16x16x32_bf16 v[136:139], v[56:59], v[176:179], 0
  v_mfma_f32_16x16x32_bf16 v[148:151], v[72:75], v[176:179], 0
  s_waitcnt lgkmcnt(15)
  v_mfma_f32_16x16x32_bf16 v[136:139], v[60:63], v[180:183], v[136:139]
  buffer_load_dwordx4 v13, s[56:59], s10 offen offset:1024 lds
  v_mfma_f32_16x16x32_bf16 v[148:151], v[76:79], v[180:183], v[148:151]
  s_waitcnt lgkmcnt(15)
  v_mfma_f32_16x16x32_bf16 v[136:139], v[64:67], v[184:187], v[136:139]
  v_mfma_f32_16x16x32_bf16 v[148:151], v[80:83], v[184:187], v[148:151]
  s_waitcnt lgkmcnt(15)
  v_mfma_f32_16x16x32_bf16 v[136:139], v[68:71], v[188:191], v[136:139]
  buffer_load_dwordx4 v14, s[56:59], s10 offen offset:2048 lds
  v_mfma_f32_16x16x32_bf16 v[148:151], v[84:87], v[188:191], v[148:151]
  s_waitcnt lgkmcnt(14)
  v_mfma_f32_16x16x32_bf16 v[112:115], v[56:59], v[192:195], 0
  v_mfma_f32_16x16x32_bf16 v[132:135], v[72:75], v[192:195], 0
  s_waitcnt lgkmcnt(12)
  v_mfma_f32_16x16x32_bf16 v[112:115], v[60:63], v[196:199], v[112:115]
  buffer_load_dwordx4 v15, s[56:59], s10 offen offset:3072 lds
  v_mfma_f32_16x16x32_bf16 v[132:135], v[76:79], v[196:199], v[132:135]
  s_waitcnt lgkmcnt(10)
  v_mfma_f32_16x16x32_bf16 v[112:115], v[64:67], v[200:203], v[112:115]
  v_mfma_f32_16x16x32_bf16 v[132:135], v[80:83], v[200:203], v[132:135]
  s_waitcnt lgkmcnt(8)
  v_mfma_f32_16x16x32_bf16 v[112:115], v[68:71], v[204:207], v[112:115]
  s_add_u32 m0, s16, 32768
  s_nop 0
  buffer_load_dwordx4 v8, s[44:47], s10 offen offset:0 lds
  v_mfma_f32_16x16x32_bf16 v[132:135], v[84:87], v[204:207], v[132:135]
  s_waitcnt lgkmcnt(6)
  v_mfma_f32_16x16x32_bf16 v[152:155], v[56:59], v[160:163], 0
  v_mfma_f32_16x16x32_bf16 v[156:159], v[72:75], v[160:163], 0
  s_waitcnt lgkmcnt(4)
  v_mfma_f32_16x16x32_bf16 v[152:155], v[60:63], v[164:167], v[152:155]
  buffer_load_dwordx4 v9, s[44:47], s10 offen offset:1024 lds
  v_mfma_f32_16x16x32_bf16 v[156:159], v[76:79], v[164:167], v[156:159]
  s_waitcnt lgkmcnt(2)
  v_mfma_f32_16x16x32_bf16 v[152:155], v[64:67], v[168:171], v[152:155]
  v_mfma_f32_16x16x32_bf16 v[156:159], v[80:83], v[168:171], v[156:159]
  s_waitcnt lgkmcnt(0)
  v_mfma_f32_16x16x32_bf16 v[152:155], v[68:71], v[172:175], v[152:155]
  buffer_load_dwordx4 v10, s[44:47], s10 offen offset:2048 lds
  v_mfma_f32_16x16x32_bf16 v[156:159], v[84:87], v[172:175], v[156:159]
  v_pk_add_f32 v[176:177], v[96:97], v[136:137]
  v_pk_add_f32 v[184:185], v[96:97], v[136:137] neg_lo:[0,1] neg_hi:[0,1]
  v_pk_add_f32 v[178:179], v[98:99], v[138:139]
  v_pk_add_f32 v[186:187], v[98:99], v[138:139] neg_lo:[0,1] neg_hi:[0,1]
  v_pk_add_f32 v[180:181], v[108:109], v[148:149]
  v_pk_add_f32 v[188:189], v[108:109], v[148:149] neg_lo:[0,1] neg_hi:[0,1]
  v_pk_add_f32 v[182:183], v[110:111], v[150:151]
  v_pk_add_f32 v[190:191], v[110:111], v[150:151] neg_lo:[0,1] neg_hi:[0,1]
  v_pk_add_f32 v[192:193], v[112:113], v[152:153]
  v_pk_add_f32 v[200:201], v[112:113], v[152:153] neg_lo:[0,1] neg_hi:[0,1]
  v_pk_add_f32 v[194:195], v[114:115], v[154:155]
  v_pk_add_f32 v[202:203], v[114:115], v[154:155] neg_lo:[0,1] neg_hi:[0,1]
  buffer_load_dwordx4 v11, s[44:47], s10 offen offset:3072 lds
  s_add_u32 s10, s10, 128
  s_and_b32 s10, s10, 0x7ff
  v_pk_add_f32 v[196:197], v[132:133], v[156:157]
  v_pk_add_f32 v[204:205], v[132:133], v[156:157] neg_lo:[0,1] neg_hi:[0,1]
  v_pk_add_f32 v[198:199], v[134:135], v[158:159]
  v_pk_add_f32 v[206:207], v[134:135], v[158:159] neg_lo:[0,1] neg_hi:[0,1]
  v_pk_add_f32 v[96:97], v[176:177], v[192:193]
  v_pk_add_f32 v[136:137], v[176:177], v[192:193] neg_lo:[0,1] neg_hi:[0,1]
  v_pk_add_f32 v[108:109], v[180:181], v[196:197]
  v_pk_add_f32 v[148:149], v[180:181], v[196:197] neg_lo:[0,1] neg_hi:[0,1]
  v_pk_add_f32 v[112:113], v[184:185], v[204:205]
  v_pk_add_f32 v[132:133], v[188:189], v[200:201] neg_lo:[0,1] neg_hi:[0,1]
  v_pk_add_f32 v[152:153], v[184:185], v[204:205] neg_lo:[0,1] neg_hi:[0,1]
  v_pk_add_f32 v[156:157], v[188:189], v[200:201]
  v_pk_add_f32 v[98:99], v[178:179], v[194:195]
  v_pk_add_f32 v[138:139], v[178:179], v[194:195] neg_lo:[0,1] neg_hi:[0,1]
  v_pk_add_f32 v[110:111], v[182:183], v[198:199]
  v_pk_add_f32 v[150:151], v[182:183], v[198:199] neg_lo:[0,1] neg_hi:[0,1]
  s_add_u32 m0, s17, 49152
  s_nop 0
  buffer_load_dwordx4 v12, s[56:59], s10 offen offset:0 lds
  v_pk_add_f32 v[114:115], v[186:187], v[206:207]
  v_pk_add_f32 v[134:135], v[190:191], v[202:203] neg_lo:[0,1] neg_hi:[0,1]
  v_pk_add_f32 v[154:155], v[186:187], v[206:207] neg_lo:[0,1] neg_hi:[0,1]
  v_pk_add_f32 v[158:159], v[190:191], v[202:203]
  v_cmp_gt_u32 vcc, 16, v0
  s_nop 1
  v_cndmask_b32 v112, v112, v184, vcc
  v_cndmask_b32 v132, v132, -v200, vcc
  v_cndmask_b32 v152, v152, v188, vcc
  v_cndmask_b32 v156, v156, -v204, vcc
  v_cvt_pk_bf16_f32 v160, v96, v108
  v_cvt_pk_bf16_f32 v161, v112, v132
  v_cvt_pk_bf16_f32 v162, v136, v148
  v_cvt_pk_bf16_f32 v163, v152, v156
  v_cvt_pk_bf16_f32 v164, v97, v109
  v_cvt_pk_bf16_f32 v165, v113, v133
  v_cvt_pk_bf16_f32 v166, v137, v149
  buffer_load_dwordx4 v13, s[56:59], s10 offen offset:1024 lds
  v_cvt_pk_bf16_f32 v167, v153, v157
  v_cvt_pk_bf16_f32 v168, v98, v110
  v_cvt_pk_bf16_f32 v169, v114, v134
  v_cvt_pk_bf16_f32 v170, v138, v150
  v_cvt_pk_bf16_f32 v171, v154, v158
  v_cvt_pk_bf16_f32 v172, v99, v111
  v_cvt_pk_bf16_f32 v173, v115, v135
  v_cvt_pk_bf16_f32 v174, v139, v151
  v_cvt_pk_bf16_f32 v175, v155, v159
  s_mov_b32 s28, 262144
  v_mul_lo_u32 v55, v6, s28
  v_lshl_add_u32 v55, v5, 2, v55
  s_mul_i32 s28, s3, 1048576
  s_lshl_b32 s29, s42, 10
  s_add_u32 s28, s28, s29
  s_lshl_b32 s29, s43, 6
  buffer_load_dwordx4 v14, s[56:59], s10 offen offset:2048 lds
  s_add_u32 s28, s28, s29
  s_and_b32 s29, s3, 1
  s_lshl_b32 s29, s29, 13
  s_add_u32 s29, s29, 131072
  v_lshrrev_b32 v74, 2, v4
  v_lshlrev_b32 v74, 7, v74
  v_and_b32 v75, 3, v4
  v_lshl_or_b32 v74, v75, 3, v74
  v_add_u32 v74, s29, v74
  v_bfe_u32 v75, v4, 3, 2
  s_and_b32 s29, s3, 2
  v_xor_b32 v75, s29, v75
  v_lshl_add_u32 v72, v75, 5, v74
  v_xor_b32 v73, 32, v72
  ds_read_b64_tr_b16 v[56:57], v72 offset:0
  ds_read_b64_tr_b16 v[58:59], v72 offset:2048
  buffer_load_dwordx4 v15, s[56:59], s10 offen offset:3072 lds
  ds_read_b64_tr_b16 v[60:61], v72 offset:4096
  ds_read_b64_tr_b16 v[62:63], v72 offset:6144
  ds_read_b64_tr_b16 v[64:65], v73 offset:0
  ds_read_b64_tr_b16 v[66:67], v73 offset:2048
  ds_read_b64_tr_b16 v[68:69], v73 offset:4096
  ds_read_b64_tr_b16 v[70:71], v73 offset:6144
  s_add_u32 m0, s16, 49152
  s_nop 0
  buffer_load_dwordx4 v8, s[44:47], s10 offen offset:0 lds
  buffer_load_dwordx4 v9, s[44:47], s10 offen offset:1024 lds
  buffer_load_dwordx4 v10, s[44:47], s10 offen offset:2048 lds
  buffer_load_dwordx4 v11, s[44:47], s10 offen offset:3072 lds
  s_add_u32 s10, s10, 128
  s_and_b32 s10, s10, 0x7ff
  s_add_u32 s60, s34, 19922944
  s_addc_u32 s61, s35, 0
  s_mov_b32 s62, 8192
  s_mov_b32 s63, 0x20000
  s_lshl_b32 s29, s39, 14
  s_add_u32 s66, s29, 19988480
  s_add_u32 s64, s34, s66
  s_addc_u32 s65, s35, 0
  s_mov_b32 s66, 8192
  s_mov_b32 s67, 0x20000
  s_bitcmp1_b32 s3, 0
  s_cselect_b32 s68, s22, s20
  s_cselect_b32 s69, s23, s21
  s_mov_b32 s70, 2097152
  s_mov_b32 s71, 0x20000
  s_mov_b32 s20, s6
  s_mov_b32 s21, s7
  s_mov_b32 s22, 2101248
  s_mov_b32 s23, 0x20000
  s_mov_b32 s72, s8
  s_mov_b32 s73, s9
  s_mov_b32 s74, 2101248
  s_mov_b32 s75, 0x20000
  s_waitcnt vmcnt(35)
  s_barrier
  ds_read_b128 v[88:91], v16 offset:0
  ds_read_b128 v[96:99], v20 offset:0
  ds_read_b128 v[92:95], v16 offset:4096
  ds_read_b128 v[108:111], v20 offset:4096
  s_waitcnt lgkmcnt(2)
  v_mfma_f32_32x32x16_bf16 v[72:87], v[88:91], v[96:99], 0
  ds_read_b128 v[112:115], v17 offset:0
  ds_read_b128 v[136:139], v21 offset:0
  buffer_store_dword v160, v55, s[24:27], s28 offen sc1
  s_add_u32 s28, s28, 16384
  s_waitcnt lgkmcnt(2)
  v_mfma_f32_32x32x16_bf16 v[176:191], v[88:91], v[108:111], 0
  ds_read_b128 v[132:135], v17 offset:4096
  ds_read_b128 v[148:151], v21 offset:4096
  buffer_store_dword v161, v55, s[24:27], s28 offen sc1
  s_add_u32 s28, s28, 16384
  v_mfma_f32_32x32x16_bf16 v[208:223], v[92:95], v[108:111], 0
  buffer_store_dword v162, v55, s[24:27], s28 offen sc1
  s_add_u32 s28, s28, 16384
  v_mfma_f32_32x32x16_bf16 v[192:207], v[92:95], v[96:99], 0
  buffer_store_dword v163, v55, s[24:27], s28 offen sc1
  s_add_u32 s28, s28, 16384
  s_waitcnt lgkmcnt(2)
  v_mfma_f32_32x32x16_bf16 v[72:87], v[112:115], v[136:139], v[72:87]
  ds_read_b128 v[88:91], v18 offset:0
  ds_read_b128 v[96:99], v22 offset:0
  buffer_store_dword v164, v55, s[24:27], s28 offen sc1
  s_add_u32 s28, s28, 16384
  s_waitcnt lgkmcnt(2)
  v_mfma_f32_32x32x16_bf16 v[176:191], v[112:115], v[148:151], v[176:191]
  ds_read_b128 v[92:95], v18 offset:4096
  ds_read_b128 v[108:111], v22 offset:4096
  buffer_store_dword v165, v55, s[24:27], s28 offen sc1
  s_add_u32 s28, s28, 16384
  v_mfma_f32_32x32x16_bf16 v[208:223], v[132:135], v[148:151], v[208:223]
  buffer_store_dword v166, v55, s[24:27], s28 offen sc1
  s_add_u32 s28, s28, 16384
  v_mfma_f32_32x32x16_bf16 v[192:207], v[132:135], v[136:139], v[192:207]
  buffer_store_dword v167, v55, s[24:27], s28 offen sc1
  s_add_u32 s28, s28, 16384
  s_waitcnt lgkmcnt(2)
  v_mfma_f32_32x32x16_bf16 v[72:87], v[88:91], v[96:99], v[72:87]
  ds_read_b128 v[112:115], v19 offset:0
  ds_read_b128 v[136:139], v23 offset:0
  buffer_store_dword v168, v55, s[24:27], s28 offen sc1
  s_add_u32 s28, s28, 16384
  s_waitcnt lgkmcnt(2)
  v_mfma_f32_32x32x16_bf16 v[176:191], v[88:91], v[108:111], v[176:191]
  ds_read_b128 v[132:135], v19 offset:4096
  ds_read_b128 v[148:151], v23 offset:4096
  buffer_store_dword v169, v55, s[24:27], s28 offen sc1
  s_add_u32 s28, s28, 16384
  v_mfma_f32_32x32x16_bf16 v[208:223], v[92:95], v[108:111], v[208:223]
  buffer_store_dword v170, v55, s[24:27], s28 offen sc1
  s_add_u32 s28, s28, 16384
  v_mfma_f32_32x32x16_bf16 v[192:207], v[92:95], v[96:99], v[192:207]
  buffer_store_dword v171, v55, s[24:27], s28 offen sc1
  s_add_u32 s28, s28, 16384
  s_waitcnt vmcnt(28) lgkmcnt(0)
  s_barrier
  v_mfma_f32_32x32x16_bf16 v[72:87], v[112:115], v[136:139], v[72:87]
  ds_read_b128 v[88:91], v16 offset:16384
  ds_read_b128 v[96:99], v20 offset:16384
  buffer_store_dword v172, v55, s[24:27], s28 offen sc1
  s_add_u32 s28, s28, 16384
  v_mfma_f32_32x32x16_bf16 v[176:191], v[112:115], v[148:151], v[176:191]
  ds_read_b128 v[92:95], v16 offset:20480
  ds_read_b128 v[108:111], v20 offset:20480
  buffer_store_dword v173, v55, s[24:27], s28 offen sc1
  s_add_u32 s28, s28, 16384
  v_mfma_f32_32x32x16_bf16 v[208:223], v[132:135], v[148:151], v[208:223]
  s_add_u32 m0, s17, 0
  s_nop 0
  buffer_load_dwordx4 v12, s[56:59], s10 offen offset:0 lds
  buffer_store_dword v174, v55, s[24:27], s28 offen sc1
  s_add_u32 s28, s28, 16384
  v_mfma_f32_32x32x16_bf16 v[192:207], v[132:135], v[136:139], v[192:207]
  buffer_load_dwordx4 v13, s[56:59], s10 offen offset:1024 lds
  buffer_store_dword v175, v55, s[24:27], s28 offen sc1
  s_sub_u32 s29, 15, s38
  s_waitcnt lgkmcnt(2)
  v_mfma_f32_32x32x16_bf16 v[72:87], v[88:91], v[96:99], v[72:87]
  ds_read_b128 v[112:115], v17 offset:16384
  ds_read_b128 v[136:139], v21 offset:16384
  s_lshl_b32 s29, s29, 9
  v_lshl_add_u32 v152, v0, 2, s29
  v_mov_b32 v153, -1
  s_waitcnt lgkmcnt(2)
  v_mfma_f32_32x32x16_bf16 v[176:191], v[88:91], v[108:111], v[176:191]
  ds_read_b128 v[132:135], v17 offset:20480
  ds_read_b128 v[148:151], v21 offset:20480
  s_cmp_ge_u32 s3, 2
  s_cbranch_scc1 gated_mix__spectral_gfnet__ssm_conv_s5__prompt_kernel_skip5
  buffer_store_dword v153, v152, s[64:67], 0 offen sc1
gated_mix__spectral_gfnet__ssm_conv_s5__prompt_kernel_skip5:
  v_mfma_f32_32x32x16_bf16 v[208:223], v[92:95], v[108:111], v[208:223]
  buffer_load_dwordx4 v14, s[56:59], s10 offen offset:2048 lds
  s_cmp_lg_u32 s3, 0
  s_cbranch_scc1 gated_mix__spectral_gfnet__ssm_conv_s5__prompt_kernel_skip6
  s_mov_b64 exec, 1
  buffer_store_dword v2, v25, s[48:51], s5 offen sc1
  buffer_store_dword v2, v24, s[48:51], s4 offen sc1
  s_mov_b64 exec, -1
gated_mix__spectral_gfnet__ssm_conv_s5__prompt_kernel_skip6:
  v_mfma_f32_32x32x16_bf16 v[192:207], v[92:95], v[96:99], v[192:207]
  buffer_load_dwordx4 v15, s[56:59], s10 offen offset:3072 lds
  s_or_b32 s29, s3, s2
  s_cmp_lg_u32 s29, 0
  s_cbranch_scc1 gated_mix__spectral_gfnet__ssm_conv_s5__prompt_kernel_skip7
  s_mov_b64 exec, 1
  buffer_store_dword v7, v2, s[52:55], 0 offen sc1
  s_mov_b64 exec, -1
gated_mix__spectral_gfnet__ssm_conv_s5__prompt_kernel_skip7:
  s_waitcnt lgkmcnt(2)
  v_mfma_f32_32x32x16_bf16 v[72:87], v[112:115], v[136:139], v[72:87]
  ds_read_b128 v[88:91], v18 offset:16384
  ds_read_b128 v[96:99], v22 offset:16384
  v_mov_b32 v152, 0
  v_mov_b32 v153, 0
  v_dot2c_f32_bf16 v152, v28, v44
  s_waitcnt lgkmcnt(2)
  v_mfma_f32_32x32x16_bf16 v[176:191], v[112:115], v[148:151], v[176:191]
  ds_read_b128 v[92:95], v18 offset:20480
  ds_read_b128 v[108:111], v22 offset:20480
  v_dot2c_f32_bf16 v153, v36, v44
  v_dot2c_f32_bf16 v152, v29, v45
  v_dot2c_f32_bf16 v153, v37, v45
  v_mfma_f32_32x32x16_bf16 v[208:223], v[132:135], v[148:151], v[208:223]
  s_add_u32 m0, s16, 0
  s_nop 0
  buffer_load_dwordx4 v8, s[44:47], s10 offen offset:0 lds
  v_dot2c_f32_bf16 v152, v30, v46
  v_dot2c_f32_bf16 v153, v38, v46
  v_dot2c_f32_bf16 v152, v31, v47
  v_mfma_f32_32x32x16_bf16 v[192:207], v[132:135], v[136:139], v[192:207]
  buffer_load_dwordx4 v9, s[44:47], s10 offen offset:1024 lds
  v_dot2c_f32_bf16 v153, v39, v47
  v_dot2c_f32_bf16 v152, v32, v48
  v_dot2c_f32_bf16 v153, v40, v48
  s_waitcnt lgkmcnt(2)
  v_mfma_f32_32x32x16_bf16 v[72:87], v[88:91], v[96:99], v[72:87]
  ds_read_b128 v[112:115], v19 offset:16384
  ds_read_b128 v[136:139], v23 offset:16384
  v_dot2c_f32_bf16 v152, v33, v49
  v_dot2c_f32_bf16 v153, v41, v49
  v_dot2c_f32_bf16 v152, v34, v50
  s_waitcnt lgkmcnt(2)
  v_mfma_f32_32x32x16_bf16 v[176:191], v[88:91], v[108:111], v[176:191]
  ds_read_b128 v[132:135], v19 offset:20480
  ds_read_b128 v[148:151], v23 offset:20480
  v_dot2c_f32_bf16 v153, v42, v50
  v_dot2c_f32_bf16 v152, v35, v51
  v_dot2c_f32_bf16 v153, v43, v51
  v_mfma_f32_32x32x16_bf16 v[208:223], v[92:95], v[108:111], v[208:223]
  buffer_load_dwordx4 v10, s[44:47], s10 offen offset:2048 lds
  s_nop 0
  v_permlane32_swap_b32 v152, v153
  v_add_f32 v152, v152, v153
  v_mov_b32 v153, v152
  v_mfma_f32_32x32x16_bf16 v[192:207], v[92:95], v[96:99], v[192:207]
  buffer_load_dwordx4 v11, s[44:47], s10 offen offset:3072 lds
  s_add_u32 s10, s10, 128
  s_and_b32 s10, s10, 0x7ff
  v_permlane16_swap_b32 v152, v153
  v_add_f32 v152, v152, v153
  s_nop 1
  v_add_f32 v152, v152, v152 row_ror:8 row_mask:0xf bank_mask:0xf
  s_waitcnt vmcnt(32) lgkmcnt(0)
  s_barrier
  v_mfma_f32_32x32x16_bf16 v[72:87], v[112:115], v[136:139], v[72:87]
  ds_read_b128 v[88:91], v16 offset:32768
  ds_read_b128 v[96:99], v20 offset:32768
  v_add_f32 v152, v152, v152 row_ror:4 row_mask:0xf bank_mask:0xf
  s_nop 1
  v_add_f32 v152, v152, v152 row_ror:2 row_mask:0xf bank_mask:0xf
  s_nop 1
  v_add_f32 v152, v152, v152 row_ror:1 row_mask:0xf bank_mask:0xf
  v_mfma_f32_32x32x16_bf16 v[176:191], v[112:115], v[148:151], v[176:191]
  ds_read_b128 v[92:95], v16 offset:36864
  ds_read_b128 v[108:111], v20 offset:36864
  v_cvt_pk_bf16_f32 v152, v152, v152
  v_and_b32 v152, 0xffff0000, v152
  v_mul_f32 v152, 0xbfb8aa3b, v152
  v_mfma_f32_32x32x16_bf16 v[208:223], v[132:135], v[148:151], v[208:223]
  s_add_u32 m0, s17, 16384
  s_nop 0
  buffer_load_dwordx4 v12, s[56:59], s10 offen offset:0 lds
  v_exp_f32 v152, v152
  s_nop 0
  v_add_f32 v152, 1.0, v152
  v_rcp_f32 v152, v152
  v_mfma_f32_32x32x16_bf16 v[192:207], v[132:135], v[136:139], v[192:207]
  buffer_load_dwordx4 v13, s[56:59], s10 offen offset:1024 lds
  v_cvt_pk_bf16_f32 v152, v152, v152
  v_and_b32 v152, 0xffff0000, v152
  s_and_b32 s6, s18, 1
  s_waitcnt lgkmcnt(2)
  v_mfma_f32_32x32x16_bf16 v[72:87], v[88:91], v[96:99], v[72:87]
  ds_read_b128 v[112:115], v17 offset:32768
  ds_read_b128 v[136:139], v21 offset:32768
  s_lshl_b32 s6, s6, 2
  s_add_u32 s6, s6, s3
  s_lshl_b32 s6, s6, 10
  s_waitcnt lgkmcnt(2)
  v_mfma_f32_32x32x16_bf16 v[176:191], v[88:91], v[108:111], v[176:191]
  ds_read_b128 v[132:135], v17 offset:36864
  ds_read_b128 v[148:151], v21 offset:36864
  s_lshr_b32 s7, s18, 1
  s_lshl_b32 s7, s7, 2
  s_add_u32 s6, s6, s7
  v_mfma_f32_32x32x16_bf16 v[208:223], v[92:95], v[108:111], v[208:223]
  buffer_load_dwordx4 v14, s[56:59], s10 offen offset:2048 lds
  v_lshrrev_b32 v154, 5, v4
  v_lshlrev_b32 v154, 9, v154
  s_mov_b32 exec_lo, 1
  s_mov_b32 exec_hi, 1
  buffer_store_dword v152, v154, s[60:63], s6 offen sc1
  s_mov_b64 exec, -1
  v_mfma_f32_32x32x16_bf16 v[192:207], v[92:95], v[96:99], v[192:207]
  buffer_load_dwordx4 v15, s[56:59], s10 offen offset:3072 lds
  v_lshlrev_b32 v52, 16, v52
  v_lshlrev_b32 v53, 16, v53
  v_lshlrev_b32 v54, 16, v54
  s_waitcnt lgkmcnt(2)
  v_mfma_f32_32x32x16_bf16 v[72:87], v[112:115], v[136:139], v[72:87]
  ds_read_b128 v[88:91], v18 offset:32768
  ds_read_b128 v[96:99], v22 offset:32768
  v_mul_f32 v54, 0x3fb8aa3b, v54
  v_exp_f32 v54, v54
  s_nop 0
  v_cvt_pk_bf16_f32 v54, v54, v54
  s_waitcnt lgkmcnt(2)
  v_mfma_f32_32x32x16_bf16 v[176:191], v[112:115], v[148:151], v[176:191]
  ds_read_b128 v[92:95], v18 offset:36864
  ds_read_b128 v[108:111], v22 offset:36864
  v_and_b32 v54, 0xffff0000, v54
  v_mul_f32 v40, v54, v52
  v_mul_f32 v41, v54, v53
  v_mfma_f32_32x32x16_bf16 v[208:223], v[132:135], v[148:151], v[208:223]
  s_add_u32 m0, s16, 16384
  s_nop 0
  buffer_load_dwordx4 v8, s[44:47], s10 offen offset:0 lds
  v_mul_f32 v40, 0x3fb8aa3b, v40
  v_mul_f32 v41, 0.15915494, v41
  v_exp_f32 v40, v40
  v_mfma_f32_32x32x16_bf16 v[192:207], v[132:135], v[136:139], v[192:207]
  buffer_load_dwordx4 v9, s[44:47], s10 offen offset:1024 lds
  v_rndne_f32 v42, v41
  v_sub_f32 v41, v41, v42
  v_cos_f32 v42, v41
  s_waitcnt lgkmcnt(2)
  v_mfma_f32_32x32x16_bf16 v[72:87], v[88:91], v[96:99], v[72:87]
  ds_read_b128 v[112:115], v19 offset:32768
  ds_read_b128 v[136:139], v23 offset:32768
  v_sin_f32 v43, v41
  v_mul_f32 v28, v40, v42
  v_mul_f32 v29, v40, v43
  s_waitcnt lgkmcnt(2)
  v_mfma_f32_32x32x16_bf16 v[176:191], v[88:91], v[108:111], v[176:191]
  ds_read_b128 v[132:135], v19 offset:36864
  ds_read_b128 v[148:151], v23 offset:36864
  v_mul_f32 v40, v52, v52
  v_fma_f32 v40, v53, v53, v40
  v_rcp_f32 v40, v40
  v_mfma_f32_32x32x16_bf16 v[208:223], v[92:95], v[108:111], v[208:223]
  buffer_load_dwordx4 v10, s[44:47], s10 offen offset:2048 lds
  v_add_f32 v41, -1.0, v28
  v_add_f32 v40, v40, v40
  v_mul_f32 v42, v41, v52
  v_mfma_f32_32x32x16_bf16 v[192:207], v[92:95], v[96:99], v[192:207]
  buffer_load_dwordx4 v11, s[44:47], s10 offen offset:3072 lds
  s_add_u32 s10, s10, 128
  s_and_b32 s10, s10, 0x7ff
  v_fma_f32 v42, v29, v53, v42
  v_mul_f32 v43, v29, v52
  v_fma_f32 v43, -v41, v53, v43
  s_waitcnt vmcnt(33) lgkmcnt(0)
  s_barrier
  v_mfma_f32_32x32x16_bf16 v[72:87], v[112:115], v[136:139], v[72:87]
  ds_read_b128 v[88:91], v16 offset:49152
  ds_read_b128 v[96:99], v20 offset:49152
  v_mul_f32 v38, v42, v40
  v_mul_f32 v39, v43, v40
  v_mul_f32 v40, v29, v29
  v_mfma_f32_32x32x16_bf16 v[176:191], v[112:115], v[148:151], v[176:191]
  ds_read_b128 v[92:95], v16 offset:53248
  ds_read_b128 v[108:111], v20 offset:53248
  v_mul_f32 v31, v28, v29
  v_fma_f32 v30, v28, v28, -v40
  v_add_f32 v31, v31, v31
  v_mfma_f32_32x32x16_bf16 v[208:223], v[132:135], v[148:151], v[208:223]
  s_add_u32 m0, s17, 32768
  s_nop 0
  buffer_load_dwordx4 v12, s[56:59], s10 offen offset:0 lds
  v_mul_f32 v40, v31, v31
  v_mul_f32 v31, v30, v31
  v_fma_f32 v30, v30, v30, -v40
  v_mfma_f32_32x32x16_bf16 v[192:207], v[132:135], v[136:139], v[192:207]
  buffer_load_dwordx4 v13, s[56:59], s10 offen offset:1024 lds
  v_add_f32 v31, v31, v31
  v_mul_f32 v40, v31, v31
  v_mul_f32 v31, v30, v31
  s_waitcnt lgkmcnt(2)
  v_mfma_f32_32x32x16_bf16 v[72:87], v[88:91], v[96:99], v[72:87]
  ds_read_b128 v[112:115], v17 offset:49152
  ds_read_b128 v[136:139], v21 offset:49152
  v_fma_f32 v30, v30, v30, -v40
  v_add_f32 v31, v31, v31
  v_mul_f32 v40, v31, v31
  s_waitcnt lgkmcnt(2)
  v_mfma_f32_32x32x16_bf16 v[176:191], v[88:91], v[108:111], v[176:191]
  ds_read_b128 v[132:135], v17 offset:53248
  ds_read_b128 v[148:151], v21 offset:53248
  v_mul_f32 v31, v30, v31
  v_fma_f32 v30, v30, v30, -v40
  v_add_f32 v31, v31, v31
  v_mfma_f32_32x32x16_bf16 v[208:223], v[92:95], v[108:111], v[208:223]
  buffer_load_dwordx4 v14, s[56:59], s10 offen offset:2048 lds
  v_mul_f32 v40, v31, v31
  v_mul_f32 v33, v30, v31
  v_fma_f32 v32, v30, v30, -v40
  v_mfma_f32_32x32x16_bf16 v[192:207], v[92:95], v[96:99], v[192:207]
  buffer_load_dwordx4 v15, s[56:59], s10 offen offset:3072 lds
  v_add_f32 v33, v33, v33
  v_mul_f32 v40, v33, v33
  v_mul_f32 v35, v32, v33
  s_waitcnt lgkmcnt(2)
  v_mfma_f32_32x32x16_bf16 v[72:87], v[112:115], v[136:139], v[72:87]
  ds_read_b128 v[88:91], v18 offset:49152
  ds_read_b128 v[96:99], v22 offset:49152
  v_fma_f32 v34, v32, v32, -v40
  v_add_f32 v35, v35, v35
  v_mul_f32 v40, v35, v35
  s_waitcnt lgkmcnt(2)
  v_mfma_f32_32x32x16_bf16 v[176:191], v[112:115], v[148:151], v[176:191]
  ds_read_b128 v[92:95], v18 offset:53248
  ds_read_b128 v[108:111], v22 offset:53248
  v_mul_f32 v45, v34, v35
  v_fma_f32 v44, v34, v34, -v40
  v_add_f32 v45, v45, v45
  v_mfma_f32_32x32x16_bf16 v[208:223], v[132:135], v[148:151], v[208:223]
  s_add_u32 m0, s16, 32768
  s_nop 0
  buffer_load_dwordx4 v8, s[44:47], s10 offen offset:0 lds
  v_mul_f32 v40, v45, v45
  v_mul_f32 v37, v44, v45
  v_fma_f32 v36, v44, v44, -v40
  v_mfma_f32_32x32x16_bf16 v[192:207], v[132:135], v[136:139], v[192:207]
  buffer_load_dwordx4 v9, s[44:47], s10 offen offset:1024 lds
  v_add_f32 v37, v37, v37
  v_mul_f32 v40, v37, v37
  v_mul_f32 v37, v36, v37
  s_waitcnt lgkmcnt(2)
  v_mfma_f32_32x32x16_bf16 v[72:87], v[88:91], v[96:99], v[72:87]
  ds_read_b128 v[112:115], v19 offset:49152
  ds_read_b128 v[136:139], v23 offset:49152
  v_fma_f32 v36, v36, v36, -v40
  v_add_f32 v37, v37, v37
  v_mul_f32 v40, v37, v37
  s_waitcnt lgkmcnt(2)
  v_mfma_f32_32x32x16_bf16 v[176:191], v[88:91], v[108:111], v[176:191]
  ds_read_b128 v[132:135], v19 offset:53248
  ds_read_b128 v[148:151], v23 offset:53248
  v_mul_f32 v37, v36, v37
  v_fma_f32 v36, v36, v36, -v40
  v_add_f32 v37, v37, v37
  v_mfma_f32_32x32x16_bf16 v[208:223], v[92:95], v[108:111], v[208:223]
  buffer_load_dwordx4 v10, s[44:47], s10 offen offset:2048 lds
  s_lshl_b32 s6, s3, 8
  s_add_u32 s6, s6, 147584
  v_lshl_add_u32 v40, v5, 3, s6
  v_mfma_f32_32x32x16_bf16 v[192:207], v[92:95], v[96:99], v[192:207]
  buffer_load_dwordx4 v11, s[44:47], s10 offen offset:3072 lds
  s_add_u32 s10, s10, 128
  s_and_b32 s10, s10, 0x7ff
  v_lshl_add_u32 v40, v6, 10, v40
  s_sub_u32 s6, 15, s38
  s_lshl_b32 s6, s6, 9
  s_waitcnt vmcnt(17) lgkmcnt(0)
  s_barrier
  v_mfma_f32_32x32x16_bf16 v[72:87], v[112:115], v[136:139], v[72:87]
  ds_read_b128 v[88:91], v16 offset:0
  ds_read_b128 v[96:99], v20 offset:0
  s_and_b32 s7, s3, 1
  s_lshl_b32 s7, s7, 8
  s_add_u32 s6, s6, s7
  v_mfma_f32_32x32x16_bf16 v[176:191], v[112:115], v[148:151], v[176:191]
  ds_read_b128 v[92:95], v16 offset:4096
  ds_read_b128 v[108:111], v20 offset:4096
  buffer_load_dword v156, v2, s[52:55], 0 offen sc1
  v_and_b32 v41, 31, v4
  v_lshl_add_u32 v41, v41, 3, s6
  s_lshl_b32 s7, s38, 1
  v_mfma_f32_32x32x16_bf16 v[208:223], v[132:135], v[148:151], v[208:223]
  s_add_u32 m0, s17, 49152
  s_nop 0
  buffer_load_dwordx4 v12, s[56:59], s10 offen offset:0 lds
  s_lshr_b32 s8, s3, 1
  s_add_u32 s7, s7, s8
  s_lshl_b32 s6, s7, 9
  v_mfma_f32_32x32x16_bf16 v[192:207], v[132:135], v[136:139], v[192:207]
  buffer_load_dwordx4 v13, s[56:59], s10 offen offset:1024 lds
  s_and_b32 s7, s7, 3
  s_lshl_b32 s7, s7, 2
  v_xor_b32 v42, s7, v5
  s_waitcnt lgkmcnt(2)
  v_mfma_f32_32x32x16_bf16 v[72:87], v[88:91], v[96:99], v[72:87]
  ds_read_b128 v[112:115], v17 offset:0
  ds_read_b128 v[136:139], v21 offset:0
  v_lshlrev_b32 v42, 4, v42
  v_lshrrev_b32 v43, 1, v6
  v_lshl_or_b32 v42, v43, 14, v42
  s_waitcnt lgkmcnt(2)
  v_mfma_f32_32x32x16_bf16 v[176:191], v[88:91], v[108:111], v[176:191]
  ds_read_b128 v[132:135], v17 offset:4096
  ds_read_b128 v[148:151], v21 offset:4096
  v_and_b32 v43, 1, v6
  v_lshl_or_b32 v42, v43, 19, v42
  s_and_b32 s8, s3, 1
  v_mfma_f32_32x32x16_bf16 v[208:223], v[92:95], v[108:111], v[208:223]
  buffer_load_dwordx4 v14, s[56:59], s10 offen offset:2048 lds
  s_lshl_b32 s8, s8, 8
  s_add_u32 s6, s6, s8
  s_lshl_b32 s8, s39, 15
  v_mfma_f32_32x32x16_bf16 v[192:207], v[92:95], v[96:99], v[192:207]
  buffer_load_dwordx4 v15, s[56:59], s10 offen offset:3072 lds
  s_add_u32 s6, s6, s8
  v_and_b32 v46, 7, v4
  v_xor_b32 v46, v46, v6
  s_waitcnt lgkmcnt(2)
  v_mfma_f32_32x32x16_bf16 v[72:87], v[112:115], v[136:139], v[72:87]
  ds_read_b128 v[88:91], v18 offset:0
  ds_read_b128 v[96:99], v22 offset:0
  v_and_b32 v47, 4, v46
  v_lshlrev_b32 v48, 4, v47
  v_and_b32 v47, 1, v46
  s_waitcnt lgkmcnt(2)
  v_mfma_f32_32x32x16_bf16 v[176:191], v[112:115], v[148:151], v[176:191]
  ds_read_b128 v[92:95], v18 offset:4096
  ds_read_b128 v[108:111], v22 offset:4096
  v_lshl_or_b32 v48, v47, 5, v48
  v_bfe_u32 v47, v46, 1, 1
  v_lshl_or_b32 v48, v47, 4, v48
  v_mfma_f32_32x32x16_bf16 v[208:223], v[132:135], v[148:151], v[208:223]
  s_add_u32 m0, s16, 49152
  s_nop 0
  buffer_load_dwordx4 v8, s[44:47], s10 offen offset:0 lds
  v_lshrrev_b32 v47, 3, v4
  v_lshl_or_b32 v48, v47, 11, v48
  s_lshr_b32 s9, s3, 1
  v_mfma_f32_32x32x16_bf16 v[192:207], v[132:135], v[136:139], v[192:207]
  buffer_load_dwordx4 v9, s[44:47], s10 offen offset:1024 lds
  s_lshl_b32 s9, s9, 20
  s_lshl_b32 s7, s43, 15
  s_add_u32 s9, s9, s7
  s_waitcnt lgkmcnt(2)
  v_mfma_f32_32x32x16_bf16 v[72:87], v[88:91], v[96:99], v[72:87]
  ds_read_b128 v[112:115], v19 offset:0
  ds_read_b128 v[136:139], v23 offset:0
  v_add_u32 v48, s9, v48
  v_xor_b32 v49, 64, v48
  v_add_u32 v49, 15360, v49
  s_waitcnt lgkmcnt(2)
  v_mfma_f32_32x32x16_bf16 v[176:191], v[88:91], v[108:111], v[176:191]
  ds_read_b128 v[132:135], v19 offset:4096
  ds_read_b128 v[148:151], v23 offset:4096
  v_add_u32 v50, 522240, v48
  v_add_u32 v51, 522240, v49
  s_lshl_b32 s7, s19, 7
  v_mfma_f32_32x32x16_bf16 v[208:223], v[92:95], v[108:111], v[208:223]
  buffer_load_dwordx4 v10, s[44:47], s10 offen offset:2048 lds
  s_lshl_b32 s8, s3, 12
  v_lshrrev_b32 v46, 1, v5
  v_xor_b32 v46, v46, v6
  v_mfma_f32_32x32x16_bf16 v[192:207], v[92:95], v[96:99], v[192:207]
  buffer_load_dwordx4 v11, s[44:47], s10 offen offset:3072 lds
  s_add_u32 s10, s10, 128
  s_and_b32 s10, s10, 0x7ff
  v_lshlrev_b32 v46, 4, v46
  v_lshl_or_b32 v46, v5, 7, v46
  v_add_u32 v52, s8, v46
  s_waitcnt vmcnt(17) lgkmcnt(0)
  s_barrier
  v_mfma_f32_32x32x16_bf16 v[72:87], v[112:115], v[136:139], v[72:87]
  ds_read_b128 v[88:91], v16 offset:16384
  ds_read_b128 v[96:99], v20 offset:16384
  v_xor_b32 v53, 64, v52
  v_add_u32 v54, 0x10000, v52
  v_add_u32 v55, 0x10000, v53
  v_mfma_f32_32x32x16_bf16 v[176:191], v[112:115], v[148:151], v[176:191]
  ds_read_b128 v[92:95], v16 offset:20480
  ds_read_b128 v[108:111], v20 offset:20480
  s_cmp_lg_u32 s3, 1
  s_cbranch_scc1 gated_mix__spectral_gfnet__ssm_conv_s5__prompt_kernel_skip9
  s_getpc_b64 s[88:89]
gated_mix__spectral_gfnet__ssm_conv_s5__prompt_kernel_pc8:
  s_lshr_b32 s87, s2, 3
  s_mul_i32 s87, s87, 512
  v_min_u32 v158, 3, v4
  v_lshl_add_u32 v158, v158, 7, s87
  v_min_u32 v158, gated_mix__spectral_gfnet__ssm_conv_s5__prompt_kernel_end-gated_mix__spectral_gfnet__ssm_conv_s5__prompt_kernel_pc8, v158
  v_mov_b32 v159, 0
  v_lshl_add_u64 v[158:159], v[158:159], 0, s[88:89]
  global_load_dword v1, v[158:159], off
gated_mix__spectral_gfnet__ssm_conv_s5__prompt_kernel_skip9:
  s_lshl_b32 s76, s3, 9
  s_add_u32 s76, s76, s13
  s_lshr_b32 s29, s3, 1
  v_mfma_f32_32x32x16_bf16 v[208:223], v[132:135], v[148:151], v[208:223]
  s_add_u32 m0, s17, 0
  s_nop 0
  buffer_load_dwordx4 v12, s[56:59], s10 offen offset:0 lds
  s_and_b32 s29, s29, s14
  s_mul_i32 s29, s29, 960
  s_sub_u32 s76, s76, s29
  v_mfma_f32_32x32x16_bf16 v[192:207], v[132:135], v[136:139], v[192:207]
  buffer_load_dwordx4 v13, s[56:59], s10 offen offset:1024 lds
  s_add_u32 s78, s76, 128
  s_add_u32 s80, s76, 256
  s_add_u32 s82, s76, 384
  s_waitcnt lgkmcnt(2)
  v_mfma_f32_32x32x16_bf16 v[72:87], v[88:91], v[96:99], v[72:87]
  ds_read_b128 v[112:115], v17 offset:16384
  ds_read_b128 v[136:139], v21 offset:16384
  s_sub_u32 s77, 2048, s76
  s_and_b32 s77, s77, 2047
  s_sub_u32 s79, 2048, s78
  s_waitcnt lgkmcnt(2)
  v_mfma_f32_32x32x16_bf16 v[176:191], v[88:91], v[108:111], v[176:191]
  ds_read_b128 v[132:135], v17 offset:20480
  ds_read_b128 v[148:151], v21 offset:20480
  s_and_b32 s79, s79, 2047
  s_sub_u32 s81, 2048, s80
  s_and_b32 s81, s81, 2047
  v_mfma_f32_32x32x16_bf16 v[208:223], v[92:95], v[108:111], v[208:223]
  buffer_load_dwordx4 v14, s[56:59], s10 offen offset:2048 lds
  s_sub_u32 s83, 2048, s82
  s_and_b32 s83, s83, 2047
  s_cmp_eq_u32 s3, 0
  s_cselect_b32 s32, s14, 0
  v_mfma_f32_32x32x16_bf16 v[192:207], v[92:95], v[96:99], v[192:207]
  buffer_load_dwordx4 v15, s[56:59], s10 offen offset:3072 lds
  s_cmp_eq_u32 s32, 1
  s_cselect_b32 s77, 1024, s77
  s_mul_i32 s76, s76, 1026
  s_waitcnt lgkmcnt(2)
  v_mfma_f32_32x32x16_bf16 v[72:87], v[112:115], v[136:139], v[72:87]
  ds_read_b128 v[88:91], v18 offset:16384
  ds_read_b128 v[96:99], v22 offset:16384
  s_mul_i32 s77, s77, 1026
  s_mul_i32 s78, s78, 1026
  s_mul_i32 s79, s79, 1026
  s_waitcnt lgkmcnt(2)
  v_mfma_f32_32x32x16_bf16 v[176:191], v[112:115], v[148:151], v[176:191]
  ds_read_b128 v[92:95], v18 offset:20480
  ds_read_b128 v[108:111], v22 offset:20480
  s_mul_i32 s80, s80, 1026
  s_mul_i32 s81, s81, 1026
  s_mul_i32 s82, s82, 1026
  v_mfma_f32_32x32x16_bf16 v[208:223], v[132:135], v[148:151], v[208:223]
  s_add_u32 m0, s16, 0
  s_nop 0
  buffer_load_dwordx4 v8, s[44:47], s10 offen offset:0 lds
  s_mul_i32 s83, s83, 1026
  v_lshlrev_b32 v43, 4, v4
  s_lshl_b32 s9, s3, 12
  v_mfma_f32_32x32x16_bf16 v[192:207], v[132:135], v[136:139], v[192:207]
  buffer_load_dwordx4 v9, s[44:47], s10 offen offset:1024 lds
  s_and_b32 s29, s76, 15
  s_and_b32 s33, s77, 15
  s_add_u32 s33, s33, 2048
  s_waitcnt lgkmcnt(2)
  v_mfma_f32_32x32x16_bf16 v[72:87], v[88:91], v[96:99], v[72:87]
  ds_read_b128 v[112:115], v19 offset:16384
  ds_read_b128 v[136:139], v23 offset:16384
  v_lshlrev_b32 v46, 9, v6
  v_lshl_add_u32 v46, v5, 3, v46
  s_lshl_b32 s86, s12, 1
  s_waitcnt lgkmcnt(2)
  v_mfma_f32_32x32x16_bf16 v[176:191], v[88:91], v[108:111], v[176:191]
  ds_read_b128 v[132:135], v19 offset:20480
  ds_read_b128 v[148:151], v23 offset:20480
  v_add_u32 v46, s86, v46
  s_add_u32 s86, s33, 1664
  v_sub_u32 v154, s86, v46
  v_mfma_f32_32x32x16_bf16 v[208:223], v[92:95], v[108:111], v[208:223]
  buffer_load_dwordx4 v10, s[44:47], s10 offen offset:2048 lds
  v_add_u32 v46, s29, v46
  v_cmp_lt_u32 s[36:37], 1, v6
  s_nop 1
  v_cndmask_b32 v46, v46, v154, s[36:37]
  v_mfma_f32_32x32x16_bf16 v[192:207], v[92:95], v[96:99], v[192:207]
  buffer_load_dwordx4 v11, s[44:47], s10 offen offset:3072 lds
  s_add_u32 s10, s10, 128
  s_and_b32 s10, s10, 0x7ff
  v_cndmask_b32 v152, 1.0, -1.0, s[36:37]
  v_add_u32 v47, 384, v46
  v_and_b32 v154, 1024, v47
  s_waitcnt vmcnt(17) lgkmcnt(0)
  s_barrier
  v_mfma_f32_32x32x16_bf16 v[72:87], v[112:115], v[136:139], v[72:87]
  ds_read_b128 v[88:91], v16 offset:32768
  ds_read_b128 v[96:99], v20 offset:32768
  v_cmp_ne_u32 s[84:85], 0, v154
  s_lshl_b32 s86, s3, 8
  s_add_u32 s86, s86, 146432
  v_mfma_f32_32x32x16_bf16 v[176:191], v[112:115], v[148:151], v[176:191]
  ds_read_b128 v[92:95], v16 offset:36864
  ds_read_b128 v[108:111], v20 offset:36864
  v_add_u32 v154, s86, v47
  v_add_u32 v46, s9, v46
  v_add_u32 v47, s9, v47
  v_mfma_f32_32x32x16_bf16 v[208:223], v[132:135], v[148:151], v[208:223]
  s_add_u32 m0, s17, 16384
  s_nop 0
  buffer_load_dwordx4 v12, s[56:59], s10 offen offset:0 lds
  v_cndmask_b32 v47, v47, v154, s[84:85]
  v_sub_u32 v47, v47, v46
  v_cndmask_b32 v153, 0, -1, s[84:85]
  v_mfma_f32_32x32x16_bf16 v[192:207], v[132:135], v[136:139], v[192:207]
  buffer_load_dwordx4 v13, s[56:59], s10 offen offset:1024 lds
  s_waitcnt lgkmcnt(2)
  v_mfma_f32_32x32x16_bf16 v[72:87], v[88:91], v[96:99], v[72:87]
  ds_read_b128 v[112:115], v17 offset:32768
  ds_read_b128 v[136:139], v21 offset:32768
  s_waitcnt lgkmcnt(2)
  v_mfma_f32_32x32x16_bf16 v[176:191], v[88:91], v[108:111], v[176:191]
  ds_read_b128 v[132:135], v17 offset:36864
  ds_read_b128 v[148:151], v21 offset:36864
  v_mfma_f32_32x32x16_bf16 v[208:223], v[92:95], v[108:111], v[208:223]
  buffer_load_dwordx4 v14, s[56:59], s10 offen offset:2048 lds
  v_mfma_f32_32x32x16_bf16 v[192:207], v[92:95], v[96:99], v[192:207]
  buffer_load_dwordx4 v15, s[56:59], s10 offen offset:3072 lds
  s_waitcnt lgkmcnt(2)
  v_mfma_f32_32x32x16_bf16 v[72:87], v[112:115], v[136:139], v[72:87]
  ds_read_b128 v[88:91], v18 offset:32768
  ds_read_b128 v[96:99], v22 offset:32768
  s_waitcnt lgkmcnt(2)
  v_mfma_f32_32x32x16_bf16 v[176:191], v[112:115], v[148:151], v[176:191]
  ds_read_b128 v[92:95], v18 offset:36864
  ds_read_b128 v[108:111], v22 offset:36864
  v_mfma_f32_32x32x16_bf16 v[208:223], v[132:135], v[148:151], v[208:223]
  s_add_u32 m0, s16, 16384
  s_nop 0
  buffer_load_dwordx4 v8, s[44:47], s10 offen offset:0 lds
  v_mfma_f32_32x32x16_bf16 v[192:207], v[132:135], v[136:139], v[192:207]
  buffer_load_dwordx4 v9, s[44:47], s10 offen offset:1024 lds
  s_waitcnt lgkmcnt(2)
  v_mfma_f32_32x32x16_bf16 v[72:87], v[88:91], v[96:99], v[72:87]
  ds_read_b128 v[112:115], v19 offset:32768
  ds_read_b128 v[136:139], v23 offset:32768
  s_waitcnt lgkmcnt(2)
  v_mfma_f32_32x32x16_bf16 v[176:191], v[88:91], v[108:111], v[176:191]
  ds_read_b128 v[132:135], v19 offset:36864
  ds_read_b128 v[148:151], v23 offset:36864
  v_mfma_f32_32x32x16_bf16 v[208:223], v[92:95], v[108:111], v[208:223]
  buffer_load_dwordx4 v10, s[44:47], s10 offen offset:2048 lds
  v_mfma_f32_32x32x16_bf16 v[192:207], v[92:95], v[96:99], v[192:207]
  buffer_load_dwordx4 v11, s[44:47], s10 offen offset:3072 lds
  s_add_u32 s10, s10, 128
  s_and_b32 s10, s10, 0x7ff
  s_waitcnt vmcnt(16) lgkmcnt(0)
  s_barrier
  v_mfma_f32_32x32x16_bf16 v[72:87], v[112:115], v[136:139], v[72:87]
  ds_read_b128 v[88:91], v16 offset:49152
  ds_read_b128 v[96:99], v20 offset:49152
  v_mfma_f32_32x32x16_bf16 v[176:191], v[112:115], v[148:151], v[176:191]
  ds_read_b128 v[92:95], v16 offset:53248
  ds_read_b128 v[108:111], v20 offset:53248
  v_cmp_ne_u32 vcc, 1, v156
  s_nop 0
  s_cbranch_vccz gated_mix__spectral_gfnet__ssm_conv_s5__prompt_kernel_skip10
  s_mov_b32 s87, 0
gated_mix__spectral_gfnet__ssm_conv_s5__prompt_kernel_poll11:
  s_sleep 2
  buffer_load_dword v156, v2, s[52:55], 0 offen sc1
  s_waitcnt vmcnt(0)
  v_cmp_ne_u32 vcc, 1, v156
  s_nop 0
  s_cbranch_vccz gated_mix__spectral_gfnet__ssm_conv_s5__prompt_kernel_pollout12
  s_add_u32 s87, s87, 1
  s_cmp_lt_u32 s87, 1048576
  s_cbranch_scc1 gated_mix__spectral_gfnet__ssm_conv_s5__prompt_kernel_poll11
gated_mix__spectral_gfnet__ssm_conv_s5__prompt_kernel_pollout12:
gated_mix__spectral_gfnet__ssm_conv_s5__prompt_kernel_skip10:
  s_cmp_lg_u32 s3, 0
  s_cbranch_scc1 gated_mix__spectral_gfnet__ssm_conv_s5__prompt_kernel_skip13
  s_mov_b64 exec, 1
  buffer_store_dword v7, v24, s[48:51], 0 offen sc1
  s_mov_b64 exec, -1
gated_mix__spectral_gfnet__ssm_conv_s5__prompt_kernel_skip13:
  v_mfma_f32_32x32x16_bf16 v[208:223], v[132:135], v[148:151], v[208:223]
  s_add_u32 m0, s17, 32768
  s_nop 0
  buffer_load_dwordx4 v12, s[56:59], s10 offen offset:0 lds
  v_mfma_f32_32x32x16_bf16 v[192:207], v[132:135], v[136:139], v[192:207]
  buffer_load_dwordx4 v13, s[56:59], s10 offen offset:1024 lds
  s_waitcnt lgkmcnt(2)
  v_mfma_f32_32x32x16_bf16 v[72:87], v[88:91], v[96:99], v[72:87]
  ds_read_b128 v[112:115], v17 offset:49152
  ds_read_b128 v[136:139], v21 offset:49152
  s_waitcnt lgkmcnt(2)
  v_mfma_f32_32x32x16_bf16 v[176:191], v[88:91], v[108:111], v[176:191]
  ds_read_b128 v[132:135], v17 offset:53248
  ds_read_b128 v[148:151], v21 offset:53248
  v_mfma_f32_32x32x16_bf16 v[208:223], v[92:95], v[108:111], v[208:223]
  buffer_load_dwordx4 v14, s[56:59], s10 offen offset:2048 lds
  v_mfma_f32_32x32x16_bf16 v[192:207], v[92:95], v[96:99], v[192:207]
  buffer_load_dwordx4 v15, s[56:59], s10 offen offset:3072 lds
  s_waitcnt lgkmcnt(2)
  v_mfma_f32_32x32x16_bf16 v[72:87], v[112:115], v[136:139], v[72:87]
  ds_read_b128 v[88:91], v18 offset:49152
  ds_read_b128 v[96:99], v22 offset:49152
  s_waitcnt lgkmcnt(2)
  v_mfma_f32_32x32x16_bf16 v[176:191], v[112:115], v[148:151], v[176:191]
  ds_read_b128 v[92:95], v18 offset:53248
  ds_read_b128 v[108:111], v22 offset:53248
  v_mfma_f32_32x32x16_bf16 v[208:223], v[132:135], v[148:151], v[208:223]
  s_add_u32 m0, s16, 32768
  s_nop 0
  buffer_load_dwordx4 v8, s[44:47], s10 offen offset:0 lds
  v_mfma_f32_32x32x16_bf16 v[192:207], v[132:135], v[136:139], v[192:207]
  buffer_load_dwordx4 v9, s[44:47], s10 offen offset:1024 lds
  s_waitcnt lgkmcnt(2)
  v_mfma_f32_32x32x16_bf16 v[72:87], v[88:91], v[96:99], v[72:87]
  ds_read_b128 v[112:115], v19 offset:49152
  ds_read_b128 v[136:139], v23 offset:49152
  s_waitcnt lgkmcnt(2)
  v_mfma_f32_32x32x16_bf16 v[176:191], v[88:91], v[108:111], v[176:191]
  ds_read_b128 v[132:135], v19 offset:53248
  ds_read_b128 v[148:151], v23 offset:53248
  v_mfma_f32_32x32x16_bf16 v[208:223], v[92:95], v[108:111], v[208:223]
  buffer_load_dwordx4 v10, s[44:47], s10 offen offset:2048 lds
  v_mfma_f32_32x32x16_bf16 v[192:207], v[92:95], v[96:99], v[192:207]
  buffer_load_dwordx4 v11, s[44:47], s10 offen offset:3072 lds
  s_add_u32 s10, s10, 128
  s_and_b32 s10, s10, 0x7ff
  s_waitcnt vmcnt(16) lgkmcnt(0)
  s_barrier
  v_mfma_f32_32x32x16_bf16 v[72:87], v[112:115], v[136:139], v[72:87]
  ds_read_b128 v[88:91], v16 offset:0
  ds_read_b128 v[96:99], v20 offset:0
  v_mfma_f32_32x32x16_bf16 v[176:191], v[112:115], v[148:151], v[176:191]
  ds_read_b128 v[92:95], v16 offset:4096
  ds_read_b128 v[108:111], v20 offset:4096
  v_mfma_f32_32x32x16_bf16 v[208:223], v[132:135], v[148:151], v[208:223]
  s_add_u32 m0, s17, 49152
  s_nop 0
  buffer_load_dwordx4 v12, s[56:59], s10 offen offset:0 lds
  v_mfma_f32_32x32x16_bf16 v[192:207], v[132:135], v[136:139], v[192:207]
  buffer_load_dwordx4 v13, s[56:59], s10 offen offset:1024 lds
  s_waitcnt lgkmcnt(2)
  v_mfma_f32_32x32x16_bf16 v[72:87], v[88:91], v[96:99], v[72:87]
  ds_read_b128 v[112:115], v17 offset:0
  ds_read_b128 v[136:139], v21 offset:0
  s_waitcnt lgkmcnt(2)
  v_mfma_f32_32x32x16_bf16 v[176:191], v[88:91], v[108:111], v[176:191]
  ds_read_b128 v[132:135], v17 offset:4096
  ds_read_b128 v[148:151], v21 offset:4096
  v_mfma_f32_32x32x16_bf16 v[208:223], v[92:95], v[108:111], v[208:223]
  buffer_load_dwordx4 v14, s[56:59], s10 offen offset:2048 lds
  v_mfma_f32_32x32x16_bf16 v[192:207], v[92:95], v[96:99], v[192:207]
  buffer_load_dwordx4 v15, s[56:59], s10 offen offset:3072 lds
  s_waitcnt lgkmcnt(2)
  v_mfma_f32_32x32x16_bf16 v[72:87], v[112:115], v[136:139], v[72:87]
  ds_read_b128 v[88:91], v18 offset:0
  ds_read_b128 v[96:99], v22 offset:0
  s_waitcnt lgkmcnt(2)
  v_mfma_f32_32x32x16_bf16 v[176:191], v[112:115], v[148:151], v[176:191]
  ds_read_b128 v[92:95], v18 offset:4096
  ds_read_b128 v[108:111], v22 offset:4096
  v_mfma_f32_32x32x16_bf16 v[208:223], v[132:135], v[148:151], v[208:223]
  s_add_u32 m0, s16, 49152
  s_nop 0
  buffer_load_dwordx4 v8, s[44:47], s10 offen offset:0 lds
  v_mfma_f32_32x32x16_bf16 v[192:207], v[132:135], v[136:139], v[192:207]
  buffer_load_dwordx4 v9, s[44:47], s10 offen offset:1024 lds
  s_waitcnt lgkmcnt(2)
  v_mfma_f32_32x32x16_bf16 v[72:87], v[88:91], v[96:99], v[72:87]
  ds_read_b128 v[112:115], v19 offset:0
  ds_read_b128 v[136:139], v23 offset:0
  s_waitcnt lgkmcnt(2)
  v_mfma_f32_32x32x16_bf16 v[176:191], v[88:91], v[108:111], v[176:191]
  ds_read_b128 v[132:135], v19 offset:4096
  ds_read_b128 v[148:151], v23 offset:4096
  v_mfma_f32_32x32x16_bf16 v[208:223], v[92:95], v[108:111], v[208:223]
  buffer_load_dwordx4 v10, s[44:47], s10 offen offset:2048 lds
  v_mfma_f32_32x32x16_bf16 v[192:207], v[92:95], v[96:99], v[192:207]
  buffer_load_dwordx4 v11, s[44:47], s10 offen offset:3072 lds
  s_add_u32 s10, s10, 128
  s_and_b32 s10, s10, 0x7ff
  s_waitcnt vmcnt(16) lgkmcnt(0)
  s_barrier
  v_mfma_f32_32x32x16_bf16 v[72:87], v[112:115], v[136:139], v[72:87]
  ds_read_b128 v[88:91], v16 offset:16384
  ds_read_b128 v[96:99], v20 offset:16384
  v_mfma_f32_32x32x16_bf16 v[176:191], v[112:115], v[148:151], v[176:191]
  ds_read_b128 v[92:95], v16 offset:20480
  ds_read_b128 v[108:111], v20 offset:20480
  v_mfma_f32_32x32x16_bf16 v[208:223], v[132:135], v[148:151], v[208:223]
  s_add_u32 m0, s17, 0
  s_nop 0
  buffer_load_dwordx4 v12, s[56:59], s10 offen offset:0 lds
  v_mfma_f32_32x32x16_bf16 v[192:207], v[132:135], v[136:139], v[192:207]
  buffer_load_dwordx4 v13, s[56:59], s10 offen offset:1024 lds
  s_waitcnt lgkmcnt(2)
  v_mfma_f32_32x32x16_bf16 v[72:87], v[88:91], v[96:99], v[72:87]
  ds_read_b128 v[112:115], v17 offset:16384
  ds_read_b128 v[136:139], v21 offset:16384
  s_waitcnt lgkmcnt(2)
  v_mfma_f32_32x32x16_bf16 v[176:191], v[88:91], v[108:111], v[176:191]
  ds_read_b128 v[132:135], v17 offset:20480
  ds_read_b128 v[148:151], v21 offset:20480
  v_mfma_f32_32x32x16_bf16 v[208:223], v[92:95], v[108:111], v[208:223]
  buffer_load_dwordx4 v14, s[56:59], s10 offen offset:2048 lds
  v_mfma_f32_32x32x16_bf16 v[192:207], v[92:95], v[96:99], v[192:207]
  buffer_load_dwordx4 v15, s[56:59], s10 offen offset:3072 lds
  s_waitcnt lgkmcnt(2)
  v_mfma_f32_32x32x16_bf16 v[72:87], v[112:115], v[136:139], v[72:87]
  ds_read_b128 v[88:91], v18 offset:16384
  ds_read_b128 v[96:99], v22 offset:16384
  s_waitcnt lgkmcnt(2)
  v_mfma_f32_32x32x16_bf16 v[176:191], v[112:115], v[148:151], v[176:191]
  ds_read_b128 v[92:95], v18 offset:20480
  ds_read_b128 v[108:111], v22 offset:20480
  v_mfma_f32_32x32x16_bf16 v[208:223], v[132:135], v[148:151], v[208:223]
  s_add_u32 m0, s16, 0
  s_nop 0
  buffer_load_dwordx4 v8, s[44:47], s10 offen offset:0 lds
  v_mfma_f32_32x32x16_bf16 v[192:207], v[132:135], v[136:139], v[192:207]
  buffer_load_dwordx4 v9, s[44:47], s10 offen offset:1024 lds
  s_waitcnt lgkmcnt(2)
  v_mfma_f32_32x32x16_bf16 v[72:87], v[88:91], v[96:99], v[72:87]
  ds_read_b128 v[112:115], v19 offset:16384
  ds_read_b128 v[136:139], v23 offset:16384
  s_waitcnt lgkmcnt(2)
  v_mfma_f32_32x32x16_bf16 v[176:191], v[88:91], v[108:111], v[176:191]
  ds_read_b128 v[132:135], v19 offset:20480
  ds_read_b128 v[148:151], v23 offset:20480
  v_mfma_f32_32x32x16_bf16 v[208:223], v[92:95], v[108:111], v[208:223]
  buffer_load_dwordx4 v10, s[44:47], s10 offen offset:2048 lds
  v_mfma_f32_32x32x16_bf16 v[192:207], v[92:95], v[96:99], v[192:207]
  buffer_load_dwordx4 v11, s[44:47], s10 offen offset:3072 lds
  s_add_u32 s10, s10, 128
  s_and_b32 s10, s10, 0x7ff
  s_waitcnt vmcnt(16) lgkmcnt(0)
  s_barrier
  v_mfma_f32_32x32x16_bf16 v[72:87], v[112:115], v[136:139], v[72:87]
  ds_read_b128 v[88:91], v16 offset:32768
  ds_read_b128 v[96:99], v20 offset:32768
  v_mfma_f32_32x32x16_bf16 v[176:191], v[112:115], v[148:151], v[176:191]
  ds_read_b128 v[92:95], v16 offset:36864
  ds_read_b128 v[108:111], v20 offset:36864
  v_mfma_f32_32x32x16_bf16 v[208:223], v[132:135], v[148:151], v[208:223]
  s_add_u32 m0, s17, 16384
  s_nop 0
  buffer_load_dwordx4 v12, s[56:59], s10 offen offset:0 lds
  v_mfma_f32_32x32x16_bf16 v[192:207], v[132:135], v[136:139], v[192:207]
  buffer_load_dwordx4 v13, s[56:59], s10 offen offset:1024 lds
  s_waitcnt lgkmcnt(2)
  v_mfma_f32_32x32x16_bf16 v[72:87], v[88:91], v[96:99], v[72:87]
  ds_read_b128 v[112:115], v17 offset:32768
  ds_read_b128 v[136:139], v21 offset:32768
  s_waitcnt lgkmcnt(2)
  v_mfma_f32_32x32x16_bf16 v[176:191], v[88:91], v[108:111], v[176:191]
  ds_read_b128 v[132:135], v17 offset:36864
  ds_read_b128 v[148:151], v21 offset:36864
  v_mfma_f32_32x32x16_bf16 v[208:223], v[92:95], v[108:111], v[208:223]
  buffer_load_dwordx4 v14, s[56:59], s10 offen offset:2048 lds
  v_mfma_f32_32x32x16_bf16 v[192:207], v[92:95], v[96:99], v[192:207]
  buffer_load_dwordx4 v15, s[56:59], s10 offen offset:3072 lds
  s_waitcnt lgkmcnt(2)
  v_mfma_f32_32x32x16_bf16 v[72:87], v[112:115], v[136:139], v[72:87]
  ds_read_b128 v[88:91], v18 offset:32768
  ds_read_b128 v[96:99], v22 offset:32768
  s_waitcnt lgkmcnt(2)
  v_mfma_f32_32x32x16_bf16 v[176:191], v[112:115], v[148:151], v[176:191]
  ds_read_b128 v[92:95], v18 offset:36864
  ds_read_b128 v[108:111], v22 offset:36864
  v_mfma_f32_32x32x16_bf16 v[208:223], v[132:135], v[148:151], v[208:223]
  s_add_u32 m0, s16, 16384
  s_nop 0
  buffer_load_dwordx4 v8, s[44:47], s10 offen offset:0 lds
  v_mfma_f32_32x32x16_bf16 v[192:207], v[132:135], v[136:139], v[192:207]
  buffer_load_dwordx4 v9, s[44:47], s10 offen offset:1024 lds
  s_waitcnt lgkmcnt(2)
  v_mfma_f32_32x32x16_bf16 v[72:87], v[88:91], v[96:99], v[72:87]
  ds_read_b128 v[112:115], v19 offset:32768
  ds_read_b128 v[136:139], v23 offset:32768
  s_waitcnt lgkmcnt(2)
  v_mfma_f32_32x32x16_bf16 v[176:191], v[88:91], v[108:111], v[176:191]
  ds_read_b128 v[132:135], v19 offset:36864
  ds_read_b128 v[148:151], v23 offset:36864
  v_mfma_f32_32x32x16_bf16 v[208:223], v[92:95], v[108:111], v[208:223]
  buffer_load_dwordx4 v10, s[44:47], s10 offen offset:2048 lds
  v_mfma_f32_32x32x16_bf16 v[192:207], v[92:95], v[96:99], v[192:207]
  buffer_load_dwordx4 v11, s[44:47], s10 offen offset:3072 lds
  s_add_u32 s10, s10, 128
  s_and_b32 s10, s10, 0x7ff
  s_waitcnt vmcnt(16) lgkmcnt(0)
  s_barrier
  v_mfma_f32_32x32x16_bf16 v[72:87], v[112:115], v[136:139], v[72:87]
  ds_read_b128 v[88:91], v16 offset:49152
  ds_read_b128 v[96:99], v20 offset:49152
  v_mfma_f32_32x32x16_bf16 v[176:191], v[112:115], v[148:151], v[176:191]
  ds_read_b128 v[92:95], v16 offset:53248
  ds_read_b128 v[108:111], v20 offset:53248
  v_mfma_f32_32x32x16_bf16 v[208:223], v[132:135], v[148:151], v[208:223]
  s_add_u32 m0, s17, 32768
  s_nop 0
  buffer_load_dwordx4 v12, s[56:59], s10 offen offset:0 lds
  v_mfma_f32_32x32x16_bf16 v[192:207], v[132:135], v[136:139], v[192:207]
  buffer_load_dwordx4 v13, s[56:59], s10 offen offset:1024 lds
  s_waitcnt lgkmcnt(2)
  v_mfma_f32_32x32x16_bf16 v[72:87], v[88:91], v[96:99], v[72:87]
  ds_read_b128 v[112:115], v17 offset:49152
  ds_read_b128 v[136:139], v21 offset:49152
  s_waitcnt lgkmcnt(2)
  v_mfma_f32_32x32x16_bf16 v[176:191], v[88:91], v[108:111], v[176:191]
  ds_read_b128 v[132:135], v17 offset:53248
  ds_read_b128 v[148:151], v21 offset:53248
  v_mfma_f32_32x32x16_bf16 v[208:223], v[92:95], v[108:111], v[208:223]
  buffer_load_dwordx4 v14, s[56:59], s10 offen offset:2048 lds
  v_mfma_f32_32x32x16_bf16 v[192:207], v[92:95], v[96:99], v[192:207]
  buffer_load_dwordx4 v15, s[56:59], s10 offen offset:3072 lds
  s_waitcnt lgkmcnt(2)
  v_mfma_f32_32x32x16_bf16 v[72:87], v[112:115], v[136:139], v[72:87]
  ds_read_b128 v[88:91], v18 offset:49152
  ds_read_b128 v[96:99], v22 offset:49152
  s_waitcnt lgkmcnt(2)
  v_mfma_f32_32x32x16_bf16 v[176:191], v[112:115], v[148:151], v[176:191]
  ds_read_b128 v[92:95], v18 offset:53248
  ds_read_b128 v[108:111], v22 offset:53248
  v_mfma_f32_32x32x16_bf16 v[208:223], v[132:135], v[148:151], v[208:223]
  s_add_u32 m0, s16, 32768
  s_nop 0
  buffer_load_dwordx4 v8, s[44:47], s10 offen offset:0 lds
  v_mfma_f32_32x32x16_bf16 v[192:207], v[132:135], v[136:139], v[192:207]
  buffer_load_dwordx4 v9, s[44:47], s10 offen offset:1024 lds
  s_waitcnt lgkmcnt(2)
  v_mfma_f32_32x32x16_bf16 v[72:87], v[88:91], v[96:99], v[72:87]
  ds_read_b128 v[112:115], v19 offset:49152
  ds_read_b128 v[136:139], v23 offset:49152
  s_waitcnt lgkmcnt(2)
  v_mfma_f32_32x32x16_bf16 v[176:191], v[88:91], v[108:111], v[176:191]
  ds_read_b128 v[132:135], v19 offset:53248
  ds_read_b128 v[148:151], v23 offset:53248
  v_mfma_f32_32x32x16_bf16 v[208:223], v[92:95], v[108:111], v[208:223]
  buffer_load_dwordx4 v10, s[44:47], s10 offen offset:2048 lds
  v_mfma_f32_32x32x16_bf16 v[192:207], v[92:95], v[96:99], v[192:207]
  buffer_load_dwordx4 v11, s[44:47], s10 offen offset:3072 lds
  s_add_u32 s10, s10, 128
  s_and_b32 s10, s10, 0x7ff
  s_waitcnt vmcnt(16) lgkmcnt(0)
  s_barrier
  v_mfma_f32_32x32x16_bf16 v[72:87], v[112:115], v[136:139], v[72:87]
  ds_read_b128 v[88:91], v16 offset:0
  ds_read_b128 v[96:99], v20 offset:0
  v_mfma_f32_32x32x16_bf16 v[176:191], v[112:115], v[148:151], v[176:191]
  ds_read_b128 v[92:95], v16 offset:4096
  ds_read_b128 v[108:111], v20 offset:4096
  s_cmp_lg_u32 s3, 2
  s_cbranch_scc1 gated_mix__spectral_gfnet__ssm_conv_s5__prompt_kernel_skip15
  s_getpc_b64 s[86:87]
gated_mix__spectral_gfnet__ssm_conv_s5__prompt_kernel_pc14:
  s_lshr_b32 s88, s2, 3
  s_mul_i32 s88, s88, 512
  v_min_u32 v154, 3, v4
  v_lshl_add_u32 v154, v154, 7, s88
  v_min_u32 v154, gated_mix__spectral_gfnet__ssm_conv_s5__prompt_kernel_end-gated_mix__spectral_gfnet__ssm_conv_s5__prompt_kernel_pc14, v154
  v_mov_b32 v155, 0
  v_lshl_add_u64 v[154:155], v[154:155], 0, s[86:87]
  global_load_dword v1, v[154:155], off
gated_mix__spectral_gfnet__ssm_conv_s5__prompt_kernel_skip15:
  v_mfma_f32_32x32x16_bf16 v[208:223], v[132:135], v[148:151], v[208:223]
  s_add_u32 m0, s17, 49152
  s_nop 0
  buffer_load_dwordx4 v12, s[56:59], s10 offen offset:0 lds
  v_mfma_f32_32x32x16_bf16 v[192:207], v[132:135], v[136:139], v[192:207]
  buffer_load_dwordx4 v13, s[56:59], s10 offen offset:1024 lds
  s_waitcnt lgkmcnt(2)
  v_mfma_f32_32x32x16_bf16 v[72:87], v[88:91], v[96:99], v[72:87]
  ds_read_b128 v[112:115], v17 offset:0
  ds_read_b128 v[136:139], v21 offset:0
  s_waitcnt lgkmcnt(2)
  v_mfma_f32_32x32x16_bf16 v[176:191], v[88:91], v[108:111], v[176:191]
  ds_read_b128 v[132:135], v17 offset:4096
  ds_read_b128 v[148:151], v21 offset:4096
  v_mfma_f32_32x32x16_bf16 v[208:223], v[92:95], v[108:111], v[208:223]
  buffer_load_dwordx4 v14, s[56:59], s10 offen offset:2048 lds
  v_mfma_f32_32x32x16_bf16 v[192:207], v[92:95], v[96:99], v[192:207]
  buffer_load_dwordx4 v15, s[56:59], s10 offen offset:3072 lds
  s_waitcnt lgkmcnt(2)
  v_mfma_f32_32x32x16_bf16 v[72:87], v[112:115], v[136:139], v[72:87]
  ds_read_b128 v[88:91], v18 offset:0
  ds_read_b128 v[96:99], v22 offset:0
  s_waitcnt lgkmcnt(2)
  v_mfma_f32_32x32x16_bf16 v[176:191], v[112:115], v[148:151], v[176:191]
  ds_read_b128 v[92:95], v18 offset:4096
  ds_read_b128 v[108:111], v22 offset:4096
  v_mfma_f32_32x32x16_bf16 v[208:223], v[132:135], v[148:151], v[208:223]
  s_add_u32 m0, s16, 49152
  s_nop 0
  buffer_load_dwordx4 v8, s[44:47], s10 offen offset:0 lds
  v_mfma_f32_32x32x16_bf16 v[192:207], v[132:135], v[136:139], v[192:207]
  buffer_load_dwordx4 v9, s[44:47], s10 offen offset:1024 lds
  s_waitcnt lgkmcnt(2)
  v_mfma_f32_32x32x16_bf16 v[72:87], v[88:91], v[96:99], v[72:87]
  ds_read_b128 v[112:115], v19 offset:0
  ds_read_b128 v[136:139], v23 offset:0
  s_waitcnt lgkmcnt(2)
  v_mfma_f32_32x32x16_bf16 v[176:191], v[88:91], v[108:111], v[176:191]
  ds_read_b128 v[132:135], v19 offset:4096
  ds_read_b128 v[148:151], v23 offset:4096
  v_mfma_f32_32x32x16_bf16 v[208:223], v[92:95], v[108:111], v[208:223]
  buffer_load_dwordx4 v10, s[44:47], s10 offen offset:2048 lds
  v_mfma_f32_32x32x16_bf16 v[192:207], v[92:95], v[96:99], v[192:207]
  buffer_load_dwordx4 v11, s[44:47], s10 offen offset:3072 lds
  s_add_u32 s10, s10, 128
  s_and_b32 s10, s10, 0x7ff
  s_waitcnt vmcnt(16) lgkmcnt(0)
  s_barrier
  v_mfma_f32_32x32x16_bf16 v[72:87], v[112:115], v[136:139], v[72:87]
  ds_read_b128 v[88:91], v16 offset:16384
  ds_read_b128 v[96:99], v20 offset:16384
  v_mfma_f32_32x32x16_bf16 v[176:191], v[112:115], v[148:151], v[176:191]
  ds_read_b128 v[92:95], v16 offset:20480
  ds_read_b128 v[108:111], v20 offset:20480
  v_mfma_f32_32x32x16_bf16 v[208:223], v[132:135], v[148:151], v[208:223]
  buffer_load_dword v157, v3, s[48:51], 0 offen sc1
  v_mov_b32 v154, 2130706432
  v_writelane_b32 v154, s76, 0
  v_writelane_b32 v154, s77, 1
  v_writelane_b32 v154, s78, 2
  v_writelane_b32 v154, s79, 3
  v_writelane_b32 v154, s80, 4
  v_writelane_b32 v154, s81, 5
  v_writelane_b32 v154, s82, 6
  v_writelane_b32 v154, s83, 7
  v_and_b32 v154, -16, v154
  s_mov_b64 exec, 255
  buffer_load_dwordx4 v[160:163], v154, s[20:23], 0 offen offset:1024
  buffer_load_dwordx4 v[164:167], v154, s[72:75], 0 offen offset:1024
  s_mov_b64 exec, -1
  v_mfma_f32_32x32x16_bf16 v[192:207], v[132:135], v[136:139], v[192:207]
  s_and_b32 s28, s76, -16
  s_add_u32 m0, s9, 131072
  s_nop 0
  buffer_load_dwordx4 v43, s[20:23], s28 offen lds
  s_waitcnt lgkmcnt(2)
  v_mfma_f32_32x32x16_bf16 v[72:87], v[88:91], v[96:99], v[72:87]
  ds_read_b128 v[112:115], v17 offset:16384
  ds_read_b128 v[136:139], v21 offset:16384
  s_waitcnt lgkmcnt(2)
  v_mfma_f32_32x32x16_bf16 v[176:191], v[88:91], v[108:111], v[176:191]
  ds_read_b128 v[132:135], v17 offset:20480
  ds_read_b128 v[148:151], v21 offset:20480
  v_mfma_f32_32x32x16_bf16 v[208:223], v[92:95], v[108:111], v[208:223]
  s_add_u32 m0, s9, 132096
  s_nop 0
  buffer_load_dwordx4 v43, s[72:75], s28 offen lds
  v_mfma_f32_32x32x16_bf16 v[192:207], v[92:95], v[96:99], v[192:207]
  s_and_b32 s28, s77, -16
  s_add_u32 m0, s9, 133120
  s_nop 0
  buffer_load_dwordx4 v43, s[20:23], s28 offen lds
  s_waitcnt lgkmcnt(2)
  v_mfma_f32_32x32x16_bf16 v[72:87], v[112:115], v[136:139], v[72:87]
  ds_read_b128 v[88:91], v18 offset:16384
  ds_read_b128 v[96:99], v22 offset:16384
  s_waitcnt lgkmcnt(2)
  v_mfma_f32_32x32x16_bf16 v[176:191], v[112:115], v[148:151], v[176:191]
  ds_read_b128 v[92:95], v18 offset:20480
  ds_read_b128 v[108:111], v22 offset:20480
  v_mfma_f32_32x32x16_bf16 v[208:223], v[132:135], v[148:151], v[208:223]
  s_add_u32 m0, s9, 134144
  s_nop 0
  buffer_load_dwordx4 v43, s[72:75], s28 offen lds
  v_mfma_f32_32x32x16_bf16 v[192:207], v[132:135], v[136:139], v[192:207]
  s_and_b32 s28, s78, -16
  s_add_u32 m0, s9, 0
  s_nop 0
  buffer_load_dwordx4 v43, s[20:23], s28 offen lds
  s_waitcnt lgkmcnt(2)
  v_mfma_f32_32x32x16_bf16 v[72:87], v[88:91], v[96:99], v[72:87]
  ds_read_b128 v[112:115], v19 offset:16384
  ds_read_b128 v[136:139], v23 offset:16384
  s_waitcnt lgkmcnt(2)
  v_mfma_f32_32x32x16_bf16 v[176:191], v[88:91], v[108:111], v[176:191]
  ds_read_b128 v[132:135], v19 offset:20480
  ds_read_b128 v[148:151], v23 offset:20480
  v_mfma_f32_32x32x16_bf16 v[208:223], v[92:95], v[108:111], v[208:223]
  s_add_u32 m0, s9, 1024
  s_nop 0
  buffer_load_dwordx4 v43, s[72:75], s28 offen lds
  v_mfma_f32_32x32x16_bf16 v[192:207], v[92:95], v[96:99], v[192:207]
  s_and_b32 s28, s79, -16
  s_add_u32 m0, s9, 2048
  s_nop 0
  buffer_load_dwordx4 v43, s[20:23], s28 offen lds
  s_waitcnt vmcnt(18) lgkmcnt(0)
  s_barrier
  v_mfma_f32_32x32x16_bf16 v[72:87], v[112:115], v[136:139], v[72:87]
  ds_read_b128 v[88:91], v16 offset:32768
  ds_read_b128 v[96:99], v20 offset:32768
  v_mfma_f32_32x32x16_bf16 v[176:191], v[112:115], v[148:151], v[176:191]
  ds_read_b128 v[92:95], v16 offset:36864
  ds_read_b128 v[108:111], v20 offset:36864
  v_mfma_f32_32x32x16_bf16 v[208:223], v[132:135], v[148:151], v[208:223]
  s_add_u32 m0, s9, 3072
  s_nop 0
  buffer_load_dwordx4 v43, s[72:75], s28 offen lds
  v_mfma_f32_32x32x16_bf16 v[192:207], v[132:135], v[136:139], v[192:207]
  s_and_b32 s28, s80, -16
  s_add_u32 m0, s9, 65536
  s_nop 0
  buffer_load_dwordx4 v43, s[20:23], s28 offen lds
  s_waitcnt lgkmcnt(2)
  v_mfma_f32_32x32x16_bf16 v[72:87], v[88:91], v[96:99], v[72:87]
  ds_read_b128 v[112:115], v17 offset:32768
  ds_read_b128 v[136:139], v21 offset:32768
  s_waitcnt lgkmcnt(2)
  v_mfma_f32_32x32x16_bf16 v[176:191], v[88:91], v[108:111], v[176:191]
  ds_read_b128 v[132:135], v17 offset:36864
  ds_read_b128 v[148:151], v21 offset:36864
  v_mfma_f32_32x32x16_bf16 v[208:223], v[92:95], v[108:111], v[208:223]
  s_add_u32 m0, s9, 66560
  s_nop 0
  buffer_load_dwordx4 v43, s[72:75], s28 offen lds
  v_mfma_f32_32x32x16_bf16 v[192:207], v[92:95], v[96:99], v[192:207]
  s_and_b32 s28, s81, -16
  s_add_u32 m0, s9, 67584
  s_nop 0
  buffer_load_dwordx4 v43, s[20:23], s28 offen lds
  s_waitcnt lgkmcnt(2)
  v_mfma_f32_32x32x16_bf16 v[72:87], v[112:115], v[136:139], v[72:87]
  ds_read_b128 v[88:91], v18 offset:32768
  ds_read_b128 v[96:99], v22 offset:32768
  s_waitcnt lgkmcnt(2)
  v_mfma_f32_32x32x16_bf16 v[176:191], v[112:115], v[148:151], v[176:191]
  ds_read_b128 v[92:95], v18 offset:36864
  ds_read_b128 v[108:111], v22 offset:36864
  v_mfma_f32_32x32x16_bf16 v[208:223], v[132:135], v[148:151], v[208:223]
  s_add_u32 m0, s9, 68608
  s_nop 0
  buffer_load_dwordx4 v43, s[72:75], s28 offen lds
  v_mfma_f32_32x32x16_bf16 v[192:207], v[132:135], v[136:139], v[192:207]
  s_and_b32 s28, s82, -16
  s_add_u32 m0, s9, 16384
  s_nop 0
  buffer_load_dwordx4 v43, s[20:23], s28 offen lds
  s_waitcnt lgkmcnt(2)
  v_mfma_f32_32x32x16_bf16 v[72:87], v[88:91], v[96:99], v[72:87]
  ds_read_b128 v[112:115], v19 offset:32768
  ds_read_b128 v[136:139], v23 offset:32768
  s_waitcnt lgkmcnt(2)
  v_mfma_f32_32x32x16_bf16 v[176:191], v[88:91], v[108:111], v[176:191]
  ds_read_b128 v[132:135], v19 offset:36864
  ds_read_b128 v[148:151], v23 offset:36864
  v_mfma_f32_32x32x16_bf16 v[208:223], v[92:95], v[108:111], v[208:223]
  s_add_u32 m0, s9, 17408
  s_nop 0
  buffer_load_dwordx4 v43, s[72:75], s28 offen lds
  v_mfma_f32_32x32x16_bf16 v[192:207], v[92:95], v[96:99], v[192:207]
  s_and_b32 s28, s83, -16
  s_add_u32 m0, s9, 18432
  s_nop 0
  buffer_load_dwordx4 v43, s[20:23], s28 offen lds
  s_waitcnt vmcnt(18) lgkmcnt(0)
  s_barrier
  v_mfma_f32_32x32x16_bf16 v[72:87], v[112:115], v[136:139], v[72:87]
  ds_read_b128 v[88:91], v16 offset:49152
  ds_read_b128 v[96:99], v20 offset:49152
  v_mfma_f32_32x32x16_bf16 v[176:191], v[112:115], v[148:151], v[176:191]
  ds_read_b128 v[92:95], v16 offset:53248
  ds_read_b128 v[108:111], v20 offset:53248
  v_mfma_f32_32x32x16_bf16 v[208:223], v[132:135], v[148:151], v[208:223]
  s_add_u32 m0, s9, 19456
  s_nop 0
  buffer_load_dwordx4 v43, s[72:75], s28 offen lds
  v_mfma_f32_32x32x16_bf16 v[192:207], v[132:135], v[136:139], v[192:207]
  s_add_u32 m0, s8, 81920
  s_nop 0
  buffer_load_dwordx4 v48, s[68:71], s7 offen offset:0 lds
  s_waitcnt lgkmcnt(2)
  v_mfma_f32_32x32x16_bf16 v[72:87], v[88:91], v[96:99], v[72:87]
  ds_read_b128 v[112:115], v17 offset:49152
  ds_read_b128 v[136:139], v21 offset:49152
  s_waitcnt lgkmcnt(2)
  v_mfma_f32_32x32x16_bf16 v[176:191], v[88:91], v[108:111], v[176:191]
  ds_read_b128 v[132:135], v17 offset:53248
  ds_read_b128 v[148:151], v21 offset:53248
  v_mfma_f32_32x32x16_bf16 v[208:223], v[92:95], v[108:111], v[208:223]
  buffer_load_dwordx4 v49, s[68:71], s7 offen offset:1024 lds
  v_mfma_f32_32x32x16_bf16 v[192:207], v[92:95], v[96:99], v[192:207]
  buffer_load_dwordx4 v50, s[68:71], s7 offen offset:2048 lds
  s_waitcnt lgkmcnt(2)
  v_mfma_f32_32x32x16_bf16 v[72:87], v[112:115], v[136:139], v[72:87]
  ds_read_b128 v[88:91], v18 offset:49152
  ds_read_b128 v[96:99], v22 offset:49152
  s_waitcnt lgkmcnt(2)
  v_mfma_f32_32x32x16_bf16 v[176:191], v[112:115], v[148:151], v[176:191]
  ds_read_b128 v[92:95], v18 offset:53248
  ds_read_b128 v[108:111], v22 offset:53248
  v_mfma_f32_32x32x16_bf16 v[208:223], v[132:135], v[148:151], v[208:223]
  buffer_load_dwordx4 v51, s[68:71], s7 offen offset:3072 lds
  s_add_u32 s7, s7, 128
  s_and_b32 s7, s7, 0x7ff
  v_mfma_f32_32x32x16_bf16 v[192:207], v[132:135], v[136:139], v[192:207]
  s_add_u32 m0, s8, 32768
  s_nop 0
  buffer_load_dwordx4 v48, s[68:71], s7 offen offset:0 lds
  s_waitcnt lgkmcnt(2)
  v_mfma_f32_32x32x16_bf16 v[72:87], v[88:91], v[96:99], v[72:87]
  ds_read_b128 v[112:115], v19 offset:49152
  ds_read_b128 v[136:139], v23 offset:49152
  s_waitcnt lgkmcnt(2)
  v_mfma_f32_32x32x16_bf16 v[176:191], v[88:91], v[108:111], v[176:191]
  ds_read_b128 v[132:135], v19 offset:53248
  ds_read_b128 v[148:151], v23 offset:53248
  v_mfma_f32_32x32x16_bf16 v[208:223], v[92:95], v[108:111], v[208:223]
  buffer_load_dwordx4 v49, s[68:71], s7 offen offset:1024 lds
  v_mfma_f32_32x32x16_bf16 v[192:207], v[92:95], v[96:99], v[192:207]
  buffer_load_dwordx4 v50, s[68:71], s7 offen offset:2048 lds
  s_waitcnt lgkmcnt(2)
  v_mfma_f32_32x32x16_bf16 v[72:87], v[112:115], v[136:139], v[72:87]
  s_waitcnt lgkmcnt(0)
  v_mfma_f32_32x32x16_bf16 v[176:191], v[112:115], v[148:151], v[176:191]
  v_mfma_f32_32x32x16_bf16 v[208:223], v[132:135], v[148:151], v[208:223]
  buffer_load_dwordx4 v51, s[68:71], s7 offen offset:3072 lds
  s_add_u32 s7, s7, 128
  s_and_b32 s7, s7, 0x7ff
  v_mfma_f32_32x32x16_bf16 v[192:207], v[132:135], v[136:139], v[192:207]
  s_add_u32 m0, s8, 98304
  s_nop 0
  buffer_load_dwordx4 v48, s[68:71], s7 offen offset:0 lds
  buffer_load_dwordx4 v49, s[68:71], s7 offen offset:1024 lds
  s_nop 0
  v_pk_fma_f32 v[8:9], v[28:29], v[72:73], v[74:75] op_sel:[0,0,0] op_sel_hi:[0,1,1]
  s_nop 0
  v_pk_fma_f32 v[10:11], v[28:29], v[176:177], v[178:179] op_sel:[0,0,0] op_sel_hi:[0,1,1]
  v_pk_fma_f32 v[8:9], v[28:29], v[176:177], v[8:9] op_sel:[1,0,0] op_sel_hi:[1,1,1] neg_lo:[1,0,0] neg_hi:[1,0,0]
  v_pk_fma_f32 v[10:11], v[28:29], v[72:73], v[10:11] op_sel:[1,0,0] op_sel_hi:[1,1,1]
  v_pk_fma_f32 v[12:13], v[28:29], v[8:9], v[76:77] op_sel:[0,0,0] op_sel_hi:[0,1,1]
  v_pk_fma_f32 v[14:15], v[28:29], v[10:11], v[180:181] op_sel:[0,0,0] op_sel_hi:[0,1,1]
  v_pk_fma_f32 v[12:13], v[28:29], v[10:11], v[12:13] op_sel:[1,0,0] op_sel_hi:[1,1,1] neg_lo:[1,0,0] neg_hi:[1,0,0]
  v_pk_fma_f32 v[14:15], v[28:29], v[8:9], v[14:15] op_sel:[1,0,0] op_sel_hi:[1,1,1]
  v_pk_fma_f32 v[8:9], v[28:29], v[12:13], v[78:79] op_sel:[0,0,0] op_sel_hi:[0,1,1]
  v_pk_fma_f32 v[10:11], v[28:29], v[14:15], v[182:183] op_sel:[0,0,0] op_sel_hi:[0,1,1]
  v_pk_fma_f32 v[8:9], v[28:29], v[14:15], v[8:9] op_sel:[1,0,0] op_sel_hi:[1,1,1] neg_lo:[1,0,0] neg_hi:[1,0,0]
  v_pk_fma_f32 v[10:11], v[28:29], v[12:13], v[10:11] op_sel:[1,0,0] op_sel_hi:[1,1,1]
  v_pk_fma_f32 v[12:13], v[28:29], v[8:9], v[80:81] op_sel:[0,0,0] op_sel_hi:[0,1,1]
  v_pk_fma_f32 v[14:15], v[28:29], v[10:11], v[184:185] op_sel:[0,0,0] op_sel_hi:[0,1,1]
  v_pk_fma_f32 v[12:13], v[28:29], v[10:11], v[12:13] op_sel:[1,0,0] op_sel_hi:[1,1,1] neg_lo:[1,0,0] neg_hi:[1,0,0]
  v_pk_fma_f32 v[14:15], v[28:29], v[8:9], v[14:15] op_sel:[1,0,0] op_sel_hi:[1,1,1]
  buffer_load_dwordx4 v50, s[68:71], s7 offen offset:2048 lds
  v_pk_fma_f32 v[8:9], v[28:29], v[12:13], v[82:83] op_sel:[0,0,0] op_sel_hi:[0,1,1]
  v_pk_fma_f32 v[10:11], v[28:29], v[14:15], v[186:187] op_sel:[0,0,0] op_sel_hi:[0,1,1]
  v_pk_fma_f32 v[8:9], v[28:29], v[14:15], v[8:9] op_sel:[1,0,0] op_sel_hi:[1,1,1] neg_lo:[1,0,0] neg_hi:[1,0,0]
  v_pk_fma_f32 v[10:11], v[28:29], v[12:13], v[10:11] op_sel:[1,0,0] op_sel_hi:[1,1,1]
  v_pk_fma_f32 v[12:13], v[28:29], v[8:9], v[84:85] op_sel:[0,0,0] op_sel_hi:[0,1,1]
  v_pk_fma_f32 v[14:15], v[28:29], v[10:11], v[188:189] op_sel:[0,0,0] op_sel_hi:[0,1,1]
  v_pk_fma_f32 v[12:13], v[28:29], v[10:11], v[12:13] op_sel:[1,0,0] op_sel_hi:[1,1,1] neg_lo:[1,0,0] neg_hi:[1,0,0]
  v_pk_fma_f32 v[14:15], v[28:29], v[8:9], v[14:15] op_sel:[1,0,0] op_sel_hi:[1,1,1]
  v_pk_fma_f32 v[8:9], v[28:29], v[12:13], v[86:87] op_sel:[0,0,0] op_sel_hi:[0,1,1]
  v_pk_fma_f32 v[10:11], v[28:29], v[14:15], v[190:191] op_sel:[0,0,0] op_sel_hi:[0,1,1]
  v_pk_fma_f32 v[8:9], v[28:29], v[14:15], v[8:9] op_sel:[1,0,0] op_sel_hi:[1,1,1] neg_lo:[1,0,0] neg_hi:[1,0,0]
  v_pk_fma_f32 v[10:11], v[28:29], v[12:13], v[10:11] op_sel:[1,0,0] op_sel_hi:[1,1,1]
  v_pk_fma_f32 v[12:13], v[28:29], v[8:9], v[192:193] op_sel:[0,0,0] op_sel_hi:[0,1,1]
  v_pk_fma_f32 v[14:15], v[28:29], v[10:11], v[208:209] op_sel:[0,0,0] op_sel_hi:[0,1,1]
  v_pk_fma_f32 v[12:13], v[28:29], v[10:11], v[12:13] op_sel:[1,0,0] op_sel_hi:[1,1,1] neg_lo:[1,0,0] neg_hi:[1,0,0]
  v_pk_fma_f32 v[14:15], v[28:29], v[8:9], v[14:15] op_sel:[1,0,0] op_sel_hi:[1,1,1]
  buffer_load_dwordx4 v51, s[68:71], s7 offen offset:3072 lds
  s_add_u32 s7, s7, 128
  s_and_b32 s7, s7, 0x7ff
  v_pk_fma_f32 v[8:9], v[28:29], v[12:13], v[194:195] op_sel:[0,0,0] op_sel_hi:[0,1,1]
  v_pk_fma_f32 v[10:11], v[28:29], v[14:15], v[210:211] op_sel:[0,0,0] op_sel_hi:[0,1,1]
  v_pk_fma_f32 v[8:9], v[28:29], v[14:15], v[8:9] op_sel:[1,0,0] op_sel_hi:[1,1,1] neg_lo:[1,0,0] neg_hi:[1,0,0]
  v_pk_fma_f32 v[10:11], v[28:29], v[12:13], v[10:11] op_sel:[1,0,0] op_sel_hi:[1,1,1]
  v_pk_fma_f32 v[12:13], v[28:29], v[8:9], v[196:197] op_sel:[0,0,0] op_sel_hi:[0,1,1]
  v_pk_fma_f32 v[14:15], v[28:29], v[10:11], v[212:213] op_sel:[0,0,0] op_sel_hi:[0,1,1]
  v_pk_fma_f32 v[12:13], v[28:29], v[10:11], v[12:13] op_sel:[1,0,0] op_sel_hi:[1,1,1] neg_lo:[1,0,0] neg_hi:[1,0,0]
  v_pk_fma_f32 v[14:15], v[28:29], v[8:9], v[14:15] op_sel:[1,0,0] op_sel_hi:[1,1,1]
  v_pk_fma_f32 v[8:9], v[28:29], v[12:13], v[198:199] op_sel:[0,0,0] op_sel_hi:[0,1,1]
  v_pk_fma_f32 v[10:11], v[28:29], v[14:15], v[214:215] op_sel:[0,0,0] op_sel_hi:[0,1,1]
  v_pk_fma_f32 v[8:9], v[28:29], v[14:15], v[8:9] op_sel:[1,0,0] op_sel_hi:[1,1,1] neg_lo:[1,0,0] neg_hi:[1,0,0]
  v_pk_fma_f32 v[10:11], v[28:29], v[12:13], v[10:11] op_sel:[1,0,0] op_sel_hi:[1,1,1]
  v_pk_fma_f32 v[12:13], v[28:29], v[8:9], v[200:201] op_sel:[0,0,0] op_sel_hi:[0,1,1]
  v_pk_fma_f32 v[14:15], v[28:29], v[10:11], v[216:217] op_sel:[0,0,0] op_sel_hi:[0,1,1]
  v_pk_fma_f32 v[12:13], v[28:29], v[10:11], v[12:13] op_sel:[1,0,0] op_sel_hi:[1,1,1] neg_lo:[1,0,0] neg_hi:[1,0,0]
  v_pk_fma_f32 v[14:15], v[28:29], v[8:9], v[14:15] op_sel:[1,0,0] op_sel_hi:[1,1,1]
  v_pk_fma_f32 v[8:9], v[28:29], v[12:13], v[202:203] op_sel:[0,0,0] op_sel_hi:[0,1,1]
  v_pk_fma_f32 v[10:11], v[28:29], v[14:15], v[218:219] op_sel:[0,0,0] op_sel_hi:[0,1,1]
  v_pk_fma_f32 v[8:9], v[28:29], v[14:15], v[8:9] op_sel:[1,0,0] op_sel_hi:[1,1,1] neg_lo:[1,0,0] neg_hi:[1,0,0]
  v_pk_fma_f32 v[10:11], v[28:29], v[12:13], v[10:11] op_sel:[1,0,0] op_sel_hi:[1,1,1]
  v_pk_fma_f32 v[12:13], v[28:29], v[8:9], v[204:205] op_sel:[0,0,0] op_sel_hi:[0,1,1]
  v_pk_fma_f32 v[14:15], v[28:29], v[10:11], v[220:221] op_sel:[0,0,0] op_sel_hi:[0,1,1]
  v_pk_fma_f32 v[12:13], v[28:29], v[10:11], v[12:13] op_sel:[1,0,0] op_sel_hi:[1,1,1] neg_lo:[1,0,0] neg_hi:[1,0,0]
  v_pk_fma_f32 v[14:15], v[28:29], v[8:9], v[14:15] op_sel:[1,0,0] op_sel_hi:[1,1,1]
  v_pk_fma_f32 v[8:9], v[28:29], v[12:13], v[206:207] op_sel:[0,0,0] op_sel_hi:[0,1,1]
  v_pk_fma_f32 v[10:11], v[28:29], v[14:15], v[222:223] op_sel:[0,0,0] op_sel_hi:[0,1,1]
  v_pk_fma_f32 v[8:9], v[28:29], v[14:15], v[8:9] op_sel:[1,0,0] op_sel_hi:[1,1,1] neg_lo:[1,0,0] neg_hi:[1,0,0]
  v_pk_fma_f32 v[10:11], v[28:29], v[12:13], v[10:11] op_sel:[1,0,0] op_sel_hi:[1,1,1]
  v_fma_f32 v12, v30, v8, v9
  v_fma_f32 v13, v30, v10, v11
  v_fma_f32 v12, -v31, v10, v12
  v_fma_f32 v13, v31, v8, v13
  v_mov_b32 v14, v12
  v_mov_b32 v15, v13
  s_nop 0
  v_permlane32_swap_b32 v12, v14
  v_permlane32_swap_b32 v13, v15
  v_fma_f32 v14, v32, v12, v14
  v_fma_f32 v15, v32, v13, v15
  v_fma_f32 v14, -v33, v13, v14
  v_fma_f32 v15, v33, v12, v15
  ds_write_b64 v40, v[14:15]
  s_waitcnt vmcnt(30)
  v_cmp_ne_u32 vcc, 1, v157
  s_nop 0
  s_cbranch_vccz gated_mix__spectral_gfnet__ssm_conv_s5__prompt_kernel_skip16
  s_mov_b32 s10, 0
gated_mix__spectral_gfnet__ssm_conv_s5__prompt_kernel_poll17:
  s_sleep 2
  buffer_load_dword v157, v3, s[48:51], 0 offen sc1
  s_waitcnt vmcnt(0)
  v_cmp_ne_u32 vcc, 1, v157
  s_nop 0
  s_cbranch_vccz gated_mix__spectral_gfnet__ssm_conv_s5__prompt_kernel_pollout18
  s_add_u32 s10, s10, 1
  s_cmp_lt_u32 s10, 1048576
  s_cbranch_scc1 gated_mix__spectral_gfnet__ssm_conv_s5__prompt_kernel_poll17
gated_mix__spectral_gfnet__ssm_conv_s5__prompt_kernel_pollout18:
gated_mix__spectral_gfnet__ssm_conv_s5__prompt_kernel_skip16:
  s_waitcnt lgkmcnt(0)
  s_barrier
  v_and_b32 v40, 0xfffffdff, v40
  ds_read_b64 v[16:17], v40
  s_cmp_lt_u32 s3, 2
  s_cbranch_scc1 gated_mix__spectral_gfnet__ssm_conv_s5__prompt_kernel_skip19
  s_waitcnt lgkmcnt(0)
  v_fma_f32 v14, v34, v16, v14
  s_waitcnt lgkmcnt(0)
  v_fma_f32 v15, v34, v17, v15
  s_waitcnt lgkmcnt(0)
  v_fma_f32 v14, -v35, v17, v14
  s_waitcnt lgkmcnt(0)
  v_fma_f32 v15, v35, v16, v15
  v_min_u32 v14, -2, v14
  v_min_u32 v15, -2, v15
  s_mov_b32 exec_hi, 0
  buffer_store_dwordx2 v[14:15], v41, s[64:67], 0 offen sc1
  s_mov_b64 exec, -1
gated_mix__spectral_gfnet__ssm_conv_s5__prompt_kernel_skip19:
  v_lshrrev_b32 v2, 5, v4
  v_lshl_add_u32 v41, v2, 12, v41
  v_add_u32 v41, 512, v41
  v_and_b32 v14, 3, v5
  v_lshlrev_b32 v2, 6, v14
  v_lshrrev_b32 v14, 2, v5
  v_lshl_or_b32 v2, v14, 4, v2
  v_lshl_or_b32 v2, v6, 12, v2
  s_mul_i32 s10, s15, 16384
  s_lshl_b32 s11, s3, 8
  s_add_u32 s10, s10, s11
  buffer_load_dwordx4 v[20:23], v2, s[24:27], s10 offen offset:0 sc1
  buffer_load_dwordx4 v[88:91], v2, s[24:27], s10 offen offset:1024 sc1
  buffer_load_dwordx4 v[92:95], v2, s[24:27], s10 offen offset:2048 sc1
  buffer_load_dwordx4 v[96:99], v2, s[24:27], s10 offen offset:3072 sc1
  s_lshl_b32 s10, s3, 8
  s_add_u32 s10, s10, 147456
  v_lshl_add_u32 v2, v4, 11, s10
  s_mov_b64 exec, 255
  s_waitcnt vmcnt(33)
  ds_write_b128 v2, v[160:163]
  s_waitcnt vmcnt(32)
  ds_write_b128 v2, v[164:167] offset:1024
  s_mov_b64 exec, -1
  s_waitcnt vmcnt(16)
  s_cmp_eq_u32 s14, 0
  s_cbranch_scc1 gated_mix__spectral_gfnet__ssm_conv_s5__prompt_kernel_skip20
  v_add_u32 v2, 131072, v46
  v_and_b32 v14, 0xfffe0000, v153
  v_add3_u32 v14, v14, v47, v2
  s_cmp_eq_u32 s32, 0
  s_cbranch_scc1 gated_mix__spectral_gfnet__ssm_conv_s5__prompt_kernel_skip21
  s_mov_b32 exec_hi, 0
  v_add_u32 v2, 2048, v2
  v_add_u32 v14, 2048, v14
  s_mov_b64 exec, -1
gated_mix__spectral_gfnet__ssm_conv_s5__prompt_kernel_skip21:
  ds_read_u16_d16_hi v168, v2 offset:0
  ds_read_u16_d16_hi v172, v2 offset:1024
  ds_read_u16_d16_hi v169, v2 offset:128
  ds_read_u16_d16_hi v173, v2 offset:1152
  ds_read_u16_d16_hi v170, v2 offset:256
  ds_read_u16_d16_hi v174, v2 offset:1280
  ds_read_u16_d16_hi v171, v14 offset:0
  ds_read_u16_d16_hi v175, v14 offset:1024
gated_mix__spectral_gfnet__ssm_conv_s5__prompt_kernel_skip20:
  v_add_u32 v2, 131072, v46
  v_and_b32 v14, 0xfffe0000, v153
  v_add3_u32 v14, v14, v47, v2
  s_cmp_eq_u32 s32, 0
  s_cbranch_scc1 gated_mix__spectral_gfnet__ssm_conv_s5__prompt_kernel_skip22
  s_mov_b32 exec_lo, 0
  v_subrev_u32 v2, 2048, v2
  v_subrev_u32 v14, 2048, v14
  s_mov_b64 exec, -1
gated_mix__spectral_gfnet__ssm_conv_s5__prompt_kernel_skip22:
  ds_read_u16_d16_hi v108, v2 offset:0
  ds_read_u16_d16_hi v112, v2 offset:1024
  ds_read_u16_d16_hi v109, v2 offset:128
  ds_read_u16_d16_hi v113, v2 offset:1152
  ds_read_u16_d16_hi v110, v2 offset:256
  ds_read_u16_d16_hi v114, v2 offset:1280
  ds_read_u16_d16_hi v111, v14 offset:0
  ds_read_u16_d16_hi v115, v14 offset:1024
  v_add_u32 v2, 0, v46
  v_and_b32 v14, 0x1000, v153
  v_add3_u32 v14, v14, v47, v2
  s_waitcnt vmcnt(12)
  ds_read_b128 a[0:3], v54 offset:16384
  ds_read_b128 a[4:7], v55 offset:16384
  ds_read_b128 a[8:11], v54 offset:18432
  ds_read_b128 a[12:15], v55 offset:18432
  s_add_u32 m0, s8, 114688
  s_nop 0
  buffer_load_dwordx4 v48, s[68:71], s7 offen offset:0 lds
  ds_read_u16_d16_hi v132, v2 offset:0
  ds_read_u16_d16_hi v136, v2 offset:1024
  ds_read_u16_d16_hi v133, v2 offset:128
  ds_read_u16_d16_hi v137, v2 offset:1152
  ds_read_u16_d16_hi v134, v2 offset:256
  ds_read_u16_d16_hi v138, v2 offset:1280
  ds_read_u16_d16_hi v135, v14 offset:0
  ds_read_u16_d16_hi v139, v14 offset:1024
  v_add_u32 v2, 65536, v46
  v_and_b32 v14, 0xffff2000, v153
  v_add3_u32 v14, v14, v47, v2
  ds_read_u16_d16_hi v148, v2 offset:0
  ds_read_u16_d16_hi v156, v2 offset:1024
  ds_read_u16_d16_hi v149, v2 offset:128
  ds_read_u16_d16_hi v157, v2 offset:1152
  ds_read_u16_d16_hi v150, v2 offset:256
  ds_read_u16_d16_hi v158, v2 offset:1280
  ds_read_u16_d16_hi v151, v14 offset:0
  buffer_load_dwordx4 v49, s[68:71], s7 offen offset:1024 lds
  ds_read_u16_d16_hi v159, v14 offset:1024
  v_add_u32 v2, 16384, v46
  v_and_b32 v14, 0xfffff000, v153
  v_add3_u32 v14, v14, v47, v2
  ds_read_u16_d16_hi v160, v2 offset:0
  ds_read_u16_d16_hi v164, v2 offset:1024
  ds_read_u16_d16_hi v161, v2 offset:128
  ds_read_u16_d16_hi v165, v2 offset:1152
  ds_read_u16_d16_hi v162, v2 offset:256
  ds_read_u16_d16_hi v166, v2 offset:1280
  ds_read_u16_d16_hi v163, v14 offset:0
  ds_read_u16_d16_hi v167, v14 offset:1024
  v_pk_mul_f32 v[226:227], v[38:39], v[72:73] op_sel:[1,0] op_sel_hi:[1,1]
  v_pk_mul_f32 v[72:73], v[38:39], v[72:73] op_sel:[0,0] op_sel_hi:[0,1]
  v_pk_fma_f32 v[72:73], v[38:39], v[176:177], v[72:73] op_sel:[1,0,0] op_sel_hi:[1,1,1] neg_lo:[1,0,0] neg_hi:[1,0,0]
  v_pk_fma_f32 v[176:177], v[38:39], v[176:177], v[226:227] op_sel:[0,0,0] op_sel_hi:[0,1,1]
  v_pk_mul_f32 v[224:225], v[38:39], v[74:75] op_sel:[1,0] op_sel_hi:[1,1]
  v_pk_mul_f32 v[74:75], v[38:39], v[74:75] op_sel:[0,0] op_sel_hi:[0,1]
  buffer_load_dwordx4 v50, s[68:71], s7 offen offset:2048 lds
  v_pk_fma_f32 v[74:75], v[38:39], v[178:179], v[74:75] op_sel:[1,0,0] op_sel_hi:[1,1,1] neg_lo:[1,0,0] neg_hi:[1,0,0]
  v_pk_fma_f32 v[178:179], v[38:39], v[178:179], v[224:225] op_sel:[0,0,0] op_sel_hi:[0,1,1]
  v_pk_mul_f32 v[226:227], v[38:39], v[76:77] op_sel:[1,0] op_sel_hi:[1,1]
  v_pk_mul_f32 v[76:77], v[38:39], v[76:77] op_sel:[0,0] op_sel_hi:[0,1]
  v_pk_fma_f32 v[76:77], v[38:39], v[180:181], v[76:77] op_sel:[1,0,0] op_sel_hi:[1,1,1] neg_lo:[1,0,0] neg_hi:[1,0,0]
  v_pk_fma_f32 v[180:181], v[38:39], v[180:181], v[226:227] op_sel:[0,0,0] op_sel_hi:[0,1,1]
  v_pk_mul_f32 v[224:225], v[38:39], v[78:79] op_sel:[1,0] op_sel_hi:[1,1]
  v_pk_mul_f32 v[78:79], v[38:39], v[78:79] op_sel:[0,0] op_sel_hi:[0,1]
  v_pk_fma_f32 v[78:79], v[38:39], v[182:183], v[78:79] op_sel:[1,0,0] op_sel_hi:[1,1,1] neg_lo:[1,0,0] neg_hi:[1,0,0]
  v_pk_fma_f32 v[182:183], v[38:39], v[182:183], v[224:225] op_sel:[0,0,0] op_sel_hi:[0,1,1]
  v_pk_mul_f32 v[226:227], v[38:39], v[80:81] op_sel:[1,0] op_sel_hi:[1,1]
  v_pk_mul_f32 v[80:81], v[38:39], v[80:81] op_sel:[0,0] op_sel_hi:[0,1]
  v_pk_fma_f32 v[80:81], v[38:39], v[184:185], v[80:81] op_sel:[1,0,0] op_sel_hi:[1,1,1] neg_lo:[1,0,0] neg_hi:[1,0,0]
  v_pk_fma_f32 v[184:185], v[38:39], v[184:185], v[226:227] op_sel:[0,0,0] op_sel_hi:[0,1,1]
  v_pk_mul_f32 v[224:225], v[38:39], v[82:83] op_sel:[1,0] op_sel_hi:[1,1]
  v_pk_mul_f32 v[82:83], v[38:39], v[82:83] op_sel:[0,0] op_sel_hi:[0,1]
  v_pk_fma_f32 v[82:83], v[38:39], v[186:187], v[82:83] op_sel:[1,0,0] op_sel_hi:[1,1,1] neg_lo:[1,0,0] neg_hi:[1,0,0]
  v_pk_fma_f32 v[186:187], v[38:39], v[186:187], v[224:225] op_sel:[0,0,0] op_sel_hi:[0,1,1]
  buffer_load_dwordx4 v51, s[68:71], s7 offen offset:3072 lds
  s_add_u32 s7, s7, 128
  s_and_b32 s7, s7, 0x7ff
  v_pk_mul_f32 v[226:227], v[38:39], v[84:85] op_sel:[1,0] op_sel_hi:[1,1]
  v_pk_mul_f32 v[84:85], v[38:39], v[84:85] op_sel:[0,0] op_sel_hi:[0,1]
  v_pk_fma_f32 v[84:85], v[38:39], v[188:189], v[84:85] op_sel:[1,0,0] op_sel_hi:[1,1,1] neg_lo:[1,0,0] neg_hi:[1,0,0]
  v_pk_fma_f32 v[188:189], v[38:39], v[188:189], v[226:227] op_sel:[0,0,0] op_sel_hi:[0,1,1]
  v_pk_mul_f32 v[224:225], v[38:39], v[86:87] op_sel:[1,0] op_sel_hi:[1,1]
  v_pk_mul_f32 v[86:87], v[38:39], v[86:87] op_sel:[0,0] op_sel_hi:[0,1]
  v_pk_fma_f32 v[86:87], v[38:39], v[190:191], v[86:87] op_sel:[1,0,0] op_sel_hi:[1,1,1] neg_lo:[1,0,0] neg_hi:[1,0,0]
  v_pk_fma_f32 v[190:191], v[38:39], v[190:191], v[224:225] op_sel:[0,0,0] op_sel_hi:[0,1,1]
  v_pk_mul_f32 v[226:227], v[38:39], v[192:193] op_sel:[1,0] op_sel_hi:[1,1]
  v_pk_mul_f32 v[192:193], v[38:39], v[192:193] op_sel:[0,0] op_sel_hi:[0,1]
  v_pk_fma_f32 v[192:193], v[38:39], v[208:209], v[192:193] op_sel:[1,0,0] op_sel_hi:[1,1,1] neg_lo:[1,0,0] neg_hi:[1,0,0]
  v_pk_fma_f32 v[208:209], v[38:39], v[208:209], v[226:227] op_sel:[0,0,0] op_sel_hi:[0,1,1]
  v_pk_mul_f32 v[224:225], v[38:39], v[194:195] op_sel:[1,0] op_sel_hi:[1,1]
  v_pk_mul_f32 v[194:195], v[38:39], v[194:195] op_sel:[0,0] op_sel_hi:[0,1]
  v_pk_fma_f32 v[194:195], v[38:39], v[210:211], v[194:195] op_sel:[1,0,0] op_sel_hi:[1,1,1] neg_lo:[1,0,0] neg_hi:[1,0,0]
  v_pk_fma_f32 v[210:211], v[38:39], v[210:211], v[224:225] op_sel:[0,0,0] op_sel_hi:[0,1,1]
  v_pk_mul_f32 v[226:227], v[38:39], v[196:197] op_sel:[1,0] op_sel_hi:[1,1]
  v_pk_mul_f32 v[196:197], v[38:39], v[196:197] op_sel:[0,0] op_sel_hi:[0,1]
  s_waitcnt vmcnt(12)
  ds_read_b128 a[16:19], v52 offset:32768
  ds_read_b128 a[20:23], v53 offset:32768
  ds_read_b128 a[24:27], v52 offset:34816
  ds_read_b128 a[28:31], v53 offset:34816
  s_waitcnt lgkmcnt(15)
  s_add_u32 m0, s8, 81920
  s_nop 0
  buffer_load_dwordx4 v48, s[68:71], s7 offen offset:0 lds
  v_pk_fma_f32 v[196:197], v[38:39], v[212:213], v[196:197] op_sel:[1,0,0] op_sel_hi:[1,1,1] neg_lo:[1,0,0] neg_hi:[1,0,0]
  v_pk_fma_f32 v[212:213], v[38:39], v[212:213], v[226:227] op_sel:[0,0,0] op_sel_hi:[0,1,1]
  v_pk_mul_f32 v[224:225], v[38:39], v[198:199] op_sel:[1,0] op_sel_hi:[1,1]
  v_pk_mul_f32 v[198:199], v[38:39], v[198:199] op_sel:[0,0] op_sel_hi:[0,1]
  v_pk_fma_f32 v[198:199], v[38:39], v[214:215], v[198:199] op_sel:[1,0,0] op_sel_hi:[1,1,1] neg_lo:[1,0,0] neg_hi:[1,0,0]
  v_pk_fma_f32 v[214:215], v[38:39], v[214:215], v[224:225] op_sel:[0,0,0] op_sel_hi:[0,1,1]
  v_pk_mul_f32 v[226:227], v[38:39], v[200:201] op_sel:[1,0] op_sel_hi:[1,1]
  v_pk_mul_f32 v[200:201], v[38:39], v[200:201] op_sel:[0,0] op_sel_hi:[0,1]
  v_pk_fma_f32 v[200:201], v[38:39], v[216:217], v[200:201] op_sel:[1,0,0] op_sel_hi:[1,1,1] neg_lo:[1,0,0] neg_hi:[1,0,0]
  v_pk_fma_f32 v[216:217], v[38:39], v[216:217], v[226:227] op_sel:[0,0,0] op_sel_hi:[0,1,1]
  v_pk_mul_f32 v[224:225], v[38:39], v[202:203] op_sel:[1,0] op_sel_hi:[1,1]
  v_pk_mul_f32 v[202:203], v[38:39], v[202:203] op_sel:[0,0] op_sel_hi:[0,1]
  v_pk_fma_f32 v[202:203], v[38:39], v[218:219], v[202:203] op_sel:[1,0,0] op_sel_hi:[1,1,1] neg_lo:[1,0,0] neg_hi:[1,0,0]
  v_pk_fma_f32 v[218:219], v[38:39], v[218:219], v[224:225] op_sel:[0,0,0] op_sel_hi:[0,1,1]
  v_pk_mul_f32 v[226:227], v[38:39], v[204:205] op_sel:[1,0] op_sel_hi:[1,1]
  v_pk_mul_f32 v[204:205], v[38:39], v[204:205] op_sel:[0,0] op_sel_hi:[0,1]
  v_pk_fma_f32 v[204:205], v[38:39], v[220:221], v[204:205] op_sel:[1,0,0] op_sel_hi:[1,1,1] neg_lo:[1,0,0] neg_hi:[1,0,0]
  v_pk_fma_f32 v[220:221], v[38:39], v[220:221], v[226:227] op_sel:[0,0,0] op_sel_hi:[0,1,1]
  buffer_load_dwordx4 v49, s[68:71], s7 offen offset:1024 lds
  v_pk_mul_f32 v[224:225], v[38:39], v[206:207] op_sel:[1,0] op_sel_hi:[1,1]
  v_pk_mul_f32 v[206:207], v[38:39], v[206:207] op_sel:[0,0] op_sel_hi:[0,1]
  v_pk_fma_f32 v[206:207], v[38:39], v[222:223], v[206:207] op_sel:[1,0,0] op_sel_hi:[1,1,1] neg_lo:[1,0,0] neg_hi:[1,0,0]
  v_pk_fma_f32 v[222:223], v[38:39], v[222:223], v[224:225] op_sel:[0,0,0] op_sel_hi:[0,1,1]
  s_waitcnt lgkmcnt(4)
  s_cmp_lg_u32 s12, 0
  s_cbranch_scc1 gated_mix__spectral_gfnet__ssm_conv_s5__prompt_kernel_skip23
  s_add_u32 s11, s33, s9
  s_add_u32 s11, s11, 131072
  s_lshl_b32 s10, s3, 8
  s_add_u32 s10, s10, s29
  s_add_u32 s10, s10, 147456
  s_lshl_b32 vcc_lo, s32, 11
  s_sub_u32 s11, s11, vcc_lo
  v_mov_b32 v228, s11
  v_mov_b32 v229, s10
  v_cndmask_b32 v228, v228, v229, s[36:37]
  ds_read_u16_d16_hi v14, v228
  ds_read_u16_d16_hi v15, v228 offset:1024
  s_add_u32 s11, s33, s9
  s_add_u32 s11, s11, 0
  s_lshl_b32 s10, s3, 8
  s_add_u32 s10, s10, s29
  s_add_u32 s10, s10, 151552
  v_mov_b32 v228, s11
  v_mov_b32 v229, s10
  v_cndmask_b32 v228, v228, v229, s[36:37]
  ds_read_u16_d16_hi v18, v228
  ds_read_u16_d16_hi v19, v228 offset:1024
  s_add_u32 s11, s33, s9
  s_add_u32 s11, s11, 65536
  s_lshl_b32 s10, s3, 8
  s_add_u32 s10, s10, s29
  s_add_u32 s10, s10, 155648
  v_mov_b32 v228, s11
  v_mov_b32 v229, s10
  v_cndmask_b32 v228, v228, v229, s[36:37]
  ds_read_u16_d16_hi v154, v228
  ds_read_u16_d16_hi v155, v228 offset:1024
  s_add_u32 s11, s33, s9
  s_add_u32 s11, s11, 16384
  s_lshl_b32 s10, s3, 8
  s_add_u32 s10, s10, s29
  s_add_u32 s10, s10, 159744
  v_mov_b32 v228, s11
  v_mov_b32 v229, s10
  v_cndmask_b32 v228, v228, v229, s[36:37]
  ds_read_u16_d16_hi v224, v228
  ds_read_u16_d16_hi v225, v228 offset:1024
  s_add_u32 s11, s33, s9
  s_add_u32 s11, s11, 131072
  s_lshl_b32 s10, s3, 8
  s_add_u32 s10, s10, s29
  s_add_u32 s10, s10, 147456
  s_lshl_b32 vcc_lo, s32, 11
  s_add_u32 s10, s10, vcc_lo
  v_mov_b32 v228, s11
  v_mov_b32 v229, s10
  v_cndmask_b32 v228, v228, v229, s[36:37]
  ds_read_u16_d16_hi v226, v228
  ds_read_u16_d16_hi v227, v228 offset:1024
  s_waitcnt lgkmcnt(0)
  s_mov_b32 exec_lo, 1
  s_mov_b32 exec_hi, 0
  v_add_f32 v108, v108, v14
  v_sub_f32 v112, v112, v15
  v_mul_f32 v108, 0.5, v108
  v_mul_f32 v112, 0.5, v112
  v_add_f32 v132, v132, v18
  v_sub_f32 v136, v136, v19
  v_mul_f32 v132, 0.5, v132
  v_mul_f32 v136, 0.5, v136
  v_add_f32 v148, v148, v154
  v_sub_f32 v156, v156, v155
  v_mul_f32 v148, 0.5, v148
  v_mul_f32 v156, 0.5, v156
  v_add_f32 v160, v160, v224
  v_sub_f32 v164, v164, v225
  v_mul_f32 v160, 0.5, v160
  v_mul_f32 v164, 0.5, v164
  v_add_f32 v168, v168, v226
  v_sub_f32 v172, v172, v227
  v_mul_f32 v168, 0.5, v168
  v_mul_f32 v172, 0.5, v172
  s_mov_b32 exec_lo, 0
  s_mov_b32 exec_hi, 1
  v_add_f32 v111, v111, v14
  v_sub_f32 v115, v115, v15
  v_mul_f32 v111, 0.5, v111
  v_mul_f32 v115, 0.5, v115
  v_add_f32 v135, v135, v18
  v_sub_f32 v139, v139, v19
  v_mul_f32 v135, 0.5, v135
  v_mul_f32 v139, 0.5, v139
  v_add_f32 v151, v151, v154
  v_sub_f32 v159, v159, v155
  v_mul_f32 v151, 0.5, v151
  v_mul_f32 v159, 0.5, v159
  v_add_f32 v163, v163, v224
  v_sub_f32 v167, v167, v225
  v_mul_f32 v163, 0.5, v163
  v_mul_f32 v167, 0.5, v167
  v_add_f32 v171, v171, v226
  v_sub_f32 v175, v175, v227
  v_mul_f32 v171, 0.5, v171
  v_mul_f32 v175, 0.5, v175
  s_mov_b64 exec, -1
gated_mix__spectral_gfnet__ssm_conv_s5__prompt_kernel_skip23:
  v_pk_mul_f32 v[112:113], v[152:153], v[112:113] op_sel_hi:[0,1]
  v_pk_mul_f32 v[114:115], v[152:153], v[114:115] op_sel_hi:[0,1]
  v_pk_mul_f32 v[136:137], v[152:153], v[136:137] op_sel_hi:[0,1]
  v_pk_mul_f32 v[138:139], v[152:153], v[138:139] op_sel_hi:[0,1]
  v_pk_mul_f32 v[156:157], v[152:153], v[156:157] op_sel_hi:[0,1]
  v_pk_mul_f32 v[158:159], v[152:153], v[158:159] op_sel_hi:[0,1]
  v_pk_mul_f32 v[164:165], v[152:153], v[164:165] op_sel_hi:[0,1]
  v_pk_mul_f32 v[166:167], v[152:153], v[166:167] op_sel_hi:[0,1]
  v_pk_mul_f32 v[172:173], v[152:153], v[172:173] op_sel_hi:[0,1]
  v_pk_mul_f32 v[174:175], v[152:153], v[174:175] op_sel_hi:[0,1]
  buffer_load_dwordx4 v50, s[68:71], s7 offen offset:2048 lds
  buffer_load_dwordx4 v51, s[68:71], s7 offen offset:3072 lds
  s_add_u32 s7, s7, 128
  s_and_b32 s7, s7, 0x7ff
  buffer_load_dwordx2 v[14:15], v41, s[64:67], 0 offen offset:0 sc1
  buffer_load_dwordx2 v[18:19], v41, s[64:67], 0 offen offset:512 sc1
  buffer_load_dwordx2 v[46:47], v41, s[64:67], 0 offen offset:1024 sc1
  buffer_load_dwordx2 v[152:153], v41, s[64:67], 0 offen offset:1536 sc1
  buffer_load_dwordx2 v[154:155], v41, s[64:67], 0 offen offset:2048 sc1
  buffer_load_dwordx2 v[224:225], v41, s[64:67], 0 offen offset:2560 sc1
  buffer_load_dwordx2 v[226:227], v41, s[64:67], 0 offen offset:3072 sc1
  buffer_load_dwordx2 v[228:229], v41, s[64:67], 0 offen offset:3584 sc1
  s_waitcnt lgkmcnt(0)
  s_add_u32 m0, s8, 32768
  s_nop 0
  buffer_load_dwordx4 v48, s[68:71], s7 offen offset:0 lds
  v_and_b32 v2, 7, v5
  v_lshlrev_b32 v40, 2, v6
  v_xor_b32 v2, v2, v40
  v_lshlrev_b32 v2, 4, v2
  v_lshl_or_b32 v2, v5, 10, v2
  s_lshl_b32 s9, s3, 8
  s_add_u32 s9, s9, 49152
  v_add_u32 v2, s9, v2
  s_waitcnt vmcnt(20)
  v_mov_b32 v232, v20
  s_waitcnt vmcnt(19)
  v_mov_b32 v233, v88
  s_waitcnt vmcnt(18)
  v_mov_b32 v234, v92
  s_waitcnt vmcnt(17)
  v_mov_b32 v235, v96
  v_mov_b32 v236, v21
  v_mov_b32 v237, v89
  v_mov_b32 v238, v93
  v_mov_b32 v239, v97
  v_mfma_f32_16x16x32_bf16 v[240:243], v[232:235], v[100:103], 0
  buffer_load_dwordx4 v49, s[68:71], s7 offen offset:1024 lds
  v_mfma_f32_16x16x32_bf16 v[244:247], v[232:235], v[104:107], 0
  v_mfma_f32_16x16x32_bf16 v[248:251], v[236:239], v[100:103], 0
  v_mfma_f32_16x16x32_bf16 v[252:255], v[236:239], v[104:107], 0
  v_mov_b32 v232, v22
  v_mov_b32 v233, v90
  v_mov_b32 v234, v94
  v_mov_b32 v235, v98
  v_mov_b32 v236, v23
  v_mov_b32 v237, v91
  buffer_load_dwordx4 v50, s[68:71], s7 offen offset:2048 lds
  v_mov_b32 v238, v95
  v_mov_b32 v239, v99
  v_xor_b32 v40, 0, v2
  v_cvt_pk_bf16_f32 v96, v240, v244
  v_cvt_pk_bf16_f32 v97, v241, v245
  v_cvt_pk_bf16_f32 v98, v242, v246
  v_cvt_pk_bf16_f32 v99, v243, v247
  ds_write_b128 v40, v[96:99]
  v_mfma_f32_16x16x32_bf16 v[240:243], v[232:235], v[100:103], 0
  v_mfma_f32_16x16x32_bf16 v[244:247], v[232:235], v[104:107], 0
  v_xor_b32 v40, 16, v2
  v_cvt_pk_bf16_f32 v20, v248, v252
  buffer_load_dwordx4 v51, s[68:71], s7 offen offset:3072 lds
  s_add_u32 s7, s7, 128
  s_and_b32 s7, s7, 0x7ff
  v_cvt_pk_bf16_f32 v21, v249, v253
  v_cvt_pk_bf16_f32 v22, v250, v254
  v_cvt_pk_bf16_f32 v23, v251, v255
  ds_write_b128 v40, v[20:23]
  v_mfma_f32_16x16x32_bf16 v[248:251], v[236:239], v[100:103], 0
  v_mfma_f32_16x16x32_bf16 v[252:255], v[236:239], v[104:107], 0
  v_xor_b32 v40, 32, v2
  v_cvt_pk_bf16_f32 v88, v240, v244
  v_cvt_pk_bf16_f32 v89, v241, v245
  v_cvt_pk_bf16_f32 v90, v242, v246
  v_cvt_pk_bf16_f32 v91, v243, v247
  ds_write_b128 v40, v[88:91]
  v_xor_b32 v40, 48, v2
  s_nop 0
  v_cvt_pk_bf16_f32 v92, v248, v252
  v_cvt_pk_bf16_f32 v93, v249, v253
  v_cvt_pk_bf16_f32 v94, v250, v254
  v_cvt_pk_bf16_f32 v95, v251, v255
  ds_write_b128 v40, v[92:95]
  s_waitcnt vmcnt(4)
  v_max_u32 v2, v14, v15
  v_max3_u32 v2, v2, v18, v19
  v_max3_u32 v2, v2, v46, v47
  v_max3_u32 v2, v2, v152, v153
  v_max3_u32 v2, v2, v154, v155
  v_max3_u32 v2, v2, v224, v225
  v_max3_u32 v2, v2, v226, v227
  v_max3_u32 v2, v2, v228, v229
  v_cmp_eq_u32 vcc, -1, v2
  s_nop 0
  s_cbranch_vccz gated_mix__spectral_gfnet__ssm_conv_s5__prompt_kernel_skip24
  s_mov_b32 s9, 0
gated_mix__spectral_gfnet__ssm_conv_s5__prompt_kernel_lb25:
  buffer_load_dwordx2 v[14:15], v41, s[64:67], 0 offen offset:0 sc1
  buffer_load_dwordx2 v[18:19], v41, s[64:67], 0 offen offset:512 sc1
  buffer_load_dwordx2 v[46:47], v41, s[64:67], 0 offen offset:1024 sc1
  buffer_load_dwordx2 v[152:153], v41, s[64:67], 0 offen offset:1536 sc1
  buffer_load_dwordx2 v[154:155], v41, s[64:67], 0 offen offset:2048 sc1
  buffer_load_dwordx2 v[224:225], v41, s[64:67], 0 offen offset:2560 sc1
  buffer_load_dwordx2 v[226:227], v41, s[64:67], 0 offen offset:3072 sc1
  buffer_load_dwordx2 v[228:229], v41, s[64:67], 0 offen offset:3584 sc1
  s_waitcnt vmcnt(0)
  v_max_u32 v2, v14, v15
  v_max3_u32 v2, v2, v18, v19
  v_max3_u32 v2, v2, v46, v47
  v_max3_u32 v2, v2, v152, v153
  v_max3_u32 v2, v2, v154, v155
  v_max3_u32 v2, v2, v224, v225
  v_max3_u32 v2, v2, v226, v227
  v_max3_u32 v2, v2, v228, v229
  v_cmp_eq_u32 vcc, -1, v2
  s_nop 0
  s_cbranch_vccz gated_mix__spectral_gfnet__ssm_conv_s5__prompt_kernel_lbout26
  s_add_u32 s9, s9, 1
  s_cmp_lt_u32 s9, 1048576
  s_cbranch_scc1 gated_mix__spectral_gfnet__ssm_conv_s5__prompt_kernel_lb25
gated_mix__spectral_gfnet__ssm_conv_s5__prompt_kernel_lbout26:
gated_mix__spectral_gfnet__ssm_conv_s5__prompt_kernel_skip24:
  s_add_u32 s20, s34, 10485760
  s_addc_u32 s21, s35, 0
  s_mov_b32 s22, 8388608
  s_mov_b32 s23, 0x20000
  v_fma_f32 v226, v44, v228, v226
  v_fma_f32 v227, v44, v229, v227
  v_fma_f32 v226, -v45, v229, v226
  v_fma_f32 v227, v45, v228, v227
  v_fma_f32 v224, v44, v226, v224
  v_fma_f32 v225, v44, v227, v225
  v_fma_f32 v224, -v45, v227, v224
  v_fma_f32 v225, v45, v226, v225
  v_fma_f32 v154, v44, v224, v154
  v_fma_f32 v155, v44, v225, v155
  v_fma_f32 v154, -v45, v225, v154
  v_fma_f32 v155, v45, v224, v155
  v_fma_f32 v152, v44, v154, v152
  v_fma_f32 v153, v44, v155, v153
  v_fma_f32 v152, -v45, v155, v152
  v_fma_f32 v153, v45, v154, v153
  v_fma_f32 v46, v44, v152, v46
  v_fma_f32 v47, v44, v153, v47
  v_fma_f32 v46, -v45, v153, v46
  v_fma_f32 v47, v45, v152, v47
  v_fma_f32 v18, v44, v46, v18
  v_fma_f32 v19, v44, v47, v19
  v_fma_f32 v18, -v45, v47, v18
  v_fma_f32 v19, v45, v46, v19
  v_fma_f32 v14, v44, v18, v14
  v_fma_f32 v15, v44, v19, v15
  v_fma_f32 v14, -v45, v19, v14
  v_fma_f32 v15, v45, v18, v15
  v_mov_b32 v18, v14
  v_mov_b32 v19, v15
  s_nop 0
  v_permlane32_swap_b32 v14, v18
  v_permlane32_swap_b32 v15, v19
  v_fma_f32 v14, v36, v18, v14
  v_fma_f32 v15, v36, v19, v15
  v_fma_f32 v14, -v37, v19, v14
  v_fma_f32 v15, v37, v18, v15
  s_cmp_lt_u32 s3, 2
  s_cbranch_scc1 gated_mix__spectral_gfnet__ssm_conv_s5__prompt_kernel_skip27
  v_fma_f32 v16, v34, v14, v16
  v_fma_f32 v17, v34, v15, v17
  v_fma_f32 v16, -v35, v15, v16
  v_fma_f32 v17, v35, v14, v17
  v_mov_b32 v14, v16
  v_mov_b32 v15, v17
gated_mix__spectral_gfnet__ssm_conv_s5__prompt_kernel_skip27:
  v_fma_f32 v12, v32, v14, v12
  v_fma_f32 v13, v32, v15, v13
  v_fma_f32 v12, -v33, v15, v12
  v_fma_f32 v13, v33, v14, v13
  s_mov_b32 exec_lo, 0
  v_mov_b32 v14, v12
  v_mov_b32 v15, v13
  s_mov_b64 exec, -1
  v_fma_f32 v8, v30, v14, v8
  v_fma_f32 v10, v30, v15, v10
  v_fma_f32 v8, -v31, v15, v8
  v_fma_f32 v10, v31, v14, v10
  v_mul_f32 v46, v38, v14
  v_mul_f32 v152, v38, v15
  v_fma_f32 v46, -v39, v15, v46
  v_fma_f32 v152, v39, v14, v152
  v_mul_f32 v47, v38, v8
  v_mul_f32 v153, v38, v10
  v_fma_f32 v47, -v39, v10, v47
  v_fma_f32 v153, v39, v8, v153
  v_pk_fma_f32 v[72:73], v[28:29], v[46:47], v[72:73] op_sel:[0,0,0] op_sel_hi:[0,1,1]
  v_pk_fma_f32 v[176:177], v[28:29], v[152:153], v[176:177] op_sel:[0,0,0] op_sel_hi:[0,1,1]
  v_pk_fma_f32 v[72:73], v[28:29], v[152:153], v[72:73] op_sel:[1,0,0] op_sel_hi:[1,1,1] neg_lo:[1,0,0] neg_hi:[1,0,0]
  v_pk_fma_f32 v[176:177], v[28:29], v[46:47], v[176:177] op_sel:[1,0,0] op_sel_hi:[1,1,1]
  v_cvt_pk_bf16_f32 v20, v72, v73
  v_cvt_pk_bf16_f32 v21, -v176, -v177
  v_pk_fma_f32 v[74:75], v[28:29], v[72:73], v[74:75] op_sel:[0,0,0] op_sel_hi:[0,1,1]
  v_pk_fma_f32 v[178:179], v[28:29], v[176:177], v[178:179] op_sel:[0,0,0] op_sel_hi:[0,1,1]
  v_pk_fma_f32 v[74:75], v[28:29], v[176:177], v[74:75] op_sel:[1,0,0] op_sel_hi:[1,1,1] neg_lo:[1,0,0] neg_hi:[1,0,0]
  v_pk_fma_f32 v[178:179], v[28:29], v[72:73], v[178:179] op_sel:[1,0,0] op_sel_hi:[1,1,1]
  v_cvt_pk_bf16_f32 v22, v74, v75
  v_cvt_pk_bf16_f32 v23, -v178, -v179
  v_pk_fma_f32 v[76:77], v[28:29], v[74:75], v[76:77] op_sel:[0,0,0] op_sel_hi:[0,1,1]
  v_pk_fma_f32 v[180:181], v[28:29], v[178:179], v[180:181] op_sel:[0,0,0] op_sel_hi:[0,1,1]
  v_pk_fma_f32 v[76:77], v[28:29], v[178:179], v[76:77] op_sel:[1,0,0] op_sel_hi:[1,1,1] neg_lo:[1,0,0] neg_hi:[1,0,0]
  v_pk_fma_f32 v[180:181], v[28:29], v[74:75], v[180:181] op_sel:[1,0,0] op_sel_hi:[1,1,1]
  v_permlane32_swap_b32 v20, v21
  v_permlane32_swap_b32 v22, v23
  s_nop 1
  v_permlane16_swap_b32 v20, v22
  v_permlane16_swap_b32 v21, v23
  buffer_store_dwordx4 v[20:23], v42, s[20:23], s6 offen sc1
  s_add_u32 s6, s6, 1048576
  v_cvt_pk_bf16_f32 v88, v76, v77
  v_cvt_pk_bf16_f32 v89, -v180, -v181
  v_pk_fma_f32 v[78:79], v[28:29], v[76:77], v[78:79] op_sel:[0,0,0] op_sel_hi:[0,1,1]
  v_pk_fma_f32 v[182:183], v[28:29], v[180:181], v[182:183] op_sel:[0,0,0] op_sel_hi:[0,1,1]
  v_pk_fma_f32 v[78:79], v[28:29], v[180:181], v[78:79] op_sel:[1,0,0] op_sel_hi:[1,1,1] neg_lo:[1,0,0] neg_hi:[1,0,0]
  v_pk_fma_f32 v[182:183], v[28:29], v[76:77], v[182:183] op_sel:[1,0,0] op_sel_hi:[1,1,1]
  v_cvt_pk_bf16_f32 v90, v78, v79
  v_cvt_pk_bf16_f32 v91, -v182, -v183
  v_pk_fma_f32 v[80:81], v[28:29], v[78:79], v[80:81] op_sel:[0,0,0] op_sel_hi:[0,1,1]
  v_pk_fma_f32 v[184:185], v[28:29], v[182:183], v[184:185] op_sel:[0,0,0] op_sel_hi:[0,1,1]
  v_pk_fma_f32 v[80:81], v[28:29], v[182:183], v[80:81] op_sel:[1,0,0] op_sel_hi:[1,1,1] neg_lo:[1,0,0] neg_hi:[1,0,0]
  v_pk_fma_f32 v[184:185], v[28:29], v[78:79], v[184:185] op_sel:[1,0,0] op_sel_hi:[1,1,1]
  v_permlane32_swap_b32 v88, v89
  v_permlane32_swap_b32 v90, v91
  s_nop 1
  v_permlane16_swap_b32 v88, v90
  v_permlane16_swap_b32 v89, v91
  buffer_store_dwordx4 v[88:91], v42, s[20:23], s6 offen sc1
  s_add_u32 s6, s6, 1048576
  v_cvt_pk_bf16_f32 v92, v80, v81
  v_cvt_pk_bf16_f32 v93, -v184, -v185
  v_pk_fma_f32 v[82:83], v[28:29], v[80:81], v[82:83] op_sel:[0,0,0] op_sel_hi:[0,1,1]
  v_pk_fma_f32 v[186:187], v[28:29], v[184:185], v[186:187] op_sel:[0,0,0] op_sel_hi:[0,1,1]
  v_pk_fma_f32 v[82:83], v[28:29], v[184:185], v[82:83] op_sel:[1,0,0] op_sel_hi:[1,1,1] neg_lo:[1,0,0] neg_hi:[1,0,0]
  v_pk_fma_f32 v[186:187], v[28:29], v[80:81], v[186:187] op_sel:[1,0,0] op_sel_hi:[1,1,1]
  v_cvt_pk_bf16_f32 v94, v82, v83
  v_cvt_pk_bf16_f32 v95, -v186, -v187
  v_pk_fma_f32 v[84:85], v[28:29], v[82:83], v[84:85] op_sel:[0,0,0] op_sel_hi:[0,1,1]
  v_pk_fma_f32 v[188:189], v[28:29], v[186:187], v[188:189] op_sel:[0,0,0] op_sel_hi:[0,1,1]
  v_pk_fma_f32 v[84:85], v[28:29], v[186:187], v[84:85] op_sel:[1,0,0] op_sel_hi:[1,1,1] neg_lo:[1,0,0] neg_hi:[1,0,0]
  v_pk_fma_f32 v[188:189], v[28:29], v[82:83], v[188:189] op_sel:[1,0,0] op_sel_hi:[1,1,1]
  v_permlane32_swap_b32 v92, v93
  v_permlane32_swap_b32 v94, v95
  s_nop 1
  v_permlane16_swap_b32 v92, v94
  v_permlane16_swap_b32 v93, v95
  buffer_store_dwordx4 v[92:95], v42, s[20:23], s6 offen sc1
  s_add_u32 s6, s6, 1048576
  v_cvt_pk_bf16_f32 v20, v84, v85
  v_cvt_pk_bf16_f32 v21, -v188, -v189
  v_pk_fma_f32 v[86:87], v[28:29], v[84:85], v[86:87] op_sel:[0,0,0] op_sel_hi:[0,1,1]
  v_pk_fma_f32 v[190:191], v[28:29], v[188:189], v[190:191] op_sel:[0,0,0] op_sel_hi:[0,1,1]
  v_pk_fma_f32 v[86:87], v[28:29], v[188:189], v[86:87] op_sel:[1,0,0] op_sel_hi:[1,1,1] neg_lo:[1,0,0] neg_hi:[1,0,0]
  v_pk_fma_f32 v[190:191], v[28:29], v[84:85], v[190:191] op_sel:[1,0,0] op_sel_hi:[1,1,1]
  v_cvt_pk_bf16_f32 v22, v86, v87
  v_cvt_pk_bf16_f32 v23, -v190, -v191
  v_pk_fma_f32 v[192:193], v[28:29], v[86:87], v[192:193] op_sel:[0,0,0] op_sel_hi:[0,1,1]
  v_pk_fma_f32 v[208:209], v[28:29], v[190:191], v[208:209] op_sel:[0,0,0] op_sel_hi:[0,1,1]
  v_pk_fma_f32 v[192:193], v[28:29], v[190:191], v[192:193] op_sel:[1,0,0] op_sel_hi:[1,1,1] neg_lo:[1,0,0] neg_hi:[1,0,0]
  v_pk_fma_f32 v[208:209], v[28:29], v[86:87], v[208:209] op_sel:[1,0,0] op_sel_hi:[1,1,1]
  v_permlane32_swap_b32 v20, v21
  v_permlane32_swap_b32 v22, v23
  s_nop 1
  v_permlane16_swap_b32 v20, v22
  v_permlane16_swap_b32 v21, v23
  buffer_store_dwordx4 v[20:23], v42, s[20:23], s6 offen sc1
  s_add_u32 s6, s6, 1048576
  v_cvt_pk_bf16_f32 v88, v192, v193
  v_cvt_pk_bf16_f32 v89, -v208, -v209
  v_pk_fma_f32 v[194:195], v[28:29], v[192:193], v[194:195] op_sel:[0,0,0] op_sel_hi:[0,1,1]
  v_pk_fma_f32 v[210:211], v[28:29], v[208:209], v[210:211] op_sel:[0,0,0] op_sel_hi:[0,1,1]
  v_pk_fma_f32 v[194:195], v[28:29], v[208:209], v[194:195] op_sel:[1,0,0] op_sel_hi:[1,1,1] neg_lo:[1,0,0] neg_hi:[1,0,0]
  v_pk_fma_f32 v[210:211], v[28:29], v[192:193], v[210:211] op_sel:[1,0,0] op_sel_hi:[1,1,1]
  v_cvt_pk_bf16_f32 v90, v194, v195
  v_cvt_pk_bf16_f32 v91, -v210, -v211
  v_pk_fma_f32 v[196:197], v[28:29], v[194:195], v[196:197] op_sel:[0,0,0] op_sel_hi:[0,1,1]
  v_pk_fma_f32 v[212:213], v[28:29], v[210:211], v[212:213] op_sel:[0,0,0] op_sel_hi:[0,1,1]
  v_pk_fma_f32 v[196:197], v[28:29], v[210:211], v[196:197] op_sel:[1,0,0] op_sel_hi:[1,1,1] neg_lo:[1,0,0] neg_hi:[1,0,0]
  v_pk_fma_f32 v[212:213], v[28:29], v[194:195], v[212:213] op_sel:[1,0,0] op_sel_hi:[1,1,1]
  v_permlane32_swap_b32 v88, v89
  v_permlane32_swap_b32 v90, v91
  s_nop 1
  v_permlane16_swap_b32 v88, v90
  v_permlane16_swap_b32 v89, v91
  buffer_store_dwordx4 v[88:91], v42, s[20:23], s6 offen sc1
  s_add_u32 s6, s6, 1048576
  v_cvt_pk_bf16_f32 v92, v196, v197
  v_cvt_pk_bf16_f32 v93, -v212, -v213
  v_pk_fma_f32 v[198:199], v[28:29], v[196:197], v[198:199] op_sel:[0,0,0] op_sel_hi:[0,1,1]
  v_pk_fma_f32 v[214:215], v[28:29], v[212:213], v[214:215] op_sel:[0,0,0] op_sel_hi:[0,1,1]
  v_pk_fma_f32 v[198:199], v[28:29], v[212:213], v[198:199] op_sel:[1,0,0] op_sel_hi:[1,1,1] neg_lo:[1,0,0] neg_hi:[1,0,0]
  v_pk_fma_f32 v[214:215], v[28:29], v[196:197], v[214:215] op_sel:[1,0,0] op_sel_hi:[1,1,1]
  v_cvt_pk_bf16_f32 v94, v198, v199
  v_cvt_pk_bf16_f32 v95, -v214, -v215
  v_pk_fma_f32 v[200:201], v[28:29], v[198:199], v[200:201] op_sel:[0,0,0] op_sel_hi:[0,1,1]
  v_pk_fma_f32 v[216:217], v[28:29], v[214:215], v[216:217] op_sel:[0,0,0] op_sel_hi:[0,1,1]
  v_pk_fma_f32 v[200:201], v[28:29], v[214:215], v[200:201] op_sel:[1,0,0] op_sel_hi:[1,1,1] neg_lo:[1,0,0] neg_hi:[1,0,0]
  v_pk_fma_f32 v[216:217], v[28:29], v[198:199], v[216:217] op_sel:[1,0,0] op_sel_hi:[1,1,1]
  v_permlane32_swap_b32 v92, v93
  v_permlane32_swap_b32 v94, v95
  s_nop 1
  v_permlane16_swap_b32 v92, v94
  v_permlane16_swap_b32 v93, v95
  buffer_store_dwordx4 v[92:95], v42, s[20:23], s6 offen sc1
  s_add_u32 s6, s6, 1048576
  v_cvt_pk_bf16_f32 v20, v200, v201
  v_cvt_pk_bf16_f32 v21, -v216, -v217
  v_pk_fma_f32 v[202:203], v[28:29], v[200:201], v[202:203] op_sel:[0,0,0] op_sel_hi:[0,1,1]
  v_pk_fma_f32 v[218:219], v[28:29], v[216:217], v[218:219] op_sel:[0,0,0] op_sel_hi:[0,1,1]
  v_pk_fma_f32 v[202:203], v[28:29], v[216:217], v[202:203] op_sel:[1,0,0] op_sel_hi:[1,1,1] neg_lo:[1,0,0] neg_hi:[1,0,0]
  v_pk_fma_f32 v[218:219], v[28:29], v[200:201], v[218:219] op_sel:[1,0,0] op_sel_hi:[1,1,1]
  v_cvt_pk_bf16_f32 v22, v202, v203
  v_cvt_pk_bf16_f32 v23, -v218, -v219
  v_pk_fma_f32 v[204:205], v[28:29], v[202:203], v[204:205] op_sel:[0,0,0] op_sel_hi:[0,1,1]
  v_pk_fma_f32 v[220:221], v[28:29], v[218:219], v[220:221] op_sel:[0,0,0] op_sel_hi:[0,1,1]
  v_pk_fma_f32 v[204:205], v[28:29], v[218:219], v[204:205] op_sel:[1,0,0] op_sel_hi:[1,1,1] neg_lo:[1,0,0] neg_hi:[1,0,0]
  v_pk_fma_f32 v[220:221], v[28:29], v[202:203], v[220:221] op_sel:[1,0,0] op_sel_hi:[1,1,1]
  v_permlane32_swap_b32 v20, v21
  v_permlane32_swap_b32 v22, v23
  s_nop 1
  v_permlane16_swap_b32 v20, v22
  v_permlane16_swap_b32 v21, v23
  buffer_store_dwordx4 v[20:23], v42, s[20:23], s6 offen sc1
  s_add_u32 s6, s6, 1048576
  v_cvt_pk_bf16_f32 v88, v204, v205
  v_cvt_pk_bf16_f32 v89, -v220, -v221
  v_pk_fma_f32 v[206:207], v[28:29], v[204:205], v[206:207] op_sel:[0,0,0] op_sel_hi:[0,1,1]
  v_pk_fma_f32 v[222:223], v[28:29], v[220:221], v[222:223] op_sel:[0,0,0] op_sel_hi:[0,1,1]
  v_pk_fma_f32 v[206:207], v[28:29], v[220:221], v[206:207] op_sel:[1,0,0] op_sel_hi:[1,1,1] neg_lo:[1,0,0] neg_hi:[1,0,0]
  v_pk_fma_f32 v[222:223], v[28:29], v[204:205], v[222:223] op_sel:[1,0,0] op_sel_hi:[1,1,1]
  v_cvt_pk_bf16_f32 v90, v206, v207
  v_cvt_pk_bf16_f32 v91, -v222, -v223
  v_permlane32_swap_b32 v88, v89
  s_nop 0
  v_permlane32_swap_b32 v90, v91
  s_nop 1
  v_permlane16_swap_b32 v88, v90
  v_permlane16_swap_b32 v89, v91
  buffer_store_dwordx4 v[88:91], v42, s[20:23], s6 offen sc1
  ds_read_b128 a[32:35], v54 offset:32768
  ds_read_b128 a[36:39], v55 offset:32768
  ds_read_b128 a[40:43], v54 offset:34816
  ds_read_b128 a[44:47], v55 offset:34816
  ds_read_b128 a[48:51], v54 offset:49152
  ds_read_b128 a[52:55], v55 offset:49152
  ds_read_b128 a[56:59], v54 offset:51200
  ds_read_b128 a[60:63], v55 offset:51200
  ds_read_b128 a[64:67], v54 offset:16384
  ds_read_b128 a[68:71], v55 offset:16384
  ds_read_b128 a[72:75], v54 offset:18432
  ds_read_b128 a[76:79], v55 offset:18432
  s_waitcnt vmcnt(8)
  ds_read_b128 a[80:83], v52 offset:32768
  ds_read_b128 a[84:87], v53 offset:32768
  ds_read_b128 a[88:91], v52 offset:34816
  ds_read_b128 a[92:95], v53 offset:34816
  s_cmp_lg_u32 s3, 3
  s_cbranch_scc1 gated_mix__spectral_gfnet__ssm_conv_s5__prompt_kernel_skip29
  s_getpc_b64 s[10:11]
gated_mix__spectral_gfnet__ssm_conv_s5__prompt_kernel_pc28:
  s_lshr_b32 s6, s2, 3
  s_mul_i32 s6, s6, 512
  v_min_u32 v8, 3, v4
  v_lshl_add_u32 v8, v8, 7, s6
  v_min_u32 v8, gated_mix__spectral_gfnet__ssm_conv_s5__prompt_kernel_end-gated_mix__spectral_gfnet__ssm_conv_s5__prompt_kernel_pc28, v8
  v_mov_b32 v9, 0
  v_lshl_add_u64 v[8:9], v[8:9], 0, s[10:11]
  global_load_dword v1, v[8:9], off
gated_mix__spectral_gfnet__ssm_conv_s5__prompt_kernel_skip29:
  s_waitcnt lgkmcnt(15)
  s_barrier
  v_lshlrev_b32 v2, 7, v0
  s_add_u32 m0, s8, 0
  s_nop 0
  buffer_load_dwordx4 v48, s[68:71], s7 offen offset:0 lds
  s_and_b32 s6, s3, 1
  s_lshl_b32 s6, s6, 2
  v_xor_b32 v9, s6, v4
  s_lshl_b32 s6, s3, 12
  s_add_u32 s6, s6, 49152
  v_lshl_add_u32 v10, v9, 4, s6
  v_xor_b32 v9, 0, v10
  ds_read_b128 v[12:15], v9 offset:0
  v_xor_b32 v9, 16, v10
  ds_read_b128 v[16:19], v9 offset:1024
  v_xor_b32 v9, 32, v10
  ds_read_b128 v[20:23], v9 offset:2048
  v_xor_b32 v9, 48, v10
  ds_read_b128 v[28:31], v9 offset:3072
  s_waitcnt lgkmcnt(3)
  v_mfma_f32_16x16x32_bf16 v[32:35], v[12:15], v[116:119], 0
  buffer_load_dwordx4 v49, s[68:71], s7 offen offset:1024 lds
  v_mfma_f32_16x16x32_bf16 v[36:39], v[12:15], v[120:123], 0
  s_waitcnt lgkmcnt(2)
  v_mfma_f32_16x16x32_bf16 v[40:43], v[16:19], v[116:119], 0
  v_mfma_f32_16x16x32_bf16 v[44:47], v[16:19], v[120:123], 0
  s_waitcnt lgkmcnt(1)
  v_mfma_f32_16x16x32_bf16 v[72:75], v[20:23], v[116:119], 0
  buffer_load_dwordx4 v50, s[68:71], s7 offen offset:2048 lds
  v_mfma_f32_16x16x32_bf16 v[76:79], v[20:23], v[120:123], 0
  s_waitcnt lgkmcnt(0)
  v_mfma_f32_16x16x32_bf16 v[80:83], v[28:31], v[116:119], 0
  v_mfma_f32_16x16x32_bf16 v[84:87], v[28:31], v[120:123], 0
  v_pk_mul_f32 v[88:89], v[32:33], v[124:125]
  v_pk_mul_f32 v[90:91], v[36:37], v[124:125]
  v_pk_fma_f32 v[88:89], v[36:37], v[128:129], v[88:89]
  v_pk_fma_f32 v[90:91], v[32:33], v[128:129], v[90:91] neg_lo:[0,1,0] neg_hi:[0,1,0]
  buffer_load_dwordx4 v51, s[68:71], s7 offen offset:3072 lds
  s_add_u32 s7, s7, 128
  s_and_b32 s7, s7, 0x7ff
  v_cvt_pk_bf16_f32 v12, v88, v90
  v_cvt_pk_bf16_f32 v13, v89, v91
  v_pk_mul_f32 v[88:89], v[34:35], v[126:127]
  v_pk_mul_f32 v[90:91], v[38:39], v[126:127]
  v_pk_fma_f32 v[88:89], v[38:39], v[130:131], v[88:89]
  v_pk_fma_f32 v[90:91], v[34:35], v[130:131], v[90:91] neg_lo:[0,1,0] neg_hi:[0,1,0]
  v_cvt_pk_bf16_f32 v14, v88, v90
  v_cvt_pk_bf16_f32 v15, v89, v91
  v_pk_mul_f32 v[88:89], v[40:41], v[124:125]
  v_pk_mul_f32 v[90:91], v[44:45], v[124:125]
  v_pk_fma_f32 v[88:89], v[44:45], v[128:129], v[88:89]
  v_pk_fma_f32 v[90:91], v[40:41], v[128:129], v[90:91] neg_lo:[0,1,0] neg_hi:[0,1,0]
  v_cvt_pk_bf16_f32 v16, v88, v90
  v_cvt_pk_bf16_f32 v17, v89, v91
  v_pk_mul_f32 v[88:89], v[42:43], v[126:127]
  v_pk_mul_f32 v[90:91], v[46:47], v[126:127]
  s_add_u32 m0, s8, 65536
  s_nop 0
  buffer_load_dwordx4 v48, s[68:71], s7 offen offset:0 lds
  v_pk_fma_f32 v[88:89], v[46:47], v[130:131], v[88:89]
  v_pk_fma_f32 v[90:91], v[42:43], v[130:131], v[90:91] neg_lo:[0,1,0] neg_hi:[0,1,0]
  v_cvt_pk_bf16_f32 v18, v88, v90
  v_cvt_pk_bf16_f32 v19, v89, v91
  v_mfma_f32_16x16x32_bf16 v[32:35], a[224:227], v[12:15], 0
  v_mfma_f32_16x16x32_bf16 v[36:39], a[228:231], v[12:15], 0
  v_pk_mul_f32 v[88:89], v[72:73], v[124:125]
  v_pk_mul_f32 v[90:91], v[76:77], v[124:125]
  v_pk_fma_f32 v[88:89], v[76:77], v[128:129], v[88:89]
  v_pk_fma_f32 v[90:91], v[72:73], v[128:129], v[90:91] neg_lo:[0,1,0] neg_hi:[0,1,0]
  buffer_load_dwordx4 v49, s[68:71], s7 offen offset:1024 lds
  v_cvt_pk_bf16_f32 v20, v88, v90
  v_cvt_pk_bf16_f32 v21, v89, v91
  v_pk_mul_f32 v[88:89], v[74:75], v[126:127]
  v_pk_mul_f32 v[90:91], v[78:79], v[126:127]
  v_pk_fma_f32 v[88:89], v[78:79], v[130:131], v[88:89]
  v_pk_fma_f32 v[90:91], v[74:75], v[130:131], v[90:91] neg_lo:[0,1,0] neg_hi:[0,1,0]
  v_cvt_pk_bf16_f32 v22, v88, v90
  v_cvt_pk_bf16_f32 v23, v89, v91
  v_mfma_f32_16x16x32_bf16 v[40:43], a[224:227], v[16:19], 0
  v_mfma_f32_16x16x32_bf16 v[44:47], a[228:231], v[16:19], 0
  buffer_load_dwordx4 v50, s[68:71], s7 offen offset:2048 lds
  v_pk_mul_f32 v[88:89], v[80:81], v[124:125]
  v_pk_mul_f32 v[90:91], v[84:85], v[124:125]
  v_pk_fma_f32 v[88:89], v[84:85], v[128:129], v[88:89]
  v_pk_fma_f32 v[90:91], v[80:81], v[128:129], v[90:91] neg_lo:[0,1,0] neg_hi:[0,1,0]
  v_cvt_pk_bf16_f32 v28, v88, v90
  v_cvt_pk_bf16_f32 v29, v89, v91
  v_pk_mul_f32 v[88:89], v[82:83], v[126:127]
  v_pk_mul_f32 v[90:91], v[86:87], v[126:127]
  v_pk_fma_f32 v[88:89], v[86:87], v[130:131], v[88:89]
  v_pk_fma_f32 v[90:91], v[82:83], v[130:131], v[90:91] neg_lo:[0,1,0] neg_hi:[0,1,0]
  v_cvt_pk_bf16_f32 v30, v88, v90
  v_cvt_pk_bf16_f32 v31, v89, v91
  v_mfma_f32_16x16x32_bf16 v[72:75], a[224:227], v[20:23], 0
  buffer_load_dwordx4 v51, s[68:71], s7 offen offset:3072 lds
  s_add_u32 s7, s7, 128
  s_and_b32 s7, s7, 0x7ff
  v_mfma_f32_16x16x32_bf16 v[76:79], a[228:231], v[20:23], 0
  v_mfma_f32_16x16x32_bf16 v[80:83], a[224:227], v[28:31], 0
  v_mfma_f32_16x16x32_bf16 v[84:87], a[228:231], v[28:31], 0
  s_cmp_eq_u32 s14, 0
  s_cbranch_scc1 gated_mix__spectral_gfnet__ssm_conv_s5__prompt_kernel_skip30
  v_pk_mul_f32 v[88:89], v[32:33], v[168:169]
  v_pk_mul_f32 v[90:91], v[36:37], v[168:169]
  v_pk_fma_f32 v[88:89], v[36:37], v[172:173], v[88:89] neg_lo:[0,1,0] neg_hi:[0,1,0]
  v_pk_fma_f32 v[90:91], v[32:33], v[172:173], v[90:91]
  v_cvt_pk_bf16_f32 v92, v88, v90
  v_cvt_pk_bf16_f32 v93, v89, v91
  v_pk_mul_f32 v[88:89], v[34:35], v[170:171]
  v_pk_mul_f32 v[90:91], v[38:39], v[170:171]
  v_pk_fma_f32 v[88:89], v[38:39], v[174:175], v[88:89] neg_lo:[0,1,0] neg_hi:[0,1,0]
  v_pk_fma_f32 v[90:91], v[34:35], v[174:175], v[90:91]
  v_cvt_pk_bf16_f32 v94, v88, v90
  v_cvt_pk_bf16_f32 v95, v89, v91
  s_nop 1
  v_mfma_f32_16x16x32_bf16 v[168:171], v[92:95], a[232:235], 0
  v_mfma_f32_16x16x32_bf16 v[172:175], v[92:95], a[236:239], 0
  s_nop 6
  v_pk_mul_f32 v[88:89], v[168:169], v[140:141]
  v_pk_mul_f32 v[90:91], v[172:173], v[140:141]
  v_pk_fma_f32 v[88:89], v[172:173], v[144:145], v[88:89] neg_lo:[0,1,0] neg_hi:[0,1,0]
  v_pk_fma_f32 v[90:91], v[168:169], v[144:145], v[90:91]
  v_cvt_pk_bf16_f32 v92, v88, v90
  v_cvt_pk_bf16_f32 v93, v89, v91
  v_pk_mul_f32 v[88:89], v[170:171], v[142:143]
  v_pk_mul_f32 v[90:91], v[174:175], v[142:143]
  v_pk_fma_f32 v[88:89], v[174:175], v[146:147], v[88:89] neg_lo:[0,1,0] neg_hi:[0,1,0]
  v_pk_fma_f32 v[90:91], v[170:171], v[146:147], v[90:91]
  v_cvt_pk_bf16_f32 v94, v88, v90
  v_cvt_pk_bf16_f32 v95, v89, v91
  s_nop 1
  v_mfma_f32_16x16x32_bf16 v[168:171], a[240:243], v[92:95], 0
  v_mfma_f32_16x16x32_bf16 v[172:175], a[244:247], v[92:95], 0
gated_mix__spectral_gfnet__ssm_conv_s5__prompt_kernel_skip30:
  v_pk_mul_f32 v[88:89], v[32:33], v[108:109]
  v_pk_mul_f32 v[90:91], v[36:37], v[108:109]
  s_add_u32 m0, s8, 16384
  s_nop 0
  buffer_load_dwordx4 v48, s[68:71], s7 offen offset:0 lds
  v_pk_fma_f32 v[88:89], v[36:37], v[112:113], v[88:89] neg_lo:[0,1,0] neg_hi:[0,1,0]
  v_pk_fma_f32 v[90:91], v[32:33], v[112:113], v[90:91]
  v_cvt_pk_bf16_f32 v12, v88, v90
  v_cvt_pk_bf16_f32 v13, v89, v91
  v_pk_mul_f32 v[88:89], v[34:35], v[110:111]
  v_pk_mul_f32 v[90:91], v[38:39], v[110:111]
  v_pk_fma_f32 v[88:89], v[38:39], v[114:115], v[88:89] neg_lo:[0,1,0] neg_hi:[0,1,0]
  v_pk_fma_f32 v[90:91], v[34:35], v[114:115], v[90:91]
  v_cvt_pk_bf16_f32 v14, v88, v90
  v_cvt_pk_bf16_f32 v15, v89, v91
  v_pk_mul_f32 v[88:89], v[40:41], v[132:133]
  v_pk_mul_f32 v[90:91], v[44:45], v[132:133]
  v_pk_fma_f32 v[88:89], v[44:45], v[136:137], v[88:89] neg_lo:[0,1,0] neg_hi:[0,1,0]
  v_pk_fma_f32 v[90:91], v[40:41], v[136:137], v[90:91]
  v_cvt_pk_bf16_f32 v16, v88, v90
  v_cvt_pk_bf16_f32 v17, v89, v91
  buffer_load_dwordx4 v49, s[68:71], s7 offen offset:1024 lds
  v_pk_mul_f32 v[88:89], v[42:43], v[134:135]
  v_pk_mul_f32 v[90:91], v[46:47], v[134:135]
  v_pk_fma_f32 v[88:89], v[46:47], v[138:139], v[88:89] neg_lo:[0,1,0] neg_hi:[0,1,0]
  v_pk_fma_f32 v[90:91], v[42:43], v[138:139], v[90:91]
  v_cvt_pk_bf16_f32 v18, v88, v90
  v_cvt_pk_bf16_f32 v19, v89, v91
  v_mfma_f32_16x16x32_bf16 v[32:35], v[12:15], a[232:235], 0
  v_mfma_f32_16x16x32_bf16 v[36:39], v[12:15], a[236:239], 0
  v_pk_mul_f32 v[88:89], v[72:73], v[148:149]
  v_pk_mul_f32 v[90:91], v[76:77], v[148:149]
  buffer_load_dwordx4 v50, s[68:71], s7 offen offset:2048 lds
  v_pk_fma_f32 v[88:89], v[76:77], v[156:157], v[88:89] neg_lo:[0,1,0] neg_hi:[0,1,0]
  v_pk_fma_f32 v[90:91], v[72:73], v[156:157], v[90:91]
  v_cvt_pk_bf16_f32 v20, v88, v90
  v_cvt_pk_bf16_f32 v21, v89, v91
  v_pk_mul_f32 v[88:89], v[74:75], v[150:151]
  v_pk_mul_f32 v[90:91], v[78:79], v[150:151]
  v_pk_fma_f32 v[88:89], v[78:79], v[158:159], v[88:89] neg_lo:[0,1,0] neg_hi:[0,1,0]
  v_pk_fma_f32 v[90:91], v[74:75], v[158:159], v[90:91]
  v_cvt_pk_bf16_f32 v22, v88, v90
  v_cvt_pk_bf16_f32 v23, v89, v91
  v_mfma_f32_16x16x32_bf16 v[40:43], v[16:19], a[232:235], 0
  v_mfma_f32_16x16x32_bf16 v[44:47], v[16:19], a[236:239], 0
  buffer_load_dwordx4 v51, s[68:71], s7 offen offset:3072 lds
  s_add_u32 s7, s7, 128
  s_and_b32 s7, s7, 0x7ff
  v_pk_mul_f32 v[88:89], v[80:81], v[160:161]
  v_pk_mul_f32 v[90:91], v[84:85], v[160:161]
  v_pk_fma_f32 v[88:89], v[84:85], v[164:165], v[88:89] neg_lo:[0,1,0] neg_hi:[0,1,0]
  v_pk_fma_f32 v[90:91], v[80:81], v[164:165], v[90:91]
  v_cvt_pk_bf16_f32 v28, v88, v90
  v_cvt_pk_bf16_f32 v29, v89, v91
  v_pk_mul_f32 v[88:89], v[82:83], v[162:163]
  v_pk_mul_f32 v[90:91], v[86:87], v[162:163]
  v_pk_fma_f32 v[88:89], v[86:87], v[166:167], v[88:89] neg_lo:[0,1,0] neg_hi:[0,1,0]
  v_pk_fma_f32 v[90:91], v[82:83], v[166:167], v[90:91]
  v_cvt_pk_bf16_f32 v30, v88, v90
  v_cvt_pk_bf16_f32 v31, v89, v91
  v_mfma_f32_16x16x32_bf16 v[72:75], v[20:23], a[232:235], 0
  s_add_u32 m0, s8, 98304
  s_nop 0
  buffer_load_dwordx4 v48, s[68:71], s7 offen offset:0 lds
  v_mfma_f32_16x16x32_bf16 v[76:79], v[20:23], a[236:239], 0
  v_mfma_f32_16x16x32_bf16 v[80:83], v[28:31], a[232:235], 0
  v_mfma_f32_16x16x32_bf16 v[84:87], v[28:31], a[236:239], 0
  s_waitcnt vmcnt(13)
  s_barrier
  s_cmp_lg_u32 s3, 0
  s_cbranch_scc1 gated_mix__spectral_gfnet__ssm_conv_s5__prompt_kernel_skip31
  s_mov_b64 exec, 1
  buffer_store_dword v7, v25, s[48:51], s5 offen sc1
  s_mov_b64 exec, -1
gated_mix__spectral_gfnet__ssm_conv_s5__prompt_kernel_skip31:
  v_pk_mul_f32 v[88:89], v[32:33], v[140:141]
  buffer_load_dwordx4 v49, s[68:71], s7 offen offset:1024 lds
  v_pk_mul_f32 v[90:91], v[36:37], v[140:141]
  v_pk_fma_f32 v[88:89], v[36:37], v[144:145], v[88:89] neg_lo:[0,1,0] neg_hi:[0,1,0]
  v_pk_fma_f32 v[90:91], v[32:33], v[144:145], v[90:91]
  v_cvt_pk_bf16_f32 v12, v88, v90
  v_cvt_pk_bf16_f32 v13, v89, v91
  v_pk_mul_f32 v[88:89], v[34:35], v[142:143]
  v_pk_mul_f32 v[90:91], v[38:39], v[142:143]
  v_pk_fma_f32 v[88:89], v[38:39], v[146:147], v[88:89] neg_lo:[0,1,0] neg_hi:[0,1,0]
  v_pk_fma_f32 v[90:91], v[34:35], v[146:147], v[90:91]
  v_cvt_pk_bf16_f32 v14, v88, v90
  v_cvt_pk_bf16_f32 v15, v89, v91
  v_pk_mul_f32 v[88:89], v[40:41], v[140:141]
  v_pk_mul_f32 v[90:91], v[44:45], v[140:141]
  v_pk_fma_f32 v[88:89], v[44:45], v[144:145], v[88:89] neg_lo:[0,1,0] neg_hi:[0,1,0]
  v_pk_fma_f32 v[90:91], v[40:41], v[144:145], v[90:91]
  v_cvt_pk_bf16_f32 v16, v88, v90
  buffer_load_dwordx4 v50, s[68:71], s7 offen offset:2048 lds
  v_cvt_pk_bf16_f32 v17, v89, v91
  v_pk_mul_f32 v[88:89], v[42:43], v[142:143]
  v_pk_mul_f32 v[90:91], v[46:47], v[142:143]
  v_pk_fma_f32 v[88:89], v[46:47], v[146:147], v[88:89] neg_lo:[0,1,0] neg_hi:[0,1,0]
  v_pk_fma_f32 v[90:91], v[42:43], v[146:147], v[90:91]
  v_cvt_pk_bf16_f32 v18, v88, v90
  v_cvt_pk_bf16_f32 v19, v89, v91
  v_mfma_f32_16x16x32_bf16 v[32:35], a[240:243], v[12:15], 0
  v_mfma_f32_16x16x32_bf16 v[36:39], a[244:247], v[12:15], 0
  v_pk_mul_f32 v[88:89], v[72:73], v[140:141]
  buffer_load_dwordx4 v51, s[68:71], s7 offen offset:3072 lds
  s_add_u32 s7, s7, 128
  s_and_b32 s7, s7, 0x7ff
  v_pk_mul_f32 v[90:91], v[76:77], v[140:141]
  v_pk_fma_f32 v[88:89], v[76:77], v[144:145], v[88:89] neg_lo:[0,1,0] neg_hi:[0,1,0]
  v_pk_fma_f32 v[90:91], v[72:73], v[144:145], v[90:91]
  v_cvt_pk_bf16_f32 v20, v88, v90
  v_cvt_pk_bf16_f32 v21, v89, v91
  v_pk_mul_f32 v[88:89], v[74:75], v[142:143]
  v_pk_mul_f32 v[90:91], v[78:79], v[142:143]
  v_pk_fma_f32 v[88:89], v[78:79], v[146:147], v[88:89] neg_lo:[0,1,0] neg_hi:[0,1,0]
  v_pk_fma_f32 v[90:91], v[74:75], v[146:147], v[90:91]
  v_cvt_pk_bf16_f32 v22, v88, v90
  v_cvt_pk_bf16_f32 v23, v89, v91
  v_mfma_f32_16x16x32_bf16 v[40:43], a[240:243], v[16:19], 0
  v_mfma_f32_16x16x32_bf16 v[44:47], a[244:247], v[16:19], 0
  s_add_u32 m0, s8, 114688
  s_nop 0
  buffer_load_dwordx4 v48, s[68:71], s7 offen offset:0 lds
  v_pk_mul_f32 v[88:89], v[80:81], v[140:141]
  v_pk_mul_f32 v[90:91], v[84:85], v[140:141]
  v_pk_fma_f32 v[88:89], v[84:85], v[144:145], v[88:89] neg_lo:[0,1,0] neg_hi:[0,1,0]
  v_pk_fma_f32 v[90:91], v[80:81], v[144:145], v[90:91]
  v_cvt_pk_bf16_f32 v28, v88, v90
  v_cvt_pk_bf16_f32 v29, v89, v91
  v_pk_mul_f32 v[88:89], v[82:83], v[142:143]
  v_pk_mul_f32 v[90:91], v[86:87], v[142:143]
  v_pk_fma_f32 v[88:89], v[86:87], v[146:147], v[88:89] neg_lo:[0,1,0] neg_hi:[0,1,0]
  v_pk_fma_f32 v[90:91], v[82:83], v[146:147], v[90:91]
  v_cvt_pk_bf16_f32 v30, v88, v90
  v_cvt_pk_bf16_f32 v31, v89, v91
  v_mfma_f32_16x16x32_bf16 v[72:75], a[240:243], v[20:23], 0
  buffer_load_dwordx4 v49, s[68:71], s7 offen offset:1024 lds
  v_mfma_f32_16x16x32_bf16 v[76:79], a[244:247], v[20:23], 0
  v_mfma_f32_16x16x32_bf16 v[80:83], a[240:243], v[28:31], 0
  v_mfma_f32_16x16x32_bf16 v[84:87], a[244:247], v[28:31], 0
  v_lshlrev_b32 v9, 12, v6
  v_lshl_add_u32 v9, v5, 4, v9
  s_lshl_b32 s6, s3, 8
  s_add_u32 s6, s6, 147456
  buffer_load_dwordx4 v50, s[68:71], s7 offen offset:2048 lds
  v_add_u32 v9, s6, v9
  s_sub_u32 s6, s14, 1
  s_or_b32 s6, s6, s3
  s_cmp_lg_u32 s6, 0
  s_cbranch_scc1 gated_mix__spectral_gfnet__ssm_conv_s5__prompt_kernel_skip32
  v_mov_b32 v36, v172
  v_mov_b32 v37, v173
  v_mov_b32 v38, v174
  v_mov_b32 v39, v175
gated_mix__spectral_gfnet__ssm_conv_s5__prompt_kernel_skip32:
  v_cvt_pk_bf16_f32 v12, v32, v36
  v_cvt_pk_bf16_f32 v13, v40, v44
  v_cvt_pk_bf16_f32 v14, v72, v76
  v_cvt_pk_bf16_f32 v15, v80, v84
  ds_write_b128 v9, v[12:15] offset:0
  v_cvt_pk_bf16_f32 v16, v33, v37
  v_cvt_pk_bf16_f32 v17, v41, v45
  v_cvt_pk_bf16_f32 v18, v73, v77
  v_cvt_pk_bf16_f32 v19, v81, v85
  ds_write_b128 v9, v[16:19] offset:1024
  v_cvt_pk_bf16_f32 v20, v34, v38
  buffer_load_dwordx4 v51, s[68:71], s7 offen offset:3072 lds
  s_add_u32 s7, s7, 128
  s_and_b32 s7, s7, 0x7ff
  v_cvt_pk_bf16_f32 v21, v42, v46
  v_cvt_pk_bf16_f32 v22, v74, v78
  v_cvt_pk_bf16_f32 v23, v82, v86
  ds_write_b128 v9, v[20:23] offset:2048
  v_cvt_pk_bf16_f32 v28, v35, v39
  v_cvt_pk_bf16_f32 v29, v43, v47
  v_cvt_pk_bf16_f32 v30, v75, v79
  v_cvt_pk_bf16_f32 v31, v83, v87
  ds_write_b128 v9, v[28:31] offset:3072
  s_add_u32 m0, s8, 81920
  s_nop 0
  buffer_load_dwordx4 v48, s[68:71], s7 offen offset:0 lds
  buffer_load_dwordx4 v49, s[68:71], s7 offen offset:1024 lds
  buffer_load_dwordx4 v50, s[68:71], s7 offen offset:2048 lds
  buffer_load_dwordx4 v51, s[68:71], s7 offen offset:3072 lds
  s_add_u32 s7, s7, 128
  s_and_b32 s7, s7, 0x7ff
  s_waitcnt vmcnt(20)
  ds_read_b128 a[96:99], v52 offset:0
  ds_read_b128 a[100:103], v53 offset:0
  ds_read_b128 a[104:107], v52 offset:2048
  ds_read_b128 a[108:111], v53 offset:2048
  s_add_u32 m0, s8, 32768
  s_nop 0
  buffer_load_dwordx4 v48, s[68:71], s7 offen offset:0 lds
  buffer_load_dwordx4 v49, s[68:71], s7 offen offset:1024 lds
  buffer_load_dwordx4 v50, s[68:71], s7 offen offset:2048 lds
  buffer_load_dwordx4 v51, s[68:71], s7 offen offset:3072 lds
  s_add_u32 s7, s7, 128
  s_and_b32 s7, s7, 0x7ff
  s_waitcnt vmcnt(20)
  ds_read_b128 a[112:115], v54 offset:0
  ds_read_b128 a[116:119], v55 offset:0
  ds_read_b128 a[120:123], v54 offset:2048
  ds_read_b128 a[124:127], v55 offset:2048
  s_waitcnt lgkmcnt(4)
  s_add_u32 m0, s8, 0
  s_nop 0
  buffer_load_dwordx4 v48, s[68:71], s7 offen offset:0 lds
  buffer_load_dwordx4 v49, s[68:71], s7 offen offset:1024 lds
  buffer_load_dwordx4 v50, s[68:71], s7 offen offset:2048 lds
  buffer_load_dwordx4 v51, s[68:71], s7 offen offset:3072 lds
  s_add_u32 s7, s7, 128
  s_and_b32 s7, s7, 0x7ff
  s_waitcnt lgkmcnt(0)
  s_barrier
  s_lshl_b32 s6, s3, 12
  s_add_u32 s6, s6, 147456
  v_lshl_add_u32 v9, v4, 4, s6
  ds_read_b128 v[12:15], v9 offset:0
  ds_read_b128 v[16:19], v9 offset:1024
  ds_read_b128 v[20:23], v9 offset:2048
  ds_read_b128 v[28:31], v9 offset:3072
  s_mov_b32 s6, 1048576
  v_mul_lo_u32 v9, v6, s6
  v_lshl_add_u32 v9, v5, 2, v9
  s_mul_i32 s9, s3, 65536
  s_lshr_b32 s6, s40, 4
  s_lshl_b32 s6, s6, 12
  s_add_u32 s9, s9, s6
  s_lshl_b32 s6, s41, 10
  s_add_u32 s9, s9, s6
  s_and_b32 s6, s40, 15
  s_lshl_b32 s6, s6, 6
  s_add_u32 s9, s9, s6
  s_waitcnt lgkmcnt(3)
  v_mfma_f32_16x16x32_bf16 v[32:35], a[248:251], v[12:15], 0
  v_mfma_f32_16x16x32_bf16 v[36:39], a[252:255], v[12:15], 0
  s_waitcnt lgkmcnt(2)
  v_mfma_f32_16x16x32_bf16 v[40:43], a[248:251], v[16:19], 0
  v_mfma_f32_16x16x32_bf16 v[44:47], a[252:255], v[16:19], 0
  s_waitcnt lgkmcnt(1)
  v_mfma_f32_16x16x32_bf16 v[72:75], a[248:251], v[20:23], 0
  v_mfma_f32_16x16x32_bf16 v[76:79], a[252:255], v[20:23], 0
  s_waitcnt lgkmcnt(0)
  v_mfma_f32_16x16x32_bf16 v[80:83], a[248:251], v[28:31], 0
  v_mfma_f32_16x16x32_bf16 v[84:87], a[252:255], v[28:31], 0
  v_cvt_pk_bf16_f32 v12, v32, v36
  v_cvt_pk_bf16_f32 v13, v33, v37
  v_cvt_pk_bf16_f32 v14, v34, v38
  v_cvt_pk_bf16_f32 v15, v35, v39
  v_cvt_pk_bf16_f32 v16, v40, v44
  v_cvt_pk_bf16_f32 v17, v41, v45
  v_cvt_pk_bf16_f32 v18, v42, v46
  v_cvt_pk_bf16_f32 v19, v43, v47
  v_cvt_pk_bf16_f32 v20, v72, v76
  v_cvt_pk_bf16_f32 v21, v73, v77
  v_cvt_pk_bf16_f32 v22, v74, v78
  v_cvt_pk_bf16_f32 v23, v75, v79
  v_cvt_pk_bf16_f32 v28, v80, v84
  v_cvt_pk_bf16_f32 v29, v81, v85
  v_cvt_pk_bf16_f32 v30, v82, v86
  v_cvt_pk_bf16_f32 v31, v83, v87
  buffer_load_dword v8, v2, s[48:51], s5 offen sc1
  s_add_u32 s24, s34, 5242880
  s_addc_u32 s25, s35, 0
  s_mov_b32 s26, 4194304
  s_mov_b32 s27, 0x20000
  s_waitcnt vmcnt(21)
  ds_read_b128 a[128:131], v52 offset:16384
  ds_read_b128 a[132:135], v53 offset:16384
  ds_read_b128 a[136:139], v52 offset:18432
  ds_read_b128 a[140:143], v53 offset:18432
  s_waitcnt vmcnt(17)
  ds_read_b128 a[144:147], v54 offset:32768
  ds_read_b128 a[148:151], v55 offset:32768
  ds_read_b128 a[152:155], v54 offset:34816
  ds_read_b128 a[156:159], v55 offset:34816
  s_waitcnt vmcnt(13)
  ds_read_b128 a[160:163], v54 offset:49152
  ds_read_b128 a[164:167], v55 offset:49152
  ds_read_b128 a[168:171], v54 offset:51200
  ds_read_b128 a[172:175], v55 offset:51200
  s_waitcnt vmcnt(9)
  ds_read_b128 a[176:179], v54 offset:16384
  ds_read_b128 a[180:183], v55 offset:16384
  ds_read_b128 a[184:187], v54 offset:18432
  ds_read_b128 a[188:191], v55 offset:18432
  s_waitcnt vmcnt(5)
  ds_read_b128 a[192:195], v52 offset:32768
  ds_read_b128 a[196:199], v53 offset:32768
  ds_read_b128 a[200:203], v52 offset:34816
  ds_read_b128 a[204:207], v53 offset:34816
  s_waitcnt vmcnt(1)
  ds_read_b128 a[208:211], v52 offset:0
  ds_read_b128 a[212:215], v53 offset:0
  ds_read_b128 a[216:219], v52 offset:2048
  ds_read_b128 a[220:223], v53 offset:2048
  buffer_store_dword v12, v9, s[24:27], s9 offen sc1
  s_add_u32 s9, s9, 262144
  buffer_store_dword v13, v9, s[24:27], s9 offen sc1
  s_add_u32 s9, s9, 262144
  buffer_store_dword v14, v9, s[24:27], s9 offen sc1
  s_add_u32 s9, s9, 262144
  buffer_store_dword v15, v9, s[24:27], s9 offen sc1
  s_sub_u32 s9, s9, 770048
  buffer_store_dword v16, v9, s[24:27], s9 offen sc1
  s_add_u32 s9, s9, 262144
  buffer_store_dword v17, v9, s[24:27], s9 offen sc1
  s_add_u32 s9, s9, 262144
  buffer_store_dword v18, v9, s[24:27], s9 offen sc1
  s_add_u32 s9, s9, 262144
  buffer_store_dword v19, v9, s[24:27], s9 offen sc1
  s_sub_u32 s9, s9, 770048
  buffer_store_dword v20, v9, s[24:27], s9 offen sc1
  s_add_u32 s9, s9, 262144
  buffer_store_dword v21, v9, s[24:27], s9 offen sc1
  s_add_u32 s9, s9, 262144
  buffer_store_dword v22, v9, s[24:27], s9 offen sc1
  s_add_u32 s9, s9, 262144
  buffer_store_dword v23, v9, s[24:27], s9 offen sc1
  s_sub_u32 s9, s9, 770048
  buffer_store_dword v28, v9, s[24:27], s9 offen sc1
  s_add_u32 s9, s9, 262144
  buffer_store_dword v29, v9, s[24:27], s9 offen sc1
  s_add_u32 s9, s9, 262144
  buffer_store_dword v30, v9, s[24:27], s9 offen sc1
  s_add_u32 s9, s9, 262144
  buffer_store_dword v31, v9, s[24:27], s9 offen sc1
  s_lshr_b32 s10, s3, 1
  s_xor_b32 s10, s10, s3
  s_lshl_b32 s10, s10, 13
  s_lshl_b32 s6, s42, 19
  s_add_u32 s10, s10, s6
  v_lshl_add_u32 v10, v4, 4, s10
  v_add_u32 v11, 4096, v10
  s_lshl_b32 s6, s19, 15
  s_lshl_b32 s9, s3, 13
  v_and_b32 v16, 3, v4
  v_and_b32 v17, 2, v6
  v_xor_b32 v17, v17, v16
  v_lshlrev_b32 v16, 9, v16
  v_lshl_or_b32 v16, v17, 6, v16
  v_bfe_u32 v17, v4, 2, 2
  v_lshl_or_b32 v16, v17, 4, v16
  v_and_b32 v17, 1, v6
  v_lshl_or_b32 v16, v17, 3, v16
  s_and_b32 s10, s3, 1
  s_lshl_b32 s10, s10, 14
  v_add_u32 v12, s10, v16
  v_xor_b32 v13, 64, v12
  v_add_u32 v14, 0x10000, v12
  v_add_u32 v15, 0x10000, v13
  v_lshlrev_b32 v16, 16, v56
  v_and_b32 v17, 0xffff0000, v56
  v_lshlrev_b32 v18, 16, v57
  v_and_b32 v19, 0xffff0000, v57
  v_pk_mul_f32 v[16:17], v[26:27], v[16:17] op_sel:[0,0] op_sel_hi:[0,1]
  v_pk_mul_f32 v[18:19], v[26:27], v[18:19] op_sel:[0,0] op_sel_hi:[0,1]
  v_lshlrev_b32 v20, 16, v58
  v_and_b32 v21, 0xffff0000, v58
  v_lshlrev_b32 v22, 16, v59
  v_and_b32 v23, 0xffff0000, v59
  v_pk_mul_f32 v[20:21], v[26:27], v[20:21] op_sel:[0,0] op_sel_hi:[0,1]
  v_pk_mul_f32 v[22:23], v[26:27], v[22:23] op_sel:[0,0] op_sel_hi:[0,1]
  v_lshlrev_b32 v28, 16, v60
  v_and_b32 v29, 0xffff0000, v60
  v_lshlrev_b32 v30, 16, v61
  v_and_b32 v31, 0xffff0000, v61
  v_pk_mul_f32 v[28:29], v[26:27], v[28:29] op_sel:[0,0] op_sel_hi:[0,1]
  v_pk_mul_f32 v[30:31], v[26:27], v[30:31] op_sel:[0,0] op_sel_hi:[0,1]
  v_lshlrev_b32 v32, 16, v62
  v_and_b32 v33, 0xffff0000, v62
  v_lshlrev_b32 v34, 16, v63
  v_and_b32 v35, 0xffff0000, v63
  v_pk_mul_f32 v[32:33], v[26:27], v[32:33] op_sel:[0,0] op_sel_hi:[0,1]
  v_pk_mul_f32 v[34:35], v[26:27], v[34:35] op_sel:[0,0] op_sel_hi:[0,1]
  v_lshlrev_b32 v76, 16, v64
  v_and_b32 v77, 0xffff0000, v64
  v_lshlrev_b32 v78, 16, v65
  v_and_b32 v79, 0xffff0000, v65
  v_pk_mul_f32 v[76:77], v[26:27], v[76:77] op_sel:[1,0] op_sel_hi:[1,1]
  v_pk_mul_f32 v[78:79], v[26:27], v[78:79] op_sel:[1,0] op_sel_hi:[1,1]
  v_lshlrev_b32 v80, 16, v66
  v_and_b32 v81, 0xffff0000, v66
  v_lshlrev_b32 v82, 16, v67
  v_and_b32 v83, 0xffff0000, v67
  v_pk_mul_f32 v[80:81], v[26:27], v[80:81] op_sel:[1,0] op_sel_hi:[1,1]
  v_pk_mul_f32 v[82:83], v[26:27], v[82:83] op_sel:[1,0] op_sel_hi:[1,1]
  v_lshlrev_b32 v84, 16, v68
  v_and_b32 v85, 0xffff0000, v68
  v_lshlrev_b32 v86, 16, v69
  v_and_b32 v87, 0xffff0000, v69
  v_pk_mul_f32 v[84:85], v[26:27], v[84:85] op_sel:[1,0] op_sel_hi:[1,1]
  v_pk_mul_f32 v[86:87], v[26:27], v[86:87] op_sel:[1,0] op_sel_hi:[1,1]
  v_lshlrev_b32 v88, 16, v70
  v_and_b32 v89, 0xffff0000, v70
  v_lshlrev_b32 v90, 16, v71
  v_and_b32 v91, 0xffff0000, v71
  v_pk_mul_f32 v[88:89], v[26:27], v[88:89] op_sel:[1,0] op_sel_hi:[1,1]
  v_pk_mul_f32 v[90:91], v[26:27], v[90:91] op_sel:[1,0] op_sel_hi:[1,1]
  s_waitcnt vmcnt(16)
  v_cmp_ne_u32 vcc, 1, v8
  s_nop 0
  s_cbranch_vccz gated_mix__spectral_gfnet__ssm_conv_s5__prompt_kernel_skip33
  s_mov_b32 s10, 0
gated_mix__spectral_gfnet__ssm_conv_s5__prompt_kernel_poll34:
  s_sleep 2
  buffer_load_dword v8, v2, s[48:51], s5 offen sc1
  s_waitcnt vmcnt(0)
  v_cmp_ne_u32 vcc, 1, v8
  s_nop 0
  s_cbranch_vccz gated_mix__spectral_gfnet__ssm_conv_s5__prompt_kernel_pollout35
  s_add_u32 s10, s10, 1
  s_cmp_lt_u32 s10, 1048576
  s_cbranch_scc1 gated_mix__spectral_gfnet__ssm_conv_s5__prompt_kernel_poll34
gated_mix__spectral_gfnet__ssm_conv_s5__prompt_kernel_pollout35:
gated_mix__spectral_gfnet__ssm_conv_s5__prompt_kernel_skip33:
  s_waitcnt lgkmcnt(0)
  s_barrier
  s_add_u32 m0, s9, 0
  s_nop 0
  buffer_load_dwordx4 v10, s[20:23], s6 offen offset:0 sc1 lds
  buffer_load_dwordx4 v10, s[20:23], s6 offen offset:1024 sc1 lds
  buffer_load_dwordx4 v10, s[20:23], s6 offen offset:2048 sc1 lds
  v_lshrrev_b32 v2, 1, v6
  v_lshlrev_b32 v2, 3, v2
  v_and_b32 v8, 1, v6
  v_lshl_add_u32 v2, v8, 1, v2
  v_cvt_f32_u32 v9, v2
  v_bfe_i32 v2, v5, 0, 1
  v_and_b32 v26, 0x02020202, v2
  v_xor_b32 v26, 0x03020100, v26
  v_and_b32 v2, 0x80000000, v2
  v_bfe_i32 v27, v5, 1, 1
  v_and_b32 v27, 0x80008000, v27
  v_xor_b32 v27, v27, v2
  buffer_load_dwordx4 v10, s[20:23], s6 offen offset:3072 sc1 lds
  s_and_b32 s10, s3, 1
  s_lshl_b32 s10, s10, 6
  v_add_u32 v2, s10, v5
  v_cvt_f32_u32 v2, v2
  v_mul_f32 v2, 0x3c000000, v2
  v_mul_f32 v8, v2, v9
  v_fmamk_f32 v188, v2, 0x0, v8
  v_fmamk_f32 v189, v2, 0x3f800000, v8
  v_fmamk_f32 v190, v2, 0x40800000, v8
  v_fmamk_f32 v191, v2, 0x40a00000, v8
  v_fmamk_f32 v192, v2, 0x41800000, v8
  v_fmamk_f32 v193, v2, 0x41880000, v8
  s_add_u32 m0, s9, 4096
  s_nop 0
  buffer_load_dwordx4 v11, s[20:23], s6 offen offset:0 sc1 lds
  v_fmamk_f32 v194, v2, 0x41a00000, v8
  v_fmamk_f32 v195, v2, 0x41a80000, v8
  v_cos_f32 v196, v188
  v_cos_f32 v197, v189
  v_cos_f32 v198, v190
  v_cos_f32 v199, v191
  v_cos_f32 v200, v192
  buffer_load_dwordx4 v11, s[20:23], s6 offen offset:1024 sc1 lds
  v_cos_f32 v201, v193
  v_cos_f32 v202, v194
  v_cos_f32 v203, v195
  v_sin_f32 v188, v188
  v_sin_f32 v189, v189
  v_sin_f32 v190, v190
  buffer_load_dwordx4 v11, s[20:23], s6 offen offset:2048 sc1 lds
  v_sin_f32 v191, v191
  v_sin_f32 v192, v192
  v_sin_f32 v193, v193
  v_sin_f32 v194, v194
  v_sin_f32 v195, v195
  v_cvt_pk_bf16_f32 v56, v196, -v188
  v_cvt_pk_bf16_f32 v57, v197, -v189
  buffer_load_dwordx4 v11, s[20:23], s6 offen offset:3072 sc1 lds
  s_add_u32 s6, s6, 32768
  s_and_b32 s6, s6, 0x7ffff
  v_cvt_pk_bf16_f32 v58, v198, -v190
  v_cvt_pk_bf16_f32 v59, v199, -v191
  v_cvt_pk_bf16_f32 v60, v200, -v192
  v_cvt_pk_bf16_f32 v61, v201, -v193
  v_cvt_pk_bf16_f32 v62, v202, -v194
  v_cvt_pk_bf16_f32 v63, v203, -v195
  v_perm_b32 v64, v56, v56, v26
  v_xor_b32 v64, v27, v64
  v_perm_b32 v65, v57, v57, v26
  v_xor_b32 v65, v27, v65
  v_perm_b32 v66, v58, v58, v26
  v_xor_b32 v66, v27, v66
  s_add_u32 m0, s9, 32768
  s_nop 0
  buffer_load_dwordx4 v10, s[20:23], s6 offen offset:0 sc1 lds
  v_perm_b32 v67, v59, v59, v26
  v_xor_b32 v67, v27, v67
  v_perm_b32 v68, v60, v60, v26
  v_xor_b32 v68, v27, v68
  v_perm_b32 v69, v61, v61, v26
  v_xor_b32 v69, v27, v69
  v_perm_b32 v70, v62, v62, v26
  v_xor_b32 v70, v27, v70
  v_perm_b32 v71, v63, v63, v26
  v_xor_b32 v71, v27, v71
  v_add_f32 v2, 0x3e000000, v2
  v_mul_f32 v8, v2, v9
  buffer_load_dwordx4 v10, s[20:23], s6 offen offset:1024 sc1 lds
  v_fmamk_f32 v188, v2, 0x0, v8
  v_fmamk_f32 v189, v2, 0x3f800000, v8
  v_fmamk_f32 v190, v2, 0x40800000, v8
  v_fmamk_f32 v191, v2, 0x40a00000, v8
  v_fmamk_f32 v192, v2, 0x41800000, v8
  v_fmamk_f32 v193, v2, 0x41880000, v8
  v_fmamk_f32 v194, v2, 0x41a00000, v8
  v_fmamk_f32 v195, v2, 0x41a80000, v8
  v_cos_f32 v196, v188
  v_cos_f32 v197, v189
  buffer_load_dwordx4 v10, s[20:23], s6 offen offset:2048 sc1 lds
  v_cos_f32 v198, v190
  v_cos_f32 v199, v191
  v_cos_f32 v200, v192
  v_cos_f32 v201, v193
  v_cos_f32 v202, v194
  v_cos_f32 v203, v195
  buffer_load_dwordx4 v10, s[20:23], s6 offen offset:3072 sc1 lds
  v_sin_f32 v188, v188
  v_sin_f32 v189, v189
  v_sin_f32 v190, v190
  v_sin_f32 v191, v191
  v_sin_f32 v192, v192
  v_sin_f32 v193, v193
  s_add_u32 m0, s9, 36864
  s_nop 0
  buffer_load_dwordx4 v11, s[20:23], s6 offen offset:0 sc1 lds
  v_sin_f32 v194, v194
  v_sin_f32 v195, v195
  v_cvt_pk_bf16_f32 v172, v196, -v188
  v_cvt_pk_bf16_f32 v173, v197, -v189
  v_cvt_pk_bf16_f32 v174, v198, -v190
  v_cvt_pk_bf16_f32 v175, v199, -v191
  v_cvt_pk_bf16_f32 v176, v200, -v192
  v_cvt_pk_bf16_f32 v177, v201, -v193
  v_cvt_pk_bf16_f32 v178, v202, -v194
  v_cvt_pk_bf16_f32 v179, v203, -v195
  buffer_load_dwordx4 v11, s[20:23], s6 offen offset:1024 sc1 lds
  v_perm_b32 v180, v172, v172, v26
  v_xor_b32 v180, v27, v180
  v_perm_b32 v181, v173, v173, v26
  v_xor_b32 v181, v27, v181
  v_perm_b32 v182, v174, v174, v26
  v_xor_b32 v182, v27, v182
  v_perm_b32 v183, v175, v175, v26
  v_xor_b32 v183, v27, v183
  v_perm_b32 v184, v176, v176, v26
  v_xor_b32 v184, v27, v184
  v_perm_b32 v185, v177, v177, v26
  v_xor_b32 v185, v27, v185
  buffer_load_dwordx4 v11, s[20:23], s6 offen offset:2048 sc1 lds
  v_perm_b32 v186, v178, v178, v26
  v_xor_b32 v186, v27, v186
  v_perm_b32 v187, v179, v179, v26
  v_xor_b32 v187, v27, v187
  v_lshlrev_b32 v8, 31, v5
  v_or_b32 v8, 0x3f003f00, v8
  v_cmp_eq_u32 vcc, 0, v6
  s_nop 1
  v_cndmask_b32 v56, v56, v8, vcc
  v_cndmask_b32 v172, v172, v8, vcc
  buffer_load_dwordx4 v11, s[20:23], s6 offen offset:3072 sc1 lds
  s_add_u32 s6, s6, 32768
  s_and_b32 s6, s6, 0x7ffff
  s_add_u32 m0, s9, 65536
  s_nop 0
  buffer_load_dwordx4 v10, s[20:23], s6 offen offset:0 sc1 lds
  buffer_load_dwordx4 v10, s[20:23], s6 offen offset:1024 sc1 lds
  buffer_load_dwordx4 v10, s[20:23], s6 offen offset:2048 sc1 lds
  buffer_load_dwordx4 v10, s[20:23], s6 offen offset:3072 sc1 lds
  s_add_u32 m0, s9, 69632
  s_nop 0
  buffer_load_dwordx4 v11, s[20:23], s6 offen offset:0 sc1 lds
  buffer_load_dwordx4 v11, s[20:23], s6 offen offset:1024 sc1 lds
  buffer_load_dwordx4 v11, s[20:23], s6 offen offset:2048 sc1 lds
  buffer_load_dwordx4 v11, s[20:23], s6 offen offset:3072 sc1 lds
  s_add_u32 s6, s6, 32768
  s_and_b32 s6, s6, 0x7ffff
  s_mov_b32 s44, s30
  s_mov_b32 s45, s31
  s_mov_b32 s46, 8388608
  s_mov_b32 s47, 0x20000
  s_waitcnt vmcnt(16)
  s_barrier
  ds_read_b64_tr_b16 v[108:109], v12 offset:0
  ds_read_b64_tr_b16 v[110:111], v13 offset:0
  ds_read_b64_tr_b16 v[112:113], v12 offset:2048
  ds_read_b64_tr_b16 v[114:115], v13 offset:2048
  ds_read_b64_tr_b16 v[116:117], v12 offset:4096
  ds_read_b64_tr_b16 v[118:119], v13 offset:4096
  ds_read_b64_tr_b16 v[120:121], v12 offset:6144
  ds_read_b64_tr_b16 v[122:123], v13 offset:6144
  ds_read_b64_tr_b16 v[124:125], v12 offset:8192
  ds_read_b64_tr_b16 v[126:127], v13 offset:8192
  ds_read_b64_tr_b16 v[128:129], v12 offset:10240
  ds_read_b64_tr_b16 v[130:131], v13 offset:10240
  ds_read_b64_tr_b16 v[132:133], v12 offset:12288
  ds_read_b64_tr_b16 v[134:135], v13 offset:12288
  ds_read_b64_tr_b16 v[136:137], v12 offset:14336
  ds_read_b64_tr_b16 v[138:139], v13 offset:14336
  s_waitcnt lgkmcnt(0)
  v_mfma_f32_16x16x32_bf16 v[16:19], v[108:111], a[0:3], v[16:19]
  ds_read_b64_tr_b16 v[140:141], v12 offset:256
  ds_read_b64_tr_b16 v[142:143], v13 offset:256
  v_mfma_f32_16x16x32_bf16 v[76:79], v[108:111], a[8:11], v[76:79]
  ds_read_b64_tr_b16 v[144:145], v12 offset:2304
  ds_read_b64_tr_b16 v[146:147], v13 offset:2304
  v_mfma_f32_16x16x32_bf16 v[20:23], v[112:115], a[0:3], v[20:23]
  ds_read_b64_tr_b16 v[148:149], v12 offset:4352
  ds_read_b64_tr_b16 v[150:151], v13 offset:4352
  v_mfma_f32_16x16x32_bf16 v[80:83], v[112:115], a[8:11], v[80:83]
  ds_read_b64_tr_b16 v[152:153], v12 offset:6400
  ds_read_b64_tr_b16 v[154:155], v13 offset:6400
  v_mfma_f32_16x16x32_bf16 v[28:31], v[116:119], a[0:3], v[28:31]
  ds_read_b64_tr_b16 v[156:157], v12 offset:8448
  ds_read_b64_tr_b16 v[158:159], v13 offset:8448
  v_mfma_f32_16x16x32_bf16 v[84:87], v[116:119], a[8:11], v[84:87]
  ds_read_b64_tr_b16 v[160:161], v12 offset:10496
  ds_read_b64_tr_b16 v[162:163], v13 offset:10496
  v_mfma_f32_16x16x32_bf16 v[32:35], v[120:123], a[0:3], v[32:35]
  ds_read_b64_tr_b16 v[164:165], v12 offset:12544
  ds_read_b64_tr_b16 v[166:167], v13 offset:12544
  v_mfma_f32_16x16x32_bf16 v[88:91], v[120:123], a[8:11], v[88:91]
  ds_read_b64_tr_b16 v[168:169], v12 offset:14592
  ds_read_b64_tr_b16 v[170:171], v13 offset:14592
  v_mfma_f32_16x16x32_bf16 v[36:39], v[124:127], a[0:3], 0
  s_add_u32 m0, s9, 98304
  s_nop 0
  buffer_load_dwordx4 v10, s[20:23], s6 offen offset:0 sc1 lds
  s_lshl_b32 s11, s3, 13
  s_add_u32 s11, s11, 0
  v_mfma_f32_16x16x32_bf16 v[92:95], v[124:127], a[8:11], 0
  v_lshl_add_u32 v2, v4, 4, s11
  v_lshrrev_b32 v8, 5, v4
  v_mfma_f32_16x16x32_bf16 v[40:43], v[128:131], a[0:3], 0
  buffer_load_dwordx4 v10, s[20:23], s6 offen offset:1024 sc1 lds
  v_lshlrev_b32 v8, 9, v8
  v_bfe_u32 v26, v4, 3, 2
  v_mfma_f32_16x16x32_bf16 v[96:99], v[128:131], a[8:11], 0
  v_lshl_or_b32 v8, v26, 6, v8
  v_and_b32 v26, 3, v4
  v_mfma_f32_16x16x32_bf16 v[44:47], v[132:135], a[0:3], 0
  buffer_load_dwordx4 v10, s[20:23], s6 offen offset:2048 sc1 lds
  v_lshl_or_b32 v8, v26, 4, v8
  v_bfe_u32 v26, v4, 2, 1
  v_mfma_f32_16x16x32_bf16 v[100:103], v[132:135], a[8:11], 0
  v_lshl_or_b32 v8, v26, 3, v8
  s_lshr_b32 s11, s3, 1
  v_mfma_f32_16x16x32_bf16 v[72:75], v[136:139], a[0:3], 0
  buffer_load_dwordx4 v10, s[20:23], s6 offen offset:3072 sc1 lds
  s_lshl_b32 s11, s11, 13
  s_add_u32 s11, s11, 131072
  v_mfma_f32_16x16x32_bf16 v[104:107], v[136:139], a[8:11], 0
  v_add_u32 v8, s11, v8
  v_lshlrev_b32 v9, 18, v6
  s_waitcnt vmcnt(12) lgkmcnt(0)
  s_barrier
  v_mfma_f32_16x16x32_bf16 v[16:19], v[140:143], a[4:7], v[16:19]
  ds_read_b64_tr_b16 v[108:109], v12 offset:32768
  ds_read_b64_tr_b16 v[110:111], v13 offset:32768
  v_mfma_f32_16x16x32_bf16 v[76:79], v[140:143], a[12:15], v[76:79]
  ds_read_b64_tr_b16 v[112:113], v12 offset:34816
  ds_read_b64_tr_b16 v[114:115], v13 offset:34816
  v_mfma_f32_16x16x32_bf16 v[20:23], v[144:147], a[4:7], v[20:23]
  ds_read_b64_tr_b16 v[116:117], v12 offset:36864
  ds_read_b64_tr_b16 v[118:119], v13 offset:36864
  v_mfma_f32_16x16x32_bf16 v[80:83], v[144:147], a[12:15], v[80:83]
  ds_read_b64_tr_b16 v[120:121], v12 offset:38912
  ds_read_b64_tr_b16 v[122:123], v13 offset:38912
  v_mfma_f32_16x16x32_bf16 v[28:31], v[148:151], a[4:7], v[28:31]
  ds_read_b64_tr_b16 v[124:125], v12 offset:40960
  ds_read_b64_tr_b16 v[126:127], v13 offset:40960
  v_mfma_f32_16x16x32_bf16 v[84:87], v[148:151], a[12:15], v[84:87]
  ds_read_b64_tr_b16 v[128:129], v12 offset:43008
  ds_read_b64_tr_b16 v[130:131], v13 offset:43008
  v_mfma_f32_16x16x32_bf16 v[32:35], v[152:155], a[4:7], v[32:35]
  ds_read_b64_tr_b16 v[132:133], v12 offset:45056
  ds_read_b64_tr_b16 v[134:135], v13 offset:45056
  v_mfma_f32_16x16x32_bf16 v[88:91], v[152:155], a[12:15], v[88:91]
  ds_read_b64_tr_b16 v[136:137], v12 offset:47104
  ds_read_b64_tr_b16 v[138:139], v13 offset:47104
  v_mfma_f32_16x16x32_bf16 v[36:39], v[156:159], a[4:7], v[36:39]
  s_add_u32 m0, s9, 102400
  s_nop 0
  buffer_load_dwordx4 v11, s[20:23], s6 offen offset:0 sc1 lds
  v_lshl_or_b32 v9, v5, 2, v9
  s_and_b32 s10, s3, 1
  v_mfma_f32_16x16x32_bf16 v[92:95], v[156:159], a[12:15], v[92:95]
  s_lshl_b32 s10, s10, 22
  s_lshl_b32 s11, s42, 12
  v_mfma_f32_16x16x32_bf16 v[40:43], v[160:163], a[4:7], v[40:43]
  buffer_load_dwordx4 v11, s[20:23], s6 offen offset:1024 sc1 lds
  s_add_u32 s10, s10, s11
  s_lshl_b32 s11, s43, 6
  v_mfma_f32_16x16x32_bf16 v[96:99], v[160:163], a[12:15], v[96:99]
  s_add_u32 s10, s10, s11
  s_lshr_b32 s11, s3, 1
  v_mfma_f32_16x16x32_bf16 v[44:47], v[164:167], a[4:7], v[44:47]
  buffer_load_dwordx4 v11, s[20:23], s6 offen offset:2048 sc1 lds
  s_lshl_b32 s11, s11, 11
  s_add_u32 s10, s10, s11
  v_mfma_f32_16x16x32_bf16 v[100:103], v[164:167], a[12:15], v[100:103]
  v_mfma_f32_16x16x32_bf16 v[72:75], v[168:171], a[4:7], v[72:75]
  buffer_load_dwordx4 v11, s[20:23], s6 offen offset:3072 sc1 lds
  s_add_u32 s6, s6, 32768
  s_and_b32 s6, s6, 0x7ffff
  v_mfma_f32_16x16x32_bf16 v[104:107], v[168:171], a[12:15], v[104:107]
  s_waitcnt lgkmcnt(0)
  v_mfma_f32_16x16x32_bf16 v[16:19], v[108:111], a[16:19], v[16:19]
  ds_read_b64_tr_b16 v[140:141], v12 offset:33024
  ds_read_b64_tr_b16 v[142:143], v13 offset:33024
  v_mfma_f32_16x16x32_bf16 v[76:79], v[108:111], a[24:27], v[76:79]
  ds_read_b64_tr_b16 v[144:145], v12 offset:35072
  ds_read_b64_tr_b16 v[146:147], v13 offset:35072
  v_mfma_f32_16x16x32_bf16 v[20:23], v[112:115], a[16:19], v[20:23]
  ds_read_b64_tr_b16 v[148:149], v12 offset:37120
  ds_read_b64_tr_b16 v[150:151], v13 offset:37120
  v_mfma_f32_16x16x32_bf16 v[80:83], v[112:115], a[24:27], v[80:83]
  ds_read_b64_tr_b16 v[152:153], v12 offset:39168
  ds_read_b64_tr_b16 v[154:155], v13 offset:39168
  v_mfma_f32_16x16x32_bf16 v[28:31], v[116:119], a[16:19], v[28:31]
  ds_read_b64_tr_b16 v[156:157], v12 offset:41216
  ds_read_b64_tr_b16 v[158:159], v13 offset:41216
  v_mfma_f32_16x16x32_bf16 v[84:87], v[116:119], a[24:27], v[84:87]
  ds_read_b64_tr_b16 v[160:161], v12 offset:43264
  ds_read_b64_tr_b16 v[162:163], v13 offset:43264
  v_mfma_f32_16x16x32_bf16 v[32:35], v[120:123], a[16:19], v[32:35]
  ds_read_b64_tr_b16 v[164:165], v12 offset:45312
  ds_read_b64_tr_b16 v[166:167], v13 offset:45312
  v_mfma_f32_16x16x32_bf16 v[88:91], v[120:123], a[24:27], v[88:91]
  ds_read_b64_tr_b16 v[168:169], v12 offset:47360
  ds_read_b64_tr_b16 v[170:171], v13 offset:47360
  v_mfma_f32_16x16x32_bf16 v[36:39], v[124:127], a[16:19], v[36:39]
  s_add_u32 m0, s9, 0
  s_nop 0
  buffer_load_dwordx4 v10, s[20:23], s6 offen offset:0 sc1 lds
  v_mfma_f32_16x16x32_bf16 v[92:95], v[124:127], a[24:27], v[92:95]
  v_mfma_f32_16x16x32_bf16 v[40:43], v[128:131], a[16:19], v[40:43]
  buffer_load_dwordx4 v10, s[20:23], s6 offen offset:1024 sc1 lds
  v_mfma_f32_16x16x32_bf16 v[96:99], v[128:131], a[24:27], v[96:99]
  v_mfma_f32_16x16x32_bf16 v[44:47], v[132:135], a[16:19], v[44:47]
  buffer_load_dwordx4 v10, s[20:23], s6 offen offset:2048 sc1 lds
  v_mfma_f32_16x16x32_bf16 v[100:103], v[132:135], a[24:27], v[100:103]
  v_mfma_f32_16x16x32_bf16 v[72:75], v[136:139], a[16:19], v[72:75]
  buffer_load_dwordx4 v10, s[20:23], s6 offen offset:3072 sc1 lds
  v_mfma_f32_16x16x32_bf16 v[104:107], v[136:139], a[24:27], v[104:107]
  s_waitcnt vmcnt(12) lgkmcnt(0)
  s_barrier
  v_mfma_f32_16x16x32_bf16 v[16:19], v[140:143], a[20:23], v[16:19]
  ds_read_b64_tr_b16 v[108:109], v14 offset:0
  ds_read_b64_tr_b16 v[110:111], v15 offset:0
  v_mfma_f32_16x16x32_bf16 v[76:79], v[140:143], a[28:31], v[76:79]
  ds_read_b64_tr_b16 v[112:113], v14 offset:2048
  ds_read_b64_tr_b16 v[114:115], v15 offset:2048
  v_mfma_f32_16x16x32_bf16 v[20:23], v[144:147], a[20:23], v[20:23]
  ds_read_b64_tr_b16 v[116:117], v14 offset:4096
  ds_read_b64_tr_b16 v[118:119], v15 offset:4096
  v_mfma_f32_16x16x32_bf16 v[80:83], v[144:147], a[28:31], v[80:83]
  ds_read_b64_tr_b16 v[120:121], v14 offset:6144
  ds_read_b64_tr_b16 v[122:123], v15 offset:6144
  v_mfma_f32_16x16x32_bf16 v[28:31], v[148:151], a[20:23], v[28:31]
  ds_read_b64_tr_b16 v[124:125], v14 offset:8192
  ds_read_b64_tr_b16 v[126:127], v15 offset:8192
  v_mfma_f32_16x16x32_bf16 v[84:87], v[148:151], a[28:31], v[84:87]
  ds_read_b64_tr_b16 v[128:129], v14 offset:10240
  ds_read_b64_tr_b16 v[130:131], v15 offset:10240
  v_mfma_f32_16x16x32_bf16 v[32:35], v[152:155], a[20:23], v[32:35]
  ds_read_b64_tr_b16 v[132:133], v14 offset:12288
  ds_read_b64_tr_b16 v[134:135], v15 offset:12288
  v_mfma_f32_16x16x32_bf16 v[88:91], v[152:155], a[28:31], v[88:91]
  ds_read_b64_tr_b16 v[136:137], v14 offset:14336
  ds_read_b64_tr_b16 v[138:139], v15 offset:14336
  v_mfma_f32_16x16x32_bf16 v[36:39], v[156:159], a[20:23], v[36:39]
  s_add_u32 m0, s9, 4096
  s_nop 0
  buffer_load_dwordx4 v11, s[20:23], s6 offen offset:0 sc1 lds
  v_mfma_f32_16x16x32_bf16 v[92:95], v[156:159], a[28:31], v[92:95]
  v_mfma_f32_16x16x32_bf16 v[40:43], v[160:163], a[20:23], v[40:43]
  buffer_load_dwordx4 v11, s[20:23], s6 offen offset:1024 sc1 lds
  v_mfma_f32_16x16x32_bf16 v[96:99], v[160:163], a[28:31], v[96:99]
  v_mfma_f32_16x16x32_bf16 v[44:47], v[164:167], a[20:23], v[44:47]
  buffer_load_dwordx4 v11, s[20:23], s6 offen offset:2048 sc1 lds
  v_mfma_f32_16x16x32_bf16 v[100:103], v[164:167], a[28:31], v[100:103]
  v_mfma_f32_16x16x32_bf16 v[72:75], v[168:171], a[20:23], v[72:75]
  buffer_load_dwordx4 v11, s[20:23], s6 offen offset:3072 sc1 lds
  s_add_u32 s6, s6, 32768
  s_and_b32 s6, s6, 0x7ffff
  v_mfma_f32_16x16x32_bf16 v[104:107], v[168:171], a[28:31], v[104:107]
  s_add_u32 m0, s8, 147456
  s_nop 0
  buffer_load_dwordx4 v48, s[68:71], s7 offen offset:0 lds
  buffer_load_dwordx4 v49, s[68:71], s7 offen offset:1024 lds
  buffer_load_dwordx4 v50, s[68:71], s7 offen offset:2048 lds
  buffer_load_dwordx4 v51, s[68:71], s7 offen offset:3072 lds
  s_add_u32 s7, s7, 128
  s_and_b32 s7, s7, 0x7ff
  s_waitcnt lgkmcnt(0)
  v_mfma_f32_16x16x32_bf16 v[16:19], v[108:111], a[32:35], v[16:19]
  ds_read_b64_tr_b16 v[140:141], v14 offset:256
  ds_read_b64_tr_b16 v[142:143], v15 offset:256
  v_mfma_f32_16x16x32_bf16 v[76:79], v[108:111], a[40:43], v[76:79]
  ds_read_b64_tr_b16 v[144:145], v14 offset:2304
  ds_read_b64_tr_b16 v[146:147], v15 offset:2304
  v_mfma_f32_16x16x32_bf16 v[20:23], v[112:115], a[32:35], v[20:23]
  ds_read_b64_tr_b16 v[148:149], v14 offset:4352
  ds_read_b64_tr_b16 v[150:151], v15 offset:4352
  v_mfma_f32_16x16x32_bf16 v[80:83], v[112:115], a[40:43], v[80:83]
  ds_read_b64_tr_b16 v[152:153], v14 offset:6400
  ds_read_b64_tr_b16 v[154:155], v15 offset:6400
  v_mfma_f32_16x16x32_bf16 v[28:31], v[116:119], a[32:35], v[28:31]
  ds_read_b64_tr_b16 v[156:157], v14 offset:8448
  ds_read_b64_tr_b16 v[158:159], v15 offset:8448
  v_mfma_f32_16x16x32_bf16 v[84:87], v[116:119], a[40:43], v[84:87]
  ds_read_b64_tr_b16 v[160:161], v14 offset:10496
  ds_read_b64_tr_b16 v[162:163], v15 offset:10496
  v_mfma_f32_16x16x32_bf16 v[32:35], v[120:123], a[32:35], v[32:35]
  ds_read_b64_tr_b16 v[164:165], v14 offset:12544
  ds_read_b64_tr_b16 v[166:167], v15 offset:12544
  v_mfma_f32_16x16x32_bf16 v[88:91], v[120:123], a[40:43], v[88:91]
  ds_read_b64_tr_b16 v[168:169], v14 offset:14592
  ds_read_b64_tr_b16 v[170:171], v15 offset:14592
  v_mfma_f32_16x16x32_bf16 v[36:39], v[124:127], a[32:35], v[36:39]
  s_add_u32 m0, s9, 32768
  s_nop 0
  buffer_load_dwordx4 v10, s[20:23], s6 offen offset:0 sc1 lds
  v_mfma_f32_16x16x32_bf16 v[92:95], v[124:127], a[40:43], v[92:95]
  v_mfma_f32_16x16x32_bf16 v[40:43], v[128:131], a[32:35], v[40:43]
  buffer_load_dwordx4 v10, s[20:23], s6 offen offset:1024 sc1 lds
  v_mfma_f32_16x16x32_bf16 v[96:99], v[128:131], a[40:43], v[96:99]
  v_mfma_f32_16x16x32_bf16 v[44:47], v[132:135], a[32:35], v[44:47]
  buffer_load_dwordx4 v10, s[20:23], s6 offen offset:2048 sc1 lds
  v_mfma_f32_16x16x32_bf16 v[100:103], v[132:135], a[40:43], v[100:103]
  v_mfma_f32_16x16x32_bf16 v[72:75], v[136:139], a[32:35], v[72:75]
  buffer_load_dwordx4 v10, s[20:23], s6 offen offset:3072 sc1 lds
  v_mfma_f32_16x16x32_bf16 v[104:107], v[136:139], a[40:43], v[104:107]
  s_waitcnt vmcnt(16) lgkmcnt(0)
  s_barrier
  v_mfma_f32_16x16x32_bf16 v[16:19], v[140:143], a[36:39], v[16:19]
  ds_read_b64_tr_b16 v[108:109], v14 offset:32768
  ds_read_b64_tr_b16 v[110:111], v15 offset:32768
  v_mfma_f32_16x16x32_bf16 v[76:79], v[140:143], a[44:47], v[76:79]
  ds_read_b64_tr_b16 v[112:113], v14 offset:34816
  ds_read_b64_tr_b16 v[114:115], v15 offset:34816
  v_mfma_f32_16x16x32_bf16 v[20:23], v[144:147], a[36:39], v[20:23]
  ds_read_b64_tr_b16 v[116:117], v14 offset:36864
  ds_read_b64_tr_b16 v[118:119], v15 offset:36864
  v_mfma_f32_16x16x32_bf16 v[80:83], v[144:147], a[44:47], v[80:83]
  ds_read_b64_tr_b16 v[120:121], v14 offset:38912
  ds_read_b64_tr_b16 v[122:123], v15 offset:38912
  v_mfma_f32_16x16x32_bf16 v[28:31], v[148:151], a[36:39], v[28:31]
  ds_read_b64_tr_b16 v[124:125], v14 offset:40960
  ds_read_b64_tr_b16 v[126:127], v15 offset:40960
  v_mfma_f32_16x16x32_bf16 v[84:87], v[148:151], a[44:47], v[84:87]
  ds_read_b64_tr_b16 v[128:129], v14 offset:43008
  ds_read_b64_tr_b16 v[130:131], v15 offset:43008
  v_mfma_f32_16x16x32_bf16 v[32:35], v[152:155], a[36:39], v[32:35]
  ds_read_b64_tr_b16 v[132:133], v14 offset:45056
  ds_read_b64_tr_b16 v[134:135], v15 offset:45056
  v_mfma_f32_16x16x32_bf16 v[88:91], v[152:155], a[44:47], v[88:91]
  ds_read_b64_tr_b16 v[136:137], v14 offset:47104
  ds_read_b64_tr_b16 v[138:139], v15 offset:47104
  v_mfma_f32_16x16x32_bf16 v[36:39], v[156:159], a[36:39], v[36:39]
  s_add_u32 m0, s9, 36864
  s_nop 0
  buffer_load_dwordx4 v11, s[20:23], s6 offen offset:0 sc1 lds
  v_mfma_f32_16x16x32_bf16 v[92:95], v[156:159], a[44:47], v[92:95]
  s_cmp_lg_u32 s3, 0
  s_cbranch_scc1 gated_mix__spectral_gfnet__ssm_conv_s5__prompt_kernel_skip36
  s_mov_b64 exec, 1
  buffer_store_dword v7, v24, s[48:51], s4 offen sc1
  s_mov_b64 exec, -1
gated_mix__spectral_gfnet__ssm_conv_s5__prompt_kernel_skip36:
  v_mfma_f32_16x16x32_bf16 v[40:43], v[160:163], a[36:39], v[40:43]
  buffer_load_dwordx4 v11, s[20:23], s6 offen offset:1024 sc1 lds
  v_mfma_f32_16x16x32_bf16 v[96:99], v[160:163], a[44:47], v[96:99]
  v_mfma_f32_16x16x32_bf16 v[44:47], v[164:167], a[36:39], v[44:47]
  buffer_load_dwordx4 v11, s[20:23], s6 offen offset:2048 sc1 lds
  v_mfma_f32_16x16x32_bf16 v[100:103], v[164:167], a[44:47], v[100:103]
  v_mfma_f32_16x16x32_bf16 v[72:75], v[168:171], a[36:39], v[72:75]
  buffer_load_dwordx4 v11, s[20:23], s6 offen offset:3072 sc1 lds
  s_add_u32 s6, s6, 32768
  s_and_b32 s6, s6, 0x7ffff
  v_mfma_f32_16x16x32_bf16 v[104:107], v[168:171], a[44:47], v[104:107]
  s_add_u32 m0, s8, 131072
  s_nop 0
  buffer_load_dwordx4 v48, s[68:71], s7 offen offset:0 lds
  buffer_load_dwordx4 v49, s[68:71], s7 offen offset:1024 lds
  buffer_load_dwordx4 v50, s[68:71], s7 offen offset:2048 lds
  buffer_load_dwordx4 v51, s[68:71], s7 offen offset:3072 lds
  s_add_u32 s7, s7, 128
  s_and_b32 s7, s7, 0x7ff
  s_waitcnt lgkmcnt(0)
  v_mfma_f32_16x16x32_bf16 v[16:19], v[108:111], a[48:51], v[16:19]
  ds_read_b64_tr_b16 v[140:141], v14 offset:33024
  ds_read_b64_tr_b16 v[142:143], v15 offset:33024
  v_mfma_f32_16x16x32_bf16 v[76:79], v[108:111], a[56:59], v[76:79]
  ds_read_b64_tr_b16 v[144:145], v14 offset:35072
  ds_read_b64_tr_b16 v[146:147], v15 offset:35072
  v_mfma_f32_16x16x32_bf16 v[20:23], v[112:115], a[48:51], v[20:23]
  ds_read_b64_tr_b16 v[148:149], v14 offset:37120
  ds_read_b64_tr_b16 v[150:151], v15 offset:37120
  v_mfma_f32_16x16x32_bf16 v[80:83], v[112:115], a[56:59], v[80:83]
  ds_read_b64_tr_b16 v[152:153], v14 offset:39168
  ds_read_b64_tr_b16 v[154:155], v15 offset:39168
  v_mfma_f32_16x16x32_bf16 v[28:31], v[116:119], a[48:51], v[28:31]
  ds_read_b64_tr_b16 v[156:157], v14 offset:41216
  ds_read_b64_tr_b16 v[158:159], v15 offset:41216
  v_mfma_f32_16x16x32_bf16 v[84:87], v[116:119], a[56:59], v[84:87]
  ds_read_b64_tr_b16 v[160:161], v14 offset:43264
  ds_read_b64_tr_b16 v[162:163], v15 offset:43264
  v_mfma_f32_16x16x32_bf16 v[32:35], v[120:123], a[48:51], v[32:35]
  ds_read_b64_tr_b16 v[164:165], v14 offset:45312
  ds_read_b64_tr_b16 v[166:167], v15 offset:45312
  v_mfma_f32_16x16x32_bf16 v[88:91], v[120:123], a[56:59], v[88:91]
  ds_read_b64_tr_b16 v[168:169], v14 offset:47360
  ds_read_b64_tr_b16 v[170:171], v15 offset:47360
  v_mfma_f32_16x16x32_bf16 v[36:39], v[124:127], a[48:51], v[36:39]
  s_add_u32 m0, s9, 65536
  s_nop 0
  buffer_load_dwordx4 v10, s[20:23], s6 offen offset:0 sc1 lds
  v_mfma_f32_16x16x32_bf16 v[92:95], v[124:127], a[56:59], v[92:95]
  v_mfma_f32_16x16x32_bf16 v[40:43], v[128:131], a[48:51], v[40:43]
  buffer_load_dwordx4 v10, s[20:23], s6 offen offset:1024 sc1 lds
  v_mfma_f32_16x16x32_bf16 v[96:99], v[128:131], a[56:59], v[96:99]
  v_mfma_f32_16x16x32_bf16 v[44:47], v[132:135], a[48:51], v[44:47]
  buffer_load_dwordx4 v10, s[20:23], s6 offen offset:2048 sc1 lds
  v_mfma_f32_16x16x32_bf16 v[100:103], v[132:135], a[56:59], v[100:103]
  v_mfma_f32_16x16x32_bf16 v[72:75], v[136:139], a[48:51], v[72:75]
  buffer_load_dwordx4 v10, s[20:23], s6 offen offset:3072 sc1 lds
  v_mfma_f32_16x16x32_bf16 v[104:107], v[136:139], a[56:59], v[104:107]
  v_add_u32 v54, 0x10000, v54
  v_add_u32 v55, 0x10000, v55
  s_waitcnt vmcnt(16)
  ds_read_b128 a[224:227], v54 offset:16384
  ds_read_b128 a[228:231], v55 offset:16384
  ds_read_b128 a[232:235], v54 offset:18432
  ds_read_b128 a[236:239], v55 offset:18432
  s_waitcnt lgkmcnt(4)
  s_barrier
  v_mfma_f32_16x16x32_bf16 v[16:19], v[140:143], a[52:55], v[16:19]
  ds_read_b64_tr_b16 v[108:109], v12 offset:0
  ds_read_b64_tr_b16 v[110:111], v13 offset:0
  v_mfma_f32_16x16x32_bf16 v[76:79], v[140:143], a[60:63], v[76:79]
  ds_read_b64_tr_b16 v[112:113], v12 offset:2048
  ds_read_b64_tr_b16 v[114:115], v13 offset:2048
  v_mfma_f32_16x16x32_bf16 v[20:23], v[144:147], a[52:55], v[20:23]
  ds_read_b64_tr_b16 v[116:117], v12 offset:4096
  ds_read_b64_tr_b16 v[118:119], v13 offset:4096
  v_mfma_f32_16x16x32_bf16 v[80:83], v[144:147], a[60:63], v[80:83]
  ds_read_b64_tr_b16 v[120:121], v12 offset:6144
  ds_read_b64_tr_b16 v[122:123], v13 offset:6144
  v_mfma_f32_16x16x32_bf16 v[28:31], v[148:151], a[52:55], v[28:31]
  ds_read_b64_tr_b16 v[124:125], v12 offset:8192
  ds_read_b64_tr_b16 v[126:127], v13 offset:8192
  v_mfma_f32_16x16x32_bf16 v[84:87], v[148:151], a[60:63], v[84:87]
  ds_read_b64_tr_b16 v[128:129], v12 offset:10240
  ds_read_b64_tr_b16 v[130:131], v13 offset:10240
  v_mfma_f32_16x16x32_bf16 v[32:35], v[152:155], a[52:55], v[32:35]
  ds_read_b64_tr_b16 v[132:133], v12 offset:12288
  ds_read_b64_tr_b16 v[134:135], v13 offset:12288
  v_mfma_f32_16x16x32_bf16 v[88:91], v[152:155], a[60:63], v[88:91]
  ds_read_b64_tr_b16 v[136:137], v12 offset:14336
  ds_read_b64_tr_b16 v[138:139], v13 offset:14336
  v_mfma_f32_16x16x32_bf16 v[36:39], v[156:159], a[52:55], v[36:39]
  s_add_u32 m0, s9, 69632
  s_nop 0
  buffer_load_dwordx4 v11, s[20:23], s6 offen offset:0 sc1 lds
  v_mfma_f32_16x16x32_bf16 v[92:95], v[156:159], a[60:63], v[92:95]
  v_mfma_f32_16x16x32_bf16 v[40:43], v[160:163], a[52:55], v[40:43]
  buffer_load_dwordx4 v11, s[20:23], s6 offen offset:1024 sc1 lds
  v_mfma_f32_16x16x32_bf16 v[96:99], v[160:163], a[60:63], v[96:99]
  v_mfma_f32_16x16x32_bf16 v[44:47], v[164:167], a[52:55], v[44:47]
  buffer_load_dwordx4 v11, s[20:23], s6 offen offset:2048 sc1 lds
  v_mfma_f32_16x16x32_bf16 v[100:103], v[164:167], a[60:63], v[100:103]
  v_mfma_f32_16x16x32_bf16 v[72:75], v[168:171], a[52:55], v[72:75]
  buffer_load_dwordx4 v11, s[20:23], s6 offen offset:3072 sc1 lds
  s_add_u32 s6, s6, 32768
  s_and_b32 s6, s6, 0x7ffff
  v_mfma_f32_16x16x32_bf16 v[104:107], v[168:171], a[60:63], v[104:107]
  s_waitcnt lgkmcnt(0)
  v_mfma_f32_16x16x32_bf16 v[16:19], v[108:111], a[64:67], v[16:19]
  ds_read_b64_tr_b16 v[140:141], v12 offset:256
  ds_read_b64_tr_b16 v[142:143], v13 offset:256
  v_mfma_f32_16x16x32_bf16 v[76:79], v[108:111], a[72:75], v[76:79]
  ds_read_b64_tr_b16 v[144:145], v12 offset:2304
  ds_read_b64_tr_b16 v[146:147], v13 offset:2304
  v_mfma_f32_16x16x32_bf16 v[20:23], v[112:115], a[64:67], v[20:23]
  ds_read_b64_tr_b16 v[148:149], v12 offset:4352
  ds_read_b64_tr_b16 v[150:151], v13 offset:4352
  v_mfma_f32_16x16x32_bf16 v[80:83], v[112:115], a[72:75], v[80:83]
  ds_read_b64_tr_b16 v[152:153], v12 offset:6400
  ds_read_b64_tr_b16 v[154:155], v13 offset:6400
  v_mfma_f32_16x16x32_bf16 v[28:31], v[116:119], a[64:67], v[28:31]
  ds_read_b64_tr_b16 v[156:157], v12 offset:8448
  ds_read_b64_tr_b16 v[158:159], v13 offset:8448
  v_mfma_f32_16x16x32_bf16 v[84:87], v[116:119], a[72:75], v[84:87]
  ds_read_b64_tr_b16 v[160:161], v12 offset:10496
  ds_read_b64_tr_b16 v[162:163], v13 offset:10496
  v_mfma_f32_16x16x32_bf16 v[32:35], v[120:123], a[64:67], v[32:35]
  ds_read_b64_tr_b16 v[164:165], v12 offset:12544
  ds_read_b64_tr_b16 v[166:167], v13 offset:12544
  v_mfma_f32_16x16x32_bf16 v[88:91], v[120:123], a[72:75], v[88:91]
  ds_read_b64_tr_b16 v[168:169], v12 offset:14592
  ds_read_b64_tr_b16 v[170:171], v13 offset:14592
  v_mfma_f32_16x16x32_bf16 v[36:39], v[124:127], a[64:67], v[36:39]
  s_add_u32 m0, s9, 98304
  s_nop 0
  buffer_load_dwordx4 v10, s[20:23], s6 offen offset:0 sc1 lds
  v_mfma_f32_16x16x32_bf16 v[92:95], v[124:127], a[72:75], v[92:95]
  v_mfma_f32_16x16x32_bf16 v[40:43], v[128:131], a[64:67], v[40:43]
  buffer_load_dwordx4 v10, s[20:23], s6 offen offset:1024 sc1 lds
  v_mfma_f32_16x16x32_bf16 v[96:99], v[128:131], a[72:75], v[96:99]
  v_mfma_f32_16x16x32_bf16 v[44:47], v[132:135], a[64:67], v[44:47]
  buffer_load_dwordx4 v10, s[20:23], s6 offen offset:2048 sc1 lds
  v_mfma_f32_16x16x32_bf16 v[100:103], v[132:135], a[72:75], v[100:103]
  v_mfma_f32_16x16x32_bf16 v[72:75], v[136:139], a[64:67], v[72:75]
  buffer_load_dwordx4 v10, s[20:23], s6 offen offset:3072 sc1 lds
  v_mfma_f32_16x16x32_bf16 v[104:107], v[136:139], a[72:75], v[104:107]
  s_waitcnt vmcnt(12)
  ds_read_b128 a[240:243], v54 offset:0
  ds_read_b128 a[244:247], v55 offset:0
  ds_read_b128 a[248:251], v54 offset:2048
  ds_read_b128 a[252:255], v55 offset:2048
  s_waitcnt lgkmcnt(4)
  s_barrier
  v_mfma_f32_16x16x32_bf16 v[16:19], v[140:143], a[68:71], v[16:19]
  ds_read_b64_tr_b16 v[108:109], v12 offset:32768
  ds_read_b64_tr_b16 v[110:111], v13 offset:32768
  v_mfma_f32_16x16x32_bf16 v[76:79], v[140:143], a[76:79], v[76:79]
  ds_read_b64_tr_b16 v[112:113], v12 offset:34816
  ds_read_b64_tr_b16 v[114:115], v13 offset:34816
  v_mfma_f32_16x16x32_bf16 v[20:23], v[144:147], a[68:71], v[20:23]
  ds_read_b64_tr_b16 v[116:117], v12 offset:36864
  ds_read_b64_tr_b16 v[118:119], v13 offset:36864
  v_mfma_f32_16x16x32_bf16 v[80:83], v[144:147], a[76:79], v[80:83]
  ds_read_b64_tr_b16 v[120:121], v12 offset:38912
  ds_read_b64_tr_b16 v[122:123], v13 offset:38912
  v_mfma_f32_16x16x32_bf16 v[28:31], v[148:151], a[68:71], v[28:31]
  ds_read_b64_tr_b16 v[124:125], v12 offset:40960
  ds_read_b64_tr_b16 v[126:127], v13 offset:40960
  v_mfma_f32_16x16x32_bf16 v[84:87], v[148:151], a[76:79], v[84:87]
  ds_read_b64_tr_b16 v[128:129], v12 offset:43008
  ds_read_b64_tr_b16 v[130:131], v13 offset:43008
  v_mfma_f32_16x16x32_bf16 v[32:35], v[152:155], a[68:71], v[32:35]
  ds_read_b64_tr_b16 v[132:133], v12 offset:45056
  ds_read_b64_tr_b16 v[134:135], v13 offset:45056
  v_mfma_f32_16x16x32_bf16 v[88:91], v[152:155], a[76:79], v[88:91]
  ds_read_b64_tr_b16 v[136:137], v12 offset:47104
  ds_read_b64_tr_b16 v[138:139], v13 offset:47104
  v_mfma_f32_16x16x32_bf16 v[36:39], v[156:159], a[68:71], v[36:39]
  s_add_u32 m0, s9, 102400
  s_nop 0
  buffer_load_dwordx4 v11, s[20:23], s6 offen offset:0 sc1 lds
  v_mfma_f32_16x16x32_bf16 v[92:95], v[156:159], a[76:79], v[92:95]
  v_mfma_f32_16x16x32_bf16 v[40:43], v[160:163], a[68:71], v[40:43]
  buffer_load_dwordx4 v11, s[20:23], s6 offen offset:1024 sc1 lds
  v_mfma_f32_16x16x32_bf16 v[96:99], v[160:163], a[76:79], v[96:99]
  v_mfma_f32_16x16x32_bf16 v[44:47], v[164:167], a[68:71], v[44:47]
  buffer_load_dwordx4 v11, s[20:23], s6 offen offset:2048 sc1 lds
  v_mfma_f32_16x16x32_bf16 v[100:103], v[164:167], a[76:79], v[100:103]
  v_mfma_f32_16x16x32_bf16 v[72:75], v[168:171], a[68:71], v[72:75]
  buffer_load_dwordx4 v11, s[20:23], s6 offen offset:3072 sc1 lds
  s_add_u32 s6, s6, 32768
  s_and_b32 s6, s6, 0x7ffff
  v_mfma_f32_16x16x32_bf16 v[104:107], v[168:171], a[76:79], v[104:107]
  s_waitcnt lgkmcnt(0)
  v_mfma_f32_16x16x32_bf16 v[16:19], v[108:111], a[80:83], v[16:19]
  ds_read_b64_tr_b16 v[140:141], v12 offset:33024
  ds_read_b64_tr_b16 v[142:143], v13 offset:33024
  v_mfma_f32_16x16x32_bf16 v[76:79], v[108:111], a[88:91], v[76:79]
  ds_read_b64_tr_b16 v[144:145], v12 offset:35072
  ds_read_b64_tr_b16 v[146:147], v13 offset:35072
  v_mfma_f32_16x16x32_bf16 v[20:23], v[112:115], a[80:83], v[20:23]
  ds_read_b64_tr_b16 v[148:149], v12 offset:37120
  ds_read_b64_tr_b16 v[150:151], v13 offset:37120
  v_mfma_f32_16x16x32_bf16 v[80:83], v[112:115], a[88:91], v[80:83]
  ds_read_b64_tr_b16 v[152:153], v12 offset:39168
  ds_read_b64_tr_b16 v[154:155], v13 offset:39168
  v_mfma_f32_16x16x32_bf16 v[28:31], v[116:119], a[80:83], v[28:31]
  ds_read_b64_tr_b16 v[156:157], v12 offset:41216
  ds_read_b64_tr_b16 v[158:159], v13 offset:41216
  v_mfma_f32_16x16x32_bf16 v[84:87], v[116:119], a[88:91], v[84:87]
  ds_read_b64_tr_b16 v[160:161], v12 offset:43264
  ds_read_b64_tr_b16 v[162:163], v13 offset:43264
  v_mfma_f32_16x16x32_bf16 v[32:35], v[120:123], a[80:83], v[32:35]
  ds_read_b64_tr_b16 v[164:165], v12 offset:45312
  ds_read_b64_tr_b16 v[166:167], v13 offset:45312
  v_mfma_f32_16x16x32_bf16 v[88:91], v[120:123], a[88:91], v[88:91]
  ds_read_b64_tr_b16 v[168:169], v12 offset:47360
  ds_read_b64_tr_b16 v[170:171], v13 offset:47360
  v_mfma_f32_16x16x32_bf16 v[36:39], v[124:127], a[80:83], v[36:39]
  s_add_u32 m0, s9, 0
  s_nop 0
  buffer_load_dwordx4 v10, s[20:23], s6 offen offset:0 sc1 lds
  v_mfma_f32_16x16x32_bf16 v[92:95], v[124:127], a[88:91], v[92:95]
  v_mfma_f32_16x16x32_bf16 v[40:43], v[128:131], a[80:83], v[40:43]
  buffer_load_dwordx4 v10, s[20:23], s6 offen offset:1024 sc1 lds
  v_mfma_f32_16x16x32_bf16 v[96:99], v[128:131], a[88:91], v[96:99]
  v_mfma_f32_16x16x32_bf16 v[44:47], v[132:135], a[80:83], v[44:47]
  buffer_load_dwordx4 v10, s[20:23], s6 offen offset:2048 sc1 lds
  v_mfma_f32_16x16x32_bf16 v[100:103], v[132:135], a[88:91], v[100:103]
  v_mfma_f32_16x16x32_bf16 v[72:75], v[136:139], a[80:83], v[72:75]
  buffer_load_dwordx4 v10, s[20:23], s6 offen offset:3072 sc1 lds
  v_mfma_f32_16x16x32_bf16 v[104:107], v[136:139], a[88:91], v[104:107]
  s_waitcnt vmcnt(12) lgkmcnt(0)
  s_barrier
  v_mfma_f32_16x16x32_bf16 v[16:19], v[140:143], a[84:87], v[16:19]
  ds_read_b64_tr_b16 v[108:109], v14 offset:0
  ds_read_b64_tr_b16 v[110:111], v15 offset:0
  v_mfma_f32_16x16x32_bf16 v[76:79], v[140:143], a[92:95], v[76:79]
  ds_read_b64_tr_b16 v[112:113], v14 offset:2048
  ds_read_b64_tr_b16 v[114:115], v15 offset:2048
  v_mfma_f32_16x16x32_bf16 v[20:23], v[144:147], a[84:87], v[20:23]
  ds_read_b64_tr_b16 v[116:117], v14 offset:4096
  ds_read_b64_tr_b16 v[118:119], v15 offset:4096
  v_mfma_f32_16x16x32_bf16 v[80:83], v[144:147], a[92:95], v[80:83]
  ds_read_b64_tr_b16 v[120:121], v14 offset:6144
  ds_read_b64_tr_b16 v[122:123], v15 offset:6144
  v_mfma_f32_16x16x32_bf16 v[28:31], v[148:151], a[84:87], v[28:31]
  ds_read_b64_tr_b16 v[124:125], v14 offset:8192
  ds_read_b64_tr_b16 v[126:127], v15 offset:8192
  v_mfma_f32_16x16x32_bf16 v[84:87], v[148:151], a[92:95], v[84:87]
  ds_read_b64_tr_b16 v[128:129], v14 offset:10240
  ds_read_b64_tr_b16 v[130:131], v15 offset:10240
  v_mfma_f32_16x16x32_bf16 v[32:35], v[152:155], a[84:87], v[32:35]
  ds_read_b64_tr_b16 v[132:133], v14 offset:12288
  ds_read_b64_tr_b16 v[134:135], v15 offset:12288
  v_mfma_f32_16x16x32_bf16 v[88:91], v[152:155], a[92:95], v[88:91]
  ds_read_b64_tr_b16 v[136:137], v14 offset:14336
  ds_read_b64_tr_b16 v[138:139], v15 offset:14336
  v_mfma_f32_16x16x32_bf16 v[36:39], v[156:159], a[84:87], v[36:39]
  s_add_u32 m0, s9, 4096
  s_nop 0
  buffer_load_dwordx4 v11, s[20:23], s6 offen offset:0 sc1 lds
  v_mfma_f32_16x16x32_bf16 v[92:95], v[156:159], a[92:95], v[92:95]
  s_cmp_lg_u32 s3, 1
  s_cbranch_scc1 gated_mix__spectral_gfnet__ssm_conv_s5__prompt_kernel_skip38
  s_getpc_b64 s[16:17]
gated_mix__spectral_gfnet__ssm_conv_s5__prompt_kernel_pc37:
  s_lshr_b32 s7, s2, 3
  s_mul_i32 s7, s7, 384
  v_min_u32 v48, 2, v4
  v_lshl_add_u32 v48, v48, 7, s7
  v_min_u32 v48, gated_mix__spectral_gfnet__ssm_conv_s5__prompt_kernel_end-gated_mix__spectral_gfnet__ssm_conv_s5__prompt_kernel_pc37, v48
  v_mov_b32 v49, 0
  v_lshl_add_u64 v[48:49], v[48:49], 0, s[16:17]
  global_load_dword v1, v[48:49], off
gated_mix__spectral_gfnet__ssm_conv_s5__prompt_kernel_skip38:
  v_mfma_f32_16x16x32_bf16 v[40:43], v[160:163], a[84:87], v[40:43]
  buffer_load_dwordx4 v11, s[20:23], s6 offen offset:1024 sc1 lds
  v_mfma_f32_16x16x32_bf16 v[96:99], v[160:163], a[92:95], v[96:99]
  v_mfma_f32_16x16x32_bf16 v[44:47], v[164:167], a[84:87], v[44:47]
  buffer_load_dwordx4 v11, s[20:23], s6 offen offset:2048 sc1 lds
  v_mfma_f32_16x16x32_bf16 v[100:103], v[164:167], a[92:95], v[100:103]
  v_mfma_f32_16x16x32_bf16 v[72:75], v[168:171], a[84:87], v[72:75]
  buffer_load_dwordx4 v11, s[20:23], s6 offen offset:3072 sc1 lds
  s_add_u32 s6, s6, 32768
  s_and_b32 s6, s6, 0x7ffff
  v_mfma_f32_16x16x32_bf16 v[104:107], v[168:171], a[92:95], v[104:107]
  s_waitcnt lgkmcnt(0)
  v_mfma_f32_16x16x32_bf16 v[16:19], v[108:111], a[96:99], v[16:19]
  ds_read_b64_tr_b16 v[140:141], v14 offset:256
  ds_read_b64_tr_b16 v[142:143], v15 offset:256
  v_mfma_f32_16x16x32_bf16 v[76:79], v[108:111], a[104:107], v[76:79]
  ds_read_b64_tr_b16 v[144:145], v14 offset:2304
  ds_read_b64_tr_b16 v[146:147], v15 offset:2304
  v_mfma_f32_16x16x32_bf16 v[20:23], v[112:115], a[96:99], v[20:23]
  ds_read_b64_tr_b16 v[148:149], v14 offset:4352
  ds_read_b64_tr_b16 v[150:151], v15 offset:4352
  v_mfma_f32_16x16x32_bf16 v[80:83], v[112:115], a[104:107], v[80:83]
  ds_read_b64_tr_b16 v[152:153], v14 offset:6400
  ds_read_b64_tr_b16 v[154:155], v15 offset:6400
  v_mfma_f32_16x16x32_bf16 v[28:31], v[116:119], a[96:99], v[28:31]
  ds_read_b64_tr_b16 v[156:157], v14 offset:8448
  ds_read_b64_tr_b16 v[158:159], v15 offset:8448
  v_mfma_f32_16x16x32_bf16 v[84:87], v[116:119], a[104:107], v[84:87]
  ds_read_b64_tr_b16 v[160:161], v14 offset:10496
  ds_read_b64_tr_b16 v[162:163], v15 offset:10496
  v_mfma_f32_16x16x32_bf16 v[32:35], v[120:123], a[96:99], v[32:35]
  ds_read_b64_tr_b16 v[164:165], v14 offset:12544
  ds_read_b64_tr_b16 v[166:167], v15 offset:12544
  v_mfma_f32_16x16x32_bf16 v[88:91], v[120:123], a[104:107], v[88:91]
  ds_read_b64_tr_b16 v[168:169], v14 offset:14592
  ds_read_b64_tr_b16 v[170:171], v15 offset:14592
  v_mfma_f32_16x16x32_bf16 v[36:39], v[124:127], a[96:99], v[36:39]
  s_add_u32 m0, s9, 32768
  s_nop 0
  buffer_load_dwordx4 v10, s[20:23], s6 offen offset:0 sc1 lds
  v_mfma_f32_16x16x32_bf16 v[92:95], v[124:127], a[104:107], v[92:95]
  v_mfma_f32_16x16x32_bf16 v[40:43], v[128:131], a[96:99], v[40:43]
  buffer_load_dwordx4 v10, s[20:23], s6 offen offset:1024 sc1 lds
  v_mfma_f32_16x16x32_bf16 v[96:99], v[128:131], a[104:107], v[96:99]
  v_mfma_f32_16x16x32_bf16 v[44:47], v[132:135], a[96:99], v[44:47]
  buffer_load_dwordx4 v10, s[20:23], s6 offen offset:2048 sc1 lds
  v_mfma_f32_16x16x32_bf16 v[100:103], v[132:135], a[104:107], v[100:103]
  v_mfma_f32_16x16x32_bf16 v[72:75], v[136:139], a[96:99], v[72:75]
  buffer_load_dwordx4 v10, s[20:23], s6 offen offset:3072 sc1 lds
  v_mfma_f32_16x16x32_bf16 v[104:107], v[136:139], a[104:107], v[104:107]
  s_waitcnt vmcnt(12) lgkmcnt(0)
  s_barrier
  v_mfma_f32_16x16x32_bf16 v[16:19], v[140:143], a[100:103], v[16:19]
  ds_read_b64_tr_b16 v[108:109], v14 offset:32768
  ds_read_b64_tr_b16 v[110:111], v15 offset:32768
  v_mfma_f32_16x16x32_bf16 v[76:79], v[140:143], a[108:111], v[76:79]
  ds_read_b64_tr_b16 v[112:113], v14 offset:34816
  ds_read_b64_tr_b16 v[114:115], v15 offset:34816
  v_mfma_f32_16x16x32_bf16 v[20:23], v[144:147], a[100:103], v[20:23]
  ds_read_b64_tr_b16 v[116:117], v14 offset:36864
  ds_read_b64_tr_b16 v[118:119], v15 offset:36864
  v_mfma_f32_16x16x32_bf16 v[80:83], v[144:147], a[108:111], v[80:83]
  ds_read_b64_tr_b16 v[120:121], v14 offset:38912
  ds_read_b64_tr_b16 v[122:123], v15 offset:38912
  v_mfma_f32_16x16x32_bf16 v[28:31], v[148:151], a[100:103], v[28:31]
  ds_read_b64_tr_b16 v[124:125], v14 offset:40960
  ds_read_b64_tr_b16 v[126:127], v15 offset:40960
  v_mfma_f32_16x16x32_bf16 v[84:87], v[148:151], a[108:111], v[84:87]
  ds_read_b64_tr_b16 v[128:129], v14 offset:43008
  ds_read_b64_tr_b16 v[130:131], v15 offset:43008
  v_mfma_f32_16x16x32_bf16 v[32:35], v[152:155], a[100:103], v[32:35]
  ds_read_b64_tr_b16 v[132:133], v14 offset:45056
  ds_read_b64_tr_b16 v[134:135], v15 offset:45056
  v_mfma_f32_16x16x32_bf16 v[88:91], v[152:155], a[108:111], v[88:91]
  ds_read_b64_tr_b16 v[136:137], v14 offset:47104
  ds_read_b64_tr_b16 v[138:139], v15 offset:47104
  v_mfma_f32_16x16x32_bf16 v[36:39], v[156:159], a[100:103], v[36:39]
  s_add_u32 m0, s9, 36864
  s_nop 0
  buffer_load_dwordx4 v11, s[20:23], s6 offen offset:0 sc1 lds
  v_mfma_f32_16x16x32_bf16 v[92:95], v[156:159], a[108:111], v[92:95]
  v_mfma_f32_16x16x32_bf16 v[40:43], v[160:163], a[100:103], v[40:43]
  buffer_load_dwordx4 v11, s[20:23], s6 offen offset:1024 sc1 lds
  v_mfma_f32_16x16x32_bf16 v[96:99], v[160:163], a[108:111], v[96:99]
  v_mfma_f32_16x16x32_bf16 v[44:47], v[164:167], a[100:103], v[44:47]
  buffer_load_dwordx4 v11, s[20:23], s6 offen offset:2048 sc1 lds
  v_mfma_f32_16x16x32_bf16 v[100:103], v[164:167], a[108:111], v[100:103]
  v_mfma_f32_16x16x32_bf16 v[72:75], v[168:171], a[100:103], v[72:75]
  buffer_load_dwordx4 v11, s[20:23], s6 offen offset:3072 sc1 lds
  s_add_u32 s6, s6, 32768
  s_and_b32 s6, s6, 0x7ffff
  v_mfma_f32_16x16x32_bf16 v[104:107], v[168:171], a[108:111], v[104:107]
  s_waitcnt lgkmcnt(0)
  v_mfma_f32_16x16x32_bf16 v[16:19], v[108:111], a[112:115], v[16:19]
  ds_read_b64_tr_b16 v[140:141], v14 offset:33024
  ds_read_b64_tr_b16 v[142:143], v15 offset:33024
  v_mfma_f32_16x16x32_bf16 v[76:79], v[108:111], a[120:123], v[76:79]
  ds_read_b64_tr_b16 v[144:145], v14 offset:35072
  ds_read_b64_tr_b16 v[146:147], v15 offset:35072
  v_mfma_f32_16x16x32_bf16 v[20:23], v[112:115], a[112:115], v[20:23]
  ds_read_b64_tr_b16 v[148:149], v14 offset:37120
  ds_read_b64_tr_b16 v[150:151], v15 offset:37120
  v_mfma_f32_16x16x32_bf16 v[80:83], v[112:115], a[120:123], v[80:83]
  ds_read_b64_tr_b16 v[152:153], v14 offset:39168
  ds_read_b64_tr_b16 v[154:155], v15 offset:39168
  v_mfma_f32_16x16x32_bf16 v[28:31], v[116:119], a[112:115], v[28:31]
  ds_read_b64_tr_b16 v[156:157], v14 offset:41216
  ds_read_b64_tr_b16 v[158:159], v15 offset:41216
  v_mfma_f32_16x16x32_bf16 v[84:87], v[116:119], a[120:123], v[84:87]
  ds_read_b64_tr_b16 v[160:161], v14 offset:43264
  ds_read_b64_tr_b16 v[162:163], v15 offset:43264
  v_mfma_f32_16x16x32_bf16 v[32:35], v[120:123], a[112:115], v[32:35]
  ds_read_b64_tr_b16 v[164:165], v14 offset:45312
  ds_read_b64_tr_b16 v[166:167], v15 offset:45312
  v_mfma_f32_16x16x32_bf16 v[88:91], v[120:123], a[120:123], v[88:91]
  ds_read_b64_tr_b16 v[168:169], v14 offset:47360
  ds_read_b64_tr_b16 v[170:171], v15 offset:47360
  v_mfma_f32_16x16x32_bf16 v[36:39], v[124:127], a[112:115], v[36:39]
  s_add_u32 m0, s9, 65536
  s_nop 0
  buffer_load_dwordx4 v10, s[20:23], s6 offen offset:0 sc1 lds
  v_mfma_f32_16x16x32_bf16 v[92:95], v[124:127], a[120:123], v[92:95]
  v_mfma_f32_16x16x32_bf16 v[40:43], v[128:131], a[112:115], v[40:43]
  buffer_load_dwordx4 v10, s[20:23], s6 offen offset:1024 sc1 lds
  v_mfma_f32_16x16x32_bf16 v[96:99], v[128:131], a[120:123], v[96:99]
  v_mfma_f32_16x16x32_bf16 v[44:47], v[132:135], a[112:115], v[44:47]
  buffer_load_dwordx4 v10, s[20:23], s6 offen offset:2048 sc1 lds
  v_mfma_f32_16x16x32_bf16 v[100:103], v[132:135], a[120:123], v[100:103]
  v_mfma_f32_16x16x32_bf16 v[72:75], v[136:139], a[112:115], v[72:75]
  buffer_load_dwordx4 v10, s[20:23], s6 offen offset:3072 sc1 lds
  v_mfma_f32_16x16x32_bf16 v[104:107], v[136:139], a[120:123], v[104:107]
  s_waitcnt vmcnt(12) lgkmcnt(0)
  s_barrier
  v_mfma_f32_16x16x32_bf16 v[16:19], v[140:143], a[116:119], v[16:19]
  ds_read_b64_tr_b16 v[108:109], v12 offset:0
  ds_read_b64_tr_b16 v[110:111], v13 offset:0
  v_mfma_f32_16x16x32_bf16 v[76:79], v[140:143], a[124:127], v[76:79]
  ds_read_b64_tr_b16 v[112:113], v12 offset:2048
  ds_read_b64_tr_b16 v[114:115], v13 offset:2048
  v_mfma_f32_16x16x32_bf16 v[20:23], v[144:147], a[116:119], v[20:23]
  ds_read_b64_tr_b16 v[116:117], v12 offset:4096
  ds_read_b64_tr_b16 v[118:119], v13 offset:4096
  v_mfma_f32_16x16x32_bf16 v[80:83], v[144:147], a[124:127], v[80:83]
  ds_read_b64_tr_b16 v[120:121], v12 offset:6144
  ds_read_b64_tr_b16 v[122:123], v13 offset:6144
  v_mfma_f32_16x16x32_bf16 v[28:31], v[148:151], a[116:119], v[28:31]
  ds_read_b64_tr_b16 v[124:125], v12 offset:8192
  ds_read_b64_tr_b16 v[126:127], v13 offset:8192
  v_mfma_f32_16x16x32_bf16 v[84:87], v[148:151], a[124:127], v[84:87]
  ds_read_b64_tr_b16 v[128:129], v12 offset:10240
  ds_read_b64_tr_b16 v[130:131], v13 offset:10240
  v_mfma_f32_16x16x32_bf16 v[32:35], v[152:155], a[116:119], v[32:35]
  ds_read_b64_tr_b16 v[132:133], v12 offset:12288
  ds_read_b64_tr_b16 v[134:135], v13 offset:12288
  v_mfma_f32_16x16x32_bf16 v[88:91], v[152:155], a[124:127], v[88:91]
  ds_read_b64_tr_b16 v[136:137], v12 offset:14336
  ds_read_b64_tr_b16 v[138:139], v13 offset:14336
  v_mfma_f32_16x16x32_bf16 v[36:39], v[156:159], a[116:119], v[36:39]
  s_add_u32 m0, s9, 69632
  s_nop 0
  buffer_load_dwordx4 v11, s[20:23], s6 offen offset:0 sc1 lds
  v_mfma_f32_16x16x32_bf16 v[92:95], v[156:159], a[124:127], v[92:95]
  v_mfma_f32_16x16x32_bf16 v[40:43], v[160:163], a[116:119], v[40:43]
  buffer_load_dwordx4 v11, s[20:23], s6 offen offset:1024 sc1 lds
  v_mfma_f32_16x16x32_bf16 v[96:99], v[160:163], a[124:127], v[96:99]
  v_mfma_f32_16x16x32_bf16 v[44:47], v[164:167], a[116:119], v[44:47]
  buffer_load_dwordx4 v11, s[20:23], s6 offen offset:2048 sc1 lds
  v_mfma_f32_16x16x32_bf16 v[100:103], v[164:167], a[124:127], v[100:103]
  v_mfma_f32_16x16x32_bf16 v[72:75], v[168:171], a[116:119], v[72:75]
  buffer_load_dwordx4 v11, s[20:23], s6 offen offset:3072 sc1 lds
  s_add_u32 s6, s6, 32768
  s_and_b32 s6, s6, 0x7ffff
  v_mfma_f32_16x16x32_bf16 v[104:107], v[168:171], a[124:127], v[104:107]
  s_waitcnt lgkmcnt(0)
  v_mfma_f32_16x16x32_bf16 v[16:19], v[108:111], a[128:131], v[16:19]
  ds_read_b64_tr_b16 v[140:141], v12 offset:256
  ds_read_b64_tr_b16 v[142:143], v13 offset:256
  v_mfma_f32_16x16x32_bf16 v[76:79], v[108:111], a[136:139], v[76:79]
  ds_read_b64_tr_b16 v[144:145], v12 offset:2304
  ds_read_b64_tr_b16 v[146:147], v13 offset:2304
  v_mfma_f32_16x16x32_bf16 v[20:23], v[112:115], a[128:131], v[20:23]
  ds_read_b64_tr_b16 v[148:149], v12 offset:4352
  ds_read_b64_tr_b16 v[150:151], v13 offset:4352
  v_mfma_f32_16x16x32_bf16 v[80:83], v[112:115], a[136:139], v[80:83]
  ds_read_b64_tr_b16 v[152:153], v12 offset:6400
  ds_read_b64_tr_b16 v[154:155], v13 offset:6400
  v_mfma_f32_16x16x32_bf16 v[28:31], v[116:119], a[128:131], v[28:31]
  ds_read_b64_tr_b16 v[156:157], v12 offset:8448
  ds_read_b64_tr_b16 v[158:159], v13 offset:8448
  v_mfma_f32_16x16x32_bf16 v[84:87], v[116:119], a[136:139], v[84:87]
  ds_read_b64_tr_b16 v[160:161], v12 offset:10496
  ds_read_b64_tr_b16 v[162:163], v13 offset:10496
  v_mfma_f32_16x16x32_bf16 v[32:35], v[120:123], a[128:131], v[32:35]
  ds_read_b64_tr_b16 v[164:165], v12 offset:12544
  ds_read_b64_tr_b16 v[166:167], v13 offset:12544
  v_mfma_f32_16x16x32_bf16 v[88:91], v[120:123], a[136:139], v[88:91]
  ds_read_b64_tr_b16 v[168:169], v12 offset:14592
  ds_read_b64_tr_b16 v[170:171], v13 offset:14592
  v_mfma_f32_16x16x32_bf16 v[36:39], v[124:127], a[128:131], v[36:39]
  s_add_u32 m0, s9, 98304
  s_nop 0
  buffer_load_dwordx4 v10, s[20:23], s6 offen offset:0 sc1 lds
  v_mfma_f32_16x16x32_bf16 v[92:95], v[124:127], a[136:139], v[92:95]
  v_mfma_f32_16x16x32_bf16 v[40:43], v[128:131], a[128:131], v[40:43]
  buffer_load_dwordx4 v10, s[20:23], s6 offen offset:1024 sc1 lds
  v_mfma_f32_16x16x32_bf16 v[96:99], v[128:131], a[136:139], v[96:99]
  v_mfma_f32_16x16x32_bf16 v[44:47], v[132:135], a[128:131], v[44:47]
  buffer_load_dwordx4 v10, s[20:23], s6 offen offset:2048 sc1 lds
  v_mfma_f32_16x16x32_bf16 v[100:103], v[132:135], a[136:139], v[100:103]
  v_mfma_f32_16x16x32_bf16 v[72:75], v[136:139], a[128:131], v[72:75]
  buffer_load_dwordx4 v10, s[20:23], s6 offen offset:3072 sc1 lds
  v_mfma_f32_16x16x32_bf16 v[104:107], v[136:139], a[136:139], v[104:107]
  s_waitcnt vmcnt(12) lgkmcnt(0)
  s_barrier
  v_mfma_f32_16x16x32_bf16 v[16:19], v[140:143], a[132:135], v[16:19]
  ds_read_b64_tr_b16 v[108:109], v12 offset:32768
  ds_read_b64_tr_b16 v[110:111], v13 offset:32768
  v_mfma_f32_16x16x32_bf16 v[76:79], v[140:143], a[140:143], v[76:79]
  ds_read_b64_tr_b16 v[112:113], v12 offset:34816
  ds_read_b64_tr_b16 v[114:115], v13 offset:34816
  v_mfma_f32_16x16x32_bf16 v[20:23], v[144:147], a[132:135], v[20:23]
  ds_read_b64_tr_b16 v[116:117], v12 offset:36864
  ds_read_b64_tr_b16 v[118:119], v13 offset:36864
  v_mfma_f32_16x16x32_bf16 v[80:83], v[144:147], a[140:143], v[80:83]
  ds_read_b64_tr_b16 v[120:121], v12 offset:38912
  ds_read_b64_tr_b16 v[122:123], v13 offset:38912
  v_mfma_f32_16x16x32_bf16 v[28:31], v[148:151], a[132:135], v[28:31]
  ds_read_b64_tr_b16 v[124:125], v12 offset:40960
  ds_read_b64_tr_b16 v[126:127], v13 offset:40960
  v_mfma_f32_16x16x32_bf16 v[84:87], v[148:151], a[140:143], v[84:87]
  ds_read_b64_tr_b16 v[128:129], v12 offset:43008
  ds_read_b64_tr_b16 v[130:131], v13 offset:43008
  v_mfma_f32_16x16x32_bf16 v[32:35], v[152:155], a[132:135], v[32:35]
  ds_read_b64_tr_b16 v[132:133], v12 offset:45056
  ds_read_b64_tr_b16 v[134:135], v13 offset:45056
  v_mfma_f32_16x16x32_bf16 v[88:91], v[152:155], a[140:143], v[88:91]
  ds_read_b64_tr_b16 v[136:137], v12 offset:47104
  ds_read_b64_tr_b16 v[138:139], v13 offset:47104
  v_mfma_f32_16x16x32_bf16 v[36:39], v[156:159], a[132:135], v[36:39]
  s_add_u32 m0, s9, 102400
  s_nop 0
  buffer_load_dwordx4 v11, s[20:23], s6 offen offset:0 sc1 lds
  v_mfma_f32_16x16x32_bf16 v[92:95], v[156:159], a[140:143], v[92:95]
  buffer_load_dword v27, v3, s[48:51], s4 offen sc1
  v_mfma_f32_16x16x32_bf16 v[40:43], v[160:163], a[132:135], v[40:43]
  buffer_load_dwordx4 v11, s[20:23], s6 offen offset:1024 sc1 lds
  v_mfma_f32_16x16x32_bf16 v[96:99], v[160:163], a[140:143], v[96:99]
  v_mfma_f32_16x16x32_bf16 v[44:47], v[164:167], a[132:135], v[44:47]
  buffer_load_dwordx4 v11, s[20:23], s6 offen offset:2048 sc1 lds
  v_mfma_f32_16x16x32_bf16 v[100:103], v[164:167], a[140:143], v[100:103]
  v_mfma_f32_16x16x32_bf16 v[72:75], v[168:171], a[132:135], v[72:75]
  buffer_load_dwordx4 v11, s[20:23], s6 offen offset:3072 sc1 lds
  s_add_u32 s6, s6, 32768
  s_and_b32 s6, s6, 0x7ffff
  v_mfma_f32_16x16x32_bf16 v[104:107], v[168:171], a[140:143], v[104:107]
  s_waitcnt lgkmcnt(0)
  v_mfma_f32_16x16x32_bf16 v[16:19], v[108:111], a[144:147], v[16:19]
  ds_read_b64_tr_b16 v[140:141], v12 offset:33024
  ds_read_b64_tr_b16 v[142:143], v13 offset:33024
  v_mfma_f32_16x16x32_bf16 v[76:79], v[108:111], a[152:155], v[76:79]
  ds_read_b64_tr_b16 v[144:145], v12 offset:35072
  ds_read_b64_tr_b16 v[146:147], v13 offset:35072
  v_mfma_f32_16x16x32_bf16 v[20:23], v[112:115], a[144:147], v[20:23]
  ds_read_b64_tr_b16 v[148:149], v12 offset:37120
  ds_read_b64_tr_b16 v[150:151], v13 offset:37120
  v_mfma_f32_16x16x32_bf16 v[80:83], v[112:115], a[152:155], v[80:83]
  ds_read_b64_tr_b16 v[152:153], v12 offset:39168
  ds_read_b64_tr_b16 v[154:155], v13 offset:39168
  v_mfma_f32_16x16x32_bf16 v[28:31], v[116:119], a[144:147], v[28:31]
  ds_read_b64_tr_b16 v[156:157], v12 offset:41216
  ds_read_b64_tr_b16 v[158:159], v13 offset:41216
  v_mfma_f32_16x16x32_bf16 v[84:87], v[116:119], a[152:155], v[84:87]
  ds_read_b64_tr_b16 v[160:161], v12 offset:43264
  ds_read_b64_tr_b16 v[162:163], v13 offset:43264
  v_mfma_f32_16x16x32_bf16 v[32:35], v[120:123], a[144:147], v[32:35]
  ds_read_b64_tr_b16 v[164:165], v12 offset:45312
  ds_read_b64_tr_b16 v[166:167], v13 offset:45312
  v_mfma_f32_16x16x32_bf16 v[88:91], v[120:123], a[152:155], v[88:91]
  ds_read_b64_tr_b16 v[168:169], v12 offset:47360
  ds_read_b64_tr_b16 v[170:171], v13 offset:47360
  v_mfma_f32_16x16x32_bf16 v[36:39], v[124:127], a[144:147], v[36:39]
  s_add_u32 m0, s9, 0
  s_nop 0
  buffer_load_dwordx4 v10, s[20:23], s6 offen offset:0 sc1 lds
  v_mfma_f32_16x16x32_bf16 v[92:95], v[124:127], a[152:155], v[92:95]
  v_mfma_f32_16x16x32_bf16 v[40:43], v[128:131], a[144:147], v[40:43]
  buffer_load_dwordx4 v10, s[20:23], s6 offen offset:1024 sc1 lds
  v_mfma_f32_16x16x32_bf16 v[96:99], v[128:131], a[152:155], v[96:99]
  v_mfma_f32_16x16x32_bf16 v[44:47], v[132:135], a[144:147], v[44:47]
  buffer_load_dwordx4 v10, s[20:23], s6 offen offset:2048 sc1 lds
  v_mfma_f32_16x16x32_bf16 v[100:103], v[132:135], a[152:155], v[100:103]
  v_mfma_f32_16x16x32_bf16 v[72:75], v[136:139], a[144:147], v[72:75]
  buffer_load_dwordx4 v10, s[20:23], s6 offen offset:3072 sc1 lds
  v_mfma_f32_16x16x32_bf16 v[104:107], v[136:139], a[152:155], v[104:107]
  s_waitcnt vmcnt(13) lgkmcnt(0)
  s_barrier
  v_mfma_f32_16x16x32_bf16 v[16:19], v[140:143], a[148:151], v[16:19]
  ds_read_b64_tr_b16 v[108:109], v14 offset:0
  ds_read_b64_tr_b16 v[110:111], v15 offset:0
  v_mfma_f32_16x16x32_bf16 v[76:79], v[140:143], a[156:159], v[76:79]
  ds_read_b64_tr_b16 v[112:113], v14 offset:2048
  ds_read_b64_tr_b16 v[114:115], v15 offset:2048
  v_mfma_f32_16x16x32_bf16 v[20:23], v[144:147], a[148:151], v[20:23]
  ds_read_b64_tr_b16 v[116:117], v14 offset:4096
  ds_read_b64_tr_b16 v[118:119], v15 offset:4096
  v_mfma_f32_16x16x32_bf16 v[80:83], v[144:147], a[156:159], v[80:83]
  ds_read_b64_tr_b16 v[120:121], v14 offset:6144
  ds_read_b64_tr_b16 v[122:123], v15 offset:6144
  v_mfma_f32_16x16x32_bf16 v[28:31], v[148:151], a[148:151], v[28:31]
  ds_read_b64_tr_b16 v[124:125], v14 offset:8192
  ds_read_b64_tr_b16 v[126:127], v15 offset:8192
  v_mfma_f32_16x16x32_bf16 v[84:87], v[148:151], a[156:159], v[84:87]
  ds_read_b64_tr_b16 v[128:129], v14 offset:10240
  ds_read_b64_tr_b16 v[130:131], v15 offset:10240
  v_mfma_f32_16x16x32_bf16 v[32:35], v[152:155], a[148:151], v[32:35]
  ds_read_b64_tr_b16 v[132:133], v14 offset:12288
  ds_read_b64_tr_b16 v[134:135], v15 offset:12288
  v_mfma_f32_16x16x32_bf16 v[88:91], v[152:155], a[156:159], v[88:91]
  ds_read_b64_tr_b16 v[136:137], v14 offset:14336
  ds_read_b64_tr_b16 v[138:139], v15 offset:14336
  v_mfma_f32_16x16x32_bf16 v[36:39], v[156:159], a[148:151], v[36:39]
  s_add_u32 m0, s9, 4096
  s_nop 0
  buffer_load_dwordx4 v11, s[20:23], s6 offen offset:0 sc1 lds
  v_mfma_f32_16x16x32_bf16 v[92:95], v[156:159], a[156:159], v[92:95]
  v_mfma_f32_16x16x32_bf16 v[40:43], v[160:163], a[148:151], v[40:43]
  buffer_load_dwordx4 v11, s[20:23], s6 offen offset:1024 sc1 lds
  v_mfma_f32_16x16x32_bf16 v[96:99], v[160:163], a[156:159], v[96:99]
  v_mfma_f32_16x16x32_bf16 v[44:47], v[164:167], a[148:151], v[44:47]
  buffer_load_dwordx4 v11, s[20:23], s6 offen offset:2048 sc1 lds
  v_mfma_f32_16x16x32_bf16 v[100:103], v[164:167], a[156:159], v[100:103]
  v_mfma_f32_16x16x32_bf16 v[72:75], v[168:171], a[148:151], v[72:75]
  buffer_load_dwordx4 v11, s[20:23], s6 offen offset:3072 sc1 lds
  s_add_u32 s6, s6, 32768
  s_and_b32 s6, s6, 0x7ffff
  v_mfma_f32_16x16x32_bf16 v[104:107], v[168:171], a[156:159], v[104:107]
  s_waitcnt lgkmcnt(0)
  v_mfma_f32_16x16x32_bf16 v[16:19], v[108:111], a[160:163], v[16:19]
  ds_read_b64_tr_b16 v[140:141], v14 offset:256
  ds_read_b64_tr_b16 v[142:143], v15 offset:256
  v_mfma_f32_16x16x32_bf16 v[76:79], v[108:111], a[168:171], v[76:79]
  ds_read_b64_tr_b16 v[144:145], v14 offset:2304
  ds_read_b64_tr_b16 v[146:147], v15 offset:2304
  v_mfma_f32_16x16x32_bf16 v[20:23], v[112:115], a[160:163], v[20:23]
  ds_read_b64_tr_b16 v[148:149], v14 offset:4352
  ds_read_b64_tr_b16 v[150:151], v15 offset:4352
  v_mfma_f32_16x16x32_bf16 v[80:83], v[112:115], a[168:171], v[80:83]
  ds_read_b64_tr_b16 v[152:153], v14 offset:6400
  ds_read_b64_tr_b16 v[154:155], v15 offset:6400
  v_mfma_f32_16x16x32_bf16 v[28:31], v[116:119], a[160:163], v[28:31]
  ds_read_b64_tr_b16 v[156:157], v14 offset:8448
  ds_read_b64_tr_b16 v[158:159], v15 offset:8448
  v_mfma_f32_16x16x32_bf16 v[84:87], v[116:119], a[168:171], v[84:87]
  ds_read_b64_tr_b16 v[160:161], v14 offset:10496
  ds_read_b64_tr_b16 v[162:163], v15 offset:10496
  v_mfma_f32_16x16x32_bf16 v[32:35], v[120:123], a[160:163], v[32:35]
  ds_read_b64_tr_b16 v[164:165], v14 offset:12544
  ds_read_b64_tr_b16 v[166:167], v15 offset:12544
  v_mfma_f32_16x16x32_bf16 v[88:91], v[120:123], a[168:171], v[88:91]
  ds_read_b64_tr_b16 v[168:169], v14 offset:14592
  ds_read_b64_tr_b16 v[170:171], v15 offset:14592
  v_mfma_f32_16x16x32_bf16 v[36:39], v[124:127], a[160:163], v[36:39]
  s_add_u32 m0, s9, 32768
  s_nop 0
  buffer_load_dwordx4 v10, s[20:23], s6 offen offset:0 sc1 lds
  v_mfma_f32_16x16x32_bf16 v[92:95], v[124:127], a[168:171], v[92:95]
  v_mfma_f32_16x16x32_bf16 v[40:43], v[128:131], a[160:163], v[40:43]
  buffer_load_dwordx4 v10, s[20:23], s6 offen offset:1024 sc1 lds
  v_mfma_f32_16x16x32_bf16 v[96:99], v[128:131], a[168:171], v[96:99]
  v_mfma_f32_16x16x32_bf16 v[44:47], v[132:135], a[160:163], v[44:47]
  buffer_load_dwordx4 v10, s[20:23], s6 offen offset:2048 sc1 lds
  v_mfma_f32_16x16x32_bf16 v[100:103], v[132:135], a[168:171], v[100:103]
  v_mfma_f32_16x16x32_bf16 v[72:75], v[136:139], a[160:163], v[72:75]
  buffer_load_dwordx4 v10, s[20:23], s6 offen offset:3072 sc1 lds
  v_mfma_f32_16x16x32_bf16 v[104:107], v[136:139], a[168:171], v[104:107]
  s_waitcnt vmcnt(15)
  v_cmp_ne_u32 vcc, 1, v27
  s_nop 0
  s_cbranch_vccz gated_mix__spectral_gfnet__ssm_conv_s5__prompt_kernel_skip39
  s_mov_b32 s7, 0
gated_mix__spectral_gfnet__ssm_conv_s5__prompt_kernel_poll40:
  s_sleep 2
  buffer_load_dword v27, v3, s[48:51], s4 offen sc1
  s_waitcnt vmcnt(0)
  v_cmp_ne_u32 vcc, 1, v27
  s_nop 0
  s_cbranch_vccz gated_mix__spectral_gfnet__ssm_conv_s5__prompt_kernel_pollout41
  s_add_u32 s7, s7, 1
  s_cmp_lt_u32 s7, 1048576
  s_cbranch_scc1 gated_mix__spectral_gfnet__ssm_conv_s5__prompt_kernel_poll40
gated_mix__spectral_gfnet__ssm_conv_s5__prompt_kernel_pollout41:
gated_mix__spectral_gfnet__ssm_conv_s5__prompt_kernel_skip39:
  s_waitcnt vmcnt(12) lgkmcnt(0)
  s_barrier
  v_mfma_f32_16x16x32_bf16 v[16:19], v[140:143], a[164:167], v[16:19]
  ds_read_b64_tr_b16 v[108:109], v14 offset:32768
  ds_read_b64_tr_b16 v[110:111], v15 offset:32768
  v_mfma_f32_16x16x32_bf16 v[76:79], v[140:143], a[172:175], v[76:79]
  ds_read_b64_tr_b16 v[112:113], v14 offset:34816
  ds_read_b64_tr_b16 v[114:115], v15 offset:34816
  v_mfma_f32_16x16x32_bf16 v[20:23], v[144:147], a[164:167], v[20:23]
  ds_read_b64_tr_b16 v[116:117], v14 offset:36864
  ds_read_b64_tr_b16 v[118:119], v15 offset:36864
  v_mfma_f32_16x16x32_bf16 v[80:83], v[144:147], a[172:175], v[80:83]
  ds_read_b64_tr_b16 v[120:121], v14 offset:38912
  ds_read_b64_tr_b16 v[122:123], v15 offset:38912
  v_mfma_f32_16x16x32_bf16 v[28:31], v[148:151], a[164:167], v[28:31]
  ds_read_b64_tr_b16 v[124:125], v14 offset:40960
  ds_read_b64_tr_b16 v[126:127], v15 offset:40960
  v_mfma_f32_16x16x32_bf16 v[84:87], v[148:151], a[172:175], v[84:87]
  ds_read_b64_tr_b16 v[128:129], v14 offset:43008
  ds_read_b64_tr_b16 v[130:131], v15 offset:43008
  v_mfma_f32_16x16x32_bf16 v[32:35], v[152:155], a[164:167], v[32:35]
  ds_read_b64_tr_b16 v[132:133], v14 offset:45056
  ds_read_b64_tr_b16 v[134:135], v15 offset:45056
  v_mfma_f32_16x16x32_bf16 v[88:91], v[152:155], a[172:175], v[88:91]
  ds_read_b64_tr_b16 v[136:137], v14 offset:47104
  ds_read_b64_tr_b16 v[138:139], v15 offset:47104
  v_mfma_f32_16x16x32_bf16 v[36:39], v[156:159], a[164:167], v[36:39]
  s_add_u32 m0, s9, 36864
  s_nop 0
  buffer_load_dwordx4 v11, s[20:23], s6 offen offset:0 sc1 lds
  v_mfma_f32_16x16x32_bf16 v[92:95], v[156:159], a[172:175], v[92:95]
  v_lshlrev_b32 v26, 4, v4
  s_lshl_b32 s7, s42, 4
  s_add_u32 s7, s7, s43
  s_mul_i32 s7, s7, 16384
  s_lshl_b32 s8, s3, 12
  s_add_u32 s7, s7, s8
  buffer_load_dwordx4 v[48:51], v26, s[24:27], s7 offen offset:0 sc1
  buffer_load_dwordx4 v[52:55], v26, s[24:27], s7 offen offset:1024 sc1
  buffer_load_dwordx4 v[188:191], v26, s[24:27], s7 offen offset:2048 sc1
  buffer_load_dwordx4 v[192:195], v26, s[24:27], s7 offen offset:3072 sc1
  v_mfma_f32_16x16x32_bf16 v[40:43], v[160:163], a[164:167], v[40:43]
  buffer_load_dwordx4 v11, s[20:23], s6 offen offset:1024 sc1 lds
  v_mfma_f32_16x16x32_bf16 v[96:99], v[160:163], a[172:175], v[96:99]
  v_mfma_f32_16x16x32_bf16 v[44:47], v[164:167], a[164:167], v[44:47]
  buffer_load_dwordx4 v11, s[20:23], s6 offen offset:2048 sc1 lds
  v_mfma_f32_16x16x32_bf16 v[100:103], v[164:167], a[172:175], v[100:103]
  v_mfma_f32_16x16x32_bf16 v[72:75], v[168:171], a[164:167], v[72:75]
  buffer_load_dwordx4 v11, s[20:23], s6 offen offset:3072 sc1 lds
  s_add_u32 s6, s6, 32768
  s_and_b32 s6, s6, 0x7ffff
  v_mfma_f32_16x16x32_bf16 v[104:107], v[168:171], a[172:175], v[104:107]
  s_waitcnt lgkmcnt(0)
  v_mfma_f32_16x16x32_bf16 v[16:19], v[108:111], a[176:179], v[16:19]
  ds_read_b64_tr_b16 v[140:141], v14 offset:33024
  ds_read_b64_tr_b16 v[142:143], v15 offset:33024
  v_mfma_f32_16x16x32_bf16 v[76:79], v[108:111], a[184:187], v[76:79]
  ds_read_b64_tr_b16 v[144:145], v14 offset:35072
  ds_read_b64_tr_b16 v[146:147], v15 offset:35072
  v_mfma_f32_16x16x32_bf16 v[20:23], v[112:115], a[176:179], v[20:23]
  ds_read_b64_tr_b16 v[148:149], v14 offset:37120
  ds_read_b64_tr_b16 v[150:151], v15 offset:37120
  v_mfma_f32_16x16x32_bf16 v[80:83], v[112:115], a[184:187], v[80:83]
  ds_read_b64_tr_b16 v[152:153], v14 offset:39168
  ds_read_b64_tr_b16 v[154:155], v15 offset:39168
  v_mfma_f32_16x16x32_bf16 v[28:31], v[116:119], a[176:179], v[28:31]
  ds_read_b64_tr_b16 v[156:157], v14 offset:41216
  ds_read_b64_tr_b16 v[158:159], v15 offset:41216
  v_mfma_f32_16x16x32_bf16 v[84:87], v[116:119], a[184:187], v[84:87]
  ds_read_b64_tr_b16 v[160:161], v14 offset:43264
  ds_read_b64_tr_b16 v[162:163], v15 offset:43264
  v_mfma_f32_16x16x32_bf16 v[32:35], v[120:123], a[176:179], v[32:35]
  ds_read_b64_tr_b16 v[164:165], v14 offset:45312
  ds_read_b64_tr_b16 v[166:167], v15 offset:45312
  v_mfma_f32_16x16x32_bf16 v[88:91], v[120:123], a[184:187], v[88:91]
  ds_read_b64_tr_b16 v[168:169], v14 offset:47360
  ds_read_b64_tr_b16 v[170:171], v15 offset:47360
  v_mfma_f32_16x16x32_bf16 v[36:39], v[124:127], a[176:179], v[36:39]
  s_add_u32 m0, s9, 65536
  s_nop 0
  buffer_load_dwordx4 v10, s[20:23], s6 offen offset:0 sc1 lds
  v_mfma_f32_16x16x32_bf16 v[92:95], v[124:127], a[184:187], v[92:95]
  v_mfma_f32_16x16x32_bf16 v[40:43], v[128:131], a[176:179], v[40:43]
  buffer_load_dwordx4 v10, s[20:23], s6 offen offset:1024 sc1 lds
  v_mfma_f32_16x16x32_bf16 v[96:99], v[128:131], a[184:187], v[96:99]
  v_mfma_f32_16x16x32_bf16 v[44:47], v[132:135], a[176:179], v[44:47]
  buffer_load_dwordx4 v10, s[20:23], s6 offen offset:2048 sc1 lds
  v_mfma_f32_16x16x32_bf16 v[100:103], v[132:135], a[184:187], v[100:103]
  v_mfma_f32_16x16x32_bf16 v[72:75], v[136:139], a[176:179], v[72:75]
  buffer_load_dwordx4 v10, s[20:23], s6 offen offset:3072 sc1 lds
  v_mfma_f32_16x16x32_bf16 v[104:107], v[136:139], a[184:187], v[104:107]
  s_waitcnt vmcnt(16) lgkmcnt(0)
  s_barrier
  v_mfma_f32_16x16x32_bf16 v[16:19], v[140:143], a[180:183], v[16:19]
  ds_read_b64_tr_b16 v[108:109], v12 offset:0
  ds_read_b64_tr_b16 v[110:111], v13 offset:0
  v_mfma_f32_16x16x32_bf16 v[76:79], v[140:143], a[188:191], v[76:79]
  ds_read_b64_tr_b16 v[112:113], v12 offset:2048
  ds_read_b64_tr_b16 v[114:115], v13 offset:2048
  v_mfma_f32_16x16x32_bf16 v[20:23], v[144:147], a[180:183], v[20:23]
  ds_read_b64_tr_b16 v[116:117], v12 offset:4096
  ds_read_b64_tr_b16 v[118:119], v13 offset:4096
  v_mfma_f32_16x16x32_bf16 v[80:83], v[144:147], a[188:191], v[80:83]
  ds_read_b64_tr_b16 v[120:121], v12 offset:6144
  ds_read_b64_tr_b16 v[122:123], v13 offset:6144
  v_mfma_f32_16x16x32_bf16 v[28:31], v[148:151], a[180:183], v[28:31]
  ds_read_b64_tr_b16 v[124:125], v12 offset:8192
  ds_read_b64_tr_b16 v[126:127], v13 offset:8192
  v_mfma_f32_16x16x32_bf16 v[84:87], v[148:151], a[188:191], v[84:87]
  ds_read_b64_tr_b16 v[128:129], v12 offset:10240
  ds_read_b64_tr_b16 v[130:131], v13 offset:10240
  v_mfma_f32_16x16x32_bf16 v[32:35], v[152:155], a[180:183], v[32:35]
  ds_read_b64_tr_b16 v[132:133], v12 offset:12288
  ds_read_b64_tr_b16 v[134:135], v13 offset:12288
  v_mfma_f32_16x16x32_bf16 v[88:91], v[152:155], a[188:191], v[88:91]
  ds_read_b64_tr_b16 v[136:137], v12 offset:14336
  ds_read_b64_tr_b16 v[138:139], v13 offset:14336
  v_mfma_f32_16x16x32_bf16 v[36:39], v[156:159], a[180:183], v[36:39]
  s_add_u32 m0, s9, 69632
  s_nop 0
  buffer_load_dwordx4 v11, s[20:23], s6 offen offset:0 sc1 lds
  v_mfma_f32_16x16x32_bf16 v[92:95], v[156:159], a[188:191], v[92:95]
  v_mfma_f32_16x16x32_bf16 v[40:43], v[160:163], a[180:183], v[40:43]
  buffer_load_dwordx4 v11, s[20:23], s6 offen offset:1024 sc1 lds
  v_mfma_f32_16x16x32_bf16 v[96:99], v[160:163], a[188:191], v[96:99]
  v_mfma_f32_16x16x32_bf16 v[44:47], v[164:167], a[180:183], v[44:47]
  buffer_load_dwordx4 v11, s[20:23], s6 offen offset:2048 sc1 lds
  v_mfma_f32_16x16x32_bf16 v[100:103], v[164:167], a[188:191], v[100:103]
  v_mfma_f32_16x16x32_bf16 v[72:75], v[168:171], a[180:183], v[72:75]
  buffer_load_dwordx4 v11, s[20:23], s6 offen offset:3072 sc1 lds
  s_add_u32 s6, s6, 32768
  s_and_b32 s6, s6, 0x7ffff
  v_mfma_f32_16x16x32_bf16 v[104:107], v[168:171], a[188:191], v[104:107]
  s_waitcnt lgkmcnt(0)
  v_mfma_f32_16x16x32_bf16 v[16:19], v[108:111], a[192:195], v[16:19]
  ds_read_b64_tr_b16 v[140:141], v12 offset:256
  ds_read_b64_tr_b16 v[142:143], v13 offset:256
  v_mfma_f32_16x16x32_bf16 v[76:79], v[108:111], a[200:203], v[76:79]
  ds_read_b64_tr_b16 v[144:145], v12 offset:2304
  ds_read_b64_tr_b16 v[146:147], v13 offset:2304
  v_mfma_f32_16x16x32_bf16 v[20:23], v[112:115], a[192:195], v[20:23]
  ds_read_b64_tr_b16 v[148:149], v12 offset:4352
  ds_read_b64_tr_b16 v[150:151], v13 offset:4352
  v_mfma_f32_16x16x32_bf16 v[80:83], v[112:115], a[200:203], v[80:83]
  ds_read_b64_tr_b16 v[152:153], v12 offset:6400
  ds_read_b64_tr_b16 v[154:155], v13 offset:6400
  v_mfma_f32_16x16x32_bf16 v[28:31], v[116:119], a[192:195], v[28:31]
  ds_read_b64_tr_b16 v[156:157], v12 offset:8448
  ds_read_b64_tr_b16 v[158:159], v13 offset:8448
  v_mfma_f32_16x16x32_bf16 v[84:87], v[116:119], a[200:203], v[84:87]
  ds_read_b64_tr_b16 v[160:161], v12 offset:10496
  ds_read_b64_tr_b16 v[162:163], v13 offset:10496
  v_mfma_f32_16x16x32_bf16 v[32:35], v[120:123], a[192:195], v[32:35]
  ds_read_b64_tr_b16 v[164:165], v12 offset:12544
  ds_read_b64_tr_b16 v[166:167], v13 offset:12544
  v_mfma_f32_16x16x32_bf16 v[88:91], v[120:123], a[200:203], v[88:91]
  ds_read_b64_tr_b16 v[168:169], v12 offset:14592
  ds_read_b64_tr_b16 v[170:171], v13 offset:14592
  v_mfma_f32_16x16x32_bf16 v[36:39], v[124:127], a[192:195], v[36:39]
  s_add_u32 m0, s9, 98304
  s_nop 0
  buffer_load_dwordx4 v10, s[20:23], s6 offen offset:0 sc1 lds
  v_mfma_f32_16x16x32_bf16 v[92:95], v[124:127], a[200:203], v[92:95]
  v_mfma_f32_16x16x32_bf16 v[40:43], v[128:131], a[192:195], v[40:43]
  buffer_load_dwordx4 v10, s[20:23], s6 offen offset:1024 sc1 lds
  v_mfma_f32_16x16x32_bf16 v[96:99], v[128:131], a[200:203], v[96:99]
  v_mfma_f32_16x16x32_bf16 v[44:47], v[132:135], a[192:195], v[44:47]
  buffer_load_dwordx4 v10, s[20:23], s6 offen offset:2048 sc1 lds
  v_mfma_f32_16x16x32_bf16 v[100:103], v[132:135], a[200:203], v[100:103]
  v_mfma_f32_16x16x32_bf16 v[72:75], v[136:139], a[192:195], v[72:75]
  buffer_load_dwordx4 v10, s[20:23], s6 offen offset:3072 sc1 lds
  v_mfma_f32_16x16x32_bf16 v[104:107], v[136:139], a[200:203], v[104:107]
  s_waitcnt vmcnt(12) lgkmcnt(0)
  s_barrier
  v_mfma_f32_16x16x32_bf16 v[16:19], v[140:143], a[196:199], v[16:19]
  ds_read_b64_tr_b16 v[108:109], v12 offset:32768
  ds_read_b64_tr_b16 v[110:111], v13 offset:32768
  v_mfma_f32_16x16x32_bf16 v[76:79], v[140:143], a[204:207], v[76:79]
  ds_read_b64_tr_b16 v[112:113], v12 offset:34816
  ds_read_b64_tr_b16 v[114:115], v13 offset:34816
  v_mfma_f32_16x16x32_bf16 v[20:23], v[144:147], a[196:199], v[20:23]
  ds_read_b64_tr_b16 v[116:117], v12 offset:36864
  ds_read_b64_tr_b16 v[118:119], v13 offset:36864
  v_mfma_f32_16x16x32_bf16 v[80:83], v[144:147], a[204:207], v[80:83]
  ds_read_b64_tr_b16 v[120:121], v12 offset:38912
  ds_read_b64_tr_b16 v[122:123], v13 offset:38912
  v_mfma_f32_16x16x32_bf16 v[28:31], v[148:151], a[196:199], v[28:31]
  ds_read_b64_tr_b16 v[124:125], v12 offset:40960
  ds_read_b64_tr_b16 v[126:127], v13 offset:40960
  v_mfma_f32_16x16x32_bf16 v[84:87], v[148:151], a[204:207], v[84:87]
  ds_read_b64_tr_b16 v[128:129], v12 offset:43008
  ds_read_b64_tr_b16 v[130:131], v13 offset:43008
  v_mfma_f32_16x16x32_bf16 v[32:35], v[152:155], a[196:199], v[32:35]
  ds_read_b64_tr_b16 v[132:133], v12 offset:45056
  ds_read_b64_tr_b16 v[134:135], v13 offset:45056
  v_mfma_f32_16x16x32_bf16 v[88:91], v[152:155], a[204:207], v[88:91]
  ds_read_b64_tr_b16 v[136:137], v12 offset:47104
  ds_read_b64_tr_b16 v[138:139], v13 offset:47104
  v_mfma_f32_16x16x32_bf16 v[36:39], v[156:159], a[196:199], v[36:39]
  s_add_u32 m0, s9, 102400
  s_nop 0
  buffer_load_dwordx4 v11, s[20:23], s6 offen offset:0 sc1 lds
  v_mfma_f32_16x16x32_bf16 v[92:95], v[156:159], a[204:207], v[92:95]
  v_mfma_f32_16x16x32_bf16 v[40:43], v[160:163], a[196:199], v[40:43]
  buffer_load_dwordx4 v11, s[20:23], s6 offen offset:1024 sc1 lds
  v_mfma_f32_16x16x32_bf16 v[96:99], v[160:163], a[204:207], v[96:99]
  v_mfma_f32_16x16x32_bf16 v[44:47], v[164:167], a[196:199], v[44:47]
  buffer_load_dwordx4 v11, s[20:23], s6 offen offset:2048 sc1 lds
  v_mfma_f32_16x16x32_bf16 v[100:103], v[164:167], a[204:207], v[100:103]
  v_mfma_f32_16x16x32_bf16 v[72:75], v[168:171], a[196:199], v[72:75]
  buffer_load_dwordx4 v11, s[20:23], s6 offen offset:3072 sc1 lds
  s_add_u32 s6, s6, 32768
  s_and_b32 s6, s6, 0x7ffff
  v_mfma_f32_16x16x32_bf16 v[104:107], v[168:171], a[204:207], v[104:107]
  s_waitcnt lgkmcnt(0)
  v_mfma_f32_16x16x32_bf16 v[16:19], v[108:111], a[208:211], v[16:19]
  ds_read_b64_tr_b16 v[140:141], v12 offset:33024
  ds_read_b64_tr_b16 v[142:143], v13 offset:33024
  v_mfma_f32_16x16x32_bf16 v[76:79], v[108:111], a[216:219], v[76:79]
  ds_read_b64_tr_b16 v[144:145], v12 offset:35072
  ds_read_b64_tr_b16 v[146:147], v13 offset:35072
  v_mfma_f32_16x16x32_bf16 v[20:23], v[112:115], a[208:211], v[20:23]
  ds_read_b64_tr_b16 v[148:149], v12 offset:37120
  ds_read_b64_tr_b16 v[150:151], v13 offset:37120
  v_mfma_f32_16x16x32_bf16 v[80:83], v[112:115], a[216:219], v[80:83]
  ds_read_b64_tr_b16 v[152:153], v12 offset:39168
  ds_read_b64_tr_b16 v[154:155], v13 offset:39168
  v_mfma_f32_16x16x32_bf16 v[28:31], v[116:119], a[208:211], v[28:31]
  ds_read_b64_tr_b16 v[156:157], v12 offset:41216
  ds_read_b64_tr_b16 v[158:159], v13 offset:41216
  v_mfma_f32_16x16x32_bf16 v[84:87], v[116:119], a[216:219], v[84:87]
  ds_read_b64_tr_b16 v[160:161], v12 offset:43264
  ds_read_b64_tr_b16 v[162:163], v13 offset:43264
  v_mfma_f32_16x16x32_bf16 v[32:35], v[120:123], a[208:211], v[32:35]
  ds_read_b64_tr_b16 v[164:165], v12 offset:45312
  ds_read_b64_tr_b16 v[166:167], v13 offset:45312
  s_lshl_b32 s7, s3, 10
  s_add_u32 s7, s7, 131072
  v_lshl_add_u32 v226, v4, 4, s7
  v_lshlrev_b32 v26, 16, v48
  v_mfma_f32_16x16x32_bf16 v[88:91], v[120:123], a[216:219], v[88:91]
  ds_read_b64_tr_b16 v[168:169], v12 offset:47360
  ds_read_b64_tr_b16 v[170:171], v13 offset:47360
  v_and_b32 v196, 0xffff0000, v48
  v_lshlrev_b32 v27, 16, v49
  v_and_b32 v197, 0xffff0000, v49
  v_lshlrev_b32 v198, 16, v52
  v_mfma_f32_16x16x32_bf16 v[36:39], v[124:127], a[208:211], v[36:39]
  v_and_b32 v200, 0xffff0000, v52
  v_lshlrev_b32 v199, 16, v53
  v_and_b32 v201, 0xffff0000, v53
  v_lshlrev_b32 v202, 16, v188
  v_mfma_f32_16x16x32_bf16 v[92:95], v[124:127], a[216:219], v[92:95]
  v_and_b32 v204, 0xffff0000, v188
  v_lshlrev_b32 v203, 16, v189
  v_and_b32 v205, 0xffff0000, v189
  v_lshlrev_b32 v206, 16, v192
  v_mfma_f32_16x16x32_bf16 v[40:43], v[128:131], a[208:211], v[40:43]
  v_and_b32 v208, 0xffff0000, v192
  v_lshlrev_b32 v207, 16, v193
  v_and_b32 v209, 0xffff0000, v193
  v_pk_add_f32 v[210:211], v[26:27], v[202:203]
  v_mfma_f32_16x16x32_bf16 v[96:99], v[128:131], a[216:219], v[96:99]
  v_pk_add_f32 v[214:215], v[26:27], v[202:203] neg_lo:[0,1] neg_hi:[0,1]
  v_pk_add_f32 v[218:219], v[198:199], v[206:207]
  v_pk_add_f32 v[212:213], v[196:197], v[204:205]
  v_pk_add_f32 v[216:217], v[196:197], v[204:205] neg_lo:[0,1] neg_hi:[0,1]
  v_mfma_f32_16x16x32_bf16 v[44:47], v[132:135], a[208:211], v[44:47]
  v_pk_add_f32 v[220:221], v[200:201], v[208:209]
  v_pk_add_f32 v[222:223], v[208:209], v[200:201] neg_lo:[0,1] neg_hi:[0,1]
  v_pk_add_f32 v[224:225], v[198:199], v[206:207] neg_lo:[0,1] neg_hi:[0,1]
  s_cmp_lg_u32 s3, 0
  s_cbranch_scc1 gated_mix__spectral_gfnet__ssm_conv_s5__prompt_kernel_skip42
  s_mov_b64 exec, 15
  v_pk_add_f32 v[218:219], v[198:199], v[198:199]
  v_pk_add_f32 v[220:221], v[206:207], v[206:207]
  v_pk_add_f32 v[222:223], v[200:201], v[200:201] neg_lo:[1,1] neg_hi:[1,1]
  v_pk_add_f32 v[224:225], v[208:209], v[208:209] neg_lo:[1,1] neg_hi:[1,1]
  s_mov_b64 exec, -1
gated_mix__spectral_gfnet__ssm_conv_s5__prompt_kernel_skip42:
  v_mfma_f32_16x16x32_bf16 v[100:103], v[132:135], a[216:219], v[100:103]
  v_pk_add_f32 v[26:27], v[210:211], v[218:219]
  v_cvt_pk_bf16_f32 v228, v26, v27
  v_pk_add_f32 v[196:197], v[212:213], v[220:221]
  v_cvt_pk_bf16_f32 v229, v196, v197
  v_mfma_f32_16x16x32_bf16 v[72:75], v[136:139], a[208:211], v[72:75]
  v_pk_add_f32 v[198:199], v[214:215], v[222:223]
  v_cvt_pk_bf16_f32 v230, v198, v199
  v_pk_add_f32 v[200:201], v[216:217], v[224:225]
  v_cvt_pk_bf16_f32 v231, v200, v201
  v_mfma_f32_16x16x32_bf16 v[104:107], v[136:139], a[216:219], v[104:107]
  v_pk_add_f32 v[202:203], v[210:211], v[218:219] neg_lo:[0,1] neg_hi:[0,1]
  v_cvt_pk_bf16_f32 v232, v202, v203
  v_pk_add_f32 v[204:205], v[212:213], v[220:221] neg_lo:[0,1] neg_hi:[0,1]
  v_cvt_pk_bf16_f32 v233, v204, v205
  s_waitcnt vmcnt(8) lgkmcnt(0)
  s_barrier
  v_mfma_f32_16x16x32_bf16 v[16:19], v[140:143], a[212:215], v[16:19]
  ds_read_b64_tr_b16 v[108:109], v14 offset:0
  ds_read_b64_tr_b16 v[110:111], v15 offset:0
  v_mfma_f32_16x16x32_bf16 v[76:79], v[140:143], a[220:223], v[76:79]
  ds_read_b64_tr_b16 v[112:113], v14 offset:2048
  ds_read_b64_tr_b16 v[114:115], v15 offset:2048
  v_mfma_f32_16x16x32_bf16 v[20:23], v[144:147], a[212:215], v[20:23]
  ds_read_b64_tr_b16 v[116:117], v14 offset:4096
  ds_read_b64_tr_b16 v[118:119], v15 offset:4096
  v_mfma_f32_16x16x32_bf16 v[80:83], v[144:147], a[220:223], v[80:83]
  ds_read_b64_tr_b16 v[120:121], v14 offset:6144
  ds_read_b64_tr_b16 v[122:123], v15 offset:6144
  v_mfma_f32_16x16x32_bf16 v[28:31], v[148:151], a[212:215], v[28:31]
  ds_read_b64_tr_b16 v[124:125], v14 offset:8192
  ds_read_b64_tr_b16 v[126:127], v15 offset:8192
  v_mfma_f32_16x16x32_bf16 v[84:87], v[148:151], a[220:223], v[84:87]
  ds_read_b64_tr_b16 v[128:129], v14 offset:10240
  ds_read_b64_tr_b16 v[130:131], v15 offset:10240
  v_mfma_f32_16x16x32_bf16 v[32:35], v[152:155], a[212:215], v[32:35]
  ds_read_b64_tr_b16 v[132:133], v14 offset:12288
  ds_read_b64_tr_b16 v[134:135], v15 offset:12288
  v_pk_add_f32 v[206:207], v[214:215], v[222:223] neg_lo:[0,1] neg_hi:[0,1]
  v_cvt_pk_bf16_f32 v234, v206, v207
  v_pk_add_f32 v[208:209], v[216:217], v[224:225] neg_lo:[0,1] neg_hi:[0,1]
  v_cvt_pk_bf16_f32 v235, v208, v209
  v_mfma_f32_16x16x32_bf16 v[88:91], v[152:155], a[220:223], v[88:91]
  ds_read_b64_tr_b16 v[136:137], v14 offset:14336
  ds_read_b64_tr_b16 v[138:139], v15 offset:14336
  v_lshlrev_b32 v26, 16, v50
  v_and_b32 v196, 0xffff0000, v50
  v_lshlrev_b32 v27, 16, v51
  v_and_b32 v197, 0xffff0000, v51
  v_mfma_f32_16x16x32_bf16 v[36:39], v[156:159], a[212:215], v[36:39]
  v_lshlrev_b32 v198, 16, v54
  v_and_b32 v200, 0xffff0000, v54
  v_lshlrev_b32 v199, 16, v55
  v_and_b32 v201, 0xffff0000, v55
  v_mfma_f32_16x16x32_bf16 v[92:95], v[156:159], a[220:223], v[92:95]
  v_lshlrev_b32 v202, 16, v190
  v_and_b32 v204, 0xffff0000, v190
  v_lshlrev_b32 v203, 16, v191
  v_and_b32 v205, 0xffff0000, v191
  v_mfma_f32_16x16x32_bf16 v[40:43], v[160:163], a[212:215], v[40:43]
  v_lshlrev_b32 v206, 16, v194
  v_and_b32 v208, 0xffff0000, v194
  v_lshlrev_b32 v207, 16, v195
  v_and_b32 v209, 0xffff0000, v195
  v_mfma_f32_16x16x32_bf16 v[96:99], v[160:163], a[220:223], v[96:99]
  v_pk_add_f32 v[210:211], v[26:27], v[202:203]
  v_pk_add_f32 v[214:215], v[26:27], v[202:203] neg_lo:[0,1] neg_hi:[0,1]
  v_pk_add_f32 v[218:219], v[198:199], v[206:207]
  v_pk_add_f32 v[212:213], v[196:197], v[204:205]
  v_mfma_f32_16x16x32_bf16 v[44:47], v[164:167], a[212:215], v[44:47]
  v_pk_add_f32 v[216:217], v[196:197], v[204:205] neg_lo:[0,1] neg_hi:[0,1]
  v_pk_add_f32 v[220:221], v[200:201], v[208:209]
  v_pk_add_f32 v[222:223], v[208:209], v[200:201] neg_lo:[0,1] neg_hi:[0,1]
  v_pk_add_f32 v[224:225], v[198:199], v[206:207] neg_lo:[0,1] neg_hi:[0,1]
  v_mfma_f32_16x16x32_bf16 v[100:103], v[164:167], a[220:223], v[100:103]
  s_cmp_lg_u32 s3, 0
  s_cbranch_scc1 gated_mix__spectral_gfnet__ssm_conv_s5__prompt_kernel_skip43
  s_mov_b64 exec, 15
  v_pk_add_f32 v[218:219], v[198:199], v[198:199]
  v_pk_add_f32 v[220:221], v[206:207], v[206:207]
  v_pk_add_f32 v[222:223], v[200:201], v[200:201] neg_lo:[1,1] neg_hi:[1,1]
  v_pk_add_f32 v[224:225], v[208:209], v[208:209] neg_lo:[1,1] neg_hi:[1,1]
  s_mov_b64 exec, -1
gated_mix__spectral_gfnet__ssm_conv_s5__prompt_kernel_skip43:
  v_mfma_f32_16x16x32_bf16 v[72:75], v[168:171], a[212:215], v[72:75]
  v_pk_add_f32 v[26:27], v[210:211], v[218:219]
  v_cvt_pk_bf16_f32 v49, v26, v27
  v_pk_add_f32 v[196:197], v[212:213], v[220:221]
  v_cvt_pk_bf16_f32 v51, v196, v197
  v_mfma_f32_16x16x32_bf16 v[104:107], v[168:171], a[220:223], v[104:107]
  v_pk_add_f32 v[198:199], v[214:215], v[222:223]
  v_cvt_pk_bf16_f32 v53, v198, v199
  v_pk_add_f32 v[200:201], v[216:217], v[224:225]
  v_cvt_pk_bf16_f32 v55, v200, v201
  s_waitcnt lgkmcnt(0)
  v_mfma_f32_16x16x32_bf16 v[16:19], v[108:111], a[224:227], v[16:19]
  ds_read_b64_tr_b16 v[140:141], v14 offset:256
  ds_read_b64_tr_b16 v[142:143], v15 offset:256
  v_mfma_f32_16x16x32_bf16 v[76:79], v[108:111], a[232:235], v[76:79]
  ds_read_b64_tr_b16 v[144:145], v14 offset:2304
  ds_read_b64_tr_b16 v[146:147], v15 offset:2304
  v_mfma_f32_16x16x32_bf16 v[20:23], v[112:115], a[224:227], v[20:23]
  ds_read_b64_tr_b16 v[148:149], v14 offset:4352
  ds_read_b64_tr_b16 v[150:151], v15 offset:4352
  v_mfma_f32_16x16x32_bf16 v[80:83], v[112:115], a[232:235], v[80:83]
  ds_read_b64_tr_b16 v[152:153], v14 offset:6400
  ds_read_b64_tr_b16 v[154:155], v15 offset:6400
  v_mfma_f32_16x16x32_bf16 v[28:31], v[116:119], a[224:227], v[28:31]
  ds_read_b64_tr_b16 v[156:157], v14 offset:8448
  ds_read_b64_tr_b16 v[158:159], v15 offset:8448
  v_mfma_f32_16x16x32_bf16 v[84:87], v[116:119], a[232:235], v[84:87]
  ds_read_b64_tr_b16 v[160:161], v14 offset:10496
  ds_read_b64_tr_b16 v[162:163], v15 offset:10496
  v_mfma_f32_16x16x32_bf16 v[32:35], v[120:123], a[224:227], v[32:35]
  ds_read_b64_tr_b16 v[164:165], v14 offset:12544
  ds_read_b64_tr_b16 v[166:167], v15 offset:12544
  v_pk_add_f32 v[202:203], v[210:211], v[218:219] neg_lo:[0,1] neg_hi:[0,1]
  v_cvt_pk_bf16_f32 v189, v202, v203
  v_pk_add_f32 v[204:205], v[212:213], v[220:221] neg_lo:[0,1] neg_hi:[0,1]
  v_cvt_pk_bf16_f32 v191, v204, v205
  v_mfma_f32_16x16x32_bf16 v[88:91], v[120:123], a[232:235], v[88:91]
  ds_read_b64_tr_b16 v[168:169], v14 offset:14592
  ds_read_b64_tr_b16 v[170:171], v15 offset:14592
  v_pk_add_f32 v[206:207], v[214:215], v[222:223] neg_lo:[0,1] neg_hi:[0,1]
  v_cvt_pk_bf16_f32 v193, v206, v207
  v_pk_add_f32 v[208:209], v[216:217], v[224:225] neg_lo:[0,1] neg_hi:[0,1]
  v_cvt_pk_bf16_f32 v195, v208, v209
  v_mfma_f32_16x16x32_bf16 v[36:39], v[124:127], a[224:227], v[36:39]
  v_mov_b32 v48, v228
  v_mov_b32 v50, v229
  ds_write_b128 v226, v[48:51] offset:0
  v_mov_b32 v52, v230
  v_mfma_f32_16x16x32_bf16 v[92:95], v[124:127], a[232:235], v[92:95]
  v_mov_b32 v54, v231
  ds_write_b128 v226, v[52:55] offset:4096
  v_mov_b32 v188, v232
  v_mov_b32 v190, v233
  v_mfma_f32_16x16x32_bf16 v[40:43], v[128:131], a[224:227], v[40:43]
  ds_write_b128 v226, v[188:191] offset:8192
  v_mov_b32 v192, v234
  v_mov_b32 v194, v235
  ds_write_b128 v226, v[192:195] offset:12288
  v_mfma_f32_16x16x32_bf16 v[96:99], v[128:131], a[232:235], v[96:99]
  v_mfma_f32_16x16x32_bf16 v[44:47], v[132:135], a[224:227], v[44:47]
  v_mfma_f32_16x16x32_bf16 v[100:103], v[132:135], a[232:235], v[100:103]
  v_mfma_f32_16x16x32_bf16 v[72:75], v[136:139], a[224:227], v[72:75]
  v_mfma_f32_16x16x32_bf16 v[104:107], v[136:139], a[232:235], v[104:107]
  s_waitcnt lgkmcnt(0)
  s_waitcnt vmcnt(0)
  s_barrier
  v_mfma_f32_16x16x32_bf16 v[16:19], v[140:143], a[228:231], v[16:19]
  ds_read_b64_tr_b16 v[108:109], v14 offset:32768
  ds_read_b64_tr_b16 v[110:111], v15 offset:32768
  v_mfma_f32_16x16x32_bf16 v[76:79], v[140:143], a[236:239], v[76:79]
  ds_read_b64_tr_b16 v[112:113], v14 offset:34816
  ds_read_b64_tr_b16 v[114:115], v15 offset:34816
  v_mfma_f32_16x16x32_bf16 v[20:23], v[144:147], a[228:231], v[20:23]
  ds_read_b64_tr_b16 v[116:117], v14 offset:36864
  ds_read_b64_tr_b16 v[118:119], v15 offset:36864
  v_mfma_f32_16x16x32_bf16 v[80:83], v[144:147], a[236:239], v[80:83]
  ds_read_b64_tr_b16 v[120:121], v14 offset:38912
  ds_read_b64_tr_b16 v[122:123], v15 offset:38912
  v_mfma_f32_16x16x32_bf16 v[28:31], v[148:151], a[228:231], v[28:31]
  ds_read_b64_tr_b16 v[124:125], v14 offset:40960
  ds_read_b64_tr_b16 v[126:127], v15 offset:40960
  v_mfma_f32_16x16x32_bf16 v[84:87], v[148:151], a[236:239], v[84:87]
  ds_read_b64_tr_b16 v[128:129], v14 offset:43008
  ds_read_b64_tr_b16 v[130:131], v15 offset:43008
  v_mfma_f32_16x16x32_bf16 v[32:35], v[152:155], a[228:231], v[32:35]
  ds_read_b64_tr_b16 v[132:133], v14 offset:45056
  ds_read_b64_tr_b16 v[134:135], v15 offset:45056
  v_mfma_f32_16x16x32_bf16 v[88:91], v[152:155], a[236:239], v[88:91]
  ds_read_b64_tr_b16 v[136:137], v14 offset:47104
  ds_read_b64_tr_b16 v[138:139], v15 offset:47104
  v_mfma_f32_16x16x32_bf16 v[36:39], v[156:159], a[228:231], v[36:39]
  v_mfma_f32_16x16x32_bf16 v[92:95], v[156:159], a[236:239], v[92:95]
  v_lshlrev_b32 v26, 4, v6
  s_lshl_b32 s7, s42, 9
  s_and_b32 s8, s3, 1
  s_lshl_b32 s8, s8, 8
  s_add_u32 s7, s7, s8
  buffer_load_dwordx4 v[48:51], v26, s[60:63], s7 offen offset:0 sc1
  buffer_load_dwordx4 v[52:55], v26, s[60:63], s7 offen offset:64 sc1
  buffer_load_dwordx4 v[188:191], v26, s[60:63], s7 offen offset:128 sc1
  buffer_load_dwordx4 v[192:195], v26, s[60:63], s7 offen offset:192 sc1
  v_and_b32 v26, 1, v6
  v_mul_u32_u24 v26, 0x8000, v26
  v_lshl_or_b32 v26, v26, 16, v26
  v_xor_b32 v27, 0x80000000, v26
  v_mfma_f32_16x16x32_bf16 v[40:43], v[160:163], a[228:231], v[40:43]
  v_xor_b32 v196, v26, v56
  v_alignbit_b32 v197, v57, v57, 16
  v_xor_b32 v197, v27, v197
  v_xor_b32 v198, v26, v58
  v_mfma_f32_16x16x32_bf16 v[96:99], v[160:163], a[236:239], v[96:99]
  v_alignbit_b32 v199, v59, v59, 16
  v_xor_b32 v199, v27, v199
  v_xor_b32 v200, v26, v60
  v_alignbit_b32 v201, v61, v61, 16
  v_mfma_f32_16x16x32_bf16 v[44:47], v[164:167], a[228:231], v[44:47]
  v_xor_b32 v201, v27, v201
  v_xor_b32 v202, v26, v62
  v_alignbit_b32 v203, v63, v63, 16
  v_xor_b32 v203, v27, v203
  v_mfma_f32_16x16x32_bf16 v[100:103], v[164:167], a[236:239], v[100:103]
  v_xor_b32 v204, v26, v64
  v_alignbit_b32 v205, v65, v65, 16
  v_xor_b32 v205, v27, v205
  v_xor_b32 v206, v26, v66
  v_mfma_f32_16x16x32_bf16 v[72:75], v[168:171], a[228:231], v[72:75]
  v_alignbit_b32 v207, v67, v67, 16
  v_xor_b32 v207, v27, v207
  v_xor_b32 v208, v26, v68
  v_alignbit_b32 v209, v69, v69, 16
  v_mfma_f32_16x16x32_bf16 v[104:107], v[168:171], a[236:239], v[104:107]
  v_xor_b32 v209, v27, v209
  v_xor_b32 v210, v26, v70
  v_alignbit_b32 v211, v71, v71, 16
  v_xor_b32 v211, v27, v211
  s_waitcnt lgkmcnt(0)
  v_mfma_f32_16x16x32_bf16 v[16:19], v[108:111], a[240:243], v[16:19]
  ds_read_b64_tr_b16 v[140:141], v14 offset:33024
  ds_read_b64_tr_b16 v[142:143], v15 offset:33024
  v_mfma_f32_16x16x32_bf16 v[76:79], v[108:111], a[248:251], v[76:79]
  ds_read_b64_tr_b16 v[144:145], v14 offset:35072
  ds_read_b64_tr_b16 v[146:147], v15 offset:35072
  v_mfma_f32_16x16x32_bf16 v[20:23], v[112:115], a[240:243], v[20:23]
  ds_read_b64_tr_b16 v[148:149], v14 offset:37120
  ds_read_b64_tr_b16 v[150:151], v15 offset:37120
  v_mfma_f32_16x16x32_bf16 v[80:83], v[112:115], a[248:251], v[80:83]
  ds_read_b64_tr_b16 v[152:153], v14 offset:39168
  ds_read_b64_tr_b16 v[154:155], v15 offset:39168
  v_mfma_f32_16x16x32_bf16 v[28:31], v[116:119], a[240:243], v[28:31]
  ds_read_b64_tr_b16 v[156:157], v14 offset:41216
  ds_read_b64_tr_b16 v[158:159], v15 offset:41216
  v_mfma_f32_16x16x32_bf16 v[84:87], v[116:119], a[248:251], v[84:87]
  ds_read_b64_tr_b16 v[160:161], v14 offset:43264
  ds_read_b64_tr_b16 v[162:163], v15 offset:43264
  v_mfma_f32_16x16x32_bf16 v[32:35], v[120:123], a[240:243], v[32:35]
  ds_read_b64_tr_b16 v[164:165], v14 offset:45312
  ds_read_b64_tr_b16 v[166:167], v15 offset:45312
  v_mfma_f32_16x16x32_bf16 v[88:91], v[120:123], a[248:251], v[88:91]
  ds_read_b64_tr_b16 v[168:169], v14 offset:47360
  ds_read_b64_tr_b16 v[170:171], v15 offset:47360
  v_mfma_f32_16x16x32_bf16 v[36:39], v[124:127], a[240:243], v[36:39]
  v_xor_b32 v212, v26, v172
  v_alignbit_b32 v213, v173, v173, 16
  v_xor_b32 v213, v27, v213
  v_xor_b32 v214, v26, v174
  v_mfma_f32_16x16x32_bf16 v[92:95], v[124:127], a[248:251], v[92:95]
  v_alignbit_b32 v215, v175, v175, 16
  v_xor_b32 v215, v27, v215
  v_xor_b32 v216, v26, v176
  v_alignbit_b32 v217, v177, v177, 16
  v_mfma_f32_16x16x32_bf16 v[40:43], v[128:131], a[240:243], v[40:43]
  v_xor_b32 v217, v27, v217
  v_xor_b32 v218, v26, v178
  v_alignbit_b32 v219, v179, v179, 16
  v_xor_b32 v219, v27, v219
  v_mfma_f32_16x16x32_bf16 v[96:99], v[128:131], a[248:251], v[96:99]
  v_xor_b32 v220, v26, v180
  v_alignbit_b32 v221, v181, v181, 16
  v_xor_b32 v221, v27, v221
  v_xor_b32 v222, v26, v182
  v_mfma_f32_16x16x32_bf16 v[44:47], v[132:135], a[240:243], v[44:47]
  v_alignbit_b32 v223, v183, v183, 16
  v_xor_b32 v223, v27, v223
  v_xor_b32 v224, v26, v184
  v_alignbit_b32 v225, v185, v185, 16
  v_mfma_f32_16x16x32_bf16 v[100:103], v[132:135], a[248:251], v[100:103]
  v_xor_b32 v225, v27, v225
  v_xor_b32 v226, v26, v186
  v_alignbit_b32 v227, v187, v187, 16
  v_xor_b32 v227, v27, v227
  v_mfma_f32_16x16x32_bf16 v[72:75], v[136:139], a[240:243], v[72:75]
  v_mfma_f32_16x16x32_bf16 v[104:107], v[136:139], a[248:251], v[104:107]
  s_waitcnt lgkmcnt(0)
  v_mfma_f32_16x16x32_bf16 v[36:39], v[156:159], a[244:247], v[36:39]
  ds_read_b64_tr_b16 v[108:109], v8 offset:0
  ds_read_b64_tr_b16 v[110:111], v8 offset:256
  v_mfma_f32_16x16x32_bf16 v[92:95], v[156:159], a[252:255], v[92:95]
  ds_read_b64_tr_b16 v[124:125], v8 offset:4096
  ds_read_b64_tr_b16 v[126:127], v8 offset:4352
  v_mfma_f32_16x16x32_bf16 v[40:43], v[160:163], a[244:247], v[40:43]
  ds_read_b64_tr_b16 v[112:113], v8 offset:1024
  ds_read_b64_tr_b16 v[114:115], v8 offset:1280
  v_mfma_f32_16x16x32_bf16 v[96:99], v[160:163], a[252:255], v[96:99]
  ds_read_b64_tr_b16 v[128:129], v8 offset:5120
  ds_read_b64_tr_b16 v[130:131], v8 offset:5376
  v_mfma_f32_16x16x32_bf16 v[44:47], v[164:167], a[244:247], v[44:47]
  ds_read_b64_tr_b16 v[116:117], v8 offset:2048
  ds_read_b64_tr_b16 v[118:119], v8 offset:2304
  v_mfma_f32_16x16x32_bf16 v[100:103], v[164:167], a[252:255], v[100:103]
  ds_read_b64_tr_b16 v[132:133], v8 offset:6144
  ds_read_b64_tr_b16 v[134:135], v8 offset:6400
  v_mfma_f32_16x16x32_bf16 v[72:75], v[168:171], a[244:247], v[72:75]
  ds_read_b64_tr_b16 v[120:121], v8 offset:3072
  ds_read_b64_tr_b16 v[122:123], v8 offset:3328
  v_mfma_f32_16x16x32_bf16 v[104:107], v[168:171], a[252:255], v[104:107]
  ds_read_b64_tr_b16 v[136:137], v8 offset:7168
  ds_read_b64_tr_b16 v[138:139], v8 offset:7424
  v_mfma_f32_16x16x32_bf16 v[16:19], v[140:143], a[244:247], v[16:19]
  v_mfma_f32_16x16x32_bf16 v[76:79], v[140:143], a[252:255], v[76:79]
  v_mfma_f32_16x16x32_bf16 v[20:23], v[144:147], a[244:247], v[20:23]
  v_mfma_f32_16x16x32_bf16 v[80:83], v[144:147], a[252:255], v[80:83]
  v_mfma_f32_16x16x32_bf16 v[28:31], v[148:151], a[244:247], v[28:31]
  v_mfma_f32_16x16x32_bf16 v[84:87], v[148:151], a[252:255], v[84:87]
  v_mfma_f32_16x16x32_bf16 v[32:35], v[152:155], a[244:247], v[32:35]
  v_mfma_f32_16x16x32_bf16 v[88:91], v[152:155], a[252:255], v[88:91]
  s_waitcnt lgkmcnt(14)
  v_mfma_f32_16x16x32_bf16 v[140:143], v[56:59], v[108:111], 0
  ds_write_b128 v2, v[36:39] offset:0
  s_waitcnt lgkmcnt(13)
  v_mfma_f32_16x16x32_bf16 v[156:159], v[56:59], v[124:127], 0
  ds_write_b128 v2, v[92:95] offset:4096
  s_waitcnt lgkmcnt(12)
  v_mfma_f32_16x16x32_bf16 v[140:143], v[60:63], v[112:115], v[140:143]
  ds_write_b128 v2, v[40:43] offset:1024
  s_waitcnt lgkmcnt(11)
  v_mfma_f32_16x16x32_bf16 v[156:159], v[60:63], v[128:131], v[156:159]
  ds_write_b128 v2, v[96:99] offset:5120
  s_waitcnt lgkmcnt(10)
  v_mfma_f32_16x16x32_bf16 v[140:143], v[64:67], v[116:119], v[140:143]
  ds_write_b128 v2, v[44:47] offset:2048
  s_waitcnt lgkmcnt(9)
  v_mfma_f32_16x16x32_bf16 v[156:159], v[64:67], v[132:135], v[156:159]
  ds_write_b128 v2, v[100:103] offset:6144
  s_waitcnt lgkmcnt(8)
  v_mfma_f32_16x16x32_bf16 v[140:143], v[68:71], v[120:123], v[140:143]
  ds_write_b128 v2, v[72:75] offset:3072
  s_waitcnt lgkmcnt(7)
  v_mfma_f32_16x16x32_bf16 v[156:159], v[68:71], v[136:139], v[156:159]
  ds_write_b128 v2, v[104:107] offset:7168
  v_mfma_f32_16x16x32_bf16 v[144:147], v[172:175], v[108:111], 0
  v_mfma_f32_16x16x32_bf16 v[160:163], v[172:175], v[124:127], 0
  v_mfma_f32_16x16x32_bf16 v[144:147], v[176:179], v[112:115], v[144:147]
  v_mfma_f32_16x16x32_bf16 v[160:163], v[176:179], v[128:131], v[160:163]
  v_mfma_f32_16x16x32_bf16 v[144:147], v[180:183], v[116:119], v[144:147]
  v_mfma_f32_16x16x32_bf16 v[160:163], v[180:183], v[132:135], v[160:163]
  v_mfma_f32_16x16x32_bf16 v[144:147], v[184:187], v[120:123], v[144:147]
  v_mfma_f32_16x16x32_bf16 v[160:163], v[184:187], v[136:139], v[160:163]
  v_xor_b32 v2, 0x2000, v2
  s_waitcnt lgkmcnt(0)
  s_barrier
  v_mfma_f32_16x16x32_bf16 v[148:151], v[196:199], v[108:111], 0
  ds_read_b128 v[36:39], v2 offset:0
  v_mfma_f32_16x16x32_bf16 v[164:167], v[196:199], v[124:127], 0
  ds_read_b128 v[92:95], v2 offset:4096
  v_mfma_f32_16x16x32_bf16 v[148:151], v[200:203], v[112:115], v[148:151]
  ds_read_b128 v[40:43], v2 offset:1024
  v_mfma_f32_16x16x32_bf16 v[164:167], v[200:203], v[128:131], v[164:167]
  ds_read_b128 v[96:99], v2 offset:5120
  v_mfma_f32_16x16x32_bf16 v[148:151], v[204:207], v[116:119], v[148:151]
  ds_read_b128 v[44:47], v2 offset:2048
  v_mfma_f32_16x16x32_bf16 v[164:167], v[204:207], v[132:135], v[164:167]
  ds_read_b128 v[100:103], v2 offset:6144
  v_mfma_f32_16x16x32_bf16 v[148:151], v[208:211], v[120:123], v[148:151]
  ds_read_b128 v[72:75], v2 offset:3072
  v_mfma_f32_16x16x32_bf16 v[164:167], v[208:211], v[136:139], v[164:167]
  ds_read_b128 v[104:107], v2 offset:7168
  s_waitcnt vmcnt(3)
  v_sub_f32 v12, 1.0, v48
  v_sub_f32 v13, 1.0, v49
  v_cvt_pk_bf16_f32 v13, v12, v13
  v_lshlrev_b32 v12, 16, v13
  v_and_b32 v13, 0xffff0000, v13
  v_sub_f32 v14, 1.0, v50
  v_sub_f32 v15, 1.0, v51
  v_cvt_pk_bf16_f32 v15, v14, v15
  v_lshlrev_b32 v14, 16, v15
  v_and_b32 v15, 0xffff0000, v15
  s_waitcnt lgkmcnt(7)
  v_pk_add_f32 v[16:17], v[16:17], v[36:37]
  v_pk_mul_f32 v[140:141], v[48:49], v[140:141]
  v_pk_fma_f32 v[16:17], v[12:13], v[16:17], v[140:141]
  s_waitcnt lgkmcnt(6)
  v_pk_add_f32 v[76:77], v[76:77], v[92:93]
  v_pk_mul_f32 v[156:157], v[48:49], v[156:157]
  v_pk_fma_f32 v[76:77], v[12:13], v[76:77], v[156:157]
  buffer_store_dword v16, v9, s[44:47], s10 offen offset:0
  buffer_store_dword v76, v9, s[44:47], s10 offen offset:1024
  s_add_u32 s10, s10, 65536
  buffer_store_dword v17, v9, s[44:47], s10 offen offset:0
  buffer_store_dword v77, v9, s[44:47], s10 offen offset:1024
  s_add_u32 s10, s10, 65536
  v_pk_add_f32 v[18:19], v[18:19], v[38:39]
  v_pk_mul_f32 v[142:143], v[50:51], v[142:143]
  v_pk_fma_f32 v[18:19], v[14:15], v[18:19], v[142:143]
  v_pk_add_f32 v[78:79], v[78:79], v[94:95]
  v_pk_mul_f32 v[158:159], v[50:51], v[158:159]
  v_pk_fma_f32 v[78:79], v[14:15], v[78:79], v[158:159]
  buffer_store_dword v18, v9, s[44:47], s10 offen offset:0
  buffer_store_dword v78, v9, s[44:47], s10 offen offset:1024
  s_add_u32 s10, s10, 65536
  buffer_store_dword v19, v9, s[44:47], s10 offen offset:0
  buffer_store_dword v79, v9, s[44:47], s10 offen offset:1024
  s_add_u32 s10, s10, 851968
  v_mfma_f32_16x16x32_bf16 v[152:155], v[212:215], v[108:111], 0
  v_mfma_f32_16x16x32_bf16 v[168:171], v[212:215], v[124:127], 0
  v_mfma_f32_16x16x32_bf16 v[152:155], v[216:219], v[112:115], v[152:155]
  v_mfma_f32_16x16x32_bf16 v[168:171], v[216:219], v[128:131], v[168:171]
  v_mfma_f32_16x16x32_bf16 v[152:155], v[220:223], v[116:119], v[152:155]
  v_mfma_f32_16x16x32_bf16 v[168:171], v[220:223], v[132:135], v[168:171]
  v_mfma_f32_16x16x32_bf16 v[152:155], v[224:227], v[120:123], v[152:155]
  v_mfma_f32_16x16x32_bf16 v[168:171], v[224:227], v[136:139], v[168:171]
  s_waitcnt vmcnt(10)
  v_sub_f32 v12, 1.0, v52
  v_sub_f32 v13, 1.0, v53
  v_cvt_pk_bf16_f32 v13, v12, v13
  v_lshlrev_b32 v12, 16, v13
  v_and_b32 v13, 0xffff0000, v13
  v_sub_f32 v14, 1.0, v54
  v_sub_f32 v15, 1.0, v55
  v_cvt_pk_bf16_f32 v15, v14, v15
  v_lshlrev_b32 v14, 16, v15
  v_and_b32 v15, 0xffff0000, v15
  s_waitcnt lgkmcnt(5)
  v_pk_add_f32 v[20:21], v[20:21], v[40:41]
  v_pk_mul_f32 v[144:145], v[52:53], v[144:145]
  v_pk_fma_f32 v[20:21], v[12:13], v[20:21], v[144:145]
  s_waitcnt lgkmcnt(4)
  v_pk_add_f32 v[80:81], v[80:81], v[96:97]
  v_pk_mul_f32 v[160:161], v[52:53], v[160:161]
  v_pk_fma_f32 v[80:81], v[12:13], v[80:81], v[160:161]
  buffer_store_dword v20, v9, s[44:47], s10 offen offset:0
  buffer_store_dword v80, v9, s[44:47], s10 offen offset:1024
  s_add_u32 s10, s10, 65536
  buffer_store_dword v21, v9, s[44:47], s10 offen offset:0
  buffer_store_dword v81, v9, s[44:47], s10 offen offset:1024
  s_add_u32 s10, s10, 65536
  v_pk_add_f32 v[22:23], v[22:23], v[42:43]
  v_pk_mul_f32 v[146:147], v[54:55], v[146:147]
  v_pk_fma_f32 v[22:23], v[14:15], v[22:23], v[146:147]
  v_pk_add_f32 v[82:83], v[82:83], v[98:99]
  v_pk_mul_f32 v[162:163], v[54:55], v[162:163]
  v_pk_fma_f32 v[82:83], v[14:15], v[82:83], v[162:163]
  buffer_store_dword v22, v9, s[44:47], s10 offen offset:0
  buffer_store_dword v82, v9, s[44:47], s10 offen offset:1024
  s_add_u32 s10, s10, 65536
  buffer_store_dword v23, v9, s[44:47], s10 offen offset:0
  buffer_store_dword v83, v9, s[44:47], s10 offen offset:1024
  s_add_u32 s10, s10, 851968
  s_waitcnt vmcnt(17)
  v_sub_f32 v12, 1.0, v188
  v_sub_f32 v13, 1.0, v189
  v_cvt_pk_bf16_f32 v13, v12, v13
  v_lshlrev_b32 v12, 16, v13
  v_and_b32 v13, 0xffff0000, v13
  v_sub_f32 v14, 1.0, v190
  v_sub_f32 v15, 1.0, v191
  v_cvt_pk_bf16_f32 v15, v14, v15
  v_lshlrev_b32 v14, 16, v15
  v_and_b32 v15, 0xffff0000, v15
  s_waitcnt lgkmcnt(3)
  v_pk_add_f32 v[28:29], v[28:29], v[44:45]
  v_pk_mul_f32 v[148:149], v[188:189], v[148:149]
  v_pk_fma_f32 v[28:29], v[12:13], v[28:29], v[148:149]
  s_waitcnt lgkmcnt(2)
  v_pk_add_f32 v[84:85], v[84:85], v[100:101]
  v_pk_mul_f32 v[164:165], v[188:189], v[164:165]
  v_pk_fma_f32 v[84:85], v[12:13], v[84:85], v[164:165]
  buffer_store_dword v28, v9, s[44:47], s10 offen offset:0
  buffer_store_dword v84, v9, s[44:47], s10 offen offset:1024
  s_add_u32 s10, s10, 65536
  buffer_store_dword v29, v9, s[44:47], s10 offen offset:0
  buffer_store_dword v85, v9, s[44:47], s10 offen offset:1024
  s_add_u32 s10, s10, 65536
  v_pk_add_f32 v[30:31], v[30:31], v[46:47]
  v_pk_mul_f32 v[150:151], v[190:191], v[150:151]
  v_pk_fma_f32 v[30:31], v[14:15], v[30:31], v[150:151]
  v_pk_add_f32 v[86:87], v[86:87], v[102:103]
  v_pk_mul_f32 v[166:167], v[190:191], v[166:167]
  v_pk_fma_f32 v[86:87], v[14:15], v[86:87], v[166:167]
  buffer_store_dword v30, v9, s[44:47], s10 offen offset:0
  buffer_store_dword v86, v9, s[44:47], s10 offen offset:1024
  s_add_u32 s10, s10, 65536
  buffer_store_dword v31, v9, s[44:47], s10 offen offset:0
  buffer_store_dword v87, v9, s[44:47], s10 offen offset:1024
  s_add_u32 s10, s10, 851968
  s_waitcnt vmcnt(24)
  v_sub_f32 v12, 1.0, v192
  v_sub_f32 v13, 1.0, v193
  v_cvt_pk_bf16_f32 v13, v12, v13
  v_lshlrev_b32 v12, 16, v13
  v_and_b32 v13, 0xffff0000, v13
  v_sub_f32 v14, 1.0, v194
  v_sub_f32 v15, 1.0, v195
  v_cvt_pk_bf16_f32 v15, v14, v15
  v_lshlrev_b32 v14, 16, v15
  v_and_b32 v15, 0xffff0000, v15
  s_waitcnt lgkmcnt(1)
  v_pk_add_f32 v[32:33], v[32:33], v[72:73]
  v_pk_mul_f32 v[152:153], v[192:193], v[152:153]
  v_pk_fma_f32 v[32:33], v[12:13], v[32:33], v[152:153]
  s_waitcnt lgkmcnt(0)
  v_pk_add_f32 v[88:89], v[88:89], v[104:105]
  v_pk_mul_f32 v[168:169], v[192:193], v[168:169]
  v_pk_fma_f32 v[88:89], v[12:13], v[88:89], v[168:169]
  buffer_store_dword v32, v9, s[44:47], s10 offen offset:0
  buffer_store_dword v88, v9, s[44:47], s10 offen offset:1024
  s_add_u32 s10, s10, 65536
  buffer_store_dword v33, v9, s[44:47], s10 offen offset:0
  buffer_store_dword v89, v9, s[44:47], s10 offen offset:1024
  s_add_u32 s10, s10, 65536
  v_pk_add_f32 v[34:35], v[34:35], v[74:75]
  v_pk_mul_f32 v[154:155], v[194:195], v[154:155]
  v_pk_fma_f32 v[34:35], v[14:15], v[34:35], v[154:155]
  v_pk_add_f32 v[90:91], v[90:91], v[106:107]
  v_pk_mul_f32 v[170:171], v[194:195], v[170:171]
  v_pk_fma_f32 v[90:91], v[14:15], v[90:91], v[170:171]
  buffer_store_dword v34, v9, s[44:47], s10 offen offset:0
  buffer_store_dword v90, v9, s[44:47], s10 offen offset:1024
  s_add_u32 s10, s10, 65536
  buffer_store_dword v35, v9, s[44:47], s10 offen offset:0
  buffer_store_dword v91, v9, s[44:47], s10 offen offset:1024
gated_mix__spectral_gfnet__ssm_conv_s5__prompt_kernel_end:
  s_endpgm
.section .rodata,"a"
.p2align 6
.amdhsa_kernel gated_mix__spectral_gfnet__ssm_conv_s5__prompt_kernel
  .amdhsa_next_free_vgpr 512
  .amdhsa_next_free_sgpr 102
  .amdhsa_accum_offset 256
  .amdhsa_group_segment_fixed_size 0
  .amdhsa_kernarg_size 128
  .amdhsa_user_sgpr_count 2
  .amdhsa_user_sgpr_kernarg_segment_ptr 1
  .amdhsa_system_sgpr_workgroup_id_x 1
  .amdhsa_float_denorm_mode_32 3
.end_amdhsa_kernel
```

```asm
; @launch grid=(256,1,1) block=(256,1,1) lds=163840
.amdgcn_target "amdgcn-amd-amdhsa--gfx950"
.text
.p2align 8
.globl gated_mix__spectral_gfnet__ssm_conv_s5__prompt_kernel
.type gated_mix__spectral_gfnet__ssm_conv_s5__prompt_kernel,@function
gated_mix__spectral_gfnet__ssm_conv_s5__prompt_kernel:
  s_cmp_ge_u32 s2, 256
  s_cbranch_scc1 gated_mix__spectral_gfnet__ssm_conv_s5__prompt_kernel_end
  s_load_dwordx16 s[4:19], s[0:1], 0
  s_load_dwordx16 s[20:35], s[0:1], 64
  s_getpc_b64 s[36:37]
gated_mix__spectral_gfnet__ssm_conv_s5__prompt_kernel_pc1:
  s_lshr_b32 s3, s2, 3
  s_mul_i32 s3, s3, 1280
  s_add_u32 s3, s3, 0
  v_min_u32 v2, 9, v0
  v_lshl_add_u32 v2, v2, 7, s3
  v_min_u32 v2, gated_mix__spectral_gfnet__ssm_conv_s5__prompt_kernel_end-gated_mix__spectral_gfnet__ssm_conv_s5__prompt_kernel_pc1, v2
  v_mov_b32 v3, s37
  v_add_co_u32 v2, vcc, s36, v2
  s_nop 1
  v_addc_co_u32 v3, vcc, 0, v3, vcc
  v_lshrrev_b32 v4, 6, v0
  s_nop 0
  v_readfirstlane_b32 s3, v4
  v_and_b32 v4, 63, v0
  v_and_b32 v5, 15, v0
  v_bfe_u32 v6, v0, 4, 2
  s_and_b32 s36, s2, 7
  s_lshr_b32 s37, s2, 3
  s_and_b32 s41, s37, 3
  s_lshr_b32 s37, s37, 2
  s_lshl_b32 s40, s36, 3
  s_add_u32 s40, s40, s37
  s_and_b32 s38, s36, 3
  s_lshl_b32 s38, s38, 2
  s_add_u32 s38, s38, s41
  s_lshr_b32 s39, s36, 2
  s_lshl_b32 s39, s39, 3
  s_add_u32 s39, s39, s37
  s_and_b32 s42, s36, 1
  s_lshl_b32 s42, s42, 3
  s_add_u32 s42, s42, s37
  s_lshr_b32 s43, s36, 1
  s_lshl_b32 s43, s43, 2
  s_add_u32 s43, s43, s41
  s_cmp_lg_u32 s3, 0
  s_cbranch_scc1 gated_mix__spectral_gfnet__ssm_conv_s5__prompt_kernel_skip2
  global_load_dword v1, v[2:3], off
gated_mix__spectral_gfnet__ssm_conv_s5__prompt_kernel_skip2:
  s_waitcnt lgkmcnt(0)
  s_mov_b32 s44, s4
  s_mov_b32 s45, s5
  s_mov_b32 s46, 4194304
  s_mov_b32 s47, 0x20000
  v_bfe_u32 v3, v4, 1, 2
  v_xor_b32 v3, v3, v6
  v_lshlrev_b32 v2, 9, v3
  v_and_b32 v3, 1, v4
  v_lshl_or_b32 v2, v3, 4, v2
  v_lshrrev_b32 v3, 3, v4
  v_lshl_or_b32 v2, v3, 15, v2
  s_lshl_b32 s4, s42, 11
  s_lshl_b32 m0, s43, 5
  s_add_u32 s4, s4, m0
  s_lshl_b32 m0, s3, 20
  s_add_u32 s4, s4, m0
  s_lshl_b32 m0, s3, 12
  s_add_u32 m0, m0, 131072
  s_nop 0
  buffer_load_dwordx4 v2, s[44:47], s4 offen offset:0 lds
  s_add_u32 s4, s4, 261120
  buffer_load_dwordx4 v2, s[44:47], s4 offen offset:1024 lds
  s_add_u32 s4, s4, 261120
  buffer_load_dwordx4 v2, s[44:47], s4 offen offset:2048 lds
  s_add_u32 s4, s4, 261120
  buffer_load_dwordx4 v2, s[44:47], s4 offen offset:3072 lds
  s_add_u32 s48, s34, 20316160
  s_addc_u32 s49, s35, 0
  s_mov_b32 s50, 40960
  s_mov_b32 s51, 0x20000
  s_mov_b32 s52, s32
  s_mov_b32 s53, s33
  s_mov_b32 s54, 256
  s_mov_b32 s55, 0x20000
  v_mov_b32 v2, 0
  v_lshlrev_b32 v3, 4, v0
  s_cmp_lg_u32 s2, 0
  s_cbranch_scc1 gated_mix__spectral_gfnet__ssm_conv_s5__prompt_kernel_skip3
  buffer_store_dword v2, v3, s[48:51], 0 offen sc1
gated_mix__spectral_gfnet__ssm_conv_s5__prompt_kernel_skip3:
  s_bitcmp1_b32 s3, 0
  s_cselect_b32 s56, s18, s16
  s_cselect_b32 s57, s19, s17
  s_mov_b32 s58, 2097152
  s_mov_b32 s59, 0x20000
  v_lshrrev_b32 v24, 5, v4
  v_lshlrev_b32 v24, 5, v24
  v_bfe_u32 v25, v4, 3, 1
  v_lshl_or_b32 v24, v25, 4, v24
  v_bfe_u32 v25, v4, 4, 1
  v_or_b32 v24, v24, v25
  v_lshlrev_b32 v24, 11, v24
  v_lshrrev_b32 v25, 3, v4
  v_lshlrev_b32 v25, 11, v25
  v_and_b32 v26, 7, v4
  v_xor_b32 v26, v26, v6
  v_lshlrev_b32 v26, 4, v26
  v_or_b32 v24, v24, v26
  v_or_b32 v25, v25, v26
  v_xor_b32 v8, 0, v24
  v_add_u32 v8, 0, v8
  v_xor_b32 v12, 0, v25
  v_add_u32 v12, 0, v12
  v_xor_b32 v9, 64, v24
  v_add_u32 v9, 3072, v9
  v_xor_b32 v13, 64, v25
  v_add_u32 v13, 15360, v13
  v_xor_b32 v10, 0, v24
  v_add_u32 v10, 6144, v10
  v_xor_b32 v14, 0, v25
  v_add_u32 v14, 30720, v14
  v_xor_b32 v11, 64, v24
  v_add_u32 v11, 9216, v11
  v_xor_b32 v15, 64, v25
  v_add_u32 v15, 46080, v15
  s_lshl_b32 s10, s38, 18
  s_lshr_b32 s18, s3, 1
  s_lshl_b32 s16, s18, 17
  s_add_u32 s10, s10, s16
  s_lshl_b32 s11, s39, 17
  s_lshl_b32 s16, s18, 16
  s_add_u32 s11, s11, s16
  s_and_b32 s18, s3, 1
  s_lshl_b32 s18, s18, 14
  s_add_u32 s10, s10, s18
  s_lshl_b32 s18, s3, 12
  s_add_u32 s16, s18, 0
  s_add_u32 s17, s18, 65536
  v_and_b32 v24, 31, v4
  v_lshlrev_b32 v24, 7, v24
  v_bfe_u32 v25, v4, 1, 3
  v_lshrrev_b32 v26, 5, v4
  v_xor_b32 v25, v25, v26
  v_lshl_or_b32 v24, v25, 4, v24
  s_lshr_b32 s18, s3, 1
  s_lshl_b32 s18, s18, 13
  s_add_u32 s18, s18, 0
  v_add_u32 v25, s18, v24
  s_and_b32 s18, s3, 1
  s_lshl_b32 s18, s18, 13
  s_add_u32 s18, s18, 65536
  v_add_u32 v26, s18, v24
  v_xor_b32 v16, 0, v25
  v_xor_b32 v20, 0, v26
  v_xor_b32 v17, 32, v25
  v_xor_b32 v21, 32, v26
  v_xor_b32 v18, 64, v25
  v_xor_b32 v22, 64, v26
  v_xor_b32 v19, 96, v25
  v_xor_b32 v23, 96, v26
  v_add_u32 v8, s10, v8
  v_add_u32 v12, s11, v12
  v_add_u32 v9, s10, v9
  v_add_u32 v13, s11, v13
  v_add_u32 v10, s10, v10
  v_add_u32 v14, s11, v14
  v_add_u32 v11, s10, v11
  v_add_u32 v15, s11, v15
  s_add_u32 s10, s38, 0
  s_and_b32 s10, s10, 15
  s_lshl_b32 s10, s10, 7
  s_and_b32 s4, s2, 7
  s_lshl_b32 s4, s4, 9
  s_lshr_b32 s5, s2, 3
  s_lshl_b32 s5, s5, 4
  s_add_u32 s4, s4, s5
  v_mov_b32 v24, s4
  s_lshl_b32 s4, s2, 7
  v_mov_b32 v25, s4
  s_mov_b32 s4, 4096
  s_mov_b32 s5, 8192
  v_mov_b32 v7, 1
  s_mov_b32 s60, s28
  s_mov_b32 s61, s29
  s_mov_b32 s62, 2048
  s_mov_b32 s63, 0x20000
  s_mov_b32 s64, s12
  s_mov_b32 s65, s13
  s_mov_b32 s66, 2048
  s_mov_b32 s67, 0x20000
  s_mov_b32 s68, s14
  s_mov_b32 s69, s15
  s_mov_b32 s70, 2048
  s_mov_b32 s71, 0x20000
  s_mov_b32 s72, s24
  s_mov_b32 s73, s25
  s_mov_b32 s74, 2048
  s_mov_b32 s75, 0x20000
  s_mov_b32 s76, s26
  s_mov_b32 s77, s27
  s_mov_b32 s78, 2048
  s_mov_b32 s79, 0x20000
  s_lshl_b32 s15, s40, 2
  s_add_u32 s15, s15, s41
  s_cmp_eq_u32 s15, 3
  s_cselect_b32 s12, 1, s41
  s_cselect_b32 s13, 64, s40
  s_and_b32 s14, s15, 0xfd
  s_cmp_eq_u32 s14, 0
  s_cselect_b32 s14, 1, 0
  s_lshl_b32 s18, s38, 4
  s_add_u32 s18, s18, s39
  s_and_b32 s19, s42, 7
  s_lshl_b32 s19, s19, 1
  s_lshr_b32 s24, s42, 3
  s_add_u32 s19, s19, s24
  v_cvt_f32_u32 v57, v5
  v_cvt_f32_u32 v58, v6
  v_mul_f32 v58, 4.0, v58
  s_cmp_lg_u32 s3, 0
  s_cbranch_scc1 gated_mix__spectral_gfnet__ssm_conv_s5__prompt_kernel_skip4
  v_cvt_f32_u32 v86, s14
  v_mul_f32 v86, 0xc4700000, v86
  v_cmp_lt_u32 vcc, 7, v5
  v_cvt_f32_u32 v85, s13
  s_nop 0
  v_cndmask_b32 v86, 0, v86, vcc
  v_add_f32 v85, v85, v86
  v_fmamk_f32 v59, v57, 0x43000000, v85
  v_mul_f32 v59, 0x3a000000, v59
  v_mul_f32 v84, v59, v58
  v_fmamk_f32 v76, v59, 0x0, v84
  v_fmamk_f32 v77, v59, 0x3f800000, v84
  v_fmamk_f32 v78, v59, 0x40000000, v84
  v_fmamk_f32 v79, v59, 0x40400000, v84
  v_cos_f32 v80, v76
  v_cos_f32 v81, v77
  v_cos_f32 v82, v78
  v_cos_f32 v83, v79
  v_sin_f32 v76, v76
  v_sin_f32 v77, v77
  v_sin_f32 v78, v78
  v_sin_f32 v79, v79
  v_cvt_pk_bf16_f32 v60, v80, v76
  v_cvt_pk_bf16_f32 v64, -v76, v80
  v_cvt_pk_bf16_f32 v61, v81, v77
  v_cvt_pk_bf16_f32 v65, -v77, v81
  v_cvt_pk_bf16_f32 v62, v82, v78
  v_cvt_pk_bf16_f32 v66, -v78, v82
  v_cvt_pk_bf16_f32 v63, v83, v79
  v_cvt_pk_bf16_f32 v67, -v79, v83
  v_xor_b32 v85, 3, v5
  v_cndmask_b32 v85, v5, v85, vcc
  v_cvt_f32_u32 v59, v85
  v_mul_f32 v59, 0x3d800000, v59
  v_mul_f32 v84, v59, v58
  v_fmamk_f32 v76, v59, 0x0, v84
  v_fmamk_f32 v77, v59, 0x3f800000, v84
  v_fmamk_f32 v78, v59, 0x40000000, v84
  v_fmamk_f32 v79, v59, 0x40400000, v84
  v_cos_f32 v80, v76
  v_cos_f32 v81, v77
  v_cos_f32 v82, v78
  v_cos_f32 v83, v79
  v_sin_f32 v76, v76
  v_sin_f32 v77, v77
  v_sin_f32 v78, v78
  v_sin_f32 v79, v79
  v_cvt_pk_bf16_f32 v68, v80, v76
  v_cvt_pk_bf16_f32 v72, -v76, v80
  v_cvt_pk_bf16_f32 v69, v81, v77
  v_cvt_pk_bf16_f32 v73, -v77, v81
  v_cvt_pk_bf16_f32 v70, v82, v78
  v_cvt_pk_bf16_f32 v74, -v78, v82
  v_cvt_pk_bf16_f32 v71, v83, v79
  v_cvt_pk_bf16_f32 v75, -v79, v83
  s_cmp_eq_u32 s14, 0
  s_cbranch_scc1 gated_mix__spectral_gfnet__ssm_conv_s5__prompt_kernel_skip5
  v_cndmask_b32 v85, 0, 16, vcc
  v_and_b32 v60, 0xffff, v60
  v_lshlrev_b32 v60, v85, v60
  v_and_b32 v61, 0xffff, v61
  v_lshlrev_b32 v61, v85, v61
  v_and_b32 v62, 0xffff, v62
  v_lshlrev_b32 v62, v85, v62
  v_and_b32 v63, 0xffff, v63
  v_lshlrev_b32 v63, v85, v63
  v_and_b32 v64, 0xffff, v64
  v_lshlrev_b32 v64, v85, v64
  v_and_b32 v65, 0xffff, v65
  v_lshlrev_b32 v65, v85, v65
  v_and_b32 v66, 0xffff, v66
  v_lshlrev_b32 v66, v85, v66
  v_and_b32 v67, 0xffff, v67
  v_lshlrev_b32 v67, v85, v67
  v_cmp_eq_u32 vcc, 0, v5
  v_mov_b32 v85, 0x3f80
  s_nop 0
  v_cndmask_b32 v64, v64, v85, vcc
  v_mov_b32 v85, 0xbf80
  v_cndmask_b32 v65, v65, v85, vcc
  v_mov_b32 v85, 0x3f80
  v_cndmask_b32 v66, v66, v85, vcc
  v_mov_b32 v85, 0xbf80
  v_cndmask_b32 v67, v67, v85, vcc
gated_mix__spectral_gfnet__ssm_conv_s5__prompt_kernel_skip5:
gated_mix__spectral_gfnet__ssm_conv_s5__prompt_kernel_skip4:
  s_cmp_lg_u32 s3, 1
  s_cbranch_scc1 gated_mix__spectral_gfnet__ssm_conv_s5__prompt_kernel_skip6
  v_cvt_f32_u32 v86, s14
  v_mul_f32 v86, 0xc4700000, v86
  v_cmp_lt_u32 vcc, 1, v6
  v_cvt_f32_u32 v85, s13
  s_nop 0
  v_cndmask_b32 v86, 0, v86, vcc
  v_add_f32 v85, v85, v86
  v_fmamk_f32 v85, v58, 0x43000000, v85
  v_mul_f32 v84, v85, v57
  v_mul_f32 v84, 0x3a000000, v84
  v_mul_f32 v59, 0x3d800000, v57
  v_fmamk_f32 v76, v59, 0x0, v84
  v_fmamk_f32 v77, v59, 0x3f800000, v84
  v_fmamk_f32 v78, v59, 0x40000000, v84
  v_fmamk_f32 v79, v59, 0x40400000, v84
  v_cos_f32 v80, v76
  v_cos_f32 v81, v77
  v_cos_f32 v82, v78
  v_cos_f32 v83, v79
  v_sin_f32 v76, v76
  v_sin_f32 v77, v77
  v_sin_f32 v78, v78
  v_sin_f32 v79, v79
  v_cvt_pk_bf16_f32 v60, v80, -v76
  v_cvt_pk_bf16_f32 v64, v76, v80
  v_cvt_pk_bf16_f32 v61, v81, -v77
  v_cvt_pk_bf16_f32 v65, v77, v81
  v_cvt_pk_bf16_f32 v62, v82, -v78
  v_cvt_pk_bf16_f32 v66, v78, v82
  v_cvt_pk_bf16_f32 v63, v83, -v79
  v_cvt_pk_bf16_f32 v67, v79, v83
  v_add_f32 v85, 0x40400000, v58
  v_cndmask_b32 v85, v58, v85, vcc
  v_mul_f32 v84, v59, v85
  v_cndmask_b32 v59, v59, -v59, vcc
  v_fmamk_f32 v76, v59, 0x0, v84
  v_fmamk_f32 v77, v59, 0x3f800000, v84
  v_fmamk_f32 v78, v59, 0x40000000, v84
  v_fmamk_f32 v79, v59, 0x40400000, v84
  v_cos_f32 v80, v76
  v_cos_f32 v81, v77
  v_cos_f32 v82, v78
  v_cos_f32 v83, v79
  v_sin_f32 v76, v76
  v_sin_f32 v77, v77
  v_sin_f32 v78, v78
  v_sin_f32 v79, v79
  v_cvt_pk_bf16_f32 v68, v80, -v76
  v_cvt_pk_bf16_f32 v72, v76, v80
  v_cvt_pk_bf16_f32 v69, v81, -v77
  v_cvt_pk_bf16_f32 v73, v77, v81
  v_cvt_pk_bf16_f32 v70, v82, -v78
  v_cvt_pk_bf16_f32 v74, v78, v82
  v_cvt_pk_bf16_f32 v71, v83, -v79
  v_cvt_pk_bf16_f32 v75, v79, v83
  s_cmp_eq_u32 s14, 0
  s_cbranch_scc1 gated_mix__spectral_gfnet__ssm_conv_s5__prompt_kernel_skip7
  v_lshlrev_b32 v85, 16, v60
  v_and_b32 v86, 0xffff0000, v60
  v_add_f32 v85, v85, v85
  v_add_f32 v86, v86, v86
  v_cvt_pk_bf16_f32 v85, v85, v86
  v_cndmask_b32 v60, v85, 0, vcc
  v_cndmask_b32 v64, 0, v85, vcc
  v_lshlrev_b32 v85, 16, v61
  v_and_b32 v86, 0xffff0000, v61
  v_add_f32 v85, v85, v85
  v_add_f32 v86, v86, v86
  v_cvt_pk_bf16_f32 v85, v85, v86
  v_cndmask_b32 v61, v85, 0, vcc
  v_cndmask_b32 v65, 0, v85, vcc
  v_lshlrev_b32 v85, 16, v62
  v_and_b32 v86, 0xffff0000, v62
  v_add_f32 v85, v85, v85
  v_add_f32 v86, v86, v86
  v_cvt_pk_bf16_f32 v85, v85, v86
  v_cndmask_b32 v62, v85, 0, vcc
  v_cndmask_b32 v66, 0, v85, vcc
  v_lshlrev_b32 v85, 16, v63
  v_and_b32 v86, 0xffff0000, v63
  v_add_f32 v85, v85, v85
  v_add_f32 v86, v86, v86
  v_cvt_pk_bf16_f32 v85, v85, v86
  v_cndmask_b32 v63, v85, 0, vcc
  v_cndmask_b32 v67, 0, v85, vcc
  v_lshlrev_b32 v85, 31, v5
  v_or_b32 v85, 0x3f803f80, v85
  v_cmp_eq_u32 vcc, 0, v6
  s_nop 1
  v_cndmask_b32 v60, v60, v85, vcc
gated_mix__spectral_gfnet__ssm_conv_s5__prompt_kernel_skip7:
gated_mix__spectral_gfnet__ssm_conv_s5__prompt_kernel_skip6:
  s_cmp_lg_u32 s3, 2
  s_cbranch_scc1 gated_mix__spectral_gfnet__ssm_conv_s5__prompt_kernel_skip8
  v_cvt_f32_u32 v86, s12
  v_fma_f32 v85, v57, 4.0, v86
  v_mul_f32 v59, 0x3c800000, v85
  v_mul_f32 v84, v59, v58
  v_fmamk_f32 v76, v59, 0x0, v84
  v_fmamk_f32 v77, v59, 0x3f800000, v84
  v_fmamk_f32 v78, v59, 0x40000000, v84
  v_fmamk_f32 v79, v59, 0x40400000, v84
  v_cos_f32 v80, v76
  v_cos_f32 v81, v77
  v_cos_f32 v82, v78
  v_cos_f32 v83, v79
  v_sin_f32 v76, v76
  v_sin_f32 v77, v77
  v_sin_f32 v78, v78
  v_sin_f32 v79, v79
  v_cvt_pk_bf16_f32 v60, v80, v76
  v_cvt_pk_bf16_f32 v64, -v76, v80
  v_cvt_pk_bf16_f32 v61, v81, v77
  v_cvt_pk_bf16_f32 v65, -v77, v81
  v_cvt_pk_bf16_f32 v62, v82, v78
  v_cvt_pk_bf16_f32 v66, -v78, v82
  v_cvt_pk_bf16_f32 v63, v83, v79
  v_cvt_pk_bf16_f32 v67, -v79, v83
  v_mul_f32 v59, 0x3d800000, v59
  v_mul_f32 v84, 0x3d800000, v84
  v_fmamk_f32 v76, v59, 0x0, v84
  v_fmamk_f32 v77, v59, 0x3f800000, v84
  v_fmamk_f32 v78, v59, 0x40000000, v84
  v_fmamk_f32 v79, v59, 0x40400000, v84
  v_cos_f32 v68, v76
  v_cos_f32 v69, v77
  v_cos_f32 v70, v78
  v_cos_f32 v71, v79
  v_sin_f32 v72, v76
  v_sin_f32 v73, v77
  v_sin_f32 v74, v78
  v_sin_f32 v75, v79
gated_mix__spectral_gfnet__ssm_conv_s5__prompt_kernel_skip8:
  s_cmp_lg_u32 s3, 3
  s_cbranch_scc1 gated_mix__spectral_gfnet__ssm_conv_s5__prompt_kernel_skip9
  v_cvt_f32_u32 v86, s12
  v_fma_f32 v85, v58, 4.0, v86
  v_mul_f32 v84, v85, v57
  v_mul_f32 v84, 0x3c800000, v84
  v_mul_f32 v59, 0x3d800000, v57
  v_fmamk_f32 v76, v59, 0x0, v84
  v_fmamk_f32 v77, v59, 0x3f800000, v84
  v_fmamk_f32 v78, v59, 0x40000000, v84
  v_fmamk_f32 v79, v59, 0x40400000, v84
  v_cos_f32 v80, v76
  v_cos_f32 v81, v77
  v_cos_f32 v82, v78
  v_cos_f32 v83, v79
  v_sin_f32 v76, v76
  v_sin_f32 v77, v77
  v_sin_f32 v78, v78
  v_sin_f32 v79, v79
  v_cvt_pk_bf16_f32 v60, v80, -v76
  v_cvt_pk_bf16_f32 v64, v76, v80
  v_cvt_pk_bf16_f32 v61, v81, -v77
  v_cvt_pk_bf16_f32 v65, v77, v81
  v_cvt_pk_bf16_f32 v62, v82, -v78
  v_cvt_pk_bf16_f32 v66, v78, v82
  v_cvt_pk_bf16_f32 v63, v83, -v79
  v_cvt_pk_bf16_f32 v67, v79, v83
  v_mul_f32 v59, 0x3d800000, v59
  v_mul_f32 v84, 0x3d800000, v84
  v_fmamk_f32 v76, v59, 0x0, v84
  v_fmamk_f32 v77, v59, 0x3f800000, v84
  v_fmamk_f32 v78, v59, 0x40000000, v84
  v_fmamk_f32 v79, v59, 0x40400000, v84
  v_cos_f32 v68, v76
  v_cos_f32 v69, v77
  v_cos_f32 v70, v78
  v_cos_f32 v71, v79
  v_sin_f32 v72, v76
  v_sin_f32 v73, v77
  v_sin_f32 v74, v78
  v_sin_f32 v75, v79
  v_mul_f32 v68, 0x35800000, v68
  v_mul_f32 v69, 0x35800000, v69
  v_mul_f32 v70, 0x35800000, v70
  v_mul_f32 v71, 0x35800000, v71
  v_mul_f32 v72, 0x35800000, v72
  v_mul_f32 v73, 0x35800000, v73
  v_mul_f32 v74, 0x35800000, v74
  v_mul_f32 v75, 0x35800000, v75
gated_mix__spectral_gfnet__ssm_conv_s5__prompt_kernel_skip9:
  s_lshl_b32 s28, s3, 12
  s_add_u32 s28, s28, 147456
  v_lshl_add_u32 v85, v4, 4, s28
  ds_write_b128 v85, v[60:63] offset:0
  ds_write_b128 v85, v[64:67] offset:1024
  ds_write_b128 v85, v[68:71] offset:2048
  ds_write_b128 v85, v[72:75] offset:3072
  s_add_u32 m0, s17, 0
  s_nop 0
  buffer_load_dwordx4 v12, s[56:59], s10 offen offset:0 lds
  s_lshl_b32 s28, s3, 4
  v_add_u32 v109, s28, v5
  v_cvt_f32_u32 v57, v109
  v_mul_f32 v57, 0x3c000000, v57
  v_lshrrev_b32 v59, 1, v6
  v_lshlrev_b32 v59, 4, v59
  v_and_b32 v108, 1, v6
  v_lshl_add_u32 v59, v108, 2, v59
  buffer_load_dwordx4 v13, s[56:59], s10 offen offset:1024 lds
  v_cvt_f32_u32 v58, v59
  v_mul_f32 v58, v58, v57
  v_cmp_eq_u32 vcc, 0, v109
  v_fmamk_f32 v92, v57, 0x0, v58
  v_fmamk_f32 v93, v57, 0x3f800000, v58
  v_fmamk_f32 v94, v57, 0x40000000, v58
  v_fmamk_f32 v95, v57, 0x40400000, v58
  v_fmamk_f32 v96, v57, 0x41000000, v58
  buffer_load_dwordx4 v14, s[56:59], s10 offen offset:2048 lds
  v_fmamk_f32 v97, v57, 0x41100000, v58
  v_fmamk_f32 v98, v57, 0x41200000, v58
  v_fmamk_f32 v99, v57, 0x41300000, v58
  v_cos_f32 v100, v92
  v_cos_f32 v101, v93
  v_cos_f32 v102, v94
  buffer_load_dwordx4 v15, s[56:59], s10 offen offset:3072 lds
  v_cos_f32 v103, v95
  v_cos_f32 v104, v96
  v_cos_f32 v105, v97
  v_cos_f32 v106, v98
  s_add_u32 m0, s16, 0
  s_nop 0
  buffer_load_dwordx4 v8, s[44:47], s10 offen offset:0 lds
  v_cos_f32 v107, v99
  v_sin_f32 v92, v92
  v_sin_f32 v93, v93
  v_sin_f32 v94, v94
  buffer_load_dwordx4 v9, s[44:47], s10 offen offset:1024 lds
  v_sin_f32 v95, v95
  v_sin_f32 v96, v96
  v_sin_f32 v97, v97
  v_sin_f32 v98, v98
  buffer_load_dwordx4 v10, s[44:47], s10 offen offset:2048 lds
  v_sin_f32 v99, v99
  v_mov_b32 v58, 0x80008000
  v_bfe_i32 v108, v5, 0, 1
  v_bfe_i32 v59, v5, 1, 1
  v_cmp_ne_u32 s[32:33], 0, v108
  v_and_b32 v108, v58, v108
  v_and_b32 v59, v58, v59
  buffer_load_dwordx4 v11, s[44:47], s10 offen offset:3072 lds
  s_add_u32 s10, s10, 128
  s_and_b32 s10, s10, 0x7ff
  v_xor_b32 v109, v59, v108
  v_mov_b32 v57, 0xbf803f80
  v_cvt_pk_bf16_f32 v60, v100, v101
  v_cvt_pk_bf16_f32 v76, -v92, -v93
  v_cndmask_b32 v76, v76, v57, vcc
  v_cvt_pk_bf16_f32 v61, v102, v103
  v_cvt_pk_bf16_f32 v77, -v94, -v95
  v_cndmask_b32 v77, v77, v57, vcc
  v_and_b32 v29, 31, v4
  v_lshlrev_b32 v29, 1, v29
  s_lshl_b32 s24, s39, 7
  s_and_b32 s25, s3, 1
  s_lshl_b32 s25, s25, 6
  s_add_u32 s24, s24, s25
  buffer_load_ushort v26, v29, s[64:67], s24 offen
  v_cvt_pk_bf16_f32 v62, v104, v105
  v_cvt_pk_bf16_f32 v78, -v96, -v97
  v_cndmask_b32 v78, v78, v57, vcc
  v_cvt_pk_bf16_f32 v63, v106, v107
  v_cvt_pk_bf16_f32 v79, -v98, -v99
  v_cndmask_b32 v79, v79, v57, vcc
  v_cndmask_b32 v64, v60, v76, s[32:33]
  v_cndmask_b32 v80, v76, v60, s[32:33]
  buffer_load_ushort v27, v29, s[68:71], s24 offen
  v_xor_b32 v68, v108, v60
  v_xor_b32 v84, v108, v76
  v_xor_b32 v72, v109, v64
  v_xor_b32 v88, v59, v80
  v_xor_b32 v64, v59, v64
  v_xor_b32 v80, v109, v80
  v_cndmask_b32 v65, v61, v77, s[32:33]
  v_cndmask_b32 v81, v77, v61, s[32:33]
  buffer_load_ushort v28, v29, s[72:75], s24 offen
  v_xor_b32 v69, v108, v61
  v_xor_b32 v85, v108, v77
  v_xor_b32 v73, v109, v65
  v_xor_b32 v89, v59, v81
  v_xor_b32 v65, v59, v65
  v_xor_b32 v81, v109, v81
  v_cndmask_b32 v66, v62, v78, s[32:33]
  v_cndmask_b32 v82, v78, v62, s[32:33]
  v_lshlrev_b32 v29, 1, v5
  s_lshl_b32 s24, s43, 5
  s_lshr_b32 s25, s3, 1
  s_lshl_b32 s25, s25, 10
  s_add_u32 s24, s24, s25
  buffer_load_short_d16_hi v30, v29, s[76:79], s24 offen offset:0
  v_xor_b32 v70, v108, v62
  v_xor_b32 v86, v108, v78
  v_xor_b32 v74, v109, v66
  v_xor_b32 v90, v59, v82
  v_xor_b32 v66, v59, v66
  v_xor_b32 v82, v109, v82
  v_cndmask_b32 v67, v63, v79, s[32:33]
  v_cndmask_b32 v83, v79, v63, s[32:33]
  buffer_load_short_d16_hi v31, v29, s[76:79], s24 offen offset:512
  v_xor_b32 v71, v108, v63
  v_xor_b32 v87, v108, v79
  v_xor_b32 v75, v109, v67
  v_xor_b32 v91, v59, v83
  v_xor_b32 v67, v59, v67
  v_xor_b32 v83, v109, v83
  s_mov_b32 s80, s34
  s_mov_b32 s81, s35
  s_add_u32 m0, s17, 16384
  s_nop 0
  buffer_load_dwordx4 v12, s[56:59], s10 offen offset:0 lds
  s_mov_b32 s82, 4194304
  s_mov_b32 s83, 0x20000
  buffer_load_dwordx4 v13, s[56:59], s10 offen offset:1024 lds
  buffer_load_dwordx4 v14, s[56:59], s10 offen offset:2048 lds
  buffer_load_dwordx4 v15, s[56:59], s10 offen offset:3072 lds
  s_add_u32 m0, s16, 16384
  s_nop 0
  buffer_load_dwordx4 v8, s[44:47], s10 offen offset:0 lds
  buffer_load_dwordx4 v9, s[44:47], s10 offen offset:1024 lds
  buffer_load_dwordx4 v10, s[44:47], s10 offen offset:2048 lds
  buffer_load_dwordx4 v11, s[44:47], s10 offen offset:3072 lds
  s_add_u32 s10, s10, 128
  s_and_b32 s10, s10, 0x7ff
  s_waitcnt vmcnt(21) lgkmcnt(0)
  s_barrier
  v_bfe_u32 v29, v4, 2, 3
  v_lshrrev_b32 v57, 5, v4
  v_lshl_or_b32 v29, v57, 4, v29
  v_lshlrev_b32 v29, 7, v29
  v_and_b32 v57, 3, v4
  v_lshl_or_b32 v29, v57, 3, v29
  v_add_u32 v29, 131072, v29
  v_bfe_u32 v57, v4, 3, 2
  v_xor_b32 v92, 0, v57
  v_lshl_add_u32 v92, v92, 5, v29
  v_xor_b32 v93, 1, v57
  v_lshl_add_u32 v93, v93, 5, v29
  v_xor_b32 v94, 2, v57
  v_lshl_add_u32 v94, v94, 5, v29
  v_xor_b32 v95, 3, v57
  s_add_u32 m0, s17, 32768
  s_nop 0
  buffer_load_dwordx4 v12, s[56:59], s10 offen offset:0 lds
  v_lshl_add_u32 v95, v95, 5, v29
  ds_read_b64_tr_b16 v[128:129], v92 offset:0
  ds_read_b64_tr_b16 v[130:131], v92 offset:1024
  ds_read_b64_tr_b16 v[132:133], v92 offset:4096
  ds_read_b64_tr_b16 v[134:135], v92 offset:5120
  ds_read_b64_tr_b16 v[136:137], v92 offset:8192
  ds_read_b64_tr_b16 v[138:139], v92 offset:9216
  ds_read_b64_tr_b16 v[140:141], v92 offset:12288
  ds_read_b64_tr_b16 v[142:143], v92 offset:13312
  ds_read_b64_tr_b16 v[144:145], v94 offset:0
  ds_read_b64_tr_b16 v[146:147], v94 offset:1024
  ds_read_b64_tr_b16 v[148:149], v94 offset:4096
  ds_read_b64_tr_b16 v[150:151], v94 offset:5120
  ds_read_b64_tr_b16 v[152:153], v94 offset:8192
  buffer_load_dwordx4 v13, s[56:59], s10 offen offset:1024 lds
  ds_read_b64_tr_b16 v[154:155], v94 offset:9216
  ds_read_b64_tr_b16 v[156:157], v94 offset:12288
  ds_read_b64_tr_b16 v[158:159], v94 offset:13312
  ds_read_b64_tr_b16 v[160:161], v93 offset:0
  ds_read_b64_tr_b16 v[162:163], v93 offset:1024
  ds_read_b64_tr_b16 v[164:165], v93 offset:4096
  ds_read_b64_tr_b16 v[166:167], v93 offset:5120
  ds_read_b64_tr_b16 v[168:169], v93 offset:8192
  ds_read_b64_tr_b16 v[170:171], v93 offset:9216
  ds_read_b64_tr_b16 v[172:173], v93 offset:12288
  ds_read_b64_tr_b16 v[174:175], v93 offset:13312
  s_waitcnt lgkmcnt(15)
  v_mfma_f32_16x16x32_bf16 v[96:99], v[60:63], v[128:131], 0
  buffer_load_dwordx4 v14, s[56:59], s10 offen offset:2048 lds
  v_mfma_f32_16x16x32_bf16 v[100:103], v[76:79], v[128:131], 0
  s_waitcnt lgkmcnt(15)
  v_mfma_f32_16x16x32_bf16 v[96:99], v[64:67], v[132:135], v[96:99]
  v_mfma_f32_16x16x32_bf16 v[100:103], v[80:83], v[132:135], v[100:103]
  s_waitcnt lgkmcnt(15)
  v_mfma_f32_16x16x32_bf16 v[96:99], v[68:71], v[136:139], v[96:99]
  buffer_load_dwordx4 v15, s[56:59], s10 offen offset:3072 lds
  v_mfma_f32_16x16x32_bf16 v[100:103], v[84:87], v[136:139], v[100:103]
  s_waitcnt lgkmcnt(15)
  v_mfma_f32_16x16x32_bf16 v[96:99], v[72:75], v[140:143], v[96:99]
  v_mfma_f32_16x16x32_bf16 v[100:103], v[88:91], v[140:143], v[100:103]
  ds_read_b64_tr_b16 v[128:129], v95 offset:0
  ds_read_b64_tr_b16 v[130:131], v95 offset:1024
  s_add_u32 m0, s16, 32768
  s_nop 0
  buffer_load_dwordx4 v8, s[44:47], s10 offen offset:0 lds
  ds_read_b64_tr_b16 v[132:133], v95 offset:4096
  ds_read_b64_tr_b16 v[134:135], v95 offset:5120
  ds_read_b64_tr_b16 v[136:137], v95 offset:8192
  ds_read_b64_tr_b16 v[138:139], v95 offset:9216
  ds_read_b64_tr_b16 v[140:141], v95 offset:12288
  ds_read_b64_tr_b16 v[142:143], v95 offset:13312
  s_waitcnt lgkmcnt(15)
  v_mfma_f32_16x16x32_bf16 v[112:115], v[60:63], v[144:147], 0
  v_mfma_f32_16x16x32_bf16 v[116:119], v[76:79], v[144:147], 0
  buffer_load_dwordx4 v9, s[44:47], s10 offen offset:1024 lds
  s_waitcnt lgkmcnt(15)
  v_mfma_f32_16x16x32_bf16 v[112:115], v[64:67], v[148:151], v[112:115]
  v_mfma_f32_16x16x32_bf16 v[116:119], v[80:83], v[148:151], v[116:119]
  s_waitcnt lgkmcnt(15)
  v_mfma_f32_16x16x32_bf16 v[112:115], v[68:71], v[152:155], v[112:115]
  v_mfma_f32_16x16x32_bf16 v[116:119], v[84:87], v[152:155], v[116:119]
  buffer_load_dwordx4 v10, s[44:47], s10 offen offset:2048 lds
  s_waitcnt lgkmcnt(15)
  v_mfma_f32_16x16x32_bf16 v[112:115], v[72:75], v[156:159], v[112:115]
  v_mfma_f32_16x16x32_bf16 v[116:119], v[88:91], v[156:159], v[116:119]
  s_waitcnt lgkmcnt(14)
  v_mfma_f32_16x16x32_bf16 v[104:107], v[60:63], v[160:163], 0
  v_mfma_f32_16x16x32_bf16 v[108:111], v[76:79], v[160:163], 0
  buffer_load_dwordx4 v11, s[44:47], s10 offen offset:3072 lds
  s_add_u32 s10, s10, 128
  s_and_b32 s10, s10, 0x7ff
  s_waitcnt lgkmcnt(12)
  v_mfma_f32_16x16x32_bf16 v[104:107], v[64:67], v[164:167], v[104:107]
  v_mfma_f32_16x16x32_bf16 v[108:111], v[80:83], v[164:167], v[108:111]
  s_waitcnt lgkmcnt(10)
  v_mfma_f32_16x16x32_bf16 v[104:107], v[68:71], v[168:171], v[104:107]
  v_mfma_f32_16x16x32_bf16 v[108:111], v[84:87], v[168:171], v[108:111]
  s_add_u32 m0, s17, 49152
  s_nop 0
  buffer_load_dwordx4 v12, s[56:59], s10 offen offset:0 lds
  s_waitcnt lgkmcnt(8)
  v_mfma_f32_16x16x32_bf16 v[104:107], v[72:75], v[172:175], v[104:107]
  v_mfma_f32_16x16x32_bf16 v[108:111], v[88:91], v[172:175], v[108:111]
  s_waitcnt lgkmcnt(6)
  v_mfma_f32_16x16x32_bf16 v[120:123], v[60:63], v[128:131], 0
  v_mfma_f32_16x16x32_bf16 v[124:127], v[76:79], v[128:131], 0
  buffer_load_dwordx4 v13, s[56:59], s10 offen offset:1024 lds
  s_waitcnt lgkmcnt(4)
  v_mfma_f32_16x16x32_bf16 v[120:123], v[64:67], v[132:135], v[120:123]
  v_mfma_f32_16x16x32_bf16 v[124:127], v[80:83], v[132:135], v[124:127]
  s_waitcnt lgkmcnt(2)
  v_mfma_f32_16x16x32_bf16 v[120:123], v[68:71], v[136:139], v[120:123]
  v_mfma_f32_16x16x32_bf16 v[124:127], v[84:87], v[136:139], v[124:127]
  buffer_load_dwordx4 v14, s[56:59], s10 offen offset:2048 lds
  s_waitcnt lgkmcnt(0)
  v_mfma_f32_16x16x32_bf16 v[120:123], v[72:75], v[140:143], v[120:123]
  v_mfma_f32_16x16x32_bf16 v[124:127], v[88:91], v[140:143], v[124:127]
  v_pk_add_f32 v[144:145], v[96:97], v[112:113]
  v_pk_add_f32 v[152:153], v[96:97], v[112:113] neg_lo:[0,1] neg_hi:[0,1]
  v_pk_add_f32 v[146:147], v[98:99], v[114:115]
  v_pk_add_f32 v[154:155], v[98:99], v[114:115] neg_lo:[0,1] neg_hi:[0,1]
  v_pk_add_f32 v[148:149], v[100:101], v[116:117]
  v_pk_add_f32 v[156:157], v[100:101], v[116:117] neg_lo:[0,1] neg_hi:[0,1]
  buffer_load_dwordx4 v15, s[56:59], s10 offen offset:3072 lds
  v_pk_add_f32 v[150:151], v[102:103], v[118:119]
  v_pk_add_f32 v[158:159], v[102:103], v[118:119] neg_lo:[0,1] neg_hi:[0,1]
  v_pk_add_f32 v[160:161], v[104:105], v[120:121]
  v_pk_add_f32 v[168:169], v[104:105], v[120:121] neg_lo:[0,1] neg_hi:[0,1]
  v_pk_add_f32 v[162:163], v[106:107], v[122:123]
  v_pk_add_f32 v[170:171], v[106:107], v[122:123] neg_lo:[0,1] neg_hi:[0,1]
  v_pk_add_f32 v[164:165], v[108:109], v[124:125]
  v_pk_add_f32 v[172:173], v[108:109], v[124:125] neg_lo:[0,1] neg_hi:[0,1]
  v_pk_add_f32 v[166:167], v[110:111], v[126:127]
  v_pk_add_f32 v[174:175], v[110:111], v[126:127] neg_lo:[0,1] neg_hi:[0,1]
  v_pk_add_f32 v[96:97], v[144:145], v[160:161]
  v_pk_add_f32 v[112:113], v[144:145], v[160:161] neg_lo:[0,1] neg_hi:[0,1]
  v_pk_add_f32 v[100:101], v[148:149], v[164:165]
  v_pk_add_f32 v[116:117], v[148:149], v[164:165] neg_lo:[0,1] neg_hi:[0,1]
  s_add_u32 m0, s16, 49152
  s_nop 0
  buffer_load_dwordx4 v8, s[44:47], s10 offen offset:0 lds
  v_pk_add_f32 v[104:105], v[152:153], v[172:173]
  v_pk_add_f32 v[108:109], v[156:157], v[168:169] neg_lo:[0,1] neg_hi:[0,1]
  v_pk_add_f32 v[120:121], v[152:153], v[172:173] neg_lo:[0,1] neg_hi:[0,1]
  v_pk_add_f32 v[124:125], v[156:157], v[168:169]
  v_pk_add_f32 v[98:99], v[146:147], v[162:163]
  v_pk_add_f32 v[114:115], v[146:147], v[162:163] neg_lo:[0,1] neg_hi:[0,1]
  v_pk_add_f32 v[102:103], v[150:151], v[166:167]
  v_pk_add_f32 v[118:119], v[150:151], v[166:167] neg_lo:[0,1] neg_hi:[0,1]
  v_pk_add_f32 v[106:107], v[154:155], v[174:175]
  v_pk_add_f32 v[110:111], v[158:159], v[170:171] neg_lo:[0,1] neg_hi:[0,1]
  v_pk_add_f32 v[122:123], v[154:155], v[174:175] neg_lo:[0,1] neg_hi:[0,1]
  v_pk_add_f32 v[126:127], v[158:159], v[170:171]
  v_cmp_gt_u32 vcc, 16, v0
  s_nop 1
  v_cndmask_b32 v104, v104, v152, vcc
  buffer_load_dwordx4 v9, s[44:47], s10 offen offset:1024 lds
  v_cndmask_b32 v108, v108, -v168, vcc
  v_cndmask_b32 v120, v120, v156, vcc
  v_cndmask_b32 v124, v124, -v172, vcc
  v_cvt_pk_bf16_f32 v128, v96, v100
  v_cvt_pk_bf16_f32 v129, v104, v108
  v_cvt_pk_bf16_f32 v130, v112, v116
  v_cvt_pk_bf16_f32 v131, v120, v124
  v_cvt_pk_bf16_f32 v132, v97, v101
  v_cvt_pk_bf16_f32 v133, v105, v109
  v_cvt_pk_bf16_f32 v134, v113, v117
  v_cvt_pk_bf16_f32 v135, v121, v125
  v_cvt_pk_bf16_f32 v136, v98, v102
  v_cvt_pk_bf16_f32 v137, v106, v110
  v_cvt_pk_bf16_f32 v138, v114, v118
  buffer_load_dwordx4 v10, s[44:47], s10 offen offset:2048 lds
  v_cvt_pk_bf16_f32 v139, v122, v126
  v_cvt_pk_bf16_f32 v140, v99, v103
  v_cvt_pk_bf16_f32 v141, v107, v111
  v_cvt_pk_bf16_f32 v142, v115, v119
  v_cvt_pk_bf16_f32 v143, v123, v127
  s_mov_b32 s24, 262144
  v_mul_lo_u32 v29, v6, s24
  v_lshl_add_u32 v29, v5, 2, v29
  s_mul_i32 s24, s3, 1048576
  s_lshl_b32 s25, s42, 10
  s_add_u32 s24, s24, s25
  s_lshl_b32 s25, s43, 6
  s_add_u32 s24, s24, s25
  s_and_b32 s25, s3, 1
  buffer_load_dwordx4 v11, s[44:47], s10 offen offset:3072 lds
  s_add_u32 s10, s10, 128
  s_and_b32 s10, s10, 0x7ff
  s_lshl_b32 s25, s25, 13
  s_add_u32 s25, s25, 131072
  v_lshrrev_b32 v76, 2, v4
  v_lshlrev_b32 v76, 7, v76
  v_and_b32 v77, 3, v4
  v_lshl_or_b32 v76, v77, 3, v76
  v_add_u32 v76, s25, v76
  v_bfe_u32 v77, v4, 3, 2
  s_and_b32 s25, s3, 2
  v_xor_b32 v77, s25, v77
  v_lshl_add_u32 v74, v77, 5, v76
  v_xor_b32 v75, 32, v74
  ds_read_b64_tr_b16 v[58:59], v74 offset:0
  ds_read_b64_tr_b16 v[60:61], v74 offset:2048
  ds_read_b64_tr_b16 v[62:63], v74 offset:4096
  ds_read_b64_tr_b16 v[64:65], v74 offset:6144
  ds_read_b64_tr_b16 v[66:67], v75 offset:0
  ds_read_b64_tr_b16 v[68:69], v75 offset:2048
  ds_read_b64_tr_b16 v[70:71], v75 offset:4096
  ds_read_b64_tr_b16 v[72:73], v75 offset:6144
  v_lshlrev_b32 v56, 4, v4
  s_lshl_b32 s26, s18, 14
  s_lshl_b32 s27, s3, 12
  s_add_u32 s26, s26, s27
  buffer_load_dwordx4 v[32:35], v56, s[44:47], s26 offen offset:0
  buffer_load_dwordx4 v[36:39], v56, s[44:47], s26 offen offset:1024
  buffer_load_dwordx4 v[40:43], v56, s[44:47], s26 offen offset:2048
  buffer_load_dwordx4 v[44:47], v56, s[44:47], s26 offen offset:3072
  buffer_load_dwordx4 v[48:51], v56, s[60:63], 0 offen offset:0
  buffer_load_dwordx4 v[52:55], v56, s[60:63], 0 offen offset:1024
  s_waitcnt vmcnt(35)
  s_barrier
  ds_read_b128 v[124:127], v16 offset:0
  ds_read_b128 v[164:167], v20 offset:0
  ds_read_b128 v[160:163], v16 offset:4096
  ds_read_b128 v[168:171], v20 offset:4096
  s_waitcnt lgkmcnt(2)
  v_mfma_f32_32x32x16_bf16 v[76:91], v[124:127], v[164:167], 0
  ds_read_b128 v[172:175], v17 offset:0
  ds_read_b128 v[180:183], v21 offset:0
  buffer_store_dword v128, v29, s[80:83], s24 offen sc1
  s_add_u32 s24, s24, 16384
  buffer_store_dword v129, v29, s[80:83], s24 offen sc1
  s_waitcnt lgkmcnt(2)
  v_mfma_f32_32x32x16_bf16 v[92:107], v[124:127], v[168:171], 0
  ds_read_b128 v[176:179], v17 offset:4096
  ds_read_b128 v[184:187], v21 offset:4096
  s_add_u32 s24, s24, 16384
  buffer_store_dword v130, v29, s[80:83], s24 offen sc1
  v_mfma_f32_32x32x16_bf16 v[144:159], v[160:163], v[168:171], 0
  s_add_u32 s24, s24, 16384
  buffer_store_dword v131, v29, s[80:83], s24 offen sc1
  v_mfma_f32_32x32x16_bf16 v[108:123], v[160:163], v[164:167], 0
  s_add_u32 s24, s24, 16384
  buffer_store_dword v132, v29, s[80:83], s24 offen sc1
  s_waitcnt lgkmcnt(2)
  v_mfma_f32_32x32x16_bf16 v[76:91], v[172:175], v[180:183], v[76:91]
  ds_read_b128 v[124:127], v18 offset:0
  ds_read_b128 v[164:167], v22 offset:0
  s_add_u32 s24, s24, 16384
  buffer_store_dword v133, v29, s[80:83], s24 offen sc1
  s_waitcnt lgkmcnt(2)
  v_mfma_f32_32x32x16_bf16 v[92:107], v[172:175], v[184:187], v[92:107]
  ds_read_b128 v[160:163], v18 offset:4096
  ds_read_b128 v[168:171], v22 offset:4096
  s_add_u32 s24, s24, 16384
  buffer_store_dword v134, v29, s[80:83], s24 offen sc1
  v_mfma_f32_32x32x16_bf16 v[144:159], v[176:179], v[184:187], v[144:159]
  s_add_u32 s24, s24, 16384
  buffer_store_dword v135, v29, s[80:83], s24 offen sc1
  v_mfma_f32_32x32x16_bf16 v[108:123], v[176:179], v[180:183], v[108:123]
  s_add_u32 s24, s24, 16384
  buffer_store_dword v136, v29, s[80:83], s24 offen sc1
  s_waitcnt lgkmcnt(2)
  v_mfma_f32_32x32x16_bf16 v[76:91], v[124:127], v[164:167], v[76:91]
  ds_read_b128 v[172:175], v19 offset:0
  ds_read_b128 v[180:183], v23 offset:0
  s_add_u32 s24, s24, 16384
  buffer_store_dword v137, v29, s[80:83], s24 offen sc1
  s_add_u32 s24, s24, 16384
  s_waitcnt lgkmcnt(2)
  v_mfma_f32_32x32x16_bf16 v[92:107], v[124:127], v[168:171], v[92:107]
  ds_read_b128 v[176:179], v19 offset:4096
  ds_read_b128 v[184:187], v23 offset:4096
  buffer_store_dword v138, v29, s[80:83], s24 offen sc1
  s_add_u32 s24, s24, 16384
  v_mfma_f32_32x32x16_bf16 v[144:159], v[160:163], v[168:171], v[144:159]
  buffer_store_dword v139, v29, s[80:83], s24 offen sc1
  s_add_u32 s24, s24, 16384
  v_mfma_f32_32x32x16_bf16 v[108:123], v[160:163], v[164:167], v[108:123]
  buffer_store_dword v140, v29, s[80:83], s24 offen sc1
  s_add_u32 s24, s24, 16384
  s_waitcnt vmcnt(35) lgkmcnt(0)
  s_barrier
  v_mfma_f32_32x32x16_bf16 v[76:91], v[172:175], v[180:183], v[76:91]
  ds_read_b128 v[124:127], v16 offset:16384
  ds_read_b128 v[164:167], v20 offset:16384
  buffer_store_dword v141, v29, s[80:83], s24 offen sc1
  s_add_u32 s24, s24, 16384
  v_mfma_f32_32x32x16_bf16 v[92:107], v[172:175], v[184:187], v[92:107]
  ds_read_b128 v[160:163], v16 offset:20480
  ds_read_b128 v[168:171], v20 offset:20480
  buffer_store_dword v142, v29, s[80:83], s24 offen sc1
  s_add_u32 s24, s24, 16384
  v_mfma_f32_32x32x16_bf16 v[144:159], v[176:179], v[184:187], v[144:159]
  s_add_u32 m0, s17, 0
  s_nop 0
  buffer_load_dwordx4 v12, s[56:59], s10 offen offset:0 lds
  buffer_store_dword v143, v29, s[80:83], s24 offen sc1
  s_lshl_b32 s24, s39, 14
  v_mfma_f32_32x32x16_bf16 v[108:123], v[176:179], v[180:183], v[108:123]
  buffer_load_dwordx4 v13, s[56:59], s10 offen offset:1024 lds
  s_add_u32 s66, s24, 19988480
  s_add_u32 s64, s34, s66
  s_addc_u32 s65, s35, 0
  s_waitcnt lgkmcnt(2)
  v_mfma_f32_32x32x16_bf16 v[76:91], v[124:127], v[164:167], v[76:91]
  ds_read_b128 v[172:175], v17 offset:16384
  ds_read_b128 v[180:183], v21 offset:16384
  s_mov_b32 s66, 8192
  s_mov_b32 s67, 0x20000
  s_sub_u32 s24, 15, s38
  s_waitcnt lgkmcnt(2)
  v_mfma_f32_32x32x16_bf16 v[92:107], v[124:127], v[168:171], v[92:107]
  ds_read_b128 v[176:179], v17 offset:20480
  ds_read_b128 v[184:187], v21 offset:20480
  s_lshl_b32 s24, s24, 9
  v_lshl_add_u32 v74, v0, 2, s24
  v_mov_b32 v75, -1
  s_cmp_ge_u32 s3, 2
  s_cbranch_scc1 gated_mix__spectral_gfnet__ssm_conv_s5__prompt_kernel_skip10
  buffer_store_dword v75, v74, s[64:67], 0 offen sc1
gated_mix__spectral_gfnet__ssm_conv_s5__prompt_kernel_skip10:
  v_mfma_f32_32x32x16_bf16 v[144:159], v[160:163], v[168:171], v[144:159]
  buffer_load_dwordx4 v14, s[56:59], s10 offen offset:2048 lds
  s_cmp_lg_u32 s3, 0
  s_cbranch_scc1 gated_mix__spectral_gfnet__ssm_conv_s5__prompt_kernel_skip11
  s_mov_b64 exec, 1
  buffer_store_dword v2, v25, s[48:51], s5 offen sc1
  buffer_store_dword v2, v24, s[48:51], s4 offen sc1
  s_mov_b64 exec, -1
gated_mix__spectral_gfnet__ssm_conv_s5__prompt_kernel_skip11:
  v_mfma_f32_32x32x16_bf16 v[108:123], v[160:163], v[164:167], v[108:123]
  buffer_load_dwordx4 v15, s[56:59], s10 offen offset:3072 lds
  s_waitcnt lgkmcnt(2)
  v_mfma_f32_32x32x16_bf16 v[76:91], v[172:175], v[180:183], v[76:91]
  ds_read_b128 v[124:127], v18 offset:16384
  ds_read_b128 v[164:167], v22 offset:16384
  s_or_b32 s24, s3, s2
  s_waitcnt lgkmcnt(2)
  v_mfma_f32_32x32x16_bf16 v[92:107], v[172:175], v[184:187], v[92:107]
  ds_read_b128 v[160:163], v18 offset:20480
  ds_read_b128 v[168:171], v22 offset:20480
  s_cmp_lg_u32 s24, 0
  s_cbranch_scc1 gated_mix__spectral_gfnet__ssm_conv_s5__prompt_kernel_skip12
  s_mov_b64 exec, 1
  buffer_store_dword v7, v2, s[52:55], 0 offen sc1
  s_mov_b64 exec, -1
gated_mix__spectral_gfnet__ssm_conv_s5__prompt_kernel_skip12:
  v_mfma_f32_32x32x16_bf16 v[144:159], v[176:179], v[184:187], v[144:159]
  s_add_u32 m0, s16, 0
  s_nop 0
  buffer_load_dwordx4 v8, s[44:47], s10 offen offset:0 lds
  s_bitcmp1_b32 s3, 0
  s_cselect_b32 s68, s22, s20
  s_cselect_b32 s69, s23, s21
  v_mfma_f32_32x32x16_bf16 v[108:123], v[176:179], v[180:183], v[108:123]
  buffer_load_dwordx4 v9, s[44:47], s10 offen offset:1024 lds
  s_mov_b32 s70, 2097152
  s_mov_b32 s71, 0x20000
  s_waitcnt lgkmcnt(2)
  v_mfma_f32_32x32x16_bf16 v[76:91], v[124:127], v[164:167], v[76:91]
  ds_read_b128 v[172:175], v19 offset:16384
  ds_read_b128 v[180:183], v23 offset:16384
  v_and_b32 v74, 7, v4
  v_xor_b32 v74, v74, v6
  v_and_b32 v75, 4, v74
  v_lshlrev_b32 v128, 4, v75
  s_waitcnt lgkmcnt(2)
  v_mfma_f32_32x32x16_bf16 v[92:107], v[124:127], v[168:171], v[92:107]
  ds_read_b128 v[176:179], v19 offset:20480
  ds_read_b128 v[184:187], v23 offset:20480
  v_and_b32 v75, 1, v74
  v_lshl_or_b32 v128, v75, 5, v128
  v_bfe_u32 v75, v74, 1, 1
  v_mfma_f32_32x32x16_bf16 v[144:159], v[160:163], v[168:171], v[144:159]
  buffer_load_dwordx4 v10, s[44:47], s10 offen offset:2048 lds
  v_lshl_or_b32 v128, v75, 4, v128
  v_lshrrev_b32 v75, 3, v4
  v_lshl_or_b32 v128, v75, 11, v128
  s_lshr_b32 s22, s3, 1
  v_mfma_f32_32x32x16_bf16 v[108:123], v[160:163], v[164:167], v[108:123]
  buffer_load_dwordx4 v11, s[44:47], s10 offen offset:3072 lds
  s_add_u32 s10, s10, 128
  s_and_b32 s10, s10, 0x7ff
  s_lshl_b32 s22, s22, 20
  s_lshl_b32 s20, s43, 15
  s_add_u32 s22, s22, s20
  v_add_u32 v128, s22, v128
  s_waitcnt vmcnt(38) lgkmcnt(0)
  s_barrier
  v_mfma_f32_32x32x16_bf16 v[76:91], v[172:175], v[180:183], v[76:91]
  ds_read_b128 v[124:127], v16 offset:32768
  ds_read_b128 v[164:167], v20 offset:32768
  v_xor_b32 v129, 64, v128
  v_add_u32 v129, 15360, v129
  v_add_u32 v130, 522240, v128
  v_mfma_f32_32x32x16_bf16 v[92:107], v[172:175], v[184:187], v[92:107]
  ds_read_b128 v[160:163], v16 offset:36864
  ds_read_b128 v[168:171], v20 offset:36864
  v_add_u32 v131, 522240, v129
  s_lshl_b32 s20, s19, 7
  s_lshl_b32 s21, s3, 12
  v_lshrrev_b32 v74, 1, v5
  v_mfma_f32_32x32x16_bf16 v[144:159], v[176:179], v[184:187], v[144:159]
  s_add_u32 m0, s17, 16384
  s_nop 0
  buffer_load_dwordx4 v12, s[56:59], s10 offen offset:0 lds
  v_xor_b32 v74, v74, v6
  v_lshlrev_b32 v74, 4, v74
  v_lshl_or_b32 v74, v5, 7, v74
  v_add_u32 v132, s21, v74
  v_mfma_f32_32x32x16_bf16 v[108:123], v[176:179], v[180:183], v[108:123]
  buffer_load_dwordx4 v13, s[56:59], s10 offen offset:1024 lds
  v_xor_b32 v133, 64, v132
  v_add_u32 v134, 0x10000, v132
  v_add_u32 v135, 0x10000, v133
  s_waitcnt lgkmcnt(2)
  v_mfma_f32_32x32x16_bf16 v[76:91], v[124:127], v[164:167], v[76:91]
  ds_read_b128 v[172:175], v17 offset:32768
  ds_read_b128 v[180:183], v21 offset:32768
  s_waitcnt lgkmcnt(2)
  v_mfma_f32_32x32x16_bf16 v[92:107], v[124:127], v[168:171], v[92:107]
  ds_read_b128 v[176:179], v17 offset:36864
  ds_read_b128 v[184:187], v21 offset:36864
  v_mfma_f32_32x32x16_bf16 v[144:159], v[160:163], v[168:171], v[144:159]
  buffer_load_dwordx4 v14, s[56:59], s10 offen offset:2048 lds
  v_mfma_f32_32x32x16_bf16 v[108:123], v[160:163], v[164:167], v[108:123]
  buffer_load_dwordx4 v15, s[56:59], s10 offen offset:3072 lds
  s_waitcnt lgkmcnt(2)
  v_mfma_f32_32x32x16_bf16 v[76:91], v[172:175], v[180:183], v[76:91]
  ds_read_b128 v[124:127], v18 offset:32768
  ds_read_b128 v[164:167], v22 offset:32768
  s_waitcnt lgkmcnt(2)
  v_mfma_f32_32x32x16_bf16 v[92:107], v[172:175], v[184:187], v[92:107]
  ds_read_b128 v[160:163], v18 offset:36864
  ds_read_b128 v[168:171], v22 offset:36864
  v_mfma_f32_32x32x16_bf16 v[144:159], v[176:179], v[184:187], v[144:159]
  s_add_u32 m0, s16, 16384
  s_nop 0
  buffer_load_dwordx4 v8, s[44:47], s10 offen offset:0 lds
  v_mfma_f32_32x32x16_bf16 v[108:123], v[176:179], v[180:183], v[108:123]
  buffer_load_dwordx4 v9, s[44:47], s10 offen offset:1024 lds
  s_waitcnt lgkmcnt(2)
  v_mfma_f32_32x32x16_bf16 v[76:91], v[124:127], v[164:167], v[76:91]
  ds_read_b128 v[172:175], v19 offset:32768
  ds_read_b128 v[180:183], v23 offset:32768
  s_waitcnt lgkmcnt(2)
  v_mfma_f32_32x32x16_bf16 v[92:107], v[124:127], v[168:171], v[92:107]
  ds_read_b128 v[176:179], v19 offset:36864
  ds_read_b128 v[184:187], v23 offset:36864
  v_mfma_f32_32x32x16_bf16 v[144:159], v[160:163], v[168:171], v[144:159]
  buffer_load_dwordx4 v10, s[44:47], s10 offen offset:2048 lds
  v_mfma_f32_32x32x16_bf16 v[108:123], v[160:163], v[164:167], v[108:123]
  buffer_load_dwordx4 v11, s[44:47], s10 offen offset:3072 lds
  s_add_u32 s10, s10, 128
  s_and_b32 s10, s10, 0x7ff
  s_waitcnt vmcnt(38) lgkmcnt(0)
  s_barrier
  v_mfma_f32_32x32x16_bf16 v[76:91], v[172:175], v[180:183], v[76:91]
  ds_read_b128 v[124:127], v16 offset:49152
  ds_read_b128 v[164:167], v20 offset:49152
  v_mfma_f32_32x32x16_bf16 v[92:107], v[172:175], v[184:187], v[92:107]
  ds_read_b128 v[160:163], v16 offset:53248
  ds_read_b128 v[168:171], v20 offset:53248
  v_mfma_f32_32x32x16_bf16 v[144:159], v[176:179], v[184:187], v[144:159]
  s_add_u32 m0, s17, 32768
  s_nop 0
  buffer_load_dwordx4 v12, s[56:59], s10 offen offset:0 lds
  v_mfma_f32_32x32x16_bf16 v[108:123], v[176:179], v[180:183], v[108:123]
  buffer_load_dwordx4 v13, s[56:59], s10 offen offset:1024 lds
  s_waitcnt lgkmcnt(2)
  v_mfma_f32_32x32x16_bf16 v[76:91], v[124:127], v[164:167], v[76:91]
  ds_read_b128 v[172:175], v17 offset:49152
  ds_read_b128 v[180:183], v21 offset:49152
  s_add_u32 s72, s34, 19922944
  s_addc_u32 s73, s35, 0
  s_waitcnt lgkmcnt(2)
  v_mfma_f32_32x32x16_bf16 v[92:107], v[124:127], v[168:171], v[92:107]
  ds_read_b128 v[176:179], v17 offset:53248
  ds_read_b128 v[184:187], v21 offset:53248
  s_mov_b32 s74, 8192
  s_mov_b32 s75, 0x20000
  v_mfma_f32_32x32x16_bf16 v[144:159], v[160:163], v[168:171], v[144:159]
  buffer_load_dwordx4 v14, s[56:59], s10 offen offset:2048 lds
  v_mov_b32 v74, 0
  v_mfma_f32_32x32x16_bf16 v[108:123], v[160:163], v[164:167], v[108:123]
  buffer_load_dwordx4 v15, s[56:59], s10 offen offset:3072 lds
  v_mov_b32 v75, 0
  s_waitcnt vmcnt(37)
  v_dot2c_f32_bf16 v74, v32, v48
  s_waitcnt lgkmcnt(2)
  v_mfma_f32_32x32x16_bf16 v[76:91], v[172:175], v[180:183], v[76:91]
  ds_read_b128 v[124:127], v18 offset:49152
  ds_read_b128 v[164:167], v22 offset:49152
  v_dot2c_f32_bf16 v75, v40, v48
  v_dot2c_f32_bf16 v74, v33, v49
  s_waitcnt lgkmcnt(2)
  v_mfma_f32_32x32x16_bf16 v[92:107], v[172:175], v[184:187], v[92:107]
  ds_read_b128 v[160:163], v18 offset:53248
  ds_read_b128 v[168:171], v22 offset:53248
  v_dot2c_f32_bf16 v75, v41, v49
  v_mfma_f32_32x32x16_bf16 v[144:159], v[176:179], v[184:187], v[144:159]
  s_add_u32 m0, s16, 32768
  s_nop 0
  buffer_load_dwordx4 v8, s[44:47], s10 offen offset:0 lds
  v_dot2c_f32_bf16 v74, v34, v50
  v_dot2c_f32_bf16 v75, v42, v50
  v_mfma_f32_32x32x16_bf16 v[108:123], v[176:179], v[180:183], v[108:123]
  buffer_load_dwordx4 v9, s[44:47], s10 offen offset:1024 lds
  v_dot2c_f32_bf16 v74, v35, v51
  s_waitcnt lgkmcnt(2)
  v_mfma_f32_32x32x16_bf16 v[76:91], v[124:127], v[164:167], v[76:91]
  ds_read_b128 v[172:175], v19 offset:49152
  ds_read_b128 v[180:183], v23 offset:49152
  v_dot2c_f32_bf16 v75, v43, v51
  s_waitcnt vmcnt(38)
  v_dot2c_f32_bf16 v74, v36, v52
  s_waitcnt lgkmcnt(2)
  v_mfma_f32_32x32x16_bf16 v[92:107], v[124:127], v[168:171], v[92:107]
  ds_read_b128 v[176:179], v19 offset:53248
  ds_read_b128 v[184:187], v23 offset:53248
  v_dot2c_f32_bf16 v75, v44, v52
  v_dot2c_f32_bf16 v74, v37, v53
  v_mfma_f32_32x32x16_bf16 v[144:159], v[160:163], v[168:171], v[144:159]
  buffer_load_dwordx4 v10, s[44:47], s10 offen offset:2048 lds
  v_dot2c_f32_bf16 v75, v45, v53
  v_mfma_f32_32x32x16_bf16 v[108:123], v[160:163], v[164:167], v[108:123]
  buffer_load_dwordx4 v11, s[44:47], s10 offen offset:3072 lds
  s_add_u32 s10, s10, 128
  s_and_b32 s10, s10, 0x7ff
  v_dot2c_f32_bf16 v74, v38, v54
  v_dot2c_f32_bf16 v75, v46, v54
  s_waitcnt vmcnt(16) lgkmcnt(0)
  s_barrier
  v_mfma_f32_32x32x16_bf16 v[76:91], v[172:175], v[180:183], v[76:91]
  ds_read_b128 v[124:127], v16 offset:0
  ds_read_b128 v[164:167], v20 offset:0
  v_dot2c_f32_bf16 v74, v39, v55
  v_dot2c_f32_bf16 v75, v47, v55
  v_mfma_f32_32x32x16_bf16 v[92:107], v[172:175], v[184:187], v[92:107]
  ds_read_b128 v[160:163], v16 offset:4096
  ds_read_b128 v[168:171], v20 offset:4096
  v_permlane32_swap_b32 v74, v75
  v_mfma_f32_32x32x16_bf16 v[144:159], v[176:179], v[184:187], v[144:159]
  s_add_u32 m0, s17, 49152
  s_nop 0
  buffer_load_dwordx4 v12, s[56:59], s10 offen offset:0 lds
  v_add_f32 v74, v74, v75
  v_mov_b32 v75, v74
  v_mfma_f32_32x32x16_bf16 v[108:123], v[176:179], v[180:183], v[108:123]
  buffer_load_dwordx4 v13, s[56:59], s10 offen offset:1024 lds
  v_permlane16_swap_b32 v74, v75
  s_waitcnt lgkmcnt(2)
  v_mfma_f32_32x32x16_bf16 v[76:91], v[124:127], v[164:167], v[76:91]
  ds_read_b128 v[172:175], v17 offset:0
  ds_read_b128 v[180:183], v21 offset:0
  v_add_f32 v74, v74, v75
  s_nop 1
  v_add_f32 v74, v74, v74 row_ror:8 row_mask:0xf bank_mask:0xf
  s_waitcnt lgkmcnt(2)
  v_mfma_f32_32x32x16_bf16 v[92:107], v[124:127], v[168:171], v[92:107]
  ds_read_b128 v[176:179], v17 offset:4096
  ds_read_b128 v[184:187], v21 offset:4096
  v_add_f32 v74, v74, v74 row_ror:4 row_mask:0xf bank_mask:0xf
  s_nop 1
  v_add_f32 v74, v74, v74 row_ror:2 row_mask:0xf bank_mask:0xf
  v_mfma_f32_32x32x16_bf16 v[144:159], v[160:163], v[168:171], v[144:159]
  buffer_load_dwordx4 v14, s[56:59], s10 offen offset:2048 lds
  v_add_f32 v74, v74, v74 row_ror:1 row_mask:0xf bank_mask:0xf
  v_mfma_f32_32x32x16_bf16 v[108:123], v[160:163], v[164:167], v[108:123]
  buffer_load_dwordx4 v15, s[56:59], s10 offen offset:3072 lds
  v_cvt_pk_bf16_f32 v74, v74, v74
  v_and_b32 v74, 0xffff0000, v74
  s_waitcnt lgkmcnt(2)
  v_mfma_f32_32x32x16_bf16 v[76:91], v[172:175], v[180:183], v[76:91]
  ds_read_b128 v[124:127], v18 offset:0
  ds_read_b128 v[164:167], v22 offset:0
  v_mul_f32 v74, 0xbfb8aa3b, v74
  v_exp_f32 v74, v74
  s_waitcnt lgkmcnt(2)
  v_mfma_f32_32x32x16_bf16 v[92:107], v[172:175], v[184:187], v[92:107]
  ds_read_b128 v[160:163], v18 offset:4096
  ds_read_b128 v[168:171], v22 offset:4096
  v_add_f32 v74, 1.0, v74
  v_mfma_f32_32x32x16_bf16 v[144:159], v[176:179], v[184:187], v[144:159]
  s_add_u32 m0, s16, 49152
  s_nop 0
  buffer_load_dwordx4 v8, s[44:47], s10 offen offset:0 lds
  v_rcp_f32 v74, v74
  s_nop 0
  v_cvt_pk_bf16_f32 v74, v74, v74
  v_mfma_f32_32x32x16_bf16 v[108:123], v[176:179], v[180:183], v[108:123]
  buffer_load_dwordx4 v9, s[44:47], s10 offen offset:1024 lds
  v_and_b32 v74, 0xffff0000, v74
  s_waitcnt lgkmcnt(2)
  v_mfma_f32_32x32x16_bf16 v[76:91], v[124:127], v[164:167], v[76:91]
  ds_read_b128 v[172:175], v19 offset:0
  ds_read_b128 v[180:183], v23 offset:0
  s_and_b32 s22, s18, 1
  s_lshl_b32 s22, s22, 2
  s_waitcnt lgkmcnt(2)
  v_mfma_f32_32x32x16_bf16 v[92:107], v[124:127], v[168:171], v[92:107]
  ds_read_b128 v[176:179], v19 offset:4096
  ds_read_b128 v[184:187], v23 offset:4096
  s_add_u32 s22, s22, s3
  s_lshl_b32 s22, s22, 10
  v_mfma_f32_32x32x16_bf16 v[144:159], v[160:163], v[168:171], v[144:159]
  buffer_load_dwordx4 v10, s[44:47], s10 offen offset:2048 lds
  s_lshr_b32 s23, s18, 1
  v_mfma_f32_32x32x16_bf16 v[108:123], v[160:163], v[164:167], v[108:123]
  buffer_load_dwordx4 v11, s[44:47], s10 offen offset:3072 lds
  s_add_u32 s10, s10, 128
  s_and_b32 s10, s10, 0x7ff
  s_lshl_b32 s23, s23, 2
  s_add_u32 s22, s22, s23
  s_waitcnt vmcnt(16) lgkmcnt(0)
  s_barrier
  v_mfma_f32_32x32x16_bf16 v[76:91], v[172:175], v[180:183], v[76:91]
  ds_read_b128 v[124:127], v16 offset:16384
  ds_read_b128 v[164:167], v20 offset:16384
  v_lshrrev_b32 v136, 5, v4
  v_lshlrev_b32 v136, 9, v136
  v_mfma_f32_32x32x16_bf16 v[92:107], v[172:175], v[184:187], v[92:107]
  ds_read_b128 v[160:163], v16 offset:20480
  ds_read_b128 v[168:171], v20 offset:20480
  s_cmp_lg_u32 s3, 1
  s_cbranch_scc1 gated_mix__spectral_gfnet__ssm_conv_s5__prompt_kernel_skip14
  s_getpc_b64 s[26:27]
gated_mix__spectral_gfnet__ssm_conv_s5__prompt_kernel_pc13:
  s_lshr_b32 s36, s2, 3
  s_mul_i32 s36, s36, 512
  v_min_u32 v210, 3, v4
  v_lshl_add_u32 v210, v210, 7, s36
  v_min_u32 v210, gated_mix__spectral_gfnet__ssm_conv_s5__prompt_kernel_end-gated_mix__spectral_gfnet__ssm_conv_s5__prompt_kernel_pc13, v210
  v_mov_b32 v211, 0
  v_lshl_add_u64 v[210:211], v[210:211], 0, s[26:27]
  global_load_dword v1, v[210:211], off
gated_mix__spectral_gfnet__ssm_conv_s5__prompt_kernel_skip14:
  buffer_load_dword v208, v2, s[52:55], 0 offen sc1
  s_mov_b32 exec_lo, 1
  s_mov_b32 exec_hi, 1
  buffer_store_dword v74, v136, s[72:75], s22 offen sc1
  s_mov_b64 exec, -1
  v_mfma_f32_32x32x16_bf16 v[144:159], v[176:179], v[184:187], v[144:159]
  s_add_u32 m0, s17, 0
  s_nop 0
  buffer_load_dwordx4 v12, s[56:59], s10 offen offset:0 lds
  v_mfma_f32_32x32x16_bf16 v[108:123], v[176:179], v[180:183], v[108:123]
  buffer_load_dwordx4 v13, s[56:59], s10 offen offset:1024 lds
  s_waitcnt lgkmcnt(2)
  v_mfma_f32_32x32x16_bf16 v[76:91], v[124:127], v[164:167], v[76:91]
  ds_read_b128 v[172:175], v17 offset:16384
  ds_read_b128 v[180:183], v21 offset:16384
  v_lshlrev_b32 v29, 4, v4
  v_add_u32 v29, 147456, v29
  s_waitcnt lgkmcnt(2)
  v_mfma_f32_32x32x16_bf16 v[92:107], v[124:127], v[168:171], v[92:107]
  ds_read_b128 v[176:179], v17 offset:20480
  ds_read_b128 v[184:187], v21 offset:20480
  ds_read_b128 v[32:35], v29 offset:0
  v_mfma_f32_32x32x16_bf16 v[144:159], v[160:163], v[168:171], v[144:159]
  buffer_load_dwordx4 v14, s[56:59], s10 offen offset:2048 lds
  ds_read_b128 v[36:39], v29 offset:1024
  v_mfma_f32_32x32x16_bf16 v[108:123], v[160:163], v[164:167], v[108:123]
  buffer_load_dwordx4 v15, s[56:59], s10 offen offset:3072 lds
  ds_read_b128 a[224:227], v29 offset:2048
  s_waitcnt lgkmcnt(5)
  v_mfma_f32_32x32x16_bf16 v[76:91], v[172:175], v[180:183], v[76:91]
  ds_read_b128 v[124:127], v18 offset:16384
  ds_read_b128 v[164:167], v22 offset:16384
  ds_read_b128 a[228:231], v29 offset:3072
  s_waitcnt lgkmcnt(6)
  v_mfma_f32_32x32x16_bf16 v[92:107], v[172:175], v[184:187], v[92:107]
  ds_read_b128 v[160:163], v18 offset:20480
  ds_read_b128 v[168:171], v22 offset:20480
  ds_read_b128 a[248:251], v29 offset:4096
  v_mfma_f32_32x32x16_bf16 v[144:159], v[176:179], v[184:187], v[144:159]
  s_add_u32 m0, s16, 0
  s_nop 0
  buffer_load_dwordx4 v8, s[44:47], s10 offen offset:0 lds
  ds_read_b128 a[252:255], v29 offset:5120
  v_mfma_f32_32x32x16_bf16 v[108:123], v[176:179], v[180:183], v[108:123]
  buffer_load_dwordx4 v9, s[44:47], s10 offen offset:1024 lds
  ds_read_b128 a[232:235], v29 offset:6144
  s_waitcnt lgkmcnt(6)
  v_mfma_f32_32x32x16_bf16 v[76:91], v[124:127], v[164:167], v[76:91]
  ds_read_b128 v[172:175], v19 offset:16384
  ds_read_b128 v[180:183], v23 offset:16384
  ds_read_b128 a[236:239], v29 offset:7168
  s_waitcnt lgkmcnt(6)
  v_mfma_f32_32x32x16_bf16 v[92:107], v[124:127], v[168:171], v[92:107]
  ds_read_b128 v[176:179], v19 offset:20480
  ds_read_b128 v[184:187], v23 offset:20480
  ds_read_b128 v[40:43], v29 offset:8192
  v_mfma_f32_32x32x16_bf16 v[144:159], v[160:163], v[168:171], v[144:159]
  buffer_load_dwordx4 v10, s[44:47], s10 offen offset:2048 lds
  ds_read_b128 v[44:47], v29 offset:9216
  v_mfma_f32_32x32x16_bf16 v[108:123], v[160:163], v[164:167], v[108:123]
  buffer_load_dwordx4 v11, s[44:47], s10 offen offset:3072 lds
  s_add_u32 s10, s10, 128
  s_and_b32 s10, s10, 0x7ff
  ds_read_b128 v[48:51], v29 offset:10240
  s_waitcnt vmcnt(18) lgkmcnt(3)
  s_barrier
  v_mfma_f32_32x32x16_bf16 v[76:91], v[172:175], v[180:183], v[76:91]
  ds_read_b128 v[124:127], v16 offset:32768
  ds_read_b128 v[164:167], v20 offset:32768
  ds_read_b128 v[52:55], v29 offset:11264
  v_mfma_f32_32x32x16_bf16 v[92:107], v[172:175], v[184:187], v[92:107]
  ds_read_b128 v[160:163], v16 offset:36864
  ds_read_b128 v[168:171], v20 offset:36864
  ds_read_b128 a[240:243], v29 offset:12288
  v_mfma_f32_32x32x16_bf16 v[144:159], v[176:179], v[184:187], v[144:159]
  s_add_u32 m0, s17, 16384
  s_nop 0
  buffer_load_dwordx4 v12, s[56:59], s10 offen offset:0 lds
  ds_read_b128 a[244:247], v29 offset:13312
  v_mfma_f32_32x32x16_bf16 v[108:123], v[176:179], v[180:183], v[108:123]
  buffer_load_dwordx4 v13, s[56:59], s10 offen offset:1024 lds
  ds_read_b128 v[136:139], v29 offset:14336
  s_waitcnt lgkmcnt(6)
  v_mfma_f32_32x32x16_bf16 v[76:91], v[124:127], v[164:167], v[76:91]
  ds_read_b128 v[172:175], v17 offset:32768
  ds_read_b128 v[180:183], v21 offset:32768
  ds_read_b128 v[140:143], v29 offset:15360
  s_waitcnt lgkmcnt(6)
  v_mfma_f32_32x32x16_bf16 v[92:107], v[124:127], v[168:171], v[92:107]
  ds_read_b128 v[176:179], v17 offset:36864
  ds_read_b128 v[184:187], v21 offset:36864
  s_mov_b32 s76, s6
  v_mfma_f32_32x32x16_bf16 v[144:159], v[160:163], v[168:171], v[144:159]
  buffer_load_dwordx4 v14, s[56:59], s10 offen offset:2048 lds
  s_mov_b32 s77, s7
  v_mfma_f32_32x32x16_bf16 v[108:123], v[160:163], v[164:167], v[108:123]
  buffer_load_dwordx4 v15, s[56:59], s10 offen offset:3072 lds
  s_mov_b32 s78, 2101248
  s_waitcnt lgkmcnt(3)
  v_mfma_f32_32x32x16_bf16 v[76:91], v[172:175], v[180:183], v[76:91]
  ds_read_b128 v[124:127], v18 offset:32768
  ds_read_b128 v[164:167], v22 offset:32768
  s_mov_b32 s79, 0x20000
  s_waitcnt lgkmcnt(2)
  v_mfma_f32_32x32x16_bf16 v[92:107], v[172:175], v[184:187], v[92:107]
  ds_read_b128 v[160:163], v18 offset:36864
  ds_read_b128 v[168:171], v22 offset:36864
  s_mov_b32 s84, s8
  v_mfma_f32_32x32x16_bf16 v[144:159], v[176:179], v[184:187], v[144:159]
  s_add_u32 m0, s16, 16384
  s_nop 0
  buffer_load_dwordx4 v8, s[44:47], s10 offen offset:0 lds
  s_mov_b32 s85, s9
  v_mfma_f32_32x32x16_bf16 v[108:123], v[176:179], v[180:183], v[108:123]
  buffer_load_dwordx4 v9, s[44:47], s10 offen offset:1024 lds
  s_mov_b32 s86, 2101248
  s_waitcnt lgkmcnt(2)
  v_mfma_f32_32x32x16_bf16 v[76:91], v[124:127], v[164:167], v[76:91]
  ds_read_b128 v[172:175], v19 offset:32768
  ds_read_b128 v[180:183], v23 offset:32768
  s_mov_b32 s87, 0x20000
  s_waitcnt lgkmcnt(2)
  v_mfma_f32_32x32x16_bf16 v[92:107], v[124:127], v[168:171], v[92:107]
  ds_read_b128 v[176:179], v19 offset:36864
  ds_read_b128 v[184:187], v23 offset:36864
  s_lshl_b32 s88, s3, 9
  v_mfma_f32_32x32x16_bf16 v[144:159], v[160:163], v[168:171], v[144:159]
  buffer_load_dwordx4 v10, s[44:47], s10 offen offset:2048 lds
  s_add_u32 s88, s88, s13
  v_mfma_f32_32x32x16_bf16 v[108:123], v[160:163], v[164:167], v[108:123]
  buffer_load_dwordx4 v11, s[44:47], s10 offen offset:3072 lds
  s_add_u32 s10, s10, 128
  s_and_b32 s10, s10, 0x7ff
  s_lshr_b32 s8, s3, 1
  s_waitcnt vmcnt(18) lgkmcnt(0)
  s_barrier
  v_mfma_f32_32x32x16_bf16 v[76:91], v[172:175], v[180:183], v[76:91]
  ds_read_b128 v[124:127], v16 offset:49152
  ds_read_b128 v[164:167], v20 offset:49152
  s_and_b32 s8, s8, s14
  v_mfma_f32_32x32x16_bf16 v[92:107], v[172:175], v[184:187], v[92:107]
  ds_read_b128 v[160:163], v16 offset:53248
  ds_read_b128 v[168:171], v20 offset:53248
  s_mul_i32 s8, s8, 960
  v_mfma_f32_32x32x16_bf16 v[144:159], v[176:179], v[184:187], v[144:159]
  s_add_u32 m0, s17, 32768
  s_nop 0
  buffer_load_dwordx4 v12, s[56:59], s10 offen offset:0 lds
  s_sub_u32 s88, s88, s8
  v_mfma_f32_32x32x16_bf16 v[108:123], v[176:179], v[180:183], v[108:123]
  buffer_load_dwordx4 v13, s[56:59], s10 offen offset:1024 lds
  s_add_u32 s90, s88, 128
  s_waitcnt lgkmcnt(2)
  v_mfma_f32_32x32x16_bf16 v[76:91], v[124:127], v[164:167], v[76:91]
  ds_read_b128 v[172:175], v17 offset:49152
  ds_read_b128 v[180:183], v21 offset:49152
  s_add_u32 s92, s88, 256
  s_waitcnt lgkmcnt(2)
  v_mfma_f32_32x32x16_bf16 v[92:107], v[124:127], v[168:171], v[92:107]
  ds_read_b128 v[176:179], v17 offset:53248
  ds_read_b128 v[184:187], v21 offset:53248
  s_add_u32 s94, s88, 384
  v_mfma_f32_32x32x16_bf16 v[144:159], v[160:163], v[168:171], v[144:159]
  buffer_load_dwordx4 v14, s[56:59], s10 offen offset:2048 lds
  s_sub_u32 s89, 2048, s88
  v_mfma_f32_32x32x16_bf16 v[108:123], v[160:163], v[164:167], v[108:123]
  buffer_load_dwordx4 v15, s[56:59], s10 offen offset:3072 lds
  s_and_b32 s89, s89, 2047
  s_waitcnt lgkmcnt(2)
  v_mfma_f32_32x32x16_bf16 v[76:91], v[172:175], v[180:183], v[76:91]
  ds_read_b128 v[124:127], v18 offset:49152
  ds_read_b128 v[164:167], v22 offset:49152
  s_sub_u32 s91, 2048, s90
  s_waitcnt lgkmcnt(2)
  v_mfma_f32_32x32x16_bf16 v[92:107], v[172:175], v[184:187], v[92:107]
  ds_read_b128 v[160:163], v18 offset:53248
  ds_read_b128 v[168:171], v22 offset:53248
  s_and_b32 s91, s91, 2047
  v_mfma_f32_32x32x16_bf16 v[144:159], v[176:179], v[184:187], v[144:159]
  s_add_u32 m0, s16, 32768
  s_nop 0
  buffer_load_dwordx4 v8, s[44:47], s10 offen offset:0 lds
  s_sub_u32 s93, 2048, s92
  v_mfma_f32_32x32x16_bf16 v[108:123], v[176:179], v[180:183], v[108:123]
  buffer_load_dwordx4 v9, s[44:47], s10 offen offset:1024 lds
  s_and_b32 s93, s93, 2047
  s_waitcnt lgkmcnt(2)
  v_mfma_f32_32x32x16_bf16 v[76:91], v[124:127], v[164:167], v[76:91]
  ds_read_b128 v[172:175], v19 offset:49152
  ds_read_b128 v[180:183], v23 offset:49152
  s_sub_u32 s95, 2048, s94
  s_waitcnt lgkmcnt(2)
  v_mfma_f32_32x32x16_bf16 v[92:107], v[124:127], v[168:171], v[92:107]
  ds_read_b128 v[176:179], v19 offset:53248
  ds_read_b128 v[184:187], v23 offset:53248
  s_and_b32 s95, s95, 2047
  v_mfma_f32_32x32x16_bf16 v[144:159], v[160:163], v[168:171], v[144:159]
  buffer_load_dwordx4 v10, s[44:47], s10 offen offset:2048 lds
  s_cmp_eq_u32 s3, 0
  s_cselect_b32 s9, s14, 0
  v_mfma_f32_32x32x16_bf16 v[108:123], v[160:163], v[164:167], v[108:123]
  buffer_load_dwordx4 v11, s[44:47], s10 offen offset:3072 lds
  s_add_u32 s10, s10, 128
  s_and_b32 s10, s10, 0x7ff
  s_waitcnt vmcnt(24)
  s_waitcnt vmcnt(16) lgkmcnt(0)
  s_barrier
  v_mfma_f32_32x32x16_bf16 v[76:91], v[172:175], v[180:183], v[76:91]
  ds_read_b128 v[124:127], v16 offset:0
  ds_read_b128 v[164:167], v20 offset:0
  s_cmp_eq_u32 s9, 1
  s_cselect_b32 s89, 1024, s89
  v_mfma_f32_32x32x16_bf16 v[92:107], v[172:175], v[184:187], v[92:107]
  ds_read_b128 v[160:163], v16 offset:4096
  ds_read_b128 v[168:171], v20 offset:4096
  v_cmp_ne_u32 vcc, 1, v208
  s_nop 0
  s_cbranch_vccz gated_mix__spectral_gfnet__ssm_conv_s5__prompt_kernel_skip15
  s_mov_b32 s26, 0
gated_mix__spectral_gfnet__ssm_conv_s5__prompt_kernel_poll16:
  s_sleep 5
  buffer_load_dword v208, v2, s[52:55], 0 offen sc1
  s_waitcnt vmcnt(0)
  v_cmp_ne_u32 vcc, 1, v208
  s_nop 0
  s_cbranch_vccz gated_mix__spectral_gfnet__ssm_conv_s5__prompt_kernel_pollout17
  s_add_u32 s26, s26, 1
  s_cmp_lt_u32 s26, 1048576
  s_cbranch_scc1 gated_mix__spectral_gfnet__ssm_conv_s5__prompt_kernel_poll16
gated_mix__spectral_gfnet__ssm_conv_s5__prompt_kernel_pollout17:
gated_mix__spectral_gfnet__ssm_conv_s5__prompt_kernel_skip15:
  s_cmp_lg_u32 s3, 0
  s_cbranch_scc1 gated_mix__spectral_gfnet__ssm_conv_s5__prompt_kernel_skip18
  s_mov_b64 exec, 1
  buffer_store_dword v7, v24, s[48:51], 0 offen sc1
  s_mov_b64 exec, -1
gated_mix__spectral_gfnet__ssm_conv_s5__prompt_kernel_skip18:
  v_mfma_f32_32x32x16_bf16 v[144:159], v[176:179], v[184:187], v[144:159]
  s_add_u32 m0, s17, 49152
  s_nop 0
  buffer_load_dwordx4 v12, s[56:59], s10 offen offset:0 lds
  s_mul_i32 s88, s88, 1026
  v_mfma_f32_32x32x16_bf16 v[108:123], v[176:179], v[180:183], v[108:123]
  buffer_load_dwordx4 v13, s[56:59], s10 offen offset:1024 lds
  s_mul_i32 s89, s89, 1026
  s_waitcnt lgkmcnt(2)
  v_mfma_f32_32x32x16_bf16 v[76:91], v[124:127], v[164:167], v[76:91]
  ds_read_b128 v[172:175], v17 offset:0
  ds_read_b128 v[180:183], v21 offset:0
  s_mul_i32 s90, s90, 1026
  s_waitcnt lgkmcnt(2)
  v_mfma_f32_32x32x16_bf16 v[92:107], v[124:127], v[168:171], v[92:107]
  ds_read_b128 v[176:179], v17 offset:4096
  ds_read_b128 v[184:187], v21 offset:4096
  s_mul_i32 s91, s91, 1026
  v_mfma_f32_32x32x16_bf16 v[144:159], v[160:163], v[168:171], v[144:159]
  buffer_load_dwordx4 v14, s[56:59], s10 offen offset:2048 lds
  s_mul_i32 s92, s92, 1026
  v_mfma_f32_32x32x16_bf16 v[108:123], v[160:163], v[164:167], v[108:123]
  buffer_load_dwordx4 v15, s[56:59], s10 offen offset:3072 lds
  s_mul_i32 s93, s93, 1026
  s_waitcnt lgkmcnt(2)
  v_mfma_f32_32x32x16_bf16 v[76:91], v[172:175], v[180:183], v[76:91]
  ds_read_b128 v[124:127], v18 offset:0
  ds_read_b128 v[164:167], v22 offset:0
  s_mul_i32 s94, s94, 1026
  s_waitcnt lgkmcnt(2)
  v_mfma_f32_32x32x16_bf16 v[92:107], v[172:175], v[184:187], v[92:107]
  ds_read_b128 v[160:163], v18 offset:4096
  ds_read_b128 v[168:171], v22 offset:4096
  s_mul_i32 s95, s95, 1026
  v_mfma_f32_32x32x16_bf16 v[144:159], v[176:179], v[184:187], v[144:159]
  s_add_u32 m0, s16, 49152
  s_nop 0
  buffer_load_dwordx4 v8, s[44:47], s10 offen offset:0 lds
  v_lshlrev_b32 v29, 4, v4
  v_mfma_f32_32x32x16_bf16 v[108:123], v[176:179], v[180:183], v[108:123]
  buffer_load_dwordx4 v9, s[44:47], s10 offen offset:1024 lds
  s_lshl_b32 s6, s3, 12
  s_waitcnt lgkmcnt(2)
  v_mfma_f32_32x32x16_bf16 v[76:91], v[124:127], v[164:167], v[76:91]
  ds_read_b128 v[172:175], v19 offset:0
  ds_read_b128 v[180:183], v23 offset:0
  s_and_b32 s8, s88, 15
  s_waitcnt lgkmcnt(2)
  v_mfma_f32_32x32x16_bf16 v[92:107], v[124:127], v[168:171], v[92:107]
  ds_read_b128 v[176:179], v19 offset:4096
  ds_read_b128 v[184:187], v23 offset:4096
  s_and_b32 s28, s89, 15
  v_mfma_f32_32x32x16_bf16 v[144:159], v[160:163], v[168:171], v[144:159]
  buffer_load_dwordx4 v10, s[44:47], s10 offen offset:2048 lds
  s_add_u32 s28, s28, 2048
  v_mfma_f32_32x32x16_bf16 v[108:123], v[160:163], v[164:167], v[108:123]
  buffer_load_dwordx4 v11, s[44:47], s10 offen offset:3072 lds
  s_add_u32 s10, s10, 128
  s_and_b32 s10, s10, 0x7ff
  v_lshlrev_b32 v57, 9, v6
  s_waitcnt vmcnt(16) lgkmcnt(0)
  s_barrier
  v_mfma_f32_32x32x16_bf16 v[76:91], v[172:175], v[180:183], v[76:91]
  ds_read_b128 v[124:127], v16 offset:16384
  ds_read_b128 v[164:167], v20 offset:16384
  v_lshl_add_u32 v57, v5, 3, v57
  v_mfma_f32_32x32x16_bf16 v[92:107], v[172:175], v[184:187], v[92:107]
  ds_read_b128 v[160:163], v16 offset:20480
  ds_read_b128 v[168:171], v20 offset:20480
  s_lshl_b32 s29, s12, 1
  v_mfma_f32_32x32x16_bf16 v[144:159], v[176:179], v[184:187], v[144:159]
  s_add_u32 m0, s17, 0
  s_nop 0
  buffer_load_dwordx4 v12, s[56:59], s10 offen offset:0 lds
  v_add_u32 v57, s29, v57
  v_mfma_f32_32x32x16_bf16 v[108:123], v[176:179], v[180:183], v[108:123]
  buffer_load_dwordx4 v13, s[56:59], s10 offen offset:1024 lds
  s_add_u32 s29, s28, 1664
  s_waitcnt lgkmcnt(2)
  v_mfma_f32_32x32x16_bf16 v[76:91], v[124:127], v[164:167], v[76:91]
  ds_read_b128 v[172:175], v17 offset:16384
  ds_read_b128 v[180:183], v21 offset:16384
  v_sub_u32 v75, s29, v57
  s_waitcnt lgkmcnt(2)
  v_mfma_f32_32x32x16_bf16 v[92:107], v[124:127], v[168:171], v[92:107]
  ds_read_b128 v[176:179], v17 offset:20480
  ds_read_b128 v[184:187], v21 offset:20480
  v_add_u32 v57, s8, v57
  v_mfma_f32_32x32x16_bf16 v[144:159], v[160:163], v[168:171], v[144:159]
  buffer_load_dwordx4 v14, s[56:59], s10 offen offset:2048 lds
  v_cmp_lt_u32 s[22:23], 1, v6
  v_mfma_f32_32x32x16_bf16 v[108:123], v[160:163], v[164:167], v[108:123]
  buffer_load_dwordx4 v15, s[56:59], s10 offen offset:3072 lds
  v_cndmask_b32 v57, v57, v75, s[22:23]
  s_waitcnt lgkmcnt(2)
  v_mfma_f32_32x32x16_bf16 v[76:91], v[172:175], v[180:183], v[76:91]
  ds_read_b128 v[124:127], v18 offset:16384
  ds_read_b128 v[164:167], v22 offset:16384
  v_cndmask_b32 v188, 1.0, -1.0, s[22:23]
  s_waitcnt lgkmcnt(2)
  v_mfma_f32_32x32x16_bf16 v[92:107], v[172:175], v[184:187], v[92:107]
  ds_read_b128 v[160:163], v18 offset:20480
  ds_read_b128 v[168:171], v22 offset:20480
  v_add_u32 v74, 384, v57
  v_mfma_f32_32x32x16_bf16 v[144:159], v[176:179], v[184:187], v[144:159]
  s_add_u32 m0, s16, 0
  s_nop 0
  buffer_load_dwordx4 v8, s[44:47], s10 offen offset:0 lds
  v_and_b32 v75, 1024, v74
  v_mfma_f32_32x32x16_bf16 v[108:123], v[176:179], v[180:183], v[108:123]
  buffer_load_dwordx4 v9, s[44:47], s10 offen offset:1024 lds
  v_cmp_ne_u32 s[24:25], 0, v75
  s_waitcnt lgkmcnt(2)
  v_mfma_f32_32x32x16_bf16 v[76:91], v[124:127], v[164:167], v[76:91]
  ds_read_b128 v[172:175], v19 offset:16384
  ds_read_b128 v[180:183], v23 offset:16384
  s_lshl_b32 s29, s3, 8
  s_waitcnt lgkmcnt(2)
  v_mfma_f32_32x32x16_bf16 v[92:107], v[124:127], v[168:171], v[92:107]
  ds_read_b128 v[176:179], v19 offset:20480
  ds_read_b128 v[184:187], v23 offset:20480
  s_add_u32 s29, s29, 146432
  v_mfma_f32_32x32x16_bf16 v[144:159], v[160:163], v[168:171], v[144:159]
  buffer_load_dwordx4 v10, s[44:47], s10 offen offset:2048 lds
  v_add_u32 v75, s29, v74
  v_mfma_f32_32x32x16_bf16 v[108:123], v[160:163], v[164:167], v[108:123]
  buffer_load_dwordx4 v11, s[44:47], s10 offen offset:3072 lds
  s_add_u32 s10, s10, 128
  s_and_b32 s10, s10, 0x7ff
  v_add_u32 v57, s6, v57
  s_waitcnt vmcnt(16) lgkmcnt(0)
  s_barrier
  v_mfma_f32_32x32x16_bf16 v[76:91], v[172:175], v[180:183], v[76:91]
  ds_read_b128 v[124:127], v16 offset:32768
  ds_read_b128 v[164:167], v20 offset:32768
  v_add_u32 v74, s6, v74
  v_mfma_f32_32x32x16_bf16 v[92:107], v[172:175], v[184:187], v[92:107]
  ds_read_b128 v[160:163], v16 offset:36864
  ds_read_b128 v[168:171], v20 offset:36864
  v_cndmask_b32 v74, v74, v75, s[24:25]
  v_mfma_f32_32x32x16_bf16 v[144:159], v[176:179], v[184:187], v[144:159]
  s_add_u32 m0, s17, 16384
  s_nop 0
  buffer_load_dwordx4 v12, s[56:59], s10 offen offset:0 lds
  v_sub_u32 v74, v74, v57
  v_mfma_f32_32x32x16_bf16 v[108:123], v[176:179], v[180:183], v[108:123]
  buffer_load_dwordx4 v13, s[56:59], s10 offen offset:1024 lds
  v_cndmask_b32 v189, 0, -1, s[24:25]
  s_waitcnt lgkmcnt(2)
  v_mfma_f32_32x32x16_bf16 v[76:91], v[124:127], v[164:167], v[76:91]
  ds_read_b128 v[172:175], v17 offset:32768
  ds_read_b128 v[180:183], v21 offset:32768
  v_lshlrev_b32 v26, 16, v26
  v_lshlrev_b32 v27, 16, v27
  s_waitcnt lgkmcnt(2)
  v_mfma_f32_32x32x16_bf16 v[92:107], v[124:127], v[168:171], v[92:107]
  ds_read_b128 v[176:179], v17 offset:36864
  ds_read_b128 v[184:187], v21 offset:36864
  v_lshlrev_b32 v28, 16, v28
  v_mfma_f32_32x32x16_bf16 v[144:159], v[160:163], v[168:171], v[144:159]
  buffer_load_dwordx4 v14, s[56:59], s10 offen offset:2048 lds
  v_mul_f32 v28, 0x3fb8aa3b, v28
  v_mfma_f32_32x32x16_bf16 v[108:123], v[160:163], v[164:167], v[108:123]
  buffer_load_dwordx4 v15, s[56:59], s10 offen offset:3072 lds
  v_exp_f32 v28, v28
  s_waitcnt lgkmcnt(2)
  v_mfma_f32_32x32x16_bf16 v[76:91], v[172:175], v[180:183], v[76:91]
  ds_read_b128 v[124:127], v18 offset:32768
  ds_read_b128 v[164:167], v22 offset:32768
  v_cvt_pk_bf16_f32 v28, v28, v28
  v_and_b32 v28, 0xffff0000, v28
  s_waitcnt lgkmcnt(2)
  v_mfma_f32_32x32x16_bf16 v[92:107], v[172:175], v[184:187], v[92:107]
  ds_read_b128 v[160:163], v18 offset:36864
  ds_read_b128 v[168:171], v22 offset:36864
  v_mul_f32 v204, v28, v26
  v_mfma_f32_32x32x16_bf16 v[144:159], v[176:179], v[184:187], v[144:159]
  s_add_u32 m0, s16, 16384
  s_nop 0
  buffer_load_dwordx4 v8, s[44:47], s10 offen offset:0 lds
  v_mul_f32 v205, v28, v27
  v_mfma_f32_32x32x16_bf16 v[108:123], v[176:179], v[180:183], v[108:123]
  buffer_load_dwordx4 v9, s[44:47], s10 offen offset:1024 lds
  v_mul_f32 v204, 0x3fb8aa3b, v204
  s_waitcnt lgkmcnt(2)
  v_mfma_f32_32x32x16_bf16 v[76:91], v[124:127], v[164:167], v[76:91]
  ds_read_b128 v[172:175], v19 offset:32768
  ds_read_b128 v[180:183], v23 offset:32768
  v_mul_f32 v205, 0.15915494, v205
  s_waitcnt lgkmcnt(2)
  v_mfma_f32_32x32x16_bf16 v[92:107], v[124:127], v[168:171], v[92:107]
  ds_read_b128 v[176:179], v19 offset:36864
  ds_read_b128 v[184:187], v23 offset:36864
  v_exp_f32 v204, v204
  v_rndne_f32 v206, v205
  v_mfma_f32_32x32x16_bf16 v[144:159], v[160:163], v[168:171], v[144:159]
  buffer_load_dwordx4 v10, s[44:47], s10 offen offset:2048 lds
  v_sub_f32 v205, v205, v206
  v_mfma_f32_32x32x16_bf16 v[108:123], v[160:163], v[164:167], v[108:123]
  buffer_load_dwordx4 v11, s[44:47], s10 offen offset:3072 lds
  s_add_u32 s10, s10, 128
  s_and_b32 s10, s10, 0x7ff
  v_cos_f32 v206, v205
  s_waitcnt vmcnt(16) lgkmcnt(0)
  s_barrier
  v_mfma_f32_32x32x16_bf16 v[76:91], v[172:175], v[180:183], v[76:91]
  ds_read_b128 v[124:127], v16 offset:49152
  ds_read_b128 v[164:167], v20 offset:49152
  v_sin_f32 v207, v205
  v_mfma_f32_32x32x16_bf16 v[92:107], v[172:175], v[184:187], v[92:107]
  ds_read_b128 v[160:163], v16 offset:53248
  ds_read_b128 v[168:171], v20 offset:53248
  v_mul_f32 v190, v204, v206
  v_mfma_f32_32x32x16_bf16 v[144:159], v[176:179], v[184:187], v[144:159]
  s_add_u32 m0, s17, 32768
  s_nop 0
  buffer_load_dwordx4 v12, s[56:59], s10 offen offset:0 lds
  v_mul_f32 v191, v204, v207
  v_mul_f32 v204, v26, v26
  v_mfma_f32_32x32x16_bf16 v[108:123], v[176:179], v[180:183], v[108:123]
  buffer_load_dwordx4 v13, s[56:59], s10 offen offset:1024 lds
  v_fma_f32 v204, v27, v27, v204
  s_waitcnt lgkmcnt(2)
  v_mfma_f32_32x32x16_bf16 v[76:91], v[124:127], v[164:167], v[76:91]
  ds_read_b128 v[172:175], v17 offset:49152
  ds_read_b128 v[180:183], v21 offset:49152
  v_rcp_f32 v204, v204
  s_waitcnt lgkmcnt(2)
  v_mfma_f32_32x32x16_bf16 v[92:107], v[124:127], v[168:171], v[92:107]
  ds_read_b128 v[176:179], v17 offset:53248
  ds_read_b128 v[184:187], v21 offset:53248
  v_add_f32 v205, -1.0, v190
  v_mfma_f32_32x32x16_bf16 v[144:159], v[160:163], v[168:171], v[144:159]
  buffer_load_dwordx4 v14, s[56:59], s10 offen offset:2048 lds
  v_add_f32 v204, v204, v204
  v_mul_f32 v206, v205, v26
  v_mfma_f32_32x32x16_bf16 v[108:123], v[160:163], v[164:167], v[108:123]
  buffer_load_dwordx4 v15, s[56:59], s10 offen offset:3072 lds
  v_fma_f32 v206, v191, v27, v206
  s_waitcnt lgkmcnt(2)
  v_mfma_f32_32x32x16_bf16 v[76:91], v[172:175], v[180:183], v[76:91]
  ds_read_b128 v[124:127], v18 offset:49152
  ds_read_b128 v[164:167], v22 offset:49152
  v_mul_f32 v207, v191, v26
  s_waitcnt lgkmcnt(2)
  v_mfma_f32_32x32x16_bf16 v[92:107], v[172:175], v[184:187], v[92:107]
  ds_read_b128 v[160:163], v18 offset:53248
  ds_read_b128 v[168:171], v22 offset:53248
  v_fma_f32 v207, -v205, v27, v207
  v_mfma_f32_32x32x16_bf16 v[144:159], v[176:179], v[184:187], v[144:159]
  s_add_u32 m0, s16, 32768
  s_nop 0
  buffer_load_dwordx4 v8, s[44:47], s10 offen offset:0 lds
  v_mul_f32 v200, v206, v204
  v_mfma_f32_32x32x16_bf16 v[108:123], v[176:179], v[180:183], v[108:123]
  buffer_load_dwordx4 v9, s[44:47], s10 offen offset:1024 lds
  v_mul_f32 v201, v207, v204
  v_mul_f32 v204, v191, v191
  s_waitcnt lgkmcnt(2)
  v_mfma_f32_32x32x16_bf16 v[76:91], v[124:127], v[164:167], v[76:91]
  ds_read_b128 v[172:175], v19 offset:49152
  ds_read_b128 v[180:183], v23 offset:49152
  v_mul_f32 v193, v190, v191
  s_waitcnt lgkmcnt(2)
  v_mfma_f32_32x32x16_bf16 v[92:107], v[124:127], v[168:171], v[92:107]
  ds_read_b128 v[176:179], v19 offset:53248
  ds_read_b128 v[184:187], v23 offset:53248
  v_fma_f32 v192, v190, v190, -v204
  v_mfma_f32_32x32x16_bf16 v[144:159], v[160:163], v[168:171], v[144:159]
  buffer_load_dwordx4 v10, s[44:47], s10 offen offset:2048 lds
  v_add_f32 v193, v193, v193
  v_mfma_f32_32x32x16_bf16 v[108:123], v[160:163], v[164:167], v[108:123]
  buffer_load_dwordx4 v11, s[44:47], s10 offen offset:3072 lds
  s_add_u32 s10, s10, 128
  s_and_b32 s10, s10, 0x7ff
  v_mul_f32 v204, v193, v193
  s_waitcnt vmcnt(16) lgkmcnt(0)
  s_barrier
  v_mfma_f32_32x32x16_bf16 v[76:91], v[172:175], v[180:183], v[76:91]
  ds_read_b128 v[124:127], v16 offset:0
  ds_read_b128 v[164:167], v20 offset:0
  v_mul_f32 v193, v192, v193
  v_fma_f32 v192, v192, v192, -v204
  v_mfma_f32_32x32x16_bf16 v[92:107], v[172:175], v[184:187], v[92:107]
  ds_read_b128 v[160:163], v16 offset:4096
  ds_read_b128 v[168:171], v20 offset:4096
  s_cmp_lg_u32 s3, 2
  s_cbranch_scc1 gated_mix__spectral_gfnet__ssm_conv_s5__prompt_kernel_skip20
  s_getpc_b64 s[26:27]
gated_mix__spectral_gfnet__ssm_conv_s5__prompt_kernel_pc19:
  s_lshr_b32 s36, s2, 3
  s_mul_i32 s36, s36, 512
  v_min_u32 v210, 3, v4
  v_lshl_add_u32 v210, v210, 7, s36
  v_min_u32 v210, gated_mix__spectral_gfnet__ssm_conv_s5__prompt_kernel_end-gated_mix__spectral_gfnet__ssm_conv_s5__prompt_kernel_pc19, v210
  v_mov_b32 v211, 0
  v_lshl_add_u64 v[210:211], v[210:211], 0, s[26:27]
  global_load_dword v1, v[210:211], off
gated_mix__spectral_gfnet__ssm_conv_s5__prompt_kernel_skip20:
  v_add_f32 v193, v193, v193
  v_mfma_f32_32x32x16_bf16 v[144:159], v[176:179], v[184:187], v[144:159]
  s_add_u32 m0, s17, 49152
  s_nop 0
  buffer_load_dwordx4 v12, s[56:59], s10 offen offset:0 lds
  v_mul_f32 v204, v193, v193
  v_mfma_f32_32x32x16_bf16 v[108:123], v[176:179], v[180:183], v[108:123]
  buffer_load_dwordx4 v13, s[56:59], s10 offen offset:1024 lds
  v_mul_f32 v193, v192, v193
  s_waitcnt lgkmcnt(2)
  v_mfma_f32_32x32x16_bf16 v[76:91], v[124:127], v[164:167], v[76:91]
  ds_read_b128 v[172:175], v17 offset:0
  ds_read_b128 v[180:183], v21 offset:0
  v_fma_f32 v192, v192, v192, -v204
  v_add_f32 v193, v193, v193
  s_waitcnt lgkmcnt(2)
  v_mfma_f32_32x32x16_bf16 v[92:107], v[124:127], v[168:171], v[92:107]
  ds_read_b128 v[176:179], v17 offset:4096
  ds_read_b128 v[184:187], v21 offset:4096
  v_mul_f32 v204, v193, v193
  v_mfma_f32_32x32x16_bf16 v[144:159], v[160:163], v[168:171], v[144:159]
  buffer_load_dwordx4 v14, s[56:59], s10 offen offset:2048 lds
  v_mul_f32 v193, v192, v193
  v_mfma_f32_32x32x16_bf16 v[108:123], v[160:163], v[164:167], v[108:123]
  buffer_load_dwordx4 v15, s[56:59], s10 offen offset:3072 lds
  v_fma_f32 v192, v192, v192, -v204
  s_waitcnt lgkmcnt(2)
  v_mfma_f32_32x32x16_bf16 v[76:91], v[172:175], v[180:183], v[76:91]
  ds_read_b128 v[124:127], v18 offset:0
  ds_read_b128 v[164:167], v22 offset:0
  v_add_f32 v193, v193, v193
  s_waitcnt lgkmcnt(2)
  v_mfma_f32_32x32x16_bf16 v[92:107], v[172:175], v[184:187], v[92:107]
  ds_read_b128 v[160:163], v18 offset:4096
  ds_read_b128 v[168:171], v22 offset:4096
  v_mul_f32 v204, v193, v193
  v_mul_f32 v195, v192, v193
  v_mfma_f32_32x32x16_bf16 v[144:159], v[176:179], v[184:187], v[144:159]
  s_add_u32 m0, s16, 49152
  s_nop 0
  buffer_load_dwordx4 v8, s[44:47], s10 offen offset:0 lds
  v_fma_f32 v194, v192, v192, -v204
  v_mfma_f32_32x32x16_bf16 v[108:123], v[176:179], v[180:183], v[108:123]
  buffer_load_dwordx4 v9, s[44:47], s10 offen offset:1024 lds
  v_add_f32 v195, v195, v195
  s_waitcnt lgkmcnt(2)
  v_mfma_f32_32x32x16_bf16 v[76:91], v[124:127], v[164:167], v[76:91]
  ds_read_b128 v[172:175], v19 offset:0
  ds_read_b128 v[180:183], v23 offset:0
  v_mul_f32 v204, v195, v195
  s_waitcnt lgkmcnt(2)
  v_mfma_f32_32x32x16_bf16 v[92:107], v[124:127], v[168:171], v[92:107]
  ds_read_b128 v[176:179], v19 offset:4096
  ds_read_b128 v[184:187], v23 offset:4096
  v_mul_f32 v197, v194, v195
  v_mfma_f32_32x32x16_bf16 v[144:159], v[160:163], v[168:171], v[144:159]
  buffer_load_dwordx4 v10, s[44:47], s10 offen offset:2048 lds
  v_fma_f32 v196, v194, v194, -v204
  v_add_f32 v197, v197, v197
  v_mfma_f32_32x32x16_bf16 v[108:123], v[160:163], v[164:167], v[108:123]
  buffer_load_dwordx4 v11, s[44:47], s10 offen offset:3072 lds
  s_add_u32 s10, s10, 128
  s_and_b32 s10, s10, 0x7ff
  v_mul_f32 v204, v197, v197
  s_waitcnt vmcnt(16) lgkmcnt(0)
  s_barrier
  v_mfma_f32_32x32x16_bf16 v[76:91], v[172:175], v[180:183], v[76:91]
  ds_read_b128 v[124:127], v16 offset:16384
  ds_read_b128 v[164:167], v20 offset:16384
  v_mul_f32 v203, v196, v197
  v_mfma_f32_32x32x16_bf16 v[92:107], v[172:175], v[184:187], v[92:107]
  ds_read_b128 v[160:163], v16 offset:20480
  ds_read_b128 v[168:171], v20 offset:20480
  v_fma_f32 v202, v196, v196, -v204
  v_mfma_f32_32x32x16_bf16 v[144:159], v[176:179], v[184:187], v[144:159]
  buffer_load_dword v209, v3, s[48:51], 0 offen sc1
  v_mov_b32 v56, 2130706432
  v_writelane_b32 v56, s88, 0
  v_writelane_b32 v56, s89, 1
  v_writelane_b32 v56, s90, 2
  v_writelane_b32 v56, s91, 3
  v_writelane_b32 v56, s92, 4
  v_writelane_b32 v56, s93, 5
  v_writelane_b32 v56, s94, 6
  v_writelane_b32 v56, s95, 7
  v_and_b32 v56, -16, v56
  s_mov_b64 exec, 255
  buffer_load_dwordx4 v[212:215], v56, s[76:79], 0 offen offset:1024
  buffer_load_dwordx4 v[216:219], v56, s[84:87], 0 offen offset:1024
  s_mov_b64 exec, -1
  v_add_f32 v203, v203, v203
  v_mfma_f32_32x32x16_bf16 v[108:123], v[176:179], v[180:183], v[108:123]
  s_and_b32 s7, s88, -16
  s_add_u32 m0, s6, 131072
  s_nop 0
  buffer_load_dwordx4 v29, s[76:79], s7 offen lds
  v_mul_f32 v204, v203, v203
  v_mul_f32 v199, v202, v203
  s_waitcnt lgkmcnt(2)
  v_mfma_f32_32x32x16_bf16 v[76:91], v[124:127], v[164:167], v[76:91]
  ds_read_b128 v[172:175], v17 offset:16384
  ds_read_b128 v[180:183], v21 offset:16384
  v_fma_f32 v198, v202, v202, -v204
  s_waitcnt lgkmcnt(2)
  v_mfma_f32_32x32x16_bf16 v[92:107], v[124:127], v[168:171], v[92:107]
  ds_read_b128 v[176:179], v17 offset:20480
  ds_read_b128 v[184:187], v21 offset:20480
  v_add_f32 v199, v199, v199
  v_mfma_f32_32x32x16_bf16 v[144:159], v[160:163], v[168:171], v[144:159]
  s_add_u32 m0, s6, 132096
  s_nop 0
  buffer_load_dwordx4 v29, s[84:87], s7 offen lds
  v_mul_f32 v204, v199, v199
  v_mfma_f32_32x32x16_bf16 v[108:123], v[160:163], v[164:167], v[108:123]
  s_and_b32 s7, s89, -16
  s_add_u32 m0, s6, 133120
  s_nop 0
  buffer_load_dwordx4 v29, s[76:79], s7 offen lds
  v_mul_f32 v199, v198, v199
  v_fma_f32 v198, v198, v198, -v204
  s_waitcnt lgkmcnt(2)
  v_mfma_f32_32x32x16_bf16 v[76:91], v[172:175], v[180:183], v[76:91]
  ds_read_b128 v[124:127], v18 offset:16384
  ds_read_b128 v[164:167], v22 offset:16384
  v_add_f32 v199, v199, v199
  s_waitcnt lgkmcnt(2)
  v_mfma_f32_32x32x16_bf16 v[92:107], v[172:175], v[184:187], v[92:107]
  ds_read_b128 v[160:163], v18 offset:20480
  ds_read_b128 v[168:171], v22 offset:20480
  v_mul_f32 v204, v199, v199
  v_mfma_f32_32x32x16_bf16 v[144:159], v[176:179], v[184:187], v[144:159]
  s_add_u32 m0, s6, 134144
  s_nop 0
  buffer_load_dwordx4 v29, s[84:87], s7 offen lds
  v_mul_f32 v199, v198, v199
  v_mfma_f32_32x32x16_bf16 v[108:123], v[176:179], v[180:183], v[108:123]
  s_and_b32 s7, s90, -16
  s_add_u32 m0, s6, 0
  s_nop 0
  buffer_load_dwordx4 v29, s[76:79], s7 offen lds
  v_fma_f32 v198, v198, v198, -v204
  s_waitcnt lgkmcnt(2)
  v_mfma_f32_32x32x16_bf16 v[76:91], v[124:127], v[164:167], v[76:91]
  ds_read_b128 v[172:175], v19 offset:16384
  ds_read_b128 v[180:183], v23 offset:16384
  v_add_f32 v199, v199, v199
  s_lshl_b32 s29, s3, 8
  s_waitcnt lgkmcnt(2)
  v_mfma_f32_32x32x16_bf16 v[92:107], v[124:127], v[168:171], v[92:107]
  ds_read_b128 v[176:179], v19 offset:20480
  ds_read_b128 v[184:187], v23 offset:20480
  s_add_u32 s29, s29, 147584
  v_mfma_f32_32x32x16_bf16 v[144:159], v[160:163], v[168:171], v[144:159]
  s_add_u32 m0, s6, 1024
  s_nop 0
  buffer_load_dwordx4 v29, s[84:87], s7 offen lds
  v_lshl_add_u32 v26, v5, 3, s29
  v_mfma_f32_32x32x16_bf16 v[108:123], v[160:163], v[164:167], v[108:123]
  s_and_b32 s7, s91, -16
  s_add_u32 m0, s6, 2048
  s_nop 0
  buffer_load_dwordx4 v29, s[76:79], s7 offen lds
  v_lshl_add_u32 v26, v6, 10, v26
  s_waitcnt vmcnt(18) lgkmcnt(0)
  s_barrier
  v_mfma_f32_32x32x16_bf16 v[76:91], v[172:175], v[180:183], v[76:91]
  ds_read_b128 v[124:127], v16 offset:32768
  ds_read_b128 v[164:167], v20 offset:32768
  s_sub_u32 s29, 15, s38
  v_mfma_f32_32x32x16_bf16 v[92:107], v[172:175], v[184:187], v[92:107]
  ds_read_b128 v[160:163], v16 offset:36864
  ds_read_b128 v[168:171], v20 offset:36864
  s_lshl_b32 s29, s29, 9
  s_and_b32 s32, s3, 1
  v_mfma_f32_32x32x16_bf16 v[144:159], v[176:179], v[184:187], v[144:159]
  s_add_u32 m0, s6, 3072
  s_nop 0
  buffer_load_dwordx4 v29, s[84:87], s7 offen lds
  s_lshl_b32 s32, s32, 8
  v_mfma_f32_32x32x16_bf16 v[108:123], v[176:179], v[180:183], v[108:123]
  s_and_b32 s7, s92, -16
  s_add_u32 m0, s6, 65536
  s_nop 0
  buffer_load_dwordx4 v29, s[76:79], s7 offen lds
  s_add_u32 s29, s29, s32
  s_waitcnt lgkmcnt(2)
  v_mfma_f32_32x32x16_bf16 v[76:91], v[124:127], v[164:167], v[76:91]
  ds_read_b128 v[172:175], v17 offset:32768
  ds_read_b128 v[180:183], v21 offset:32768
  v_and_b32 v27, 31, v4
  s_waitcnt lgkmcnt(2)
  v_mfma_f32_32x32x16_bf16 v[92:107], v[124:127], v[168:171], v[92:107]
  ds_read_b128 v[176:179], v17 offset:36864
  ds_read_b128 v[184:187], v21 offset:36864
  v_lshl_add_u32 v27, v27, 3, s29
  s_lshl_b32 s32, s38, 1
  v_mfma_f32_32x32x16_bf16 v[144:159], v[160:163], v[168:171], v[144:159]
  s_add_u32 m0, s6, 66560
  s_nop 0
  buffer_load_dwordx4 v29, s[84:87], s7 offen lds
  s_lshr_b32 s33, s3, 1
  v_mfma_f32_32x32x16_bf16 v[108:123], v[160:163], v[164:167], v[108:123]
  s_and_b32 s7, s93, -16
  s_add_u32 m0, s6, 67584
  s_nop 0
  buffer_load_dwordx4 v29, s[76:79], s7 offen lds
  s_add_u32 s32, s32, s33
  s_waitcnt lgkmcnt(2)
  v_mfma_f32_32x32x16_bf16 v[76:91], v[172:175], v[180:183], v[76:91]
  ds_read_b128 v[124:127], v18 offset:32768
  ds_read_b128 v[164:167], v22 offset:32768
  s_lshl_b32 s29, s32, 9
  s_waitcnt lgkmcnt(2)
  v_mfma_f32_32x32x16_bf16 v[92:107], v[172:175], v[184:187], v[92:107]
  ds_read_b128 v[160:163], v18 offset:36864
  ds_read_b128 v[168:171], v22 offset:36864
  s_and_b32 s32, s32, 3
  v_mfma_f32_32x32x16_bf16 v[144:159], v[176:179], v[184:187], v[144:159]
  s_add_u32 m0, s6, 68608
  s_nop 0
  buffer_load_dwordx4 v29, s[84:87], s7 offen lds
  s_lshl_b32 s32, s32, 2
  v_xor_b32 v28, s32, v5
  v_mfma_f32_32x32x16_bf16 v[108:123], v[176:179], v[180:183], v[108:123]
  s_and_b32 s7, s94, -16
  s_add_u32 m0, s6, 16384
  s_nop 0
  buffer_load_dwordx4 v29, s[76:79], s7 offen lds
  v_lshlrev_b32 v28, 4, v28
  s_waitcnt lgkmcnt(2)
  v_mfma_f32_32x32x16_bf16 v[76:91], v[124:127], v[164:167], v[76:91]
  ds_read_b128 v[172:175], v19 offset:32768
  ds_read_b128 v[180:183], v23 offset:32768
  v_lshrrev_b32 v75, 1, v6
  s_waitcnt lgkmcnt(2)
  v_mfma_f32_32x32x16_bf16 v[92:107], v[124:127], v[168:171], v[92:107]
  ds_read_b128 v[176:179], v19 offset:36864
  ds_read_b128 v[184:187], v23 offset:36864
  v_lshl_or_b32 v28, v75, 14, v28
  v_mfma_f32_32x32x16_bf16 v[144:159], v[160:163], v[168:171], v[144:159]
  s_add_u32 m0, s6, 17408
  s_nop 0
  buffer_load_dwordx4 v29, s[84:87], s7 offen lds
  v_and_b32 v75, 1, v6
  v_mfma_f32_32x32x16_bf16 v[108:123], v[160:163], v[164:167], v[108:123]
  s_and_b32 s7, s95, -16
  s_add_u32 m0, s6, 18432
  s_nop 0
  buffer_load_dwordx4 v29, s[76:79], s7 offen lds
  v_lshl_or_b32 v28, v75, 19, v28
  s_and_b32 s33, s3, 1
  s_waitcnt vmcnt(18) lgkmcnt(0)
  s_barrier
  v_mfma_f32_32x32x16_bf16 v[76:91], v[172:175], v[180:183], v[76:91]
  ds_read_b128 v[124:127], v16 offset:49152
  ds_read_b128 v[164:167], v20 offset:49152
  s_lshl_b32 s33, s33, 8
  v_mfma_f32_32x32x16_bf16 v[92:107], v[172:175], v[184:187], v[92:107]
  ds_read_b128 v[160:163], v16 offset:53248
  ds_read_b128 v[168:171], v20 offset:53248
  s_add_u32 s29, s29, s33
  v_mfma_f32_32x32x16_bf16 v[144:159], v[176:179], v[184:187], v[144:159]
  s_add_u32 m0, s6, 19456
  s_nop 0
  buffer_load_dwordx4 v29, s[84:87], s7 offen lds
  s_lshl_b32 s33, s39, 15
  v_mfma_f32_32x32x16_bf16 v[108:123], v[176:179], v[180:183], v[108:123]
  s_add_u32 m0, s21, 81920
  s_nop 0
  buffer_load_dwordx4 v128, s[68:71], s20 offen offset:0 lds
  s_add_u32 s29, s29, s33
  s_waitcnt lgkmcnt(2)
  v_mfma_f32_32x32x16_bf16 v[76:91], v[124:127], v[164:167], v[76:91]
  ds_read_b128 v[172:175], v17 offset:49152
  ds_read_b128 v[180:183], v21 offset:49152
  s_waitcnt lgkmcnt(2)
  v_mfma_f32_32x32x16_bf16 v[92:107], v[124:127], v[168:171], v[92:107]
  ds_read_b128 v[176:179], v17 offset:53248
  ds_read_b128 v[184:187], v21 offset:53248
  v_mfma_f32_32x32x16_bf16 v[144:159], v[160:163], v[168:171], v[144:159]
  buffer_load_dwordx4 v129, s[68:71], s20 offen offset:1024 lds
  v_mfma_f32_32x32x16_bf16 v[108:123], v[160:163], v[164:167], v[108:123]
  buffer_load_dwordx4 v130, s[68:71], s20 offen offset:2048 lds
  s_waitcnt lgkmcnt(2)
  v_mfma_f32_32x32x16_bf16 v[76:91], v[172:175], v[180:183], v[76:91]
  ds_read_b128 v[124:127], v18 offset:49152
  ds_read_b128 v[164:167], v22 offset:49152
  s_waitcnt lgkmcnt(2)
  v_mfma_f32_32x32x16_bf16 v[92:107], v[172:175], v[184:187], v[92:107]
  ds_read_b128 v[160:163], v18 offset:53248
  ds_read_b128 v[168:171], v22 offset:53248
  v_mfma_f32_32x32x16_bf16 v[144:159], v[176:179], v[184:187], v[144:159]
  buffer_load_dwordx4 v131, s[68:71], s20 offen offset:3072 lds
  s_add_u32 s20, s20, 128
  s_and_b32 s20, s20, 0x7ff
  v_mfma_f32_32x32x16_bf16 v[108:123], v[176:179], v[180:183], v[108:123]
  s_add_u32 m0, s21, 32768
  s_nop 0
  buffer_load_dwordx4 v128, s[68:71], s20 offen offset:0 lds
  s_waitcnt lgkmcnt(2)
  v_mfma_f32_32x32x16_bf16 v[76:91], v[124:127], v[164:167], v[76:91]
  ds_read_b128 v[172:175], v19 offset:49152
  ds_read_b128 v[180:183], v23 offset:49152
  s_waitcnt lgkmcnt(2)
  v_mfma_f32_32x32x16_bf16 v[92:107], v[124:127], v[168:171], v[92:107]
  ds_read_b128 v[176:179], v19 offset:53248
  ds_read_b128 v[184:187], v23 offset:53248
  v_mfma_f32_32x32x16_bf16 v[144:159], v[160:163], v[168:171], v[144:159]
  buffer_load_dwordx4 v129, s[68:71], s20 offen offset:1024 lds
  v_mfma_f32_32x32x16_bf16 v[108:123], v[160:163], v[164:167], v[108:123]
  buffer_load_dwordx4 v130, s[68:71], s20 offen offset:2048 lds
  s_waitcnt lgkmcnt(2)
  v_mfma_f32_32x32x16_bf16 v[76:91], v[172:175], v[180:183], v[76:91]
  s_waitcnt lgkmcnt(0)
  v_mfma_f32_32x32x16_bf16 v[92:107], v[172:175], v[184:187], v[92:107]
  v_mfma_f32_32x32x16_bf16 v[144:159], v[176:179], v[184:187], v[144:159]
  buffer_load_dwordx4 v131, s[68:71], s20 offen offset:3072 lds
  s_add_u32 s20, s20, 128
  s_and_b32 s20, s20, 0x7ff
  v_mfma_f32_32x32x16_bf16 v[108:123], v[176:179], v[180:183], v[108:123]
  s_add_u32 m0, s21, 98304
  s_nop 0
  buffer_load_dwordx4 v128, s[68:71], s20 offen offset:0 lds
  buffer_load_dwordx4 v129, s[68:71], s20 offen offset:1024 lds
  s_nop 0
  v_pk_fma_f32 v[8:9], v[190:191], v[76:77], v[78:79] op_sel:[0,0,0] op_sel_hi:[0,1,1]
  s_nop 0
  v_pk_fma_f32 v[10:11], v[190:191], v[92:93], v[94:95] op_sel:[0,0,0] op_sel_hi:[0,1,1]
  v_pk_fma_f32 v[8:9], v[190:191], v[92:93], v[8:9] op_sel:[1,0,0] op_sel_hi:[1,1,1] neg_lo:[1,0,0] neg_hi:[1,0,0]
  v_pk_fma_f32 v[10:11], v[190:191], v[76:77], v[10:11] op_sel:[1,0,0] op_sel_hi:[1,1,1]
  v_pk_fma_f32 v[12:13], v[190:191], v[8:9], v[80:81] op_sel:[0,0,0] op_sel_hi:[0,1,1]
  v_pk_fma_f32 v[14:15], v[190:191], v[10:11], v[96:97] op_sel:[0,0,0] op_sel_hi:[0,1,1]
  v_pk_fma_f32 v[12:13], v[190:191], v[10:11], v[12:13] op_sel:[1,0,0] op_sel_hi:[1,1,1] neg_lo:[1,0,0] neg_hi:[1,0,0]
  v_pk_fma_f32 v[14:15], v[190:191], v[8:9], v[14:15] op_sel:[1,0,0] op_sel_hi:[1,1,1]
  v_pk_fma_f32 v[8:9], v[190:191], v[12:13], v[82:83] op_sel:[0,0,0] op_sel_hi:[0,1,1]
  v_pk_fma_f32 v[10:11], v[190:191], v[14:15], v[98:99] op_sel:[0,0,0] op_sel_hi:[0,1,1]
  v_pk_fma_f32 v[8:9], v[190:191], v[14:15], v[8:9] op_sel:[1,0,0] op_sel_hi:[1,1,1] neg_lo:[1,0,0] neg_hi:[1,0,0]
  v_pk_fma_f32 v[10:11], v[190:191], v[12:13], v[10:11] op_sel:[1,0,0] op_sel_hi:[1,1,1]
  v_pk_fma_f32 v[12:13], v[190:191], v[8:9], v[84:85] op_sel:[0,0,0] op_sel_hi:[0,1,1]
  v_pk_fma_f32 v[14:15], v[190:191], v[10:11], v[100:101] op_sel:[0,0,0] op_sel_hi:[0,1,1]
  v_pk_fma_f32 v[12:13], v[190:191], v[10:11], v[12:13] op_sel:[1,0,0] op_sel_hi:[1,1,1] neg_lo:[1,0,0] neg_hi:[1,0,0]
  v_pk_fma_f32 v[14:15], v[190:191], v[8:9], v[14:15] op_sel:[1,0,0] op_sel_hi:[1,1,1]
  buffer_load_dwordx4 v130, s[68:71], s20 offen offset:2048 lds
  v_pk_fma_f32 v[8:9], v[190:191], v[12:13], v[86:87] op_sel:[0,0,0] op_sel_hi:[0,1,1]
  v_pk_fma_f32 v[10:11], v[190:191], v[14:15], v[102:103] op_sel:[0,0,0] op_sel_hi:[0,1,1]
  v_pk_fma_f32 v[8:9], v[190:191], v[14:15], v[8:9] op_sel:[1,0,0] op_sel_hi:[1,1,1] neg_lo:[1,0,0] neg_hi:[1,0,0]
  v_pk_fma_f32 v[10:11], v[190:191], v[12:13], v[10:11] op_sel:[1,0,0] op_sel_hi:[1,1,1]
  v_pk_fma_f32 v[12:13], v[190:191], v[8:9], v[88:89] op_sel:[0,0,0] op_sel_hi:[0,1,1]
  v_pk_fma_f32 v[14:15], v[190:191], v[10:11], v[104:105] op_sel:[0,0,0] op_sel_hi:[0,1,1]
  v_pk_fma_f32 v[12:13], v[190:191], v[10:11], v[12:13] op_sel:[1,0,0] op_sel_hi:[1,1,1] neg_lo:[1,0,0] neg_hi:[1,0,0]
  v_pk_fma_f32 v[14:15], v[190:191], v[8:9], v[14:15] op_sel:[1,0,0] op_sel_hi:[1,1,1]
  v_pk_fma_f32 v[8:9], v[190:191], v[12:13], v[90:91] op_sel:[0,0,0] op_sel_hi:[0,1,1]
  v_pk_fma_f32 v[10:11], v[190:191], v[14:15], v[106:107] op_sel:[0,0,0] op_sel_hi:[0,1,1]
  v_pk_fma_f32 v[8:9], v[190:191], v[14:15], v[8:9] op_sel:[1,0,0] op_sel_hi:[1,1,1] neg_lo:[1,0,0] neg_hi:[1,0,0]
  v_pk_fma_f32 v[10:11], v[190:191], v[12:13], v[10:11] op_sel:[1,0,0] op_sel_hi:[1,1,1]
  v_pk_fma_f32 v[12:13], v[190:191], v[8:9], v[108:109] op_sel:[0,0,0] op_sel_hi:[0,1,1]
  v_pk_fma_f32 v[14:15], v[190:191], v[10:11], v[144:145] op_sel:[0,0,0] op_sel_hi:[0,1,1]
  v_pk_fma_f32 v[12:13], v[190:191], v[10:11], v[12:13] op_sel:[1,0,0] op_sel_hi:[1,1,1] neg_lo:[1,0,0] neg_hi:[1,0,0]
  v_pk_fma_f32 v[14:15], v[190:191], v[8:9], v[14:15] op_sel:[1,0,0] op_sel_hi:[1,1,1]
  buffer_load_dwordx4 v131, s[68:71], s20 offen offset:3072 lds
  s_add_u32 s20, s20, 128
  s_and_b32 s20, s20, 0x7ff
  v_pk_fma_f32 v[8:9], v[190:191], v[12:13], v[110:111] op_sel:[0,0,0] op_sel_hi:[0,1,1]
  v_pk_fma_f32 v[10:11], v[190:191], v[14:15], v[146:147] op_sel:[0,0,0] op_sel_hi:[0,1,1]
  v_pk_fma_f32 v[8:9], v[190:191], v[14:15], v[8:9] op_sel:[1,0,0] op_sel_hi:[1,1,1] neg_lo:[1,0,0] neg_hi:[1,0,0]
  v_pk_fma_f32 v[10:11], v[190:191], v[12:13], v[10:11] op_sel:[1,0,0] op_sel_hi:[1,1,1]
  v_pk_fma_f32 v[12:13], v[190:191], v[8:9], v[112:113] op_sel:[0,0,0] op_sel_hi:[0,1,1]
  v_pk_fma_f32 v[14:15], v[190:191], v[10:11], v[148:149] op_sel:[0,0,0] op_sel_hi:[0,1,1]
  v_pk_fma_f32 v[12:13], v[190:191], v[10:11], v[12:13] op_sel:[1,0,0] op_sel_hi:[1,1,1] neg_lo:[1,0,0] neg_hi:[1,0,0]
  v_pk_fma_f32 v[14:15], v[190:191], v[8:9], v[14:15] op_sel:[1,0,0] op_sel_hi:[1,1,1]
  v_pk_fma_f32 v[8:9], v[190:191], v[12:13], v[114:115] op_sel:[0,0,0] op_sel_hi:[0,1,1]
  v_pk_fma_f32 v[10:11], v[190:191], v[14:15], v[150:151] op_sel:[0,0,0] op_sel_hi:[0,1,1]
  v_pk_fma_f32 v[8:9], v[190:191], v[14:15], v[8:9] op_sel:[1,0,0] op_sel_hi:[1,1,1] neg_lo:[1,0,0] neg_hi:[1,0,0]
  v_pk_fma_f32 v[10:11], v[190:191], v[12:13], v[10:11] op_sel:[1,0,0] op_sel_hi:[1,1,1]
  v_pk_fma_f32 v[12:13], v[190:191], v[8:9], v[116:117] op_sel:[0,0,0] op_sel_hi:[0,1,1]
  v_pk_fma_f32 v[14:15], v[190:191], v[10:11], v[152:153] op_sel:[0,0,0] op_sel_hi:[0,1,1]
  v_pk_fma_f32 v[12:13], v[190:191], v[10:11], v[12:13] op_sel:[1,0,0] op_sel_hi:[1,1,1] neg_lo:[1,0,0] neg_hi:[1,0,0]
  v_pk_fma_f32 v[14:15], v[190:191], v[8:9], v[14:15] op_sel:[1,0,0] op_sel_hi:[1,1,1]
  v_pk_fma_f32 v[8:9], v[190:191], v[12:13], v[118:119] op_sel:[0,0,0] op_sel_hi:[0,1,1]
  v_pk_fma_f32 v[10:11], v[190:191], v[14:15], v[154:155] op_sel:[0,0,0] op_sel_hi:[0,1,1]
  v_pk_fma_f32 v[8:9], v[190:191], v[14:15], v[8:9] op_sel:[1,0,0] op_sel_hi:[1,1,1] neg_lo:[1,0,0] neg_hi:[1,0,0]
  v_pk_fma_f32 v[10:11], v[190:191], v[12:13], v[10:11] op_sel:[1,0,0] op_sel_hi:[1,1,1]
  v_pk_fma_f32 v[12:13], v[190:191], v[8:9], v[120:121] op_sel:[0,0,0] op_sel_hi:[0,1,1]
  v_pk_fma_f32 v[14:15], v[190:191], v[10:11], v[156:157] op_sel:[0,0,0] op_sel_hi:[0,1,1]
  v_pk_fma_f32 v[12:13], v[190:191], v[10:11], v[12:13] op_sel:[1,0,0] op_sel_hi:[1,1,1] neg_lo:[1,0,0] neg_hi:[1,0,0]
  v_pk_fma_f32 v[14:15], v[190:191], v[8:9], v[14:15] op_sel:[1,0,0] op_sel_hi:[1,1,1]
  v_pk_fma_f32 v[8:9], v[190:191], v[12:13], v[122:123] op_sel:[0,0,0] op_sel_hi:[0,1,1]
  v_pk_fma_f32 v[10:11], v[190:191], v[14:15], v[158:159] op_sel:[0,0,0] op_sel_hi:[0,1,1]
  v_pk_fma_f32 v[8:9], v[190:191], v[14:15], v[8:9] op_sel:[1,0,0] op_sel_hi:[1,1,1] neg_lo:[1,0,0] neg_hi:[1,0,0]
  v_pk_fma_f32 v[10:11], v[190:191], v[12:13], v[10:11] op_sel:[1,0,0] op_sel_hi:[1,1,1]
  v_fma_f32 v12, v192, v8, v9
  v_fma_f32 v13, v192, v10, v11
  v_fma_f32 v12, -v193, v10, v12
  v_fma_f32 v13, v193, v8, v13
  v_mov_b32 v14, v12
  v_mov_b32 v15, v13
  s_nop 0
  v_permlane32_swap_b32 v12, v14
  v_permlane32_swap_b32 v13, v15
  v_fma_f32 v14, v194, v12, v14
  v_fma_f32 v15, v194, v13, v15
  v_fma_f32 v14, -v195, v13, v14
  v_fma_f32 v15, v195, v12, v15
  ds_write_b64 v26, v[14:15]
  s_waitcnt vmcnt(30)
  v_cmp_ne_u32 vcc, 1, v209
  s_nop 0
  s_cbranch_vccz gated_mix__spectral_gfnet__ssm_conv_s5__prompt_kernel_skip21
  s_mov_b32 s10, 0
gated_mix__spectral_gfnet__ssm_conv_s5__prompt_kernel_poll22:
  s_sleep 5
  buffer_load_dword v209, v3, s[48:51], 0 offen sc1
  s_waitcnt vmcnt(0)
  v_cmp_ne_u32 vcc, 1, v209
  s_nop 0
  s_cbranch_vccz gated_mix__spectral_gfnet__ssm_conv_s5__prompt_kernel_pollout23
  s_add_u32 s10, s10, 1
  s_cmp_lt_u32 s10, 1048576
  s_cbranch_scc1 gated_mix__spectral_gfnet__ssm_conv_s5__prompt_kernel_poll22
gated_mix__spectral_gfnet__ssm_conv_s5__prompt_kernel_pollout23:
gated_mix__spectral_gfnet__ssm_conv_s5__prompt_kernel_skip21:
  s_waitcnt lgkmcnt(0)
  s_barrier
  v_and_b32 v26, 0xfffffdff, v26
  ds_read_b64 v[16:17], v26
  s_cmp_lt_u32 s3, 2
  s_cbranch_scc1 gated_mix__spectral_gfnet__ssm_conv_s5__prompt_kernel_skip24
  s_waitcnt lgkmcnt(0)
  v_fma_f32 v14, v196, v16, v14
  s_waitcnt lgkmcnt(0)
  v_fma_f32 v15, v196, v17, v15
  s_waitcnt lgkmcnt(0)
  v_fma_f32 v14, -v197, v17, v14
  s_waitcnt lgkmcnt(0)
  v_fma_f32 v15, v197, v16, v15
  v_min_u32 v14, -2, v14
  v_min_u32 v15, -2, v15
  s_mov_b32 exec_hi, 0
  buffer_store_dwordx2 v[14:15], v27, s[64:67], 0 offen sc1
  s_mov_b64 exec, -1
gated_mix__spectral_gfnet__ssm_conv_s5__prompt_kernel_skip24:
  v_lshrrev_b32 v2, 5, v4
  v_lshl_add_u32 v27, v2, 12, v27
  v_add_u32 v27, 512, v27
  v_and_b32 v14, 3, v5
  v_lshlrev_b32 v2, 6, v14
  v_lshrrev_b32 v14, 2, v5
  v_lshl_or_b32 v2, v14, 4, v2
  v_lshl_or_b32 v2, v6, 12, v2
  s_mul_i32 s10, s15, 16384
  s_lshl_b32 s11, s3, 8
  s_add_u32 s10, s10, s11
  buffer_load_dwordx4 v[20:23], v2, s[80:83], s10 offen offset:0 sc1
  buffer_load_dwordx4 v[124:127], v2, s[80:83], s10 offen offset:1024 sc1
  buffer_load_dwordx4 v[160:163], v2, s[80:83], s10 offen offset:2048 sc1
  buffer_load_dwordx4 v[164:167], v2, s[80:83], s10 offen offset:3072 sc1
  s_lshl_b32 s10, s3, 8
  s_add_u32 s10, s10, 147456
  v_lshl_add_u32 v2, v4, 11, s10
  s_mov_b64 exec, 255
  s_waitcnt vmcnt(33)
  ds_write_b128 v2, v[212:215]
  s_waitcnt vmcnt(32)
  ds_write_b128 v2, v[216:219] offset:1024
  s_mov_b64 exec, -1
  s_waitcnt vmcnt(16)
  s_cmp_eq_u32 s14, 0
  s_cbranch_scc1 gated_mix__spectral_gfnet__ssm_conv_s5__prompt_kernel_skip25
  v_add_u32 v2, 131072, v57
  v_and_b32 v14, 0xfffe0000, v189
  v_add3_u32 v14, v14, v74, v2
  s_cmp_eq_u32 s9, 0
  s_cbranch_scc1 gated_mix__spectral_gfnet__ssm_conv_s5__prompt_kernel_skip26
  s_mov_b32 exec_hi, 0
  v_add_u32 v2, 2048, v2
  v_add_u32 v14, 2048, v14
  s_mov_b64 exec, -1
gated_mix__spectral_gfnet__ssm_conv_s5__prompt_kernel_skip26:
  ds_read_u16_d16_hi v216, v2 offset:0
  ds_read_u16_d16_hi v220, v2 offset:1024
  ds_read_u16_d16_hi v217, v2 offset:128
  ds_read_u16_d16_hi v221, v2 offset:1152
  ds_read_u16_d16_hi v218, v2 offset:256
  ds_read_u16_d16_hi v222, v2 offset:1280
  ds_read_u16_d16_hi v219, v14 offset:0
  ds_read_u16_d16_hi v223, v14 offset:1024
gated_mix__spectral_gfnet__ssm_conv_s5__prompt_kernel_skip25:
  v_add_u32 v2, 131072, v57
  v_and_b32 v14, 0xfffe0000, v189
  v_add3_u32 v14, v14, v74, v2
  s_cmp_eq_u32 s9, 0
  s_cbranch_scc1 gated_mix__spectral_gfnet__ssm_conv_s5__prompt_kernel_skip27
  s_mov_b32 exec_lo, 0
  v_subrev_u32 v2, 2048, v2
  v_subrev_u32 v14, 2048, v14
  s_mov_b64 exec, -1
gated_mix__spectral_gfnet__ssm_conv_s5__prompt_kernel_skip27:
  ds_read_u16_d16_hi v168, v2 offset:0
  ds_read_u16_d16_hi v172, v2 offset:1024
  ds_read_u16_d16_hi v169, v2 offset:128
  ds_read_u16_d16_hi v173, v2 offset:1152
  ds_read_u16_d16_hi v170, v2 offset:256
  ds_read_u16_d16_hi v174, v2 offset:1280
  ds_read_u16_d16_hi v171, v14 offset:0
  ds_read_u16_d16_hi v175, v14 offset:1024
  v_add_u32 v2, 0, v57
  v_and_b32 v14, 0x1000, v189
  v_add3_u32 v14, v14, v74, v2
  s_waitcnt vmcnt(12)
  ds_read_b128 a[0:3], v134 offset:16384
  ds_read_b128 a[4:7], v135 offset:16384
  ds_read_b128 a[8:11], v134 offset:18432
  ds_read_b128 a[12:15], v135 offset:18432
  s_add_u32 m0, s21, 114688
  s_nop 0
  buffer_load_dwordx4 v128, s[68:71], s20 offen offset:0 lds
  ds_read_u16_d16_hi v176, v2 offset:0
  ds_read_u16_d16_hi v180, v2 offset:1024
  ds_read_u16_d16_hi v177, v2 offset:128
  ds_read_u16_d16_hi v181, v2 offset:1152
  ds_read_u16_d16_hi v178, v2 offset:256
  ds_read_u16_d16_hi v182, v2 offset:1280
  ds_read_u16_d16_hi v179, v14 offset:0
  ds_read_u16_d16_hi v183, v14 offset:1024
  v_add_u32 v2, 65536, v57
  v_and_b32 v14, 0xffff2000, v189
  v_add3_u32 v14, v14, v74, v2
  ds_read_u16_d16_hi v184, v2 offset:0
  ds_read_u16_d16_hi v204, v2 offset:1024
  ds_read_u16_d16_hi v185, v2 offset:128
  ds_read_u16_d16_hi v205, v2 offset:1152
  ds_read_u16_d16_hi v186, v2 offset:256
  ds_read_u16_d16_hi v206, v2 offset:1280
  ds_read_u16_d16_hi v187, v14 offset:0
  buffer_load_dwordx4 v129, s[68:71], s20 offen offset:1024 lds
  ds_read_u16_d16_hi v207, v14 offset:1024
  v_add_u32 v2, 16384, v57
  v_and_b32 v14, 0xfffff000, v189
  v_add3_u32 v14, v14, v74, v2
  ds_read_u16_d16_hi v208, v2 offset:0
  ds_read_u16_d16_hi v212, v2 offset:1024
  ds_read_u16_d16_hi v209, v2 offset:128
  ds_read_u16_d16_hi v213, v2 offset:1152
  ds_read_u16_d16_hi v210, v2 offset:256
  ds_read_u16_d16_hi v214, v2 offset:1280
  ds_read_u16_d16_hi v211, v14 offset:0
  ds_read_u16_d16_hi v215, v14 offset:1024
  v_pk_mul_f32 v[226:227], v[200:201], v[76:77] op_sel:[1,0] op_sel_hi:[1,1]
  v_pk_mul_f32 v[76:77], v[200:201], v[76:77] op_sel:[0,0] op_sel_hi:[0,1]
  v_pk_fma_f32 v[76:77], v[200:201], v[92:93], v[76:77] op_sel:[1,0,0] op_sel_hi:[1,1,1] neg_lo:[1,0,0] neg_hi:[1,0,0]
  v_pk_fma_f32 v[92:93], v[200:201], v[92:93], v[226:227] op_sel:[0,0,0] op_sel_hi:[0,1,1]
  v_pk_mul_f32 v[224:225], v[200:201], v[78:79] op_sel:[1,0] op_sel_hi:[1,1]
  v_pk_mul_f32 v[78:79], v[200:201], v[78:79] op_sel:[0,0] op_sel_hi:[0,1]
  buffer_load_dwordx4 v130, s[68:71], s20 offen offset:2048 lds
  v_pk_fma_f32 v[78:79], v[200:201], v[94:95], v[78:79] op_sel:[1,0,0] op_sel_hi:[1,1,1] neg_lo:[1,0,0] neg_hi:[1,0,0]
  v_pk_fma_f32 v[94:95], v[200:201], v[94:95], v[224:225] op_sel:[0,0,0] op_sel_hi:[0,1,1]
  v_pk_mul_f32 v[226:227], v[200:201], v[80:81] op_sel:[1,0] op_sel_hi:[1,1]
  v_pk_mul_f32 v[80:81], v[200:201], v[80:81] op_sel:[0,0] op_sel_hi:[0,1]
  v_pk_fma_f32 v[80:81], v[200:201], v[96:97], v[80:81] op_sel:[1,0,0] op_sel_hi:[1,1,1] neg_lo:[1,0,0] neg_hi:[1,0,0]
  v_pk_fma_f32 v[96:97], v[200:201], v[96:97], v[226:227] op_sel:[0,0,0] op_sel_hi:[0,1,1]
  v_pk_mul_f32 v[224:225], v[200:201], v[82:83] op_sel:[1,0] op_sel_hi:[1,1]
  v_pk_mul_f32 v[82:83], v[200:201], v[82:83] op_sel:[0,0] op_sel_hi:[0,1]
  v_pk_fma_f32 v[82:83], v[200:201], v[98:99], v[82:83] op_sel:[1,0,0] op_sel_hi:[1,1,1] neg_lo:[1,0,0] neg_hi:[1,0,0]
  v_pk_fma_f32 v[98:99], v[200:201], v[98:99], v[224:225] op_sel:[0,0,0] op_sel_hi:[0,1,1]
  v_pk_mul_f32 v[226:227], v[200:201], v[84:85] op_sel:[1,0] op_sel_hi:[1,1]
  v_pk_mul_f32 v[84:85], v[200:201], v[84:85] op_sel:[0,0] op_sel_hi:[0,1]
  v_pk_fma_f32 v[84:85], v[200:201], v[100:101], v[84:85] op_sel:[1,0,0] op_sel_hi:[1,1,1] neg_lo:[1,0,0] neg_hi:[1,0,0]
  v_pk_fma_f32 v[100:101], v[200:201], v[100:101], v[226:227] op_sel:[0,0,0] op_sel_hi:[0,1,1]
  v_pk_mul_f32 v[224:225], v[200:201], v[86:87] op_sel:[1,0] op_sel_hi:[1,1]
  v_pk_mul_f32 v[86:87], v[200:201], v[86:87] op_sel:[0,0] op_sel_hi:[0,1]
  v_pk_fma_f32 v[86:87], v[200:201], v[102:103], v[86:87] op_sel:[1,0,0] op_sel_hi:[1,1,1] neg_lo:[1,0,0] neg_hi:[1,0,0]
  v_pk_fma_f32 v[102:103], v[200:201], v[102:103], v[224:225] op_sel:[0,0,0] op_sel_hi:[0,1,1]
  buffer_load_dwordx4 v131, s[68:71], s20 offen offset:3072 lds
  s_add_u32 s20, s20, 128
  s_and_b32 s20, s20, 0x7ff
  v_pk_mul_f32 v[226:227], v[200:201], v[88:89] op_sel:[1,0] op_sel_hi:[1,1]
  v_pk_mul_f32 v[88:89], v[200:201], v[88:89] op_sel:[0,0] op_sel_hi:[0,1]
  v_pk_fma_f32 v[88:89], v[200:201], v[104:105], v[88:89] op_sel:[1,0,0] op_sel_hi:[1,1,1] neg_lo:[1,0,0] neg_hi:[1,0,0]
  v_pk_fma_f32 v[104:105], v[200:201], v[104:105], v[226:227] op_sel:[0,0,0] op_sel_hi:[0,1,1]
  v_pk_mul_f32 v[224:225], v[200:201], v[90:91] op_sel:[1,0] op_sel_hi:[1,1]
  v_pk_mul_f32 v[90:91], v[200:201], v[90:91] op_sel:[0,0] op_sel_hi:[0,1]
  v_pk_fma_f32 v[90:91], v[200:201], v[106:107], v[90:91] op_sel:[1,0,0] op_sel_hi:[1,1,1] neg_lo:[1,0,0] neg_hi:[1,0,0]
  v_pk_fma_f32 v[106:107], v[200:201], v[106:107], v[224:225] op_sel:[0,0,0] op_sel_hi:[0,1,1]
  v_pk_mul_f32 v[226:227], v[200:201], v[108:109] op_sel:[1,0] op_sel_hi:[1,1]
  v_pk_mul_f32 v[108:109], v[200:201], v[108:109] op_sel:[0,0] op_sel_hi:[0,1]
  v_pk_fma_f32 v[108:109], v[200:201], v[144:145], v[108:109] op_sel:[1,0,0] op_sel_hi:[1,1,1] neg_lo:[1,0,0] neg_hi:[1,0,0]
  v_pk_fma_f32 v[144:145], v[200:201], v[144:145], v[226:227] op_sel:[0,0,0] op_sel_hi:[0,1,1]
  v_pk_mul_f32 v[224:225], v[200:201], v[110:111] op_sel:[1,0] op_sel_hi:[1,1]
  v_pk_mul_f32 v[110:111], v[200:201], v[110:111] op_sel:[0,0] op_sel_hi:[0,1]
  v_pk_fma_f32 v[110:111], v[200:201], v[146:147], v[110:111] op_sel:[1,0,0] op_sel_hi:[1,1,1] neg_lo:[1,0,0] neg_hi:[1,0,0]
  v_pk_fma_f32 v[146:147], v[200:201], v[146:147], v[224:225] op_sel:[0,0,0] op_sel_hi:[0,1,1]
  v_pk_mul_f32 v[226:227], v[200:201], v[112:113] op_sel:[1,0] op_sel_hi:[1,1]
  v_pk_mul_f32 v[112:113], v[200:201], v[112:113] op_sel:[0,0] op_sel_hi:[0,1]
  s_waitcnt vmcnt(12)
  ds_read_b128 a[16:19], v132 offset:32768
  ds_read_b128 a[20:23], v133 offset:32768
  ds_read_b128 a[24:27], v132 offset:34816
  ds_read_b128 a[28:31], v133 offset:34816
  s_waitcnt lgkmcnt(15)
  s_add_u32 m0, s21, 81920
  s_nop 0
  buffer_load_dwordx4 v128, s[68:71], s20 offen offset:0 lds
  v_pk_fma_f32 v[112:113], v[200:201], v[148:149], v[112:113] op_sel:[1,0,0] op_sel_hi:[1,1,1] neg_lo:[1,0,0] neg_hi:[1,0,0]
  v_pk_fma_f32 v[148:149], v[200:201], v[148:149], v[226:227] op_sel:[0,0,0] op_sel_hi:[0,1,1]
  v_pk_mul_f32 v[224:225], v[200:201], v[114:115] op_sel:[1,0] op_sel_hi:[1,1]
  v_pk_mul_f32 v[114:115], v[200:201], v[114:115] op_sel:[0,0] op_sel_hi:[0,1]
  v_pk_fma_f32 v[114:115], v[200:201], v[150:151], v[114:115] op_sel:[1,0,0] op_sel_hi:[1,1,1] neg_lo:[1,0,0] neg_hi:[1,0,0]
  v_pk_fma_f32 v[150:151], v[200:201], v[150:151], v[224:225] op_sel:[0,0,0] op_sel_hi:[0,1,1]
  v_pk_mul_f32 v[226:227], v[200:201], v[116:117] op_sel:[1,0] op_sel_hi:[1,1]
  v_pk_mul_f32 v[116:117], v[200:201], v[116:117] op_sel:[0,0] op_sel_hi:[0,1]
  v_pk_fma_f32 v[116:117], v[200:201], v[152:153], v[116:117] op_sel:[1,0,0] op_sel_hi:[1,1,1] neg_lo:[1,0,0] neg_hi:[1,0,0]
  v_pk_fma_f32 v[152:153], v[200:201], v[152:153], v[226:227] op_sel:[0,0,0] op_sel_hi:[0,1,1]
  v_pk_mul_f32 v[224:225], v[200:201], v[118:119] op_sel:[1,0] op_sel_hi:[1,1]
  v_pk_mul_f32 v[118:119], v[200:201], v[118:119] op_sel:[0,0] op_sel_hi:[0,1]
  v_pk_fma_f32 v[118:119], v[200:201], v[154:155], v[118:119] op_sel:[1,0,0] op_sel_hi:[1,1,1] neg_lo:[1,0,0] neg_hi:[1,0,0]
  v_pk_fma_f32 v[154:155], v[200:201], v[154:155], v[224:225] op_sel:[0,0,0] op_sel_hi:[0,1,1]
  v_pk_mul_f32 v[226:227], v[200:201], v[120:121] op_sel:[1,0] op_sel_hi:[1,1]
  v_pk_mul_f32 v[120:121], v[200:201], v[120:121] op_sel:[0,0] op_sel_hi:[0,1]
  v_pk_fma_f32 v[120:121], v[200:201], v[156:157], v[120:121] op_sel:[1,0,0] op_sel_hi:[1,1,1] neg_lo:[1,0,0] neg_hi:[1,0,0]
  v_pk_fma_f32 v[156:157], v[200:201], v[156:157], v[226:227] op_sel:[0,0,0] op_sel_hi:[0,1,1]
  buffer_load_dwordx4 v129, s[68:71], s20 offen offset:1024 lds
  v_pk_mul_f32 v[224:225], v[200:201], v[122:123] op_sel:[1,0] op_sel_hi:[1,1]
  v_pk_mul_f32 v[122:123], v[200:201], v[122:123] op_sel:[0,0] op_sel_hi:[0,1]
  v_pk_fma_f32 v[122:123], v[200:201], v[158:159], v[122:123] op_sel:[1,0,0] op_sel_hi:[1,1,1] neg_lo:[1,0,0] neg_hi:[1,0,0]
  v_pk_fma_f32 v[158:159], v[200:201], v[158:159], v[224:225] op_sel:[0,0,0] op_sel_hi:[0,1,1]
  v_pk_mul_f32 v[14:15], v[200:201], v[196:197] op_sel:[0,0] op_sel_hi:[0,1]
  v_pk_fma_f32 v[14:15], v[200:201], v[196:197], v[14:15] op_sel:[1,1,0] op_sel_hi:[1,0,1] neg_lo:[1,0,0]
  s_cmp_ge_u32 s3, 2
  s_cbranch_scc1 gated_mix__spectral_gfnet__ssm_conv_s5__prompt_kernel_skip28
  v_mov_b32 v14, v200
  v_mov_b32 v15, v201
  v_mov_b32 v16, 0
  v_mov_b32 v17, 0
gated_mix__spectral_gfnet__ssm_conv_s5__prompt_kernel_skip28:
  v_pk_mul_f32 v[226:227], v[194:195], v[14:15] op_sel:[0,0] op_sel_hi:[0,1]
  v_pk_fma_f32 v[226:227], v[194:195], v[14:15], v[226:227] op_sel:[1,1,0] op_sel_hi:[1,0,1] neg_lo:[1,0,0]
  v_pk_fma_f32 v[12:13], v[194:195], v[16:17], v[12:13] op_sel:[0,0,0] op_sel_hi:[0,1,1]
  v_pk_fma_f32 v[12:13], v[194:195], v[16:17], v[12:13] op_sel:[1,1,0] op_sel_hi:[1,0,1] neg_lo:[1,0,0]
  s_mov_b32 exec_lo, 0
  v_mov_b32 v14, v226
  v_mov_b32 v15, v227
  v_mov_b32 v16, v12
  v_mov_b32 v17, v13
  s_mov_b64 exec, -1
  buffer_load_dwordx4 v130, s[68:71], s20 offen offset:2048 lds
  v_mov_b32 v9, v10
  v_pk_mul_f32 v[18:19], v[192:193], v[14:15] op_sel:[0,0] op_sel_hi:[0,1]
  v_pk_fma_f32 v[18:19], v[192:193], v[14:15], v[18:19] op_sel:[1,1,0] op_sel_hi:[1,0,1] neg_lo:[1,0,0]
  v_pk_fma_f32 v[8:9], v[192:193], v[16:17], v[8:9] op_sel:[0,0,0] op_sel_hi:[0,1,1]
  v_pk_fma_f32 v[8:9], v[192:193], v[16:17], v[8:9] op_sel:[1,1,0] op_sel_hi:[1,0,1] neg_lo:[1,0,0]
  v_pk_mul_f32 v[224:225], v[200:201], v[8:9] op_sel:[0,0] op_sel_hi:[0,1]
  v_pk_fma_f32 v[224:225], v[200:201], v[8:9], v[224:225] op_sel:[1,1,0] op_sel_hi:[1,0,1] neg_lo:[1,0,0]
  v_pk_mul_f32 v[226:227], v[200:201], v[16:17] op_sel:[0,0] op_sel_hi:[0,1]
  v_pk_fma_f32 v[226:227], v[200:201], v[16:17], v[226:227] op_sel:[1,1,0] op_sel_hi:[1,0,1] neg_lo:[1,0,0]
  s_waitcnt lgkmcnt(4)
  s_cmp_lg_u32 s12, 0
  s_cbranch_scc1 gated_mix__spectral_gfnet__ssm_conv_s5__prompt_kernel_skip29
  s_add_u32 s10, s28, s6
  s_add_u32 s10, s10, 131072
  s_lshl_b32 s7, s3, 8
  s_add_u32 s7, s7, s8
  s_add_u32 s7, s7, 147456
  s_lshl_b32 vcc_lo, s9, 11
  s_sub_u32 s10, s10, vcc_lo
  v_mov_b32 v194, s10
  v_mov_b32 v195, s7
  v_cndmask_b32 v194, v194, v195, s[22:23]
  ds_read_u16_d16_hi v8, v194
  ds_read_u16_d16_hi v9, v194 offset:1024
  s_add_u32 s10, s28, s6
  s_add_u32 s10, s10, 0
  s_lshl_b32 s7, s3, 8
  s_add_u32 s7, s7, s8
  s_add_u32 s7, s7, 151552
  v_mov_b32 v194, s10
  v_mov_b32 v195, s7
  v_cndmask_b32 v194, v194, v195, s[22:23]
  ds_read_u16_d16_hi v10, v194
  ds_read_u16_d16_hi v11, v194 offset:1024
  s_add_u32 s10, s28, s6
  s_add_u32 s10, s10, 65536
  s_lshl_b32 s7, s3, 8
  s_add_u32 s7, s7, s8
  s_add_u32 s7, s7, 155648
  v_mov_b32 v194, s10
  v_mov_b32 v195, s7
  v_cndmask_b32 v194, v194, v195, s[22:23]
  ds_read_u16_d16_hi v12, v194
  ds_read_u16_d16_hi v13, v194 offset:1024
  s_add_u32 s10, s28, s6
  s_add_u32 s10, s10, 16384
  s_lshl_b32 s7, s3, 8
  s_add_u32 s7, s7, s8
  s_add_u32 s7, s7, 159744
  v_mov_b32 v194, s10
  v_mov_b32 v195, s7
  v_cndmask_b32 v194, v194, v195, s[22:23]
  ds_read_u16_d16_hi v16, v194
  ds_read_u16_d16_hi v17, v194 offset:1024
  s_add_u32 s10, s28, s6
  s_add_u32 s10, s10, 131072
  s_lshl_b32 s7, s3, 8
  s_add_u32 s7, s7, s8
  s_add_u32 s7, s7, 147456
  s_lshl_b32 vcc_lo, s9, 11
  s_add_u32 s7, s7, vcc_lo
  v_mov_b32 v194, s10
  v_mov_b32 v195, s7
  v_cndmask_b32 v194, v194, v195, s[22:23]
  ds_read_u16_d16_hi v192, v194
  ds_read_u16_d16_hi v193, v194 offset:1024
  s_waitcnt lgkmcnt(0)
  s_mov_b32 exec_lo, 1
  s_mov_b32 exec_hi, 0
  v_add_f32 v168, v168, v8
  v_sub_f32 v172, v172, v9
  v_mul_f32 v168, 0.5, v168
  v_mul_f32 v172, 0.5, v172
  v_add_f32 v176, v176, v10
  v_sub_f32 v180, v180, v11
  v_mul_f32 v176, 0.5, v176
  v_mul_f32 v180, 0.5, v180
  v_add_f32 v184, v184, v12
  v_sub_f32 v204, v204, v13
  v_mul_f32 v184, 0.5, v184
  v_mul_f32 v204, 0.5, v204
  v_add_f32 v208, v208, v16
  v_sub_f32 v212, v212, v17
  v_mul_f32 v208, 0.5, v208
  v_mul_f32 v212, 0.5, v212
  v_add_f32 v216, v216, v192
  v_sub_f32 v220, v220, v193
  v_mul_f32 v216, 0.5, v216
  v_mul_f32 v220, 0.5, v220
  s_mov_b32 exec_lo, 0
  s_mov_b32 exec_hi, 1
  v_add_f32 v171, v171, v8
  v_sub_f32 v175, v175, v9
  v_mul_f32 v171, 0.5, v171
  v_mul_f32 v175, 0.5, v175
  v_add_f32 v179, v179, v10
  v_sub_f32 v183, v183, v11
  v_mul_f32 v179, 0.5, v179
  v_mul_f32 v183, 0.5, v183
  v_add_f32 v187, v187, v12
  v_sub_f32 v207, v207, v13
  v_mul_f32 v187, 0.5, v187
  v_mul_f32 v207, 0.5, v207
  v_add_f32 v211, v211, v16
  v_sub_f32 v215, v215, v17
  v_mul_f32 v211, 0.5, v211
  v_mul_f32 v215, 0.5, v215
  v_add_f32 v219, v219, v192
  v_sub_f32 v223, v223, v193
  v_mul_f32 v219, 0.5, v219
  v_mul_f32 v223, 0.5, v223
  s_mov_b64 exec, -1
gated_mix__spectral_gfnet__ssm_conv_s5__prompt_kernel_skip29:
  v_pk_mul_f32 v[172:173], v[188:189], v[172:173] op_sel_hi:[0,1]
  v_pk_mul_f32 v[174:175], v[188:189], v[174:175] op_sel_hi:[0,1]
  v_pk_mul_f32 v[180:181], v[188:189], v[180:181] op_sel_hi:[0,1]
  v_pk_mul_f32 v[182:183], v[188:189], v[182:183] op_sel_hi:[0,1]
  v_pk_mul_f32 v[204:205], v[188:189], v[204:205] op_sel_hi:[0,1]
  v_pk_mul_f32 v[206:207], v[188:189], v[206:207] op_sel_hi:[0,1]
  v_pk_mul_f32 v[212:213], v[188:189], v[212:213] op_sel_hi:[0,1]
  buffer_load_dwordx4 v131, s[68:71], s20 offen offset:3072 lds
  s_add_u32 s20, s20, 128
  s_and_b32 s20, s20, 0x7ff
  v_pk_mul_f32 v[214:215], v[188:189], v[214:215] op_sel_hi:[0,1]
  v_pk_mul_f32 v[220:221], v[188:189], v[220:221] op_sel_hi:[0,1]
  v_pk_mul_f32 v[222:223], v[188:189], v[222:223] op_sel_hi:[0,1]
  buffer_load_dwordx2 v[8:9], v27, s[64:67], 0 offen offset:0 sc1
  buffer_load_dwordx2 v[10:11], v27, s[64:67], 0 offen offset:512 sc1
  buffer_load_dwordx2 v[12:13], v27, s[64:67], 0 offen offset:1024 sc1
  buffer_load_dwordx2 v[16:17], v27, s[64:67], 0 offen offset:1536 sc1
  buffer_load_dwordx2 v[56:57], v27, s[64:67], 0 offen offset:2048 sc1
  buffer_load_dwordx2 v[74:75], v27, s[64:67], 0 offen offset:2560 sc1
  buffer_load_dwordx2 v[188:189], v27, s[64:67], 0 offen offset:3072 sc1
  buffer_load_dwordx2 v[192:193], v27, s[64:67], 0 offen offset:3584 sc1
  s_waitcnt lgkmcnt(0)
  s_add_u32 m0, s21, 32768
  s_nop 0
  buffer_load_dwordx4 v128, s[68:71], s20 offen offset:0 lds
  v_and_b32 v2, 7, v5
  v_lshlrev_b32 v26, 2, v6
  v_xor_b32 v2, v2, v26
  v_lshlrev_b32 v2, 4, v2
  v_lshl_or_b32 v2, v5, 10, v2
  s_lshl_b32 s6, s3, 8
  s_add_u32 s6, s6, 49152
  v_add_u32 v2, s6, v2
  s_waitcnt vmcnt(20)
  v_mov_b32 v228, v20
  s_waitcnt vmcnt(19)
  v_mov_b32 v229, v124
  s_waitcnt vmcnt(18)
  v_mov_b32 v230, v160
  s_waitcnt vmcnt(17)
  v_mov_b32 v231, v164
  v_mov_b32 v232, v21
  v_mov_b32 v233, v125
  v_mov_b32 v234, v161
  v_mov_b32 v235, v165
  v_mfma_f32_16x16x32_bf16 v[236:239], v[228:231], v[32:35], 0
  buffer_load_dwordx4 v129, s[68:71], s20 offen offset:1024 lds
  v_mfma_f32_16x16x32_bf16 v[240:243], v[228:231], v[36:39], 0
  v_mfma_f32_16x16x32_bf16 v[244:247], v[232:235], v[32:35], 0
  v_mfma_f32_16x16x32_bf16 v[248:251], v[232:235], v[36:39], 0
  v_mov_b32 v228, v22
  v_mov_b32 v229, v126
  v_mov_b32 v230, v162
  v_mov_b32 v231, v166
  v_mov_b32 v232, v23
  v_mov_b32 v233, v127
  buffer_load_dwordx4 v130, s[68:71], s20 offen offset:2048 lds
  v_mov_b32 v234, v163
  v_mov_b32 v235, v167
  v_xor_b32 v26, 0, v2
  v_cvt_pk_bf16_f32 v164, v236, v240
  v_cvt_pk_bf16_f32 v165, v237, v241
  v_cvt_pk_bf16_f32 v166, v238, v242
  v_cvt_pk_bf16_f32 v167, v239, v243
  ds_write_b128 v26, v[164:167]
  v_mfma_f32_16x16x32_bf16 v[236:239], v[228:231], v[32:35], 0
  v_mfma_f32_16x16x32_bf16 v[240:243], v[228:231], v[36:39], 0
  v_xor_b32 v26, 16, v2
  v_cvt_pk_bf16_f32 v20, v244, v248
  buffer_load_dwordx4 v131, s[68:71], s20 offen offset:3072 lds
  s_add_u32 s20, s20, 128
  s_and_b32 s20, s20, 0x7ff
  v_cvt_pk_bf16_f32 v21, v245, v249
  v_cvt_pk_bf16_f32 v22, v246, v250
  v_cvt_pk_bf16_f32 v23, v247, v251
  ds_write_b128 v26, v[20:23]
  v_mfma_f32_16x16x32_bf16 v[244:247], v[232:235], v[32:35], 0
  v_mfma_f32_16x16x32_bf16 v[248:251], v[232:235], v[36:39], 0
  v_xor_b32 v26, 32, v2
  v_cvt_pk_bf16_f32 v124, v236, v240
  v_cvt_pk_bf16_f32 v125, v237, v241
  v_cvt_pk_bf16_f32 v126, v238, v242
  v_cvt_pk_bf16_f32 v127, v239, v243
  ds_write_b128 v26, v[124:127]
  v_xor_b32 v26, 48, v2
  s_nop 0
  v_cvt_pk_bf16_f32 v160, v244, v248
  v_cvt_pk_bf16_f32 v161, v245, v249
  v_cvt_pk_bf16_f32 v162, v246, v250
  v_cvt_pk_bf16_f32 v163, v247, v251
  ds_write_b128 v26, v[160:163]
  s_waitcnt vmcnt(4)
  v_max_u32 v2, v8, v9
  v_max3_u32 v2, v2, v10, v11
  v_max3_u32 v2, v2, v12, v13
  v_max3_u32 v2, v2, v16, v17
  v_max3_u32 v2, v2, v56, v57
  v_max3_u32 v2, v2, v74, v75
  v_max3_u32 v2, v2, v188, v189
  v_max3_u32 v2, v2, v192, v193
  v_cmp_eq_u32 vcc, -1, v2
  s_nop 0
  s_cbranch_vccz gated_mix__spectral_gfnet__ssm_conv_s5__prompt_kernel_skip30
  s_mov_b32 s6, 0
gated_mix__spectral_gfnet__ssm_conv_s5__prompt_kernel_lb31:
  buffer_load_dwordx2 v[8:9], v27, s[64:67], 0 offen offset:0 sc1
  buffer_load_dwordx2 v[10:11], v27, s[64:67], 0 offen offset:512 sc1
  buffer_load_dwordx2 v[12:13], v27, s[64:67], 0 offen offset:1024 sc1
  buffer_load_dwordx2 v[16:17], v27, s[64:67], 0 offen offset:1536 sc1
  buffer_load_dwordx2 v[56:57], v27, s[64:67], 0 offen offset:2048 sc1
  buffer_load_dwordx2 v[74:75], v27, s[64:67], 0 offen offset:2560 sc1
  buffer_load_dwordx2 v[188:189], v27, s[64:67], 0 offen offset:3072 sc1
  buffer_load_dwordx2 v[192:193], v27, s[64:67], 0 offen offset:3584 sc1
  s_waitcnt vmcnt(0)
  v_max_u32 v2, v8, v9
  v_max3_u32 v2, v2, v10, v11
  v_max3_u32 v2, v2, v12, v13
  v_max3_u32 v2, v2, v16, v17
  v_max3_u32 v2, v2, v56, v57
  v_max3_u32 v2, v2, v74, v75
  v_max3_u32 v2, v2, v188, v189
  v_max3_u32 v2, v2, v192, v193
  v_cmp_eq_u32 vcc, -1, v2
  s_nop 0
  s_cbranch_vccz gated_mix__spectral_gfnet__ssm_conv_s5__prompt_kernel_lbout32
  s_add_u32 s6, s6, 1
  s_cmp_lt_u32 s6, 1048576
  s_cbranch_scc1 gated_mix__spectral_gfnet__ssm_conv_s5__prompt_kernel_lb31
gated_mix__spectral_gfnet__ssm_conv_s5__prompt_kernel_lbout32:
gated_mix__spectral_gfnet__ssm_conv_s5__prompt_kernel_skip30:
  s_add_u32 s8, s34, 10485760
  s_addc_u32 s9, s35, 0
  s_mov_b32 s10, 8388608
  s_mov_b32 s11, 0x20000
  v_pk_fma_f32 v[188:189], v[202:203], v[192:193], v[188:189] op_sel:[0,0,0] op_sel_hi:[0,1,1]
  v_pk_fma_f32 v[188:189], v[202:203], v[192:193], v[188:189] op_sel:[1,1,0] op_sel_hi:[1,0,1] neg_lo:[1,0,0]
  v_pk_fma_f32 v[74:75], v[202:203], v[188:189], v[74:75] op_sel:[0,0,0] op_sel_hi:[0,1,1]
  v_pk_fma_f32 v[74:75], v[202:203], v[188:189], v[74:75] op_sel:[1,1,0] op_sel_hi:[1,0,1] neg_lo:[1,0,0]
  v_pk_fma_f32 v[56:57], v[202:203], v[74:75], v[56:57] op_sel:[0,0,0] op_sel_hi:[0,1,1]
  v_pk_fma_f32 v[56:57], v[202:203], v[74:75], v[56:57] op_sel:[1,1,0] op_sel_hi:[1,0,1] neg_lo:[1,0,0]
  v_pk_fma_f32 v[16:17], v[202:203], v[56:57], v[16:17] op_sel:[0,0,0] op_sel_hi:[0,1,1]
  v_pk_fma_f32 v[16:17], v[202:203], v[56:57], v[16:17] op_sel:[1,1,0] op_sel_hi:[1,0,1] neg_lo:[1,0,0]
  v_pk_fma_f32 v[12:13], v[202:203], v[16:17], v[12:13] op_sel:[0,0,0] op_sel_hi:[0,1,1]
  v_pk_fma_f32 v[12:13], v[202:203], v[16:17], v[12:13] op_sel:[1,1,0] op_sel_hi:[1,0,1] neg_lo:[1,0,0]
  v_pk_fma_f32 v[10:11], v[202:203], v[12:13], v[10:11] op_sel:[0,0,0] op_sel_hi:[0,1,1]
  v_pk_fma_f32 v[10:11], v[202:203], v[12:13], v[10:11] op_sel:[1,1,0] op_sel_hi:[1,0,1] neg_lo:[1,0,0]
  v_pk_fma_f32 v[8:9], v[202:203], v[10:11], v[8:9] op_sel:[0,0,0] op_sel_hi:[0,1,1]
  v_pk_fma_f32 v[8:9], v[202:203], v[10:11], v[8:9] op_sel:[1,1,0] op_sel_hi:[1,0,1] neg_lo:[1,0,0]
  v_mov_b32 v10, v8
  v_mov_b32 v11, v9
  s_nop 0
  v_permlane32_swap_b32 v8, v10
  v_permlane32_swap_b32 v9, v11
  v_pk_fma_f32 v[8:9], v[198:199], v[10:11], v[8:9] op_sel:[0,0,0] op_sel_hi:[0,1,1]
  v_pk_fma_f32 v[8:9], v[198:199], v[10:11], v[8:9] op_sel:[1,1,0] op_sel_hi:[1,0,1] neg_lo:[1,0,0]
  v_pk_fma_f32 v[226:227], v[14:15], v[8:9], v[226:227] op_sel:[0,0,0] op_sel_hi:[0,1,1]
  v_pk_fma_f32 v[226:227], v[14:15], v[8:9], v[226:227] op_sel:[1,1,0] op_sel_hi:[1,0,1] neg_lo:[1,0,0]
  v_pk_fma_f32 v[224:225], v[18:19], v[8:9], v[224:225] op_sel:[0,0,0] op_sel_hi:[0,1,1]
  v_pk_fma_f32 v[224:225], v[18:19], v[8:9], v[224:225] op_sel:[1,1,0] op_sel_hi:[1,0,1] neg_lo:[1,0,0]
  v_swap_b32 v227, v224
  v_pk_fma_f32 v[76:77], v[190:191], v[226:227], v[76:77] op_sel:[0,0,0] op_sel_hi:[0,1,1]
  v_pk_fma_f32 v[92:93], v[190:191], v[224:225], v[92:93] op_sel:[0,0,0] op_sel_hi:[0,1,1]
  v_pk_fma_f32 v[76:77], v[190:191], v[224:225], v[76:77] op_sel:[1,0,0] op_sel_hi:[1,1,1] neg_lo:[1,0,0] neg_hi:[1,0,0]
  v_pk_fma_f32 v[92:93], v[190:191], v[226:227], v[92:93] op_sel:[1,0,0] op_sel_hi:[1,1,1]
  v_cvt_pk_bf16_f32 v20, v76, v77
  v_cvt_pk_bf16_f32 v21, -v92, -v93
  v_pk_fma_f32 v[78:79], v[190:191], v[76:77], v[78:79] op_sel:[0,0,0] op_sel_hi:[0,1,1]
  v_pk_fma_f32 v[94:95], v[190:191], v[92:93], v[94:95] op_sel:[0,0,0] op_sel_hi:[0,1,1]
  v_pk_fma_f32 v[78:79], v[190:191], v[92:93], v[78:79] op_sel:[1,0,0] op_sel_hi:[1,1,1] neg_lo:[1,0,0] neg_hi:[1,0,0]
  v_pk_fma_f32 v[94:95], v[190:191], v[76:77], v[94:95] op_sel:[1,0,0] op_sel_hi:[1,1,1]
  v_cvt_pk_bf16_f32 v22, v78, v79
  v_cvt_pk_bf16_f32 v23, -v94, -v95
  v_pk_fma_f32 v[80:81], v[190:191], v[78:79], v[80:81] op_sel:[0,0,0] op_sel_hi:[0,1,1]
  v_pk_fma_f32 v[96:97], v[190:191], v[94:95], v[96:97] op_sel:[0,0,0] op_sel_hi:[0,1,1]
  v_permlane32_swap_b32 v20, v21
  v_permlane32_swap_b32 v22, v23
  v_pk_fma_f32 v[80:81], v[190:191], v[94:95], v[80:81] op_sel:[1,0,0] op_sel_hi:[1,1,1] neg_lo:[1,0,0] neg_hi:[1,0,0]
  v_pk_fma_f32 v[96:97], v[190:191], v[78:79], v[96:97] op_sel:[1,0,0] op_sel_hi:[1,1,1]
  v_permlane16_swap_b32 v20, v22
  v_permlane16_swap_b32 v21, v23
  buffer_store_dwordx4 v[20:23], v28, s[8:11], s29 offen sc1
  s_add_u32 s29, s29, 1048576
  v_cvt_pk_bf16_f32 v32, v80, v81
  v_cvt_pk_bf16_f32 v33, -v96, -v97
  v_pk_fma_f32 v[82:83], v[190:191], v[80:81], v[82:83] op_sel:[0,0,0] op_sel_hi:[0,1,1]
  v_pk_fma_f32 v[98:99], v[190:191], v[96:97], v[98:99] op_sel:[0,0,0] op_sel_hi:[0,1,1]
  v_pk_fma_f32 v[82:83], v[190:191], v[96:97], v[82:83] op_sel:[1,0,0] op_sel_hi:[1,1,1] neg_lo:[1,0,0] neg_hi:[1,0,0]
  v_pk_fma_f32 v[98:99], v[190:191], v[80:81], v[98:99] op_sel:[1,0,0] op_sel_hi:[1,1,1]
  v_cvt_pk_bf16_f32 v34, v82, v83
  v_cvt_pk_bf16_f32 v35, -v98, -v99
  v_pk_fma_f32 v[84:85], v[190:191], v[82:83], v[84:85] op_sel:[0,0,0] op_sel_hi:[0,1,1]
  v_pk_fma_f32 v[100:101], v[190:191], v[98:99], v[100:101] op_sel:[0,0,0] op_sel_hi:[0,1,1]
  v_permlane32_swap_b32 v32, v33
  v_permlane32_swap_b32 v34, v35
  v_pk_fma_f32 v[84:85], v[190:191], v[98:99], v[84:85] op_sel:[1,0,0] op_sel_hi:[1,1,1] neg_lo:[1,0,0] neg_hi:[1,0,0]
  v_pk_fma_f32 v[100:101], v[190:191], v[82:83], v[100:101] op_sel:[1,0,0] op_sel_hi:[1,1,1]
  v_permlane16_swap_b32 v32, v34
  v_permlane16_swap_b32 v33, v35
  buffer_store_dwordx4 v[32:35], v28, s[8:11], s29 offen sc1
  s_add_u32 s29, s29, 1048576
  v_cvt_pk_bf16_f32 v36, v84, v85
  v_cvt_pk_bf16_f32 v37, -v100, -v101
  v_pk_fma_f32 v[86:87], v[190:191], v[84:85], v[86:87] op_sel:[0,0,0] op_sel_hi:[0,1,1]
  v_pk_fma_f32 v[102:103], v[190:191], v[100:101], v[102:103] op_sel:[0,0,0] op_sel_hi:[0,1,1]
  v_pk_fma_f32 v[86:87], v[190:191], v[100:101], v[86:87] op_sel:[1,0,0] op_sel_hi:[1,1,1] neg_lo:[1,0,0] neg_hi:[1,0,0]
  v_pk_fma_f32 v[102:103], v[190:191], v[84:85], v[102:103] op_sel:[1,0,0] op_sel_hi:[1,1,1]
  v_cvt_pk_bf16_f32 v38, v86, v87
  v_cvt_pk_bf16_f32 v39, -v102, -v103
  v_pk_fma_f32 v[88:89], v[190:191], v[86:87], v[88:89] op_sel:[0,0,0] op_sel_hi:[0,1,1]
  v_pk_fma_f32 v[104:105], v[190:191], v[102:103], v[104:105] op_sel:[0,0,0] op_sel_hi:[0,1,1]
  v_permlane32_swap_b32 v36, v37
  v_permlane32_swap_b32 v38, v39
  v_pk_fma_f32 v[88:89], v[190:191], v[102:103], v[88:89] op_sel:[1,0,0] op_sel_hi:[1,1,1] neg_lo:[1,0,0] neg_hi:[1,0,0]
  v_pk_fma_f32 v[104:105], v[190:191], v[86:87], v[104:105] op_sel:[1,0,0] op_sel_hi:[1,1,1]
  v_permlane16_swap_b32 v36, v38
  v_permlane16_swap_b32 v37, v39
  buffer_store_dwordx4 v[36:39], v28, s[8:11], s29 offen sc1
  s_add_u32 s29, s29, 1048576
  v_cvt_pk_bf16_f32 v20, v88, v89
  v_cvt_pk_bf16_f32 v21, -v104, -v105
  v_pk_fma_f32 v[90:91], v[190:191], v[88:89], v[90:91] op_sel:[0,0,0] op_sel_hi:[0,1,1]
  v_pk_fma_f32 v[106:107], v[190:191], v[104:105], v[106:107] op_sel:[0,0,0] op_sel_hi:[0,1,1]
  v_pk_fma_f32 v[90:91], v[190:191], v[104:105], v[90:91] op_sel:[1,0,0] op_sel_hi:[1,1,1] neg_lo:[1,0,0] neg_hi:[1,0,0]
  v_pk_fma_f32 v[106:107], v[190:191], v[88:89], v[106:107] op_sel:[1,0,0] op_sel_hi:[1,1,1]
  v_cvt_pk_bf16_f32 v22, v90, v91
  v_cvt_pk_bf16_f32 v23, -v106, -v107
  v_pk_fma_f32 v[108:109], v[190:191], v[90:91], v[108:109] op_sel:[0,0,0] op_sel_hi:[0,1,1]
  v_pk_fma_f32 v[144:145], v[190:191], v[106:107], v[144:145] op_sel:[0,0,0] op_sel_hi:[0,1,1]
  v_permlane32_swap_b32 v20, v21
  v_permlane32_swap_b32 v22, v23
  v_pk_fma_f32 v[108:109], v[190:191], v[106:107], v[108:109] op_sel:[1,0,0] op_sel_hi:[1,1,1] neg_lo:[1,0,0] neg_hi:[1,0,0]
  v_pk_fma_f32 v[144:145], v[190:191], v[90:91], v[144:145] op_sel:[1,0,0] op_sel_hi:[1,1,1]
  v_permlane16_swap_b32 v20, v22
  v_permlane16_swap_b32 v21, v23
  buffer_store_dwordx4 v[20:23], v28, s[8:11], s29 offen sc1
  s_add_u32 s29, s29, 1048576
  v_cvt_pk_bf16_f32 v32, v108, v109
  v_cvt_pk_bf16_f32 v33, -v144, -v145
  v_pk_fma_f32 v[110:111], v[190:191], v[108:109], v[110:111] op_sel:[0,0,0] op_sel_hi:[0,1,1]
  v_pk_fma_f32 v[146:147], v[190:191], v[144:145], v[146:147] op_sel:[0,0,0] op_sel_hi:[0,1,1]
  v_pk_fma_f32 v[110:111], v[190:191], v[144:145], v[110:111] op_sel:[1,0,0] op_sel_hi:[1,1,1] neg_lo:[1,0,0] neg_hi:[1,0,0]
  v_pk_fma_f32 v[146:147], v[190:191], v[108:109], v[146:147] op_sel:[1,0,0] op_sel_hi:[1,1,1]
  v_cvt_pk_bf16_f32 v34, v110, v111
  v_cvt_pk_bf16_f32 v35, -v146, -v147
  v_pk_fma_f32 v[112:113], v[190:191], v[110:111], v[112:113] op_sel:[0,0,0] op_sel_hi:[0,1,1]
  v_pk_fma_f32 v[148:149], v[190:191], v[146:147], v[148:149] op_sel:[0,0,0] op_sel_hi:[0,1,1]
  v_permlane32_swap_b32 v32, v33
  v_permlane32_swap_b32 v34, v35
  v_pk_fma_f32 v[112:113], v[190:191], v[146:147], v[112:113] op_sel:[1,0,0] op_sel_hi:[1,1,1] neg_lo:[1,0,0] neg_hi:[1,0,0]
  v_pk_fma_f32 v[148:149], v[190:191], v[110:111], v[148:149] op_sel:[1,0,0] op_sel_hi:[1,1,1]
  v_permlane16_swap_b32 v32, v34
  v_permlane16_swap_b32 v33, v35
  buffer_store_dwordx4 v[32:35], v28, s[8:11], s29 offen sc1
  s_add_u32 s29, s29, 1048576
  v_cvt_pk_bf16_f32 v36, v112, v113
  v_cvt_pk_bf16_f32 v37, -v148, -v149
  v_pk_fma_f32 v[114:115], v[190:191], v[112:113], v[114:115] op_sel:[0,0,0] op_sel_hi:[0,1,1]
  v_pk_fma_f32 v[150:151], v[190:191], v[148:149], v[150:151] op_sel:[0,0,0] op_sel_hi:[0,1,1]
  v_pk_fma_f32 v[114:115], v[190:191], v[148:149], v[114:115] op_sel:[1,0,0] op_sel_hi:[1,1,1] neg_lo:[1,0,0] neg_hi:[1,0,0]
  v_pk_fma_f32 v[150:151], v[190:191], v[112:113], v[150:151] op_sel:[1,0,0] op_sel_hi:[1,1,1]
  v_cvt_pk_bf16_f32 v38, v114, v115
  v_cvt_pk_bf16_f32 v39, -v150, -v151
  v_pk_fma_f32 v[116:117], v[190:191], v[114:115], v[116:117] op_sel:[0,0,0] op_sel_hi:[0,1,1]
  v_pk_fma_f32 v[152:153], v[190:191], v[150:151], v[152:153] op_sel:[0,0,0] op_sel_hi:[0,1,1]
  v_permlane32_swap_b32 v36, v37
  v_permlane32_swap_b32 v38, v39
  v_pk_fma_f32 v[116:117], v[190:191], v[150:151], v[116:117] op_sel:[1,0,0] op_sel_hi:[1,1,1] neg_lo:[1,0,0] neg_hi:[1,0,0]
  v_pk_fma_f32 v[152:153], v[190:191], v[114:115], v[152:153] op_sel:[1,0,0] op_sel_hi:[1,1,1]
  v_permlane16_swap_b32 v36, v38
  v_permlane16_swap_b32 v37, v39
  buffer_store_dwordx4 v[36:39], v28, s[8:11], s29 offen sc1
  s_add_u32 s29, s29, 1048576
  v_cvt_pk_bf16_f32 v20, v116, v117
  v_cvt_pk_bf16_f32 v21, -v152, -v153
  v_pk_fma_f32 v[118:119], v[190:191], v[116:117], v[118:119] op_sel:[0,0,0] op_sel_hi:[0,1,1]
  v_pk_fma_f32 v[154:155], v[190:191], v[152:153], v[154:155] op_sel:[0,0,0] op_sel_hi:[0,1,1]
  v_pk_fma_f32 v[118:119], v[190:191], v[152:153], v[118:119] op_sel:[1,0,0] op_sel_hi:[1,1,1] neg_lo:[1,0,0] neg_hi:[1,0,0]
  v_pk_fma_f32 v[154:155], v[190:191], v[116:117], v[154:155] op_sel:[1,0,0] op_sel_hi:[1,1,1]
  v_cvt_pk_bf16_f32 v22, v118, v119
  v_cvt_pk_bf16_f32 v23, -v154, -v155
  v_pk_fma_f32 v[120:121], v[190:191], v[118:119], v[120:121] op_sel:[0,0,0] op_sel_hi:[0,1,1]
  v_pk_fma_f32 v[156:157], v[190:191], v[154:155], v[156:157] op_sel:[0,0,0] op_sel_hi:[0,1,1]
  v_permlane32_swap_b32 v20, v21
  v_permlane32_swap_b32 v22, v23
  v_pk_fma_f32 v[120:121], v[190:191], v[154:155], v[120:121] op_sel:[1,0,0] op_sel_hi:[1,1,1] neg_lo:[1,0,0] neg_hi:[1,0,0]
  v_pk_fma_f32 v[156:157], v[190:191], v[118:119], v[156:157] op_sel:[1,0,0] op_sel_hi:[1,1,1]
  v_permlane16_swap_b32 v20, v22
  v_permlane16_swap_b32 v21, v23
  buffer_store_dwordx4 v[20:23], v28, s[8:11], s29 offen sc1
  s_add_u32 s29, s29, 1048576
  v_cvt_pk_bf16_f32 v32, v120, v121
  v_cvt_pk_bf16_f32 v33, -v156, -v157
  v_pk_fma_f32 v[122:123], v[190:191], v[120:121], v[122:123] op_sel:[0,0,0] op_sel_hi:[0,1,1]
  v_pk_fma_f32 v[158:159], v[190:191], v[156:157], v[158:159] op_sel:[0,0,0] op_sel_hi:[0,1,1]
  v_pk_fma_f32 v[122:123], v[190:191], v[156:157], v[122:123] op_sel:[1,0,0] op_sel_hi:[1,1,1] neg_lo:[1,0,0] neg_hi:[1,0,0]
  v_pk_fma_f32 v[158:159], v[190:191], v[120:121], v[158:159] op_sel:[1,0,0] op_sel_hi:[1,1,1]
  v_cvt_pk_bf16_f32 v34, v122, v123
  v_cvt_pk_bf16_f32 v35, -v158, -v159
  v_permlane32_swap_b32 v32, v33
  s_nop 0
  v_permlane32_swap_b32 v34, v35
  s_nop 1
  v_permlane16_swap_b32 v32, v34
  v_permlane16_swap_b32 v33, v35
  buffer_store_dwordx4 v[32:35], v28, s[8:11], s29 offen sc1
  ds_read_b128 a[32:35], v134 offset:32768
  ds_read_b128 a[36:39], v135 offset:32768
  ds_read_b128 a[40:43], v134 offset:34816
  ds_read_b128 a[44:47], v135 offset:34816
  ds_read_b128 a[48:51], v134 offset:49152
  ds_read_b128 a[52:55], v135 offset:49152
  ds_read_b128 a[56:59], v134 offset:51200
  ds_read_b128 a[60:63], v135 offset:51200
  ds_read_b128 a[64:67], v134 offset:16384
  ds_read_b128 a[68:71], v135 offset:16384
  ds_read_b128 a[72:75], v134 offset:18432
  ds_read_b128 a[76:79], v135 offset:18432
  s_waitcnt vmcnt(8)
  ds_read_b128 a[80:83], v132 offset:32768
  ds_read_b128 a[84:87], v133 offset:32768
  ds_read_b128 a[88:91], v132 offset:34816
  ds_read_b128 a[92:95], v133 offset:34816
  s_cmp_lg_u32 s3, 3
  s_cbranch_scc1 gated_mix__spectral_gfnet__ssm_conv_s5__prompt_kernel_skip34
  s_getpc_b64 s[6:7]
gated_mix__spectral_gfnet__ssm_conv_s5__prompt_kernel_pc33:
  s_lshr_b32 s16, s2, 3
  s_mul_i32 s16, s16, 512
  v_min_u32 v8, 3, v4
  v_lshl_add_u32 v8, v8, 7, s16
  v_min_u32 v8, gated_mix__spectral_gfnet__ssm_conv_s5__prompt_kernel_end-gated_mix__spectral_gfnet__ssm_conv_s5__prompt_kernel_pc33, v8
  v_mov_b32 v9, 0
  v_lshl_add_u64 v[8:9], v[8:9], 0, s[6:7]
  global_load_dword v1, v[8:9], off
gated_mix__spectral_gfnet__ssm_conv_s5__prompt_kernel_skip34:
  s_waitcnt lgkmcnt(15)
  s_barrier
  v_lshlrev_b32 v2, 7, v0
  s_add_u32 m0, s21, 0
  s_nop 0
  buffer_load_dwordx4 v128, s[68:71], s20 offen offset:0 lds
  s_and_b32 s6, s3, 1
  s_lshl_b32 s6, s6, 2
  v_xor_b32 v9, s6, v4
  s_lshl_b32 s6, s3, 12
  s_add_u32 s6, s6, 49152
  v_lshl_add_u32 v10, v9, 4, s6
  v_xor_b32 v9, 0, v10
  ds_read_b128 v[12:15], v9 offset:0
  v_xor_b32 v9, 16, v10
  ds_read_b128 v[16:19], v9 offset:1024
  v_xor_b32 v9, 32, v10
  ds_read_b128 v[20:23], v9 offset:2048
  v_xor_b32 v9, 48, v10
  ds_read_b128 v[32:35], v9 offset:3072
  s_waitcnt lgkmcnt(3)
  v_mfma_f32_16x16x32_bf16 v[36:39], v[12:15], v[40:43], 0
  buffer_load_dwordx4 v129, s[68:71], s20 offen offset:1024 lds
  v_mfma_f32_16x16x32_bf16 v[76:79], v[12:15], v[44:47], 0
  s_waitcnt lgkmcnt(2)
  v_mfma_f32_16x16x32_bf16 v[80:83], v[16:19], v[40:43], 0
  v_mfma_f32_16x16x32_bf16 v[84:87], v[16:19], v[44:47], 0
  s_waitcnt lgkmcnt(1)
  v_mfma_f32_16x16x32_bf16 v[88:91], v[20:23], v[40:43], 0
  buffer_load_dwordx4 v130, s[68:71], s20 offen offset:2048 lds
  v_mfma_f32_16x16x32_bf16 v[92:95], v[20:23], v[44:47], 0
  s_waitcnt lgkmcnt(0)
  v_mfma_f32_16x16x32_bf16 v[96:99], v[32:35], v[40:43], 0
  v_mfma_f32_16x16x32_bf16 v[100:103], v[32:35], v[44:47], 0
  v_pk_mul_f32 v[104:105], v[36:37], v[48:49]
  v_pk_mul_f32 v[106:107], v[76:77], v[48:49]
  v_pk_fma_f32 v[104:105], v[76:77], v[52:53], v[104:105]
  v_pk_fma_f32 v[106:107], v[36:37], v[52:53], v[106:107] neg_lo:[0,1,0] neg_hi:[0,1,0]
  buffer_load_dwordx4 v131, s[68:71], s20 offen offset:3072 lds
  s_add_u32 s20, s20, 128
  s_and_b32 s20, s20, 0x7ff
  v_cvt_pk_bf16_f32 v12, v104, v106
  v_cvt_pk_bf16_f32 v13, v105, v107
  v_pk_mul_f32 v[104:105], v[38:39], v[50:51]
  v_pk_mul_f32 v[106:107], v[78:79], v[50:51]
  v_pk_fma_f32 v[104:105], v[78:79], v[54:55], v[104:105]
  v_pk_fma_f32 v[106:107], v[38:39], v[54:55], v[106:107] neg_lo:[0,1,0] neg_hi:[0,1,0]
  v_cvt_pk_bf16_f32 v14, v104, v106
  v_cvt_pk_bf16_f32 v15, v105, v107
  v_pk_mul_f32 v[104:105], v[80:81], v[48:49]
  v_pk_mul_f32 v[106:107], v[84:85], v[48:49]
  v_pk_fma_f32 v[104:105], v[84:85], v[52:53], v[104:105]
  v_pk_fma_f32 v[106:107], v[80:81], v[52:53], v[106:107] neg_lo:[0,1,0] neg_hi:[0,1,0]
  v_cvt_pk_bf16_f32 v16, v104, v106
  v_cvt_pk_bf16_f32 v17, v105, v107
  v_pk_mul_f32 v[104:105], v[82:83], v[50:51]
  v_pk_mul_f32 v[106:107], v[86:87], v[50:51]
  s_add_u32 m0, s21, 65536
  s_nop 0
  buffer_load_dwordx4 v128, s[68:71], s20 offen offset:0 lds
  v_pk_fma_f32 v[104:105], v[86:87], v[54:55], v[104:105]
  v_pk_fma_f32 v[106:107], v[82:83], v[54:55], v[106:107] neg_lo:[0,1,0] neg_hi:[0,1,0]
  v_cvt_pk_bf16_f32 v18, v104, v106
  v_cvt_pk_bf16_f32 v19, v105, v107
  v_mfma_f32_16x16x32_bf16 v[36:39], a[224:227], v[12:15], 0
  v_mfma_f32_16x16x32_bf16 v[76:79], a[228:231], v[12:15], 0
  v_pk_mul_f32 v[104:105], v[88:89], v[48:49]
  v_pk_mul_f32 v[106:107], v[92:93], v[48:49]
  v_pk_fma_f32 v[104:105], v[92:93], v[52:53], v[104:105]
  v_pk_fma_f32 v[106:107], v[88:89], v[52:53], v[106:107] neg_lo:[0,1,0] neg_hi:[0,1,0]
  buffer_load_dwordx4 v129, s[68:71], s20 offen offset:1024 lds
  v_cvt_pk_bf16_f32 v20, v104, v106
  v_cvt_pk_bf16_f32 v21, v105, v107
  v_pk_mul_f32 v[104:105], v[90:91], v[50:51]
  v_pk_mul_f32 v[106:107], v[94:95], v[50:51]
  v_pk_fma_f32 v[104:105], v[94:95], v[54:55], v[104:105]
  v_pk_fma_f32 v[106:107], v[90:91], v[54:55], v[106:107] neg_lo:[0,1,0] neg_hi:[0,1,0]
  v_cvt_pk_bf16_f32 v22, v104, v106
  v_cvt_pk_bf16_f32 v23, v105, v107
  v_mfma_f32_16x16x32_bf16 v[80:83], a[224:227], v[16:19], 0
  v_mfma_f32_16x16x32_bf16 v[84:87], a[228:231], v[16:19], 0
  buffer_load_dwordx4 v130, s[68:71], s20 offen offset:2048 lds
  v_pk_mul_f32 v[104:105], v[96:97], v[48:49]
  v_pk_mul_f32 v[106:107], v[100:101], v[48:49]
  v_pk_fma_f32 v[104:105], v[100:101], v[52:53], v[104:105]
  v_pk_fma_f32 v[106:107], v[96:97], v[52:53], v[106:107] neg_lo:[0,1,0] neg_hi:[0,1,0]
  v_cvt_pk_bf16_f32 v32, v104, v106
  v_cvt_pk_bf16_f32 v33, v105, v107
  v_pk_mul_f32 v[104:105], v[98:99], v[50:51]
  v_pk_mul_f32 v[106:107], v[102:103], v[50:51]
  v_pk_fma_f32 v[104:105], v[102:103], v[54:55], v[104:105]
  v_pk_fma_f32 v[106:107], v[98:99], v[54:55], v[106:107] neg_lo:[0,1,0] neg_hi:[0,1,0]
  v_cvt_pk_bf16_f32 v34, v104, v106
  v_cvt_pk_bf16_f32 v35, v105, v107
  v_mfma_f32_16x16x32_bf16 v[88:91], a[224:227], v[20:23], 0
  buffer_load_dwordx4 v131, s[68:71], s20 offen offset:3072 lds
  s_add_u32 s20, s20, 128
  s_and_b32 s20, s20, 0x7ff
  v_mfma_f32_16x16x32_bf16 v[92:95], a[228:231], v[20:23], 0
  v_mfma_f32_16x16x32_bf16 v[96:99], a[224:227], v[32:35], 0
  v_mfma_f32_16x16x32_bf16 v[100:103], a[228:231], v[32:35], 0
  s_waitcnt vmcnt(8)
  s_barrier
  s_cmp_lg_u32 s3, 0
  s_cbranch_scc1 gated_mix__spectral_gfnet__ssm_conv_s5__prompt_kernel_skip35
  s_mov_b64 exec, 1
  buffer_store_dword v7, v25, s[48:51], s5 offen sc1
  s_mov_b64 exec, -1
gated_mix__spectral_gfnet__ssm_conv_s5__prompt_kernel_skip35:
  s_cmp_eq_u32 s14, 0
  s_cbranch_scc1 gated_mix__spectral_gfnet__ssm_conv_s5__prompt_kernel_skip36
  v_pk_mul_f32 v[104:105], v[36:37], v[216:217]
  v_pk_mul_f32 v[106:107], v[76:77], v[216:217]
  v_pk_fma_f32 v[104:105], v[76:77], v[220:221], v[104:105] neg_lo:[0,1,0] neg_hi:[0,1,0]
  v_pk_fma_f32 v[106:107], v[36:37], v[220:221], v[106:107]
  v_cvt_pk_bf16_f32 v108, v104, v106
  v_cvt_pk_bf16_f32 v109, v105, v107
  v_pk_mul_f32 v[104:105], v[38:39], v[218:219]
  v_pk_mul_f32 v[106:107], v[78:79], v[218:219]
  v_pk_fma_f32 v[104:105], v[78:79], v[222:223], v[104:105] neg_lo:[0,1,0] neg_hi:[0,1,0]
  v_pk_fma_f32 v[106:107], v[38:39], v[222:223], v[106:107]
  v_cvt_pk_bf16_f32 v110, v104, v106
  v_cvt_pk_bf16_f32 v111, v105, v107
  s_nop 1
  v_mfma_f32_16x16x32_bf16 v[216:219], v[108:111], a[232:235], 0
  v_mfma_f32_16x16x32_bf16 v[220:223], v[108:111], a[236:239], 0
  s_nop 6
  v_pk_mul_f32 v[104:105], v[216:217], v[136:137]
  v_pk_mul_f32 v[106:107], v[220:221], v[136:137]
  v_pk_fma_f32 v[104:105], v[220:221], v[140:141], v[104:105] neg_lo:[0,1,0] neg_hi:[0,1,0]
  v_pk_fma_f32 v[106:107], v[216:217], v[140:141], v[106:107]
  v_cvt_pk_bf16_f32 v108, v104, v106
  v_cvt_pk_bf16_f32 v109, v105, v107
  v_pk_mul_f32 v[104:105], v[218:219], v[138:139]
  v_pk_mul_f32 v[106:107], v[222:223], v[138:139]
  v_pk_fma_f32 v[104:105], v[222:223], v[142:143], v[104:105] neg_lo:[0,1,0] neg_hi:[0,1,0]
  v_pk_fma_f32 v[106:107], v[218:219], v[142:143], v[106:107]
  v_cvt_pk_bf16_f32 v110, v104, v106
  v_cvt_pk_bf16_f32 v111, v105, v107
  s_nop 1
  v_mfma_f32_16x16x32_bf16 v[216:219], a[240:243], v[108:111], 0
  v_mfma_f32_16x16x32_bf16 v[220:223], a[244:247], v[108:111], 0
gated_mix__spectral_gfnet__ssm_conv_s5__prompt_kernel_skip36:
  s_add_u32 m0, s21, 16384
  s_nop 0
  buffer_load_dwordx4 v128, s[68:71], s20 offen offset:0 lds
  v_pk_mul_f32 v[104:105], v[36:37], v[168:169]
  v_pk_mul_f32 v[106:107], v[76:77], v[168:169]
  v_pk_fma_f32 v[104:105], v[76:77], v[172:173], v[104:105] neg_lo:[0,1,0] neg_hi:[0,1,0]
  v_pk_fma_f32 v[106:107], v[36:37], v[172:173], v[106:107]
  v_cvt_pk_bf16_f32 v12, v104, v106
  v_cvt_pk_bf16_f32 v13, v105, v107
  v_pk_mul_f32 v[104:105], v[38:39], v[170:171]
  v_pk_mul_f32 v[106:107], v[78:79], v[170:171]
  v_pk_fma_f32 v[104:105], v[78:79], v[174:175], v[104:105] neg_lo:[0,1,0] neg_hi:[0,1,0]
  v_pk_fma_f32 v[106:107], v[38:39], v[174:175], v[106:107]
  v_cvt_pk_bf16_f32 v14, v104, v106
  v_cvt_pk_bf16_f32 v15, v105, v107
  v_pk_mul_f32 v[104:105], v[80:81], v[176:177]
  v_pk_mul_f32 v[106:107], v[84:85], v[176:177]
  v_pk_fma_f32 v[104:105], v[84:85], v[180:181], v[104:105] neg_lo:[0,1,0] neg_hi:[0,1,0]
  v_pk_fma_f32 v[106:107], v[80:81], v[180:181], v[106:107]
  buffer_load_dwordx4 v129, s[68:71], s20 offen offset:1024 lds
  v_cvt_pk_bf16_f32 v16, v104, v106
  v_cvt_pk_bf16_f32 v17, v105, v107
  v_pk_mul_f32 v[104:105], v[82:83], v[178:179]
  v_pk_mul_f32 v[106:107], v[86:87], v[178:179]
  v_pk_fma_f32 v[104:105], v[86:87], v[182:183], v[104:105] neg_lo:[0,1,0] neg_hi:[0,1,0]
  v_pk_fma_f32 v[106:107], v[82:83], v[182:183], v[106:107]
  v_cvt_pk_bf16_f32 v18, v104, v106
  v_cvt_pk_bf16_f32 v19, v105, v107
  v_mfma_f32_16x16x32_bf16 v[36:39], v[12:15], a[232:235], 0
  v_mfma_f32_16x16x32_bf16 v[76:79], v[12:15], a[236:239], 0
  buffer_load_dwordx4 v130, s[68:71], s20 offen offset:2048 lds
  v_pk_mul_f32 v[104:105], v[88:89], v[184:185]
  v_pk_mul_f32 v[106:107], v[92:93], v[184:185]
  v_pk_fma_f32 v[104:105], v[92:93], v[204:205], v[104:105] neg_lo:[0,1,0] neg_hi:[0,1,0]
  v_pk_fma_f32 v[106:107], v[88:89], v[204:205], v[106:107]
  v_cvt_pk_bf16_f32 v20, v104, v106
  v_cvt_pk_bf16_f32 v21, v105, v107
  v_pk_mul_f32 v[104:105], v[90:91], v[186:187]
  v_pk_mul_f32 v[106:107], v[94:95], v[186:187]
  v_pk_fma_f32 v[104:105], v[94:95], v[206:207], v[104:105] neg_lo:[0,1,0] neg_hi:[0,1,0]
  v_pk_fma_f32 v[106:107], v[90:91], v[206:207], v[106:107]
  v_cvt_pk_bf16_f32 v22, v104, v106
  v_cvt_pk_bf16_f32 v23, v105, v107
  v_mfma_f32_16x16x32_bf16 v[80:83], v[16:19], a[232:235], 0
  buffer_load_dwordx4 v131, s[68:71], s20 offen offset:3072 lds
  s_add_u32 s20, s20, 128
  s_and_b32 s20, s20, 0x7ff
  v_mfma_f32_16x16x32_bf16 v[84:87], v[16:19], a[236:239], 0
  v_pk_mul_f32 v[104:105], v[96:97], v[208:209]
  v_pk_mul_f32 v[106:107], v[100:101], v[208:209]
  v_pk_fma_f32 v[104:105], v[100:101], v[212:213], v[104:105] neg_lo:[0,1,0] neg_hi:[0,1,0]
  v_pk_fma_f32 v[106:107], v[96:97], v[212:213], v[106:107]
  v_cvt_pk_bf16_f32 v32, v104, v106
  v_cvt_pk_bf16_f32 v33, v105, v107
  v_pk_mul_f32 v[104:105], v[98:99], v[210:211]
  v_pk_mul_f32 v[106:107], v[102:103], v[210:211]
  v_pk_fma_f32 v[104:105], v[102:103], v[214:215], v[104:105] neg_lo:[0,1,0] neg_hi:[0,1,0]
  v_pk_fma_f32 v[106:107], v[98:99], v[214:215], v[106:107]
  v_cvt_pk_bf16_f32 v34, v104, v106
  v_cvt_pk_bf16_f32 v35, v105, v107
  s_add_u32 m0, s21, 98304
  s_nop 0
  buffer_load_dwordx4 v128, s[68:71], s20 offen offset:0 lds
  v_mfma_f32_16x16x32_bf16 v[88:91], v[20:23], a[232:235], 0
  v_mfma_f32_16x16x32_bf16 v[92:95], v[20:23], a[236:239], 0
  v_mfma_f32_16x16x32_bf16 v[96:99], v[32:35], a[232:235], 0
  v_mfma_f32_16x16x32_bf16 v[100:103], v[32:35], a[236:239], 0
  buffer_load_dwordx4 v129, s[68:71], s20 offen offset:1024 lds
  v_pk_mul_f32 v[104:105], v[36:37], v[136:137]
  v_pk_mul_f32 v[106:107], v[76:77], v[136:137]
  v_pk_fma_f32 v[104:105], v[76:77], v[140:141], v[104:105] neg_lo:[0,1,0] neg_hi:[0,1,0]
  v_pk_fma_f32 v[106:107], v[36:37], v[140:141], v[106:107]
  v_cvt_pk_bf16_f32 v12, v104, v106
  v_cvt_pk_bf16_f32 v13, v105, v107
  v_pk_mul_f32 v[104:105], v[38:39], v[138:139]
  v_pk_mul_f32 v[106:107], v[78:79], v[138:139]
  v_pk_fma_f32 v[104:105], v[78:79], v[142:143], v[104:105] neg_lo:[0,1,0] neg_hi:[0,1,0]
  v_pk_fma_f32 v[106:107], v[38:39], v[142:143], v[106:107]
  v_cvt_pk_bf16_f32 v14, v104, v106
  v_cvt_pk_bf16_f32 v15, v105, v107
  v_pk_mul_f32 v[104:105], v[80:81], v[136:137]
  v_pk_mul_f32 v[106:107], v[84:85], v[136:137]
  v_pk_fma_f32 v[104:105], v[84:85], v[140:141], v[104:105] neg_lo:[0,1,0] neg_hi:[0,1,0]
  v_pk_fma_f32 v[106:107], v[80:81], v[140:141], v[106:107]
  buffer_load_dwordx4 v130, s[68:71], s20 offen offset:2048 lds
  v_cvt_pk_bf16_f32 v16, v104, v106
  v_cvt_pk_bf16_f32 v17, v105, v107
  v_pk_mul_f32 v[104:105], v[82:83], v[138:139]
  v_pk_mul_f32 v[106:107], v[86:87], v[138:139]
  v_pk_fma_f32 v[104:105], v[86:87], v[142:143], v[104:105] neg_lo:[0,1,0] neg_hi:[0,1,0]
  v_pk_fma_f32 v[106:107], v[82:83], v[142:143], v[106:107]
  v_cvt_pk_bf16_f32 v18, v104, v106
  v_cvt_pk_bf16_f32 v19, v105, v107
  v_mfma_f32_16x16x32_bf16 v[36:39], a[240:243], v[12:15], 0
  v_mfma_f32_16x16x32_bf16 v[76:79], a[244:247], v[12:15], 0
  buffer_load_dwordx4 v131, s[68:71], s20 offen offset:3072 lds
  s_add_u32 s20, s20, 128
  s_and_b32 s20, s20, 0x7ff
  v_pk_mul_f32 v[104:105], v[88:89], v[136:137]
  v_pk_mul_f32 v[106:107], v[92:93], v[136:137]
  v_pk_fma_f32 v[104:105], v[92:93], v[140:141], v[104:105] neg_lo:[0,1,0] neg_hi:[0,1,0]
  v_pk_fma_f32 v[106:107], v[88:89], v[140:141], v[106:107]
  v_cvt_pk_bf16_f32 v20, v104, v106
  v_cvt_pk_bf16_f32 v21, v105, v107
  v_pk_mul_f32 v[104:105], v[90:91], v[138:139]
  v_pk_mul_f32 v[106:107], v[94:95], v[138:139]
  v_pk_fma_f32 v[104:105], v[94:95], v[142:143], v[104:105] neg_lo:[0,1,0] neg_hi:[0,1,0]
  v_pk_fma_f32 v[106:107], v[90:91], v[142:143], v[106:107]
  v_cvt_pk_bf16_f32 v22, v104, v106
  v_cvt_pk_bf16_f32 v23, v105, v107
  v_mfma_f32_16x16x32_bf16 v[80:83], a[240:243], v[16:19], 0
  s_add_u32 m0, s21, 114688
  s_nop 0
  buffer_load_dwordx4 v128, s[68:71], s20 offen offset:0 lds
  v_mfma_f32_16x16x32_bf16 v[84:87], a[244:247], v[16:19], 0
  v_pk_mul_f32 v[104:105], v[96:97], v[136:137]
  v_pk_mul_f32 v[106:107], v[100:101], v[136:137]
  v_pk_fma_f32 v[104:105], v[100:101], v[140:141], v[104:105] neg_lo:[0,1,0] neg_hi:[0,1,0]
  v_pk_fma_f32 v[106:107], v[96:97], v[140:141], v[106:107]
  v_cvt_pk_bf16_f32 v32, v104, v106
  v_cvt_pk_bf16_f32 v33, v105, v107
  v_pk_mul_f32 v[104:105], v[98:99], v[138:139]
  v_pk_mul_f32 v[106:107], v[102:103], v[138:139]
  v_pk_fma_f32 v[104:105], v[102:103], v[142:143], v[104:105] neg_lo:[0,1,0] neg_hi:[0,1,0]
  v_pk_fma_f32 v[106:107], v[98:99], v[142:143], v[106:107]
  v_cvt_pk_bf16_f32 v34, v104, v106
  v_cvt_pk_bf16_f32 v35, v105, v107
  buffer_load_dwordx4 v129, s[68:71], s20 offen offset:1024 lds
  v_mfma_f32_16x16x32_bf16 v[88:91], a[240:243], v[20:23], 0
  v_mfma_f32_16x16x32_bf16 v[92:95], a[244:247], v[20:23], 0
  v_mfma_f32_16x16x32_bf16 v[96:99], a[240:243], v[32:35], 0
  v_mfma_f32_16x16x32_bf16 v[100:103], a[244:247], v[32:35], 0
  buffer_load_dwordx4 v130, s[68:71], s20 offen offset:2048 lds
  v_lshlrev_b32 v9, 12, v6
  v_lshl_add_u32 v9, v5, 4, v9
  s_lshl_b32 s6, s3, 8
  s_add_u32 s6, s6, 147456
  v_add_u32 v9, s6, v9
  s_sub_u32 s6, s14, 1
  s_or_b32 s6, s6, s3
  s_cmp_lg_u32 s6, 0
  s_cbranch_scc1 gated_mix__spectral_gfnet__ssm_conv_s5__prompt_kernel_skip37
  v_mov_b32 v76, v220
  v_mov_b32 v77, v221
  v_mov_b32 v78, v222
  v_mov_b32 v79, v223
gated_mix__spectral_gfnet__ssm_conv_s5__prompt_kernel_skip37:
  v_cvt_pk_bf16_f32 v12, v36, v76
  v_cvt_pk_bf16_f32 v13, v80, v84
  v_cvt_pk_bf16_f32 v14, v88, v92
  v_cvt_pk_bf16_f32 v15, v96, v100
  ds_write_b128 v9, v[12:15] offset:0
  v_cvt_pk_bf16_f32 v16, v37, v77
  v_cvt_pk_bf16_f32 v17, v81, v85
  buffer_load_dwordx4 v131, s[68:71], s20 offen offset:3072 lds
  s_add_u32 s20, s20, 128
  s_and_b32 s20, s20, 0x7ff
  v_cvt_pk_bf16_f32 v18, v89, v93
  v_cvt_pk_bf16_f32 v19, v97, v101
  ds_write_b128 v9, v[16:19] offset:1024
  v_cvt_pk_bf16_f32 v20, v38, v78
  v_cvt_pk_bf16_f32 v21, v82, v86
  v_cvt_pk_bf16_f32 v22, v90, v94
  v_cvt_pk_bf16_f32 v23, v98, v102
  ds_write_b128 v9, v[20:23] offset:2048
  v_cvt_pk_bf16_f32 v32, v39, v79
  v_cvt_pk_bf16_f32 v33, v83, v87
  v_cvt_pk_bf16_f32 v34, v91, v95
  v_cvt_pk_bf16_f32 v35, v99, v103
  ds_write_b128 v9, v[32:35] offset:3072
  s_add_u32 m0, s21, 81920
  s_nop 0
  buffer_load_dwordx4 v128, s[68:71], s20 offen offset:0 lds
  buffer_load_dwordx4 v129, s[68:71], s20 offen offset:1024 lds
  buffer_load_dwordx4 v130, s[68:71], s20 offen offset:2048 lds
  buffer_load_dwordx4 v131, s[68:71], s20 offen offset:3072 lds
  s_add_u32 s20, s20, 128
  s_and_b32 s20, s20, 0x7ff
  s_waitcnt vmcnt(20)
  ds_read_b128 a[96:99], v132 offset:0
  ds_read_b128 a[100:103], v133 offset:0
  ds_read_b128 a[104:107], v132 offset:2048
  ds_read_b128 a[108:111], v133 offset:2048
  s_add_u32 m0, s21, 32768
  s_nop 0
  buffer_load_dwordx4 v128, s[68:71], s20 offen offset:0 lds
  buffer_load_dwordx4 v129, s[68:71], s20 offen offset:1024 lds
  buffer_load_dwordx4 v130, s[68:71], s20 offen offset:2048 lds
  buffer_load_dwordx4 v131, s[68:71], s20 offen offset:3072 lds
  s_add_u32 s20, s20, 128
  s_and_b32 s20, s20, 0x7ff
  s_waitcnt vmcnt(20)
  ds_read_b128 a[112:115], v134 offset:0
  ds_read_b128 a[116:119], v135 offset:0
  ds_read_b128 a[120:123], v134 offset:2048
  ds_read_b128 a[124:127], v135 offset:2048
  s_waitcnt lgkmcnt(4)
  s_add_u32 m0, s21, 0
  s_nop 0
  buffer_load_dwordx4 v128, s[68:71], s20 offen offset:0 lds
  buffer_load_dwordx4 v129, s[68:71], s20 offen offset:1024 lds
  buffer_load_dwordx4 v130, s[68:71], s20 offen offset:2048 lds
  buffer_load_dwordx4 v131, s[68:71], s20 offen offset:3072 lds
  s_add_u32 s20, s20, 128
  s_and_b32 s20, s20, 0x7ff
  s_waitcnt lgkmcnt(0)
  s_barrier
  s_lshl_b32 s6, s3, 12
  s_add_u32 s6, s6, 147456
  v_lshl_add_u32 v9, v4, 4, s6
  ds_read_b128 v[12:15], v9 offset:0
  ds_read_b128 v[16:19], v9 offset:1024
  ds_read_b128 v[20:23], v9 offset:2048
  ds_read_b128 v[32:35], v9 offset:3072
  s_mov_b32 s6, 1048576
  v_mul_lo_u32 v9, v6, s6
  v_lshl_add_u32 v9, v5, 2, v9
  s_mul_i32 s7, s3, 65536
  s_lshr_b32 s6, s40, 4
  s_lshl_b32 s6, s6, 12
  s_add_u32 s7, s7, s6
  s_lshl_b32 s6, s41, 10
  s_add_u32 s7, s7, s6
  s_and_b32 s6, s40, 15
  s_lshl_b32 s6, s6, 6
  s_add_u32 s7, s7, s6
  s_waitcnt lgkmcnt(3)
  v_mfma_f32_16x16x32_bf16 v[36:39], a[248:251], v[12:15], 0
  v_mfma_f32_16x16x32_bf16 v[40:43], a[252:255], v[12:15], 0
  s_waitcnt lgkmcnt(2)
  v_mfma_f32_16x16x32_bf16 v[44:47], a[248:251], v[16:19], 0
  v_mfma_f32_16x16x32_bf16 v[48:51], a[252:255], v[16:19], 0
  s_waitcnt lgkmcnt(1)
  v_mfma_f32_16x16x32_bf16 v[52:55], a[248:251], v[20:23], 0
  v_mfma_f32_16x16x32_bf16 v[76:79], a[252:255], v[20:23], 0
  s_waitcnt lgkmcnt(0)
  v_mfma_f32_16x16x32_bf16 v[80:83], a[248:251], v[32:35], 0
  v_mfma_f32_16x16x32_bf16 v[84:87], a[252:255], v[32:35], 0
  v_cvt_pk_bf16_f32 v12, v36, v40
  v_cvt_pk_bf16_f32 v13, v37, v41
  v_cvt_pk_bf16_f32 v14, v38, v42
  v_cvt_pk_bf16_f32 v15, v39, v43
  v_cvt_pk_bf16_f32 v16, v44, v48
  v_cvt_pk_bf16_f32 v17, v45, v49
  v_cvt_pk_bf16_f32 v18, v46, v50
  v_cvt_pk_bf16_f32 v19, v47, v51
  v_cvt_pk_bf16_f32 v20, v52, v76
  v_cvt_pk_bf16_f32 v21, v53, v77
  v_cvt_pk_bf16_f32 v22, v54, v78
  v_cvt_pk_bf16_f32 v23, v55, v79
  v_cvt_pk_bf16_f32 v32, v80, v84
  v_cvt_pk_bf16_f32 v33, v81, v85
  v_cvt_pk_bf16_f32 v34, v82, v86
  v_cvt_pk_bf16_f32 v35, v83, v87
  buffer_load_dword v8, v2, s[48:51], s5 offen sc1
  s_add_u32 s24, s34, 5242880
  s_addc_u32 s25, s35, 0
  s_mov_b32 s26, 4194304
  s_mov_b32 s27, 0x20000
  s_waitcnt vmcnt(21)
  ds_read_b128 a[128:131], v132 offset:16384
  ds_read_b128 a[132:135], v133 offset:16384
  ds_read_b128 a[136:139], v132 offset:18432
  ds_read_b128 a[140:143], v133 offset:18432
  s_waitcnt vmcnt(17)
  ds_read_b128 a[144:147], v134 offset:32768
  ds_read_b128 a[148:151], v135 offset:32768
  ds_read_b128 a[152:155], v134 offset:34816
  ds_read_b128 a[156:159], v135 offset:34816
  s_waitcnt vmcnt(13)
  ds_read_b128 a[160:163], v134 offset:49152
  ds_read_b128 a[164:167], v135 offset:49152
  ds_read_b128 a[168:171], v134 offset:51200
  ds_read_b128 a[172:175], v135 offset:51200
  s_waitcnt vmcnt(9)
  ds_read_b128 a[176:179], v134 offset:16384
  ds_read_b128 a[180:183], v135 offset:16384
  ds_read_b128 a[184:187], v134 offset:18432
  ds_read_b128 a[188:191], v135 offset:18432
  s_waitcnt vmcnt(5)
  ds_read_b128 a[192:195], v132 offset:32768
  ds_read_b128 a[196:199], v133 offset:32768
  ds_read_b128 a[200:203], v132 offset:34816
  ds_read_b128 a[204:207], v133 offset:34816
  s_waitcnt vmcnt(1)
  ds_read_b128 a[208:211], v132 offset:0
  ds_read_b128 a[212:215], v133 offset:0
  ds_read_b128 a[216:219], v132 offset:2048
  ds_read_b128 a[220:223], v133 offset:2048
  s_lshr_b32 s17, s3, 1
  s_xor_b32 s17, s17, s3
  s_lshl_b32 s17, s17, 13
  s_lshl_b32 s6, s42, 19
  s_add_u32 s17, s17, s6
  v_lshl_add_u32 v10, v4, 4, s17
  v_add_u32 v11, 4096, v10
  s_lshl_b32 s6, s19, 15
  s_lshl_b32 s16, s3, 13
  v_and_b32 v26, 3, v4
  v_and_b32 v27, 2, v6
  v_xor_b32 v27, v27, v26
  v_lshlrev_b32 v26, 9, v26
  v_lshl_or_b32 v26, v27, 6, v26
  v_bfe_u32 v27, v4, 2, 2
  v_lshl_or_b32 v26, v27, 4, v26
  v_and_b32 v27, 1, v6
  v_lshl_or_b32 v26, v27, 3, v26
  s_and_b32 s17, s3, 1
  s_lshl_b32 s17, s17, 14
  v_add_u32 v36, s17, v26
  v_xor_b32 v37, 64, v36
  v_add_u32 v38, 0x10000, v36
  v_add_u32 v39, 0x10000, v37
  v_lshlrev_b32 v40, 16, v58
  v_and_b32 v41, 0xffff0000, v58
  v_lshlrev_b32 v42, 16, v59
  v_and_b32 v43, 0xffff0000, v59
  v_pk_mul_f32 v[40:41], v[30:31], v[40:41] op_sel:[0,0] op_sel_hi:[0,1]
  v_pk_mul_f32 v[42:43], v[30:31], v[42:43] op_sel:[0,0] op_sel_hi:[0,1]
  v_lshlrev_b32 v44, 16, v60
  v_and_b32 v45, 0xffff0000, v60
  v_lshlrev_b32 v46, 16, v61
  v_and_b32 v47, 0xffff0000, v61
  v_pk_mul_f32 v[44:45], v[30:31], v[44:45] op_sel:[0,0] op_sel_hi:[0,1]
  v_pk_mul_f32 v[46:47], v[30:31], v[46:47] op_sel:[0,0] op_sel_hi:[0,1]
  v_lshlrev_b32 v48, 16, v62
  v_and_b32 v49, 0xffff0000, v62
  v_lshlrev_b32 v50, 16, v63
  v_and_b32 v51, 0xffff0000, v63
  v_pk_mul_f32 v[48:49], v[30:31], v[48:49] op_sel:[0,0] op_sel_hi:[0,1]
  v_pk_mul_f32 v[50:51], v[30:31], v[50:51] op_sel:[0,0] op_sel_hi:[0,1]
  v_lshlrev_b32 v52, 16, v64
  v_and_b32 v53, 0xffff0000, v64
  v_lshlrev_b32 v54, 16, v65
  v_and_b32 v55, 0xffff0000, v65
  v_pk_mul_f32 v[52:53], v[30:31], v[52:53] op_sel:[0,0] op_sel_hi:[0,1]
  v_pk_mul_f32 v[54:55], v[30:31], v[54:55] op_sel:[0,0] op_sel_hi:[0,1]
  v_lshlrev_b32 v92, 16, v66
  v_and_b32 v93, 0xffff0000, v66
  v_lshlrev_b32 v94, 16, v67
  v_and_b32 v95, 0xffff0000, v67
  v_pk_mul_f32 v[92:93], v[30:31], v[92:93] op_sel:[1,0] op_sel_hi:[1,1]
  v_pk_mul_f32 v[94:95], v[30:31], v[94:95] op_sel:[1,0] op_sel_hi:[1,1]
  v_lshlrev_b32 v96, 16, v68
  v_and_b32 v97, 0xffff0000, v68
  v_lshlrev_b32 v98, 16, v69
  v_and_b32 v99, 0xffff0000, v69
  v_pk_mul_f32 v[96:97], v[30:31], v[96:97] op_sel:[1,0] op_sel_hi:[1,1]
  v_pk_mul_f32 v[98:99], v[30:31], v[98:99] op_sel:[1,0] op_sel_hi:[1,1]
  v_lshlrev_b32 v100, 16, v70
  v_and_b32 v101, 0xffff0000, v70
  v_lshlrev_b32 v102, 16, v71
  v_and_b32 v103, 0xffff0000, v71
  v_pk_mul_f32 v[100:101], v[30:31], v[100:101] op_sel:[1,0] op_sel_hi:[1,1]
  v_pk_mul_f32 v[102:103], v[30:31], v[102:103] op_sel:[1,0] op_sel_hi:[1,1]
  v_lshlrev_b32 v104, 16, v72
  v_and_b32 v105, 0xffff0000, v72
  v_lshlrev_b32 v106, 16, v73
  v_and_b32 v107, 0xffff0000, v73
  v_pk_mul_f32 v[104:105], v[30:31], v[104:105] op_sel:[1,0] op_sel_hi:[1,1]
  v_pk_mul_f32 v[106:107], v[30:31], v[106:107] op_sel:[1,0] op_sel_hi:[1,1]
  s_waitcnt vmcnt(0)
  v_cmp_ne_u32 vcc, 1, v8
  s_nop 0
  s_cbranch_vccz gated_mix__spectral_gfnet__ssm_conv_s5__prompt_kernel_skip38
  s_mov_b32 s17, 0
gated_mix__spectral_gfnet__ssm_conv_s5__prompt_kernel_poll39:
  s_sleep 5
  buffer_load_dword v8, v2, s[48:51], s5 offen sc1
  s_waitcnt vmcnt(0)
  v_cmp_ne_u32 vcc, 1, v8
  s_nop 0
  s_cbranch_vccz gated_mix__spectral_gfnet__ssm_conv_s5__prompt_kernel_pollout40
  s_add_u32 s17, s17, 1
  s_cmp_lt_u32 s17, 1048576
  s_cbranch_scc1 gated_mix__spectral_gfnet__ssm_conv_s5__prompt_kernel_poll39
gated_mix__spectral_gfnet__ssm_conv_s5__prompt_kernel_pollout40:
gated_mix__spectral_gfnet__ssm_conv_s5__prompt_kernel_skip38:
  s_waitcnt lgkmcnt(0)
  s_barrier
  s_add_u32 m0, s16, 0
  s_nop 0
  buffer_load_dwordx4 v10, s[8:11], s6 offen offset:0 sc1 lds
  buffer_load_dwordx4 v10, s[8:11], s6 offen offset:1024 sc1 lds
  buffer_load_dwordx4 v10, s[8:11], s6 offen offset:2048 sc1 lds
  v_lshrrev_b32 v2, 1, v6
  v_lshlrev_b32 v2, 3, v2
  v_and_b32 v8, 1, v6
  v_lshl_add_u32 v2, v8, 1, v2
  v_cvt_f32_u32 v26, v2
  v_bfe_i32 v2, v5, 0, 1
  v_and_b32 v27, 0x02020202, v2
  v_xor_b32 v27, 0x03020100, v27
  v_and_b32 v2, 0x80000000, v2
  v_bfe_i32 v220, v5, 1, 1
  v_and_b32 v220, 0x80008000, v220
  v_xor_b32 v220, v220, v2
  buffer_load_dwordx4 v10, s[8:11], s6 offen offset:3072 sc1 lds
  s_and_b32 s17, s3, 1
  s_lshl_b32 s17, s17, 6
  v_add_u32 v2, s17, v5
  v_cvt_f32_u32 v2, v2
  v_mul_f32 v2, 0x3c000000, v2
  v_mul_f32 v8, v2, v26
  v_fmamk_f32 v204, v2, 0x0, v8
  v_fmamk_f32 v205, v2, 0x3f800000, v8
  v_fmamk_f32 v206, v2, 0x40800000, v8
  v_fmamk_f32 v207, v2, 0x40a00000, v8
  v_fmamk_f32 v208, v2, 0x41800000, v8
  v_fmamk_f32 v209, v2, 0x41880000, v8
  s_add_u32 m0, s16, 4096
  s_nop 0
  buffer_load_dwordx4 v11, s[8:11], s6 offen offset:0 sc1 lds
  v_fmamk_f32 v210, v2, 0x41a00000, v8
  v_fmamk_f32 v211, v2, 0x41a80000, v8
  v_cos_f32 v212, v204
  v_cos_f32 v213, v205
  v_cos_f32 v214, v206
  v_cos_f32 v215, v207
  v_cos_f32 v216, v208
  buffer_load_dwordx4 v11, s[8:11], s6 offen offset:1024 sc1 lds
  v_cos_f32 v217, v209
  v_cos_f32 v218, v210
  v_cos_f32 v219, v211
  v_sin_f32 v204, v204
  v_sin_f32 v205, v205
  v_sin_f32 v206, v206
  buffer_load_dwordx4 v11, s[8:11], s6 offen offset:2048 sc1 lds
  v_sin_f32 v207, v207
  v_sin_f32 v208, v208
  v_sin_f32 v209, v209
  v_sin_f32 v210, v210
  v_sin_f32 v211, v211
  v_cvt_pk_bf16_f32 v28, v212, -v204
  v_cvt_pk_bf16_f32 v29, v213, -v205
  buffer_load_dwordx4 v11, s[8:11], s6 offen offset:3072 sc1 lds
  s_add_u32 s6, s6, 32768
  s_and_b32 s6, s6, 0x7ffff
  v_cvt_pk_bf16_f32 v30, v214, -v206
  v_cvt_pk_bf16_f32 v31, v215, -v207
  v_cvt_pk_bf16_f32 v56, v216, -v208
  v_cvt_pk_bf16_f32 v57, v217, -v209
  v_cvt_pk_bf16_f32 v58, v218, -v210
  v_cvt_pk_bf16_f32 v59, v219, -v211
  v_perm_b32 v60, v28, v28, v27
  v_xor_b32 v60, v220, v60
  v_perm_b32 v61, v29, v29, v27
  v_xor_b32 v61, v220, v61
  v_perm_b32 v62, v30, v30, v27
  v_xor_b32 v62, v220, v62
  s_add_u32 m0, s16, 32768
  s_nop 0
  buffer_load_dwordx4 v10, s[8:11], s6 offen offset:0 sc1 lds
  v_perm_b32 v63, v31, v31, v27
  v_xor_b32 v63, v220, v63
  v_perm_b32 v64, v56, v56, v27
  v_xor_b32 v64, v220, v64
  v_perm_b32 v65, v57, v57, v27
  v_xor_b32 v65, v220, v65
  v_perm_b32 v66, v58, v58, v27
  v_xor_b32 v66, v220, v66
  v_perm_b32 v67, v59, v59, v27
  v_xor_b32 v67, v220, v67
  v_add_f32 v2, 0x3e000000, v2
  v_mul_f32 v8, v2, v26
  buffer_load_dwordx4 v10, s[8:11], s6 offen offset:1024 sc1 lds
  v_fmamk_f32 v204, v2, 0x0, v8
  v_fmamk_f32 v205, v2, 0x3f800000, v8
  v_fmamk_f32 v206, v2, 0x40800000, v8
  v_fmamk_f32 v207, v2, 0x40a00000, v8
  v_fmamk_f32 v208, v2, 0x41800000, v8
  v_fmamk_f32 v209, v2, 0x41880000, v8
  v_fmamk_f32 v210, v2, 0x41a00000, v8
  v_fmamk_f32 v211, v2, 0x41a80000, v8
  v_cos_f32 v212, v204
  v_cos_f32 v213, v205
  buffer_load_dwordx4 v10, s[8:11], s6 offen offset:2048 sc1 lds
  v_cos_f32 v214, v206
  v_cos_f32 v215, v207
  v_cos_f32 v216, v208
  v_cos_f32 v217, v209
  v_cos_f32 v218, v210
  v_cos_f32 v219, v211
  buffer_load_dwordx4 v10, s[8:11], s6 offen offset:3072 sc1 lds
  v_sin_f32 v204, v204
  v_sin_f32 v205, v205
  v_sin_f32 v206, v206
  v_sin_f32 v207, v207
  v_sin_f32 v208, v208
  v_sin_f32 v209, v209
  s_add_u32 m0, s16, 36864
  s_nop 0
  buffer_load_dwordx4 v11, s[8:11], s6 offen offset:0 sc1 lds
  v_sin_f32 v210, v210
  v_sin_f32 v211, v211
  v_cvt_pk_bf16_f32 v68, v212, -v204
  v_cvt_pk_bf16_f32 v69, v213, -v205
  v_cvt_pk_bf16_f32 v70, v214, -v206
  v_cvt_pk_bf16_f32 v71, v215, -v207
  v_cvt_pk_bf16_f32 v72, v216, -v208
  v_cvt_pk_bf16_f32 v73, v217, -v209
  v_cvt_pk_bf16_f32 v74, v218, -v210
  v_cvt_pk_bf16_f32 v75, v219, -v211
  buffer_load_dwordx4 v11, s[8:11], s6 offen offset:1024 sc1 lds
  v_perm_b32 v196, v68, v68, v27
  v_xor_b32 v196, v220, v196
  v_perm_b32 v197, v69, v69, v27
  v_xor_b32 v197, v220, v197
  v_perm_b32 v198, v70, v70, v27
  v_xor_b32 v198, v220, v198
  v_perm_b32 v199, v71, v71, v27
  v_xor_b32 v199, v220, v199
  v_perm_b32 v200, v72, v72, v27
  v_xor_b32 v200, v220, v200
  v_perm_b32 v201, v73, v73, v27
  v_xor_b32 v201, v220, v201
  buffer_load_dwordx4 v11, s[8:11], s6 offen offset:2048 sc1 lds
  v_perm_b32 v202, v74, v74, v27
  v_xor_b32 v202, v220, v202
  v_perm_b32 v203, v75, v75, v27
  v_xor_b32 v203, v220, v203
  v_lshlrev_b32 v8, 31, v5
  v_or_b32 v8, 0x3f003f00, v8
  v_cmp_eq_u32 vcc, 0, v6
  s_nop 1
  v_cndmask_b32 v28, v28, v8, vcc
  v_cndmask_b32 v68, v68, v8, vcc
  buffer_load_dwordx4 v11, s[8:11], s6 offen offset:3072 sc1 lds
  s_add_u32 s6, s6, 32768
  s_and_b32 s6, s6, 0x7ffff
  s_add_u32 m0, s16, 65536
  s_nop 0
  buffer_load_dwordx4 v10, s[8:11], s6 offen offset:0 sc1 lds
  buffer_load_dwordx4 v10, s[8:11], s6 offen offset:1024 sc1 lds
  buffer_load_dwordx4 v10, s[8:11], s6 offen offset:2048 sc1 lds
  buffer_load_dwordx4 v10, s[8:11], s6 offen offset:3072 sc1 lds
  s_add_u32 m0, s16, 69632
  s_nop 0
  buffer_load_dwordx4 v11, s[8:11], s6 offen offset:0 sc1 lds
  buffer_load_dwordx4 v11, s[8:11], s6 offen offset:1024 sc1 lds
  buffer_load_dwordx4 v11, s[8:11], s6 offen offset:2048 sc1 lds
  buffer_load_dwordx4 v11, s[8:11], s6 offen offset:3072 sc1 lds
  s_add_u32 s6, s6, 32768
  s_and_b32 s6, s6, 0x7ffff
  s_mov_b32 s44, s30
  s_mov_b32 s45, s31
  s_mov_b32 s46, 8388608
  s_mov_b32 s47, 0x20000
  s_waitcnt vmcnt(16)
  s_barrier
  ds_read_b64_tr_b16 v[124:125], v36 offset:0
  ds_read_b64_tr_b16 v[126:127], v37 offset:0
  ds_read_b64_tr_b16 v[136:137], v36 offset:2048
  ds_read_b64_tr_b16 v[138:139], v37 offset:2048
  ds_read_b64_tr_b16 v[140:141], v36 offset:4096
  ds_read_b64_tr_b16 v[142:143], v37 offset:4096
  ds_read_b64_tr_b16 v[144:145], v36 offset:6144
  ds_read_b64_tr_b16 v[146:147], v37 offset:6144
  ds_read_b64_tr_b16 v[148:149], v36 offset:8192
  ds_read_b64_tr_b16 v[150:151], v37 offset:8192
  ds_read_b64_tr_b16 v[152:153], v36 offset:10240
  ds_read_b64_tr_b16 v[154:155], v37 offset:10240
  ds_read_b64_tr_b16 v[156:157], v36 offset:12288
  ds_read_b64_tr_b16 v[158:159], v37 offset:12288
  ds_read_b64_tr_b16 v[160:161], v36 offset:14336
  ds_read_b64_tr_b16 v[162:163], v37 offset:14336
  s_waitcnt lgkmcnt(0)
  v_mfma_f32_16x16x32_bf16 v[40:43], v[124:127], a[0:3], v[40:43]
  ds_read_b64_tr_b16 v[164:165], v36 offset:256
  ds_read_b64_tr_b16 v[166:167], v37 offset:256
  buffer_store_dword v12, v9, s[24:27], s7 offen sc1
  s_add_u32 s7, s7, 262144
  v_mfma_f32_16x16x32_bf16 v[92:95], v[124:127], a[8:11], v[92:95]
  ds_read_b64_tr_b16 v[168:169], v36 offset:2304
  ds_read_b64_tr_b16 v[170:171], v37 offset:2304
  buffer_store_dword v13, v9, s[24:27], s7 offen sc1
  s_add_u32 s7, s7, 262144
  v_mfma_f32_16x16x32_bf16 v[44:47], v[136:139], a[0:3], v[44:47]
  ds_read_b64_tr_b16 v[172:173], v36 offset:4352
  ds_read_b64_tr_b16 v[174:175], v37 offset:4352
  buffer_store_dword v14, v9, s[24:27], s7 offen sc1
  s_add_u32 s7, s7, 262144
  v_mfma_f32_16x16x32_bf16 v[96:99], v[136:139], a[8:11], v[96:99]
  ds_read_b64_tr_b16 v[176:177], v36 offset:6400
  ds_read_b64_tr_b16 v[178:179], v37 offset:6400
  buffer_store_dword v15, v9, s[24:27], s7 offen sc1
  s_sub_u32 s7, s7, 770048
  v_mfma_f32_16x16x32_bf16 v[48:51], v[140:143], a[0:3], v[48:51]
  ds_read_b64_tr_b16 v[180:181], v36 offset:8448
  ds_read_b64_tr_b16 v[182:183], v37 offset:8448
  buffer_store_dword v16, v9, s[24:27], s7 offen sc1
  s_add_u32 s7, s7, 262144
  v_mfma_f32_16x16x32_bf16 v[100:103], v[140:143], a[8:11], v[100:103]
  ds_read_b64_tr_b16 v[184:185], v36 offset:10496
  ds_read_b64_tr_b16 v[186:187], v37 offset:10496
  buffer_store_dword v17, v9, s[24:27], s7 offen sc1
  s_add_u32 s7, s7, 262144
  v_mfma_f32_16x16x32_bf16 v[52:55], v[144:147], a[0:3], v[52:55]
  ds_read_b64_tr_b16 v[188:189], v36 offset:12544
  ds_read_b64_tr_b16 v[190:191], v37 offset:12544
  buffer_store_dword v18, v9, s[24:27], s7 offen sc1
  s_add_u32 s7, s7, 262144
  v_mfma_f32_16x16x32_bf16 v[104:107], v[144:147], a[8:11], v[104:107]
  ds_read_b64_tr_b16 v[192:193], v36 offset:14592
  ds_read_b64_tr_b16 v[194:195], v37 offset:14592
  buffer_store_dword v19, v9, s[24:27], s7 offen sc1
  s_sub_u32 s7, s7, 770048
  v_mfma_f32_16x16x32_bf16 v[76:79], v[148:151], a[0:3], 0
  s_add_u32 m0, s16, 98304
  s_nop 0
  buffer_load_dwordx4 v10, s[8:11], s6 offen offset:0 sc1 lds
  buffer_store_dword v20, v9, s[24:27], s7 offen sc1
  s_add_u32 s7, s7, 262144
  v_mfma_f32_16x16x32_bf16 v[108:111], v[148:151], a[8:11], 0
  buffer_store_dword v21, v9, s[24:27], s7 offen sc1
  s_add_u32 s7, s7, 262144
  v_mfma_f32_16x16x32_bf16 v[80:83], v[152:155], a[0:3], 0
  buffer_load_dwordx4 v10, s[8:11], s6 offen offset:1024 sc1 lds
  buffer_store_dword v22, v9, s[24:27], s7 offen sc1
  s_add_u32 s7, s7, 262144
  v_mfma_f32_16x16x32_bf16 v[112:115], v[152:155], a[8:11], 0
  buffer_store_dword v23, v9, s[24:27], s7 offen sc1
  s_sub_u32 s7, s7, 770048
  v_mfma_f32_16x16x32_bf16 v[84:87], v[156:159], a[0:3], 0
  buffer_load_dwordx4 v10, s[8:11], s6 offen offset:2048 sc1 lds
  buffer_store_dword v32, v9, s[24:27], s7 offen sc1
  s_add_u32 s7, s7, 262144
  v_mfma_f32_16x16x32_bf16 v[116:119], v[156:159], a[8:11], 0
  buffer_store_dword v33, v9, s[24:27], s7 offen sc1
  s_add_u32 s7, s7, 262144
  v_mfma_f32_16x16x32_bf16 v[88:91], v[160:163], a[0:3], 0
  buffer_load_dwordx4 v10, s[8:11], s6 offen offset:3072 sc1 lds
  buffer_store_dword v34, v9, s[24:27], s7 offen sc1
  s_add_u32 s7, s7, 262144
  v_mfma_f32_16x16x32_bf16 v[120:123], v[160:163], a[8:11], 0
  buffer_store_dword v35, v9, s[24:27], s7 offen sc1
  s_waitcnt vmcnt(28) lgkmcnt(0)
  s_barrier
  v_mfma_f32_16x16x32_bf16 v[40:43], v[164:167], a[4:7], v[40:43]
  ds_read_b64_tr_b16 v[124:125], v36 offset:32768
  ds_read_b64_tr_b16 v[126:127], v37 offset:32768
  v_mfma_f32_16x16x32_bf16 v[92:95], v[164:167], a[12:15], v[92:95]
  ds_read_b64_tr_b16 v[136:137], v36 offset:34816
  ds_read_b64_tr_b16 v[138:139], v37 offset:34816
  v_mfma_f32_16x16x32_bf16 v[44:47], v[168:171], a[4:7], v[44:47]
  ds_read_b64_tr_b16 v[140:141], v36 offset:36864
  ds_read_b64_tr_b16 v[142:143], v37 offset:36864
  v_mfma_f32_16x16x32_bf16 v[96:99], v[168:171], a[12:15], v[96:99]
  ds_read_b64_tr_b16 v[144:145], v36 offset:38912
  ds_read_b64_tr_b16 v[146:147], v37 offset:38912
  v_mfma_f32_16x16x32_bf16 v[48:51], v[172:175], a[4:7], v[48:51]
  ds_read_b64_tr_b16 v[148:149], v36 offset:40960
  ds_read_b64_tr_b16 v[150:151], v37 offset:40960
  v_mfma_f32_16x16x32_bf16 v[100:103], v[172:175], a[12:15], v[100:103]
  ds_read_b64_tr_b16 v[152:153], v36 offset:43008
  ds_read_b64_tr_b16 v[154:155], v37 offset:43008
  v_mfma_f32_16x16x32_bf16 v[52:55], v[176:179], a[4:7], v[52:55]
  ds_read_b64_tr_b16 v[156:157], v36 offset:45056
  ds_read_b64_tr_b16 v[158:159], v37 offset:45056
  v_mfma_f32_16x16x32_bf16 v[104:107], v[176:179], a[12:15], v[104:107]
  ds_read_b64_tr_b16 v[160:161], v36 offset:47104
  ds_read_b64_tr_b16 v[162:163], v37 offset:47104
  v_mfma_f32_16x16x32_bf16 v[76:79], v[180:183], a[4:7], v[76:79]
  s_add_u32 m0, s16, 102400
  s_nop 0
  buffer_load_dwordx4 v11, s[8:11], s6 offen offset:0 sc1 lds
  v_mfma_f32_16x16x32_bf16 v[108:111], v[180:183], a[12:15], v[108:111]
  v_mfma_f32_16x16x32_bf16 v[80:83], v[184:187], a[4:7], v[80:83]
  buffer_load_dwordx4 v11, s[8:11], s6 offen offset:1024 sc1 lds
  v_mfma_f32_16x16x32_bf16 v[112:115], v[184:187], a[12:15], v[112:115]
  v_mfma_f32_16x16x32_bf16 v[84:87], v[188:191], a[4:7], v[84:87]
  buffer_load_dwordx4 v11, s[8:11], s6 offen offset:2048 sc1 lds
  v_mfma_f32_16x16x32_bf16 v[116:119], v[188:191], a[12:15], v[116:119]
  v_mfma_f32_16x16x32_bf16 v[88:91], v[192:195], a[4:7], v[88:91]
  buffer_load_dwordx4 v11, s[8:11], s6 offen offset:3072 sc1 lds
  s_add_u32 s6, s6, 32768
  s_and_b32 s6, s6, 0x7ffff
  v_mfma_f32_16x16x32_bf16 v[120:123], v[192:195], a[12:15], v[120:123]
  s_waitcnt lgkmcnt(0)
  v_mfma_f32_16x16x32_bf16 v[40:43], v[124:127], a[16:19], v[40:43]
  ds_read_b64_tr_b16 v[164:165], v36 offset:33024
  ds_read_b64_tr_b16 v[166:167], v37 offset:33024
  v_mfma_f32_16x16x32_bf16 v[92:95], v[124:127], a[24:27], v[92:95]
  ds_read_b64_tr_b16 v[168:169], v36 offset:35072
  ds_read_b64_tr_b16 v[170:171], v37 offset:35072
  v_mfma_f32_16x16x32_bf16 v[44:47], v[136:139], a[16:19], v[44:47]
  ds_read_b64_tr_b16 v[172:173], v36 offset:37120
  ds_read_b64_tr_b16 v[174:175], v37 offset:37120
  v_mfma_f32_16x16x32_bf16 v[96:99], v[136:139], a[24:27], v[96:99]
  ds_read_b64_tr_b16 v[176:177], v36 offset:39168
  ds_read_b64_tr_b16 v[178:179], v37 offset:39168
  v_mfma_f32_16x16x32_bf16 v[48:51], v[140:143], a[16:19], v[48:51]
  ds_read_b64_tr_b16 v[180:181], v36 offset:41216
  ds_read_b64_tr_b16 v[182:183], v37 offset:41216
  v_mfma_f32_16x16x32_bf16 v[100:103], v[140:143], a[24:27], v[100:103]
  ds_read_b64_tr_b16 v[184:185], v36 offset:43264
  ds_read_b64_tr_b16 v[186:187], v37 offset:43264
  v_mfma_f32_16x16x32_bf16 v[52:55], v[144:147], a[16:19], v[52:55]
  ds_read_b64_tr_b16 v[188:189], v36 offset:45312
  ds_read_b64_tr_b16 v[190:191], v37 offset:45312
  v_mfma_f32_16x16x32_bf16 v[104:107], v[144:147], a[24:27], v[104:107]
  ds_read_b64_tr_b16 v[192:193], v36 offset:47360
  ds_read_b64_tr_b16 v[194:195], v37 offset:47360
  v_mfma_f32_16x16x32_bf16 v[76:79], v[148:151], a[16:19], v[76:79]
  s_add_u32 m0, s16, 0
  s_nop 0
  buffer_load_dwordx4 v10, s[8:11], s6 offen offset:0 sc1 lds
  s_lshl_b32 s22, s3, 13
  s_add_u32 s22, s22, 0
  v_mfma_f32_16x16x32_bf16 v[108:111], v[148:151], a[24:27], v[108:111]
  v_lshl_add_u32 v2, v4, 4, s22
  v_lshrrev_b32 v8, 5, v4
  v_mfma_f32_16x16x32_bf16 v[80:83], v[152:155], a[16:19], v[80:83]
  buffer_load_dwordx4 v10, s[8:11], s6 offen offset:1024 sc1 lds
  v_lshlrev_b32 v8, 9, v8
  v_bfe_u32 v27, v4, 3, 2
  v_mfma_f32_16x16x32_bf16 v[112:115], v[152:155], a[24:27], v[112:115]
  v_lshl_or_b32 v8, v27, 6, v8
  v_and_b32 v27, 3, v4
  v_mfma_f32_16x16x32_bf16 v[84:87], v[156:159], a[16:19], v[84:87]
  buffer_load_dwordx4 v10, s[8:11], s6 offen offset:2048 sc1 lds
  v_lshl_or_b32 v8, v27, 4, v8
  v_bfe_u32 v27, v4, 2, 1
  v_mfma_f32_16x16x32_bf16 v[116:119], v[156:159], a[24:27], v[116:119]
  v_lshl_or_b32 v8, v27, 3, v8
  s_lshr_b32 s22, s3, 1
  v_mfma_f32_16x16x32_bf16 v[88:91], v[160:163], a[16:19], v[88:91]
  buffer_load_dwordx4 v10, s[8:11], s6 offen offset:3072 sc1 lds
  s_lshl_b32 s22, s22, 13
  s_add_u32 s22, s22, 131072
  v_mfma_f32_16x16x32_bf16 v[120:123], v[160:163], a[24:27], v[120:123]
  v_add_u32 v8, s22, v8
  v_lshlrev_b32 v26, 18, v6
  s_waitcnt vmcnt(28) lgkmcnt(0)
  s_barrier
  v_mfma_f32_16x16x32_bf16 v[40:43], v[164:167], a[20:23], v[40:43]
  ds_read_b64_tr_b16 v[124:125], v38 offset:0
  ds_read_b64_tr_b16 v[126:127], v39 offset:0
  v_mfma_f32_16x16x32_bf16 v[92:95], v[164:167], a[28:31], v[92:95]
  ds_read_b64_tr_b16 v[136:137], v38 offset:2048
  ds_read_b64_tr_b16 v[138:139], v39 offset:2048
  v_mfma_f32_16x16x32_bf16 v[44:47], v[168:171], a[20:23], v[44:47]
  ds_read_b64_tr_b16 v[140:141], v38 offset:4096
  ds_read_b64_tr_b16 v[142:143], v39 offset:4096
  v_mfma_f32_16x16x32_bf16 v[96:99], v[168:171], a[28:31], v[96:99]
  ds_read_b64_tr_b16 v[144:145], v38 offset:6144
  ds_read_b64_tr_b16 v[146:147], v39 offset:6144
  v_mfma_f32_16x16x32_bf16 v[48:51], v[172:175], a[20:23], v[48:51]
  ds_read_b64_tr_b16 v[148:149], v38 offset:8192
  ds_read_b64_tr_b16 v[150:151], v39 offset:8192
  v_mfma_f32_16x16x32_bf16 v[100:103], v[172:175], a[28:31], v[100:103]
  ds_read_b64_tr_b16 v[152:153], v38 offset:10240
  ds_read_b64_tr_b16 v[154:155], v39 offset:10240
  v_mfma_f32_16x16x32_bf16 v[52:55], v[176:179], a[20:23], v[52:55]
  ds_read_b64_tr_b16 v[156:157], v38 offset:12288
  ds_read_b64_tr_b16 v[158:159], v39 offset:12288
  v_mfma_f32_16x16x32_bf16 v[104:107], v[176:179], a[28:31], v[104:107]
  ds_read_b64_tr_b16 v[160:161], v38 offset:14336
  ds_read_b64_tr_b16 v[162:163], v39 offset:14336
  v_mfma_f32_16x16x32_bf16 v[76:79], v[180:183], a[20:23], v[76:79]
  s_add_u32 m0, s16, 4096
  s_nop 0
  buffer_load_dwordx4 v11, s[8:11], s6 offen offset:0 sc1 lds
  v_lshl_or_b32 v26, v5, 2, v26
  s_and_b32 s17, s3, 1
  v_mfma_f32_16x16x32_bf16 v[108:111], v[180:183], a[28:31], v[108:111]
  s_lshl_b32 s17, s17, 22
  s_lshl_b32 s22, s42, 12
  v_mfma_f32_16x16x32_bf16 v[80:83], v[184:187], a[20:23], v[80:83]
  buffer_load_dwordx4 v11, s[8:11], s6 offen offset:1024 sc1 lds
  s_add_u32 s17, s17, s22
  s_lshl_b32 s22, s43, 6
  v_mfma_f32_16x16x32_bf16 v[112:115], v[184:187], a[28:31], v[112:115]
  s_add_u32 s17, s17, s22
  s_lshr_b32 s22, s3, 1
  v_mfma_f32_16x16x32_bf16 v[84:87], v[188:191], a[20:23], v[84:87]
  buffer_load_dwordx4 v11, s[8:11], s6 offen offset:2048 sc1 lds
  s_lshl_b32 s22, s22, 11
  s_add_u32 s17, s17, s22
  v_mfma_f32_16x16x32_bf16 v[116:119], v[188:191], a[28:31], v[116:119]
  v_mfma_f32_16x16x32_bf16 v[88:91], v[192:195], a[20:23], v[88:91]
  buffer_load_dwordx4 v11, s[8:11], s6 offen offset:3072 sc1 lds
  s_add_u32 s6, s6, 32768
  s_and_b32 s6, s6, 0x7ffff
  v_mfma_f32_16x16x32_bf16 v[120:123], v[192:195], a[28:31], v[120:123]
  s_add_u32 m0, s21, 147456
  s_nop 0
  buffer_load_dwordx4 v128, s[68:71], s20 offen offset:0 lds
  buffer_load_dwordx4 v129, s[68:71], s20 offen offset:1024 lds
  buffer_load_dwordx4 v130, s[68:71], s20 offen offset:2048 lds
  buffer_load_dwordx4 v131, s[68:71], s20 offen offset:3072 lds
  s_add_u32 s20, s20, 128
  s_and_b32 s20, s20, 0x7ff
  s_waitcnt lgkmcnt(0)
  v_mfma_f32_16x16x32_bf16 v[40:43], v[124:127], a[32:35], v[40:43]
  ds_read_b64_tr_b16 v[164:165], v38 offset:256
  ds_read_b64_tr_b16 v[166:167], v39 offset:256
  v_mfma_f32_16x16x32_bf16 v[92:95], v[124:127], a[40:43], v[92:95]
  ds_read_b64_tr_b16 v[168:169], v38 offset:2304
  ds_read_b64_tr_b16 v[170:171], v39 offset:2304
  v_mfma_f32_16x16x32_bf16 v[44:47], v[136:139], a[32:35], v[44:47]
  ds_read_b64_tr_b16 v[172:173], v38 offset:4352
  ds_read_b64_tr_b16 v[174:175], v39 offset:4352
  v_mfma_f32_16x16x32_bf16 v[96:99], v[136:139], a[40:43], v[96:99]
  ds_read_b64_tr_b16 v[176:177], v38 offset:6400
  ds_read_b64_tr_b16 v[178:179], v39 offset:6400
  v_mfma_f32_16x16x32_bf16 v[48:51], v[140:143], a[32:35], v[48:51]
  ds_read_b64_tr_b16 v[180:181], v38 offset:8448
  ds_read_b64_tr_b16 v[182:183], v39 offset:8448
  v_mfma_f32_16x16x32_bf16 v[100:103], v[140:143], a[40:43], v[100:103]
  ds_read_b64_tr_b16 v[184:185], v38 offset:10496
  ds_read_b64_tr_b16 v[186:187], v39 offset:10496
  v_mfma_f32_16x16x32_bf16 v[52:55], v[144:147], a[32:35], v[52:55]
  ds_read_b64_tr_b16 v[188:189], v38 offset:12544
  ds_read_b64_tr_b16 v[190:191], v39 offset:12544
  v_mfma_f32_16x16x32_bf16 v[104:107], v[144:147], a[40:43], v[104:107]
  ds_read_b64_tr_b16 v[192:193], v38 offset:14592
  ds_read_b64_tr_b16 v[194:195], v39 offset:14592
  v_mfma_f32_16x16x32_bf16 v[76:79], v[148:151], a[32:35], v[76:79]
  s_add_u32 m0, s16, 32768
  s_nop 0
  buffer_load_dwordx4 v10, s[8:11], s6 offen offset:0 sc1 lds
  v_mfma_f32_16x16x32_bf16 v[108:111], v[148:151], a[40:43], v[108:111]
  v_mfma_f32_16x16x32_bf16 v[80:83], v[152:155], a[32:35], v[80:83]
  buffer_load_dwordx4 v10, s[8:11], s6 offen offset:1024 sc1 lds
  v_mfma_f32_16x16x32_bf16 v[112:115], v[152:155], a[40:43], v[112:115]
  v_mfma_f32_16x16x32_bf16 v[84:87], v[156:159], a[32:35], v[84:87]
  buffer_load_dwordx4 v10, s[8:11], s6 offen offset:2048 sc1 lds
  v_mfma_f32_16x16x32_bf16 v[116:119], v[156:159], a[40:43], v[116:119]
  v_mfma_f32_16x16x32_bf16 v[88:91], v[160:163], a[32:35], v[88:91]
  buffer_load_dwordx4 v10, s[8:11], s6 offen offset:3072 sc1 lds
  v_mfma_f32_16x16x32_bf16 v[120:123], v[160:163], a[40:43], v[120:123]
  s_waitcnt vmcnt(16) lgkmcnt(0)
  s_barrier
  v_mfma_f32_16x16x32_bf16 v[40:43], v[164:167], a[36:39], v[40:43]
  ds_read_b64_tr_b16 v[124:125], v38 offset:32768
  ds_read_b64_tr_b16 v[126:127], v39 offset:32768
  v_mfma_f32_16x16x32_bf16 v[92:95], v[164:167], a[44:47], v[92:95]
  ds_read_b64_tr_b16 v[136:137], v38 offset:34816
  ds_read_b64_tr_b16 v[138:139], v39 offset:34816
  v_mfma_f32_16x16x32_bf16 v[44:47], v[168:171], a[36:39], v[44:47]
  ds_read_b64_tr_b16 v[140:141], v38 offset:36864
  ds_read_b64_tr_b16 v[142:143], v39 offset:36864
  v_mfma_f32_16x16x32_bf16 v[96:99], v[168:171], a[44:47], v[96:99]
  ds_read_b64_tr_b16 v[144:145], v38 offset:38912
  ds_read_b64_tr_b16 v[146:147], v39 offset:38912
  v_mfma_f32_16x16x32_bf16 v[48:51], v[172:175], a[36:39], v[48:51]
  ds_read_b64_tr_b16 v[148:149], v38 offset:40960
  ds_read_b64_tr_b16 v[150:151], v39 offset:40960
  v_mfma_f32_16x16x32_bf16 v[100:103], v[172:175], a[44:47], v[100:103]
  ds_read_b64_tr_b16 v[152:153], v38 offset:43008
  ds_read_b64_tr_b16 v[154:155], v39 offset:43008
  v_mfma_f32_16x16x32_bf16 v[52:55], v[176:179], a[36:39], v[52:55]
  ds_read_b64_tr_b16 v[156:157], v38 offset:45056
  ds_read_b64_tr_b16 v[158:159], v39 offset:45056
  v_mfma_f32_16x16x32_bf16 v[104:107], v[176:179], a[44:47], v[104:107]
  ds_read_b64_tr_b16 v[160:161], v38 offset:47104
  ds_read_b64_tr_b16 v[162:163], v39 offset:47104
  v_mfma_f32_16x16x32_bf16 v[76:79], v[180:183], a[36:39], v[76:79]
  s_add_u32 m0, s16, 36864
  s_nop 0
  buffer_load_dwordx4 v11, s[8:11], s6 offen offset:0 sc1 lds
  v_mfma_f32_16x16x32_bf16 v[108:111], v[180:183], a[44:47], v[108:111]
  v_mfma_f32_16x16x32_bf16 v[80:83], v[184:187], a[36:39], v[80:83]
  buffer_load_dwordx4 v11, s[8:11], s6 offen offset:1024 sc1 lds
  v_mfma_f32_16x16x32_bf16 v[112:115], v[184:187], a[44:47], v[112:115]
  v_mfma_f32_16x16x32_bf16 v[84:87], v[188:191], a[36:39], v[84:87]
  buffer_load_dwordx4 v11, s[8:11], s6 offen offset:2048 sc1 lds
  v_mfma_f32_16x16x32_bf16 v[116:119], v[188:191], a[44:47], v[116:119]
  v_mfma_f32_16x16x32_bf16 v[88:91], v[192:195], a[36:39], v[88:91]
  buffer_load_dwordx4 v11, s[8:11], s6 offen offset:3072 sc1 lds
  s_add_u32 s6, s6, 32768
  s_and_b32 s6, s6, 0x7ffff
  v_mfma_f32_16x16x32_bf16 v[120:123], v[192:195], a[44:47], v[120:123]
  s_add_u32 m0, s21, 131072
  s_nop 0
  buffer_load_dwordx4 v128, s[68:71], s20 offen offset:0 lds
  buffer_load_dwordx4 v129, s[68:71], s20 offen offset:1024 lds
  buffer_load_dwordx4 v130, s[68:71], s20 offen offset:2048 lds
  buffer_load_dwordx4 v131, s[68:71], s20 offen offset:3072 lds
  s_add_u32 s20, s20, 128
  s_and_b32 s20, s20, 0x7ff
  s_waitcnt lgkmcnt(0)
  v_mfma_f32_16x16x32_bf16 v[40:43], v[124:127], a[48:51], v[40:43]
  ds_read_b64_tr_b16 v[164:165], v38 offset:33024
  ds_read_b64_tr_b16 v[166:167], v39 offset:33024
  v_mfma_f32_16x16x32_bf16 v[92:95], v[124:127], a[56:59], v[92:95]
  ds_read_b64_tr_b16 v[168:169], v38 offset:35072
  ds_read_b64_tr_b16 v[170:171], v39 offset:35072
  v_mfma_f32_16x16x32_bf16 v[44:47], v[136:139], a[48:51], v[44:47]
  ds_read_b64_tr_b16 v[172:173], v38 offset:37120
  ds_read_b64_tr_b16 v[174:175], v39 offset:37120
  v_mfma_f32_16x16x32_bf16 v[96:99], v[136:139], a[56:59], v[96:99]
  ds_read_b64_tr_b16 v[176:177], v38 offset:39168
  ds_read_b64_tr_b16 v[178:179], v39 offset:39168
  v_mfma_f32_16x16x32_bf16 v[48:51], v[140:143], a[48:51], v[48:51]
  ds_read_b64_tr_b16 v[180:181], v38 offset:41216
  ds_read_b64_tr_b16 v[182:183], v39 offset:41216
  v_mfma_f32_16x16x32_bf16 v[100:103], v[140:143], a[56:59], v[100:103]
  ds_read_b64_tr_b16 v[184:185], v38 offset:43264
  ds_read_b64_tr_b16 v[186:187], v39 offset:43264
  v_mfma_f32_16x16x32_bf16 v[52:55], v[144:147], a[48:51], v[52:55]
  ds_read_b64_tr_b16 v[188:189], v38 offset:45312
  ds_read_b64_tr_b16 v[190:191], v39 offset:45312
  v_mfma_f32_16x16x32_bf16 v[104:107], v[144:147], a[56:59], v[104:107]
  ds_read_b64_tr_b16 v[192:193], v38 offset:47360
  ds_read_b64_tr_b16 v[194:195], v39 offset:47360
  v_mfma_f32_16x16x32_bf16 v[76:79], v[148:151], a[48:51], v[76:79]
  s_add_u32 m0, s16, 65536
  s_nop 0
  buffer_load_dwordx4 v10, s[8:11], s6 offen offset:0 sc1 lds
  v_mfma_f32_16x16x32_bf16 v[108:111], v[148:151], a[56:59], v[108:111]
  v_mfma_f32_16x16x32_bf16 v[80:83], v[152:155], a[48:51], v[80:83]
  buffer_load_dwordx4 v10, s[8:11], s6 offen offset:1024 sc1 lds
  v_mfma_f32_16x16x32_bf16 v[112:115], v[152:155], a[56:59], v[112:115]
  v_mfma_f32_16x16x32_bf16 v[84:87], v[156:159], a[48:51], v[84:87]
  buffer_load_dwordx4 v10, s[8:11], s6 offen offset:2048 sc1 lds
  v_mfma_f32_16x16x32_bf16 v[116:119], v[156:159], a[56:59], v[116:119]
  v_mfma_f32_16x16x32_bf16 v[88:91], v[160:163], a[48:51], v[88:91]
  buffer_load_dwordx4 v10, s[8:11], s6 offen offset:3072 sc1 lds
  v_mfma_f32_16x16x32_bf16 v[120:123], v[160:163], a[56:59], v[120:123]
  v_xor_b32 v134, 0x30000, v134
  v_xor_b32 v135, 0x30000, v135
  s_waitcnt vmcnt(16)
  ds_read_b128 a[224:227], v134 offset:16384
  ds_read_b128 a[228:231], v135 offset:16384
  ds_read_b128 a[232:235], v134 offset:18432
  ds_read_b128 a[236:239], v135 offset:18432
  s_waitcnt lgkmcnt(4)
  s_barrier
  v_mfma_f32_16x16x32_bf16 v[40:43], v[164:167], a[52:55], v[40:43]
  ds_read_b64_tr_b16 v[124:125], v36 offset:0
  ds_read_b64_tr_b16 v[126:127], v37 offset:0
  v_mfma_f32_16x16x32_bf16 v[92:95], v[164:167], a[60:63], v[92:95]
  ds_read_b64_tr_b16 v[136:137], v36 offset:2048
  ds_read_b64_tr_b16 v[138:139], v37 offset:2048
  v_mfma_f32_16x16x32_bf16 v[44:47], v[168:171], a[52:55], v[44:47]
  ds_read_b64_tr_b16 v[140:141], v36 offset:4096
  ds_read_b64_tr_b16 v[142:143], v37 offset:4096
  v_mfma_f32_16x16x32_bf16 v[96:99], v[168:171], a[60:63], v[96:99]
  ds_read_b64_tr_b16 v[144:145], v36 offset:6144
  ds_read_b64_tr_b16 v[146:147], v37 offset:6144
  v_mfma_f32_16x16x32_bf16 v[48:51], v[172:175], a[52:55], v[48:51]
  ds_read_b64_tr_b16 v[148:149], v36 offset:8192
  ds_read_b64_tr_b16 v[150:151], v37 offset:8192
  v_mfma_f32_16x16x32_bf16 v[100:103], v[172:175], a[60:63], v[100:103]
  ds_read_b64_tr_b16 v[152:153], v36 offset:10240
  ds_read_b64_tr_b16 v[154:155], v37 offset:10240
  v_mfma_f32_16x16x32_bf16 v[52:55], v[176:179], a[52:55], v[52:55]
  ds_read_b64_tr_b16 v[156:157], v36 offset:12288
  ds_read_b64_tr_b16 v[158:159], v37 offset:12288
  v_mfma_f32_16x16x32_bf16 v[104:107], v[176:179], a[60:63], v[104:107]
  ds_read_b64_tr_b16 v[160:161], v36 offset:14336
  ds_read_b64_tr_b16 v[162:163], v37 offset:14336
  v_mfma_f32_16x16x32_bf16 v[76:79], v[180:183], a[52:55], v[76:79]
  s_add_u32 m0, s16, 69632
  s_nop 0
  buffer_load_dwordx4 v11, s[8:11], s6 offen offset:0 sc1 lds
  v_mfma_f32_16x16x32_bf16 v[108:111], v[180:183], a[60:63], v[108:111]
  s_cmp_lg_u32 s3, 0
  s_cbranch_scc1 gated_mix__spectral_gfnet__ssm_conv_s5__prompt_kernel_skip41
  s_mov_b64 exec, 1
  buffer_store_dword v7, v24, s[48:51], s4 offen sc1
  s_mov_b64 exec, -1
gated_mix__spectral_gfnet__ssm_conv_s5__prompt_kernel_skip41:
  v_mfma_f32_16x16x32_bf16 v[80:83], v[184:187], a[52:55], v[80:83]
  buffer_load_dwordx4 v11, s[8:11], s6 offen offset:1024 sc1 lds
  v_mfma_f32_16x16x32_bf16 v[112:115], v[184:187], a[60:63], v[112:115]
  v_mfma_f32_16x16x32_bf16 v[84:87], v[188:191], a[52:55], v[84:87]
  buffer_load_dwordx4 v11, s[8:11], s6 offen offset:2048 sc1 lds
  v_mfma_f32_16x16x32_bf16 v[116:119], v[188:191], a[60:63], v[116:119]
  v_mfma_f32_16x16x32_bf16 v[88:91], v[192:195], a[52:55], v[88:91]
  buffer_load_dwordx4 v11, s[8:11], s6 offen offset:3072 sc1 lds
  s_add_u32 s6, s6, 32768
  s_and_b32 s6, s6, 0x7ffff
  v_mfma_f32_16x16x32_bf16 v[120:123], v[192:195], a[60:63], v[120:123]
  s_waitcnt lgkmcnt(0)
  v_mfma_f32_16x16x32_bf16 v[40:43], v[124:127], a[64:67], v[40:43]
  ds_read_b64_tr_b16 v[164:165], v36 offset:256
  ds_read_b64_tr_b16 v[166:167], v37 offset:256
  v_mfma_f32_16x16x32_bf16 v[92:95], v[124:127], a[72:75], v[92:95]
  ds_read_b64_tr_b16 v[168:169], v36 offset:2304
  ds_read_b64_tr_b16 v[170:171], v37 offset:2304
  v_mfma_f32_16x16x32_bf16 v[44:47], v[136:139], a[64:67], v[44:47]
  ds_read_b64_tr_b16 v[172:173], v36 offset:4352
  ds_read_b64_tr_b16 v[174:175], v37 offset:4352
  v_mfma_f32_16x16x32_bf16 v[96:99], v[136:139], a[72:75], v[96:99]
  ds_read_b64_tr_b16 v[176:177], v36 offset:6400
  ds_read_b64_tr_b16 v[178:179], v37 offset:6400
  v_mfma_f32_16x16x32_bf16 v[48:51], v[140:143], a[64:67], v[48:51]
  ds_read_b64_tr_b16 v[180:181], v36 offset:8448
  ds_read_b64_tr_b16 v[182:183], v37 offset:8448
  v_mfma_f32_16x16x32_bf16 v[100:103], v[140:143], a[72:75], v[100:103]
  ds_read_b64_tr_b16 v[184:185], v36 offset:10496
  ds_read_b64_tr_b16 v[186:187], v37 offset:10496
  v_mfma_f32_16x16x32_bf16 v[52:55], v[144:147], a[64:67], v[52:55]
  ds_read_b64_tr_b16 v[188:189], v36 offset:12544
  ds_read_b64_tr_b16 v[190:191], v37 offset:12544
  v_mfma_f32_16x16x32_bf16 v[104:107], v[144:147], a[72:75], v[104:107]
  ds_read_b64_tr_b16 v[192:193], v36 offset:14592
  ds_read_b64_tr_b16 v[194:195], v37 offset:14592
  v_mfma_f32_16x16x32_bf16 v[76:79], v[148:151], a[64:67], v[76:79]
  s_add_u32 m0, s16, 98304
  s_nop 0
  buffer_load_dwordx4 v10, s[8:11], s6 offen offset:0 sc1 lds
  v_mfma_f32_16x16x32_bf16 v[108:111], v[148:151], a[72:75], v[108:111]
  v_mfma_f32_16x16x32_bf16 v[80:83], v[152:155], a[64:67], v[80:83]
  buffer_load_dwordx4 v10, s[8:11], s6 offen offset:1024 sc1 lds
  v_mfma_f32_16x16x32_bf16 v[112:115], v[152:155], a[72:75], v[112:115]
  v_mfma_f32_16x16x32_bf16 v[84:87], v[156:159], a[64:67], v[84:87]
  buffer_load_dwordx4 v10, s[8:11], s6 offen offset:2048 sc1 lds
  v_mfma_f32_16x16x32_bf16 v[116:119], v[156:159], a[72:75], v[116:119]
  v_mfma_f32_16x16x32_bf16 v[88:91], v[160:163], a[64:67], v[88:91]
  buffer_load_dwordx4 v10, s[8:11], s6 offen offset:3072 sc1 lds
  v_mfma_f32_16x16x32_bf16 v[120:123], v[160:163], a[72:75], v[120:123]
  s_waitcnt vmcnt(12)
  ds_read_b128 a[240:243], v134 offset:0
  ds_read_b128 a[244:247], v135 offset:0
  ds_read_b128 a[248:251], v134 offset:2048
  ds_read_b128 a[252:255], v135 offset:2048
  s_waitcnt lgkmcnt(4)
  s_barrier
  v_mfma_f32_16x16x32_bf16 v[40:43], v[164:167], a[68:71], v[40:43]
  ds_read_b64_tr_b16 v[124:125], v36 offset:32768
  ds_read_b64_tr_b16 v[126:127], v37 offset:32768
  v_mfma_f32_16x16x32_bf16 v[92:95], v[164:167], a[76:79], v[92:95]
  ds_read_b64_tr_b16 v[136:137], v36 offset:34816
  ds_read_b64_tr_b16 v[138:139], v37 offset:34816
  v_mfma_f32_16x16x32_bf16 v[44:47], v[168:171], a[68:71], v[44:47]
  ds_read_b64_tr_b16 v[140:141], v36 offset:36864
  ds_read_b64_tr_b16 v[142:143], v37 offset:36864
  v_mfma_f32_16x16x32_bf16 v[96:99], v[168:171], a[76:79], v[96:99]
  ds_read_b64_tr_b16 v[144:145], v36 offset:38912
  ds_read_b64_tr_b16 v[146:147], v37 offset:38912
  v_mfma_f32_16x16x32_bf16 v[48:51], v[172:175], a[68:71], v[48:51]
  ds_read_b64_tr_b16 v[148:149], v36 offset:40960
  ds_read_b64_tr_b16 v[150:151], v37 offset:40960
  v_mfma_f32_16x16x32_bf16 v[100:103], v[172:175], a[76:79], v[100:103]
  ds_read_b64_tr_b16 v[152:153], v36 offset:43008
  ds_read_b64_tr_b16 v[154:155], v37 offset:43008
  v_mfma_f32_16x16x32_bf16 v[52:55], v[176:179], a[68:71], v[52:55]
  ds_read_b64_tr_b16 v[156:157], v36 offset:45056
  ds_read_b64_tr_b16 v[158:159], v37 offset:45056
  v_mfma_f32_16x16x32_bf16 v[104:107], v[176:179], a[76:79], v[104:107]
  ds_read_b64_tr_b16 v[160:161], v36 offset:47104
  ds_read_b64_tr_b16 v[162:163], v37 offset:47104
  v_mfma_f32_16x16x32_bf16 v[76:79], v[180:183], a[68:71], v[76:79]
  s_add_u32 m0, s16, 102400
  s_nop 0
  buffer_load_dwordx4 v11, s[8:11], s6 offen offset:0 sc1 lds
  v_mfma_f32_16x16x32_bf16 v[108:111], v[180:183], a[76:79], v[108:111]
  v_mfma_f32_16x16x32_bf16 v[80:83], v[184:187], a[68:71], v[80:83]
  buffer_load_dwordx4 v11, s[8:11], s6 offen offset:1024 sc1 lds
  v_mfma_f32_16x16x32_bf16 v[112:115], v[184:187], a[76:79], v[112:115]
  v_mfma_f32_16x16x32_bf16 v[84:87], v[188:191], a[68:71], v[84:87]
  buffer_load_dwordx4 v11, s[8:11], s6 offen offset:2048 sc1 lds
  v_mfma_f32_16x16x32_bf16 v[116:119], v[188:191], a[76:79], v[116:119]
  v_mfma_f32_16x16x32_bf16 v[88:91], v[192:195], a[68:71], v[88:91]
  buffer_load_dwordx4 v11, s[8:11], s6 offen offset:3072 sc1 lds
  s_add_u32 s6, s6, 32768
  s_and_b32 s6, s6, 0x7ffff
  v_mfma_f32_16x16x32_bf16 v[120:123], v[192:195], a[76:79], v[120:123]
  s_waitcnt lgkmcnt(0)
  v_mfma_f32_16x16x32_bf16 v[40:43], v[124:127], a[80:83], v[40:43]
  ds_read_b64_tr_b16 v[164:165], v36 offset:33024
  ds_read_b64_tr_b16 v[166:167], v37 offset:33024
  v_mfma_f32_16x16x32_bf16 v[92:95], v[124:127], a[88:91], v[92:95]
  ds_read_b64_tr_b16 v[168:169], v36 offset:35072
  ds_read_b64_tr_b16 v[170:171], v37 offset:35072
  v_mfma_f32_16x16x32_bf16 v[44:47], v[136:139], a[80:83], v[44:47]
  ds_read_b64_tr_b16 v[172:173], v36 offset:37120
  ds_read_b64_tr_b16 v[174:175], v37 offset:37120
  v_mfma_f32_16x16x32_bf16 v[96:99], v[136:139], a[88:91], v[96:99]
  ds_read_b64_tr_b16 v[176:177], v36 offset:39168
  ds_read_b64_tr_b16 v[178:179], v37 offset:39168
  v_mfma_f32_16x16x32_bf16 v[48:51], v[140:143], a[80:83], v[48:51]
  ds_read_b64_tr_b16 v[180:181], v36 offset:41216
  ds_read_b64_tr_b16 v[182:183], v37 offset:41216
  v_mfma_f32_16x16x32_bf16 v[100:103], v[140:143], a[88:91], v[100:103]
  ds_read_b64_tr_b16 v[184:185], v36 offset:43264
  ds_read_b64_tr_b16 v[186:187], v37 offset:43264
  v_mfma_f32_16x16x32_bf16 v[52:55], v[144:147], a[80:83], v[52:55]
  ds_read_b64_tr_b16 v[188:189], v36 offset:45312
  ds_read_b64_tr_b16 v[190:191], v37 offset:45312
  v_mfma_f32_16x16x32_bf16 v[104:107], v[144:147], a[88:91], v[104:107]
  ds_read_b64_tr_b16 v[192:193], v36 offset:47360
  ds_read_b64_tr_b16 v[194:195], v37 offset:47360
  v_mfma_f32_16x16x32_bf16 v[76:79], v[148:151], a[80:83], v[76:79]
  s_add_u32 m0, s16, 0
  s_nop 0
  buffer_load_dwordx4 v10, s[8:11], s6 offen offset:0 sc1 lds
  v_mfma_f32_16x16x32_bf16 v[108:111], v[148:151], a[88:91], v[108:111]
  v_mfma_f32_16x16x32_bf16 v[80:83], v[152:155], a[80:83], v[80:83]
  buffer_load_dwordx4 v10, s[8:11], s6 offen offset:1024 sc1 lds
  v_mfma_f32_16x16x32_bf16 v[112:115], v[152:155], a[88:91], v[112:115]
  v_mfma_f32_16x16x32_bf16 v[84:87], v[156:159], a[80:83], v[84:87]
  buffer_load_dwordx4 v10, s[8:11], s6 offen offset:2048 sc1 lds
  v_mfma_f32_16x16x32_bf16 v[116:119], v[156:159], a[88:91], v[116:119]
  v_mfma_f32_16x16x32_bf16 v[88:91], v[160:163], a[80:83], v[88:91]
  buffer_load_dwordx4 v10, s[8:11], s6 offen offset:3072 sc1 lds
  v_mfma_f32_16x16x32_bf16 v[120:123], v[160:163], a[88:91], v[120:123]
  s_waitcnt vmcnt(12) lgkmcnt(0)
  s_barrier
  v_mfma_f32_16x16x32_bf16 v[40:43], v[164:167], a[84:87], v[40:43]
  ds_read_b64_tr_b16 v[124:125], v38 offset:0
  ds_read_b64_tr_b16 v[126:127], v39 offset:0
  v_mfma_f32_16x16x32_bf16 v[92:95], v[164:167], a[92:95], v[92:95]
  ds_read_b64_tr_b16 v[136:137], v38 offset:2048
  ds_read_b64_tr_b16 v[138:139], v39 offset:2048
  v_mfma_f32_16x16x32_bf16 v[44:47], v[168:171], a[84:87], v[44:47]
  ds_read_b64_tr_b16 v[140:141], v38 offset:4096
  ds_read_b64_tr_b16 v[142:143], v39 offset:4096
  v_mfma_f32_16x16x32_bf16 v[96:99], v[168:171], a[92:95], v[96:99]
  ds_read_b64_tr_b16 v[144:145], v38 offset:6144
  ds_read_b64_tr_b16 v[146:147], v39 offset:6144
  v_mfma_f32_16x16x32_bf16 v[48:51], v[172:175], a[84:87], v[48:51]
  ds_read_b64_tr_b16 v[148:149], v38 offset:8192
  ds_read_b64_tr_b16 v[150:151], v39 offset:8192
  v_mfma_f32_16x16x32_bf16 v[100:103], v[172:175], a[92:95], v[100:103]
  ds_read_b64_tr_b16 v[152:153], v38 offset:10240
  ds_read_b64_tr_b16 v[154:155], v39 offset:10240
  v_mfma_f32_16x16x32_bf16 v[52:55], v[176:179], a[84:87], v[52:55]
  ds_read_b64_tr_b16 v[156:157], v38 offset:12288
  ds_read_b64_tr_b16 v[158:159], v39 offset:12288
  v_mfma_f32_16x16x32_bf16 v[104:107], v[176:179], a[92:95], v[104:107]
  ds_read_b64_tr_b16 v[160:161], v38 offset:14336
  ds_read_b64_tr_b16 v[162:163], v39 offset:14336
  v_mfma_f32_16x16x32_bf16 v[76:79], v[180:183], a[84:87], v[76:79]
  s_add_u32 m0, s16, 4096
  s_nop 0
  buffer_load_dwordx4 v11, s[8:11], s6 offen offset:0 sc1 lds
  v_mfma_f32_16x16x32_bf16 v[108:111], v[180:183], a[92:95], v[108:111]
  s_cmp_lg_u32 s3, 1
  s_cbranch_scc1 gated_mix__spectral_gfnet__ssm_conv_s5__prompt_kernel_skip43
  s_getpc_b64 s[20:21]
gated_mix__spectral_gfnet__ssm_conv_s5__prompt_kernel_pc42:
  s_lshr_b32 s7, s2, 3
  s_mul_i32 s7, s7, 384
  v_min_u32 v12, 2, v4
  v_lshl_add_u32 v12, v12, 7, s7
  v_min_u32 v12, gated_mix__spectral_gfnet__ssm_conv_s5__prompt_kernel_end-gated_mix__spectral_gfnet__ssm_conv_s5__prompt_kernel_pc42, v12
  v_mov_b32 v13, 0
  v_lshl_add_u64 v[12:13], v[12:13], 0, s[20:21]
  global_load_dword v1, v[12:13], off
gated_mix__spectral_gfnet__ssm_conv_s5__prompt_kernel_skip43:
  v_mfma_f32_16x16x32_bf16 v[80:83], v[184:187], a[84:87], v[80:83]
  buffer_load_dwordx4 v11, s[8:11], s6 offen offset:1024 sc1 lds
  v_mfma_f32_16x16x32_bf16 v[112:115], v[184:187], a[92:95], v[112:115]
  v_mfma_f32_16x16x32_bf16 v[84:87], v[188:191], a[84:87], v[84:87]
  buffer_load_dwordx4 v11, s[8:11], s6 offen offset:2048 sc1 lds
  v_mfma_f32_16x16x32_bf16 v[116:119], v[188:191], a[92:95], v[116:119]
  v_mfma_f32_16x16x32_bf16 v[88:91], v[192:195], a[84:87], v[88:91]
  buffer_load_dwordx4 v11, s[8:11], s6 offen offset:3072 sc1 lds
  s_add_u32 s6, s6, 32768
  s_and_b32 s6, s6, 0x7ffff
  v_mfma_f32_16x16x32_bf16 v[120:123], v[192:195], a[92:95], v[120:123]
  s_waitcnt lgkmcnt(0)
  v_mfma_f32_16x16x32_bf16 v[40:43], v[124:127], a[96:99], v[40:43]
  ds_read_b64_tr_b16 v[164:165], v38 offset:256
  ds_read_b64_tr_b16 v[166:167], v39 offset:256
  v_mfma_f32_16x16x32_bf16 v[92:95], v[124:127], a[104:107], v[92:95]
  ds_read_b64_tr_b16 v[168:169], v38 offset:2304
  ds_read_b64_tr_b16 v[170:171], v39 offset:2304
  v_mfma_f32_16x16x32_bf16 v[44:47], v[136:139], a[96:99], v[44:47]
  ds_read_b64_tr_b16 v[172:173], v38 offset:4352
  ds_read_b64_tr_b16 v[174:175], v39 offset:4352
  v_mfma_f32_16x16x32_bf16 v[96:99], v[136:139], a[104:107], v[96:99]
  ds_read_b64_tr_b16 v[176:177], v38 offset:6400
  ds_read_b64_tr_b16 v[178:179], v39 offset:6400
  v_mfma_f32_16x16x32_bf16 v[48:51], v[140:143], a[96:99], v[48:51]
  ds_read_b64_tr_b16 v[180:181], v38 offset:8448
  ds_read_b64_tr_b16 v[182:183], v39 offset:8448
  v_mfma_f32_16x16x32_bf16 v[100:103], v[140:143], a[104:107], v[100:103]
  ds_read_b64_tr_b16 v[184:185], v38 offset:10496
  ds_read_b64_tr_b16 v[186:187], v39 offset:10496
  v_mfma_f32_16x16x32_bf16 v[52:55], v[144:147], a[96:99], v[52:55]
  ds_read_b64_tr_b16 v[188:189], v38 offset:12544
  ds_read_b64_tr_b16 v[190:191], v39 offset:12544
  v_mfma_f32_16x16x32_bf16 v[104:107], v[144:147], a[104:107], v[104:107]
  ds_read_b64_tr_b16 v[192:193], v38 offset:14592
  ds_read_b64_tr_b16 v[194:195], v39 offset:14592
  v_mfma_f32_16x16x32_bf16 v[76:79], v[148:151], a[96:99], v[76:79]
  s_add_u32 m0, s16, 32768
  s_nop 0
  buffer_load_dwordx4 v10, s[8:11], s6 offen offset:0 sc1 lds
  v_mfma_f32_16x16x32_bf16 v[108:111], v[148:151], a[104:107], v[108:111]
  v_mfma_f32_16x16x32_bf16 v[80:83], v[152:155], a[96:99], v[80:83]
  buffer_load_dwordx4 v10, s[8:11], s6 offen offset:1024 sc1 lds
  v_mfma_f32_16x16x32_bf16 v[112:115], v[152:155], a[104:107], v[112:115]
  v_mfma_f32_16x16x32_bf16 v[84:87], v[156:159], a[96:99], v[84:87]
  buffer_load_dwordx4 v10, s[8:11], s6 offen offset:2048 sc1 lds
  v_mfma_f32_16x16x32_bf16 v[116:119], v[156:159], a[104:107], v[116:119]
  v_mfma_f32_16x16x32_bf16 v[88:91], v[160:163], a[96:99], v[88:91]
  buffer_load_dwordx4 v10, s[8:11], s6 offen offset:3072 sc1 lds
  v_mfma_f32_16x16x32_bf16 v[120:123], v[160:163], a[104:107], v[120:123]
  s_waitcnt vmcnt(12) lgkmcnt(0)
  s_barrier
  v_mfma_f32_16x16x32_bf16 v[40:43], v[164:167], a[100:103], v[40:43]
  ds_read_b64_tr_b16 v[124:125], v38 offset:32768
  ds_read_b64_tr_b16 v[126:127], v39 offset:32768
  v_mfma_f32_16x16x32_bf16 v[92:95], v[164:167], a[108:111], v[92:95]
  ds_read_b64_tr_b16 v[136:137], v38 offset:34816
  ds_read_b64_tr_b16 v[138:139], v39 offset:34816
  v_mfma_f32_16x16x32_bf16 v[44:47], v[168:171], a[100:103], v[44:47]
  ds_read_b64_tr_b16 v[140:141], v38 offset:36864
  ds_read_b64_tr_b16 v[142:143], v39 offset:36864
  v_mfma_f32_16x16x32_bf16 v[96:99], v[168:171], a[108:111], v[96:99]
  ds_read_b64_tr_b16 v[144:145], v38 offset:38912
  ds_read_b64_tr_b16 v[146:147], v39 offset:38912
  v_mfma_f32_16x16x32_bf16 v[48:51], v[172:175], a[100:103], v[48:51]
  ds_read_b64_tr_b16 v[148:149], v38 offset:40960
  ds_read_b64_tr_b16 v[150:151], v39 offset:40960
  v_mfma_f32_16x16x32_bf16 v[100:103], v[172:175], a[108:111], v[100:103]
  ds_read_b64_tr_b16 v[152:153], v38 offset:43008
  ds_read_b64_tr_b16 v[154:155], v39 offset:43008
  v_mfma_f32_16x16x32_bf16 v[52:55], v[176:179], a[100:103], v[52:55]
  ds_read_b64_tr_b16 v[156:157], v38 offset:45056
  ds_read_b64_tr_b16 v[158:159], v39 offset:45056
  v_mfma_f32_16x16x32_bf16 v[104:107], v[176:179], a[108:111], v[104:107]
  ds_read_b64_tr_b16 v[160:161], v38 offset:47104
  ds_read_b64_tr_b16 v[162:163], v39 offset:47104
  v_mfma_f32_16x16x32_bf16 v[76:79], v[180:183], a[100:103], v[76:79]
  s_add_u32 m0, s16, 36864
  s_nop 0
  buffer_load_dwordx4 v11, s[8:11], s6 offen offset:0 sc1 lds
  v_mfma_f32_16x16x32_bf16 v[108:111], v[180:183], a[108:111], v[108:111]
  v_mfma_f32_16x16x32_bf16 v[80:83], v[184:187], a[100:103], v[80:83]
  buffer_load_dwordx4 v11, s[8:11], s6 offen offset:1024 sc1 lds
  v_mfma_f32_16x16x32_bf16 v[112:115], v[184:187], a[108:111], v[112:115]
  v_mfma_f32_16x16x32_bf16 v[84:87], v[188:191], a[100:103], v[84:87]
  buffer_load_dwordx4 v11, s[8:11], s6 offen offset:2048 sc1 lds
  v_mfma_f32_16x16x32_bf16 v[116:119], v[188:191], a[108:111], v[116:119]
  v_mfma_f32_16x16x32_bf16 v[88:91], v[192:195], a[100:103], v[88:91]
  buffer_load_dwordx4 v11, s[8:11], s6 offen offset:3072 sc1 lds
  s_add_u32 s6, s6, 32768
  s_and_b32 s6, s6, 0x7ffff
  v_mfma_f32_16x16x32_bf16 v[120:123], v[192:195], a[108:111], v[120:123]
  s_waitcnt lgkmcnt(0)
  v_mfma_f32_16x16x32_bf16 v[40:43], v[124:127], a[112:115], v[40:43]
  ds_read_b64_tr_b16 v[164:165], v38 offset:33024
  ds_read_b64_tr_b16 v[166:167], v39 offset:33024
  v_mfma_f32_16x16x32_bf16 v[92:95], v[124:127], a[120:123], v[92:95]
  ds_read_b64_tr_b16 v[168:169], v38 offset:35072
  ds_read_b64_tr_b16 v[170:171], v39 offset:35072
  v_mfma_f32_16x16x32_bf16 v[44:47], v[136:139], a[112:115], v[44:47]
  ds_read_b64_tr_b16 v[172:173], v38 offset:37120
  ds_read_b64_tr_b16 v[174:175], v39 offset:37120
  v_mfma_f32_16x16x32_bf16 v[96:99], v[136:139], a[120:123], v[96:99]
  ds_read_b64_tr_b16 v[176:177], v38 offset:39168
  ds_read_b64_tr_b16 v[178:179], v39 offset:39168
  v_mfma_f32_16x16x32_bf16 v[48:51], v[140:143], a[112:115], v[48:51]
  ds_read_b64_tr_b16 v[180:181], v38 offset:41216
  ds_read_b64_tr_b16 v[182:183], v39 offset:41216
  v_mfma_f32_16x16x32_bf16 v[100:103], v[140:143], a[120:123], v[100:103]
  ds_read_b64_tr_b16 v[184:185], v38 offset:43264
  ds_read_b64_tr_b16 v[186:187], v39 offset:43264
  v_mfma_f32_16x16x32_bf16 v[52:55], v[144:147], a[112:115], v[52:55]
  ds_read_b64_tr_b16 v[188:189], v38 offset:45312
  ds_read_b64_tr_b16 v[190:191], v39 offset:45312
  v_mfma_f32_16x16x32_bf16 v[104:107], v[144:147], a[120:123], v[104:107]
  ds_read_b64_tr_b16 v[192:193], v38 offset:47360
  ds_read_b64_tr_b16 v[194:195], v39 offset:47360
  v_mfma_f32_16x16x32_bf16 v[76:79], v[148:151], a[112:115], v[76:79]
  s_add_u32 m0, s16, 65536
  s_nop 0
  buffer_load_dwordx4 v10, s[8:11], s6 offen offset:0 sc1 lds
  v_mfma_f32_16x16x32_bf16 v[108:111], v[148:151], a[120:123], v[108:111]
  v_mfma_f32_16x16x32_bf16 v[80:83], v[152:155], a[112:115], v[80:83]
  buffer_load_dwordx4 v10, s[8:11], s6 offen offset:1024 sc1 lds
  v_mfma_f32_16x16x32_bf16 v[112:115], v[152:155], a[120:123], v[112:115]
  v_mfma_f32_16x16x32_bf16 v[84:87], v[156:159], a[112:115], v[84:87]
  buffer_load_dwordx4 v10, s[8:11], s6 offen offset:2048 sc1 lds
  v_mfma_f32_16x16x32_bf16 v[116:119], v[156:159], a[120:123], v[116:119]
  v_mfma_f32_16x16x32_bf16 v[88:91], v[160:163], a[112:115], v[88:91]
  buffer_load_dwordx4 v10, s[8:11], s6 offen offset:3072 sc1 lds
  v_mfma_f32_16x16x32_bf16 v[120:123], v[160:163], a[120:123], v[120:123]
  s_waitcnt vmcnt(12) lgkmcnt(0)
  s_barrier
  v_mfma_f32_16x16x32_bf16 v[40:43], v[164:167], a[116:119], v[40:43]
  ds_read_b64_tr_b16 v[124:125], v36 offset:0
  ds_read_b64_tr_b16 v[126:127], v37 offset:0
  v_mfma_f32_16x16x32_bf16 v[92:95], v[164:167], a[124:127], v[92:95]
  ds_read_b64_tr_b16 v[136:137], v36 offset:2048
  ds_read_b64_tr_b16 v[138:139], v37 offset:2048
  v_mfma_f32_16x16x32_bf16 v[44:47], v[168:171], a[116:119], v[44:47]
  ds_read_b64_tr_b16 v[140:141], v36 offset:4096
  ds_read_b64_tr_b16 v[142:143], v37 offset:4096
  v_mfma_f32_16x16x32_bf16 v[96:99], v[168:171], a[124:127], v[96:99]
  ds_read_b64_tr_b16 v[144:145], v36 offset:6144
  ds_read_b64_tr_b16 v[146:147], v37 offset:6144
  v_mfma_f32_16x16x32_bf16 v[48:51], v[172:175], a[116:119], v[48:51]
  ds_read_b64_tr_b16 v[148:149], v36 offset:8192
  ds_read_b64_tr_b16 v[150:151], v37 offset:8192
  v_mfma_f32_16x16x32_bf16 v[100:103], v[172:175], a[124:127], v[100:103]
  ds_read_b64_tr_b16 v[152:153], v36 offset:10240
  ds_read_b64_tr_b16 v[154:155], v37 offset:10240
  v_mfma_f32_16x16x32_bf16 v[52:55], v[176:179], a[116:119], v[52:55]
  ds_read_b64_tr_b16 v[156:157], v36 offset:12288
  ds_read_b64_tr_b16 v[158:159], v37 offset:12288
  v_mfma_f32_16x16x32_bf16 v[104:107], v[176:179], a[124:127], v[104:107]
  ds_read_b64_tr_b16 v[160:161], v36 offset:14336
  ds_read_b64_tr_b16 v[162:163], v37 offset:14336
  v_mfma_f32_16x16x32_bf16 v[76:79], v[180:183], a[116:119], v[76:79]
  s_add_u32 m0, s16, 69632
  s_nop 0
  buffer_load_dwordx4 v11, s[8:11], s6 offen offset:0 sc1 lds
  v_mfma_f32_16x16x32_bf16 v[108:111], v[180:183], a[124:127], v[108:111]
  v_mfma_f32_16x16x32_bf16 v[80:83], v[184:187], a[116:119], v[80:83]
  buffer_load_dwordx4 v11, s[8:11], s6 offen offset:1024 sc1 lds
  v_mfma_f32_16x16x32_bf16 v[112:115], v[184:187], a[124:127], v[112:115]
  v_mfma_f32_16x16x32_bf16 v[84:87], v[188:191], a[116:119], v[84:87]
  buffer_load_dwordx4 v11, s[8:11], s6 offen offset:2048 sc1 lds
  v_mfma_f32_16x16x32_bf16 v[116:119], v[188:191], a[124:127], v[116:119]
  v_mfma_f32_16x16x32_bf16 v[88:91], v[192:195], a[116:119], v[88:91]
  buffer_load_dwordx4 v11, s[8:11], s6 offen offset:3072 sc1 lds
  s_add_u32 s6, s6, 32768
  s_and_b32 s6, s6, 0x7ffff
  v_mfma_f32_16x16x32_bf16 v[120:123], v[192:195], a[124:127], v[120:123]
  s_waitcnt lgkmcnt(0)
  v_mfma_f32_16x16x32_bf16 v[40:43], v[124:127], a[128:131], v[40:43]
  ds_read_b64_tr_b16 v[164:165], v36 offset:256
  ds_read_b64_tr_b16 v[166:167], v37 offset:256
  v_mfma_f32_16x16x32_bf16 v[92:95], v[124:127], a[136:139], v[92:95]
  ds_read_b64_tr_b16 v[168:169], v36 offset:2304
  ds_read_b64_tr_b16 v[170:171], v37 offset:2304
  v_mfma_f32_16x16x32_bf16 v[44:47], v[136:139], a[128:131], v[44:47]
  ds_read_b64_tr_b16 v[172:173], v36 offset:4352
  ds_read_b64_tr_b16 v[174:175], v37 offset:4352
  v_mfma_f32_16x16x32_bf16 v[96:99], v[136:139], a[136:139], v[96:99]
  ds_read_b64_tr_b16 v[176:177], v36 offset:6400
  ds_read_b64_tr_b16 v[178:179], v37 offset:6400
  v_mfma_f32_16x16x32_bf16 v[48:51], v[140:143], a[128:131], v[48:51]
  ds_read_b64_tr_b16 v[180:181], v36 offset:8448
  ds_read_b64_tr_b16 v[182:183], v37 offset:8448
  v_mfma_f32_16x16x32_bf16 v[100:103], v[140:143], a[136:139], v[100:103]
  ds_read_b64_tr_b16 v[184:185], v36 offset:10496
  ds_read_b64_tr_b16 v[186:187], v37 offset:10496
  v_mfma_f32_16x16x32_bf16 v[52:55], v[144:147], a[128:131], v[52:55]
  ds_read_b64_tr_b16 v[188:189], v36 offset:12544
  ds_read_b64_tr_b16 v[190:191], v37 offset:12544
  v_mfma_f32_16x16x32_bf16 v[104:107], v[144:147], a[136:139], v[104:107]
  ds_read_b64_tr_b16 v[192:193], v36 offset:14592
  ds_read_b64_tr_b16 v[194:195], v37 offset:14592
  v_mfma_f32_16x16x32_bf16 v[76:79], v[148:151], a[128:131], v[76:79]
  s_add_u32 m0, s16, 98304
  s_nop 0
  buffer_load_dwordx4 v10, s[8:11], s6 offen offset:0 sc1 lds
  v_mfma_f32_16x16x32_bf16 v[108:111], v[148:151], a[136:139], v[108:111]
  v_mfma_f32_16x16x32_bf16 v[80:83], v[152:155], a[128:131], v[80:83]
  buffer_load_dwordx4 v10, s[8:11], s6 offen offset:1024 sc1 lds
  v_mfma_f32_16x16x32_bf16 v[112:115], v[152:155], a[136:139], v[112:115]
  v_mfma_f32_16x16x32_bf16 v[84:87], v[156:159], a[128:131], v[84:87]
  buffer_load_dwordx4 v10, s[8:11], s6 offen offset:2048 sc1 lds
  v_mfma_f32_16x16x32_bf16 v[116:119], v[156:159], a[136:139], v[116:119]
  v_mfma_f32_16x16x32_bf16 v[88:91], v[160:163], a[128:131], v[88:91]
  buffer_load_dwordx4 v10, s[8:11], s6 offen offset:3072 sc1 lds
  v_mfma_f32_16x16x32_bf16 v[120:123], v[160:163], a[136:139], v[120:123]
  s_waitcnt vmcnt(12) lgkmcnt(0)
  s_barrier
  v_mfma_f32_16x16x32_bf16 v[40:43], v[164:167], a[132:135], v[40:43]
  ds_read_b64_tr_b16 v[124:125], v36 offset:32768
  ds_read_b64_tr_b16 v[126:127], v37 offset:32768
  v_mfma_f32_16x16x32_bf16 v[92:95], v[164:167], a[140:143], v[92:95]
  ds_read_b64_tr_b16 v[136:137], v36 offset:34816
  ds_read_b64_tr_b16 v[138:139], v37 offset:34816
  v_mfma_f32_16x16x32_bf16 v[44:47], v[168:171], a[132:135], v[44:47]
  ds_read_b64_tr_b16 v[140:141], v36 offset:36864
  ds_read_b64_tr_b16 v[142:143], v37 offset:36864
  v_mfma_f32_16x16x32_bf16 v[96:99], v[168:171], a[140:143], v[96:99]
  ds_read_b64_tr_b16 v[144:145], v36 offset:38912
  ds_read_b64_tr_b16 v[146:147], v37 offset:38912
  v_mfma_f32_16x16x32_bf16 v[48:51], v[172:175], a[132:135], v[48:51]
  ds_read_b64_tr_b16 v[148:149], v36 offset:40960
  ds_read_b64_tr_b16 v[150:151], v37 offset:40960
  v_mfma_f32_16x16x32_bf16 v[100:103], v[172:175], a[140:143], v[100:103]
  ds_read_b64_tr_b16 v[152:153], v36 offset:43008
  ds_read_b64_tr_b16 v[154:155], v37 offset:43008
  v_mfma_f32_16x16x32_bf16 v[52:55], v[176:179], a[132:135], v[52:55]
  ds_read_b64_tr_b16 v[156:157], v36 offset:45056
  ds_read_b64_tr_b16 v[158:159], v37 offset:45056
  v_mfma_f32_16x16x32_bf16 v[104:107], v[176:179], a[140:143], v[104:107]
  ds_read_b64_tr_b16 v[160:161], v36 offset:47104
  ds_read_b64_tr_b16 v[162:163], v37 offset:47104
  v_mfma_f32_16x16x32_bf16 v[76:79], v[180:183], a[132:135], v[76:79]
  s_add_u32 m0, s16, 102400
  s_nop 0
  buffer_load_dwordx4 v11, s[8:11], s6 offen offset:0 sc1 lds
  v_mfma_f32_16x16x32_bf16 v[108:111], v[180:183], a[140:143], v[108:111]
  buffer_load_dword v204, v3, s[48:51], s4 offen sc1
  v_mfma_f32_16x16x32_bf16 v[80:83], v[184:187], a[132:135], v[80:83]
  buffer_load_dwordx4 v11, s[8:11], s6 offen offset:1024 sc1 lds
  v_mfma_f32_16x16x32_bf16 v[112:115], v[184:187], a[140:143], v[112:115]
  v_mfma_f32_16x16x32_bf16 v[84:87], v[188:191], a[132:135], v[84:87]
  buffer_load_dwordx4 v11, s[8:11], s6 offen offset:2048 sc1 lds
  v_mfma_f32_16x16x32_bf16 v[116:119], v[188:191], a[140:143], v[116:119]
  v_mfma_f32_16x16x32_bf16 v[88:91], v[192:195], a[132:135], v[88:91]
  buffer_load_dwordx4 v11, s[8:11], s6 offen offset:3072 sc1 lds
  s_add_u32 s6, s6, 32768
  s_and_b32 s6, s6, 0x7ffff
  v_mfma_f32_16x16x32_bf16 v[120:123], v[192:195], a[140:143], v[120:123]
  s_waitcnt lgkmcnt(0)
  v_mfma_f32_16x16x32_bf16 v[40:43], v[124:127], a[144:147], v[40:43]
  ds_read_b64_tr_b16 v[164:165], v36 offset:33024
  ds_read_b64_tr_b16 v[166:167], v37 offset:33024
  v_mfma_f32_16x16x32_bf16 v[92:95], v[124:127], a[152:155], v[92:95]
  ds_read_b64_tr_b16 v[168:169], v36 offset:35072
  ds_read_b64_tr_b16 v[170:171], v37 offset:35072
  v_mfma_f32_16x16x32_bf16 v[44:47], v[136:139], a[144:147], v[44:47]
  ds_read_b64_tr_b16 v[172:173], v36 offset:37120
  ds_read_b64_tr_b16 v[174:175], v37 offset:37120
  v_mfma_f32_16x16x32_bf16 v[96:99], v[136:139], a[152:155], v[96:99]
  ds_read_b64_tr_b16 v[176:177], v36 offset:39168
  ds_read_b64_tr_b16 v[178:179], v37 offset:39168
  v_mfma_f32_16x16x32_bf16 v[48:51], v[140:143], a[144:147], v[48:51]
  ds_read_b64_tr_b16 v[180:181], v36 offset:41216
  ds_read_b64_tr_b16 v[182:183], v37 offset:41216
  v_mfma_f32_16x16x32_bf16 v[100:103], v[140:143], a[152:155], v[100:103]
  ds_read_b64_tr_b16 v[184:185], v36 offset:43264
  ds_read_b64_tr_b16 v[186:187], v37 offset:43264
  v_mfma_f32_16x16x32_bf16 v[52:55], v[144:147], a[144:147], v[52:55]
  ds_read_b64_tr_b16 v[188:189], v36 offset:45312
  ds_read_b64_tr_b16 v[190:191], v37 offset:45312
  v_mfma_f32_16x16x32_bf16 v[104:107], v[144:147], a[152:155], v[104:107]
  ds_read_b64_tr_b16 v[192:193], v36 offset:47360
  ds_read_b64_tr_b16 v[194:195], v37 offset:47360
  v_mfma_f32_16x16x32_bf16 v[76:79], v[148:151], a[144:147], v[76:79]
  s_add_u32 m0, s16, 0
  s_nop 0
  buffer_load_dwordx4 v10, s[8:11], s6 offen offset:0 sc1 lds
  v_mfma_f32_16x16x32_bf16 v[108:111], v[148:151], a[152:155], v[108:111]
  v_mfma_f32_16x16x32_bf16 v[80:83], v[152:155], a[144:147], v[80:83]
  buffer_load_dwordx4 v10, s[8:11], s6 offen offset:1024 sc1 lds
  v_mfma_f32_16x16x32_bf16 v[112:115], v[152:155], a[152:155], v[112:115]
  v_mfma_f32_16x16x32_bf16 v[84:87], v[156:159], a[144:147], v[84:87]
  buffer_load_dwordx4 v10, s[8:11], s6 offen offset:2048 sc1 lds
  v_mfma_f32_16x16x32_bf16 v[116:119], v[156:159], a[152:155], v[116:119]
  v_mfma_f32_16x16x32_bf16 v[88:91], v[160:163], a[144:147], v[88:91]
  buffer_load_dwordx4 v10, s[8:11], s6 offen offset:3072 sc1 lds
  v_mfma_f32_16x16x32_bf16 v[120:123], v[160:163], a[152:155], v[120:123]
  s_waitcnt vmcnt(13) lgkmcnt(0)
  s_barrier
  v_mfma_f32_16x16x32_bf16 v[40:43], v[164:167], a[148:151], v[40:43]
  ds_read_b64_tr_b16 v[124:125], v38 offset:0
  ds_read_b64_tr_b16 v[126:127], v39 offset:0
  v_mfma_f32_16x16x32_bf16 v[92:95], v[164:167], a[156:159], v[92:95]
  ds_read_b64_tr_b16 v[136:137], v38 offset:2048
  ds_read_b64_tr_b16 v[138:139], v39 offset:2048
  v_mfma_f32_16x16x32_bf16 v[44:47], v[168:171], a[148:151], v[44:47]
  ds_read_b64_tr_b16 v[140:141], v38 offset:4096
  ds_read_b64_tr_b16 v[142:143], v39 offset:4096
  v_mfma_f32_16x16x32_bf16 v[96:99], v[168:171], a[156:159], v[96:99]
  ds_read_b64_tr_b16 v[144:145], v38 offset:6144
  ds_read_b64_tr_b16 v[146:147], v39 offset:6144
  v_mfma_f32_16x16x32_bf16 v[48:51], v[172:175], a[148:151], v[48:51]
  ds_read_b64_tr_b16 v[148:149], v38 offset:8192
  ds_read_b64_tr_b16 v[150:151], v39 offset:8192
  v_mfma_f32_16x16x32_bf16 v[100:103], v[172:175], a[156:159], v[100:103]
  ds_read_b64_tr_b16 v[152:153], v38 offset:10240
  ds_read_b64_tr_b16 v[154:155], v39 offset:10240
  v_mfma_f32_16x16x32_bf16 v[52:55], v[176:179], a[148:151], v[52:55]
  ds_read_b64_tr_b16 v[156:157], v38 offset:12288
  ds_read_b64_tr_b16 v[158:159], v39 offset:12288
  v_mfma_f32_16x16x32_bf16 v[104:107], v[176:179], a[156:159], v[104:107]
  ds_read_b64_tr_b16 v[160:161], v38 offset:14336
  ds_read_b64_tr_b16 v[162:163], v39 offset:14336
  v_mfma_f32_16x16x32_bf16 v[76:79], v[180:183], a[148:151], v[76:79]
  s_add_u32 m0, s16, 4096
  s_nop 0
  buffer_load_dwordx4 v11, s[8:11], s6 offen offset:0 sc1 lds
  v_mfma_f32_16x16x32_bf16 v[108:111], v[180:183], a[156:159], v[108:111]
  v_mfma_f32_16x16x32_bf16 v[80:83], v[184:187], a[148:151], v[80:83]
  buffer_load_dwordx4 v11, s[8:11], s6 offen offset:1024 sc1 lds
  v_mfma_f32_16x16x32_bf16 v[112:115], v[184:187], a[156:159], v[112:115]
  v_mfma_f32_16x16x32_bf16 v[84:87], v[188:191], a[148:151], v[84:87]
  buffer_load_dwordx4 v11, s[8:11], s6 offen offset:2048 sc1 lds
  v_mfma_f32_16x16x32_bf16 v[116:119], v[188:191], a[156:159], v[116:119]
  v_mfma_f32_16x16x32_bf16 v[88:91], v[192:195], a[148:151], v[88:91]
  buffer_load_dwordx4 v11, s[8:11], s6 offen offset:3072 sc1 lds
  s_add_u32 s6, s6, 32768
  s_and_b32 s6, s6, 0x7ffff
  v_mfma_f32_16x16x32_bf16 v[120:123], v[192:195], a[156:159], v[120:123]
  s_waitcnt lgkmcnt(0)
  v_mfma_f32_16x16x32_bf16 v[40:43], v[124:127], a[160:163], v[40:43]
  ds_read_b64_tr_b16 v[164:165], v38 offset:256
  ds_read_b64_tr_b16 v[166:167], v39 offset:256
  v_mfma_f32_16x16x32_bf16 v[92:95], v[124:127], a[168:171], v[92:95]
  ds_read_b64_tr_b16 v[168:169], v38 offset:2304
  ds_read_b64_tr_b16 v[170:171], v39 offset:2304
  v_mfma_f32_16x16x32_bf16 v[44:47], v[136:139], a[160:163], v[44:47]
  ds_read_b64_tr_b16 v[172:173], v38 offset:4352
  ds_read_b64_tr_b16 v[174:175], v39 offset:4352
  v_mfma_f32_16x16x32_bf16 v[96:99], v[136:139], a[168:171], v[96:99]
  ds_read_b64_tr_b16 v[176:177], v38 offset:6400
  ds_read_b64_tr_b16 v[178:179], v39 offset:6400
  v_mfma_f32_16x16x32_bf16 v[48:51], v[140:143], a[160:163], v[48:51]
  ds_read_b64_tr_b16 v[180:181], v38 offset:8448
  ds_read_b64_tr_b16 v[182:183], v39 offset:8448
  v_mfma_f32_16x16x32_bf16 v[100:103], v[140:143], a[168:171], v[100:103]
  ds_read_b64_tr_b16 v[184:185], v38 offset:10496
  ds_read_b64_tr_b16 v[186:187], v39 offset:10496
  v_mfma_f32_16x16x32_bf16 v[52:55], v[144:147], a[160:163], v[52:55]
  ds_read_b64_tr_b16 v[188:189], v38 offset:12544
  ds_read_b64_tr_b16 v[190:191], v39 offset:12544
  v_mfma_f32_16x16x32_bf16 v[104:107], v[144:147], a[168:171], v[104:107]
  ds_read_b64_tr_b16 v[192:193], v38 offset:14592
  ds_read_b64_tr_b16 v[194:195], v39 offset:14592
  v_mfma_f32_16x16x32_bf16 v[76:79], v[148:151], a[160:163], v[76:79]
  s_add_u32 m0, s16, 32768
  s_nop 0
  buffer_load_dwordx4 v10, s[8:11], s6 offen offset:0 sc1 lds
  v_mfma_f32_16x16x32_bf16 v[108:111], v[148:151], a[168:171], v[108:111]
  v_mfma_f32_16x16x32_bf16 v[80:83], v[152:155], a[160:163], v[80:83]
  buffer_load_dwordx4 v10, s[8:11], s6 offen offset:1024 sc1 lds
  v_mfma_f32_16x16x32_bf16 v[112:115], v[152:155], a[168:171], v[112:115]
  v_mfma_f32_16x16x32_bf16 v[84:87], v[156:159], a[160:163], v[84:87]
  buffer_load_dwordx4 v10, s[8:11], s6 offen offset:2048 sc1 lds
  v_mfma_f32_16x16x32_bf16 v[116:119], v[156:159], a[168:171], v[116:119]
  v_mfma_f32_16x16x32_bf16 v[88:91], v[160:163], a[160:163], v[88:91]
  buffer_load_dwordx4 v10, s[8:11], s6 offen offset:3072 sc1 lds
  v_mfma_f32_16x16x32_bf16 v[120:123], v[160:163], a[168:171], v[120:123]
  s_waitcnt vmcnt(15)
  v_cmp_ne_u32 vcc, 1, v204
  s_nop 0
  s_cbranch_vccz gated_mix__spectral_gfnet__ssm_conv_s5__prompt_kernel_skip44
  s_mov_b32 s7, 0
gated_mix__spectral_gfnet__ssm_conv_s5__prompt_kernel_poll45:
  s_sleep 5
  buffer_load_dword v204, v3, s[48:51], s4 offen sc1
  s_waitcnt vmcnt(0)
  v_cmp_ne_u32 vcc, 1, v204
  s_nop 0
  s_cbranch_vccz gated_mix__spectral_gfnet__ssm_conv_s5__prompt_kernel_pollout46
  s_add_u32 s7, s7, 1
  s_cmp_lt_u32 s7, 1048576
  s_cbranch_scc1 gated_mix__spectral_gfnet__ssm_conv_s5__prompt_kernel_poll45
gated_mix__spectral_gfnet__ssm_conv_s5__prompt_kernel_pollout46:
gated_mix__spectral_gfnet__ssm_conv_s5__prompt_kernel_skip44:
  s_waitcnt vmcnt(12) lgkmcnt(0)
  s_barrier
  v_mfma_f32_16x16x32_bf16 v[40:43], v[164:167], a[164:167], v[40:43]
  ds_read_b64_tr_b16 v[124:125], v38 offset:32768
  ds_read_b64_tr_b16 v[126:127], v39 offset:32768
  v_mfma_f32_16x16x32_bf16 v[92:95], v[164:167], a[172:175], v[92:95]
  ds_read_b64_tr_b16 v[136:137], v38 offset:34816
  ds_read_b64_tr_b16 v[138:139], v39 offset:34816
  v_mfma_f32_16x16x32_bf16 v[44:47], v[168:171], a[164:167], v[44:47]
  ds_read_b64_tr_b16 v[140:141], v38 offset:36864
  ds_read_b64_tr_b16 v[142:143], v39 offset:36864
  v_mfma_f32_16x16x32_bf16 v[96:99], v[168:171], a[172:175], v[96:99]
  ds_read_b64_tr_b16 v[144:145], v38 offset:38912
  ds_read_b64_tr_b16 v[146:147], v39 offset:38912
  v_mfma_f32_16x16x32_bf16 v[48:51], v[172:175], a[164:167], v[48:51]
  ds_read_b64_tr_b16 v[148:149], v38 offset:40960
  ds_read_b64_tr_b16 v[150:151], v39 offset:40960
  v_mfma_f32_16x16x32_bf16 v[100:103], v[172:175], a[172:175], v[100:103]
  ds_read_b64_tr_b16 v[152:153], v38 offset:43008
  ds_read_b64_tr_b16 v[154:155], v39 offset:43008
  v_mfma_f32_16x16x32_bf16 v[52:55], v[176:179], a[164:167], v[52:55]
  ds_read_b64_tr_b16 v[156:157], v38 offset:45056
  ds_read_b64_tr_b16 v[158:159], v39 offset:45056
  v_mfma_f32_16x16x32_bf16 v[104:107], v[176:179], a[172:175], v[104:107]
  ds_read_b64_tr_b16 v[160:161], v38 offset:47104
  ds_read_b64_tr_b16 v[162:163], v39 offset:47104
  v_mfma_f32_16x16x32_bf16 v[76:79], v[180:183], a[164:167], v[76:79]
  s_add_u32 m0, s16, 36864
  s_nop 0
  buffer_load_dwordx4 v11, s[8:11], s6 offen offset:0 sc1 lds
  v_mfma_f32_16x16x32_bf16 v[108:111], v[180:183], a[172:175], v[108:111]
  v_lshlrev_b32 v9, 4, v4
  s_lshl_b32 s7, s42, 4
  s_add_u32 s7, s7, s43
  s_mul_i32 s7, s7, 16384
  s_lshl_b32 s20, s3, 12
  s_add_u32 s7, s7, s20
  buffer_load_dwordx4 v[12:15], v9, s[24:27], s7 offen offset:0 sc1
  buffer_load_dwordx4 v[16:19], v9, s[24:27], s7 offen offset:1024 sc1
  buffer_load_dwordx4 v[20:23], v9, s[24:27], s7 offen offset:2048 sc1
  buffer_load_dwordx4 v[32:35], v9, s[24:27], s7 offen offset:3072 sc1
  v_mfma_f32_16x16x32_bf16 v[80:83], v[184:187], a[164:167], v[80:83]
  buffer_load_dwordx4 v11, s[8:11], s6 offen offset:1024 sc1 lds
  v_mfma_f32_16x16x32_bf16 v[112:115], v[184:187], a[172:175], v[112:115]
  v_mfma_f32_16x16x32_bf16 v[84:87], v[188:191], a[164:167], v[84:87]
  buffer_load_dwordx4 v11, s[8:11], s6 offen offset:2048 sc1 lds
  v_mfma_f32_16x16x32_bf16 v[116:119], v[188:191], a[172:175], v[116:119]
  v_mfma_f32_16x16x32_bf16 v[88:91], v[192:195], a[164:167], v[88:91]
  buffer_load_dwordx4 v11, s[8:11], s6 offen offset:3072 sc1 lds
  s_add_u32 s6, s6, 32768
  s_and_b32 s6, s6, 0x7ffff
  v_mfma_f32_16x16x32_bf16 v[120:123], v[192:195], a[172:175], v[120:123]
  s_waitcnt lgkmcnt(0)
  v_mfma_f32_16x16x32_bf16 v[40:43], v[124:127], a[176:179], v[40:43]
  ds_read_b64_tr_b16 v[164:165], v38 offset:33024
  ds_read_b64_tr_b16 v[166:167], v39 offset:33024
  v_mfma_f32_16x16x32_bf16 v[92:95], v[124:127], a[184:187], v[92:95]
  ds_read_b64_tr_b16 v[168:169], v38 offset:35072
  ds_read_b64_tr_b16 v[170:171], v39 offset:35072
  v_mfma_f32_16x16x32_bf16 v[44:47], v[136:139], a[176:179], v[44:47]
  ds_read_b64_tr_b16 v[172:173], v38 offset:37120
  ds_read_b64_tr_b16 v[174:175], v39 offset:37120
  v_mfma_f32_16x16x32_bf16 v[96:99], v[136:139], a[184:187], v[96:99]
  ds_read_b64_tr_b16 v[176:177], v38 offset:39168
  ds_read_b64_tr_b16 v[178:179], v39 offset:39168
  v_mfma_f32_16x16x32_bf16 v[48:51], v[140:143], a[176:179], v[48:51]
  ds_read_b64_tr_b16 v[180:181], v38 offset:41216
  ds_read_b64_tr_b16 v[182:183], v39 offset:41216
  v_mfma_f32_16x16x32_bf16 v[100:103], v[140:143], a[184:187], v[100:103]
  ds_read_b64_tr_b16 v[184:185], v38 offset:43264
  ds_read_b64_tr_b16 v[186:187], v39 offset:43264
  v_mfma_f32_16x16x32_bf16 v[52:55], v[144:147], a[176:179], v[52:55]
  ds_read_b64_tr_b16 v[188:189], v38 offset:45312
  ds_read_b64_tr_b16 v[190:191], v39 offset:45312
  v_mfma_f32_16x16x32_bf16 v[104:107], v[144:147], a[184:187], v[104:107]
  ds_read_b64_tr_b16 v[192:193], v38 offset:47360
  ds_read_b64_tr_b16 v[194:195], v39 offset:47360
  v_mfma_f32_16x16x32_bf16 v[76:79], v[148:151], a[176:179], v[76:79]
  s_add_u32 m0, s16, 65536
  s_nop 0
  buffer_load_dwordx4 v10, s[8:11], s6 offen offset:0 sc1 lds
  v_mfma_f32_16x16x32_bf16 v[108:111], v[148:151], a[184:187], v[108:111]
  v_mfma_f32_16x16x32_bf16 v[80:83], v[152:155], a[176:179], v[80:83]
  buffer_load_dwordx4 v10, s[8:11], s6 offen offset:1024 sc1 lds
  v_mfma_f32_16x16x32_bf16 v[112:115], v[152:155], a[184:187], v[112:115]
  v_mfma_f32_16x16x32_bf16 v[84:87], v[156:159], a[176:179], v[84:87]
  buffer_load_dwordx4 v10, s[8:11], s6 offen offset:2048 sc1 lds
  v_mfma_f32_16x16x32_bf16 v[116:119], v[156:159], a[184:187], v[116:119]
  v_mfma_f32_16x16x32_bf16 v[88:91], v[160:163], a[176:179], v[88:91]
  buffer_load_dwordx4 v10, s[8:11], s6 offen offset:3072 sc1 lds
  v_mfma_f32_16x16x32_bf16 v[120:123], v[160:163], a[184:187], v[120:123]
  s_waitcnt vmcnt(16) lgkmcnt(0)
  s_barrier
  v_mfma_f32_16x16x32_bf16 v[40:43], v[164:167], a[180:183], v[40:43]
  ds_read_b64_tr_b16 v[124:125], v36 offset:0
  ds_read_b64_tr_b16 v[126:127], v37 offset:0
  v_mfma_f32_16x16x32_bf16 v[92:95], v[164:167], a[188:191], v[92:95]
  ds_read_b64_tr_b16 v[136:137], v36 offset:2048
  ds_read_b64_tr_b16 v[138:139], v37 offset:2048
  v_mfma_f32_16x16x32_bf16 v[44:47], v[168:171], a[180:183], v[44:47]
  ds_read_b64_tr_b16 v[140:141], v36 offset:4096
  ds_read_b64_tr_b16 v[142:143], v37 offset:4096
  v_mfma_f32_16x16x32_bf16 v[96:99], v[168:171], a[188:191], v[96:99]
  ds_read_b64_tr_b16 v[144:145], v36 offset:6144
  ds_read_b64_tr_b16 v[146:147], v37 offset:6144
  v_mfma_f32_16x16x32_bf16 v[48:51], v[172:175], a[180:183], v[48:51]
  ds_read_b64_tr_b16 v[148:149], v36 offset:8192
  ds_read_b64_tr_b16 v[150:151], v37 offset:8192
  v_mfma_f32_16x16x32_bf16 v[100:103], v[172:175], a[188:191], v[100:103]
  ds_read_b64_tr_b16 v[152:153], v36 offset:10240
  ds_read_b64_tr_b16 v[154:155], v37 offset:10240
  v_mfma_f32_16x16x32_bf16 v[52:55], v[176:179], a[180:183], v[52:55]
  ds_read_b64_tr_b16 v[156:157], v36 offset:12288
  ds_read_b64_tr_b16 v[158:159], v37 offset:12288
  v_mfma_f32_16x16x32_bf16 v[104:107], v[176:179], a[188:191], v[104:107]
  ds_read_b64_tr_b16 v[160:161], v36 offset:14336
  ds_read_b64_tr_b16 v[162:163], v37 offset:14336
  v_mfma_f32_16x16x32_bf16 v[76:79], v[180:183], a[180:183], v[76:79]
  s_add_u32 m0, s16, 69632
  s_nop 0
  buffer_load_dwordx4 v11, s[8:11], s6 offen offset:0 sc1 lds
  v_mfma_f32_16x16x32_bf16 v[108:111], v[180:183], a[188:191], v[108:111]
  v_mfma_f32_16x16x32_bf16 v[80:83], v[184:187], a[180:183], v[80:83]
  buffer_load_dwordx4 v11, s[8:11], s6 offen offset:1024 sc1 lds
  v_mfma_f32_16x16x32_bf16 v[112:115], v[184:187], a[188:191], v[112:115]
  v_mfma_f32_16x16x32_bf16 v[84:87], v[188:191], a[180:183], v[84:87]
  buffer_load_dwordx4 v11, s[8:11], s6 offen offset:2048 sc1 lds
  v_mfma_f32_16x16x32_bf16 v[116:119], v[188:191], a[188:191], v[116:119]
  v_mfma_f32_16x16x32_bf16 v[88:91], v[192:195], a[180:183], v[88:91]
  buffer_load_dwordx4 v11, s[8:11], s6 offen offset:3072 sc1 lds
  s_add_u32 s6, s6, 32768
  s_and_b32 s6, s6, 0x7ffff
  v_mfma_f32_16x16x32_bf16 v[120:123], v[192:195], a[188:191], v[120:123]
  s_waitcnt lgkmcnt(0)
  v_mfma_f32_16x16x32_bf16 v[40:43], v[124:127], a[192:195], v[40:43]
  ds_read_b64_tr_b16 v[164:165], v36 offset:256
  ds_read_b64_tr_b16 v[166:167], v37 offset:256
  v_mfma_f32_16x16x32_bf16 v[92:95], v[124:127], a[200:203], v[92:95]
  ds_read_b64_tr_b16 v[168:169], v36 offset:2304
  ds_read_b64_tr_b16 v[170:171], v37 offset:2304
  v_mfma_f32_16x16x32_bf16 v[44:47], v[136:139], a[192:195], v[44:47]
  ds_read_b64_tr_b16 v[172:173], v36 offset:4352
  ds_read_b64_tr_b16 v[174:175], v37 offset:4352
  v_mfma_f32_16x16x32_bf16 v[96:99], v[136:139], a[200:203], v[96:99]
  ds_read_b64_tr_b16 v[176:177], v36 offset:6400
  ds_read_b64_tr_b16 v[178:179], v37 offset:6400
  v_mfma_f32_16x16x32_bf16 v[48:51], v[140:143], a[192:195], v[48:51]
  ds_read_b64_tr_b16 v[180:181], v36 offset:8448
  ds_read_b64_tr_b16 v[182:183], v37 offset:8448
  v_mfma_f32_16x16x32_bf16 v[100:103], v[140:143], a[200:203], v[100:103]
  ds_read_b64_tr_b16 v[184:185], v36 offset:10496
  ds_read_b64_tr_b16 v[186:187], v37 offset:10496
  v_mfma_f32_16x16x32_bf16 v[52:55], v[144:147], a[192:195], v[52:55]
  ds_read_b64_tr_b16 v[188:189], v36 offset:12544
  ds_read_b64_tr_b16 v[190:191], v37 offset:12544
  v_mfma_f32_16x16x32_bf16 v[104:107], v[144:147], a[200:203], v[104:107]
  ds_read_b64_tr_b16 v[192:193], v36 offset:14592
  ds_read_b64_tr_b16 v[194:195], v37 offset:14592
  v_mfma_f32_16x16x32_bf16 v[76:79], v[148:151], a[192:195], v[76:79]
  s_add_u32 m0, s16, 98304
  s_nop 0
  buffer_load_dwordx4 v10, s[8:11], s6 offen offset:0 sc1 lds
  v_mfma_f32_16x16x32_bf16 v[108:111], v[148:151], a[200:203], v[108:111]
  v_mfma_f32_16x16x32_bf16 v[80:83], v[152:155], a[192:195], v[80:83]
  buffer_load_dwordx4 v10, s[8:11], s6 offen offset:1024 sc1 lds
  v_mfma_f32_16x16x32_bf16 v[112:115], v[152:155], a[200:203], v[112:115]
  v_mfma_f32_16x16x32_bf16 v[84:87], v[156:159], a[192:195], v[84:87]
  buffer_load_dwordx4 v10, s[8:11], s6 offen offset:2048 sc1 lds
  v_mfma_f32_16x16x32_bf16 v[116:119], v[156:159], a[200:203], v[116:119]
  v_mfma_f32_16x16x32_bf16 v[88:91], v[160:163], a[192:195], v[88:91]
  buffer_load_dwordx4 v10, s[8:11], s6 offen offset:3072 sc1 lds
  v_mfma_f32_16x16x32_bf16 v[120:123], v[160:163], a[200:203], v[120:123]
  s_waitcnt vmcnt(12) lgkmcnt(0)
  s_barrier
  v_mfma_f32_16x16x32_bf16 v[40:43], v[164:167], a[196:199], v[40:43]
  ds_read_b64_tr_b16 v[124:125], v36 offset:32768
  ds_read_b64_tr_b16 v[126:127], v37 offset:32768
  v_mfma_f32_16x16x32_bf16 v[92:95], v[164:167], a[204:207], v[92:95]
  ds_read_b64_tr_b16 v[136:137], v36 offset:34816
  ds_read_b64_tr_b16 v[138:139], v37 offset:34816
  v_mfma_f32_16x16x32_bf16 v[44:47], v[168:171], a[196:199], v[44:47]
  ds_read_b64_tr_b16 v[140:141], v36 offset:36864
  ds_read_b64_tr_b16 v[142:143], v37 offset:36864
  v_mfma_f32_16x16x32_bf16 v[96:99], v[168:171], a[204:207], v[96:99]
  ds_read_b64_tr_b16 v[144:145], v36 offset:38912
  ds_read_b64_tr_b16 v[146:147], v37 offset:38912
  v_mfma_f32_16x16x32_bf16 v[48:51], v[172:175], a[196:199], v[48:51]
  ds_read_b64_tr_b16 v[148:149], v36 offset:40960
  ds_read_b64_tr_b16 v[150:151], v37 offset:40960
  v_mfma_f32_16x16x32_bf16 v[100:103], v[172:175], a[204:207], v[100:103]
  ds_read_b64_tr_b16 v[152:153], v36 offset:43008
  ds_read_b64_tr_b16 v[154:155], v37 offset:43008
  v_mfma_f32_16x16x32_bf16 v[52:55], v[176:179], a[196:199], v[52:55]
  ds_read_b64_tr_b16 v[156:157], v36 offset:45056
  ds_read_b64_tr_b16 v[158:159], v37 offset:45056
  v_mfma_f32_16x16x32_bf16 v[104:107], v[176:179], a[204:207], v[104:107]
  ds_read_b64_tr_b16 v[160:161], v36 offset:47104
  ds_read_b64_tr_b16 v[162:163], v37 offset:47104
  v_mfma_f32_16x16x32_bf16 v[76:79], v[180:183], a[196:199], v[76:79]
  s_add_u32 m0, s16, 102400
  s_nop 0
  buffer_load_dwordx4 v11, s[8:11], s6 offen offset:0 sc1 lds
  v_mfma_f32_16x16x32_bf16 v[108:111], v[180:183], a[204:207], v[108:111]
  v_mfma_f32_16x16x32_bf16 v[80:83], v[184:187], a[196:199], v[80:83]
  buffer_load_dwordx4 v11, s[8:11], s6 offen offset:1024 sc1 lds
  v_mfma_f32_16x16x32_bf16 v[112:115], v[184:187], a[204:207], v[112:115]
  v_mfma_f32_16x16x32_bf16 v[84:87], v[188:191], a[196:199], v[84:87]
  buffer_load_dwordx4 v11, s[8:11], s6 offen offset:2048 sc1 lds
  v_mfma_f32_16x16x32_bf16 v[116:119], v[188:191], a[204:207], v[116:119]
  v_mfma_f32_16x16x32_bf16 v[88:91], v[192:195], a[196:199], v[88:91]
  buffer_load_dwordx4 v11, s[8:11], s6 offen offset:3072 sc1 lds
  s_add_u32 s6, s6, 32768
  s_and_b32 s6, s6, 0x7ffff
  v_mfma_f32_16x16x32_bf16 v[120:123], v[192:195], a[204:207], v[120:123]
  s_waitcnt lgkmcnt(0)
  v_mfma_f32_16x16x32_bf16 v[40:43], v[124:127], a[208:211], v[40:43]
  ds_read_b64_tr_b16 v[164:165], v36 offset:33024
  ds_read_b64_tr_b16 v[166:167], v37 offset:33024
  v_mfma_f32_16x16x32_bf16 v[92:95], v[124:127], a[216:219], v[92:95]
  ds_read_b64_tr_b16 v[168:169], v36 offset:35072
  ds_read_b64_tr_b16 v[170:171], v37 offset:35072
  v_mfma_f32_16x16x32_bf16 v[44:47], v[136:139], a[208:211], v[44:47]
  ds_read_b64_tr_b16 v[172:173], v36 offset:37120
  ds_read_b64_tr_b16 v[174:175], v37 offset:37120
  v_mfma_f32_16x16x32_bf16 v[96:99], v[136:139], a[216:219], v[96:99]
  ds_read_b64_tr_b16 v[176:177], v36 offset:39168
  ds_read_b64_tr_b16 v[178:179], v37 offset:39168
  v_mfma_f32_16x16x32_bf16 v[48:51], v[140:143], a[208:211], v[48:51]
  ds_read_b64_tr_b16 v[180:181], v36 offset:41216
  ds_read_b64_tr_b16 v[182:183], v37 offset:41216
  v_mfma_f32_16x16x32_bf16 v[100:103], v[140:143], a[216:219], v[100:103]
  ds_read_b64_tr_b16 v[184:185], v36 offset:43264
  ds_read_b64_tr_b16 v[186:187], v37 offset:43264
  v_mfma_f32_16x16x32_bf16 v[52:55], v[144:147], a[208:211], v[52:55]
  ds_read_b64_tr_b16 v[188:189], v36 offset:45312
  ds_read_b64_tr_b16 v[190:191], v37 offset:45312
  s_lshl_b32 s7, s3, 10
  s_add_u32 s7, s7, 131072
  v_lshl_add_u32 v9, v4, 4, s7
  v_lshlrev_b32 v128, 16, v12
  v_mfma_f32_16x16x32_bf16 v[104:107], v[144:147], a[216:219], v[104:107]
  ds_read_b64_tr_b16 v[192:193], v36 offset:47360
  ds_read_b64_tr_b16 v[194:195], v37 offset:47360
  v_and_b32 v130, 0xffff0000, v12
  v_lshlrev_b32 v129, 16, v13
  v_and_b32 v131, 0xffff0000, v13
  v_lshlrev_b32 v132, 16, v16
  v_mfma_f32_16x16x32_bf16 v[76:79], v[148:151], a[208:211], v[76:79]
  v_and_b32 v134, 0xffff0000, v16
  v_lshlrev_b32 v133, 16, v17
  v_and_b32 v135, 0xffff0000, v17
  v_lshlrev_b32 v204, 16, v20
  v_mfma_f32_16x16x32_bf16 v[108:111], v[148:151], a[216:219], v[108:111]
  v_and_b32 v206, 0xffff0000, v20
  v_lshlrev_b32 v205, 16, v21
  v_and_b32 v207, 0xffff0000, v21
  v_lshlrev_b32 v208, 16, v32
  v_mfma_f32_16x16x32_bf16 v[80:83], v[152:155], a[208:211], v[80:83]
  v_and_b32 v210, 0xffff0000, v32
  v_lshlrev_b32 v209, 16, v33
  v_and_b32 v211, 0xffff0000, v33
  v_pk_add_f32 v[212:213], v[128:129], v[204:205]
  v_mfma_f32_16x16x32_bf16 v[112:115], v[152:155], a[216:219], v[112:115]
  v_pk_add_f32 v[216:217], v[128:129], v[204:205] neg_lo:[0,1] neg_hi:[0,1]
  v_pk_add_f32 v[220:221], v[132:133], v[208:209]
  v_pk_add_f32 v[214:215], v[130:131], v[206:207]
  v_pk_add_f32 v[218:219], v[130:131], v[206:207] neg_lo:[0,1] neg_hi:[0,1]
  v_mfma_f32_16x16x32_bf16 v[84:87], v[156:159], a[208:211], v[84:87]
  v_pk_add_f32 v[222:223], v[134:135], v[210:211]
  v_pk_add_f32 v[224:225], v[210:211], v[134:135] neg_lo:[0,1] neg_hi:[0,1]
  v_pk_add_f32 v[226:227], v[132:133], v[208:209] neg_lo:[0,1] neg_hi:[0,1]
  s_cmp_lg_u32 s3, 0
  s_cbranch_scc1 gated_mix__spectral_gfnet__ssm_conv_s5__prompt_kernel_skip47
  s_mov_b64 exec, 15
  v_pk_add_f32 v[220:221], v[132:133], v[132:133]
  v_pk_add_f32 v[222:223], v[208:209], v[208:209]
  v_pk_add_f32 v[224:225], v[134:135], v[134:135] neg_lo:[1,1] neg_hi:[1,1]
  v_pk_add_f32 v[226:227], v[210:211], v[210:211] neg_lo:[1,1] neg_hi:[1,1]
  s_mov_b64 exec, -1
gated_mix__spectral_gfnet__ssm_conv_s5__prompt_kernel_skip47:
  v_mfma_f32_16x16x32_bf16 v[116:119], v[156:159], a[216:219], v[116:119]
  v_pk_add_f32 v[128:129], v[212:213], v[220:221]
  v_cvt_pk_bf16_f32 v228, v128, v129
  v_pk_add_f32 v[130:131], v[214:215], v[222:223]
  v_cvt_pk_bf16_f32 v229, v130, v131
  v_mfma_f32_16x16x32_bf16 v[88:91], v[160:163], a[208:211], v[88:91]
  v_pk_add_f32 v[132:133], v[216:217], v[224:225]
  v_cvt_pk_bf16_f32 v230, v132, v133
  v_pk_add_f32 v[134:135], v[218:219], v[226:227]
  v_cvt_pk_bf16_f32 v231, v134, v135
  v_mfma_f32_16x16x32_bf16 v[120:123], v[160:163], a[216:219], v[120:123]
  v_pk_add_f32 v[204:205], v[212:213], v[220:221] neg_lo:[0,1] neg_hi:[0,1]
  v_cvt_pk_bf16_f32 v232, v204, v205
  v_pk_add_f32 v[206:207], v[214:215], v[222:223] neg_lo:[0,1] neg_hi:[0,1]
  v_cvt_pk_bf16_f32 v233, v206, v207
  s_waitcnt vmcnt(8) lgkmcnt(0)
  s_barrier
  v_mfma_f32_16x16x32_bf16 v[40:43], v[164:167], a[212:215], v[40:43]
  ds_read_b64_tr_b16 v[124:125], v38 offset:0
  ds_read_b64_tr_b16 v[126:127], v39 offset:0
  v_mfma_f32_16x16x32_bf16 v[92:95], v[164:167], a[220:223], v[92:95]
  ds_read_b64_tr_b16 v[136:137], v38 offset:2048
  ds_read_b64_tr_b16 v[138:139], v39 offset:2048
  v_mfma_f32_16x16x32_bf16 v[44:47], v[168:171], a[212:215], v[44:47]
  ds_read_b64_tr_b16 v[140:141], v38 offset:4096
  ds_read_b64_tr_b16 v[142:143], v39 offset:4096
  v_mfma_f32_16x16x32_bf16 v[96:99], v[168:171], a[220:223], v[96:99]
  ds_read_b64_tr_b16 v[144:145], v38 offset:6144
  ds_read_b64_tr_b16 v[146:147], v39 offset:6144
  v_mfma_f32_16x16x32_bf16 v[48:51], v[172:175], a[212:215], v[48:51]
  ds_read_b64_tr_b16 v[148:149], v38 offset:8192
  ds_read_b64_tr_b16 v[150:151], v39 offset:8192
  v_mfma_f32_16x16x32_bf16 v[100:103], v[172:175], a[220:223], v[100:103]
  ds_read_b64_tr_b16 v[152:153], v38 offset:10240
  ds_read_b64_tr_b16 v[154:155], v39 offset:10240
  v_mfma_f32_16x16x32_bf16 v[52:55], v[176:179], a[212:215], v[52:55]
  ds_read_b64_tr_b16 v[156:157], v38 offset:12288
  ds_read_b64_tr_b16 v[158:159], v39 offset:12288
  v_pk_add_f32 v[208:209], v[216:217], v[224:225] neg_lo:[0,1] neg_hi:[0,1]
  v_cvt_pk_bf16_f32 v234, v208, v209
  v_pk_add_f32 v[210:211], v[218:219], v[226:227] neg_lo:[0,1] neg_hi:[0,1]
  v_cvt_pk_bf16_f32 v235, v210, v211
  v_mfma_f32_16x16x32_bf16 v[104:107], v[176:179], a[220:223], v[104:107]
  ds_read_b64_tr_b16 v[160:161], v38 offset:14336
  ds_read_b64_tr_b16 v[162:163], v39 offset:14336
  v_lshlrev_b32 v128, 16, v14
  v_and_b32 v130, 0xffff0000, v14
  v_lshlrev_b32 v129, 16, v15
  v_and_b32 v131, 0xffff0000, v15
  v_mfma_f32_16x16x32_bf16 v[76:79], v[180:183], a[212:215], v[76:79]
  v_lshlrev_b32 v132, 16, v18
  v_and_b32 v134, 0xffff0000, v18
  v_lshlrev_b32 v133, 16, v19
  v_and_b32 v135, 0xffff0000, v19
  v_mfma_f32_16x16x32_bf16 v[108:111], v[180:183], a[220:223], v[108:111]
  v_lshlrev_b32 v204, 16, v22
  v_and_b32 v206, 0xffff0000, v22
  v_lshlrev_b32 v205, 16, v23
  v_and_b32 v207, 0xffff0000, v23
  v_mfma_f32_16x16x32_bf16 v[80:83], v[184:187], a[212:215], v[80:83]
  v_lshlrev_b32 v208, 16, v34
  v_and_b32 v210, 0xffff0000, v34
  v_lshlrev_b32 v209, 16, v35
  v_and_b32 v211, 0xffff0000, v35
  v_mfma_f32_16x16x32_bf16 v[112:115], v[184:187], a[220:223], v[112:115]
  v_pk_add_f32 v[212:213], v[128:129], v[204:205]
  v_pk_add_f32 v[216:217], v[128:129], v[204:205] neg_lo:[0,1] neg_hi:[0,1]
  v_pk_add_f32 v[220:221], v[132:133], v[208:209]
  v_pk_add_f32 v[214:215], v[130:131], v[206:207]
  v_mfma_f32_16x16x32_bf16 v[84:87], v[188:191], a[212:215], v[84:87]
  v_pk_add_f32 v[218:219], v[130:131], v[206:207] neg_lo:[0,1] neg_hi:[0,1]
  v_pk_add_f32 v[222:223], v[134:135], v[210:211]
  v_pk_add_f32 v[224:225], v[210:211], v[134:135] neg_lo:[0,1] neg_hi:[0,1]
  v_pk_add_f32 v[226:227], v[132:133], v[208:209] neg_lo:[0,1] neg_hi:[0,1]
  v_mfma_f32_16x16x32_bf16 v[116:119], v[188:191], a[220:223], v[116:119]
  s_cmp_lg_u32 s3, 0
  s_cbranch_scc1 gated_mix__spectral_gfnet__ssm_conv_s5__prompt_kernel_skip48
  s_mov_b64 exec, 15
  v_pk_add_f32 v[220:221], v[132:133], v[132:133]
  v_pk_add_f32 v[222:223], v[208:209], v[208:209]
  v_pk_add_f32 v[224:225], v[134:135], v[134:135] neg_lo:[1,1] neg_hi:[1,1]
  v_pk_add_f32 v[226:227], v[210:211], v[210:211] neg_lo:[1,1] neg_hi:[1,1]
  s_mov_b64 exec, -1
gated_mix__spectral_gfnet__ssm_conv_s5__prompt_kernel_skip48:
  v_mfma_f32_16x16x32_bf16 v[88:91], v[192:195], a[212:215], v[88:91]
  v_pk_add_f32 v[128:129], v[212:213], v[220:221]
  v_cvt_pk_bf16_f32 v13, v128, v129
  v_pk_add_f32 v[130:131], v[214:215], v[222:223]
  v_cvt_pk_bf16_f32 v15, v130, v131
  v_mfma_f32_16x16x32_bf16 v[120:123], v[192:195], a[220:223], v[120:123]
  v_pk_add_f32 v[132:133], v[216:217], v[224:225]
  v_cvt_pk_bf16_f32 v17, v132, v133
  v_pk_add_f32 v[134:135], v[218:219], v[226:227]
  v_cvt_pk_bf16_f32 v19, v134, v135
  s_waitcnt lgkmcnt(0)
  v_mfma_f32_16x16x32_bf16 v[40:43], v[124:127], a[224:227], v[40:43]
  ds_read_b64_tr_b16 v[164:165], v38 offset:256
  ds_read_b64_tr_b16 v[166:167], v39 offset:256
  v_mfma_f32_16x16x32_bf16 v[92:95], v[124:127], a[232:235], v[92:95]
  ds_read_b64_tr_b16 v[168:169], v38 offset:2304
  ds_read_b64_tr_b16 v[170:171], v39 offset:2304
  v_mfma_f32_16x16x32_bf16 v[44:47], v[136:139], a[224:227], v[44:47]
  ds_read_b64_tr_b16 v[172:173], v38 offset:4352
  ds_read_b64_tr_b16 v[174:175], v39 offset:4352
  v_mfma_f32_16x16x32_bf16 v[96:99], v[136:139], a[232:235], v[96:99]
  ds_read_b64_tr_b16 v[176:177], v38 offset:6400
  ds_read_b64_tr_b16 v[178:179], v39 offset:6400
  v_mfma_f32_16x16x32_bf16 v[48:51], v[140:143], a[224:227], v[48:51]
  ds_read_b64_tr_b16 v[180:181], v38 offset:8448
  ds_read_b64_tr_b16 v[182:183], v39 offset:8448
  v_mfma_f32_16x16x32_bf16 v[100:103], v[140:143], a[232:235], v[100:103]
  ds_read_b64_tr_b16 v[184:185], v38 offset:10496
  ds_read_b64_tr_b16 v[186:187], v39 offset:10496
  v_mfma_f32_16x16x32_bf16 v[52:55], v[144:147], a[224:227], v[52:55]
  ds_read_b64_tr_b16 v[188:189], v38 offset:12544
  ds_read_b64_tr_b16 v[190:191], v39 offset:12544
  v_pk_add_f32 v[204:205], v[212:213], v[220:221] neg_lo:[0,1] neg_hi:[0,1]
  v_cvt_pk_bf16_f32 v21, v204, v205
  v_pk_add_f32 v[206:207], v[214:215], v[222:223] neg_lo:[0,1] neg_hi:[0,1]
  v_cvt_pk_bf16_f32 v23, v206, v207
  v_mfma_f32_16x16x32_bf16 v[104:107], v[144:147], a[232:235], v[104:107]
  ds_read_b64_tr_b16 v[192:193], v38 offset:14592
  ds_read_b64_tr_b16 v[194:195], v39 offset:14592
  v_pk_add_f32 v[208:209], v[216:217], v[224:225] neg_lo:[0,1] neg_hi:[0,1]
  v_cvt_pk_bf16_f32 v33, v208, v209
  v_pk_add_f32 v[210:211], v[218:219], v[226:227] neg_lo:[0,1] neg_hi:[0,1]
  v_cvt_pk_bf16_f32 v35, v210, v211
  v_mfma_f32_16x16x32_bf16 v[76:79], v[148:151], a[224:227], v[76:79]
  v_mov_b32 v12, v228
  v_mov_b32 v14, v229
  ds_write_b128 v9, v[12:15] offset:0
  v_mov_b32 v16, v230
  v_mfma_f32_16x16x32_bf16 v[108:111], v[148:151], a[232:235], v[108:111]
  v_mov_b32 v18, v231
  ds_write_b128 v9, v[16:19] offset:4096
  v_mov_b32 v20, v232
  v_mov_b32 v22, v233
  v_mfma_f32_16x16x32_bf16 v[80:83], v[152:155], a[224:227], v[80:83]
  ds_write_b128 v9, v[20:23] offset:8192
  v_mov_b32 v32, v234
  v_mov_b32 v34, v235
  ds_write_b128 v9, v[32:35] offset:12288
  v_mfma_f32_16x16x32_bf16 v[112:115], v[152:155], a[232:235], v[112:115]
  v_mfma_f32_16x16x32_bf16 v[84:87], v[156:159], a[224:227], v[84:87]
  v_mfma_f32_16x16x32_bf16 v[116:119], v[156:159], a[232:235], v[116:119]
  v_mfma_f32_16x16x32_bf16 v[88:91], v[160:163], a[224:227], v[88:91]
  v_mfma_f32_16x16x32_bf16 v[120:123], v[160:163], a[232:235], v[120:123]
  s_waitcnt lgkmcnt(0)
  s_waitcnt vmcnt(0)
  s_barrier
  v_mfma_f32_16x16x32_bf16 v[40:43], v[164:167], a[228:231], v[40:43]
  ds_read_b64_tr_b16 v[124:125], v38 offset:32768
  ds_read_b64_tr_b16 v[126:127], v39 offset:32768
  v_mfma_f32_16x16x32_bf16 v[92:95], v[164:167], a[236:239], v[92:95]
  ds_read_b64_tr_b16 v[136:137], v38 offset:34816
  ds_read_b64_tr_b16 v[138:139], v39 offset:34816
  v_mfma_f32_16x16x32_bf16 v[44:47], v[168:171], a[228:231], v[44:47]
  ds_read_b64_tr_b16 v[140:141], v38 offset:36864
  ds_read_b64_tr_b16 v[142:143], v39 offset:36864
  v_mfma_f32_16x16x32_bf16 v[96:99], v[168:171], a[236:239], v[96:99]
  ds_read_b64_tr_b16 v[144:145], v38 offset:38912
  ds_read_b64_tr_b16 v[146:147], v39 offset:38912
  v_mfma_f32_16x16x32_bf16 v[48:51], v[172:175], a[228:231], v[48:51]
  ds_read_b64_tr_b16 v[148:149], v38 offset:40960
  ds_read_b64_tr_b16 v[150:151], v39 offset:40960
  v_mfma_f32_16x16x32_bf16 v[100:103], v[172:175], a[236:239], v[100:103]
  ds_read_b64_tr_b16 v[152:153], v38 offset:43008
  ds_read_b64_tr_b16 v[154:155], v39 offset:43008
  v_mfma_f32_16x16x32_bf16 v[52:55], v[176:179], a[228:231], v[52:55]
  ds_read_b64_tr_b16 v[156:157], v38 offset:45056
  ds_read_b64_tr_b16 v[158:159], v39 offset:45056
  v_mfma_f32_16x16x32_bf16 v[104:107], v[176:179], a[236:239], v[104:107]
  ds_read_b64_tr_b16 v[160:161], v38 offset:47104
  ds_read_b64_tr_b16 v[162:163], v39 offset:47104
  v_mfma_f32_16x16x32_bf16 v[76:79], v[180:183], a[228:231], v[76:79]
  v_mfma_f32_16x16x32_bf16 v[108:111], v[180:183], a[236:239], v[108:111]
  v_lshlrev_b32 v9, 4, v6
  s_lshl_b32 s7, s42, 9
  s_and_b32 s20, s3, 1
  s_lshl_b32 s20, s20, 8
  s_add_u32 s7, s7, s20
  buffer_load_dwordx4 v[12:15], v9, s[72:75], s7 offen offset:0 sc1
  buffer_load_dwordx4 v[16:19], v9, s[72:75], s7 offen offset:64 sc1
  buffer_load_dwordx4 v[20:23], v9, s[72:75], s7 offen offset:128 sc1
  buffer_load_dwordx4 v[32:35], v9, s[72:75], s7 offen offset:192 sc1
  v_and_b32 v228, 1, v6
  v_mul_u32_u24 v228, 0x8000, v228
  v_lshl_or_b32 v228, v228, 16, v228
  v_xor_b32 v229, 0x80000000, v228
  v_mfma_f32_16x16x32_bf16 v[80:83], v[184:187], a[228:231], v[80:83]
  v_xor_b32 v128, v228, v28
  v_alignbit_b32 v129, v29, v29, 16
  v_xor_b32 v129, v229, v129
  v_xor_b32 v130, v228, v30
  v_mfma_f32_16x16x32_bf16 v[112:115], v[184:187], a[236:239], v[112:115]
  v_alignbit_b32 v131, v31, v31, 16
  v_xor_b32 v131, v229, v131
  v_xor_b32 v132, v228, v56
  v_alignbit_b32 v133, v57, v57, 16
  v_mfma_f32_16x16x32_bf16 v[84:87], v[188:191], a[228:231], v[84:87]
  v_xor_b32 v133, v229, v133
  v_xor_b32 v134, v228, v58
  v_alignbit_b32 v135, v59, v59, 16
  v_xor_b32 v135, v229, v135
  v_mfma_f32_16x16x32_bf16 v[116:119], v[188:191], a[236:239], v[116:119]
  v_xor_b32 v204, v228, v60
  v_alignbit_b32 v205, v61, v61, 16
  v_xor_b32 v205, v229, v205
  v_xor_b32 v206, v228, v62
  v_mfma_f32_16x16x32_bf16 v[88:91], v[192:195], a[228:231], v[88:91]
  v_alignbit_b32 v207, v63, v63, 16
  v_xor_b32 v207, v229, v207
  v_xor_b32 v208, v228, v64
  v_alignbit_b32 v209, v65, v65, 16
  v_mfma_f32_16x16x32_bf16 v[120:123], v[192:195], a[236:239], v[120:123]
  v_xor_b32 v209, v229, v209
  v_xor_b32 v210, v228, v66
  v_alignbit_b32 v211, v67, v67, 16
  v_xor_b32 v211, v229, v211
  s_waitcnt lgkmcnt(0)
  v_mfma_f32_16x16x32_bf16 v[40:43], v[124:127], a[240:243], v[40:43]
  ds_read_b64_tr_b16 v[164:165], v38 offset:33024
  ds_read_b64_tr_b16 v[166:167], v39 offset:33024
  v_mfma_f32_16x16x32_bf16 v[92:95], v[124:127], a[248:251], v[92:95]
  ds_read_b64_tr_b16 v[168:169], v38 offset:35072
  ds_read_b64_tr_b16 v[170:171], v39 offset:35072
  v_mfma_f32_16x16x32_bf16 v[44:47], v[136:139], a[240:243], v[44:47]
  ds_read_b64_tr_b16 v[172:173], v38 offset:37120
  ds_read_b64_tr_b16 v[174:175], v39 offset:37120
  v_mfma_f32_16x16x32_bf16 v[96:99], v[136:139], a[248:251], v[96:99]
  ds_read_b64_tr_b16 v[176:177], v38 offset:39168
  ds_read_b64_tr_b16 v[178:179], v39 offset:39168
  v_mfma_f32_16x16x32_bf16 v[48:51], v[140:143], a[240:243], v[48:51]
  ds_read_b64_tr_b16 v[180:181], v38 offset:41216
  ds_read_b64_tr_b16 v[182:183], v39 offset:41216
  v_mfma_f32_16x16x32_bf16 v[100:103], v[140:143], a[248:251], v[100:103]
  ds_read_b64_tr_b16 v[184:185], v38 offset:43264
  ds_read_b64_tr_b16 v[186:187], v39 offset:43264
  v_mfma_f32_16x16x32_bf16 v[52:55], v[144:147], a[240:243], v[52:55]
  ds_read_b64_tr_b16 v[188:189], v38 offset:45312
  ds_read_b64_tr_b16 v[190:191], v39 offset:45312
  v_mfma_f32_16x16x32_bf16 v[104:107], v[144:147], a[248:251], v[104:107]
  ds_read_b64_tr_b16 v[192:193], v38 offset:47360
  ds_read_b64_tr_b16 v[194:195], v39 offset:47360
  v_mfma_f32_16x16x32_bf16 v[76:79], v[148:151], a[240:243], v[76:79]
  v_xor_b32 v212, v228, v68
  v_alignbit_b32 v213, v69, v69, 16
  v_xor_b32 v213, v229, v213
  v_xor_b32 v214, v228, v70
  v_mfma_f32_16x16x32_bf16 v[108:111], v[148:151], a[248:251], v[108:111]
  v_alignbit_b32 v215, v71, v71, 16
  v_xor_b32 v215, v229, v215
  v_xor_b32 v216, v228, v72
  v_alignbit_b32 v217, v73, v73, 16
  v_mfma_f32_16x16x32_bf16 v[80:83], v[152:155], a[240:243], v[80:83]
  v_xor_b32 v217, v229, v217
  v_xor_b32 v218, v228, v74
  v_alignbit_b32 v219, v75, v75, 16
  v_xor_b32 v219, v229, v219
  v_mfma_f32_16x16x32_bf16 v[112:115], v[152:155], a[248:251], v[112:115]
  v_xor_b32 v220, v228, v196
  v_alignbit_b32 v221, v197, v197, 16
  v_xor_b32 v221, v229, v221
  v_xor_b32 v222, v228, v198
  v_mfma_f32_16x16x32_bf16 v[84:87], v[156:159], a[240:243], v[84:87]
  v_alignbit_b32 v223, v199, v199, 16
  v_xor_b32 v223, v229, v223
  v_xor_b32 v224, v228, v200
  v_alignbit_b32 v225, v201, v201, 16
  v_mfma_f32_16x16x32_bf16 v[116:119], v[156:159], a[248:251], v[116:119]
  v_xor_b32 v225, v229, v225
  v_xor_b32 v226, v228, v202
  v_alignbit_b32 v227, v203, v203, 16
  v_xor_b32 v227, v229, v227
  v_mfma_f32_16x16x32_bf16 v[88:91], v[160:163], a[240:243], v[88:91]
  v_mfma_f32_16x16x32_bf16 v[120:123], v[160:163], a[248:251], v[120:123]
  s_waitcnt lgkmcnt(0)
  v_mfma_f32_16x16x32_bf16 v[76:79], v[180:183], a[244:247], v[76:79]
  ds_read_b64_tr_b16 v[124:125], v8 offset:0
  ds_read_b64_tr_b16 v[126:127], v8 offset:256
  v_mfma_f32_16x16x32_bf16 v[108:111], v[180:183], a[252:255], v[108:111]
  ds_read_b64_tr_b16 v[148:149], v8 offset:4096
  ds_read_b64_tr_b16 v[150:151], v8 offset:4352
  v_mfma_f32_16x16x32_bf16 v[80:83], v[184:187], a[244:247], v[80:83]
  ds_read_b64_tr_b16 v[136:137], v8 offset:1024
  ds_read_b64_tr_b16 v[138:139], v8 offset:1280
  v_mfma_f32_16x16x32_bf16 v[112:115], v[184:187], a[252:255], v[112:115]
  ds_read_b64_tr_b16 v[152:153], v8 offset:5120
  ds_read_b64_tr_b16 v[154:155], v8 offset:5376
  v_mfma_f32_16x16x32_bf16 v[84:87], v[188:191], a[244:247], v[84:87]
  ds_read_b64_tr_b16 v[140:141], v8 offset:2048
  ds_read_b64_tr_b16 v[142:143], v8 offset:2304
  v_mfma_f32_16x16x32_bf16 v[116:119], v[188:191], a[252:255], v[116:119]
  ds_read_b64_tr_b16 v[156:157], v8 offset:6144
  ds_read_b64_tr_b16 v[158:159], v8 offset:6400
  v_mfma_f32_16x16x32_bf16 v[88:91], v[192:195], a[244:247], v[88:91]
  ds_read_b64_tr_b16 v[144:145], v8 offset:3072
  ds_read_b64_tr_b16 v[146:147], v8 offset:3328
  v_mfma_f32_16x16x32_bf16 v[120:123], v[192:195], a[252:255], v[120:123]
  ds_read_b64_tr_b16 v[160:161], v8 offset:7168
  ds_read_b64_tr_b16 v[162:163], v8 offset:7424
  v_mfma_f32_16x16x32_bf16 v[40:43], v[164:167], a[244:247], v[40:43]
  v_mfma_f32_16x16x32_bf16 v[92:95], v[164:167], a[252:255], v[92:95]
  v_mfma_f32_16x16x32_bf16 v[44:47], v[168:171], a[244:247], v[44:47]
  v_mfma_f32_16x16x32_bf16 v[96:99], v[168:171], a[252:255], v[96:99]
  v_mfma_f32_16x16x32_bf16 v[48:51], v[172:175], a[244:247], v[48:51]
  v_mfma_f32_16x16x32_bf16 v[100:103], v[172:175], a[252:255], v[100:103]
  v_mfma_f32_16x16x32_bf16 v[52:55], v[176:179], a[244:247], v[52:55]
  v_mfma_f32_16x16x32_bf16 v[104:107], v[176:179], a[252:255], v[104:107]
  s_waitcnt lgkmcnt(14)
  v_mfma_f32_16x16x32_bf16 v[164:167], v[28:31], v[124:127], 0
  ds_write_b128 v2, v[76:79] offset:0
  s_waitcnt lgkmcnt(13)
  v_mfma_f32_16x16x32_bf16 v[180:183], v[28:31], v[148:151], 0
  ds_write_b128 v2, v[108:111] offset:4096
  s_waitcnt lgkmcnt(12)
  v_mfma_f32_16x16x32_bf16 v[164:167], v[56:59], v[136:139], v[164:167]
  ds_write_b128 v2, v[80:83] offset:1024
  s_waitcnt lgkmcnt(11)
  v_mfma_f32_16x16x32_bf16 v[180:183], v[56:59], v[152:155], v[180:183]
  ds_write_b128 v2, v[112:115] offset:5120
  s_waitcnt lgkmcnt(10)
  v_mfma_f32_16x16x32_bf16 v[164:167], v[60:63], v[140:143], v[164:167]
  ds_write_b128 v2, v[84:87] offset:2048
  s_waitcnt lgkmcnt(9)
  v_mfma_f32_16x16x32_bf16 v[180:183], v[60:63], v[156:159], v[180:183]
  ds_write_b128 v2, v[116:119] offset:6144
  s_waitcnt lgkmcnt(8)
  v_mfma_f32_16x16x32_bf16 v[164:167], v[64:67], v[144:147], v[164:167]
  ds_write_b128 v2, v[88:91] offset:3072
  s_waitcnt lgkmcnt(7)
  v_mfma_f32_16x16x32_bf16 v[180:183], v[64:67], v[160:163], v[180:183]
  ds_write_b128 v2, v[120:123] offset:7168
  v_mfma_f32_16x16x32_bf16 v[168:171], v[68:71], v[124:127], 0
  v_mfma_f32_16x16x32_bf16 v[184:187], v[68:71], v[148:151], 0
  v_mfma_f32_16x16x32_bf16 v[168:171], v[72:75], v[136:139], v[168:171]
  v_mfma_f32_16x16x32_bf16 v[184:187], v[72:75], v[152:155], v[184:187]
  v_mfma_f32_16x16x32_bf16 v[168:171], v[196:199], v[140:143], v[168:171]
  v_mfma_f32_16x16x32_bf16 v[184:187], v[196:199], v[156:159], v[184:187]
  v_mfma_f32_16x16x32_bf16 v[168:171], v[200:203], v[144:147], v[168:171]
  v_mfma_f32_16x16x32_bf16 v[184:187], v[200:203], v[160:163], v[184:187]
  v_xor_b32 v2, 0x2000, v2
  s_waitcnt lgkmcnt(0)
  s_barrier
  v_mfma_f32_16x16x32_bf16 v[172:175], v[128:131], v[124:127], 0
  ds_read_b128 v[76:79], v2 offset:0
  v_mfma_f32_16x16x32_bf16 v[188:191], v[128:131], v[148:151], 0
  ds_read_b128 v[108:111], v2 offset:4096
  v_mfma_f32_16x16x32_bf16 v[172:175], v[132:135], v[136:139], v[172:175]
  ds_read_b128 v[80:83], v2 offset:1024
  v_mfma_f32_16x16x32_bf16 v[188:191], v[132:135], v[152:155], v[188:191]
  ds_read_b128 v[112:115], v2 offset:5120
  v_mfma_f32_16x16x32_bf16 v[172:175], v[204:207], v[140:143], v[172:175]
  ds_read_b128 v[84:87], v2 offset:2048
  v_mfma_f32_16x16x32_bf16 v[188:191], v[204:207], v[156:159], v[188:191]
  ds_read_b128 v[116:119], v2 offset:6144
  v_mfma_f32_16x16x32_bf16 v[172:175], v[208:211], v[144:147], v[172:175]
  ds_read_b128 v[88:91], v2 offset:3072
  v_mfma_f32_16x16x32_bf16 v[188:191], v[208:211], v[160:163], v[188:191]
  ds_read_b128 v[120:123], v2 offset:7168
  s_waitcnt vmcnt(3)
  v_sub_f32 v36, 1.0, v12
  v_sub_f32 v37, 1.0, v13
  v_cvt_pk_bf16_f32 v37, v36, v37
  v_lshlrev_b32 v36, 16, v37
  v_and_b32 v37, 0xffff0000, v37
  v_sub_f32 v38, 1.0, v14
  v_sub_f32 v39, 1.0, v15
  v_cvt_pk_bf16_f32 v39, v38, v39
  v_lshlrev_b32 v38, 16, v39
  v_and_b32 v39, 0xffff0000, v39
  s_waitcnt lgkmcnt(7)
  v_pk_add_f32 v[40:41], v[40:41], v[76:77]
  v_pk_mul_f32 v[164:165], v[12:13], v[164:165]
  v_pk_fma_f32 v[40:41], v[36:37], v[40:41], v[164:165]
  s_waitcnt lgkmcnt(6)
  v_pk_add_f32 v[92:93], v[92:93], v[108:109]
  v_pk_mul_f32 v[180:181], v[12:13], v[180:181]
  v_pk_fma_f32 v[92:93], v[36:37], v[92:93], v[180:181]
  buffer_store_dword v40, v26, s[44:47], s17 offen offset:0
  buffer_store_dword v92, v26, s[44:47], s17 offen offset:1024
  s_add_u32 s17, s17, 65536
  buffer_store_dword v41, v26, s[44:47], s17 offen offset:0
  buffer_store_dword v93, v26, s[44:47], s17 offen offset:1024
  s_add_u32 s17, s17, 65536
  v_pk_add_f32 v[42:43], v[42:43], v[78:79]
  v_pk_mul_f32 v[166:167], v[14:15], v[166:167]
  v_pk_fma_f32 v[42:43], v[38:39], v[42:43], v[166:167]
  v_pk_add_f32 v[94:95], v[94:95], v[110:111]
  v_pk_mul_f32 v[182:183], v[14:15], v[182:183]
  v_pk_fma_f32 v[94:95], v[38:39], v[94:95], v[182:183]
  buffer_store_dword v42, v26, s[44:47], s17 offen offset:0
  buffer_store_dword v94, v26, s[44:47], s17 offen offset:1024
  s_add_u32 s17, s17, 65536
  buffer_store_dword v43, v26, s[44:47], s17 offen offset:0
  buffer_store_dword v95, v26, s[44:47], s17 offen offset:1024
  s_add_u32 s17, s17, 851968
  v_mfma_f32_16x16x32_bf16 v[176:179], v[212:215], v[124:127], 0
  v_mfma_f32_16x16x32_bf16 v[192:195], v[212:215], v[148:151], 0
  v_mfma_f32_16x16x32_bf16 v[176:179], v[216:219], v[136:139], v[176:179]
  v_mfma_f32_16x16x32_bf16 v[192:195], v[216:219], v[152:155], v[192:195]
  v_mfma_f32_16x16x32_bf16 v[176:179], v[220:223], v[140:143], v[176:179]
  v_mfma_f32_16x16x32_bf16 v[192:195], v[220:223], v[156:159], v[192:195]
  v_mfma_f32_16x16x32_bf16 v[176:179], v[224:227], v[144:147], v[176:179]
  v_mfma_f32_16x16x32_bf16 v[192:195], v[224:227], v[160:163], v[192:195]
  s_waitcnt vmcnt(10)
  v_sub_f32 v36, 1.0, v16
  v_sub_f32 v37, 1.0, v17
  v_cvt_pk_bf16_f32 v37, v36, v37
  v_lshlrev_b32 v36, 16, v37
  v_and_b32 v37, 0xffff0000, v37
  v_sub_f32 v38, 1.0, v18
  v_sub_f32 v39, 1.0, v19
  v_cvt_pk_bf16_f32 v39, v38, v39
  v_lshlrev_b32 v38, 16, v39
  v_and_b32 v39, 0xffff0000, v39
  s_waitcnt lgkmcnt(5)
  v_pk_add_f32 v[44:45], v[44:45], v[80:81]
  v_pk_mul_f32 v[168:169], v[16:17], v[168:169]
  v_pk_fma_f32 v[44:45], v[36:37], v[44:45], v[168:169]
  s_waitcnt lgkmcnt(4)
  v_pk_add_f32 v[96:97], v[96:97], v[112:113]
  v_pk_mul_f32 v[184:185], v[16:17], v[184:185]
  v_pk_fma_f32 v[96:97], v[36:37], v[96:97], v[184:185]
  buffer_store_dword v44, v26, s[44:47], s17 offen offset:0
  buffer_store_dword v96, v26, s[44:47], s17 offen offset:1024
  s_add_u32 s17, s17, 65536
  buffer_store_dword v45, v26, s[44:47], s17 offen offset:0
  buffer_store_dword v97, v26, s[44:47], s17 offen offset:1024
  s_add_u32 s17, s17, 65536
  v_pk_add_f32 v[46:47], v[46:47], v[82:83]
  v_pk_mul_f32 v[170:171], v[18:19], v[170:171]
  v_pk_fma_f32 v[46:47], v[38:39], v[46:47], v[170:171]
  v_pk_add_f32 v[98:99], v[98:99], v[114:115]
  v_pk_mul_f32 v[186:187], v[18:19], v[186:187]
  v_pk_fma_f32 v[98:99], v[38:39], v[98:99], v[186:187]
  buffer_store_dword v46, v26, s[44:47], s17 offen offset:0
  buffer_store_dword v98, v26, s[44:47], s17 offen offset:1024
  s_add_u32 s17, s17, 65536
  buffer_store_dword v47, v26, s[44:47], s17 offen offset:0
  buffer_store_dword v99, v26, s[44:47], s17 offen offset:1024
  s_add_u32 s17, s17, 851968
  s_waitcnt vmcnt(17)
  v_sub_f32 v36, 1.0, v20
  v_sub_f32 v37, 1.0, v21
  v_cvt_pk_bf16_f32 v37, v36, v37
  v_lshlrev_b32 v36, 16, v37
  v_and_b32 v37, 0xffff0000, v37
  v_sub_f32 v38, 1.0, v22
  v_sub_f32 v39, 1.0, v23
  v_cvt_pk_bf16_f32 v39, v38, v39
  v_lshlrev_b32 v38, 16, v39
  v_and_b32 v39, 0xffff0000, v39
  s_waitcnt lgkmcnt(3)
  v_pk_add_f32 v[48:49], v[48:49], v[84:85]
  v_pk_mul_f32 v[172:173], v[20:21], v[172:173]
  v_pk_fma_f32 v[48:49], v[36:37], v[48:49], v[172:173]
  s_waitcnt lgkmcnt(2)
  v_pk_add_f32 v[100:101], v[100:101], v[116:117]
  v_pk_mul_f32 v[188:189], v[20:21], v[188:189]
  v_pk_fma_f32 v[100:101], v[36:37], v[100:101], v[188:189]
  buffer_store_dword v48, v26, s[44:47], s17 offen offset:0
  buffer_store_dword v100, v26, s[44:47], s17 offen offset:1024
  s_add_u32 s17, s17, 65536
  buffer_store_dword v49, v26, s[44:47], s17 offen offset:0
  buffer_store_dword v101, v26, s[44:47], s17 offen offset:1024
  s_add_u32 s17, s17, 65536
  v_pk_add_f32 v[50:51], v[50:51], v[86:87]
  v_pk_mul_f32 v[174:175], v[22:23], v[174:175]
  v_pk_fma_f32 v[50:51], v[38:39], v[50:51], v[174:175]
  v_pk_add_f32 v[102:103], v[102:103], v[118:119]
  v_pk_mul_f32 v[190:191], v[22:23], v[190:191]
  v_pk_fma_f32 v[102:103], v[38:39], v[102:103], v[190:191]
  buffer_store_dword v50, v26, s[44:47], s17 offen offset:0
  buffer_store_dword v102, v26, s[44:47], s17 offen offset:1024
  s_add_u32 s17, s17, 65536
  buffer_store_dword v51, v26, s[44:47], s17 offen offset:0
  buffer_store_dword v103, v26, s[44:47], s17 offen offset:1024
  s_add_u32 s17, s17, 851968
  s_waitcnt vmcnt(24)
  v_sub_f32 v36, 1.0, v32
  v_sub_f32 v37, 1.0, v33
  v_cvt_pk_bf16_f32 v37, v36, v37
  v_lshlrev_b32 v36, 16, v37
  v_and_b32 v37, 0xffff0000, v37
  v_sub_f32 v38, 1.0, v34
  v_sub_f32 v39, 1.0, v35
  v_cvt_pk_bf16_f32 v39, v38, v39
  v_lshlrev_b32 v38, 16, v39
  v_and_b32 v39, 0xffff0000, v39
  s_waitcnt lgkmcnt(1)
  v_pk_add_f32 v[52:53], v[52:53], v[88:89]
  v_pk_mul_f32 v[176:177], v[32:33], v[176:177]
  v_pk_fma_f32 v[52:53], v[36:37], v[52:53], v[176:177]
  s_waitcnt lgkmcnt(0)
  v_pk_add_f32 v[104:105], v[104:105], v[120:121]
  v_pk_mul_f32 v[192:193], v[32:33], v[192:193]
  v_pk_fma_f32 v[104:105], v[36:37], v[104:105], v[192:193]
  buffer_store_dword v52, v26, s[44:47], s17 offen offset:0
  buffer_store_dword v104, v26, s[44:47], s17 offen offset:1024
  s_add_u32 s17, s17, 65536
  buffer_store_dword v53, v26, s[44:47], s17 offen offset:0
  buffer_store_dword v105, v26, s[44:47], s17 offen offset:1024
  s_add_u32 s17, s17, 65536
  v_pk_add_f32 v[54:55], v[54:55], v[90:91]
  v_pk_mul_f32 v[178:179], v[34:35], v[178:179]
  v_pk_fma_f32 v[54:55], v[38:39], v[54:55], v[178:179]
  v_pk_add_f32 v[106:107], v[106:107], v[122:123]
  v_pk_mul_f32 v[194:195], v[34:35], v[194:195]
  v_pk_fma_f32 v[106:107], v[38:39], v[106:107], v[194:195]
  buffer_store_dword v54, v26, s[44:47], s17 offen offset:0
  buffer_store_dword v106, v26, s[44:47], s17 offen offset:1024
  s_add_u32 s17, s17, 65536
  buffer_store_dword v55, v26, s[44:47], s17 offen offset:0
  buffer_store_dword v107, v26, s[44:47], s17 offen offset:1024
gated_mix__spectral_gfnet__ssm_conv_s5__prompt_kernel_end:
  s_endpgm
.section .rodata,"a"
.p2align 6
.amdhsa_kernel gated_mix__spectral_gfnet__ssm_conv_s5__prompt_kernel
  .amdhsa_next_free_vgpr 508
  .amdhsa_next_free_sgpr 102
  .amdhsa_accum_offset 252
  .amdhsa_group_segment_fixed_size 0
  .amdhsa_kernarg_size 128
  .amdhsa_user_sgpr_count 2
  .amdhsa_user_sgpr_kernarg_segment_ptr 1
  .amdhsa_system_sgpr_workgroup_id_x 1
  .amdhsa_float_denorm_mode_32 3
.end_amdhsa_kernel
```

```asm
; @launch grid=(256,1,1) block=(256,1,1) lds=163840
.amdgcn_target "amdgcn-amd-amdhsa--gfx950"
.text
.p2align 8
.globl gated_mix__spectral_gfnet__ssm_conv_s5__prompt_kernel
.type gated_mix__spectral_gfnet__ssm_conv_s5__prompt_kernel,@function
gated_mix__spectral_gfnet__ssm_conv_s5__prompt_kernel:
  s_cmp_ge_u32 s2, 256
  s_cbranch_scc1 gated_mix__spectral_gfnet__ssm_conv_s5__prompt_kernel_end
  s_load_dwordx16 s[4:19], s[0:1], 0
  s_load_dwordx16 s[20:35], s[0:1], 64
  s_getpc_b64 s[36:37]
gated_mix__spectral_gfnet__ssm_conv_s5__prompt_kernel_pc1:
  s_lshr_b32 s3, s2, 3
  s_mul_i32 s3, s3, 1280
  s_add_u32 s3, s3, 0
  v_min_u32 v2, 9, v0
  v_lshl_add_u32 v2, v2, 7, s3
  v_min_u32 v2, gated_mix__spectral_gfnet__ssm_conv_s5__prompt_kernel_end-gated_mix__spectral_gfnet__ssm_conv_s5__prompt_kernel_pc1, v2
  v_mov_b32 v3, s37
  v_add_co_u32 v2, vcc, s36, v2
  s_nop 1
  v_addc_co_u32 v3, vcc, 0, v3, vcc
  v_lshrrev_b32 v4, 6, v0
  s_nop 0
  v_readfirstlane_b32 s3, v4
  v_and_b32 v4, 63, v0
  v_and_b32 v5, 15, v0
  v_bfe_u32 v6, v0, 4, 2
  s_and_b32 s36, s2, 7
  s_lshr_b32 s37, s2, 3
  s_and_b32 s41, s37, 3
  s_lshr_b32 s37, s37, 2
  s_lshl_b32 s40, s36, 3
  s_add_u32 s40, s40, s37
  s_and_b32 s38, s36, 3
  s_lshl_b32 s38, s38, 2
  s_add_u32 s38, s38, s41
  s_lshr_b32 s39, s36, 2
  s_lshl_b32 s39, s39, 3
  s_add_u32 s39, s39, s37
  s_and_b32 s42, s36, 1
  s_lshl_b32 s42, s42, 3
  s_add_u32 s42, s42, s37
  s_lshr_b32 s43, s36, 1
  s_lshl_b32 s43, s43, 2
  s_add_u32 s43, s43, s41
  s_cmp_lg_u32 s3, 0
  s_cbranch_scc1 gated_mix__spectral_gfnet__ssm_conv_s5__prompt_kernel_skip2
  global_load_dword v1, v[2:3], off
gated_mix__spectral_gfnet__ssm_conv_s5__prompt_kernel_skip2:
  s_waitcnt lgkmcnt(0)
  s_mov_b32 s44, s4
  s_mov_b32 s45, s5
  s_mov_b32 s46, 4194304
  s_mov_b32 s47, 0x20000
  v_bfe_u32 v3, v4, 1, 2
  v_xor_b32 v3, v3, v6
  v_lshlrev_b32 v2, 9, v3
  v_and_b32 v3, 1, v4
  v_lshl_or_b32 v2, v3, 4, v2
  v_lshrrev_b32 v3, 3, v4
  v_lshl_or_b32 v2, v3, 15, v2
  s_lshl_b32 s4, s42, 11
  s_lshl_b32 m0, s43, 5
  s_add_u32 s4, s4, m0
  s_lshl_b32 m0, s3, 20
  s_add_u32 s4, s4, m0
  s_lshl_b32 m0, s3, 12
  s_add_u32 m0, m0, 131072
  s_nop 0
  buffer_load_dwordx4 v2, s[44:47], s4 offen offset:0 lds
  s_add_u32 s4, s4, 261120
  buffer_load_dwordx4 v2, s[44:47], s4 offen offset:1024 lds
  s_add_u32 s4, s4, 261120
  buffer_load_dwordx4 v2, s[44:47], s4 offen offset:2048 lds
  s_add_u32 s4, s4, 261120
  buffer_load_dwordx4 v2, s[44:47], s4 offen offset:3072 lds
  s_add_u32 s48, s34, 20316160
  s_addc_u32 s49, s35, 0
  s_mov_b32 s50, 40960
  s_mov_b32 s51, 0x20000
  s_mov_b32 s52, s32
  s_mov_b32 s53, s33
  s_mov_b32 s54, 256
  s_mov_b32 s55, 0x20000
  v_mov_b32 v2, 0
  v_lshlrev_b32 v3, 4, v0
  s_cmp_lg_u32 s2, 0
  s_cbranch_scc1 gated_mix__spectral_gfnet__ssm_conv_s5__prompt_kernel_skip3
  v_mov_b32 v8, 0
  v_mov_b32 v9, 0
  v_mov_b32 v10, 0
  v_mov_b32 v11, 0
  buffer_store_dwordx4 v[8:11], v3, s[48:51], 0 offen sc1
  s_mov_b32 s4, 4096
  buffer_store_dwordx4 v[8:11], v3, s[48:51], s4 offen sc1
gated_mix__spectral_gfnet__ssm_conv_s5__prompt_kernel_skip3:
  s_bitcmp1_b32 s3, 0
  s_cselect_b32 s56, s18, s16
  s_cselect_b32 s57, s19, s17
  s_mov_b32 s58, 2097152
  s_mov_b32 s59, 0x20000
  v_lshrrev_b32 v24, 5, v4
  v_lshlrev_b32 v24, 5, v24
  v_bfe_u32 v25, v4, 3, 1
  v_lshl_or_b32 v24, v25, 4, v24
  v_bfe_u32 v25, v4, 4, 1
  v_or_b32 v24, v24, v25
  v_lshlrev_b32 v24, 11, v24
  v_lshrrev_b32 v25, 3, v4
  v_lshlrev_b32 v25, 11, v25
  v_and_b32 v26, 7, v4
  v_xor_b32 v26, v26, v6
  v_lshlrev_b32 v26, 4, v26
  v_or_b32 v24, v24, v26
  v_or_b32 v25, v25, v26
  v_xor_b32 v8, 0, v24
  v_add_u32 v8, 0, v8
  v_xor_b32 v12, 0, v25
  v_add_u32 v12, 0, v12
  v_xor_b32 v9, 64, v24
  v_add_u32 v9, 3072, v9
  v_xor_b32 v13, 64, v25
  v_add_u32 v13, 15360, v13
  v_xor_b32 v10, 0, v24
  v_add_u32 v10, 6144, v10
  v_xor_b32 v14, 0, v25
  v_add_u32 v14, 30720, v14
  v_xor_b32 v11, 64, v24
  v_add_u32 v11, 9216, v11
  v_xor_b32 v15, 64, v25
  v_add_u32 v15, 46080, v15
  s_lshl_b32 s10, s38, 18
  s_lshr_b32 s18, s3, 1
  s_lshl_b32 s16, s18, 17
  s_add_u32 s10, s10, s16
  s_lshl_b32 s11, s39, 17
  s_lshl_b32 s16, s18, 16
  s_add_u32 s11, s11, s16
  s_and_b32 s18, s3, 1
  s_lshl_b32 s18, s18, 14
  s_add_u32 s10, s10, s18
  s_lshl_b32 s18, s3, 12
  s_add_u32 s16, s18, 0
  s_add_u32 s17, s18, 65536
  v_and_b32 v24, 31, v4
  v_lshlrev_b32 v24, 7, v24
  v_bfe_u32 v25, v4, 1, 3
  v_lshrrev_b32 v26, 5, v4
  v_xor_b32 v25, v25, v26
  v_lshl_or_b32 v24, v25, 4, v24
  s_lshr_b32 s18, s3, 1
  s_lshl_b32 s18, s18, 13
  s_add_u32 s18, s18, 0
  v_add_u32 v25, s18, v24
  s_and_b32 s18, s3, 1
  s_lshl_b32 s18, s18, 13
  s_add_u32 s18, s18, 65536
  v_add_u32 v26, s18, v24
  v_xor_b32 v16, 0, v25
  v_xor_b32 v20, 0, v26
  v_xor_b32 v17, 32, v25
  v_xor_b32 v21, 32, v26
  v_xor_b32 v18, 64, v25
  v_xor_b32 v22, 64, v26
  v_xor_b32 v19, 96, v25
  v_xor_b32 v23, 96, v26
  v_add_u32 v8, s10, v8
  v_add_u32 v12, s11, v12
  v_add_u32 v9, s10, v9
  v_add_u32 v13, s11, v13
  v_add_u32 v10, s10, v10
  v_add_u32 v14, s11, v14
  v_add_u32 v11, s10, v11
  v_add_u32 v15, s11, v15
  s_add_u32 s10, s38, 0
  s_and_b32 s10, s10, 15
  s_lshl_b32 s10, s10, 7
  s_and_b32 s4, s2, 7
  s_lshl_b32 s4, s4, 9
  s_lshr_b32 s5, s2, 3
  s_lshl_b32 s5, s5, 4
  s_add_u32 s4, s4, s5
  v_mov_b32 v24, s4
  s_lshl_b32 s4, s2, 7
  v_mov_b32 v25, s4
  s_mov_b32 s4, 4096
  s_mov_b32 s5, 8192
  v_mov_b32 v7, 1
  s_mov_b32 s60, s28
  s_mov_b32 s61, s29
  s_mov_b32 s62, 2048
  s_mov_b32 s63, 0x20000
  s_mov_b32 s64, s12
  s_mov_b32 s65, s13
  s_mov_b32 s66, 2048
  s_mov_b32 s67, 0x20000
  s_mov_b32 s68, s14
  s_mov_b32 s69, s15
  s_mov_b32 s70, 2048
  s_mov_b32 s71, 0x20000
  s_mov_b32 s72, s24
  s_mov_b32 s73, s25
  s_mov_b32 s74, 2048
  s_mov_b32 s75, 0x20000
  s_mov_b32 s76, s26
  s_mov_b32 s77, s27
  s_mov_b32 s78, 2048
  s_mov_b32 s79, 0x20000
  s_lshl_b32 s15, s40, 2
  s_add_u32 s15, s15, s41
  s_cmp_eq_u32 s15, 3
  s_cselect_b32 s12, 1, s41
  s_cselect_b32 s13, 64, s40
  s_and_b32 s14, s15, 0xfd
  s_cmp_eq_u32 s14, 0
  s_cselect_b32 s14, 1, 0
  s_and_b32 s18, s42, 7
  s_lshl_b32 s18, s18, 1
  s_lshr_b32 s19, s42, 3
  s_add_u32 s18, s18, s19
  v_cvt_f32_u32 v57, v5
  v_cvt_f32_u32 v58, v6
  v_mul_f32 v58, 4.0, v58
  s_cmp_lg_u32 s3, 0
  s_cbranch_scc1 gated_mix__spectral_gfnet__ssm_conv_s5__prompt_kernel_skip4
  v_cvt_f32_u32 v86, s14
  v_mul_f32 v86, 0xc4700000, v86
  v_cmp_lt_u32 vcc, 7, v5
  v_cvt_f32_u32 v85, s13
  s_nop 0
  v_cndmask_b32 v86, 0, v86, vcc
  v_add_f32 v85, v85, v86
  v_fmamk_f32 v59, v57, 0x43000000, v85
  v_mul_f32 v59, 0x3a000000, v59
  v_mul_f32 v84, v59, v58
  v_fmamk_f32 v76, v59, 0x0, v84
  v_fmamk_f32 v77, v59, 0x3f800000, v84
  v_fmamk_f32 v78, v59, 0x40000000, v84
  v_fmamk_f32 v79, v59, 0x40400000, v84
  v_cos_f32 v80, v76
  v_cos_f32 v81, v77
  v_cos_f32 v82, v78
  v_cos_f32 v83, v79
  v_sin_f32 v76, v76
  v_sin_f32 v77, v77
  v_sin_f32 v78, v78
  v_sin_f32 v79, v79
  v_cvt_pk_bf16_f32 v60, v80, v76
  v_cvt_pk_bf16_f32 v64, -v76, v80
  v_cvt_pk_bf16_f32 v61, v81, v77
  v_cvt_pk_bf16_f32 v65, -v77, v81
  v_cvt_pk_bf16_f32 v62, v82, v78
  v_cvt_pk_bf16_f32 v66, -v78, v82
  v_cvt_pk_bf16_f32 v63, v83, v79
  v_cvt_pk_bf16_f32 v67, -v79, v83
  v_xor_b32 v85, 3, v5
  v_cndmask_b32 v85, v5, v85, vcc
  v_cvt_f32_u32 v59, v85
  v_mul_f32 v59, 0x3d800000, v59
  v_mul_f32 v84, v59, v58
  v_fmamk_f32 v76, v59, 0x0, v84
  v_fmamk_f32 v77, v59, 0x3f800000, v84
  v_fmamk_f32 v78, v59, 0x40000000, v84
  v_fmamk_f32 v79, v59, 0x40400000, v84
  v_cos_f32 v80, v76
  v_cos_f32 v81, v77
  v_cos_f32 v82, v78
  v_cos_f32 v83, v79
  v_sin_f32 v76, v76
  v_sin_f32 v77, v77
  v_sin_f32 v78, v78
  v_sin_f32 v79, v79
  v_cvt_pk_bf16_f32 v68, v80, v76
  v_cvt_pk_bf16_f32 v72, -v76, v80
  v_cvt_pk_bf16_f32 v69, v81, v77
  v_cvt_pk_bf16_f32 v73, -v77, v81
  v_cvt_pk_bf16_f32 v70, v82, v78
  v_cvt_pk_bf16_f32 v74, -v78, v82
  v_cvt_pk_bf16_f32 v71, v83, v79
  v_cvt_pk_bf16_f32 v75, -v79, v83
  s_cmp_eq_u32 s14, 0
  s_cbranch_scc1 gated_mix__spectral_gfnet__ssm_conv_s5__prompt_kernel_skip5
  v_cndmask_b32 v85, 0, 16, vcc
  v_and_b32 v60, 0xffff, v60
  v_lshlrev_b32 v60, v85, v60
  v_and_b32 v61, 0xffff, v61
  v_lshlrev_b32 v61, v85, v61
  v_and_b32 v62, 0xffff, v62
  v_lshlrev_b32 v62, v85, v62
  v_and_b32 v63, 0xffff, v63
  v_lshlrev_b32 v63, v85, v63
  v_and_b32 v64, 0xffff, v64
  v_lshlrev_b32 v64, v85, v64
  v_and_b32 v65, 0xffff, v65
  v_lshlrev_b32 v65, v85, v65
  v_and_b32 v66, 0xffff, v66
  v_lshlrev_b32 v66, v85, v66
  v_and_b32 v67, 0xffff, v67
  v_lshlrev_b32 v67, v85, v67
  v_cmp_eq_u32 vcc, 0, v5
  v_mov_b32 v85, 0x3f80
  s_nop 0
  v_cndmask_b32 v64, v64, v85, vcc
  v_mov_b32 v85, 0xbf80
  v_cndmask_b32 v65, v65, v85, vcc
  v_mov_b32 v85, 0x3f80
  v_cndmask_b32 v66, v66, v85, vcc
  v_mov_b32 v85, 0xbf80
  v_cndmask_b32 v67, v67, v85, vcc
gated_mix__spectral_gfnet__ssm_conv_s5__prompt_kernel_skip5:
gated_mix__spectral_gfnet__ssm_conv_s5__prompt_kernel_skip4:
  s_cmp_lg_u32 s3, 1
  s_cbranch_scc1 gated_mix__spectral_gfnet__ssm_conv_s5__prompt_kernel_skip6
  v_cvt_f32_u32 v86, s14
  v_mul_f32 v86, 0xc4700000, v86
  v_cmp_lt_u32 vcc, 1, v6
  v_cvt_f32_u32 v85, s13
  s_nop 0
  v_cndmask_b32 v86, 0, v86, vcc
  v_add_f32 v85, v85, v86
  v_fmamk_f32 v85, v58, 0x43000000, v85
  v_mul_f32 v84, v85, v57
  v_mul_f32 v84, 0x3a000000, v84
  v_mul_f32 v59, 0x3d800000, v57
  v_fmamk_f32 v76, v59, 0x0, v84
  v_fmamk_f32 v77, v59, 0x3f800000, v84
  v_fmamk_f32 v78, v59, 0x40000000, v84
  v_fmamk_f32 v79, v59, 0x40400000, v84
  v_cos_f32 v80, v76
  v_cos_f32 v81, v77
  v_cos_f32 v82, v78
  v_cos_f32 v83, v79
  v_sin_f32 v76, v76
  v_sin_f32 v77, v77
  v_sin_f32 v78, v78
  v_sin_f32 v79, v79
  v_cvt_pk_bf16_f32 v60, v80, -v76
  v_cvt_pk_bf16_f32 v64, v76, v80
  v_cvt_pk_bf16_f32 v61, v81, -v77
  v_cvt_pk_bf16_f32 v65, v77, v81
  v_cvt_pk_bf16_f32 v62, v82, -v78
  v_cvt_pk_bf16_f32 v66, v78, v82
  v_cvt_pk_bf16_f32 v63, v83, -v79
  v_cvt_pk_bf16_f32 v67, v79, v83
  v_add_f32 v85, 0x40400000, v58
  v_cndmask_b32 v85, v58, v85, vcc
  v_mul_f32 v84, v59, v85
  v_cndmask_b32 v59, v59, -v59, vcc
  v_fmamk_f32 v76, v59, 0x0, v84
  v_fmamk_f32 v77, v59, 0x3f800000, v84
  v_fmamk_f32 v78, v59, 0x40000000, v84
  v_fmamk_f32 v79, v59, 0x40400000, v84
  v_cos_f32 v80, v76
  v_cos_f32 v81, v77
  v_cos_f32 v82, v78
  v_cos_f32 v83, v79
  v_sin_f32 v76, v76
  v_sin_f32 v77, v77
  v_sin_f32 v78, v78
  v_sin_f32 v79, v79
  v_cvt_pk_bf16_f32 v68, v80, -v76
  v_cvt_pk_bf16_f32 v72, v76, v80
  v_cvt_pk_bf16_f32 v69, v81, -v77
  v_cvt_pk_bf16_f32 v73, v77, v81
  v_cvt_pk_bf16_f32 v70, v82, -v78
  v_cvt_pk_bf16_f32 v74, v78, v82
  v_cvt_pk_bf16_f32 v71, v83, -v79
  v_cvt_pk_bf16_f32 v75, v79, v83
  s_cmp_eq_u32 s14, 0
  s_cbranch_scc1 gated_mix__spectral_gfnet__ssm_conv_s5__prompt_kernel_skip7
  v_lshlrev_b32 v85, 16, v60
  v_and_b32 v86, 0xffff0000, v60
  v_add_f32 v85, v85, v85
  v_add_f32 v86, v86, v86
  v_cvt_pk_bf16_f32 v85, v85, v86
  v_cndmask_b32 v60, v85, 0, vcc
  v_cndmask_b32 v64, 0, v85, vcc
  v_lshlrev_b32 v85, 16, v61
  v_and_b32 v86, 0xffff0000, v61
  v_add_f32 v85, v85, v85
  v_add_f32 v86, v86, v86
  v_cvt_pk_bf16_f32 v85, v85, v86
  v_cndmask_b32 v61, v85, 0, vcc
  v_cndmask_b32 v65, 0, v85, vcc
  v_lshlrev_b32 v85, 16, v62
  v_and_b32 v86, 0xffff0000, v62
  v_add_f32 v85, v85, v85
  v_add_f32 v86, v86, v86
  v_cvt_pk_bf16_f32 v85, v85, v86
  v_cndmask_b32 v62, v85, 0, vcc
  v_cndmask_b32 v66, 0, v85, vcc
  v_lshlrev_b32 v85, 16, v63
  v_and_b32 v86, 0xffff0000, v63
  v_add_f32 v85, v85, v85
  v_add_f32 v86, v86, v86
  v_cvt_pk_bf16_f32 v85, v85, v86
  v_cndmask_b32 v63, v85, 0, vcc
  v_cndmask_b32 v67, 0, v85, vcc
  v_lshlrev_b32 v85, 31, v5
  v_or_b32 v85, 0x3f803f80, v85
  v_cmp_eq_u32 vcc, 0, v6
  s_nop 1
  v_cndmask_b32 v60, v60, v85, vcc
gated_mix__spectral_gfnet__ssm_conv_s5__prompt_kernel_skip7:
gated_mix__spectral_gfnet__ssm_conv_s5__prompt_kernel_skip6:
  s_cmp_lg_u32 s3, 2
  s_cbranch_scc1 gated_mix__spectral_gfnet__ssm_conv_s5__prompt_kernel_skip8
  v_cvt_f32_u32 v86, s12
  v_fma_f32 v85, v57, 4.0, v86
  v_mul_f32 v59, 0x3c800000, v85
  v_mul_f32 v84, v59, v58
  v_fmamk_f32 v76, v59, 0x0, v84
  v_fmamk_f32 v77, v59, 0x3f800000, v84
  v_fmamk_f32 v78, v59, 0x40000000, v84
  v_fmamk_f32 v79, v59, 0x40400000, v84
  v_cos_f32 v80, v76
  v_cos_f32 v81, v77
  v_cos_f32 v82, v78
  v_cos_f32 v83, v79
  v_sin_f32 v76, v76
  v_sin_f32 v77, v77
  v_sin_f32 v78, v78
  v_sin_f32 v79, v79
  v_cvt_pk_bf16_f32 v60, v80, v76
  v_cvt_pk_bf16_f32 v64, -v76, v80
  v_cvt_pk_bf16_f32 v61, v81, v77
  v_cvt_pk_bf16_f32 v65, -v77, v81
  v_cvt_pk_bf16_f32 v62, v82, v78
  v_cvt_pk_bf16_f32 v66, -v78, v82
  v_cvt_pk_bf16_f32 v63, v83, v79
  v_cvt_pk_bf16_f32 v67, -v79, v83
  v_mul_f32 v59, 0x3d800000, v59
  v_mul_f32 v84, 0x3d800000, v84
  v_fmamk_f32 v76, v59, 0x0, v84
  v_fmamk_f32 v77, v59, 0x3f800000, v84
  v_fmamk_f32 v78, v59, 0x40000000, v84
  v_fmamk_f32 v79, v59, 0x40400000, v84
  v_cos_f32 v68, v76
  v_cos_f32 v69, v77
  v_cos_f32 v70, v78
  v_cos_f32 v71, v79
  v_sin_f32 v72, v76
  v_sin_f32 v73, v77
  v_sin_f32 v74, v78
  v_sin_f32 v75, v79
gated_mix__spectral_gfnet__ssm_conv_s5__prompt_kernel_skip8:
  s_cmp_lg_u32 s3, 3
  s_cbranch_scc1 gated_mix__spectral_gfnet__ssm_conv_s5__prompt_kernel_skip9
  v_cvt_f32_u32 v86, s12
  v_fma_f32 v85, v58, 4.0, v86
  v_mul_f32 v84, v85, v57
  v_mul_f32 v84, 0x3c800000, v84
  v_mul_f32 v59, 0x3d800000, v57
  v_fmamk_f32 v76, v59, 0x0, v84
  v_fmamk_f32 v77, v59, 0x3f800000, v84
  v_fmamk_f32 v78, v59, 0x40000000, v84
  v_fmamk_f32 v79, v59, 0x40400000, v84
  v_cos_f32 v80, v76
  v_cos_f32 v81, v77
  v_cos_f32 v82, v78
  v_cos_f32 v83, v79
  v_sin_f32 v76, v76
  v_sin_f32 v77, v77
  v_sin_f32 v78, v78
  v_sin_f32 v79, v79
  v_cvt_pk_bf16_f32 v60, v80, -v76
  v_cvt_pk_bf16_f32 v64, v76, v80
  v_cvt_pk_bf16_f32 v61, v81, -v77
  v_cvt_pk_bf16_f32 v65, v77, v81
  v_cvt_pk_bf16_f32 v62, v82, -v78
  v_cvt_pk_bf16_f32 v66, v78, v82
  v_cvt_pk_bf16_f32 v63, v83, -v79
  v_cvt_pk_bf16_f32 v67, v79, v83
  v_mul_f32 v59, 0x3d800000, v59
  v_mul_f32 v84, 0x3d800000, v84
  v_fmamk_f32 v76, v59, 0x0, v84
  v_fmamk_f32 v77, v59, 0x3f800000, v84
  v_fmamk_f32 v78, v59, 0x40000000, v84
  v_fmamk_f32 v79, v59, 0x40400000, v84
  v_cos_f32 v68, v76
  v_cos_f32 v69, v77
  v_cos_f32 v70, v78
  v_cos_f32 v71, v79
  v_sin_f32 v72, v76
  v_sin_f32 v73, v77
  v_sin_f32 v74, v78
  v_sin_f32 v75, v79
  v_mul_f32 v68, 0x35800000, v68
  v_mul_f32 v69, 0x35800000, v69
  v_mul_f32 v70, 0x35800000, v70
  v_mul_f32 v71, 0x35800000, v71
  v_mul_f32 v72, 0x35800000, v72
  v_mul_f32 v73, 0x35800000, v73
  v_mul_f32 v74, 0x35800000, v74
  v_mul_f32 v75, 0x35800000, v75
gated_mix__spectral_gfnet__ssm_conv_s5__prompt_kernel_skip9:
  s_lshl_b32 s27, s3, 12
  s_add_u32 s27, s27, 147456
  v_lshl_add_u32 v85, v4, 4, s27
  ds_write_b128 v85, v[60:63] offset:0
  ds_write_b128 v85, v[64:67] offset:1024
  ds_write_b128 v85, v[68:71] offset:2048
  ds_write_b128 v85, v[72:75] offset:3072
  s_add_u32 m0, s17, 0
  s_nop 0
  buffer_load_dwordx4 v12, s[56:59], s10 offen offset:0 lds
  s_lshl_b32 s27, s3, 4
  v_add_u32 v109, s27, v5
  v_cvt_f32_u32 v57, v109
  v_mul_f32 v57, 0x3c000000, v57
  v_lshrrev_b32 v59, 1, v6
  v_lshlrev_b32 v59, 4, v59
  v_and_b32 v108, 1, v6
  v_lshl_add_u32 v59, v108, 2, v59
  buffer_load_dwordx4 v13, s[56:59], s10 offen offset:1024 lds
  v_cvt_f32_u32 v58, v59
  v_mul_f32 v58, v58, v57
  v_cmp_eq_u32 vcc, 0, v109
  v_fmamk_f32 v92, v57, 0x0, v58
  v_fmamk_f32 v93, v57, 0x3f800000, v58
  v_fmamk_f32 v94, v57, 0x40000000, v58
  v_fmamk_f32 v95, v57, 0x40400000, v58
  v_fmamk_f32 v96, v57, 0x41000000, v58
  buffer_load_dwordx4 v14, s[56:59], s10 offen offset:2048 lds
  v_fmamk_f32 v97, v57, 0x41100000, v58
  v_fmamk_f32 v98, v57, 0x41200000, v58
  v_fmamk_f32 v99, v57, 0x41300000, v58
  v_cos_f32 v100, v92
  v_cos_f32 v101, v93
  v_cos_f32 v102, v94
  buffer_load_dwordx4 v15, s[56:59], s10 offen offset:3072 lds
  v_cos_f32 v103, v95
  v_cos_f32 v104, v96
  v_cos_f32 v105, v97
  v_cos_f32 v106, v98
  s_add_u32 m0, s16, 0
  s_nop 0
  buffer_load_dwordx4 v8, s[44:47], s10 offen offset:0 lds
  v_cos_f32 v107, v99
  v_sin_f32 v92, v92
  v_sin_f32 v93, v93
  v_sin_f32 v94, v94
  buffer_load_dwordx4 v9, s[44:47], s10 offen offset:1024 lds
  v_sin_f32 v95, v95
  v_sin_f32 v96, v96
  v_sin_f32 v97, v97
  v_sin_f32 v98, v98
  buffer_load_dwordx4 v10, s[44:47], s10 offen offset:2048 lds
  v_sin_f32 v99, v99
  v_mov_b32 v58, 0x80008000
  v_bfe_i32 v108, v5, 0, 1
  v_bfe_i32 v59, v5, 1, 1
  v_cmp_ne_u32 s[28:29], 0, v108
  v_and_b32 v108, v58, v108
  v_and_b32 v59, v58, v59
  buffer_load_dwordx4 v11, s[44:47], s10 offen offset:3072 lds
  s_add_u32 s10, s10, 128
  s_and_b32 s10, s10, 0x7ff
  v_xor_b32 v109, v59, v108
  v_mov_b32 v57, 0xbf803f80
  v_cvt_pk_bf16_f32 v60, v100, v101
  v_cvt_pk_bf16_f32 v76, -v92, -v93
  v_cndmask_b32 v76, v76, v57, vcc
  v_cvt_pk_bf16_f32 v61, v102, v103
  v_cvt_pk_bf16_f32 v77, -v94, -v95
  v_cndmask_b32 v77, v77, v57, vcc
  v_and_b32 v29, 31, v4
  v_lshlrev_b32 v29, 1, v29
  s_lshl_b32 s19, s39, 7
  s_and_b32 s24, s3, 1
  s_lshl_b32 s24, s24, 6
  s_add_u32 s19, s19, s24
  buffer_load_ushort v26, v29, s[64:67], s19 offen
  v_cvt_pk_bf16_f32 v62, v104, v105
  v_cvt_pk_bf16_f32 v78, -v96, -v97
  v_cndmask_b32 v78, v78, v57, vcc
  v_cvt_pk_bf16_f32 v63, v106, v107
  v_cvt_pk_bf16_f32 v79, -v98, -v99
  v_cndmask_b32 v79, v79, v57, vcc
  v_cndmask_b32 v64, v60, v76, s[28:29]
  v_cndmask_b32 v80, v76, v60, s[28:29]
  buffer_load_ushort v27, v29, s[68:71], s19 offen
  v_xor_b32 v68, v108, v60
  v_xor_b32 v84, v108, v76
  v_xor_b32 v72, v109, v64
  v_xor_b32 v88, v59, v80
  v_xor_b32 v64, v59, v64
  v_xor_b32 v80, v109, v80
  v_cndmask_b32 v65, v61, v77, s[28:29]
  v_cndmask_b32 v81, v77, v61, s[28:29]
  buffer_load_ushort v28, v29, s[72:75], s19 offen
  v_xor_b32 v69, v108, v61
  v_xor_b32 v85, v108, v77
  v_xor_b32 v73, v109, v65
  v_xor_b32 v89, v59, v81
  v_xor_b32 v65, v59, v65
  v_xor_b32 v81, v109, v81
  v_cndmask_b32 v66, v62, v78, s[28:29]
  v_cndmask_b32 v82, v78, v62, s[28:29]
  v_lshlrev_b32 v29, 1, v5
  s_lshl_b32 s19, s43, 5
  s_lshr_b32 s24, s3, 1
  s_lshl_b32 s24, s24, 10
  s_add_u32 s19, s19, s24
  buffer_load_short_d16_hi v30, v29, s[76:79], s19 offen offset:0
  v_xor_b32 v70, v108, v62
  v_xor_b32 v86, v108, v78
  v_xor_b32 v74, v109, v66
  v_xor_b32 v90, v59, v82
  v_xor_b32 v66, v59, v66
  v_xor_b32 v82, v109, v82
  v_cndmask_b32 v67, v63, v79, s[28:29]
  v_cndmask_b32 v83, v79, v63, s[28:29]
  buffer_load_short_d16_hi v31, v29, s[76:79], s19 offen offset:512
  v_xor_b32 v71, v108, v63
  v_xor_b32 v87, v108, v79
  v_xor_b32 v75, v109, v67
  v_xor_b32 v91, v59, v83
  v_xor_b32 v67, v59, v67
  v_xor_b32 v83, v109, v83
  s_mov_b32 s80, s34
  s_mov_b32 s81, s35
  s_add_u32 m0, s17, 16384
  s_nop 0
  buffer_load_dwordx4 v12, s[56:59], s10 offen offset:0 lds
  s_mov_b32 s82, 4194304
  s_mov_b32 s83, 0x20000
  buffer_load_dwordx4 v13, s[56:59], s10 offen offset:1024 lds
  buffer_load_dwordx4 v14, s[56:59], s10 offen offset:2048 lds
  buffer_load_dwordx4 v15, s[56:59], s10 offen offset:3072 lds
  s_add_u32 m0, s16, 16384
  s_nop 0
  buffer_load_dwordx4 v8, s[44:47], s10 offen offset:0 lds
  buffer_load_dwordx4 v9, s[44:47], s10 offen offset:1024 lds
  buffer_load_dwordx4 v10, s[44:47], s10 offen offset:2048 lds
  buffer_load_dwordx4 v11, s[44:47], s10 offen offset:3072 lds
  s_add_u32 s10, s10, 128
  s_and_b32 s10, s10, 0x7ff
  s_waitcnt vmcnt(21) lgkmcnt(0)
  s_barrier
  v_bfe_u32 v29, v4, 2, 3
  v_lshrrev_b32 v57, 5, v4
  v_lshl_or_b32 v29, v57, 4, v29
  v_lshlrev_b32 v29, 7, v29
  v_and_b32 v57, 3, v4
  v_lshl_or_b32 v29, v57, 3, v29
  v_add_u32 v29, 131072, v29
  v_bfe_u32 v57, v4, 3, 2
  v_xor_b32 v92, 0, v57
  v_lshl_add_u32 v92, v92, 5, v29
  v_xor_b32 v93, 1, v57
  v_lshl_add_u32 v93, v93, 5, v29
  v_xor_b32 v94, 2, v57
  v_lshl_add_u32 v94, v94, 5, v29
  v_xor_b32 v95, 3, v57
  s_add_u32 m0, s17, 32768
  s_nop 0
  buffer_load_dwordx4 v12, s[56:59], s10 offen offset:0 lds
  v_lshl_add_u32 v95, v95, 5, v29
  ds_read_b64_tr_b16 v[128:129], v92 offset:0
  ds_read_b64_tr_b16 v[130:131], v92 offset:1024
  ds_read_b64_tr_b16 v[132:133], v92 offset:4096
  ds_read_b64_tr_b16 v[134:135], v92 offset:5120
  ds_read_b64_tr_b16 v[136:137], v92 offset:8192
  ds_read_b64_tr_b16 v[138:139], v92 offset:9216
  ds_read_b64_tr_b16 v[140:141], v92 offset:12288
  ds_read_b64_tr_b16 v[142:143], v92 offset:13312
  ds_read_b64_tr_b16 v[144:145], v94 offset:0
  ds_read_b64_tr_b16 v[146:147], v94 offset:1024
  ds_read_b64_tr_b16 v[148:149], v94 offset:4096
  ds_read_b64_tr_b16 v[150:151], v94 offset:5120
  ds_read_b64_tr_b16 v[152:153], v94 offset:8192
  buffer_load_dwordx4 v13, s[56:59], s10 offen offset:1024 lds
  ds_read_b64_tr_b16 v[154:155], v94 offset:9216
  ds_read_b64_tr_b16 v[156:157], v94 offset:12288
  ds_read_b64_tr_b16 v[158:159], v94 offset:13312
  ds_read_b64_tr_b16 v[160:161], v93 offset:0
  ds_read_b64_tr_b16 v[162:163], v93 offset:1024
  ds_read_b64_tr_b16 v[164:165], v93 offset:4096
  ds_read_b64_tr_b16 v[166:167], v93 offset:5120
  ds_read_b64_tr_b16 v[168:169], v93 offset:8192
  ds_read_b64_tr_b16 v[170:171], v93 offset:9216
  ds_read_b64_tr_b16 v[172:173], v93 offset:12288
  ds_read_b64_tr_b16 v[174:175], v93 offset:13312
  s_waitcnt lgkmcnt(15)
  v_mfma_f32_16x16x32_bf16 v[96:99], v[60:63], v[128:131], 0
  buffer_load_dwordx4 v14, s[56:59], s10 offen offset:2048 lds
  v_mfma_f32_16x16x32_bf16 v[100:103], v[76:79], v[128:131], 0
  s_waitcnt lgkmcnt(15)
  v_mfma_f32_16x16x32_bf16 v[96:99], v[64:67], v[132:135], v[96:99]
  v_mfma_f32_16x16x32_bf16 v[100:103], v[80:83], v[132:135], v[100:103]
  s_waitcnt lgkmcnt(15)
  v_mfma_f32_16x16x32_bf16 v[96:99], v[68:71], v[136:139], v[96:99]
  buffer_load_dwordx4 v15, s[56:59], s10 offen offset:3072 lds
  v_mfma_f32_16x16x32_bf16 v[100:103], v[84:87], v[136:139], v[100:103]
  s_waitcnt lgkmcnt(15)
  v_mfma_f32_16x16x32_bf16 v[96:99], v[72:75], v[140:143], v[96:99]
  v_mfma_f32_16x16x32_bf16 v[100:103], v[88:91], v[140:143], v[100:103]
  ds_read_b64_tr_b16 v[128:129], v95 offset:0
  ds_read_b64_tr_b16 v[130:131], v95 offset:1024
  s_add_u32 m0, s16, 32768
  s_nop 0
  buffer_load_dwordx4 v8, s[44:47], s10 offen offset:0 lds
  ds_read_b64_tr_b16 v[132:133], v95 offset:4096
  ds_read_b64_tr_b16 v[134:135], v95 offset:5120
  ds_read_b64_tr_b16 v[136:137], v95 offset:8192
  ds_read_b64_tr_b16 v[138:139], v95 offset:9216
  ds_read_b64_tr_b16 v[140:141], v95 offset:12288
  ds_read_b64_tr_b16 v[142:143], v95 offset:13312
  s_waitcnt lgkmcnt(15)
  v_mfma_f32_16x16x32_bf16 v[112:115], v[60:63], v[144:147], 0
  v_mfma_f32_16x16x32_bf16 v[116:119], v[76:79], v[144:147], 0
  buffer_load_dwordx4 v9, s[44:47], s10 offen offset:1024 lds
  s_waitcnt lgkmcnt(15)
  v_mfma_f32_16x16x32_bf16 v[112:115], v[64:67], v[148:151], v[112:115]
  v_mfma_f32_16x16x32_bf16 v[116:119], v[80:83], v[148:151], v[116:119]
  s_waitcnt lgkmcnt(15)
  v_mfma_f32_16x16x32_bf16 v[112:115], v[68:71], v[152:155], v[112:115]
  v_mfma_f32_16x16x32_bf16 v[116:119], v[84:87], v[152:155], v[116:119]
  buffer_load_dwordx4 v10, s[44:47], s10 offen offset:2048 lds
  s_waitcnt lgkmcnt(15)
  v_mfma_f32_16x16x32_bf16 v[112:115], v[72:75], v[156:159], v[112:115]
  v_mfma_f32_16x16x32_bf16 v[116:119], v[88:91], v[156:159], v[116:119]
  s_waitcnt lgkmcnt(14)
  v_mfma_f32_16x16x32_bf16 v[104:107], v[60:63], v[160:163], 0
  v_mfma_f32_16x16x32_bf16 v[108:111], v[76:79], v[160:163], 0
  buffer_load_dwordx4 v11, s[44:47], s10 offen offset:3072 lds
  s_add_u32 s10, s10, 128
  s_and_b32 s10, s10, 0x7ff
  s_waitcnt lgkmcnt(12)
  v_mfma_f32_16x16x32_bf16 v[104:107], v[64:67], v[164:167], v[104:107]
  v_mfma_f32_16x16x32_bf16 v[108:111], v[80:83], v[164:167], v[108:111]
  s_waitcnt lgkmcnt(10)
  v_mfma_f32_16x16x32_bf16 v[104:107], v[68:71], v[168:171], v[104:107]
  v_mfma_f32_16x16x32_bf16 v[108:111], v[84:87], v[168:171], v[108:111]
  s_add_u32 m0, s17, 49152
  s_nop 0
  buffer_load_dwordx4 v12, s[56:59], s10 offen offset:0 lds
  s_waitcnt lgkmcnt(8)
  v_mfma_f32_16x16x32_bf16 v[104:107], v[72:75], v[172:175], v[104:107]
  v_mfma_f32_16x16x32_bf16 v[108:111], v[88:91], v[172:175], v[108:111]
  s_waitcnt lgkmcnt(6)
  v_mfma_f32_16x16x32_bf16 v[120:123], v[60:63], v[128:131], 0
  v_mfma_f32_16x16x32_bf16 v[124:127], v[76:79], v[128:131], 0
  buffer_load_dwordx4 v13, s[56:59], s10 offen offset:1024 lds
  s_waitcnt lgkmcnt(4)
  v_mfma_f32_16x16x32_bf16 v[120:123], v[64:67], v[132:135], v[120:123]
  v_mfma_f32_16x16x32_bf16 v[124:127], v[80:83], v[132:135], v[124:127]
  s_waitcnt lgkmcnt(2)
  v_mfma_f32_16x16x32_bf16 v[120:123], v[68:71], v[136:139], v[120:123]
  v_mfma_f32_16x16x32_bf16 v[124:127], v[84:87], v[136:139], v[124:127]
  buffer_load_dwordx4 v14, s[56:59], s10 offen offset:2048 lds
  s_waitcnt lgkmcnt(0)
  v_mfma_f32_16x16x32_bf16 v[120:123], v[72:75], v[140:143], v[120:123]
  v_mfma_f32_16x16x32_bf16 v[124:127], v[88:91], v[140:143], v[124:127]
  v_pk_add_f32 v[144:145], v[96:97], v[112:113]
  v_pk_add_f32 v[152:153], v[96:97], v[112:113] neg_lo:[0,1] neg_hi:[0,1]
  v_pk_add_f32 v[146:147], v[98:99], v[114:115]
  v_pk_add_f32 v[154:155], v[98:99], v[114:115] neg_lo:[0,1] neg_hi:[0,1]
  v_pk_add_f32 v[148:149], v[100:101], v[116:117]
  v_pk_add_f32 v[156:157], v[100:101], v[116:117] neg_lo:[0,1] neg_hi:[0,1]
  buffer_load_dwordx4 v15, s[56:59], s10 offen offset:3072 lds
  v_pk_add_f32 v[150:151], v[102:103], v[118:119]
  v_pk_add_f32 v[158:159], v[102:103], v[118:119] neg_lo:[0,1] neg_hi:[0,1]
  v_pk_add_f32 v[160:161], v[104:105], v[120:121]
  v_pk_add_f32 v[168:169], v[104:105], v[120:121] neg_lo:[0,1] neg_hi:[0,1]
  v_pk_add_f32 v[162:163], v[106:107], v[122:123]
  v_pk_add_f32 v[170:171], v[106:107], v[122:123] neg_lo:[0,1] neg_hi:[0,1]
  v_pk_add_f32 v[164:165], v[108:109], v[124:125]
  v_pk_add_f32 v[172:173], v[108:109], v[124:125] neg_lo:[0,1] neg_hi:[0,1]
  v_pk_add_f32 v[166:167], v[110:111], v[126:127]
  v_pk_add_f32 v[174:175], v[110:111], v[126:127] neg_lo:[0,1] neg_hi:[0,1]
  v_pk_add_f32 v[96:97], v[144:145], v[160:161]
  v_pk_add_f32 v[112:113], v[144:145], v[160:161] neg_lo:[0,1] neg_hi:[0,1]
  v_pk_add_f32 v[100:101], v[148:149], v[164:165]
  v_pk_add_f32 v[116:117], v[148:149], v[164:165] neg_lo:[0,1] neg_hi:[0,1]
  s_add_u32 m0, s16, 49152
  s_nop 0
  buffer_load_dwordx4 v8, s[44:47], s10 offen offset:0 lds
  v_pk_add_f32 v[104:105], v[152:153], v[172:173]
  v_pk_add_f32 v[108:109], v[156:157], v[168:169] neg_lo:[0,1] neg_hi:[0,1]
  v_pk_add_f32 v[120:121], v[152:153], v[172:173] neg_lo:[0,1] neg_hi:[0,1]
  v_pk_add_f32 v[124:125], v[156:157], v[168:169]
  v_pk_add_f32 v[98:99], v[146:147], v[162:163]
  v_pk_add_f32 v[114:115], v[146:147], v[162:163] neg_lo:[0,1] neg_hi:[0,1]
  v_pk_add_f32 v[102:103], v[150:151], v[166:167]
  v_pk_add_f32 v[118:119], v[150:151], v[166:167] neg_lo:[0,1] neg_hi:[0,1]
  v_pk_add_f32 v[106:107], v[154:155], v[174:175]
  v_pk_add_f32 v[110:111], v[158:159], v[170:171] neg_lo:[0,1] neg_hi:[0,1]
  v_pk_add_f32 v[122:123], v[154:155], v[174:175] neg_lo:[0,1] neg_hi:[0,1]
  v_pk_add_f32 v[126:127], v[158:159], v[170:171]
  v_cmp_gt_u32 vcc, 16, v0
  s_nop 1
  v_cndmask_b32 v104, v104, v152, vcc
  buffer_load_dwordx4 v9, s[44:47], s10 offen offset:1024 lds
  v_cndmask_b32 v108, v108, -v168, vcc
  v_cndmask_b32 v120, v120, v156, vcc
  v_cndmask_b32 v124, v124, -v172, vcc
  v_cvt_pk_bf16_f32 v128, v96, v100
  v_cvt_pk_bf16_f32 v129, v104, v108
  v_cvt_pk_bf16_f32 v130, v112, v116
  v_cvt_pk_bf16_f32 v131, v120, v124
  v_cvt_pk_bf16_f32 v132, v97, v101
  v_cvt_pk_bf16_f32 v133, v105, v109
  v_cvt_pk_bf16_f32 v134, v113, v117
  v_cvt_pk_bf16_f32 v135, v121, v125
  v_cvt_pk_bf16_f32 v136, v98, v102
  v_cvt_pk_bf16_f32 v137, v106, v110
  v_cvt_pk_bf16_f32 v138, v114, v118
  buffer_load_dwordx4 v10, s[44:47], s10 offen offset:2048 lds
  v_cvt_pk_bf16_f32 v139, v122, v126
  v_cvt_pk_bf16_f32 v140, v99, v103
  v_cvt_pk_bf16_f32 v141, v107, v111
  v_cvt_pk_bf16_f32 v142, v115, v119
  v_cvt_pk_bf16_f32 v143, v123, v127
  s_mov_b32 s19, 262144
  v_mul_lo_u32 v29, v6, s19
  v_lshl_add_u32 v29, v5, 2, v29
  s_mul_i32 s19, s3, 1048576
  s_lshl_b32 s24, s42, 10
  s_add_u32 s19, s19, s24
  s_lshl_b32 s24, s43, 6
  s_add_u32 s19, s19, s24
  s_and_b32 s24, s3, 1
  buffer_load_dwordx4 v11, s[44:47], s10 offen offset:3072 lds
  s_add_u32 s10, s10, 128
  s_and_b32 s10, s10, 0x7ff
  s_lshl_b32 s24, s24, 12
  s_add_u32 s24, s24, 131072
  v_lshrrev_b32 v76, 2, v4
  v_lshlrev_b32 v76, 7, v76
  v_and_b32 v77, 3, v4
  v_lshl_or_b32 v76, v77, 3, v76
  v_add_u32 v76, s24, v76
  v_bfe_u32 v77, v4, 3, 2
  s_and_b32 s24, s3, 2
  v_xor_b32 v77, s24, v77
  v_lshl_add_u32 v74, v77, 5, v76
  v_xor_b32 v75, 32, v74
  ds_read_b64_tr_b16 v[58:59], v74 offset:0
  ds_read_b64_tr_b16 v[60:61], v74 offset:2048
  ds_read_b64_tr_b16 v[62:63], v75 offset:0
  ds_read_b64_tr_b16 v[64:65], v75 offset:2048
  ds_read_b64_tr_b16 v[66:67], v74 offset:8192
  ds_read_b64_tr_b16 v[68:69], v74 offset:10240
  ds_read_b64_tr_b16 v[70:71], v75 offset:8192
  ds_read_b64_tr_b16 v[72:73], v75 offset:10240
  v_lshlrev_b32 v56, 4, v4
  s_lshl_b32 s25, s38, 18
  s_lshl_b32 s26, s39, 11
  s_add_u32 s25, s25, s26
  s_lshl_b32 s26, s3, 16
  s_add_u32 s25, s25, s26
  s_add_u32 s26, s25, 32768
  buffer_load_dwordx4 v[32:35], v56, s[44:47], s25 offen offset:0
  buffer_load_dwordx4 v[36:39], v56, s[44:47], s25 offen offset:1024
  buffer_load_dwordx4 v[40:43], v56, s[44:47], s26 offen offset:0
  buffer_load_dwordx4 v[44:47], v56, s[44:47], s26 offen offset:1024
  buffer_load_dwordx4 v[48:51], v56, s[60:63], 0 offen offset:0
  buffer_load_dwordx4 v[52:55], v56, s[60:63], 0 offen offset:1024
  s_waitcnt vmcnt(35)
  s_barrier
  ds_read_b128 v[124:127], v16 offset:0
  ds_read_b128 v[164:167], v20 offset:0
  ds_read_b128 v[160:163], v16 offset:4096
  ds_read_b128 v[168:171], v20 offset:4096
  s_waitcnt lgkmcnt(2)
  v_mfma_f32_32x32x16_bf16 v[76:91], v[124:127], v[164:167], 0
  ds_read_b128 v[172:175], v17 offset:0
  ds_read_b128 v[180:183], v21 offset:0
  buffer_store_dword v128, v29, s[80:83], s19 offen sc1
  s_add_u32 s19, s19, 16384
  buffer_store_dword v129, v29, s[80:83], s19 offen sc1
  s_waitcnt lgkmcnt(2)
  v_mfma_f32_32x32x16_bf16 v[92:107], v[124:127], v[168:171], 0
  ds_read_b128 v[176:179], v17 offset:4096
  ds_read_b128 v[184:187], v21 offset:4096
  s_add_u32 s19, s19, 16384
  buffer_store_dword v130, v29, s[80:83], s19 offen sc1
  v_mfma_f32_32x32x16_bf16 v[144:159], v[160:163], v[168:171], 0
  s_add_u32 s19, s19, 16384
  buffer_store_dword v131, v29, s[80:83], s19 offen sc1
  v_mfma_f32_32x32x16_bf16 v[108:123], v[160:163], v[164:167], 0
  s_add_u32 s19, s19, 16384
  buffer_store_dword v132, v29, s[80:83], s19 offen sc1
  s_waitcnt lgkmcnt(2)
  v_mfma_f32_32x32x16_bf16 v[76:91], v[172:175], v[180:183], v[76:91]
  ds_read_b128 v[124:127], v18 offset:0
  ds_read_b128 v[164:167], v22 offset:0
  s_add_u32 s19, s19, 16384
  buffer_store_dword v133, v29, s[80:83], s19 offen sc1
  s_waitcnt lgkmcnt(2)
  v_mfma_f32_32x32x16_bf16 v[92:107], v[172:175], v[184:187], v[92:107]
  ds_read_b128 v[160:163], v18 offset:4096
  ds_read_b128 v[168:171], v22 offset:4096
  s_add_u32 s19, s19, 16384
  buffer_store_dword v134, v29, s[80:83], s19 offen sc1
  v_mfma_f32_32x32x16_bf16 v[144:159], v[176:179], v[184:187], v[144:159]
  s_add_u32 s19, s19, 16384
  buffer_store_dword v135, v29, s[80:83], s19 offen sc1
  v_mfma_f32_32x32x16_bf16 v[108:123], v[176:179], v[180:183], v[108:123]
  s_add_u32 s19, s19, 16384
  buffer_store_dword v136, v29, s[80:83], s19 offen sc1
  s_waitcnt lgkmcnt(2)
  v_mfma_f32_32x32x16_bf16 v[76:91], v[124:127], v[164:167], v[76:91]
  ds_read_b128 v[172:175], v19 offset:0
  ds_read_b128 v[180:183], v23 offset:0
  s_add_u32 s19, s19, 16384
  buffer_store_dword v137, v29, s[80:83], s19 offen sc1
  s_add_u32 s19, s19, 16384
  s_waitcnt lgkmcnt(2)
  v_mfma_f32_32x32x16_bf16 v[92:107], v[124:127], v[168:171], v[92:107]
  ds_read_b128 v[176:179], v19 offset:4096
  ds_read_b128 v[184:187], v23 offset:4096
  buffer_store_dword v138, v29, s[80:83], s19 offen sc1
  s_add_u32 s19, s19, 16384
  v_mfma_f32_32x32x16_bf16 v[144:159], v[160:163], v[168:171], v[144:159]
  buffer_store_dword v139, v29, s[80:83], s19 offen sc1
  s_add_u32 s19, s19, 16384
  v_mfma_f32_32x32x16_bf16 v[108:123], v[160:163], v[164:167], v[108:123]
  buffer_store_dword v140, v29, s[80:83], s19 offen sc1
  s_add_u32 s19, s19, 16384
  s_waitcnt vmcnt(35) lgkmcnt(0)
  s_barrier
  v_mfma_f32_32x32x16_bf16 v[76:91], v[172:175], v[180:183], v[76:91]
  ds_read_b128 v[124:127], v16 offset:16384
  ds_read_b128 v[164:167], v20 offset:16384
  buffer_store_dword v141, v29, s[80:83], s19 offen sc1
  s_add_u32 s19, s19, 16384
  v_mfma_f32_32x32x16_bf16 v[92:107], v[172:175], v[184:187], v[92:107]
  ds_read_b128 v[160:163], v16 offset:20480
  ds_read_b128 v[168:171], v20 offset:20480
  buffer_store_dword v142, v29, s[80:83], s19 offen sc1
  s_add_u32 s19, s19, 16384
  v_mfma_f32_32x32x16_bf16 v[144:159], v[176:179], v[184:187], v[144:159]
  s_add_u32 m0, s17, 0
  s_nop 0
  buffer_load_dwordx4 v12, s[56:59], s10 offen offset:0 lds
  buffer_store_dword v143, v29, s[80:83], s19 offen sc1
  s_lshl_b32 s19, s39, 14
  v_mfma_f32_32x32x16_bf16 v[108:123], v[176:179], v[180:183], v[108:123]
  buffer_load_dwordx4 v13, s[56:59], s10 offen offset:1024 lds
  s_add_u32 s66, s19, 19988480
  s_add_u32 s64, s34, s66
  s_addc_u32 s65, s35, 0
  s_waitcnt lgkmcnt(2)
  v_mfma_f32_32x32x16_bf16 v[76:91], v[124:127], v[164:167], v[76:91]
  ds_read_b128 v[172:175], v17 offset:16384
  ds_read_b128 v[180:183], v21 offset:16384
  s_mov_b32 s66, 8192
  s_mov_b32 s67, 0x20000
  s_sub_u32 s19, 15, s38
  s_lshl_b32 s19, s19, 9
  s_waitcnt lgkmcnt(2)
  v_mfma_f32_32x32x16_bf16 v[92:107], v[124:127], v[168:171], v[92:107]
  ds_read_b128 v[176:179], v17 offset:20480
  ds_read_b128 v[184:187], v21 offset:20480
  v_lshl_add_u32 v74, v0, 2, s19
  v_mov_b32 v75, -1
  s_cmp_ge_u32 s3, 2
  s_cbranch_scc1 gated_mix__spectral_gfnet__ssm_conv_s5__prompt_kernel_skip10
  buffer_store_dword v75, v74, s[64:67], 0 offen sc1
gated_mix__spectral_gfnet__ssm_conv_s5__prompt_kernel_skip10:
  v_mfma_f32_32x32x16_bf16 v[144:159], v[160:163], v[168:171], v[144:159]
  buffer_load_dwordx4 v14, s[56:59], s10 offen offset:2048 lds
  s_cmp_lg_u32 s3, 0
  s_cbranch_scc1 gated_mix__spectral_gfnet__ssm_conv_s5__prompt_kernel_skip11
  s_mov_b64 exec, 1
  buffer_store_dword v2, v25, s[48:51], s5 offen sc1
  s_mov_b64 exec, -1
gated_mix__spectral_gfnet__ssm_conv_s5__prompt_kernel_skip11:
  v_mfma_f32_32x32x16_bf16 v[108:123], v[160:163], v[164:167], v[108:123]
  buffer_load_dwordx4 v15, s[56:59], s10 offen offset:3072 lds
  s_waitcnt lgkmcnt(2)
  v_mfma_f32_32x32x16_bf16 v[76:91], v[172:175], v[180:183], v[76:91]
  ds_read_b128 v[124:127], v18 offset:16384
  ds_read_b128 v[164:167], v22 offset:16384
  s_or_b32 s19, s3, s2
  s_cmp_lg_u32 s19, 0
  s_cbranch_scc1 gated_mix__spectral_gfnet__ssm_conv_s5__prompt_kernel_skip12
  s_mov_b64 exec, 1
  buffer_store_dword v7, v2, s[52:55], 0 offen sc1
  s_mov_b64 exec, -1
gated_mix__spectral_gfnet__ssm_conv_s5__prompt_kernel_skip12:
  s_waitcnt lgkmcnt(2)
  v_mfma_f32_32x32x16_bf16 v[92:107], v[172:175], v[184:187], v[92:107]
  ds_read_b128 v[160:163], v18 offset:20480
  ds_read_b128 v[168:171], v22 offset:20480
  s_bitcmp1_b32 s3, 0
  s_cselect_b32 s68, s22, s20
  s_cselect_b32 s69, s23, s21
  v_mfma_f32_32x32x16_bf16 v[144:159], v[176:179], v[184:187], v[144:159]
  s_add_u32 m0, s16, 0
  s_nop 0
  buffer_load_dwordx4 v8, s[44:47], s10 offen offset:0 lds
  s_mov_b32 s70, 2097152
  s_mov_b32 s71, 0x20000
  v_mfma_f32_32x32x16_bf16 v[108:123], v[176:179], v[180:183], v[108:123]
  buffer_load_dwordx4 v9, s[44:47], s10 offen offset:1024 lds
  v_and_b32 v74, 7, v4
  v_xor_b32 v74, v74, v6
  v_and_b32 v75, 4, v74
  v_lshlrev_b32 v128, 4, v75
  s_waitcnt lgkmcnt(2)
  v_mfma_f32_32x32x16_bf16 v[76:91], v[124:127], v[164:167], v[76:91]
  ds_read_b128 v[172:175], v19 offset:16384
  ds_read_b128 v[180:183], v23 offset:16384
  v_and_b32 v75, 1, v74
  v_lshl_or_b32 v128, v75, 5, v128
  v_bfe_u32 v75, v74, 1, 1
  v_lshl_or_b32 v128, v75, 4, v128
  v_lshrrev_b32 v75, 3, v4
  s_waitcnt lgkmcnt(2)
  v_mfma_f32_32x32x16_bf16 v[92:107], v[124:127], v[168:171], v[92:107]
  ds_read_b128 v[176:179], v19 offset:20480
  ds_read_b128 v[184:187], v23 offset:20480
  v_lshl_or_b32 v128, v75, 11, v128
  s_lshr_b32 s21, s3, 1
  s_lshl_b32 s21, s21, 20
  s_lshl_b32 s19, s43, 15
  v_mfma_f32_32x32x16_bf16 v[144:159], v[160:163], v[168:171], v[144:159]
  buffer_load_dwordx4 v10, s[44:47], s10 offen offset:2048 lds
  s_add_u32 s21, s21, s19
  v_add_u32 v128, s21, v128
  v_xor_b32 v129, 64, v128
  v_add_u32 v129, 15360, v129
  v_mfma_f32_32x32x16_bf16 v[108:123], v[160:163], v[164:167], v[108:123]
  buffer_load_dwordx4 v11, s[44:47], s10 offen offset:3072 lds
  s_add_u32 s10, s10, 128
  s_and_b32 s10, s10, 0x7ff
  v_add_u32 v130, 522240, v128
  v_add_u32 v131, 522240, v129
  s_lshl_b32 s19, s18, 7
  s_lshl_b32 s20, s3, 12
  s_waitcnt vmcnt(38) lgkmcnt(0)
  s_barrier
  v_mfma_f32_32x32x16_bf16 v[76:91], v[172:175], v[180:183], v[76:91]
  ds_read_b128 v[124:127], v16 offset:32768
  ds_read_b128 v[164:167], v20 offset:32768
  v_lshrrev_b32 v74, 1, v5
  v_xor_b32 v74, v74, v6
  v_lshlrev_b32 v74, 4, v74
  v_lshl_or_b32 v74, v5, 7, v74
  v_mfma_f32_32x32x16_bf16 v[92:107], v[172:175], v[184:187], v[92:107]
  ds_read_b128 v[160:163], v16 offset:36864
  ds_read_b128 v[168:171], v20 offset:36864
  v_add_u32 v132, s20, v74
  v_xor_b32 v133, 64, v132
  v_add_u32 v134, 0x10000, v132
  v_add_u32 v135, 0x10000, v133
  v_mfma_f32_32x32x16_bf16 v[144:159], v[176:179], v[184:187], v[144:159]
  s_add_u32 m0, s17, 16384
  s_nop 0
  buffer_load_dwordx4 v12, s[56:59], s10 offen offset:0 lds
  s_mov_b32 s72, s6
  s_mov_b32 s73, s7
  s_mov_b32 s74, 2101248
  s_mov_b32 s75, 0x20000
  v_mfma_f32_32x32x16_bf16 v[108:123], v[176:179], v[180:183], v[108:123]
  buffer_load_dwordx4 v13, s[56:59], s10 offen offset:1024 lds
  s_mov_b32 s76, s8
  s_mov_b32 s77, s9
  s_mov_b32 s78, 2101248
  s_mov_b32 s79, 0x20000
  s_waitcnt lgkmcnt(2)
  v_mfma_f32_32x32x16_bf16 v[76:91], v[124:127], v[164:167], v[76:91]
  ds_read_b128 v[172:175], v17 offset:32768
  ds_read_b128 v[180:183], v21 offset:32768
  s_waitcnt lgkmcnt(2)
  v_mfma_f32_32x32x16_bf16 v[92:107], v[124:127], v[168:171], v[92:107]
  ds_read_b128 v[176:179], v17 offset:36864
  ds_read_b128 v[184:187], v21 offset:36864
  v_mfma_f32_32x32x16_bf16 v[144:159], v[160:163], v[168:171], v[144:159]
  buffer_load_dwordx4 v14, s[56:59], s10 offen offset:2048 lds
  v_mfma_f32_32x32x16_bf16 v[108:123], v[160:163], v[164:167], v[108:123]
  buffer_load_dwordx4 v15, s[56:59], s10 offen offset:3072 lds
  s_waitcnt lgkmcnt(2)
  v_mfma_f32_32x32x16_bf16 v[76:91], v[172:175], v[180:183], v[76:91]
  ds_read_b128 v[124:127], v18 offset:32768
  ds_read_b128 v[164:167], v22 offset:32768
  s_waitcnt lgkmcnt(2)
  v_mfma_f32_32x32x16_bf16 v[92:107], v[172:175], v[184:187], v[92:107]
  ds_read_b128 v[160:163], v18 offset:36864
  ds_read_b128 v[168:171], v22 offset:36864
  v_mfma_f32_32x32x16_bf16 v[144:159], v[176:179], v[184:187], v[144:159]
  s_add_u32 m0, s16, 16384
  s_nop 0
  buffer_load_dwordx4 v8, s[44:47], s10 offen offset:0 lds
  v_mfma_f32_32x32x16_bf16 v[108:123], v[176:179], v[180:183], v[108:123]
  buffer_load_dwordx4 v9, s[44:47], s10 offen offset:1024 lds
  s_waitcnt lgkmcnt(2)
  v_mfma_f32_32x32x16_bf16 v[76:91], v[124:127], v[164:167], v[76:91]
  ds_read_b128 v[172:175], v19 offset:32768
  ds_read_b128 v[180:183], v23 offset:32768
  s_waitcnt lgkmcnt(2)
  v_mfma_f32_32x32x16_bf16 v[92:107], v[124:127], v[168:171], v[92:107]
  ds_read_b128 v[176:179], v19 offset:36864
  ds_read_b128 v[184:187], v23 offset:36864
  v_mfma_f32_32x32x16_bf16 v[144:159], v[160:163], v[168:171], v[144:159]
  buffer_load_dwordx4 v10, s[44:47], s10 offen offset:2048 lds
  v_mfma_f32_32x32x16_bf16 v[108:123], v[160:163], v[164:167], v[108:123]
  buffer_load_dwordx4 v11, s[44:47], s10 offen offset:3072 lds
  s_add_u32 s10, s10, 128
  s_and_b32 s10, s10, 0x7ff
  s_waitcnt vmcnt(38) lgkmcnt(0)
  s_barrier
  v_mfma_f32_32x32x16_bf16 v[76:91], v[172:175], v[180:183], v[76:91]
  ds_read_b128 v[124:127], v16 offset:49152
  ds_read_b128 v[164:167], v20 offset:49152
  v_mfma_f32_32x32x16_bf16 v[92:107], v[172:175], v[184:187], v[92:107]
  ds_read_b128 v[160:163], v16 offset:53248
  ds_read_b128 v[168:171], v20 offset:53248
  v_mfma_f32_32x32x16_bf16 v[144:159], v[176:179], v[184:187], v[144:159]
  s_add_u32 m0, s17, 32768
  s_nop 0
  buffer_load_dwordx4 v12, s[56:59], s10 offen offset:0 lds
  v_mfma_f32_32x32x16_bf16 v[108:123], v[176:179], v[180:183], v[108:123]
  buffer_load_dwordx4 v13, s[56:59], s10 offen offset:1024 lds
  s_waitcnt lgkmcnt(2)
  v_mfma_f32_32x32x16_bf16 v[76:91], v[124:127], v[164:167], v[76:91]
  ds_read_b128 v[172:175], v17 offset:49152
  ds_read_b128 v[180:183], v21 offset:49152
  s_add_u32 s84, s34, 19922944
  s_addc_u32 s85, s35, 0
  s_waitcnt lgkmcnt(2)
  v_mfma_f32_32x32x16_bf16 v[92:107], v[124:127], v[168:171], v[92:107]
  ds_read_b128 v[176:179], v17 offset:53248
  ds_read_b128 v[184:187], v21 offset:53248
  s_mov_b32 s86, 32768
  s_mov_b32 s87, 0x20000
  v_mfma_f32_32x32x16_bf16 v[144:159], v[160:163], v[168:171], v[144:159]
  buffer_load_dwordx4 v14, s[56:59], s10 offen offset:2048 lds
  v_mov_b32 v74, 0
  v_mfma_f32_32x32x16_bf16 v[108:123], v[160:163], v[164:167], v[108:123]
  buffer_load_dwordx4 v15, s[56:59], s10 offen offset:3072 lds
  v_mov_b32 v75, 0
  s_waitcnt vmcnt(37)
  v_dot2c_f32_bf16 v74, v32, v48
  s_waitcnt lgkmcnt(2)
  v_mfma_f32_32x32x16_bf16 v[76:91], v[172:175], v[180:183], v[76:91]
  ds_read_b128 v[124:127], v18 offset:49152
  ds_read_b128 v[164:167], v22 offset:49152
  v_dot2c_f32_bf16 v75, v40, v48
  s_waitcnt lgkmcnt(2)
  v_mfma_f32_32x32x16_bf16 v[92:107], v[172:175], v[184:187], v[92:107]
  ds_read_b128 v[160:163], v18 offset:53248
  ds_read_b128 v[168:171], v22 offset:53248
  v_dot2c_f32_bf16 v74, v33, v49
  v_dot2c_f32_bf16 v75, v41, v49
  v_mfma_f32_32x32x16_bf16 v[144:159], v[176:179], v[184:187], v[144:159]
  s_add_u32 m0, s16, 32768
  s_nop 0
  buffer_load_dwordx4 v8, s[44:47], s10 offen offset:0 lds
  v_dot2c_f32_bf16 v74, v34, v50
  v_mfma_f32_32x32x16_bf16 v[108:123], v[176:179], v[180:183], v[108:123]
  buffer_load_dwordx4 v9, s[44:47], s10 offen offset:1024 lds
  v_dot2c_f32_bf16 v75, v42, v50
  v_dot2c_f32_bf16 v74, v35, v51
  s_waitcnt lgkmcnt(2)
  v_mfma_f32_32x32x16_bf16 v[76:91], v[124:127], v[164:167], v[76:91]
  ds_read_b128 v[172:175], v19 offset:49152
  ds_read_b128 v[180:183], v23 offset:49152
  v_dot2c_f32_bf16 v75, v43, v51
  s_waitcnt lgkmcnt(2)
  v_mfma_f32_32x32x16_bf16 v[92:107], v[124:127], v[168:171], v[92:107]
  ds_read_b128 v[176:179], v19 offset:53248
  ds_read_b128 v[184:187], v23 offset:53248
  s_waitcnt vmcnt(38)
  v_dot2c_f32_bf16 v74, v36, v52
  v_dot2c_f32_bf16 v75, v44, v52
  v_mfma_f32_32x32x16_bf16 v[144:159], v[160:163], v[168:171], v[144:159]
  buffer_load_dwordx4 v10, s[44:47], s10 offen offset:2048 lds
  v_dot2c_f32_bf16 v74, v37, v53
  v_mfma_f32_32x32x16_bf16 v[108:123], v[160:163], v[164:167], v[108:123]
  buffer_load_dwordx4 v11, s[44:47], s10 offen offset:3072 lds
  s_add_u32 s10, s10, 128
  s_and_b32 s10, s10, 0x7ff
  v_dot2c_f32_bf16 v75, v45, v53
  v_dot2c_f32_bf16 v74, v38, v54
  s_waitcnt vmcnt(16) lgkmcnt(0)
  s_barrier
  v_mfma_f32_32x32x16_bf16 v[76:91], v[172:175], v[180:183], v[76:91]
  ds_read_b128 v[124:127], v16 offset:0
  ds_read_b128 v[164:167], v20 offset:0
  v_dot2c_f32_bf16 v75, v46, v54
  v_mfma_f32_32x32x16_bf16 v[92:107], v[172:175], v[184:187], v[92:107]
  ds_read_b128 v[160:163], v16 offset:4096
  ds_read_b128 v[168:171], v20 offset:4096
  v_dot2c_f32_bf16 v74, v39, v55
  v_dot2c_f32_bf16 v75, v47, v55
  v_mfma_f32_32x32x16_bf16 v[144:159], v[176:179], v[184:187], v[144:159]
  s_add_u32 m0, s17, 49152
  s_nop 0
  buffer_load_dwordx4 v12, s[56:59], s10 offen offset:0 lds
  s_lshl_b32 s6, s39, 11
  v_mfma_f32_32x32x16_bf16 v[108:123], v[176:179], v[180:183], v[108:123]
  buffer_load_dwordx4 v13, s[56:59], s10 offen offset:1024 lds
  s_lshl_b32 s7, s38, 7
  s_add_u32 s6, s6, s7
  s_waitcnt lgkmcnt(2)
  v_mfma_f32_32x32x16_bf16 v[76:91], v[124:127], v[164:167], v[76:91]
  ds_read_b128 v[172:175], v17 offset:0
  ds_read_b128 v[180:183], v21 offset:0
  v_permlane32_swap_b32 v74, v75
  v_add_f32 v74, v74, v75
  s_waitcnt lgkmcnt(2)
  v_mfma_f32_32x32x16_bf16 v[92:107], v[124:127], v[168:171], v[92:107]
  ds_read_b128 v[176:179], v17 offset:4096
  ds_read_b128 v[184:187], v21 offset:4096
  v_mov_b32 v75, v74
  v_mfma_f32_32x32x16_bf16 v[144:159], v[160:163], v[168:171], v[144:159]
  buffer_load_dwordx4 v14, s[56:59], s10 offen offset:2048 lds
  s_lshl_b32 s7, s3, 3
  s_add_u32 s6, s6, s7
  v_mfma_f32_32x32x16_bf16 v[108:123], v[160:163], v[164:167], v[108:123]
  buffer_load_dwordx4 v15, s[56:59], s10 offen offset:3072 lds
  v_permlane16_swap_b32 v74, v75
  s_waitcnt lgkmcnt(2)
  v_mfma_f32_32x32x16_bf16 v[76:91], v[172:175], v[180:183], v[76:91]
  ds_read_b128 v[124:127], v18 offset:0
  ds_read_b128 v[164:167], v22 offset:0
  v_add_f32 v74, v74, v75
  s_nop 1
  v_add_f32 v74, v74, v74 row_ror:8 row_mask:0xf bank_mask:0xf
  s_waitcnt lgkmcnt(2)
  v_mfma_f32_32x32x16_bf16 v[92:107], v[172:175], v[184:187], v[92:107]
  ds_read_b128 v[160:163], v18 offset:4096
  ds_read_b128 v[168:171], v22 offset:4096
  v_add_f32 v74, v74, v74 row_ror:4 row_mask:0xf bank_mask:0xf
  v_mfma_f32_32x32x16_bf16 v[144:159], v[176:179], v[184:187], v[144:159]
  s_add_u32 m0, s16, 49152
  s_nop 0
  buffer_load_dwordx4 v8, s[44:47], s10 offen offset:0 lds
  v_add_f32 v74, v74, v74 row_ror:2 row_mask:0xf bank_mask:0xf
  s_nop 1
  v_add_f32 v74, v74, v74 row_ror:1 row_mask:0xf bank_mask:0xf
  v_mfma_f32_32x32x16_bf16 v[108:123], v[176:179], v[180:183], v[108:123]
  buffer_load_dwordx4 v9, s[44:47], s10 offen offset:1024 lds
  v_cvt_pk_bf16_f32 v74, v74, v74
  s_waitcnt lgkmcnt(2)
  v_mfma_f32_32x32x16_bf16 v[76:91], v[124:127], v[164:167], v[76:91]
  ds_read_b128 v[172:175], v19 offset:0
  ds_read_b128 v[180:183], v23 offset:0
  v_and_b32 v74, 0xffff0000, v74
  v_mul_f32 v74, 0xbfb8aa3b, v74
  s_waitcnt lgkmcnt(2)
  v_mfma_f32_32x32x16_bf16 v[92:107], v[124:127], v[168:171], v[92:107]
  ds_read_b128 v[176:179], v19 offset:4096
  ds_read_b128 v[184:187], v23 offset:4096
  v_exp_f32 v74, v74
  v_mfma_f32_32x32x16_bf16 v[144:159], v[160:163], v[168:171], v[144:159]
  buffer_load_dwordx4 v10, s[44:47], s10 offen offset:2048 lds
  v_lshrrev_b32 v29, 3, v4
  v_add_f32 v74, 1.0, v74
  v_mfma_f32_32x32x16_bf16 v[108:123], v[160:163], v[164:167], v[108:123]
  buffer_load_dwordx4 v11, s[44:47], s10 offen offset:3072 lds
  s_add_u32 s10, s10, 128
  s_and_b32 s10, s10, 0x7ff
  v_rcp_f32 v74, v74
  s_waitcnt vmcnt(16) lgkmcnt(0)
  s_barrier
  v_mfma_f32_32x32x16_bf16 v[76:91], v[172:175], v[180:183], v[76:91]
  ds_read_b128 v[124:127], v16 offset:16384
  ds_read_b128 v[164:167], v20 offset:16384
  s_mov_b32 exec_lo, 1
  s_mov_b32 exec_hi, 1
  v_cvt_pk_bf16_f32 v74, v74, v74
  v_and_b32 v74, 0xffff0000, v74
  buffer_store_dword v74, v29, s[84:87], s6 offen sc1
  s_mov_b64 exec, -1
  v_mfma_f32_32x32x16_bf16 v[92:107], v[172:175], v[184:187], v[92:107]
  ds_read_b128 v[160:163], v16 offset:20480
  ds_read_b128 v[168:171], v20 offset:20480
  s_cmp_lg_u32 s3, 1
  s_cbranch_scc1 gated_mix__spectral_gfnet__ssm_conv_s5__prompt_kernel_skip14
  s_getpc_b64 s[36:37]
gated_mix__spectral_gfnet__ssm_conv_s5__prompt_kernel_pc13:
  s_lshr_b32 s25, s2, 3
  s_mul_i32 s25, s25, 512
  v_min_u32 v210, 3, v4
  v_lshl_add_u32 v210, v210, 7, s25
  v_min_u32 v210, gated_mix__spectral_gfnet__ssm_conv_s5__prompt_kernel_end-gated_mix__spectral_gfnet__ssm_conv_s5__prompt_kernel_pc13, v210
  v_mov_b32 v211, 0
  v_lshl_add_u64 v[210:211], v[210:211], 0, s[36:37]
  global_load_dword v1, v[210:211], off
gated_mix__spectral_gfnet__ssm_conv_s5__prompt_kernel_skip14:
  buffer_load_dword v208, v2, s[52:55], 0 offen sc1
  v_mfma_f32_32x32x16_bf16 v[144:159], v[176:179], v[184:187], v[144:159]
  s_add_u32 m0, s17, 0
  s_nop 0
  buffer_load_dwordx4 v12, s[56:59], s10 offen offset:0 lds
  v_mfma_f32_32x32x16_bf16 v[108:123], v[176:179], v[180:183], v[108:123]
  buffer_load_dwordx4 v13, s[56:59], s10 offen offset:1024 lds
  s_waitcnt lgkmcnt(2)
  v_mfma_f32_32x32x16_bf16 v[76:91], v[124:127], v[164:167], v[76:91]
  ds_read_b128 v[172:175], v17 offset:16384
  ds_read_b128 v[180:183], v21 offset:16384
  v_lshlrev_b32 v29, 4, v4
  s_waitcnt lgkmcnt(2)
  v_mfma_f32_32x32x16_bf16 v[92:107], v[124:127], v[168:171], v[92:107]
  ds_read_b128 v[176:179], v17 offset:20480
  ds_read_b128 v[184:187], v21 offset:20480
  v_add_u32 v29, 147456, v29
  v_mfma_f32_32x32x16_bf16 v[144:159], v[160:163], v[168:171], v[144:159]
  buffer_load_dwordx4 v14, s[56:59], s10 offen offset:2048 lds
  ds_read_b128 v[32:35], v29 offset:0
  v_mfma_f32_32x32x16_bf16 v[108:123], v[160:163], v[164:167], v[108:123]
  buffer_load_dwordx4 v15, s[56:59], s10 offen offset:3072 lds
  ds_read_b128 v[36:39], v29 offset:1024
  s_waitcnt lgkmcnt(4)
  v_mfma_f32_32x32x16_bf16 v[76:91], v[172:175], v[180:183], v[76:91]
  ds_read_b128 v[124:127], v18 offset:16384
  ds_read_b128 v[164:167], v22 offset:16384
  ds_read_b128 a[224:227], v29 offset:2048
  s_waitcnt lgkmcnt(5)
  v_mfma_f32_32x32x16_bf16 v[92:107], v[172:175], v[184:187], v[92:107]
  ds_read_b128 v[160:163], v18 offset:20480
  ds_read_b128 v[168:171], v22 offset:20480
  ds_read_b128 a[228:231], v29 offset:3072
  v_mfma_f32_32x32x16_bf16 v[144:159], v[176:179], v[184:187], v[144:159]
  s_add_u32 m0, s16, 0
  s_nop 0
  buffer_load_dwordx4 v8, s[44:47], s10 offen offset:0 lds
  ds_read_b128 a[248:251], v29 offset:4096
  v_mfma_f32_32x32x16_bf16 v[108:123], v[176:179], v[180:183], v[108:123]
  buffer_load_dwordx4 v9, s[44:47], s10 offen offset:1024 lds
  ds_read_b128 a[252:255], v29 offset:5120
  s_waitcnt lgkmcnt(6)
  v_mfma_f32_32x32x16_bf16 v[76:91], v[124:127], v[164:167], v[76:91]
  ds_read_b128 v[172:175], v19 offset:16384
  ds_read_b128 v[180:183], v23 offset:16384
  ds_read_b128 a[232:235], v29 offset:6144
  s_waitcnt lgkmcnt(6)
  v_mfma_f32_32x32x16_bf16 v[92:107], v[124:127], v[168:171], v[92:107]
  ds_read_b128 v[176:179], v19 offset:20480
  ds_read_b128 v[184:187], v23 offset:20480
  ds_read_b128 a[236:239], v29 offset:7168
  v_mfma_f32_32x32x16_bf16 v[144:159], v[160:163], v[168:171], v[144:159]
  buffer_load_dwordx4 v10, s[44:47], s10 offen offset:2048 lds
  ds_read_b128 v[40:43], v29 offset:8192
  v_mfma_f32_32x32x16_bf16 v[108:123], v[160:163], v[164:167], v[108:123]
  buffer_load_dwordx4 v11, s[44:47], s10 offen offset:3072 lds
  s_add_u32 s10, s10, 128
  s_and_b32 s10, s10, 0x7ff
  s_waitcnt vmcnt(18) lgkmcnt(2)
  s_barrier
  v_mfma_f32_32x32x16_bf16 v[76:91], v[172:175], v[180:183], v[76:91]
  ds_read_b128 v[124:127], v16 offset:32768
  ds_read_b128 v[164:167], v20 offset:32768
  ds_read_b128 v[44:47], v29 offset:9216
  v_mfma_f32_32x32x16_bf16 v[92:107], v[172:175], v[184:187], v[92:107]
  ds_read_b128 v[160:163], v16 offset:36864
  ds_read_b128 v[168:171], v20 offset:36864
  ds_read_b128 v[48:51], v29 offset:10240
  v_mfma_f32_32x32x16_bf16 v[144:159], v[176:179], v[184:187], v[144:159]
  s_add_u32 m0, s17, 16384
  s_nop 0
  buffer_load_dwordx4 v12, s[56:59], s10 offen offset:0 lds
  ds_read_b128 v[52:55], v29 offset:11264
  v_mfma_f32_32x32x16_bf16 v[108:123], v[176:179], v[180:183], v[108:123]
  buffer_load_dwordx4 v13, s[56:59], s10 offen offset:1024 lds
  ds_read_b128 a[240:243], v29 offset:12288
  s_waitcnt lgkmcnt(6)
  v_mfma_f32_32x32x16_bf16 v[76:91], v[124:127], v[164:167], v[76:91]
  ds_read_b128 v[172:175], v17 offset:32768
  ds_read_b128 v[180:183], v21 offset:32768
  ds_read_b128 a[244:247], v29 offset:13312
  s_waitcnt lgkmcnt(6)
  v_mfma_f32_32x32x16_bf16 v[92:107], v[124:127], v[168:171], v[92:107]
  ds_read_b128 v[176:179], v17 offset:36864
  ds_read_b128 v[184:187], v21 offset:36864
  ds_read_b128 v[136:139], v29 offset:14336
  v_mfma_f32_32x32x16_bf16 v[144:159], v[160:163], v[168:171], v[144:159]
  buffer_load_dwordx4 v14, s[56:59], s10 offen offset:2048 lds
  ds_read_b128 v[140:143], v29 offset:15360
  v_mfma_f32_32x32x16_bf16 v[108:123], v[160:163], v[164:167], v[108:123]
  buffer_load_dwordx4 v15, s[56:59], s10 offen offset:3072 lds
  s_lshl_b32 s88, s3, 9
  s_waitcnt lgkmcnt(5)
  v_mfma_f32_32x32x16_bf16 v[76:91], v[172:175], v[180:183], v[76:91]
  ds_read_b128 v[124:127], v18 offset:32768
  ds_read_b128 v[164:167], v22 offset:32768
  s_add_u32 s88, s88, s13
  s_waitcnt lgkmcnt(4)
  v_mfma_f32_32x32x16_bf16 v[92:107], v[172:175], v[184:187], v[92:107]
  ds_read_b128 v[160:163], v18 offset:36864
  ds_read_b128 v[168:171], v22 offset:36864
  s_lshr_b32 s8, s3, 1
  v_mfma_f32_32x32x16_bf16 v[144:159], v[176:179], v[184:187], v[144:159]
  s_add_u32 m0, s16, 16384
  s_nop 0
  buffer_load_dwordx4 v8, s[44:47], s10 offen offset:0 lds
  v_mfma_f32_32x32x16_bf16 v[108:123], v[176:179], v[180:183], v[108:123]
  buffer_load_dwordx4 v9, s[44:47], s10 offen offset:1024 lds
  s_and_b32 s8, s8, s14
  s_waitcnt lgkmcnt(2)
  v_mfma_f32_32x32x16_bf16 v[76:91], v[124:127], v[164:167], v[76:91]
  ds_read_b128 v[172:175], v19 offset:32768
  ds_read_b128 v[180:183], v23 offset:32768
  s_mul_i32 s8, s8, 960
  s_waitcnt lgkmcnt(2)
  v_mfma_f32_32x32x16_bf16 v[92:107], v[124:127], v[168:171], v[92:107]
  ds_read_b128 v[176:179], v19 offset:36864
  ds_read_b128 v[184:187], v23 offset:36864
  s_sub_u32 s88, s88, s8
  v_mfma_f32_32x32x16_bf16 v[144:159], v[160:163], v[168:171], v[144:159]
  buffer_load_dwordx4 v10, s[44:47], s10 offen offset:2048 lds
  s_add_u32 s90, s88, 128
  v_mfma_f32_32x32x16_bf16 v[108:123], v[160:163], v[164:167], v[108:123]
  buffer_load_dwordx4 v11, s[44:47], s10 offen offset:3072 lds
  s_add_u32 s10, s10, 128
  s_and_b32 s10, s10, 0x7ff
  s_add_u32 s92, s88, 256
  s_waitcnt vmcnt(18) lgkmcnt(0)
  s_barrier
  v_mfma_f32_32x32x16_bf16 v[76:91], v[172:175], v[180:183], v[76:91]
  ds_read_b128 v[124:127], v16 offset:49152
  ds_read_b128 v[164:167], v20 offset:49152
  s_add_u32 s94, s88, 384
  v_mfma_f32_32x32x16_bf16 v[92:107], v[172:175], v[184:187], v[92:107]
  ds_read_b128 v[160:163], v16 offset:53248
  ds_read_b128 v[168:171], v20 offset:53248
  s_sub_u32 s89, 2048, s88
  v_mfma_f32_32x32x16_bf16 v[144:159], v[176:179], v[184:187], v[144:159]
  s_add_u32 m0, s17, 32768
  s_nop 0
  buffer_load_dwordx4 v12, s[56:59], s10 offen offset:0 lds
  s_and_b32 s89, s89, 2047
  v_mfma_f32_32x32x16_bf16 v[108:123], v[176:179], v[180:183], v[108:123]
  buffer_load_dwordx4 v13, s[56:59], s10 offen offset:1024 lds
  s_sub_u32 s91, 2048, s90
  s_waitcnt lgkmcnt(2)
  v_mfma_f32_32x32x16_bf16 v[76:91], v[124:127], v[164:167], v[76:91]
  ds_read_b128 v[172:175], v17 offset:49152
  ds_read_b128 v[180:183], v21 offset:49152
  s_and_b32 s91, s91, 2047
  s_waitcnt lgkmcnt(2)
  v_mfma_f32_32x32x16_bf16 v[92:107], v[124:127], v[168:171], v[92:107]
  ds_read_b128 v[176:179], v17 offset:53248
  ds_read_b128 v[184:187], v21 offset:53248
  s_sub_u32 s93, 2048, s92
  v_mfma_f32_32x32x16_bf16 v[144:159], v[160:163], v[168:171], v[144:159]
  buffer_load_dwordx4 v14, s[56:59], s10 offen offset:2048 lds
  v_mfma_f32_32x32x16_bf16 v[108:123], v[160:163], v[164:167], v[108:123]
  buffer_load_dwordx4 v15, s[56:59], s10 offen offset:3072 lds
  s_and_b32 s93, s93, 2047
  s_waitcnt lgkmcnt(2)
  v_mfma_f32_32x32x16_bf16 v[76:91], v[172:175], v[180:183], v[76:91]
  ds_read_b128 v[124:127], v18 offset:49152
  ds_read_b128 v[164:167], v22 offset:49152
  s_sub_u32 s95, 2048, s94
  s_waitcnt lgkmcnt(2)
  v_mfma_f32_32x32x16_bf16 v[92:107], v[172:175], v[184:187], v[92:107]
  ds_read_b128 v[160:163], v18 offset:53248
  ds_read_b128 v[168:171], v22 offset:53248
  s_and_b32 s95, s95, 2047
  v_mfma_f32_32x32x16_bf16 v[144:159], v[176:179], v[184:187], v[144:159]
  s_add_u32 m0, s16, 32768
  s_nop 0
  buffer_load_dwordx4 v8, s[44:47], s10 offen offset:0 lds
  s_cmp_eq_u32 s3, 0
  s_cselect_b32 s9, s14, 0
  v_mfma_f32_32x32x16_bf16 v[108:123], v[176:179], v[180:183], v[108:123]
  buffer_load_dwordx4 v9, s[44:47], s10 offen offset:1024 lds
  s_waitcnt lgkmcnt(2)
  v_mfma_f32_32x32x16_bf16 v[76:91], v[124:127], v[164:167], v[76:91]
  ds_read_b128 v[172:175], v19 offset:49152
  ds_read_b128 v[180:183], v23 offset:49152
  s_cmp_eq_u32 s9, 1
  s_cselect_b32 s89, 1024, s89
  s_waitcnt lgkmcnt(2)
  v_mfma_f32_32x32x16_bf16 v[92:107], v[124:127], v[168:171], v[92:107]
  ds_read_b128 v[176:179], v19 offset:53248
  ds_read_b128 v[184:187], v23 offset:53248
  v_mfma_f32_32x32x16_bf16 v[144:159], v[160:163], v[168:171], v[144:159]
  buffer_load_dwordx4 v10, s[44:47], s10 offen offset:2048 lds
  s_mul_i32 s88, s88, 1026
  v_mfma_f32_32x32x16_bf16 v[108:123], v[160:163], v[164:167], v[108:123]
  buffer_load_dwordx4 v11, s[44:47], s10 offen offset:3072 lds
  s_add_u32 s10, s10, 128
  s_and_b32 s10, s10, 0x7ff
  s_mul_i32 s89, s89, 1026
  s_waitcnt vmcnt(25)
  s_waitcnt vmcnt(16) lgkmcnt(0)
  s_barrier
  v_mfma_f32_32x32x16_bf16 v[76:91], v[172:175], v[180:183], v[76:91]
  ds_read_b128 v[124:127], v16 offset:0
  ds_read_b128 v[164:167], v20 offset:0
  s_mul_i32 s90, s90, 1026
  v_mfma_f32_32x32x16_bf16 v[92:107], v[172:175], v[184:187], v[92:107]
  ds_read_b128 v[160:163], v16 offset:4096
  ds_read_b128 v[168:171], v20 offset:4096
  v_cmp_ne_u32 vcc, 1, v208
  s_nop 0
  s_cbranch_vccz gated_mix__spectral_gfnet__ssm_conv_s5__prompt_kernel_skip15
  s_mov_b32 s25, 0
gated_mix__spectral_gfnet__ssm_conv_s5__prompt_kernel_poll16:
  s_sleep 16
  buffer_load_dword v208, v2, s[52:55], 0 offen sc1
  s_waitcnt vmcnt(0)
  v_cmp_ne_u32 vcc, 1, v208
  s_nop 0
  s_cbranch_vccz gated_mix__spectral_gfnet__ssm_conv_s5__prompt_kernel_pollout17
  s_add_u32 s25, s25, 1
  s_cmp_lt_u32 s25, 1048576
  s_cbranch_scc1 gated_mix__spectral_gfnet__ssm_conv_s5__prompt_kernel_poll16
gated_mix__spectral_gfnet__ssm_conv_s5__prompt_kernel_pollout17:
gated_mix__spectral_gfnet__ssm_conv_s5__prompt_kernel_skip15:
  s_cmp_lg_u32 s3, 0
  s_cbranch_scc1 gated_mix__spectral_gfnet__ssm_conv_s5__prompt_kernel_skip18
  s_mov_b64 exec, 1
  buffer_store_dword v7, v24, s[48:51], 0 offen sc1
  s_mov_b64 exec, -1
gated_mix__spectral_gfnet__ssm_conv_s5__prompt_kernel_skip18:
  v_mfma_f32_32x32x16_bf16 v[144:159], v[176:179], v[184:187], v[144:159]
  s_add_u32 m0, s17, 49152
  s_nop 0
  buffer_load_dwordx4 v12, s[56:59], s10 offen offset:0 lds
  s_mul_i32 s91, s91, 1026
  v_mfma_f32_32x32x16_bf16 v[108:123], v[176:179], v[180:183], v[108:123]
  buffer_load_dwordx4 v13, s[56:59], s10 offen offset:1024 lds
  s_mul_i32 s92, s92, 1026
  s_waitcnt lgkmcnt(2)
  v_mfma_f32_32x32x16_bf16 v[76:91], v[124:127], v[164:167], v[76:91]
  ds_read_b128 v[172:175], v17 offset:0
  ds_read_b128 v[180:183], v21 offset:0
  s_mul_i32 s93, s93, 1026
  s_waitcnt lgkmcnt(2)
  v_mfma_f32_32x32x16_bf16 v[92:107], v[124:127], v[168:171], v[92:107]
  ds_read_b128 v[176:179], v17 offset:4096
  ds_read_b128 v[184:187], v21 offset:4096
  s_mul_i32 s94, s94, 1026
  v_mfma_f32_32x32x16_bf16 v[144:159], v[160:163], v[168:171], v[144:159]
  buffer_load_dwordx4 v14, s[56:59], s10 offen offset:2048 lds
  s_mul_i32 s95, s95, 1026
  v_mfma_f32_32x32x16_bf16 v[108:123], v[160:163], v[164:167], v[108:123]
  buffer_load_dwordx4 v15, s[56:59], s10 offen offset:3072 lds
  v_lshlrev_b32 v29, 4, v4
  s_waitcnt lgkmcnt(2)
  v_mfma_f32_32x32x16_bf16 v[76:91], v[172:175], v[180:183], v[76:91]
  ds_read_b128 v[124:127], v18 offset:0
  ds_read_b128 v[164:167], v22 offset:0
  s_lshl_b32 s6, s3, 12
  s_waitcnt lgkmcnt(2)
  v_mfma_f32_32x32x16_bf16 v[92:107], v[172:175], v[184:187], v[92:107]
  ds_read_b128 v[160:163], v18 offset:4096
  ds_read_b128 v[168:171], v22 offset:4096
  s_and_b32 s8, s88, 15
  v_mfma_f32_32x32x16_bf16 v[144:159], v[176:179], v[184:187], v[144:159]
  s_add_u32 m0, s16, 49152
  s_nop 0
  buffer_load_dwordx4 v8, s[44:47], s10 offen offset:0 lds
  s_and_b32 s21, s89, 15
  v_mfma_f32_32x32x16_bf16 v[108:123], v[176:179], v[180:183], v[108:123]
  buffer_load_dwordx4 v9, s[44:47], s10 offen offset:1024 lds
  s_add_u32 s21, s21, 2048
  s_waitcnt lgkmcnt(2)
  v_mfma_f32_32x32x16_bf16 v[76:91], v[124:127], v[164:167], v[76:91]
  ds_read_b128 v[172:175], v19 offset:0
  ds_read_b128 v[180:183], v23 offset:0
  v_lshlrev_b32 v57, 9, v6
  s_waitcnt lgkmcnt(2)
  v_mfma_f32_32x32x16_bf16 v[92:107], v[124:127], v[168:171], v[92:107]
  ds_read_b128 v[176:179], v19 offset:4096
  ds_read_b128 v[184:187], v23 offset:4096
  v_mfma_f32_32x32x16_bf16 v[144:159], v[160:163], v[168:171], v[144:159]
  buffer_load_dwordx4 v10, s[44:47], s10 offen offset:2048 lds
  v_lshl_add_u32 v57, v5, 3, v57
  v_mfma_f32_32x32x16_bf16 v[108:123], v[160:163], v[164:167], v[108:123]
  buffer_load_dwordx4 v11, s[44:47], s10 offen offset:3072 lds
  s_add_u32 s10, s10, 128
  s_and_b32 s10, s10, 0x7ff
  s_lshl_b32 s24, s12, 1
  s_waitcnt vmcnt(16) lgkmcnt(0)
  s_barrier
  v_mfma_f32_32x32x16_bf16 v[76:91], v[172:175], v[180:183], v[76:91]
  ds_read_b128 v[124:127], v16 offset:16384
  ds_read_b128 v[164:167], v20 offset:16384
  v_add_u32 v57, s24, v57
  v_mfma_f32_32x32x16_bf16 v[92:107], v[172:175], v[184:187], v[92:107]
  ds_read_b128 v[160:163], v16 offset:20480
  ds_read_b128 v[168:171], v20 offset:20480
  s_add_u32 s24, s21, 1664
  v_mfma_f32_32x32x16_bf16 v[144:159], v[176:179], v[184:187], v[144:159]
  s_add_u32 m0, s17, 0
  s_nop 0
  buffer_load_dwordx4 v12, s[56:59], s10 offen offset:0 lds
  v_sub_u32 v75, s24, v57
  v_mfma_f32_32x32x16_bf16 v[108:123], v[176:179], v[180:183], v[108:123]
  buffer_load_dwordx4 v13, s[56:59], s10 offen offset:1024 lds
  v_add_u32 v57, s8, v57
  s_waitcnt lgkmcnt(2)
  v_mfma_f32_32x32x16_bf16 v[76:91], v[124:127], v[164:167], v[76:91]
  ds_read_b128 v[172:175], v17 offset:16384
  ds_read_b128 v[180:183], v21 offset:16384
  v_cmp_lt_u32 s[22:23], 1, v6
  s_waitcnt lgkmcnt(2)
  v_mfma_f32_32x32x16_bf16 v[92:107], v[124:127], v[168:171], v[92:107]
  ds_read_b128 v[176:179], v17 offset:20480
  ds_read_b128 v[184:187], v21 offset:20480
  v_cndmask_b32 v57, v57, v75, s[22:23]
  v_mfma_f32_32x32x16_bf16 v[144:159], v[160:163], v[168:171], v[144:159]
  buffer_load_dwordx4 v14, s[56:59], s10 offen offset:2048 lds
  v_cndmask_b32 v188, 1.0, -1.0, s[22:23]
  v_mfma_f32_32x32x16_bf16 v[108:123], v[160:163], v[164:167], v[108:123]
  buffer_load_dwordx4 v15, s[56:59], s10 offen offset:3072 lds
  v_add_u32 v74, 384, v57
  s_waitcnt lgkmcnt(2)
  v_mfma_f32_32x32x16_bf16 v[76:91], v[172:175], v[180:183], v[76:91]
  ds_read_b128 v[124:127], v18 offset:16384
  ds_read_b128 v[164:167], v22 offset:16384
  s_waitcnt lgkmcnt(2)
  v_mfma_f32_32x32x16_bf16 v[92:107], v[172:175], v[184:187], v[92:107]
  ds_read_b128 v[160:163], v18 offset:20480
  ds_read_b128 v[168:171], v22 offset:20480
  v_and_b32 v75, 1024, v74
  v_mfma_f32_32x32x16_bf16 v[144:159], v[176:179], v[184:187], v[144:159]
  s_add_u32 m0, s16, 0
  s_nop 0
  buffer_load_dwordx4 v8, s[44:47], s10 offen offset:0 lds
  v_cmp_ne_u32 s[28:29], 0, v75
  v_mfma_f32_32x32x16_bf16 v[108:123], v[176:179], v[180:183], v[108:123]
  buffer_load_dwordx4 v9, s[44:47], s10 offen offset:1024 lds
  s_lshl_b32 s24, s3, 8
  s_waitcnt lgkmcnt(2)
  v_mfma_f32_32x32x16_bf16 v[76:91], v[124:127], v[164:167], v[76:91]
  ds_read_b128 v[172:175], v19 offset:16384
  ds_read_b128 v[180:183], v23 offset:16384
  s_add_u32 s24, s24, 146432
  s_waitcnt lgkmcnt(2)
  v_mfma_f32_32x32x16_bf16 v[92:107], v[124:127], v[168:171], v[92:107]
  ds_read_b128 v[176:179], v19 offset:20480
  ds_read_b128 v[184:187], v23 offset:20480
  v_add_u32 v75, s24, v74
  v_mfma_f32_32x32x16_bf16 v[144:159], v[160:163], v[168:171], v[144:159]
  buffer_load_dwordx4 v10, s[44:47], s10 offen offset:2048 lds
  v_add_u32 v57, s6, v57
  v_mfma_f32_32x32x16_bf16 v[108:123], v[160:163], v[164:167], v[108:123]
  buffer_load_dwordx4 v11, s[44:47], s10 offen offset:3072 lds
  s_add_u32 s10, s10, 128
  s_and_b32 s10, s10, 0x7ff
  v_add_u32 v74, s6, v74
  s_waitcnt vmcnt(16) lgkmcnt(0)
  s_barrier
  v_mfma_f32_32x32x16_bf16 v[76:91], v[172:175], v[180:183], v[76:91]
  ds_read_b128 v[124:127], v16 offset:32768
  ds_read_b128 v[164:167], v20 offset:32768
  v_cndmask_b32 v74, v74, v75, s[28:29]
  v_mfma_f32_32x32x16_bf16 v[92:107], v[172:175], v[184:187], v[92:107]
  ds_read_b128 v[160:163], v16 offset:36864
  ds_read_b128 v[168:171], v20 offset:36864
  v_sub_u32 v74, v74, v57
  v_mfma_f32_32x32x16_bf16 v[144:159], v[176:179], v[184:187], v[144:159]
  s_add_u32 m0, s17, 16384
  s_nop 0
  buffer_load_dwordx4 v12, s[56:59], s10 offen offset:0 lds
  v_cndmask_b32 v189, 0, -1, s[28:29]
  v_mfma_f32_32x32x16_bf16 v[108:123], v[176:179], v[180:183], v[108:123]
  buffer_load_dwordx4 v13, s[56:59], s10 offen offset:1024 lds
  s_waitcnt lgkmcnt(2)
  v_mfma_f32_32x32x16_bf16 v[76:91], v[124:127], v[164:167], v[76:91]
  ds_read_b128 v[172:175], v17 offset:32768
  ds_read_b128 v[180:183], v21 offset:32768
  v_lshlrev_b32 v26, 16, v26
  v_lshlrev_b32 v27, 16, v27
  s_waitcnt lgkmcnt(2)
  v_mfma_f32_32x32x16_bf16 v[92:107], v[124:127], v[168:171], v[92:107]
  ds_read_b128 v[176:179], v17 offset:36864
  ds_read_b128 v[184:187], v21 offset:36864
  v_lshlrev_b32 v28, 16, v28
  v_mfma_f32_32x32x16_bf16 v[144:159], v[160:163], v[168:171], v[144:159]
  buffer_load_dwordx4 v14, s[56:59], s10 offen offset:2048 lds
  v_mul_f32 v28, 0x3fb8aa3b, v28
  v_mfma_f32_32x32x16_bf16 v[108:123], v[160:163], v[164:167], v[108:123]
  buffer_load_dwordx4 v15, s[56:59], s10 offen offset:3072 lds
  v_exp_f32 v28, v28
  s_waitcnt lgkmcnt(2)
  v_mfma_f32_32x32x16_bf16 v[76:91], v[172:175], v[180:183], v[76:91]
  ds_read_b128 v[124:127], v18 offset:32768
  ds_read_b128 v[164:167], v22 offset:32768
  v_cvt_pk_bf16_f32 v28, v28, v28
  v_and_b32 v28, 0xffff0000, v28
  s_waitcnt lgkmcnt(2)
  v_mfma_f32_32x32x16_bf16 v[92:107], v[172:175], v[184:187], v[92:107]
  ds_read_b128 v[160:163], v18 offset:36864
  ds_read_b128 v[168:171], v22 offset:36864
  v_mul_f32 v204, v28, v26
  v_mfma_f32_32x32x16_bf16 v[144:159], v[176:179], v[184:187], v[144:159]
  s_add_u32 m0, s16, 16384
  s_nop 0
  buffer_load_dwordx4 v8, s[44:47], s10 offen offset:0 lds
  v_mul_f32 v205, v28, v27
  v_mfma_f32_32x32x16_bf16 v[108:123], v[176:179], v[180:183], v[108:123]
  buffer_load_dwordx4 v9, s[44:47], s10 offen offset:1024 lds
  v_mul_f32 v204, 0x3fb8aa3b, v204
  s_waitcnt lgkmcnt(2)
  v_mfma_f32_32x32x16_bf16 v[76:91], v[124:127], v[164:167], v[76:91]
  ds_read_b128 v[172:175], v19 offset:32768
  ds_read_b128 v[180:183], v23 offset:32768
  v_mul_f32 v205, 0.15915494, v205
  s_waitcnt lgkmcnt(2)
  v_mfma_f32_32x32x16_bf16 v[92:107], v[124:127], v[168:171], v[92:107]
  ds_read_b128 v[176:179], v19 offset:36864
  ds_read_b128 v[184:187], v23 offset:36864
  v_exp_f32 v204, v204
  v_rndne_f32 v206, v205
  v_mfma_f32_32x32x16_bf16 v[144:159], v[160:163], v[168:171], v[144:159]
  buffer_load_dwordx4 v10, s[44:47], s10 offen offset:2048 lds
  v_sub_f32 v205, v205, v206
  v_mfma_f32_32x32x16_bf16 v[108:123], v[160:163], v[164:167], v[108:123]
  buffer_load_dwordx4 v11, s[44:47], s10 offen offset:3072 lds
  s_add_u32 s10, s10, 128
  s_and_b32 s10, s10, 0x7ff
  v_cos_f32 v206, v205
  s_waitcnt vmcnt(16) lgkmcnt(0)
  s_barrier
  v_mfma_f32_32x32x16_bf16 v[76:91], v[172:175], v[180:183], v[76:91]
  ds_read_b128 v[124:127], v16 offset:49152
  ds_read_b128 v[164:167], v20 offset:49152
  v_sin_f32 v207, v205
  v_mfma_f32_32x32x16_bf16 v[92:107], v[172:175], v[184:187], v[92:107]
  ds_read_b128 v[160:163], v16 offset:53248
  ds_read_b128 v[168:171], v20 offset:53248
  v_mul_f32 v190, v204, v206
  v_mfma_f32_32x32x16_bf16 v[144:159], v[176:179], v[184:187], v[144:159]
  s_add_u32 m0, s17, 32768
  s_nop 0
  buffer_load_dwordx4 v12, s[56:59], s10 offen offset:0 lds
  v_mul_f32 v191, v204, v207
  v_mul_f32 v204, v26, v26
  v_mfma_f32_32x32x16_bf16 v[108:123], v[176:179], v[180:183], v[108:123]
  buffer_load_dwordx4 v13, s[56:59], s10 offen offset:1024 lds
  v_fma_f32 v204, v27, v27, v204
  s_waitcnt lgkmcnt(2)
  v_mfma_f32_32x32x16_bf16 v[76:91], v[124:127], v[164:167], v[76:91]
  ds_read_b128 v[172:175], v17 offset:49152
  ds_read_b128 v[180:183], v21 offset:49152
  v_rcp_f32 v204, v204
  s_waitcnt lgkmcnt(2)
  v_mfma_f32_32x32x16_bf16 v[92:107], v[124:127], v[168:171], v[92:107]
  ds_read_b128 v[176:179], v17 offset:53248
  ds_read_b128 v[184:187], v21 offset:53248
  v_add_f32 v205, -1.0, v190
  v_mfma_f32_32x32x16_bf16 v[144:159], v[160:163], v[168:171], v[144:159]
  buffer_load_dwordx4 v14, s[56:59], s10 offen offset:2048 lds
  v_add_f32 v204, v204, v204
  v_mul_f32 v206, v205, v26
  v_mfma_f32_32x32x16_bf16 v[108:123], v[160:163], v[164:167], v[108:123]
  buffer_load_dwordx4 v15, s[56:59], s10 offen offset:3072 lds
  v_fma_f32 v206, v191, v27, v206
  s_waitcnt lgkmcnt(2)
  v_mfma_f32_32x32x16_bf16 v[76:91], v[172:175], v[180:183], v[76:91]
  ds_read_b128 v[124:127], v18 offset:49152
  ds_read_b128 v[164:167], v22 offset:49152
  v_mul_f32 v207, v191, v26
  s_waitcnt lgkmcnt(2)
  v_mfma_f32_32x32x16_bf16 v[92:107], v[172:175], v[184:187], v[92:107]
  ds_read_b128 v[160:163], v18 offset:53248
  ds_read_b128 v[168:171], v22 offset:53248
  v_fma_f32 v207, -v205, v27, v207
  v_mfma_f32_32x32x16_bf16 v[144:159], v[176:179], v[184:187], v[144:159]
  s_add_u32 m0, s16, 32768
  s_nop 0
  buffer_load_dwordx4 v8, s[44:47], s10 offen offset:0 lds
  v_mul_f32 v200, v206, v204
  v_mfma_f32_32x32x16_bf16 v[108:123], v[176:179], v[180:183], v[108:123]
  buffer_load_dwordx4 v9, s[44:47], s10 offen offset:1024 lds
  v_mul_f32 v201, v207, v204
  v_mul_f32 v204, v191, v191
  s_waitcnt lgkmcnt(2)
  v_mfma_f32_32x32x16_bf16 v[76:91], v[124:127], v[164:167], v[76:91]
  ds_read_b128 v[172:175], v19 offset:49152
  ds_read_b128 v[180:183], v23 offset:49152
  v_mul_f32 v193, v190, v191
  s_waitcnt lgkmcnt(2)
  v_mfma_f32_32x32x16_bf16 v[92:107], v[124:127], v[168:171], v[92:107]
  ds_read_b128 v[176:179], v19 offset:53248
  ds_read_b128 v[184:187], v23 offset:53248
  v_fma_f32 v192, v190, v190, -v204
  v_mfma_f32_32x32x16_bf16 v[144:159], v[160:163], v[168:171], v[144:159]
  buffer_load_dwordx4 v10, s[44:47], s10 offen offset:2048 lds
  v_add_f32 v193, v193, v193
  v_mfma_f32_32x32x16_bf16 v[108:123], v[160:163], v[164:167], v[108:123]
  buffer_load_dwordx4 v11, s[44:47], s10 offen offset:3072 lds
  s_add_u32 s10, s10, 128
  s_and_b32 s10, s10, 0x7ff
  v_mul_f32 v204, v193, v193
  s_waitcnt vmcnt(16) lgkmcnt(0)
  s_barrier
  v_mfma_f32_32x32x16_bf16 v[76:91], v[172:175], v[180:183], v[76:91]
  ds_read_b128 v[124:127], v16 offset:0
  ds_read_b128 v[164:167], v20 offset:0
  v_mul_f32 v193, v192, v193
  v_fma_f32 v192, v192, v192, -v204
  v_mfma_f32_32x32x16_bf16 v[92:107], v[172:175], v[184:187], v[92:107]
  ds_read_b128 v[160:163], v16 offset:4096
  ds_read_b128 v[168:171], v20 offset:4096
  s_cmp_lg_u32 s3, 2
  s_cbranch_scc1 gated_mix__spectral_gfnet__ssm_conv_s5__prompt_kernel_skip20
  s_getpc_b64 s[36:37]
gated_mix__spectral_gfnet__ssm_conv_s5__prompt_kernel_pc19:
  s_lshr_b32 s25, s2, 3
  s_mul_i32 s25, s25, 512
  v_min_u32 v210, 3, v4
  v_lshl_add_u32 v210, v210, 7, s25
  v_min_u32 v210, gated_mix__spectral_gfnet__ssm_conv_s5__prompt_kernel_end-gated_mix__spectral_gfnet__ssm_conv_s5__prompt_kernel_pc19, v210
  v_mov_b32 v211, 0
  v_lshl_add_u64 v[210:211], v[210:211], 0, s[36:37]
  global_load_dword v1, v[210:211], off
gated_mix__spectral_gfnet__ssm_conv_s5__prompt_kernel_skip20:
  s_lshl_b32 s25, s41, 2
  s_add_u32 s25, s25, s3
  s_lshl_b32 s25, s25, 7
  s_add_u32 s25, s25, s40
  s_sub_u32 s26, 2048, s25
  s_and_b32 s26, s26, 2047
  s_mul_i32 s25, s25, 1026
  s_mul_i32 s26, s26, 1026
  s_sub_u32 s26, s26, s25
  v_and_b32 v208, 1, v6
  v_mul_lo_u32 v208, v208, s26
  v_lshl_add_u32 v56, v5, 7, s25
  v_add_u32 v56, v56, v208
  v_and_b32 v56, -4, v56
  s_mov_b64 exec, 0x01ff01ff
  buffer_load_dword v1, v56, s[72:75], 0 offen
  buffer_load_dword v1, v56, s[76:79], 0 offen
  s_mov_b64 exec, -1
  v_add_f32 v193, v193, v193
  v_mfma_f32_32x32x16_bf16 v[144:159], v[176:179], v[184:187], v[144:159]
  s_add_u32 m0, s17, 49152
  s_nop 0
  buffer_load_dwordx4 v12, s[56:59], s10 offen offset:0 lds
  v_mul_f32 v204, v193, v193
  v_mfma_f32_32x32x16_bf16 v[108:123], v[176:179], v[180:183], v[108:123]
  buffer_load_dwordx4 v13, s[56:59], s10 offen offset:1024 lds
  v_mul_f32 v193, v192, v193
  s_waitcnt lgkmcnt(2)
  v_mfma_f32_32x32x16_bf16 v[76:91], v[124:127], v[164:167], v[76:91]
  ds_read_b128 v[172:175], v17 offset:0
  ds_read_b128 v[180:183], v21 offset:0
  v_fma_f32 v192, v192, v192, -v204
  v_add_f32 v193, v193, v193
  s_waitcnt lgkmcnt(2)
  v_mfma_f32_32x32x16_bf16 v[92:107], v[124:127], v[168:171], v[92:107]
  ds_read_b128 v[176:179], v17 offset:4096
  ds_read_b128 v[184:187], v21 offset:4096
  v_mul_f32 v204, v193, v193
  v_mfma_f32_32x32x16_bf16 v[144:159], v[160:163], v[168:171], v[144:159]
  buffer_load_dwordx4 v14, s[56:59], s10 offen offset:2048 lds
  v_mul_f32 v193, v192, v193
  v_mfma_f32_32x32x16_bf16 v[108:123], v[160:163], v[164:167], v[108:123]
  buffer_load_dwordx4 v15, s[56:59], s10 offen offset:3072 lds
  v_fma_f32 v192, v192, v192, -v204
  s_waitcnt lgkmcnt(2)
  v_mfma_f32_32x32x16_bf16 v[76:91], v[172:175], v[180:183], v[76:91]
  ds_read_b128 v[124:127], v18 offset:0
  ds_read_b128 v[164:167], v22 offset:0
  v_add_f32 v193, v193, v193
  s_waitcnt lgkmcnt(2)
  v_mfma_f32_32x32x16_bf16 v[92:107], v[172:175], v[184:187], v[92:107]
  ds_read_b128 v[160:163], v18 offset:4096
  ds_read_b128 v[168:171], v22 offset:4096
  v_mul_f32 v204, v193, v193
  v_mul_f32 v195, v192, v193
  v_mfma_f32_32x32x16_bf16 v[144:159], v[176:179], v[184:187], v[144:159]
  s_add_u32 m0, s16, 49152
  s_nop 0
  buffer_load_dwordx4 v8, s[44:47], s10 offen offset:0 lds
  v_fma_f32 v194, v192, v192, -v204
  v_mfma_f32_32x32x16_bf16 v[108:123], v[176:179], v[180:183], v[108:123]
  buffer_load_dwordx4 v9, s[44:47], s10 offen offset:1024 lds
  v_add_f32 v195, v195, v195
  s_waitcnt lgkmcnt(2)
  v_mfma_f32_32x32x16_bf16 v[76:91], v[124:127], v[164:167], v[76:91]
  ds_read_b128 v[172:175], v19 offset:0
  ds_read_b128 v[180:183], v23 offset:0
  v_mul_f32 v204, v195, v195
  s_waitcnt lgkmcnt(2)
  v_mfma_f32_32x32x16_bf16 v[92:107], v[124:127], v[168:171], v[92:107]
  ds_read_b128 v[176:179], v19 offset:4096
  ds_read_b128 v[184:187], v23 offset:4096
  v_mul_f32 v197, v194, v195
  v_mfma_f32_32x32x16_bf16 v[144:159], v[160:163], v[168:171], v[144:159]
  buffer_load_dwordx4 v10, s[44:47], s10 offen offset:2048 lds
  v_fma_f32 v196, v194, v194, -v204
  v_add_f32 v197, v197, v197
  v_mfma_f32_32x32x16_bf16 v[108:123], v[160:163], v[164:167], v[108:123]
  buffer_load_dwordx4 v11, s[44:47], s10 offen offset:3072 lds
  s_add_u32 s10, s10, 128
  s_and_b32 s10, s10, 0x7ff
  v_mul_f32 v204, v197, v197
  s_waitcnt vmcnt(18) lgkmcnt(0)
  s_barrier
  v_mfma_f32_32x32x16_bf16 v[76:91], v[172:175], v[180:183], v[76:91]
  ds_read_b128 v[124:127], v16 offset:16384
  ds_read_b128 v[164:167], v20 offset:16384
  v_mul_f32 v203, v196, v197
  v_mfma_f32_32x32x16_bf16 v[92:107], v[172:175], v[184:187], v[92:107]
  ds_read_b128 v[160:163], v16 offset:20480
  ds_read_b128 v[168:171], v20 offset:20480
  v_fma_f32 v202, v196, v196, -v204
  v_mfma_f32_32x32x16_bf16 v[144:159], v[176:179], v[184:187], v[144:159]
  buffer_load_dword v209, v3, s[48:51], 0 offen sc1
  v_mov_b32 v56, 2130706432
  v_writelane_b32 v56, s88, 0
  v_writelane_b32 v56, s89, 1
  v_writelane_b32 v56, s90, 2
  v_writelane_b32 v56, s91, 3
  v_writelane_b32 v56, s92, 4
  v_writelane_b32 v56, s93, 5
  v_writelane_b32 v56, s94, 6
  v_writelane_b32 v56, s95, 7
  v_and_b32 v56, -16, v56
  s_mov_b64 exec, 255
  buffer_load_dwordx4 v[212:215], v56, s[72:75], 0 offen offset:1024
  buffer_load_dwordx4 v[216:219], v56, s[76:79], 0 offen offset:1024
  s_mov_b64 exec, -1
  v_add_f32 v203, v203, v203
  v_mfma_f32_32x32x16_bf16 v[108:123], v[176:179], v[180:183], v[108:123]
  s_and_b32 s7, s88, -16
  s_add_u32 m0, s6, 131072
  s_nop 0
  buffer_load_dwordx4 v29, s[72:75], s7 offen lds
  v_mul_f32 v204, v203, v203
  v_mul_f32 v199, v202, v203
  s_waitcnt lgkmcnt(2)
  v_mfma_f32_32x32x16_bf16 v[76:91], v[124:127], v[164:167], v[76:91]
  ds_read_b128 v[172:175], v17 offset:16384
  ds_read_b128 v[180:183], v21 offset:16384
  v_fma_f32 v198, v202, v202, -v204
  s_waitcnt lgkmcnt(2)
  v_mfma_f32_32x32x16_bf16 v[92:107], v[124:127], v[168:171], v[92:107]
  ds_read_b128 v[176:179], v17 offset:20480
  ds_read_b128 v[184:187], v21 offset:20480
  v_add_f32 v199, v199, v199
  v_mfma_f32_32x32x16_bf16 v[144:159], v[160:163], v[168:171], v[144:159]
  s_add_u32 m0, s6, 132096
  s_nop 0
  buffer_load_dwordx4 v29, s[76:79], s7 offen lds
  v_mul_f32 v204, v199, v199
  v_mfma_f32_32x32x16_bf16 v[108:123], v[160:163], v[164:167], v[108:123]
  s_and_b32 s7, s89, -16
  s_add_u32 m0, s6, 133120
  s_nop 0
  buffer_load_dwordx4 v29, s[72:75], s7 offen lds
  v_mul_f32 v199, v198, v199
  v_fma_f32 v198, v198, v198, -v204
  s_waitcnt lgkmcnt(2)
  v_mfma_f32_32x32x16_bf16 v[76:91], v[172:175], v[180:183], v[76:91]
  ds_read_b128 v[124:127], v18 offset:16384
  ds_read_b128 v[164:167], v22 offset:16384
  v_add_f32 v199, v199, v199
  s_waitcnt lgkmcnt(2)
  v_mfma_f32_32x32x16_bf16 v[92:107], v[172:175], v[184:187], v[92:107]
  ds_read_b128 v[160:163], v18 offset:20480
  ds_read_b128 v[168:171], v22 offset:20480
  v_mul_f32 v204, v199, v199
  v_mfma_f32_32x32x16_bf16 v[144:159], v[176:179], v[184:187], v[144:159]
  s_add_u32 m0, s6, 134144
  s_nop 0
  buffer_load_dwordx4 v29, s[76:79], s7 offen lds
  v_mul_f32 v199, v198, v199
  v_mfma_f32_32x32x16_bf16 v[108:123], v[176:179], v[180:183], v[108:123]
  s_and_b32 s7, s90, -16
  s_add_u32 m0, s6, 0
  s_nop 0
  buffer_load_dwordx4 v29, s[72:75], s7 offen lds
  v_fma_f32 v198, v198, v198, -v204
  s_waitcnt lgkmcnt(2)
  v_mfma_f32_32x32x16_bf16 v[76:91], v[124:127], v[164:167], v[76:91]
  ds_read_b128 v[172:175], v19 offset:16384
  ds_read_b128 v[180:183], v23 offset:16384
  v_add_f32 v199, v199, v199
  s_lshl_b32 s24, s3, 8
  s_waitcnt lgkmcnt(2)
  v_mfma_f32_32x32x16_bf16 v[92:107], v[124:127], v[168:171], v[92:107]
  ds_read_b128 v[176:179], v19 offset:20480
  ds_read_b128 v[184:187], v23 offset:20480
  s_add_u32 s24, s24, 147584
  v_mfma_f32_32x32x16_bf16 v[144:159], v[160:163], v[168:171], v[144:159]
  s_add_u32 m0, s6, 1024
  s_nop 0
  buffer_load_dwordx4 v29, s[76:79], s7 offen lds
  v_lshl_add_u32 v26, v5, 3, s24
  v_mfma_f32_32x32x16_bf16 v[108:123], v[160:163], v[164:167], v[108:123]
  s_and_b32 s7, s91, -16
  s_add_u32 m0, s6, 2048
  s_nop 0
  buffer_load_dwordx4 v29, s[72:75], s7 offen lds
  v_lshl_add_u32 v26, v6, 10, v26
  s_waitcnt vmcnt(20) lgkmcnt(0)
  s_barrier
  v_mfma_f32_32x32x16_bf16 v[76:91], v[172:175], v[180:183], v[76:91]
  ds_read_b128 v[124:127], v16 offset:32768
  ds_read_b128 v[164:167], v20 offset:32768
  s_sub_u32 s24, 15, s38
  v_mfma_f32_32x32x16_bf16 v[92:107], v[172:175], v[184:187], v[92:107]
  ds_read_b128 v[160:163], v16 offset:36864
  ds_read_b128 v[168:171], v20 offset:36864
  s_lshl_b32 s24, s24, 9
  s_and_b32 s27, s3, 1
  v_mfma_f32_32x32x16_bf16 v[144:159], v[176:179], v[184:187], v[144:159]
  s_add_u32 m0, s6, 3072
  s_nop 0
  buffer_load_dwordx4 v29, s[76:79], s7 offen lds
  s_lshl_b32 s27, s27, 8
  v_mfma_f32_32x32x16_bf16 v[108:123], v[176:179], v[180:183], v[108:123]
  s_and_b32 s7, s92, -16
  s_add_u32 m0, s6, 65536
  s_nop 0
  buffer_load_dwordx4 v29, s[72:75], s7 offen lds
  s_add_u32 s24, s24, s27
  s_waitcnt lgkmcnt(2)
  v_mfma_f32_32x32x16_bf16 v[76:91], v[124:127], v[164:167], v[76:91]
  ds_read_b128 v[172:175], v17 offset:32768
  ds_read_b128 v[180:183], v21 offset:32768
  v_and_b32 v27, 31, v4
  s_waitcnt lgkmcnt(2)
  v_mfma_f32_32x32x16_bf16 v[92:107], v[124:127], v[168:171], v[92:107]
  ds_read_b128 v[176:179], v17 offset:36864
  ds_read_b128 v[184:187], v21 offset:36864
  v_lshl_add_u32 v27, v27, 3, s24
  s_lshl_b32 s27, s38, 1
  v_mfma_f32_32x32x16_bf16 v[144:159], v[160:163], v[168:171], v[144:159]
  s_add_u32 m0, s6, 66560
  s_nop 0
  buffer_load_dwordx4 v29, s[76:79], s7 offen lds
  s_lshr_b32 s32, s3, 1
  v_mfma_f32_32x32x16_bf16 v[108:123], v[160:163], v[164:167], v[108:123]
  s_and_b32 s7, s93, -16
  s_add_u32 m0, s6, 67584
  s_nop 0
  buffer_load_dwordx4 v29, s[72:75], s7 offen lds
  s_add_u32 s27, s27, s32
  s_waitcnt lgkmcnt(2)
  v_mfma_f32_32x32x16_bf16 v[76:91], v[172:175], v[180:183], v[76:91]
  ds_read_b128 v[124:127], v18 offset:32768
  ds_read_b128 v[164:167], v22 offset:32768
  s_lshl_b32 s24, s27, 9
  s_waitcnt lgkmcnt(2)
  v_mfma_f32_32x32x16_bf16 v[92:107], v[172:175], v[184:187], v[92:107]
  ds_read_b128 v[160:163], v18 offset:36864
  ds_read_b128 v[168:171], v22 offset:36864
  s_and_b32 s27, s27, 3
  v_mfma_f32_32x32x16_bf16 v[144:159], v[176:179], v[184:187], v[144:159]
  s_add_u32 m0, s6, 68608
  s_nop 0
  buffer_load_dwordx4 v29, s[76:79], s7 offen lds
  s_lshl_b32 s27, s27, 2
  v_xor_b32 v28, s27, v5
  v_mfma_f32_32x32x16_bf16 v[108:123], v[176:179], v[180:183], v[108:123]
  s_and_b32 s7, s94, -16
  s_add_u32 m0, s6, 16384
  s_nop 0
  buffer_load_dwordx4 v29, s[72:75], s7 offen lds
  v_lshlrev_b32 v28, 4, v28
  s_waitcnt lgkmcnt(2)
  v_mfma_f32_32x32x16_bf16 v[76:91], v[124:127], v[164:167], v[76:91]
  ds_read_b128 v[172:175], v19 offset:32768
  ds_read_b128 v[180:183], v23 offset:32768
  v_lshrrev_b32 v75, 1, v6
  s_waitcnt lgkmcnt(2)
  v_mfma_f32_32x32x16_bf16 v[92:107], v[124:127], v[168:171], v[92:107]
  ds_read_b128 v[176:179], v19 offset:36864
  ds_read_b128 v[184:187], v23 offset:36864
  v_lshl_or_b32 v28, v75, 14, v28
  v_mfma_f32_32x32x16_bf16 v[144:159], v[160:163], v[168:171], v[144:159]
  s_add_u32 m0, s6, 17408
  s_nop 0
  buffer_load_dwordx4 v29, s[76:79], s7 offen lds
  v_and_b32 v75, 1, v6
  v_mfma_f32_32x32x16_bf16 v[108:123], v[160:163], v[164:167], v[108:123]
  s_and_b32 s7, s95, -16
  s_add_u32 m0, s6, 18432
  s_nop 0
  buffer_load_dwordx4 v29, s[72:75], s7 offen lds
  v_lshl_or_b32 v28, v75, 19, v28
  s_and_b32 s32, s3, 1
  s_waitcnt vmcnt(18) lgkmcnt(0)
  s_barrier
  v_mfma_f32_32x32x16_bf16 v[76:91], v[172:175], v[180:183], v[76:91]
  ds_read_b128 v[124:127], v16 offset:49152
  ds_read_b128 v[164:167], v20 offset:49152
  s_lshl_b32 s32, s32, 8
  v_mfma_f32_32x32x16_bf16 v[92:107], v[172:175], v[184:187], v[92:107]
  ds_read_b128 v[160:163], v16 offset:53248
  ds_read_b128 v[168:171], v20 offset:53248
  s_add_u32 s24, s24, s32
  v_mfma_f32_32x32x16_bf16 v[144:159], v[176:179], v[184:187], v[144:159]
  s_add_u32 m0, s6, 19456
  s_nop 0
  buffer_load_dwordx4 v29, s[76:79], s7 offen lds
  s_lshl_b32 s32, s39, 15
  v_mfma_f32_32x32x16_bf16 v[108:123], v[176:179], v[180:183], v[108:123]
  s_add_u32 m0, s20, 81920
  s_nop 0
  buffer_load_dwordx4 v128, s[68:71], s19 offen offset:0 lds
  s_add_u32 s24, s24, s32
  s_waitcnt lgkmcnt(2)
  v_mfma_f32_32x32x16_bf16 v[76:91], v[124:127], v[164:167], v[76:91]
  ds_read_b128 v[172:175], v17 offset:49152
  ds_read_b128 v[180:183], v21 offset:49152
  s_waitcnt lgkmcnt(2)
  v_mfma_f32_32x32x16_bf16 v[92:107], v[124:127], v[168:171], v[92:107]
  ds_read_b128 v[176:179], v17 offset:53248
  ds_read_b128 v[184:187], v21 offset:53248
  v_mfma_f32_32x32x16_bf16 v[144:159], v[160:163], v[168:171], v[144:159]
  buffer_load_dwordx4 v129, s[68:71], s19 offen offset:1024 lds
  v_mfma_f32_32x32x16_bf16 v[108:123], v[160:163], v[164:167], v[108:123]
  buffer_load_dwordx4 v130, s[68:71], s19 offen offset:2048 lds
  s_waitcnt lgkmcnt(2)
  v_mfma_f32_32x32x16_bf16 v[76:91], v[172:175], v[180:183], v[76:91]
  ds_read_b128 v[124:127], v18 offset:49152
  ds_read_b128 v[164:167], v22 offset:49152
  s_waitcnt lgkmcnt(2)
  v_mfma_f32_32x32x16_bf16 v[92:107], v[172:175], v[184:187], v[92:107]
  ds_read_b128 v[160:163], v18 offset:53248
  ds_read_b128 v[168:171], v22 offset:53248
  v_mfma_f32_32x32x16_bf16 v[144:159], v[176:179], v[184:187], v[144:159]
  buffer_load_dwordx4 v131, s[68:71], s19 offen offset:3072 lds
  s_add_u32 s19, s19, 128
  s_and_b32 s19, s19, 0x7ff
  v_mfma_f32_32x32x16_bf16 v[108:123], v[176:179], v[180:183], v[108:123]
  s_add_u32 m0, s20, 32768
  s_nop 0
  buffer_load_dwordx4 v128, s[68:71], s19 offen offset:0 lds
  s_waitcnt lgkmcnt(2)
  v_mfma_f32_32x32x16_bf16 v[76:91], v[124:127], v[164:167], v[76:91]
  ds_read_b128 v[172:175], v19 offset:49152
  ds_read_b128 v[180:183], v23 offset:49152
  s_waitcnt lgkmcnt(2)
  v_mfma_f32_32x32x16_bf16 v[92:107], v[124:127], v[168:171], v[92:107]
  ds_read_b128 v[176:179], v19 offset:53248
  ds_read_b128 v[184:187], v23 offset:53248
  v_mfma_f32_32x32x16_bf16 v[144:159], v[160:163], v[168:171], v[144:159]
  buffer_load_dwordx4 v129, s[68:71], s19 offen offset:1024 lds
  v_mfma_f32_32x32x16_bf16 v[108:123], v[160:163], v[164:167], v[108:123]
  buffer_load_dwordx4 v130, s[68:71], s19 offen offset:2048 lds
  s_waitcnt lgkmcnt(2)
  v_mfma_f32_32x32x16_bf16 v[76:91], v[172:175], v[180:183], v[76:91]
  s_waitcnt lgkmcnt(0)
  v_mfma_f32_32x32x16_bf16 v[92:107], v[172:175], v[184:187], v[92:107]
  v_mfma_f32_32x32x16_bf16 v[144:159], v[176:179], v[184:187], v[144:159]
  buffer_load_dwordx4 v131, s[68:71], s19 offen offset:3072 lds
  s_add_u32 s19, s19, 128
  s_and_b32 s19, s19, 0x7ff
  v_mfma_f32_32x32x16_bf16 v[108:123], v[176:179], v[180:183], v[108:123]
  s_add_u32 m0, s20, 98304
  s_nop 0
  buffer_load_dwordx4 v128, s[68:71], s19 offen offset:0 lds
  buffer_load_dwordx4 v129, s[68:71], s19 offen offset:1024 lds
  s_nop 0
  v_pk_fma_f32 v[8:9], v[190:191], v[76:77], v[78:79] op_sel:[0,0,0] op_sel_hi:[0,1,1]
  s_nop 0
  v_pk_fma_f32 v[10:11], v[190:191], v[92:93], v[94:95] op_sel:[0,0,0] op_sel_hi:[0,1,1]
  v_pk_fma_f32 v[8:9], v[190:191], v[92:93], v[8:9] op_sel:[1,0,0] op_sel_hi:[1,1,1] neg_lo:[1,0,0] neg_hi:[1,0,0]
  v_pk_fma_f32 v[10:11], v[190:191], v[76:77], v[10:11] op_sel:[1,0,0] op_sel_hi:[1,1,1]
  v_pk_fma_f32 v[12:13], v[190:191], v[8:9], v[80:81] op_sel:[0,0,0] op_sel_hi:[0,1,1]
  v_pk_fma_f32 v[14:15], v[190:191], v[10:11], v[96:97] op_sel:[0,0,0] op_sel_hi:[0,1,1]
  v_pk_fma_f32 v[12:13], v[190:191], v[10:11], v[12:13] op_sel:[1,0,0] op_sel_hi:[1,1,1] neg_lo:[1,0,0] neg_hi:[1,0,0]
  v_pk_fma_f32 v[14:15], v[190:191], v[8:9], v[14:15] op_sel:[1,0,0] op_sel_hi:[1,1,1]
  v_pk_fma_f32 v[8:9], v[190:191], v[12:13], v[82:83] op_sel:[0,0,0] op_sel_hi:[0,1,1]
  v_pk_fma_f32 v[10:11], v[190:191], v[14:15], v[98:99] op_sel:[0,0,0] op_sel_hi:[0,1,1]
  v_pk_fma_f32 v[8:9], v[190:191], v[14:15], v[8:9] op_sel:[1,0,0] op_sel_hi:[1,1,1] neg_lo:[1,0,0] neg_hi:[1,0,0]
  v_pk_fma_f32 v[10:11], v[190:191], v[12:13], v[10:11] op_sel:[1,0,0] op_sel_hi:[1,1,1]
  v_pk_fma_f32 v[12:13], v[190:191], v[8:9], v[84:85] op_sel:[0,0,0] op_sel_hi:[0,1,1]
  v_pk_fma_f32 v[14:15], v[190:191], v[10:11], v[100:101] op_sel:[0,0,0] op_sel_hi:[0,1,1]
  v_pk_fma_f32 v[12:13], v[190:191], v[10:11], v[12:13] op_sel:[1,0,0] op_sel_hi:[1,1,1] neg_lo:[1,0,0] neg_hi:[1,0,0]
  v_pk_fma_f32 v[14:15], v[190:191], v[8:9], v[14:15] op_sel:[1,0,0] op_sel_hi:[1,1,1]
  buffer_load_dwordx4 v130, s[68:71], s19 offen offset:2048 lds
  v_pk_fma_f32 v[8:9], v[190:191], v[12:13], v[86:87] op_sel:[0,0,0] op_sel_hi:[0,1,1]
  v_pk_fma_f32 v[10:11], v[190:191], v[14:15], v[102:103] op_sel:[0,0,0] op_sel_hi:[0,1,1]
  v_pk_fma_f32 v[8:9], v[190:191], v[14:15], v[8:9] op_sel:[1,0,0] op_sel_hi:[1,1,1] neg_lo:[1,0,0] neg_hi:[1,0,0]
  v_pk_fma_f32 v[10:11], v[190:191], v[12:13], v[10:11] op_sel:[1,0,0] op_sel_hi:[1,1,1]
  v_pk_fma_f32 v[12:13], v[190:191], v[8:9], v[88:89] op_sel:[0,0,0] op_sel_hi:[0,1,1]
  v_pk_fma_f32 v[14:15], v[190:191], v[10:11], v[104:105] op_sel:[0,0,0] op_sel_hi:[0,1,1]
  v_pk_fma_f32 v[12:13], v[190:191], v[10:11], v[12:13] op_sel:[1,0,0] op_sel_hi:[1,1,1] neg_lo:[1,0,0] neg_hi:[1,0,0]
  v_pk_fma_f32 v[14:15], v[190:191], v[8:9], v[14:15] op_sel:[1,0,0] op_sel_hi:[1,1,1]
  v_pk_fma_f32 v[8:9], v[190:191], v[12:13], v[90:91] op_sel:[0,0,0] op_sel_hi:[0,1,1]
  v_pk_fma_f32 v[10:11], v[190:191], v[14:15], v[106:107] op_sel:[0,0,0] op_sel_hi:[0,1,1]
  v_pk_fma_f32 v[8:9], v[190:191], v[14:15], v[8:9] op_sel:[1,0,0] op_sel_hi:[1,1,1] neg_lo:[1,0,0] neg_hi:[1,0,0]
  v_pk_fma_f32 v[10:11], v[190:191], v[12:13], v[10:11] op_sel:[1,0,0] op_sel_hi:[1,1,1]
  v_pk_fma_f32 v[12:13], v[190:191], v[8:9], v[108:109] op_sel:[0,0,0] op_sel_hi:[0,1,1]
  v_pk_fma_f32 v[14:15], v[190:191], v[10:11], v[144:145] op_sel:[0,0,0] op_sel_hi:[0,1,1]
  v_pk_fma_f32 v[12:13], v[190:191], v[10:11], v[12:13] op_sel:[1,0,0] op_sel_hi:[1,1,1] neg_lo:[1,0,0] neg_hi:[1,0,0]
  v_pk_fma_f32 v[14:15], v[190:191], v[8:9], v[14:15] op_sel:[1,0,0] op_sel_hi:[1,1,1]
  buffer_load_dwordx4 v131, s[68:71], s19 offen offset:3072 lds
  s_add_u32 s19, s19, 128
  s_and_b32 s19, s19, 0x7ff
  v_pk_fma_f32 v[8:9], v[190:191], v[12:13], v[110:111] op_sel:[0,0,0] op_sel_hi:[0,1,1]
  v_pk_fma_f32 v[10:11], v[190:191], v[14:15], v[146:147] op_sel:[0,0,0] op_sel_hi:[0,1,1]
  v_pk_fma_f32 v[8:9], v[190:191], v[14:15], v[8:9] op_sel:[1,0,0] op_sel_hi:[1,1,1] neg_lo:[1,0,0] neg_hi:[1,0,0]
  v_pk_fma_f32 v[10:11], v[190:191], v[12:13], v[10:11] op_sel:[1,0,0] op_sel_hi:[1,1,1]
  v_pk_fma_f32 v[12:13], v[190:191], v[8:9], v[112:113] op_sel:[0,0,0] op_sel_hi:[0,1,1]
  v_pk_fma_f32 v[14:15], v[190:191], v[10:11], v[148:149] op_sel:[0,0,0] op_sel_hi:[0,1,1]
  v_pk_fma_f32 v[12:13], v[190:191], v[10:11], v[12:13] op_sel:[1,0,0] op_sel_hi:[1,1,1] neg_lo:[1,0,0] neg_hi:[1,0,0]
  v_pk_fma_f32 v[14:15], v[190:191], v[8:9], v[14:15] op_sel:[1,0,0] op_sel_hi:[1,1,1]
  v_pk_fma_f32 v[8:9], v[190:191], v[12:13], v[114:115] op_sel:[0,0,0] op_sel_hi:[0,1,1]
  v_pk_fma_f32 v[10:11], v[190:191], v[14:15], v[150:151] op_sel:[0,0,0] op_sel_hi:[0,1,1]
  v_pk_fma_f32 v[8:9], v[190:191], v[14:15], v[8:9] op_sel:[1,0,0] op_sel_hi:[1,1,1] neg_lo:[1,0,0] neg_hi:[1,0,0]
  v_pk_fma_f32 v[10:11], v[190:191], v[12:13], v[10:11] op_sel:[1,0,0] op_sel_hi:[1,1,1]
  v_pk_fma_f32 v[12:13], v[190:191], v[8:9], v[116:117] op_sel:[0,0,0] op_sel_hi:[0,1,1]
  v_pk_fma_f32 v[14:15], v[190:191], v[10:11], v[152:153] op_sel:[0,0,0] op_sel_hi:[0,1,1]
  v_pk_fma_f32 v[12:13], v[190:191], v[10:11], v[12:13] op_sel:[1,0,0] op_sel_hi:[1,1,1] neg_lo:[1,0,0] neg_hi:[1,0,0]
  v_pk_fma_f32 v[14:15], v[190:191], v[8:9], v[14:15] op_sel:[1,0,0] op_sel_hi:[1,1,1]
  v_pk_fma_f32 v[8:9], v[190:191], v[12:13], v[118:119] op_sel:[0,0,0] op_sel_hi:[0,1,1]
  v_pk_fma_f32 v[10:11], v[190:191], v[14:15], v[154:155] op_sel:[0,0,0] op_sel_hi:[0,1,1]
  v_pk_fma_f32 v[8:9], v[190:191], v[14:15], v[8:9] op_sel:[1,0,0] op_sel_hi:[1,1,1] neg_lo:[1,0,0] neg_hi:[1,0,0]
  v_pk_fma_f32 v[10:11], v[190:191], v[12:13], v[10:11] op_sel:[1,0,0] op_sel_hi:[1,1,1]
  v_pk_fma_f32 v[12:13], v[190:191], v[8:9], v[120:121] op_sel:[0,0,0] op_sel_hi:[0,1,1]
  v_pk_fma_f32 v[14:15], v[190:191], v[10:11], v[156:157] op_sel:[0,0,0] op_sel_hi:[0,1,1]
  v_pk_fma_f32 v[12:13], v[190:191], v[10:11], v[12:13] op_sel:[1,0,0] op_sel_hi:[1,1,1] neg_lo:[1,0,0] neg_hi:[1,0,0]
  v_pk_fma_f32 v[14:15], v[190:191], v[8:9], v[14:15] op_sel:[1,0,0] op_sel_hi:[1,1,1]
  v_pk_fma_f32 v[8:9], v[190:191], v[12:13], v[122:123] op_sel:[0,0,0] op_sel_hi:[0,1,1]
  v_pk_fma_f32 v[10:11], v[190:191], v[14:15], v[158:159] op_sel:[0,0,0] op_sel_hi:[0,1,1]
  v_pk_fma_f32 v[8:9], v[190:191], v[14:15], v[8:9] op_sel:[1,0,0] op_sel_hi:[1,1,1] neg_lo:[1,0,0] neg_hi:[1,0,0]
  v_pk_fma_f32 v[10:11], v[190:191], v[12:13], v[10:11] op_sel:[1,0,0] op_sel_hi:[1,1,1]
  v_fma_f32 v12, v192, v8, v9
  v_fma_f32 v13, v192, v10, v11
  v_fma_f32 v12, -v193, v10, v12
  v_fma_f32 v13, v193, v8, v13
  v_mov_b32 v14, v12
  v_mov_b32 v15, v13
  s_nop 0
  v_permlane32_swap_b32 v12, v14
  v_permlane32_swap_b32 v13, v15
  v_fma_f32 v14, v194, v12, v14
  v_fma_f32 v15, v194, v13, v15
  v_fma_f32 v14, -v195, v13, v14
  v_fma_f32 v15, v195, v12, v15
  ds_write_b64 v26, v[14:15]
  s_waitcnt vmcnt(30)
  v_cmp_ne_u32 vcc, 1, v209
  s_nop 0
  s_cbranch_vccz gated_mix__spectral_gfnet__ssm_conv_s5__prompt_kernel_skip21
  s_mov_b32 s10, 0
gated_mix__spectral_gfnet__ssm_conv_s5__prompt_kernel_poll22:
  s_sleep 16
  buffer_load_dword v209, v3, s[48:51], 0 offen sc1
  s_waitcnt vmcnt(0)
  v_cmp_ne_u32 vcc, 1, v209
  s_nop 0
  s_cbranch_vccz gated_mix__spectral_gfnet__ssm_conv_s5__prompt_kernel_pollout23
  s_add_u32 s10, s10, 1
  s_cmp_lt_u32 s10, 1048576
  s_cbranch_scc1 gated_mix__spectral_gfnet__ssm_conv_s5__prompt_kernel_poll22
gated_mix__spectral_gfnet__ssm_conv_s5__prompt_kernel_pollout23:
gated_mix__spectral_gfnet__ssm_conv_s5__prompt_kernel_skip21:
  s_waitcnt lgkmcnt(0)
  s_barrier
  v_and_b32 v26, 0xfffffdff, v26
  ds_read_b64 v[16:17], v26
  s_cmp_lt_u32 s3, 2
  s_cbranch_scc1 gated_mix__spectral_gfnet__ssm_conv_s5__prompt_kernel_skip24
  s_waitcnt lgkmcnt(0)
  v_fma_f32 v14, v196, v16, v14
  s_waitcnt lgkmcnt(0)
  v_fma_f32 v15, v196, v17, v15
  s_waitcnt lgkmcnt(0)
  v_fma_f32 v14, -v197, v17, v14
  s_waitcnt lgkmcnt(0)
  v_fma_f32 v15, v197, v16, v15
  v_min_u32 v14, -2, v14
  v_min_u32 v15, -2, v15
  s_mov_b32 exec_hi, 0
  buffer_store_dwordx2 v[14:15], v27, s[64:67], 0 offen sc1
  s_mov_b64 exec, -1
gated_mix__spectral_gfnet__ssm_conv_s5__prompt_kernel_skip24:
  v_lshrrev_b32 v2, 5, v4
  v_lshl_add_u32 v27, v2, 12, v27
  v_add_u32 v27, 512, v27
  v_and_b32 v14, 3, v5
  v_lshlrev_b32 v2, 6, v14
  v_lshrrev_b32 v14, 2, v5
  v_lshl_or_b32 v2, v14, 4, v2
  v_lshl_or_b32 v2, v6, 12, v2
  s_mul_i32 s10, s15, 16384
  s_lshl_b32 s11, s3, 8
  s_add_u32 s10, s10, s11
  buffer_load_dwordx4 v[20:23], v2, s[80:83], s10 offen offset:0 sc1
  buffer_load_dwordx4 v[124:127], v2, s[80:83], s10 offen offset:1024 sc1
  buffer_load_dwordx4 v[160:163], v2, s[80:83], s10 offen offset:2048 sc1
  buffer_load_dwordx4 v[164:167], v2, s[80:83], s10 offen offset:3072 sc1
  s_lshl_b32 s10, s3, 8
  s_add_u32 s10, s10, 147456
  v_lshl_add_u32 v2, v4, 11, s10
  s_mov_b64 exec, 255
  s_waitcnt vmcnt(33)
  ds_write_b128 v2, v[212:215]
  s_waitcnt vmcnt(32)
  ds_write_b128 v2, v[216:219] offset:1024
  s_mov_b64 exec, -1
  s_waitcnt vmcnt(16)
  s_cmp_eq_u32 s14, 0
  s_cbranch_scc1 gated_mix__spectral_gfnet__ssm_conv_s5__prompt_kernel_skip25
  v_add_u32 v2, 131072, v57
  v_and_b32 v14, 0xfffe0000, v189
  v_add3_u32 v14, v14, v74, v2
  s_cmp_eq_u32 s9, 0
  s_cbranch_scc1 gated_mix__spectral_gfnet__ssm_conv_s5__prompt_kernel_skip26
  s_mov_b32 exec_hi, 0
  v_add_u32 v2, 2048, v2
  v_add_u32 v14, 2048, v14
  s_mov_b64 exec, -1
gated_mix__spectral_gfnet__ssm_conv_s5__prompt_kernel_skip26:
  ds_read_u16_d16_hi v216, v2 offset:0
  ds_read_u16_d16_hi v220, v2 offset:1024
  ds_read_u16_d16_hi v217, v2 offset:128
  ds_read_u16_d16_hi v221, v2 offset:1152
  ds_read_u16_d16_hi v218, v2 offset:256
  ds_read_u16_d16_hi v222, v2 offset:1280
  ds_read_u16_d16_hi v219, v14 offset:0
  ds_read_u16_d16_hi v223, v14 offset:1024
gated_mix__spectral_gfnet__ssm_conv_s5__prompt_kernel_skip25:
  v_add_u32 v2, 131072, v57
  v_and_b32 v14, 0xfffe0000, v189
  v_add3_u32 v14, v14, v74, v2
  s_cmp_eq_u32 s9, 0
  s_cbranch_scc1 gated_mix__spectral_gfnet__ssm_conv_s5__prompt_kernel_skip27
  s_mov_b32 exec_lo, 0
  v_subrev_u32 v2, 2048, v2
  v_subrev_u32 v14, 2048, v14
  s_mov_b64 exec, -1
gated_mix__spectral_gfnet__ssm_conv_s5__prompt_kernel_skip27:
  ds_read_u16_d16_hi v168, v2 offset:0
  ds_read_u16_d16_hi v172, v2 offset:1024
  ds_read_u16_d16_hi v169, v2 offset:128
  ds_read_u16_d16_hi v173, v2 offset:1152
  ds_read_u16_d16_hi v170, v2 offset:256
  ds_read_u16_d16_hi v174, v2 offset:1280
  ds_read_u16_d16_hi v171, v14 offset:0
  ds_read_u16_d16_hi v175, v14 offset:1024
  v_add_u32 v2, 0, v57
  v_and_b32 v14, 0x1000, v189
  v_add3_u32 v14, v14, v74, v2
  s_waitcnt vmcnt(12)
  ds_read_b128 a[0:3], v134 offset:16384
  ds_read_b128 a[4:7], v135 offset:16384
  ds_read_b128 a[8:11], v134 offset:18432
  ds_read_b128 a[12:15], v135 offset:18432
  s_add_u32 m0, s20, 114688
  s_nop 0
  buffer_load_dwordx4 v128, s[68:71], s19 offen offset:0 lds
  ds_read_u16_d16_hi v176, v2 offset:0
  ds_read_u16_d16_hi v180, v2 offset:1024
  ds_read_u16_d16_hi v177, v2 offset:128
  ds_read_u16_d16_hi v181, v2 offset:1152
  ds_read_u16_d16_hi v178, v2 offset:256
  ds_read_u16_d16_hi v182, v2 offset:1280
  ds_read_u16_d16_hi v179, v14 offset:0
  ds_read_u16_d16_hi v183, v14 offset:1024
  v_add_u32 v2, 65536, v57
  v_and_b32 v14, 0xffff2000, v189
  v_add3_u32 v14, v14, v74, v2
  ds_read_u16_d16_hi v184, v2 offset:0
  ds_read_u16_d16_hi v204, v2 offset:1024
  ds_read_u16_d16_hi v185, v2 offset:128
  ds_read_u16_d16_hi v205, v2 offset:1152
  ds_read_u16_d16_hi v186, v2 offset:256
  ds_read_u16_d16_hi v206, v2 offset:1280
  ds_read_u16_d16_hi v187, v14 offset:0
  buffer_load_dwordx4 v129, s[68:71], s19 offen offset:1024 lds
  ds_read_u16_d16_hi v207, v14 offset:1024
  v_add_u32 v2, 16384, v57
  v_and_b32 v14, 0xfffff000, v189
  v_add3_u32 v14, v14, v74, v2
  ds_read_u16_d16_hi v208, v2 offset:0
  ds_read_u16_d16_hi v212, v2 offset:1024
  ds_read_u16_d16_hi v209, v2 offset:128
  ds_read_u16_d16_hi v213, v2 offset:1152
  ds_read_u16_d16_hi v210, v2 offset:256
  ds_read_u16_d16_hi v214, v2 offset:1280
  ds_read_u16_d16_hi v211, v14 offset:0
  ds_read_u16_d16_hi v215, v14 offset:1024
  v_pk_mul_f32 v[226:227], v[200:201], v[76:77] op_sel:[1,0] op_sel_hi:[1,1]
  v_pk_mul_f32 v[76:77], v[200:201], v[76:77] op_sel:[0,0] op_sel_hi:[0,1]
  v_pk_fma_f32 v[76:77], v[200:201], v[92:93], v[76:77] op_sel:[1,0,0] op_sel_hi:[1,1,1] neg_lo:[1,0,0] neg_hi:[1,0,0]
  v_pk_fma_f32 v[92:93], v[200:201], v[92:93], v[226:227] op_sel:[0,0,0] op_sel_hi:[0,1,1]
  v_pk_mul_f32 v[224:225], v[200:201], v[78:79] op_sel:[1,0] op_sel_hi:[1,1]
  v_pk_mul_f32 v[78:79], v[200:201], v[78:79] op_sel:[0,0] op_sel_hi:[0,1]
  buffer_load_dwordx4 v130, s[68:71], s19 offen offset:2048 lds
  v_pk_fma_f32 v[78:79], v[200:201], v[94:95], v[78:79] op_sel:[1,0,0] op_sel_hi:[1,1,1] neg_lo:[1,0,0] neg_hi:[1,0,0]
  v_pk_fma_f32 v[94:95], v[200:201], v[94:95], v[224:225] op_sel:[0,0,0] op_sel_hi:[0,1,1]
  v_pk_mul_f32 v[226:227], v[200:201], v[80:81] op_sel:[1,0] op_sel_hi:[1,1]
  v_pk_mul_f32 v[80:81], v[200:201], v[80:81] op_sel:[0,0] op_sel_hi:[0,1]
  v_pk_fma_f32 v[80:81], v[200:201], v[96:97], v[80:81] op_sel:[1,0,0] op_sel_hi:[1,1,1] neg_lo:[1,0,0] neg_hi:[1,0,0]
  v_pk_fma_f32 v[96:97], v[200:201], v[96:97], v[226:227] op_sel:[0,0,0] op_sel_hi:[0,1,1]
  v_pk_mul_f32 v[224:225], v[200:201], v[82:83] op_sel:[1,0] op_sel_hi:[1,1]
  v_pk_mul_f32 v[82:83], v[200:201], v[82:83] op_sel:[0,0] op_sel_hi:[0,1]
  v_pk_fma_f32 v[82:83], v[200:201], v[98:99], v[82:83] op_sel:[1,0,0] op_sel_hi:[1,1,1] neg_lo:[1,0,0] neg_hi:[1,0,0]
  v_pk_fma_f32 v[98:99], v[200:201], v[98:99], v[224:225] op_sel:[0,0,0] op_sel_hi:[0,1,1]
  v_pk_mul_f32 v[226:227], v[200:201], v[84:85] op_sel:[1,0] op_sel_hi:[1,1]
  v_pk_mul_f32 v[84:85], v[200:201], v[84:85] op_sel:[0,0] op_sel_hi:[0,1]
  v_pk_fma_f32 v[84:85], v[200:201], v[100:101], v[84:85] op_sel:[1,0,0] op_sel_hi:[1,1,1] neg_lo:[1,0,0] neg_hi:[1,0,0]
  v_pk_fma_f32 v[100:101], v[200:201], v[100:101], v[226:227] op_sel:[0,0,0] op_sel_hi:[0,1,1]
  v_pk_mul_f32 v[224:225], v[200:201], v[86:87] op_sel:[1,0] op_sel_hi:[1,1]
  v_pk_mul_f32 v[86:87], v[200:201], v[86:87] op_sel:[0,0] op_sel_hi:[0,1]
  v_pk_fma_f32 v[86:87], v[200:201], v[102:103], v[86:87] op_sel:[1,0,0] op_sel_hi:[1,1,1] neg_lo:[1,0,0] neg_hi:[1,0,0]
  v_pk_fma_f32 v[102:103], v[200:201], v[102:103], v[224:225] op_sel:[0,0,0] op_sel_hi:[0,1,1]
  buffer_load_dwordx4 v131, s[68:71], s19 offen offset:3072 lds
  s_add_u32 s19, s19, 128
  s_and_b32 s19, s19, 0x7ff
  v_pk_mul_f32 v[226:227], v[200:201], v[88:89] op_sel:[1,0] op_sel_hi:[1,1]
  v_pk_mul_f32 v[88:89], v[200:201], v[88:89] op_sel:[0,0] op_sel_hi:[0,1]
  v_pk_fma_f32 v[88:89], v[200:201], v[104:105], v[88:89] op_sel:[1,0,0] op_sel_hi:[1,1,1] neg_lo:[1,0,0] neg_hi:[1,0,0]
  v_pk_fma_f32 v[104:105], v[200:201], v[104:105], v[226:227] op_sel:[0,0,0] op_sel_hi:[0,1,1]
  v_pk_mul_f32 v[224:225], v[200:201], v[90:91] op_sel:[1,0] op_sel_hi:[1,1]
  v_pk_mul_f32 v[90:91], v[200:201], v[90:91] op_sel:[0,0] op_sel_hi:[0,1]
  v_pk_fma_f32 v[90:91], v[200:201], v[106:107], v[90:91] op_sel:[1,0,0] op_sel_hi:[1,1,1] neg_lo:[1,0,0] neg_hi:[1,0,0]
  v_pk_fma_f32 v[106:107], v[200:201], v[106:107], v[224:225] op_sel:[0,0,0] op_sel_hi:[0,1,1]
  v_pk_mul_f32 v[226:227], v[200:201], v[108:109] op_sel:[1,0] op_sel_hi:[1,1]
  v_pk_mul_f32 v[108:109], v[200:201], v[108:109] op_sel:[0,0] op_sel_hi:[0,1]
  v_pk_fma_f32 v[108:109], v[200:201], v[144:145], v[108:109] op_sel:[1,0,0] op_sel_hi:[1,1,1] neg_lo:[1,0,0] neg_hi:[1,0,0]
  v_pk_fma_f32 v[144:145], v[200:201], v[144:145], v[226:227] op_sel:[0,0,0] op_sel_hi:[0,1,1]
  v_pk_mul_f32 v[224:225], v[200:201], v[110:111] op_sel:[1,0] op_sel_hi:[1,1]
  v_pk_mul_f32 v[110:111], v[200:201], v[110:111] op_sel:[0,0] op_sel_hi:[0,1]
  v_pk_fma_f32 v[110:111], v[200:201], v[146:147], v[110:111] op_sel:[1,0,0] op_sel_hi:[1,1,1] neg_lo:[1,0,0] neg_hi:[1,0,0]
  v_pk_fma_f32 v[146:147], v[200:201], v[146:147], v[224:225] op_sel:[0,0,0] op_sel_hi:[0,1,1]
  v_pk_mul_f32 v[226:227], v[200:201], v[112:113] op_sel:[1,0] op_sel_hi:[1,1]
  v_pk_mul_f32 v[112:113], v[200:201], v[112:113] op_sel:[0,0] op_sel_hi:[0,1]
  s_waitcnt vmcnt(12)
  ds_read_b128 a[16:19], v132 offset:32768
  ds_read_b128 a[20:23], v133 offset:32768
  ds_read_b128 a[24:27], v132 offset:34816
  ds_read_b128 a[28:31], v133 offset:34816
  s_waitcnt lgkmcnt(15)
  s_add_u32 m0, s20, 81920
  s_nop 0
  buffer_load_dwordx4 v128, s[68:71], s19 offen offset:0 lds
  v_pk_fma_f32 v[112:113], v[200:201], v[148:149], v[112:113] op_sel:[1,0,0] op_sel_hi:[1,1,1] neg_lo:[1,0,0] neg_hi:[1,0,0]
  v_pk_fma_f32 v[148:149], v[200:201], v[148:149], v[226:227] op_sel:[0,0,0] op_sel_hi:[0,1,1]
  v_pk_mul_f32 v[224:225], v[200:201], v[114:115] op_sel:[1,0] op_sel_hi:[1,1]
  v_pk_mul_f32 v[114:115], v[200:201], v[114:115] op_sel:[0,0] op_sel_hi:[0,1]
  v_pk_fma_f32 v[114:115], v[200:201], v[150:151], v[114:115] op_sel:[1,0,0] op_sel_hi:[1,1,1] neg_lo:[1,0,0] neg_hi:[1,0,0]
  v_pk_fma_f32 v[150:151], v[200:201], v[150:151], v[224:225] op_sel:[0,0,0] op_sel_hi:[0,1,1]
  v_pk_mul_f32 v[226:227], v[200:201], v[116:117] op_sel:[1,0] op_sel_hi:[1,1]
  v_pk_mul_f32 v[116:117], v[200:201], v[116:117] op_sel:[0,0] op_sel_hi:[0,1]
  v_pk_fma_f32 v[116:117], v[200:201], v[152:153], v[116:117] op_sel:[1,0,0] op_sel_hi:[1,1,1] neg_lo:[1,0,0] neg_hi:[1,0,0]
  v_pk_fma_f32 v[152:153], v[200:201], v[152:153], v[226:227] op_sel:[0,0,0] op_sel_hi:[0,1,1]
  v_pk_mul_f32 v[224:225], v[200:201], v[118:119] op_sel:[1,0] op_sel_hi:[1,1]
  v_pk_mul_f32 v[118:119], v[200:201], v[118:119] op_sel:[0,0] op_sel_hi:[0,1]
  v_pk_fma_f32 v[118:119], v[200:201], v[154:155], v[118:119] op_sel:[1,0,0] op_sel_hi:[1,1,1] neg_lo:[1,0,0] neg_hi:[1,0,0]
  v_pk_fma_f32 v[154:155], v[200:201], v[154:155], v[224:225] op_sel:[0,0,0] op_sel_hi:[0,1,1]
  v_pk_mul_f32 v[226:227], v[200:201], v[120:121] op_sel:[1,0] op_sel_hi:[1,1]
  v_pk_mul_f32 v[120:121], v[200:201], v[120:121] op_sel:[0,0] op_sel_hi:[0,1]
  v_pk_fma_f32 v[120:121], v[200:201], v[156:157], v[120:121] op_sel:[1,0,0] op_sel_hi:[1,1,1] neg_lo:[1,0,0] neg_hi:[1,0,0]
  v_pk_fma_f32 v[156:157], v[200:201], v[156:157], v[226:227] op_sel:[0,0,0] op_sel_hi:[0,1,1]
  buffer_load_dwordx4 v129, s[68:71], s19 offen offset:1024 lds
  v_pk_mul_f32 v[224:225], v[200:201], v[122:123] op_sel:[1,0] op_sel_hi:[1,1]
  v_pk_mul_f32 v[122:123], v[200:201], v[122:123] op_sel:[0,0] op_sel_hi:[0,1]
  v_pk_fma_f32 v[122:123], v[200:201], v[158:159], v[122:123] op_sel:[1,0,0] op_sel_hi:[1,1,1] neg_lo:[1,0,0] neg_hi:[1,0,0]
  v_pk_fma_f32 v[158:159], v[200:201], v[158:159], v[224:225] op_sel:[0,0,0] op_sel_hi:[0,1,1]
  v_pk_mul_f32 v[14:15], v[200:201], v[196:197] op_sel:[0,0] op_sel_hi:[0,1]
  v_pk_fma_f32 v[14:15], v[200:201], v[196:197], v[14:15] op_sel:[1,1,0] op_sel_hi:[1,0,1] neg_lo:[1,0,0]
  s_cmp_ge_u32 s3, 2
  s_cbranch_scc1 gated_mix__spectral_gfnet__ssm_conv_s5__prompt_kernel_skip28
  v_mov_b32 v14, v200
  v_mov_b32 v15, v201
  v_mov_b32 v16, 0
  v_mov_b32 v17, 0
gated_mix__spectral_gfnet__ssm_conv_s5__prompt_kernel_skip28:
  v_pk_mul_f32 v[226:227], v[194:195], v[14:15] op_sel:[0,0] op_sel_hi:[0,1]
  v_pk_fma_f32 v[226:227], v[194:195], v[14:15], v[226:227] op_sel:[1,1,0] op_sel_hi:[1,0,1] neg_lo:[1,0,0]
  v_pk_fma_f32 v[12:13], v[194:195], v[16:17], v[12:13] op_sel:[0,0,0] op_sel_hi:[0,1,1]
  v_pk_fma_f32 v[12:13], v[194:195], v[16:17], v[12:13] op_sel:[1,1,0] op_sel_hi:[1,0,1] neg_lo:[1,0,0]
  s_mov_b32 exec_lo, 0
  v_mov_b32 v14, v226
  v_mov_b32 v15, v227
  v_mov_b32 v16, v12
  v_mov_b32 v17, v13
  s_mov_b64 exec, -1
  buffer_load_dwordx4 v130, s[68:71], s19 offen offset:2048 lds
  v_mov_b32 v9, v10
  v_pk_mul_f32 v[18:19], v[192:193], v[14:15] op_sel:[0,0] op_sel_hi:[0,1]
  v_pk_fma_f32 v[18:19], v[192:193], v[14:15], v[18:19] op_sel:[1,1,0] op_sel_hi:[1,0,1] neg_lo:[1,0,0]
  v_pk_fma_f32 v[8:9], v[192:193], v[16:17], v[8:9] op_sel:[0,0,0] op_sel_hi:[0,1,1]
  v_pk_fma_f32 v[8:9], v[192:193], v[16:17], v[8:9] op_sel:[1,1,0] op_sel_hi:[1,0,1] neg_lo:[1,0,0]
  v_pk_mul_f32 v[224:225], v[200:201], v[8:9] op_sel:[0,0] op_sel_hi:[0,1]
  v_pk_fma_f32 v[224:225], v[200:201], v[8:9], v[224:225] op_sel:[1,1,0] op_sel_hi:[1,0,1] neg_lo:[1,0,0]
  v_pk_mul_f32 v[226:227], v[200:201], v[16:17] op_sel:[0,0] op_sel_hi:[0,1]
  v_pk_fma_f32 v[226:227], v[200:201], v[16:17], v[226:227] op_sel:[1,1,0] op_sel_hi:[1,0,1] neg_lo:[1,0,0]
  s_waitcnt lgkmcnt(4)
  s_cmp_lg_u32 s12, 0
  s_cbranch_scc1 gated_mix__spectral_gfnet__ssm_conv_s5__prompt_kernel_skip29
  s_add_u32 s10, s21, s6
  s_add_u32 s10, s10, 131072
  s_lshl_b32 s7, s3, 8
  s_add_u32 s7, s7, s8
  s_add_u32 s7, s7, 147456
  s_lshl_b32 vcc_lo, s9, 11
  s_sub_u32 s10, s10, vcc_lo
  v_mov_b32 v194, s10
  v_mov_b32 v195, s7
  v_cndmask_b32 v194, v194, v195, s[22:23]
  ds_read_u16_d16_hi v8, v194
  ds_read_u16_d16_hi v9, v194 offset:1024
  s_add_u32 s10, s21, s6
  s_add_u32 s10, s10, 0
  s_lshl_b32 s7, s3, 8
  s_add_u32 s7, s7, s8
  s_add_u32 s7, s7, 151552
  v_mov_b32 v194, s10
  v_mov_b32 v195, s7
  v_cndmask_b32 v194, v194, v195, s[22:23]
  ds_read_u16_d16_hi v10, v194
  ds_read_u16_d16_hi v11, v194 offset:1024
  s_add_u32 s10, s21, s6
  s_add_u32 s10, s10, 65536
  s_lshl_b32 s7, s3, 8
  s_add_u32 s7, s7, s8
  s_add_u32 s7, s7, 155648
  v_mov_b32 v194, s10
  v_mov_b32 v195, s7
  v_cndmask_b32 v194, v194, v195, s[22:23]
  ds_read_u16_d16_hi v12, v194
  ds_read_u16_d16_hi v13, v194 offset:1024
  s_add_u32 s10, s21, s6
  s_add_u32 s10, s10, 16384
  s_lshl_b32 s7, s3, 8
  s_add_u32 s7, s7, s8
  s_add_u32 s7, s7, 159744
  v_mov_b32 v194, s10
  v_mov_b32 v195, s7
  v_cndmask_b32 v194, v194, v195, s[22:23]
  ds_read_u16_d16_hi v16, v194
  ds_read_u16_d16_hi v17, v194 offset:1024
  s_add_u32 s10, s21, s6
  s_add_u32 s10, s10, 131072
  s_lshl_b32 s7, s3, 8
  s_add_u32 s7, s7, s8
  s_add_u32 s7, s7, 147456
  s_lshl_b32 vcc_lo, s9, 11
  s_add_u32 s7, s7, vcc_lo
  v_mov_b32 v194, s10
  v_mov_b32 v195, s7
  v_cndmask_b32 v194, v194, v195, s[22:23]
  ds_read_u16_d16_hi v192, v194
  ds_read_u16_d16_hi v193, v194 offset:1024
  s_waitcnt lgkmcnt(0)
  s_mov_b32 exec_lo, 1
  s_mov_b32 exec_hi, 0
  v_add_f32 v168, v168, v8
  v_sub_f32 v172, v172, v9
  v_mul_f32 v168, 0.5, v168
  v_mul_f32 v172, 0.5, v172
  v_add_f32 v176, v176, v10
  v_sub_f32 v180, v180, v11
  v_mul_f32 v176, 0.5, v176
  v_mul_f32 v180, 0.5, v180
  v_add_f32 v184, v184, v12
  v_sub_f32 v204, v204, v13
  v_mul_f32 v184, 0.5, v184
  v_mul_f32 v204, 0.5, v204
  v_add_f32 v208, v208, v16
  v_sub_f32 v212, v212, v17
  v_mul_f32 v208, 0.5, v208
  v_mul_f32 v212, 0.5, v212
  v_add_f32 v216, v216, v192
  v_sub_f32 v220, v220, v193
  v_mul_f32 v216, 0.5, v216
  v_mul_f32 v220, 0.5, v220
  s_mov_b32 exec_lo, 0
  s_mov_b32 exec_hi, 1
  v_add_f32 v171, v171, v8
  v_sub_f32 v175, v175, v9
  v_mul_f32 v171, 0.5, v171
  v_mul_f32 v175, 0.5, v175
  v_add_f32 v179, v179, v10
  v_sub_f32 v183, v183, v11
  v_mul_f32 v179, 0.5, v179
  v_mul_f32 v183, 0.5, v183
  v_add_f32 v187, v187, v12
  v_sub_f32 v207, v207, v13
  v_mul_f32 v187, 0.5, v187
  v_mul_f32 v207, 0.5, v207
  v_add_f32 v211, v211, v16
  v_sub_f32 v215, v215, v17
  v_mul_f32 v211, 0.5, v211
  v_mul_f32 v215, 0.5, v215
  v_add_f32 v219, v219, v192
  v_sub_f32 v223, v223, v193
  v_mul_f32 v219, 0.5, v219
  v_mul_f32 v223, 0.5, v223
  s_mov_b64 exec, -1
gated_mix__spectral_gfnet__ssm_conv_s5__prompt_kernel_skip29:
  v_pk_mul_f32 v[172:173], v[188:189], v[172:173] op_sel_hi:[0,1]
  v_pk_mul_f32 v[174:175], v[188:189], v[174:175] op_sel_hi:[0,1]
  v_pk_mul_f32 v[180:181], v[188:189], v[180:181] op_sel_hi:[0,1]
  v_pk_mul_f32 v[182:183], v[188:189], v[182:183] op_sel_hi:[0,1]
  v_pk_mul_f32 v[204:205], v[188:189], v[204:205] op_sel_hi:[0,1]
  v_pk_mul_f32 v[206:207], v[188:189], v[206:207] op_sel_hi:[0,1]
  v_pk_mul_f32 v[212:213], v[188:189], v[212:213] op_sel_hi:[0,1]
  buffer_load_dwordx4 v131, s[68:71], s19 offen offset:3072 lds
  s_add_u32 s19, s19, 128
  s_and_b32 s19, s19, 0x7ff
  v_pk_mul_f32 v[214:215], v[188:189], v[214:215] op_sel_hi:[0,1]
  v_pk_mul_f32 v[220:221], v[188:189], v[220:221] op_sel_hi:[0,1]
  v_pk_mul_f32 v[222:223], v[188:189], v[222:223] op_sel_hi:[0,1]
  buffer_load_dwordx2 v[8:9], v27, s[64:67], 0 offen offset:0 sc1
  buffer_load_dwordx2 v[10:11], v27, s[64:67], 0 offen offset:512 sc1
  buffer_load_dwordx2 v[12:13], v27, s[64:67], 0 offen offset:1024 sc1
  buffer_load_dwordx2 v[16:17], v27, s[64:67], 0 offen offset:1536 sc1
  buffer_load_dwordx2 v[56:57], v27, s[64:67], 0 offen offset:2048 sc1
  buffer_load_dwordx2 v[74:75], v27, s[64:67], 0 offen offset:2560 sc1
  buffer_load_dwordx2 v[188:189], v27, s[64:67], 0 offen offset:3072 sc1
  buffer_load_dwordx2 v[192:193], v27, s[64:67], 0 offen offset:3584 sc1
  s_waitcnt lgkmcnt(0)
  s_add_u32 m0, s20, 32768
  s_nop 0
  buffer_load_dwordx4 v128, s[68:71], s19 offen offset:0 lds
  v_and_b32 v2, 7, v5
  v_lshlrev_b32 v26, 2, v6
  v_xor_b32 v2, v2, v26
  v_lshlrev_b32 v2, 4, v2
  v_lshl_or_b32 v2, v5, 10, v2
  s_lshl_b32 s6, s3, 8
  s_add_u32 s6, s6, 49152
  v_add_u32 v2, s6, v2
  s_waitcnt vmcnt(20)
  v_mov_b32 v228, v20
  s_waitcnt vmcnt(19)
  v_mov_b32 v229, v124
  s_waitcnt vmcnt(18)
  v_mov_b32 v230, v160
  s_waitcnt vmcnt(17)
  v_mov_b32 v231, v164
  v_mov_b32 v232, v21
  v_mov_b32 v233, v125
  v_mov_b32 v234, v161
  v_mov_b32 v235, v165
  v_mfma_f32_16x16x32_bf16 v[236:239], v[228:231], v[32:35], 0
  buffer_load_dwordx4 v129, s[68:71], s19 offen offset:1024 lds
  v_mfma_f32_16x16x32_bf16 v[240:243], v[228:231], v[36:39], 0
  v_mfma_f32_16x16x32_bf16 v[244:247], v[232:235], v[32:35], 0
  v_mfma_f32_16x16x32_bf16 v[248:251], v[232:235], v[36:39], 0
  v_mov_b32 v228, v22
  v_mov_b32 v229, v126
  v_mov_b32 v230, v162
  v_mov_b32 v231, v166
  v_mov_b32 v232, v23
  v_mov_b32 v233, v127
  buffer_load_dwordx4 v130, s[68:71], s19 offen offset:2048 lds
  v_mov_b32 v234, v163
  v_mov_b32 v235, v167
  v_xor_b32 v26, 0, v2
  v_cvt_pk_bf16_f32 v164, v236, v240
  v_cvt_pk_bf16_f32 v165, v237, v241
  v_cvt_pk_bf16_f32 v166, v238, v242
  v_cvt_pk_bf16_f32 v167, v239, v243
  ds_write_b128 v26, v[164:167]
  v_mfma_f32_16x16x32_bf16 v[236:239], v[228:231], v[32:35], 0
  v_mfma_f32_16x16x32_bf16 v[240:243], v[228:231], v[36:39], 0
  v_xor_b32 v26, 16, v2
  v_cvt_pk_bf16_f32 v20, v244, v248
  buffer_load_dwordx4 v131, s[68:71], s19 offen offset:3072 lds
  s_add_u32 s19, s19, 128
  s_and_b32 s19, s19, 0x7ff
  v_cvt_pk_bf16_f32 v21, v245, v249
  v_cvt_pk_bf16_f32 v22, v246, v250
  v_cvt_pk_bf16_f32 v23, v247, v251
  ds_write_b128 v26, v[20:23]
  v_mfma_f32_16x16x32_bf16 v[244:247], v[232:235], v[32:35], 0
  v_mfma_f32_16x16x32_bf16 v[248:251], v[232:235], v[36:39], 0
  v_xor_b32 v26, 32, v2
  v_cvt_pk_bf16_f32 v124, v236, v240
  v_cvt_pk_bf16_f32 v125, v237, v241
  v_cvt_pk_bf16_f32 v126, v238, v242
  v_cvt_pk_bf16_f32 v127, v239, v243
  ds_write_b128 v26, v[124:127]
  v_xor_b32 v26, 48, v2
  s_nop 0
  v_cvt_pk_bf16_f32 v160, v244, v248
  v_cvt_pk_bf16_f32 v161, v245, v249
  v_cvt_pk_bf16_f32 v162, v246, v250
  v_cvt_pk_bf16_f32 v163, v247, v251
  ds_write_b128 v26, v[160:163]
  s_waitcnt vmcnt(4)
  v_max_u32 v2, v8, v9
  v_max3_u32 v2, v2, v10, v11
  v_max3_u32 v2, v2, v12, v13
  v_max3_u32 v2, v2, v16, v17
  v_max3_u32 v2, v2, v56, v57
  v_max3_u32 v2, v2, v74, v75
  v_max3_u32 v2, v2, v188, v189
  v_max3_u32 v2, v2, v192, v193
  v_cmp_eq_u32 vcc, -1, v2
  s_nop 0
  s_cbranch_vccz gated_mix__spectral_gfnet__ssm_conv_s5__prompt_kernel_skip30
  s_mov_b32 s6, 0
gated_mix__spectral_gfnet__ssm_conv_s5__prompt_kernel_lb31:
  buffer_load_dwordx2 v[8:9], v27, s[64:67], 0 offen offset:0 sc1
  buffer_load_dwordx2 v[10:11], v27, s[64:67], 0 offen offset:512 sc1
  buffer_load_dwordx2 v[12:13], v27, s[64:67], 0 offen offset:1024 sc1
  buffer_load_dwordx2 v[16:17], v27, s[64:67], 0 offen offset:1536 sc1
  buffer_load_dwordx2 v[56:57], v27, s[64:67], 0 offen offset:2048 sc1
  buffer_load_dwordx2 v[74:75], v27, s[64:67], 0 offen offset:2560 sc1
  buffer_load_dwordx2 v[188:189], v27, s[64:67], 0 offen offset:3072 sc1
  buffer_load_dwordx2 v[192:193], v27, s[64:67], 0 offen offset:3584 sc1
  s_waitcnt vmcnt(0)
  v_max_u32 v2, v8, v9
  v_max3_u32 v2, v2, v10, v11
  v_max3_u32 v2, v2, v12, v13
  v_max3_u32 v2, v2, v16, v17
  v_max3_u32 v2, v2, v56, v57
  v_max3_u32 v2, v2, v74, v75
  v_max3_u32 v2, v2, v188, v189
  v_max3_u32 v2, v2, v192, v193
  v_cmp_eq_u32 vcc, -1, v2
  s_nop 0
  s_cbranch_vccz gated_mix__spectral_gfnet__ssm_conv_s5__prompt_kernel_lbout32
  s_add_u32 s6, s6, 1
  s_cmp_lt_u32 s6, 1048576
  s_cbranch_scc1 gated_mix__spectral_gfnet__ssm_conv_s5__prompt_kernel_lb31
gated_mix__spectral_gfnet__ssm_conv_s5__prompt_kernel_lbout32:
gated_mix__spectral_gfnet__ssm_conv_s5__prompt_kernel_skip30:
  s_add_u32 s8, s34, 10485760
  s_addc_u32 s9, s35, 0
  s_mov_b32 s10, 8388608
  s_mov_b32 s11, 0x20000
  v_pk_fma_f32 v[188:189], v[202:203], v[192:193], v[188:189] op_sel:[0,0,0] op_sel_hi:[0,1,1]
  v_pk_fma_f32 v[188:189], v[202:203], v[192:193], v[188:189] op_sel:[1,1,0] op_sel_hi:[1,0,1] neg_lo:[1,0,0]
  v_pk_fma_f32 v[74:75], v[202:203], v[188:189], v[74:75] op_sel:[0,0,0] op_sel_hi:[0,1,1]
  v_pk_fma_f32 v[74:75], v[202:203], v[188:189], v[74:75] op_sel:[1,1,0] op_sel_hi:[1,0,1] neg_lo:[1,0,0]
  v_pk_fma_f32 v[56:57], v[202:203], v[74:75], v[56:57] op_sel:[0,0,0] op_sel_hi:[0,1,1]
  v_pk_fma_f32 v[56:57], v[202:203], v[74:75], v[56:57] op_sel:[1,1,0] op_sel_hi:[1,0,1] neg_lo:[1,0,0]
  v_pk_fma_f32 v[16:17], v[202:203], v[56:57], v[16:17] op_sel:[0,0,0] op_sel_hi:[0,1,1]
  v_pk_fma_f32 v[16:17], v[202:203], v[56:57], v[16:17] op_sel:[1,1,0] op_sel_hi:[1,0,1] neg_lo:[1,0,0]
  v_pk_fma_f32 v[12:13], v[202:203], v[16:17], v[12:13] op_sel:[0,0,0] op_sel_hi:[0,1,1]
  v_pk_fma_f32 v[12:13], v[202:203], v[16:17], v[12:13] op_sel:[1,1,0] op_sel_hi:[1,0,1] neg_lo:[1,0,0]
  v_pk_fma_f32 v[10:11], v[202:203], v[12:13], v[10:11] op_sel:[0,0,0] op_sel_hi:[0,1,1]
  v_pk_fma_f32 v[10:11], v[202:203], v[12:13], v[10:11] op_sel:[1,1,0] op_sel_hi:[1,0,1] neg_lo:[1,0,0]
  v_pk_fma_f32 v[8:9], v[202:203], v[10:11], v[8:9] op_sel:[0,0,0] op_sel_hi:[0,1,1]
  v_pk_fma_f32 v[8:9], v[202:203], v[10:11], v[8:9] op_sel:[1,1,0] op_sel_hi:[1,0,1] neg_lo:[1,0,0]
  v_mov_b32 v10, v8
  v_mov_b32 v11, v9
  s_nop 0
  v_permlane32_swap_b32 v8, v10
  v_permlane32_swap_b32 v9, v11
  v_pk_fma_f32 v[8:9], v[198:199], v[10:11], v[8:9] op_sel:[0,0,0] op_sel_hi:[0,1,1]
  v_pk_fma_f32 v[8:9], v[198:199], v[10:11], v[8:9] op_sel:[1,1,0] op_sel_hi:[1,0,1] neg_lo:[1,0,0]
  v_pk_fma_f32 v[226:227], v[14:15], v[8:9], v[226:227] op_sel:[0,0,0] op_sel_hi:[0,1,1]
  v_pk_fma_f32 v[226:227], v[14:15], v[8:9], v[226:227] op_sel:[1,1,0] op_sel_hi:[1,0,1] neg_lo:[1,0,0]
  v_pk_fma_f32 v[224:225], v[18:19], v[8:9], v[224:225] op_sel:[0,0,0] op_sel_hi:[0,1,1]
  v_pk_fma_f32 v[224:225], v[18:19], v[8:9], v[224:225] op_sel:[1,1,0] op_sel_hi:[1,0,1] neg_lo:[1,0,0]
  v_swap_b32 v227, v224
  v_pk_fma_f32 v[76:77], v[190:191], v[226:227], v[76:77] op_sel:[0,0,0] op_sel_hi:[0,1,1]
  v_pk_fma_f32 v[92:93], v[190:191], v[224:225], v[92:93] op_sel:[0,0,0] op_sel_hi:[0,1,1]
  v_pk_fma_f32 v[76:77], v[190:191], v[224:225], v[76:77] op_sel:[1,0,0] op_sel_hi:[1,1,1] neg_lo:[1,0,0] neg_hi:[1,0,0]
  v_pk_fma_f32 v[92:93], v[190:191], v[226:227], v[92:93] op_sel:[1,0,0] op_sel_hi:[1,1,1]
  v_cvt_pk_bf16_f32 v20, v76, v77
  v_cvt_pk_bf16_f32 v21, -v92, -v93
  v_pk_fma_f32 v[78:79], v[190:191], v[76:77], v[78:79] op_sel:[0,0,0] op_sel_hi:[0,1,1]
  v_pk_fma_f32 v[94:95], v[190:191], v[92:93], v[94:95] op_sel:[0,0,0] op_sel_hi:[0,1,1]
  v_pk_fma_f32 v[78:79], v[190:191], v[92:93], v[78:79] op_sel:[1,0,0] op_sel_hi:[1,1,1] neg_lo:[1,0,0] neg_hi:[1,0,0]
  v_pk_fma_f32 v[94:95], v[190:191], v[76:77], v[94:95] op_sel:[1,0,0] op_sel_hi:[1,1,1]
  v_cvt_pk_bf16_f32 v22, v78, v79
  v_cvt_pk_bf16_f32 v23, -v94, -v95
  v_pk_fma_f32 v[80:81], v[190:191], v[78:79], v[80:81] op_sel:[0,0,0] op_sel_hi:[0,1,1]
  v_pk_fma_f32 v[96:97], v[190:191], v[94:95], v[96:97] op_sel:[0,0,0] op_sel_hi:[0,1,1]
  v_permlane32_swap_b32 v20, v21
  v_permlane32_swap_b32 v22, v23
  v_pk_fma_f32 v[80:81], v[190:191], v[94:95], v[80:81] op_sel:[1,0,0] op_sel_hi:[1,1,1] neg_lo:[1,0,0] neg_hi:[1,0,0]
  v_pk_fma_f32 v[96:97], v[190:191], v[78:79], v[96:97] op_sel:[1,0,0] op_sel_hi:[1,1,1]
  v_permlane16_swap_b32 v20, v22
  v_permlane16_swap_b32 v21, v23
  buffer_store_dwordx4 v[20:23], v28, s[8:11], s24 offen sc1
  s_add_u32 s24, s24, 1048576
  v_cvt_pk_bf16_f32 v32, v80, v81
  v_cvt_pk_bf16_f32 v33, -v96, -v97
  v_pk_fma_f32 v[82:83], v[190:191], v[80:81], v[82:83] op_sel:[0,0,0] op_sel_hi:[0,1,1]
  v_pk_fma_f32 v[98:99], v[190:191], v[96:97], v[98:99] op_sel:[0,0,0] op_sel_hi:[0,1,1]
  v_pk_fma_f32 v[82:83], v[190:191], v[96:97], v[82:83] op_sel:[1,0,0] op_sel_hi:[1,1,1] neg_lo:[1,0,0] neg_hi:[1,0,0]
  v_pk_fma_f32 v[98:99], v[190:191], v[80:81], v[98:99] op_sel:[1,0,0] op_sel_hi:[1,1,1]
  v_cvt_pk_bf16_f32 v34, v82, v83
  v_cvt_pk_bf16_f32 v35, -v98, -v99
  v_pk_fma_f32 v[84:85], v[190:191], v[82:83], v[84:85] op_sel:[0,0,0] op_sel_hi:[0,1,1]
  v_pk_fma_f32 v[100:101], v[190:191], v[98:99], v[100:101] op_sel:[0,0,0] op_sel_hi:[0,1,1]
  v_permlane32_swap_b32 v32, v33
  v_permlane32_swap_b32 v34, v35
  v_pk_fma_f32 v[84:85], v[190:191], v[98:99], v[84:85] op_sel:[1,0,0] op_sel_hi:[1,1,1] neg_lo:[1,0,0] neg_hi:[1,0,0]
  v_pk_fma_f32 v[100:101], v[190:191], v[82:83], v[100:101] op_sel:[1,0,0] op_sel_hi:[1,1,1]
  v_permlane16_swap_b32 v32, v34
  v_permlane16_swap_b32 v33, v35
  buffer_store_dwordx4 v[32:35], v28, s[8:11], s24 offen sc1
  s_add_u32 s24, s24, 1048576
  v_cvt_pk_bf16_f32 v36, v84, v85
  v_cvt_pk_bf16_f32 v37, -v100, -v101
  v_pk_fma_f32 v[86:87], v[190:191], v[84:85], v[86:87] op_sel:[0,0,0] op_sel_hi:[0,1,1]
  v_pk_fma_f32 v[102:103], v[190:191], v[100:101], v[102:103] op_sel:[0,0,0] op_sel_hi:[0,1,1]
  v_pk_fma_f32 v[86:87], v[190:191], v[100:101], v[86:87] op_sel:[1,0,0] op_sel_hi:[1,1,1] neg_lo:[1,0,0] neg_hi:[1,0,0]
  v_pk_fma_f32 v[102:103], v[190:191], v[84:85], v[102:103] op_sel:[1,0,0] op_sel_hi:[1,1,1]
  v_cvt_pk_bf16_f32 v38, v86, v87
  v_cvt_pk_bf16_f32 v39, -v102, -v103
  v_pk_fma_f32 v[88:89], v[190:191], v[86:87], v[88:89] op_sel:[0,0,0] op_sel_hi:[0,1,1]
  v_pk_fma_f32 v[104:105], v[190:191], v[102:103], v[104:105] op_sel:[0,0,0] op_sel_hi:[0,1,1]
  v_permlane32_swap_b32 v36, v37
  v_permlane32_swap_b32 v38, v39
  v_pk_fma_f32 v[88:89], v[190:191], v[102:103], v[88:89] op_sel:[1,0,0] op_sel_hi:[1,1,1] neg_lo:[1,0,0] neg_hi:[1,0,0]
  v_pk_fma_f32 v[104:105], v[190:191], v[86:87], v[104:105] op_sel:[1,0,0] op_sel_hi:[1,1,1]
  v_permlane16_swap_b32 v36, v38
  v_permlane16_swap_b32 v37, v39
  buffer_store_dwordx4 v[36:39], v28, s[8:11], s24 offen sc1
  s_add_u32 s24, s24, 1048576
  v_cvt_pk_bf16_f32 v20, v88, v89
  v_cvt_pk_bf16_f32 v21, -v104, -v105
  v_pk_fma_f32 v[90:91], v[190:191], v[88:89], v[90:91] op_sel:[0,0,0] op_sel_hi:[0,1,1]
  v_pk_fma_f32 v[106:107], v[190:191], v[104:105], v[106:107] op_sel:[0,0,0] op_sel_hi:[0,1,1]
  v_pk_fma_f32 v[90:91], v[190:191], v[104:105], v[90:91] op_sel:[1,0,0] op_sel_hi:[1,1,1] neg_lo:[1,0,0] neg_hi:[1,0,0]
  v_pk_fma_f32 v[106:107], v[190:191], v[88:89], v[106:107] op_sel:[1,0,0] op_sel_hi:[1,1,1]
  v_cvt_pk_bf16_f32 v22, v90, v91
  v_cvt_pk_bf16_f32 v23, -v106, -v107
  v_pk_fma_f32 v[108:109], v[190:191], v[90:91], v[108:109] op_sel:[0,0,0] op_sel_hi:[0,1,1]
  v_pk_fma_f32 v[144:145], v[190:191], v[106:107], v[144:145] op_sel:[0,0,0] op_sel_hi:[0,1,1]
  v_permlane32_swap_b32 v20, v21
  v_permlane32_swap_b32 v22, v23
  v_pk_fma_f32 v[108:109], v[190:191], v[106:107], v[108:109] op_sel:[1,0,0] op_sel_hi:[1,1,1] neg_lo:[1,0,0] neg_hi:[1,0,0]
  v_pk_fma_f32 v[144:145], v[190:191], v[90:91], v[144:145] op_sel:[1,0,0] op_sel_hi:[1,1,1]
  v_permlane16_swap_b32 v20, v22
  v_permlane16_swap_b32 v21, v23
  buffer_store_dwordx4 v[20:23], v28, s[8:11], s24 offen sc1
  s_add_u32 s24, s24, 1048576
  v_cvt_pk_bf16_f32 v32, v108, v109
  v_cvt_pk_bf16_f32 v33, -v144, -v145
  v_pk_fma_f32 v[110:111], v[190:191], v[108:109], v[110:111] op_sel:[0,0,0] op_sel_hi:[0,1,1]
  v_pk_fma_f32 v[146:147], v[190:191], v[144:145], v[146:147] op_sel:[0,0,0] op_sel_hi:[0,1,1]
  v_pk_fma_f32 v[110:111], v[190:191], v[144:145], v[110:111] op_sel:[1,0,0] op_sel_hi:[1,1,1] neg_lo:[1,0,0] neg_hi:[1,0,0]
  v_pk_fma_f32 v[146:147], v[190:191], v[108:109], v[146:147] op_sel:[1,0,0] op_sel_hi:[1,1,1]
  v_cvt_pk_bf16_f32 v34, v110, v111
  v_cvt_pk_bf16_f32 v35, -v146, -v147
  v_pk_fma_f32 v[112:113], v[190:191], v[110:111], v[112:113] op_sel:[0,0,0] op_sel_hi:[0,1,1]
  v_pk_fma_f32 v[148:149], v[190:191], v[146:147], v[148:149] op_sel:[0,0,0] op_sel_hi:[0,1,1]
  v_permlane32_swap_b32 v32, v33
  v_permlane32_swap_b32 v34, v35
  v_pk_fma_f32 v[112:113], v[190:191], v[146:147], v[112:113] op_sel:[1,0,0] op_sel_hi:[1,1,1] neg_lo:[1,0,0] neg_hi:[1,0,0]
  v_pk_fma_f32 v[148:149], v[190:191], v[110:111], v[148:149] op_sel:[1,0,0] op_sel_hi:[1,1,1]
  v_permlane16_swap_b32 v32, v34
  v_permlane16_swap_b32 v33, v35
  buffer_store_dwordx4 v[32:35], v28, s[8:11], s24 offen sc1
  s_add_u32 s24, s24, 1048576
  v_cvt_pk_bf16_f32 v36, v112, v113
  v_cvt_pk_bf16_f32 v37, -v148, -v149
  v_pk_fma_f32 v[114:115], v[190:191], v[112:113], v[114:115] op_sel:[0,0,0] op_sel_hi:[0,1,1]
  v_pk_fma_f32 v[150:151], v[190:191], v[148:149], v[150:151] op_sel:[0,0,0] op_sel_hi:[0,1,1]
  v_pk_fma_f32 v[114:115], v[190:191], v[148:149], v[114:115] op_sel:[1,0,0] op_sel_hi:[1,1,1] neg_lo:[1,0,0] neg_hi:[1,0,0]
  v_pk_fma_f32 v[150:151], v[190:191], v[112:113], v[150:151] op_sel:[1,0,0] op_sel_hi:[1,1,1]
  v_cvt_pk_bf16_f32 v38, v114, v115
  v_cvt_pk_bf16_f32 v39, -v150, -v151
  v_pk_fma_f32 v[116:117], v[190:191], v[114:115], v[116:117] op_sel:[0,0,0] op_sel_hi:[0,1,1]
  v_pk_fma_f32 v[152:153], v[190:191], v[150:151], v[152:153] op_sel:[0,0,0] op_sel_hi:[0,1,1]
  v_permlane32_swap_b32 v36, v37
  v_permlane32_swap_b32 v38, v39
  v_pk_fma_f32 v[116:117], v[190:191], v[150:151], v[116:117] op_sel:[1,0,0] op_sel_hi:[1,1,1] neg_lo:[1,0,0] neg_hi:[1,0,0]
  v_pk_fma_f32 v[152:153], v[190:191], v[114:115], v[152:153] op_sel:[1,0,0] op_sel_hi:[1,1,1]
  v_permlane16_swap_b32 v36, v38
  v_permlane16_swap_b32 v37, v39
  buffer_store_dwordx4 v[36:39], v28, s[8:11], s24 offen sc1
  s_add_u32 s24, s24, 1048576
  v_cvt_pk_bf16_f32 v20, v116, v117
  v_cvt_pk_bf16_f32 v21, -v152, -v153
  v_pk_fma_f32 v[118:119], v[190:191], v[116:117], v[118:119] op_sel:[0,0,0] op_sel_hi:[0,1,1]
  v_pk_fma_f32 v[154:155], v[190:191], v[152:153], v[154:155] op_sel:[0,0,0] op_sel_hi:[0,1,1]
  v_pk_fma_f32 v[118:119], v[190:191], v[152:153], v[118:119] op_sel:[1,0,0] op_sel_hi:[1,1,1] neg_lo:[1,0,0] neg_hi:[1,0,0]
  v_pk_fma_f32 v[154:155], v[190:191], v[116:117], v[154:155] op_sel:[1,0,0] op_sel_hi:[1,1,1]
  v_cvt_pk_bf16_f32 v22, v118, v119
  v_cvt_pk_bf16_f32 v23, -v154, -v155
  v_pk_fma_f32 v[120:121], v[190:191], v[118:119], v[120:121] op_sel:[0,0,0] op_sel_hi:[0,1,1]
  v_pk_fma_f32 v[156:157], v[190:191], v[154:155], v[156:157] op_sel:[0,0,0] op_sel_hi:[0,1,1]
  v_permlane32_swap_b32 v20, v21
  v_permlane32_swap_b32 v22, v23
  v_pk_fma_f32 v[120:121], v[190:191], v[154:155], v[120:121] op_sel:[1,0,0] op_sel_hi:[1,1,1] neg_lo:[1,0,0] neg_hi:[1,0,0]
  v_pk_fma_f32 v[156:157], v[190:191], v[118:119], v[156:157] op_sel:[1,0,0] op_sel_hi:[1,1,1]
  v_permlane16_swap_b32 v20, v22
  v_permlane16_swap_b32 v21, v23
  buffer_store_dwordx4 v[20:23], v28, s[8:11], s24 offen sc1
  s_add_u32 s24, s24, 1048576
  v_cvt_pk_bf16_f32 v32, v120, v121
  v_cvt_pk_bf16_f32 v33, -v156, -v157
  v_pk_fma_f32 v[122:123], v[190:191], v[120:121], v[122:123] op_sel:[0,0,0] op_sel_hi:[0,1,1]
  v_pk_fma_f32 v[158:159], v[190:191], v[156:157], v[158:159] op_sel:[0,0,0] op_sel_hi:[0,1,1]
  v_pk_fma_f32 v[122:123], v[190:191], v[156:157], v[122:123] op_sel:[1,0,0] op_sel_hi:[1,1,1] neg_lo:[1,0,0] neg_hi:[1,0,0]
  v_pk_fma_f32 v[158:159], v[190:191], v[120:121], v[158:159] op_sel:[1,0,0] op_sel_hi:[1,1,1]
  v_cvt_pk_bf16_f32 v34, v122, v123
  v_cvt_pk_bf16_f32 v35, -v158, -v159
  v_permlane32_swap_b32 v32, v33
  s_nop 0
  v_permlane32_swap_b32 v34, v35
  s_nop 1
  v_permlane16_swap_b32 v32, v34
  v_permlane16_swap_b32 v33, v35
  buffer_store_dwordx4 v[32:35], v28, s[8:11], s24 offen sc1
  ds_read_b128 a[32:35], v134 offset:32768
  ds_read_b128 a[36:39], v135 offset:32768
  ds_read_b128 a[40:43], v134 offset:34816
  ds_read_b128 a[44:47], v135 offset:34816
  ds_read_b128 a[48:51], v134 offset:49152
  ds_read_b128 a[52:55], v135 offset:49152
  ds_read_b128 a[56:59], v134 offset:51200
  ds_read_b128 a[60:63], v135 offset:51200
  ds_read_b128 a[64:67], v134 offset:16384
  ds_read_b128 a[68:71], v135 offset:16384
  ds_read_b128 a[72:75], v134 offset:18432
  ds_read_b128 a[76:79], v135 offset:18432
  s_waitcnt vmcnt(8)
  ds_read_b128 a[80:83], v132 offset:32768
  ds_read_b128 a[84:87], v133 offset:32768
  ds_read_b128 a[88:91], v132 offset:34816
  ds_read_b128 a[92:95], v133 offset:34816
  s_cmp_lg_u32 s3, 3
  s_cbranch_scc1 gated_mix__spectral_gfnet__ssm_conv_s5__prompt_kernel_skip34
  s_getpc_b64 s[6:7]
gated_mix__spectral_gfnet__ssm_conv_s5__prompt_kernel_pc33:
  s_lshr_b32 s16, s2, 3
  s_mul_i32 s16, s16, 512
  v_min_u32 v8, 3, v4
  v_lshl_add_u32 v8, v8, 7, s16
  v_min_u32 v8, gated_mix__spectral_gfnet__ssm_conv_s5__prompt_kernel_end-gated_mix__spectral_gfnet__ssm_conv_s5__prompt_kernel_pc33, v8
  v_mov_b32 v9, 0
  v_lshl_add_u64 v[8:9], v[8:9], 0, s[6:7]
  global_load_dword v1, v[8:9], off
gated_mix__spectral_gfnet__ssm_conv_s5__prompt_kernel_skip34:
  s_waitcnt lgkmcnt(15)
  s_barrier
  v_lshlrev_b32 v2, 7, v0
  s_add_u32 m0, s20, 0
  s_nop 0
  buffer_load_dwordx4 v128, s[68:71], s19 offen offset:0 lds
  s_and_b32 s6, s3, 1
  s_lshl_b32 s6, s6, 2
  v_xor_b32 v9, s6, v4
  s_lshl_b32 s6, s3, 12
  s_add_u32 s6, s6, 49152
  v_lshl_add_u32 v10, v9, 4, s6
  v_xor_b32 v9, 0, v10
  ds_read_b128 v[12:15], v9 offset:0
  v_xor_b32 v9, 16, v10
  ds_read_b128 v[16:19], v9 offset:1024
  v_xor_b32 v9, 32, v10
  ds_read_b128 v[20:23], v9 offset:2048
  v_xor_b32 v9, 48, v10
  ds_read_b128 v[32:35], v9 offset:3072
  s_waitcnt lgkmcnt(3)
  v_mfma_f32_16x16x32_bf16 v[36:39], v[12:15], v[40:43], 0
  buffer_load_dwordx4 v129, s[68:71], s19 offen offset:1024 lds
  v_mfma_f32_16x16x32_bf16 v[76:79], v[12:15], v[44:47], 0
  s_waitcnt lgkmcnt(2)
  v_mfma_f32_16x16x32_bf16 v[80:83], v[16:19], v[40:43], 0
  v_mfma_f32_16x16x32_bf16 v[84:87], v[16:19], v[44:47], 0
  s_waitcnt lgkmcnt(1)
  v_mfma_f32_16x16x32_bf16 v[88:91], v[20:23], v[40:43], 0
  buffer_load_dwordx4 v130, s[68:71], s19 offen offset:2048 lds
  v_mfma_f32_16x16x32_bf16 v[92:95], v[20:23], v[44:47], 0
  s_waitcnt lgkmcnt(0)
  v_mfma_f32_16x16x32_bf16 v[96:99], v[32:35], v[40:43], 0
  v_mfma_f32_16x16x32_bf16 v[100:103], v[32:35], v[44:47], 0
  v_pk_mul_f32 v[104:105], v[36:37], v[48:49]
  v_pk_mul_f32 v[106:107], v[76:77], v[48:49]
  v_pk_fma_f32 v[104:105], v[76:77], v[52:53], v[104:105]
  v_pk_fma_f32 v[106:107], v[36:37], v[52:53], v[106:107] neg_lo:[0,1,0] neg_hi:[0,1,0]
  buffer_load_dwordx4 v131, s[68:71], s19 offen offset:3072 lds
  s_add_u32 s19, s19, 128
  s_and_b32 s19, s19, 0x7ff
  v_cvt_pk_bf16_f32 v12, v104, v106
  v_cvt_pk_bf16_f32 v13, v105, v107
  v_pk_mul_f32 v[104:105], v[38:39], v[50:51]
  v_pk_mul_f32 v[106:107], v[78:79], v[50:51]
  v_pk_fma_f32 v[104:105], v[78:79], v[54:55], v[104:105]
  v_pk_fma_f32 v[106:107], v[38:39], v[54:55], v[106:107] neg_lo:[0,1,0] neg_hi:[0,1,0]
  v_cvt_pk_bf16_f32 v14, v104, v106
  v_cvt_pk_bf16_f32 v15, v105, v107
  v_pk_mul_f32 v[104:105], v[80:81], v[48:49]
  v_pk_mul_f32 v[106:107], v[84:85], v[48:49]
  v_pk_fma_f32 v[104:105], v[84:85], v[52:53], v[104:105]
  v_pk_fma_f32 v[106:107], v[80:81], v[52:53], v[106:107] neg_lo:[0,1,0] neg_hi:[0,1,0]
  v_cvt_pk_bf16_f32 v16, v104, v106
  v_cvt_pk_bf16_f32 v17, v105, v107
  v_pk_mul_f32 v[104:105], v[82:83], v[50:51]
  v_pk_mul_f32 v[106:107], v[86:87], v[50:51]
  s_add_u32 m0, s20, 65536
  s_nop 0
  buffer_load_dwordx4 v128, s[68:71], s19 offen offset:0 lds
  v_pk_fma_f32 v[104:105], v[86:87], v[54:55], v[104:105]
  v_pk_fma_f32 v[106:107], v[82:83], v[54:55], v[106:107] neg_lo:[0,1,0] neg_hi:[0,1,0]
  v_cvt_pk_bf16_f32 v18, v104, v106
  v_cvt_pk_bf16_f32 v19, v105, v107
  v_mfma_f32_16x16x32_bf16 v[36:39], a[224:227], v[12:15], 0
  v_mfma_f32_16x16x32_bf16 v[76:79], a[228:231], v[12:15], 0
  v_pk_mul_f32 v[104:105], v[88:89], v[48:49]
  v_pk_mul_f32 v[106:107], v[92:93], v[48:49]
  v_pk_fma_f32 v[104:105], v[92:93], v[52:53], v[104:105]
  v_pk_fma_f32 v[106:107], v[88:89], v[52:53], v[106:107] neg_lo:[0,1,0] neg_hi:[0,1,0]
  buffer_load_dwordx4 v129, s[68:71], s19 offen offset:1024 lds
  v_cvt_pk_bf16_f32 v20, v104, v106
  v_cvt_pk_bf16_f32 v21, v105, v107
  v_pk_mul_f32 v[104:105], v[90:91], v[50:51]
  v_pk_mul_f32 v[106:107], v[94:95], v[50:51]
  v_pk_fma_f32 v[104:105], v[94:95], v[54:55], v[104:105]
  v_pk_fma_f32 v[106:107], v[90:91], v[54:55], v[106:107] neg_lo:[0,1,0] neg_hi:[0,1,0]
  v_cvt_pk_bf16_f32 v22, v104, v106
  v_cvt_pk_bf16_f32 v23, v105, v107
  v_mfma_f32_16x16x32_bf16 v[80:83], a[224:227], v[16:19], 0
  v_mfma_f32_16x16x32_bf16 v[84:87], a[228:231], v[16:19], 0
  buffer_load_dwordx4 v130, s[68:71], s19 offen offset:2048 lds
  v_pk_mul_f32 v[104:105], v[96:97], v[48:49]
  v_pk_mul_f32 v[106:107], v[100:101], v[48:49]
  v_pk_fma_f32 v[104:105], v[100:101], v[52:53], v[104:105]
  v_pk_fma_f32 v[106:107], v[96:97], v[52:53], v[106:107] neg_lo:[0,1,0] neg_hi:[0,1,0]
  v_cvt_pk_bf16_f32 v32, v104, v106
  v_cvt_pk_bf16_f32 v33, v105, v107
  v_pk_mul_f32 v[104:105], v[98:99], v[50:51]
  v_pk_mul_f32 v[106:107], v[102:103], v[50:51]
  v_pk_fma_f32 v[104:105], v[102:103], v[54:55], v[104:105]
  v_pk_fma_f32 v[106:107], v[98:99], v[54:55], v[106:107] neg_lo:[0,1,0] neg_hi:[0,1,0]
  v_cvt_pk_bf16_f32 v34, v104, v106
  v_cvt_pk_bf16_f32 v35, v105, v107
  v_mfma_f32_16x16x32_bf16 v[88:91], a[224:227], v[20:23], 0
  buffer_load_dwordx4 v131, s[68:71], s19 offen offset:3072 lds
  s_add_u32 s19, s19, 128
  s_and_b32 s19, s19, 0x7ff
  v_mfma_f32_16x16x32_bf16 v[92:95], a[228:231], v[20:23], 0
  v_mfma_f32_16x16x32_bf16 v[96:99], a[224:227], v[32:35], 0
  v_mfma_f32_16x16x32_bf16 v[100:103], a[228:231], v[32:35], 0
  s_waitcnt vmcnt(8)
  s_barrier
  s_cmp_lg_u32 s3, 0
  s_cbranch_scc1 gated_mix__spectral_gfnet__ssm_conv_s5__prompt_kernel_skip35
  s_mov_b64 exec, 1
  buffer_store_dword v7, v25, s[48:51], s5 offen sc1
  s_mov_b64 exec, -1
gated_mix__spectral_gfnet__ssm_conv_s5__prompt_kernel_skip35:
  s_cmp_eq_u32 s14, 0
  s_cbranch_scc1 gated_mix__spectral_gfnet__ssm_conv_s5__prompt_kernel_skip36
  v_pk_mul_f32 v[104:105], v[36:37], v[216:217]
  v_pk_mul_f32 v[106:107], v[76:77], v[216:217]
  v_pk_fma_f32 v[104:105], v[76:77], v[220:221], v[104:105] neg_lo:[0,1,0] neg_hi:[0,1,0]
  v_pk_fma_f32 v[106:107], v[36:37], v[220:221], v[106:107]
  v_cvt_pk_bf16_f32 v108, v104, v106
  v_cvt_pk_bf16_f32 v109, v105, v107
  v_pk_mul_f32 v[104:105], v[38:39], v[218:219]
  v_pk_mul_f32 v[106:107], v[78:79], v[218:219]
  v_pk_fma_f32 v[104:105], v[78:79], v[222:223], v[104:105] neg_lo:[0,1,0] neg_hi:[0,1,0]
  v_pk_fma_f32 v[106:107], v[38:39], v[222:223], v[106:107]
  v_cvt_pk_bf16_f32 v110, v104, v106
  v_cvt_pk_bf16_f32 v111, v105, v107
  s_nop 1
  v_mfma_f32_16x16x32_bf16 v[216:219], v[108:111], a[232:235], 0
  v_mfma_f32_16x16x32_bf16 v[220:223], v[108:111], a[236:239], 0
  s_nop 6
  v_pk_mul_f32 v[104:105], v[216:217], v[136:137]
  v_pk_mul_f32 v[106:107], v[220:221], v[136:137]
  v_pk_fma_f32 v[104:105], v[220:221], v[140:141], v[104:105] neg_lo:[0,1,0] neg_hi:[0,1,0]
  v_pk_fma_f32 v[106:107], v[216:217], v[140:141], v[106:107]
  v_cvt_pk_bf16_f32 v108, v104, v106
  v_cvt_pk_bf16_f32 v109, v105, v107
  v_pk_mul_f32 v[104:105], v[218:219], v[138:139]
  v_pk_mul_f32 v[106:107], v[222:223], v[138:139]
  v_pk_fma_f32 v[104:105], v[222:223], v[142:143], v[104:105] neg_lo:[0,1,0] neg_hi:[0,1,0]
  v_pk_fma_f32 v[106:107], v[218:219], v[142:143], v[106:107]
  v_cvt_pk_bf16_f32 v110, v104, v106
  v_cvt_pk_bf16_f32 v111, v105, v107
  s_nop 1
  v_mfma_f32_16x16x32_bf16 v[216:219], a[240:243], v[108:111], 0
  v_mfma_f32_16x16x32_bf16 v[220:223], a[244:247], v[108:111], 0
gated_mix__spectral_gfnet__ssm_conv_s5__prompt_kernel_skip36:
  s_add_u32 m0, s20, 16384
  s_nop 0
  buffer_load_dwordx4 v128, s[68:71], s19 offen offset:0 lds
  v_pk_mul_f32 v[104:105], v[36:37], v[168:169]
  v_pk_mul_f32 v[106:107], v[76:77], v[168:169]
  v_pk_fma_f32 v[104:105], v[76:77], v[172:173], v[104:105] neg_lo:[0,1,0] neg_hi:[0,1,0]
  v_pk_fma_f32 v[106:107], v[36:37], v[172:173], v[106:107]
  v_cvt_pk_bf16_f32 v12, v104, v106
  v_cvt_pk_bf16_f32 v13, v105, v107
  v_pk_mul_f32 v[104:105], v[38:39], v[170:171]
  v_pk_mul_f32 v[106:107], v[78:79], v[170:171]
  v_pk_fma_f32 v[104:105], v[78:79], v[174:175], v[104:105] neg_lo:[0,1,0] neg_hi:[0,1,0]
  v_pk_fma_f32 v[106:107], v[38:39], v[174:175], v[106:107]
  v_cvt_pk_bf16_f32 v14, v104, v106
  v_cvt_pk_bf16_f32 v15, v105, v107
  v_pk_mul_f32 v[104:105], v[80:81], v[176:177]
  v_pk_mul_f32 v[106:107], v[84:85], v[176:177]
  v_pk_fma_f32 v[104:105], v[84:85], v[180:181], v[104:105] neg_lo:[0,1,0] neg_hi:[0,1,0]
  v_pk_fma_f32 v[106:107], v[80:81], v[180:181], v[106:107]
  buffer_load_dwordx4 v129, s[68:71], s19 offen offset:1024 lds
  v_cvt_pk_bf16_f32 v16, v104, v106
  v_cvt_pk_bf16_f32 v17, v105, v107
  v_pk_mul_f32 v[104:105], v[82:83], v[178:179]
  v_pk_mul_f32 v[106:107], v[86:87], v[178:179]
  v_pk_fma_f32 v[104:105], v[86:87], v[182:183], v[104:105] neg_lo:[0,1,0] neg_hi:[0,1,0]
  v_pk_fma_f32 v[106:107], v[82:83], v[182:183], v[106:107]
  v_cvt_pk_bf16_f32 v18, v104, v106
  v_cvt_pk_bf16_f32 v19, v105, v107
  v_mfma_f32_16x16x32_bf16 v[36:39], v[12:15], a[232:235], 0
  v_mfma_f32_16x16x32_bf16 v[76:79], v[12:15], a[236:239], 0
  buffer_load_dwordx4 v130, s[68:71], s19 offen offset:2048 lds
  v_pk_mul_f32 v[104:105], v[88:89], v[184:185]
  v_pk_mul_f32 v[106:107], v[92:93], v[184:185]
  v_pk_fma_f32 v[104:105], v[92:93], v[204:205], v[104:105] neg_lo:[0,1,0] neg_hi:[0,1,0]
  v_pk_fma_f32 v[106:107], v[88:89], v[204:205], v[106:107]
  v_cvt_pk_bf16_f32 v20, v104, v106
  v_cvt_pk_bf16_f32 v21, v105, v107
  v_pk_mul_f32 v[104:105], v[90:91], v[186:187]
  v_pk_mul_f32 v[106:107], v[94:95], v[186:187]
  v_pk_fma_f32 v[104:105], v[94:95], v[206:207], v[104:105] neg_lo:[0,1,0] neg_hi:[0,1,0]
  v_pk_fma_f32 v[106:107], v[90:91], v[206:207], v[106:107]
  v_cvt_pk_bf16_f32 v22, v104, v106
  v_cvt_pk_bf16_f32 v23, v105, v107
  v_mfma_f32_16x16x32_bf16 v[80:83], v[16:19], a[232:235], 0
  buffer_load_dwordx4 v131, s[68:71], s19 offen offset:3072 lds
  s_add_u32 s19, s19, 128
  s_and_b32 s19, s19, 0x7ff
  v_mfma_f32_16x16x32_bf16 v[84:87], v[16:19], a[236:239], 0
  v_pk_mul_f32 v[104:105], v[96:97], v[208:209]
  v_pk_mul_f32 v[106:107], v[100:101], v[208:209]
  v_pk_fma_f32 v[104:105], v[100:101], v[212:213], v[104:105] neg_lo:[0,1,0] neg_hi:[0,1,0]
  v_pk_fma_f32 v[106:107], v[96:97], v[212:213], v[106:107]
  v_cvt_pk_bf16_f32 v32, v104, v106
  v_cvt_pk_bf16_f32 v33, v105, v107
  v_pk_mul_f32 v[104:105], v[98:99], v[210:211]
  v_pk_mul_f32 v[106:107], v[102:103], v[210:211]
  v_pk_fma_f32 v[104:105], v[102:103], v[214:215], v[104:105] neg_lo:[0,1,0] neg_hi:[0,1,0]
  v_pk_fma_f32 v[106:107], v[98:99], v[214:215], v[106:107]
  v_cvt_pk_bf16_f32 v34, v104, v106
  v_cvt_pk_bf16_f32 v35, v105, v107
  s_add_u32 m0, s20, 98304
  s_nop 0
  buffer_load_dwordx4 v128, s[68:71], s19 offen offset:0 lds
  v_mfma_f32_16x16x32_bf16 v[88:91], v[20:23], a[232:235], 0
  v_mfma_f32_16x16x32_bf16 v[92:95], v[20:23], a[236:239], 0
  v_mfma_f32_16x16x32_bf16 v[96:99], v[32:35], a[232:235], 0
  v_mfma_f32_16x16x32_bf16 v[100:103], v[32:35], a[236:239], 0
  buffer_load_dwordx4 v129, s[68:71], s19 offen offset:1024 lds
  v_pk_mul_f32 v[104:105], v[36:37], v[136:137]
  v_pk_mul_f32 v[106:107], v[76:77], v[136:137]
  v_pk_fma_f32 v[104:105], v[76:77], v[140:141], v[104:105] neg_lo:[0,1,0] neg_hi:[0,1,0]
  v_pk_fma_f32 v[106:107], v[36:37], v[140:141], v[106:107]
  v_cvt_pk_bf16_f32 v12, v104, v106
  v_cvt_pk_bf16_f32 v13, v105, v107
  v_pk_mul_f32 v[104:105], v[38:39], v[138:139]
  v_pk_mul_f32 v[106:107], v[78:79], v[138:139]
  v_pk_fma_f32 v[104:105], v[78:79], v[142:143], v[104:105] neg_lo:[0,1,0] neg_hi:[0,1,0]
  v_pk_fma_f32 v[106:107], v[38:39], v[142:143], v[106:107]
  v_cvt_pk_bf16_f32 v14, v104, v106
  v_cvt_pk_bf16_f32 v15, v105, v107
  v_pk_mul_f32 v[104:105], v[80:81], v[136:137]
  v_pk_mul_f32 v[106:107], v[84:85], v[136:137]
  v_pk_fma_f32 v[104:105], v[84:85], v[140:141], v[104:105] neg_lo:[0,1,0] neg_hi:[0,1,0]
  v_pk_fma_f32 v[106:107], v[80:81], v[140:141], v[106:107]
  buffer_load_dwordx4 v130, s[68:71], s19 offen offset:2048 lds
  v_cvt_pk_bf16_f32 v16, v104, v106
  v_cvt_pk_bf16_f32 v17, v105, v107
  v_pk_mul_f32 v[104:105], v[82:83], v[138:139]
  v_pk_mul_f32 v[106:107], v[86:87], v[138:139]
  v_pk_fma_f32 v[104:105], v[86:87], v[142:143], v[104:105] neg_lo:[0,1,0] neg_hi:[0,1,0]
  v_pk_fma_f32 v[106:107], v[82:83], v[142:143], v[106:107]
  v_cvt_pk_bf16_f32 v18, v104, v106
  v_cvt_pk_bf16_f32 v19, v105, v107
  v_mfma_f32_16x16x32_bf16 v[36:39], a[240:243], v[12:15], 0
  v_mfma_f32_16x16x32_bf16 v[76:79], a[244:247], v[12:15], 0
  buffer_load_dwordx4 v131, s[68:71], s19 offen offset:3072 lds
  s_add_u32 s19, s19, 128
  s_and_b32 s19, s19, 0x7ff
  v_pk_mul_f32 v[104:105], v[88:89], v[136:137]
  v_pk_mul_f32 v[106:107], v[92:93], v[136:137]
  v_pk_fma_f32 v[104:105], v[92:93], v[140:141], v[104:105] neg_lo:[0,1,0] neg_hi:[0,1,0]
  v_pk_fma_f32 v[106:107], v[88:89], v[140:141], v[106:107]
  v_cvt_pk_bf16_f32 v20, v104, v106
  v_cvt_pk_bf16_f32 v21, v105, v107
  v_pk_mul_f32 v[104:105], v[90:91], v[138:139]
  v_pk_mul_f32 v[106:107], v[94:95], v[138:139]
  v_pk_fma_f32 v[104:105], v[94:95], v[142:143], v[104:105] neg_lo:[0,1,0] neg_hi:[0,1,0]
  v_pk_fma_f32 v[106:107], v[90:91], v[142:143], v[106:107]
  v_cvt_pk_bf16_f32 v22, v104, v106
  v_cvt_pk_bf16_f32 v23, v105, v107
  v_mfma_f32_16x16x32_bf16 v[80:83], a[240:243], v[16:19], 0
  s_add_u32 m0, s20, 114688
  s_nop 0
  buffer_load_dwordx4 v128, s[68:71], s19 offen offset:0 lds
  v_mfma_f32_16x16x32_bf16 v[84:87], a[244:247], v[16:19], 0
  v_pk_mul_f32 v[104:105], v[96:97], v[136:137]
  v_pk_mul_f32 v[106:107], v[100:101], v[136:137]
  v_pk_fma_f32 v[104:105], v[100:101], v[140:141], v[104:105] neg_lo:[0,1,0] neg_hi:[0,1,0]
  v_pk_fma_f32 v[106:107], v[96:97], v[140:141], v[106:107]
  v_cvt_pk_bf16_f32 v32, v104, v106
  v_cvt_pk_bf16_f32 v33, v105, v107
  v_pk_mul_f32 v[104:105], v[98:99], v[138:139]
  v_pk_mul_f32 v[106:107], v[102:103], v[138:139]
  v_pk_fma_f32 v[104:105], v[102:103], v[142:143], v[104:105] neg_lo:[0,1,0] neg_hi:[0,1,0]
  v_pk_fma_f32 v[106:107], v[98:99], v[142:143], v[106:107]
  v_cvt_pk_bf16_f32 v34, v104, v106
  v_cvt_pk_bf16_f32 v35, v105, v107
  buffer_load_dwordx4 v129, s[68:71], s19 offen offset:1024 lds
  v_mfma_f32_16x16x32_bf16 v[88:91], a[240:243], v[20:23], 0
  v_mfma_f32_16x16x32_bf16 v[92:95], a[244:247], v[20:23], 0
  v_mfma_f32_16x16x32_bf16 v[96:99], a[240:243], v[32:35], 0
  v_mfma_f32_16x16x32_bf16 v[100:103], a[244:247], v[32:35], 0
  buffer_load_dwordx4 v130, s[68:71], s19 offen offset:2048 lds
  v_lshlrev_b32 v9, 12, v6
  v_lshl_add_u32 v9, v5, 4, v9
  s_lshl_b32 s6, s3, 8
  s_add_u32 s6, s6, 147456
  v_add_u32 v9, s6, v9
  s_sub_u32 s6, s14, 1
  s_or_b32 s6, s6, s3
  s_cmp_lg_u32 s6, 0
  s_cbranch_scc1 gated_mix__spectral_gfnet__ssm_conv_s5__prompt_kernel_skip37
  v_mov_b32 v76, v220
  v_mov_b32 v77, v221
  v_mov_b32 v78, v222
  v_mov_b32 v79, v223
gated_mix__spectral_gfnet__ssm_conv_s5__prompt_kernel_skip37:
  v_cvt_pk_bf16_f32 v12, v36, v76
  v_cvt_pk_bf16_f32 v13, v80, v84
  v_cvt_pk_bf16_f32 v14, v88, v92
  v_cvt_pk_bf16_f32 v15, v96, v100
  ds_write_b128 v9, v[12:15] offset:0
  v_cvt_pk_bf16_f32 v16, v37, v77
  v_cvt_pk_bf16_f32 v17, v81, v85
  buffer_load_dwordx4 v131, s[68:71], s19 offen offset:3072 lds
  s_add_u32 s19, s19, 128
  s_and_b32 s19, s19, 0x7ff
  v_cvt_pk_bf16_f32 v18, v89, v93
  v_cvt_pk_bf16_f32 v19, v97, v101
  ds_write_b128 v9, v[16:19] offset:1024
  v_cvt_pk_bf16_f32 v20, v38, v78
  v_cvt_pk_bf16_f32 v21, v82, v86
  v_cvt_pk_bf16_f32 v22, v90, v94
  v_cvt_pk_bf16_f32 v23, v98, v102
  ds_write_b128 v9, v[20:23] offset:2048
  v_cvt_pk_bf16_f32 v32, v39, v79
  v_cvt_pk_bf16_f32 v33, v83, v87
  v_cvt_pk_bf16_f32 v34, v91, v95
  v_cvt_pk_bf16_f32 v35, v99, v103
  ds_write_b128 v9, v[32:35] offset:3072
  s_add_u32 m0, s20, 81920
  s_nop 0
  buffer_load_dwordx4 v128, s[68:71], s19 offen offset:0 lds
  buffer_load_dwordx4 v129, s[68:71], s19 offen offset:1024 lds
  buffer_load_dwordx4 v130, s[68:71], s19 offen offset:2048 lds
  buffer_load_dwordx4 v131, s[68:71], s19 offen offset:3072 lds
  s_add_u32 s19, s19, 128
  s_and_b32 s19, s19, 0x7ff
  s_waitcnt vmcnt(20)
  ds_read_b128 a[96:99], v132 offset:0
  ds_read_b128 a[100:103], v133 offset:0
  ds_read_b128 a[104:107], v132 offset:2048
  ds_read_b128 a[108:111], v133 offset:2048
  s_add_u32 m0, s20, 32768
  s_nop 0
  buffer_load_dwordx4 v128, s[68:71], s19 offen offset:0 lds
  buffer_load_dwordx4 v129, s[68:71], s19 offen offset:1024 lds
  buffer_load_dwordx4 v130, s[68:71], s19 offen offset:2048 lds
  buffer_load_dwordx4 v131, s[68:71], s19 offen offset:3072 lds
  s_add_u32 s19, s19, 128
  s_and_b32 s19, s19, 0x7ff
  s_waitcnt vmcnt(20)
  ds_read_b128 a[112:115], v134 offset:0
  ds_read_b128 a[116:119], v135 offset:0
  ds_read_b128 a[120:123], v134 offset:2048
  ds_read_b128 a[124:127], v135 offset:2048
  s_waitcnt lgkmcnt(4)
  s_add_u32 m0, s20, 0
  s_nop 0
  buffer_load_dwordx4 v128, s[68:71], s19 offen offset:0 lds
  buffer_load_dwordx4 v129, s[68:71], s19 offen offset:1024 lds
  buffer_load_dwordx4 v130, s[68:71], s19 offen offset:2048 lds
  buffer_load_dwordx4 v131, s[68:71], s19 offen offset:3072 lds
  s_add_u32 s19, s19, 128
  s_and_b32 s19, s19, 0x7ff
  s_waitcnt lgkmcnt(0)
  s_barrier
  s_lshl_b32 s6, s3, 12
  s_add_u32 s6, s6, 147456
  v_lshl_add_u32 v9, v4, 4, s6
  ds_read_b128 v[12:15], v9 offset:0
  ds_read_b128 v[16:19], v9 offset:1024
  ds_read_b128 v[20:23], v9 offset:2048
  ds_read_b128 v[32:35], v9 offset:3072
  s_mov_b32 s6, 1048576
  v_mul_lo_u32 v9, v6, s6
  v_lshl_add_u32 v9, v5, 2, v9
  s_mul_i32 s7, s3, 65536
  s_lshr_b32 s6, s40, 4
  s_lshl_b32 s6, s6, 12
  s_add_u32 s7, s7, s6
  s_lshl_b32 s6, s41, 10
  s_add_u32 s7, s7, s6
  s_and_b32 s6, s40, 15
  s_lshl_b32 s6, s6, 6
  s_add_u32 s7, s7, s6
  s_waitcnt lgkmcnt(3)
  v_mfma_f32_16x16x32_bf16 v[36:39], a[248:251], v[12:15], 0
  v_mfma_f32_16x16x32_bf16 v[40:43], a[252:255], v[12:15], 0
  s_waitcnt lgkmcnt(2)
  v_mfma_f32_16x16x32_bf16 v[44:47], a[248:251], v[16:19], 0
  v_mfma_f32_16x16x32_bf16 v[48:51], a[252:255], v[16:19], 0
  s_waitcnt lgkmcnt(1)
  v_mfma_f32_16x16x32_bf16 v[52:55], a[248:251], v[20:23], 0
  v_mfma_f32_16x16x32_bf16 v[76:79], a[252:255], v[20:23], 0
  s_waitcnt lgkmcnt(0)
  v_mfma_f32_16x16x32_bf16 v[80:83], a[248:251], v[32:35], 0
  v_mfma_f32_16x16x32_bf16 v[84:87], a[252:255], v[32:35], 0
  v_cvt_pk_bf16_f32 v12, v36, v40
  v_cvt_pk_bf16_f32 v13, v37, v41
  v_cvt_pk_bf16_f32 v14, v38, v42
  v_cvt_pk_bf16_f32 v15, v39, v43
  v_cvt_pk_bf16_f32 v16, v44, v48
  v_cvt_pk_bf16_f32 v17, v45, v49
  v_cvt_pk_bf16_f32 v18, v46, v50
  v_cvt_pk_bf16_f32 v19, v47, v51
  v_cvt_pk_bf16_f32 v20, v52, v76
  v_cvt_pk_bf16_f32 v21, v53, v77
  v_cvt_pk_bf16_f32 v22, v54, v78
  v_cvt_pk_bf16_f32 v23, v55, v79
  v_cvt_pk_bf16_f32 v32, v80, v84
  v_cvt_pk_bf16_f32 v33, v81, v85
  v_cvt_pk_bf16_f32 v34, v82, v86
  v_cvt_pk_bf16_f32 v35, v83, v87
  buffer_load_dword v8, v2, s[48:51], s5 offen sc1
  s_add_u32 s24, s34, 5242880
  s_addc_u32 s25, s35, 0
  s_mov_b32 s26, 4194304
  s_mov_b32 s27, 0x20000
  s_waitcnt vmcnt(21)
  ds_read_b128 a[128:131], v132 offset:16384
  ds_read_b128 a[132:135], v133 offset:16384
  ds_read_b128 a[136:139], v132 offset:18432
  ds_read_b128 a[140:143], v133 offset:18432
  s_waitcnt vmcnt(17)
  ds_read_b128 a[144:147], v134 offset:32768
  ds_read_b128 a[148:151], v135 offset:32768
  ds_read_b128 a[152:155], v134 offset:34816
  ds_read_b128 a[156:159], v135 offset:34816
  s_waitcnt vmcnt(13)
  ds_read_b128 a[160:163], v134 offset:49152
  ds_read_b128 a[164:167], v135 offset:49152
  ds_read_b128 a[168:171], v134 offset:51200
  ds_read_b128 a[172:175], v135 offset:51200
  s_waitcnt vmcnt(9)
  ds_read_b128 a[176:179], v134 offset:16384
  ds_read_b128 a[180:183], v135 offset:16384
  ds_read_b128 a[184:187], v134 offset:18432
  ds_read_b128 a[188:191], v135 offset:18432
  s_waitcnt vmcnt(5)
  ds_read_b128 a[192:195], v132 offset:32768
  ds_read_b128 a[196:199], v133 offset:32768
  ds_read_b128 a[200:203], v132 offset:34816
  ds_read_b128 a[204:207], v133 offset:34816
  s_waitcnt vmcnt(1)
  ds_read_b128 a[208:211], v132 offset:0
  ds_read_b128 a[212:215], v133 offset:0
  ds_read_b128 a[216:219], v132 offset:2048
  ds_read_b128 a[220:223], v133 offset:2048
  buffer_store_dword v12, v9, s[24:27], s7 offen sc1
  s_add_u32 s7, s7, 262144
  buffer_store_dword v13, v9, s[24:27], s7 offen sc1
  s_add_u32 s7, s7, 262144
  buffer_store_dword v14, v9, s[24:27], s7 offen sc1
  s_add_u32 s7, s7, 262144
  buffer_store_dword v15, v9, s[24:27], s7 offen sc1
  s_sub_u32 s7, s7, 770048
  buffer_store_dword v16, v9, s[24:27], s7 offen sc1
  s_add_u32 s7, s7, 262144
  buffer_store_dword v17, v9, s[24:27], s7 offen sc1
  s_add_u32 s7, s7, 262144
  buffer_store_dword v18, v9, s[24:27], s7 offen sc1
  s_add_u32 s7, s7, 262144
  buffer_store_dword v19, v9, s[24:27], s7 offen sc1
  s_sub_u32 s7, s7, 770048
  buffer_store_dword v20, v9, s[24:27], s7 offen sc1
  s_add_u32 s7, s7, 262144
  buffer_store_dword v21, v9, s[24:27], s7 offen sc1
  s_add_u32 s7, s7, 262144
  buffer_store_dword v22, v9, s[24:27], s7 offen sc1
  s_add_u32 s7, s7, 262144
  buffer_store_dword v23, v9, s[24:27], s7 offen sc1
  s_sub_u32 s7, s7, 770048
  buffer_store_dword v32, v9, s[24:27], s7 offen sc1
  s_add_u32 s7, s7, 262144
  buffer_store_dword v33, v9, s[24:27], s7 offen sc1
  s_add_u32 s7, s7, 262144
  buffer_store_dword v34, v9, s[24:27], s7 offen sc1
  s_add_u32 s7, s7, 262144
  buffer_store_dword v35, v9, s[24:27], s7 offen sc1
  s_and_b32 s16, s3, 1
  s_mul_i32 s7, s16, 20480
  s_lshl_b32 s6, s42, 19
  s_add_u32 s7, s7, s6
  v_lshl_add_u32 v10, v4, 4, s7
  v_xor_b32 v11, 4096, v10
  s_lshr_b32 s6, s3, 1
  s_add_u32 s6, s6, s18
  s_and_b32 s6, s6, 15
  s_lshl_b32 s6, s6, 15
  s_lshl_b32 s7, s3, 13
  v_and_b32 v16, 3, v4
  v_and_b32 v17, 2, v6
  v_xor_b32 v17, v17, v16
  v_lshlrev_b32 v16, 9, v16
  v_lshl_or_b32 v16, v17, 6, v16
  v_bfe_u32 v17, v4, 2, 2
  v_lshl_or_b32 v16, v17, 4, v16
  v_and_b32 v17, 1, v6
  v_lshl_or_b32 v16, v17, 3, v16
  s_lshl_b32 s16, s16, 13
  v_add_u32 v12, s16, v16
  v_xor_b32 v13, 64, v12
  v_add_u32 v14, 0x10000, v12
  v_add_u32 v15, 0x10000, v13
  v_lshlrev_b32 v16, 16, v58
  v_and_b32 v17, 0xffff0000, v58
  v_lshlrev_b32 v18, 16, v59
  v_and_b32 v19, 0xffff0000, v59
  v_pk_mul_f32 v[16:17], v[30:31], v[16:17] op_sel:[0,0] op_sel_hi:[0,1]
  v_pk_mul_f32 v[18:19], v[30:31], v[18:19] op_sel:[0,0] op_sel_hi:[0,1]
  v_lshlrev_b32 v20, 16, v60
  v_and_b32 v21, 0xffff0000, v60
  v_lshlrev_b32 v22, 16, v61
  v_and_b32 v23, 0xffff0000, v61
  v_pk_mul_f32 v[20:21], v[30:31], v[20:21] op_sel:[0,0] op_sel_hi:[0,1]
  v_pk_mul_f32 v[22:23], v[30:31], v[22:23] op_sel:[0,0] op_sel_hi:[0,1]
  v_lshlrev_b32 v40, 16, v62
  v_and_b32 v41, 0xffff0000, v62
  v_lshlrev_b32 v42, 16, v63
  v_and_b32 v43, 0xffff0000, v63
  v_pk_mul_f32 v[40:41], v[30:31], v[40:41] op_sel:[1,0] op_sel_hi:[1,1]
  v_pk_mul_f32 v[42:43], v[30:31], v[42:43] op_sel:[1,0] op_sel_hi:[1,1]
  v_lshlrev_b32 v44, 16, v64
  v_and_b32 v45, 0xffff0000, v64
  v_lshlrev_b32 v46, 16, v65
  v_and_b32 v47, 0xffff0000, v65
  v_pk_mul_f32 v[44:45], v[30:31], v[44:45] op_sel:[1,0] op_sel_hi:[1,1]
  v_pk_mul_f32 v[46:47], v[30:31], v[46:47] op_sel:[1,0] op_sel_hi:[1,1]
  v_lshlrev_b32 v76, 16, v66
  v_and_b32 v77, 0xffff0000, v66
  v_lshlrev_b32 v78, 16, v67
  v_and_b32 v79, 0xffff0000, v67
  v_pk_mul_f32 v[76:77], v[30:31], v[76:77] op_sel:[0,0] op_sel_hi:[0,1]
  v_pk_mul_f32 v[78:79], v[30:31], v[78:79] op_sel:[0,0] op_sel_hi:[0,1]
  v_lshlrev_b32 v80, 16, v68
  v_and_b32 v81, 0xffff0000, v68
  v_lshlrev_b32 v82, 16, v69
  v_and_b32 v83, 0xffff0000, v69
  v_pk_mul_f32 v[80:81], v[30:31], v[80:81] op_sel:[0,0] op_sel_hi:[0,1]
  v_pk_mul_f32 v[82:83], v[30:31], v[82:83] op_sel:[0,0] op_sel_hi:[0,1]
  v_lshlrev_b32 v92, 16, v70
  v_and_b32 v93, 0xffff0000, v70
  v_lshlrev_b32 v94, 16, v71
  v_and_b32 v95, 0xffff0000, v71
  v_pk_mul_f32 v[92:93], v[30:31], v[92:93] op_sel:[1,0] op_sel_hi:[1,1]
  v_pk_mul_f32 v[94:95], v[30:31], v[94:95] op_sel:[1,0] op_sel_hi:[1,1]
  v_lshlrev_b32 v96, 16, v72
  v_and_b32 v97, 0xffff0000, v72
  v_lshlrev_b32 v98, 16, v73
  v_and_b32 v99, 0xffff0000, v73
  v_pk_mul_f32 v[96:97], v[30:31], v[96:97] op_sel:[1,0] op_sel_hi:[1,1]
  v_pk_mul_f32 v[98:99], v[30:31], v[98:99] op_sel:[1,0] op_sel_hi:[1,1]
  s_waitcnt vmcnt(16)
  v_cmp_ne_u32 vcc, 1, v8
  s_nop 0
  s_cbranch_vccz gated_mix__spectral_gfnet__ssm_conv_s5__prompt_kernel_skip38
  s_mov_b32 s16, 0
gated_mix__spectral_gfnet__ssm_conv_s5__prompt_kernel_poll39:
  s_sleep 5
  buffer_load_dword v8, v2, s[48:51], s5 offen sc1
  s_waitcnt vmcnt(0)
  v_cmp_ne_u32 vcc, 1, v8
  s_nop 0
  s_cbranch_vccz gated_mix__spectral_gfnet__ssm_conv_s5__prompt_kernel_pollout40
  s_add_u32 s16, s16, 1
  s_cmp_lt_u32 s16, 1048576
  s_cbranch_scc1 gated_mix__spectral_gfnet__ssm_conv_s5__prompt_kernel_poll39
gated_mix__spectral_gfnet__ssm_conv_s5__prompt_kernel_pollout40:
gated_mix__spectral_gfnet__ssm_conv_s5__prompt_kernel_skip38:
  s_waitcnt lgkmcnt(0)
  s_barrier
  s_add_u32 m0, s7, 0
  s_nop 0
  buffer_load_dwordx4 v10, s[8:11], s6 offen offset:0 sc1 lds
  buffer_load_dwordx4 v10, s[8:11], s6 offen offset:1024 sc1 lds
  buffer_load_dwordx4 v10, s[8:11], s6 offen offset:2048 sc1 lds
  v_lshrrev_b32 v2, 1, v6
  v_lshlrev_b32 v2, 3, v2
  v_and_b32 v8, 1, v6
  v_lshl_add_u32 v2, v8, 1, v2
  v_cvt_f32_u32 v9, v2
  v_bfe_i32 v2, v5, 0, 1
  v_and_b32 v26, 0x02020202, v2
  v_xor_b32 v26, 0x03020100, v26
  v_and_b32 v2, 0x80000000, v2
  v_bfe_i32 v27, v5, 1, 1
  v_and_b32 v27, 0x80008000, v27
  v_xor_b32 v27, v27, v2
  buffer_load_dwordx4 v10, s[8:11], s6 offen offset:3072 sc1 lds
  s_and_b32 s16, s3, 1
  s_lshl_b32 s16, s16, 5
  v_add_u32 v2, s16, v5
  v_cvt_f32_u32 v2, v2
  v_mul_f32 v2, 0x3c000000, v2
  v_mul_f32 v8, v2, v9
  v_fmamk_f32 v188, v2, 0x0, v8
  v_fmamk_f32 v189, v2, 0x3f800000, v8
  v_fmamk_f32 v190, v2, 0x40800000, v8
  v_fmamk_f32 v191, v2, 0x40a00000, v8
  v_fmamk_f32 v192, v2, 0x41800000, v8
  v_fmamk_f32 v193, v2, 0x41880000, v8
  s_add_u32 m0, s7, 4096
  s_nop 0
  buffer_load_dwordx4 v11, s[8:11], s6 offen offset:0 sc1 lds
  v_fmamk_f32 v194, v2, 0x41a00000, v8
  v_fmamk_f32 v195, v2, 0x41a80000, v8
  v_cos_f32 v196, v188
  v_cos_f32 v197, v189
  v_cos_f32 v198, v190
  v_cos_f32 v199, v191
  v_cos_f32 v200, v192
  buffer_load_dwordx4 v11, s[8:11], s6 offen offset:1024 sc1 lds
  v_cos_f32 v201, v193
  v_cos_f32 v202, v194
  v_cos_f32 v203, v195
  v_sin_f32 v188, v188
  v_sin_f32 v189, v189
  v_sin_f32 v190, v190
  buffer_load_dwordx4 v11, s[8:11], s6 offen offset:2048 sc1 lds
  v_sin_f32 v191, v191
  v_sin_f32 v192, v192
  v_sin_f32 v193, v193
  v_sin_f32 v194, v194
  v_sin_f32 v195, v195
  v_cvt_pk_bf16_f32 v28, v196, -v188
  v_cvt_pk_bf16_f32 v29, v197, -v189
  buffer_load_dwordx4 v11, s[8:11], s6 offen offset:3072 sc1 lds
  s_add_u32 s6, s6, 65536
  s_and_b32 s6, s6, 0x7ffff
  v_cvt_pk_bf16_f32 v30, v198, -v190
  v_cvt_pk_bf16_f32 v31, v199, -v191
  v_cvt_pk_bf16_f32 v56, v200, -v192
  v_cvt_pk_bf16_f32 v57, v201, -v193
  v_cvt_pk_bf16_f32 v58, v202, -v194
  v_cvt_pk_bf16_f32 v59, v203, -v195
  v_perm_b32 v60, v28, v28, v26
  v_xor_b32 v60, v27, v60
  v_perm_b32 v61, v29, v29, v26
  v_xor_b32 v61, v27, v61
  v_perm_b32 v62, v30, v30, v26
  v_xor_b32 v62, v27, v62
  s_add_u32 m0, s7, 32768
  s_nop 0
  buffer_load_dwordx4 v10, s[8:11], s6 offen offset:0 sc1 lds
  v_perm_b32 v63, v31, v31, v26
  v_xor_b32 v63, v27, v63
  v_perm_b32 v64, v56, v56, v26
  v_xor_b32 v64, v27, v64
  v_perm_b32 v65, v57, v57, v26
  v_xor_b32 v65, v27, v65
  v_perm_b32 v66, v58, v58, v26
  v_xor_b32 v66, v27, v66
  v_perm_b32 v67, v59, v59, v26
  v_xor_b32 v67, v27, v67
  v_add_f32 v2, 0x3e000000, v2
  v_mul_f32 v8, v2, v9
  buffer_load_dwordx4 v10, s[8:11], s6 offen offset:1024 sc1 lds
  v_fmamk_f32 v188, v2, 0x0, v8
  v_fmamk_f32 v189, v2, 0x3f800000, v8
  v_fmamk_f32 v190, v2, 0x40800000, v8
  v_fmamk_f32 v191, v2, 0x40a00000, v8
  v_fmamk_f32 v192, v2, 0x41800000, v8
  v_fmamk_f32 v193, v2, 0x41880000, v8
  v_fmamk_f32 v194, v2, 0x41a00000, v8
  v_fmamk_f32 v195, v2, 0x41a80000, v8
  v_cos_f32 v196, v188
  v_cos_f32 v197, v189
  buffer_load_dwordx4 v10, s[8:11], s6 offen offset:2048 sc1 lds
  v_cos_f32 v198, v190
  v_cos_f32 v199, v191
  v_cos_f32 v200, v192
  v_cos_f32 v201, v193
  v_cos_f32 v202, v194
  v_cos_f32 v203, v195
  buffer_load_dwordx4 v10, s[8:11], s6 offen offset:3072 sc1 lds
  v_sin_f32 v188, v188
  v_sin_f32 v189, v189
  v_sin_f32 v190, v190
  v_sin_f32 v191, v191
  v_sin_f32 v192, v192
  v_sin_f32 v193, v193
  s_add_u32 m0, s7, 36864
  s_nop 0
  buffer_load_dwordx4 v11, s[8:11], s6 offen offset:0 sc1 lds
  v_sin_f32 v194, v194
  v_sin_f32 v195, v195
  v_cvt_pk_bf16_f32 v68, v196, -v188
  v_cvt_pk_bf16_f32 v69, v197, -v189
  v_cvt_pk_bf16_f32 v70, v198, -v190
  v_cvt_pk_bf16_f32 v71, v199, -v191
  v_cvt_pk_bf16_f32 v72, v200, -v192
  v_cvt_pk_bf16_f32 v73, v201, -v193
  v_cvt_pk_bf16_f32 v74, v202, -v194
  v_cvt_pk_bf16_f32 v75, v203, -v195
  buffer_load_dwordx4 v11, s[8:11], s6 offen offset:1024 sc1 lds
  v_perm_b32 v180, v68, v68, v26
  v_xor_b32 v180, v27, v180
  v_perm_b32 v181, v69, v69, v26
  v_xor_b32 v181, v27, v181
  v_perm_b32 v182, v70, v70, v26
  v_xor_b32 v182, v27, v182
  v_perm_b32 v183, v71, v71, v26
  v_xor_b32 v183, v27, v183
  v_perm_b32 v184, v72, v72, v26
  v_xor_b32 v184, v27, v184
  v_perm_b32 v185, v73, v73, v26
  v_xor_b32 v185, v27, v185
  buffer_load_dwordx4 v11, s[8:11], s6 offen offset:2048 sc1 lds
  v_perm_b32 v186, v74, v74, v26
  v_xor_b32 v186, v27, v186
  v_perm_b32 v187, v75, v75, v26
  v_xor_b32 v187, v27, v187
  v_lshlrev_b32 v8, 31, v5
  v_or_b32 v8, 0x3f003f00, v8
  v_cmp_eq_u32 vcc, 0, v6
  s_nop 1
  v_cndmask_b32 v28, v28, v8, vcc
  v_cndmask_b32 v68, v68, v8, vcc
  buffer_load_dwordx4 v11, s[8:11], s6 offen offset:3072 sc1 lds
  s_add_u32 s6, s6, 65536
  s_and_b32 s6, s6, 0x7ffff
  s_add_u32 m0, s7, 65536
  s_nop 0
  buffer_load_dwordx4 v10, s[8:11], s6 offen offset:0 sc1 lds
  buffer_load_dwordx4 v10, s[8:11], s6 offen offset:1024 sc1 lds
  buffer_load_dwordx4 v10, s[8:11], s6 offen offset:2048 sc1 lds
  buffer_load_dwordx4 v10, s[8:11], s6 offen offset:3072 sc1 lds
  s_add_u32 m0, s7, 69632
  s_nop 0
  buffer_load_dwordx4 v11, s[8:11], s6 offen offset:0 sc1 lds
  buffer_load_dwordx4 v11, s[8:11], s6 offen offset:1024 sc1 lds
  buffer_load_dwordx4 v11, s[8:11], s6 offen offset:2048 sc1 lds
  buffer_load_dwordx4 v11, s[8:11], s6 offen offset:3072 sc1 lds
  s_add_u32 s6, s6, 65536
  s_and_b32 s6, s6, 0x7ffff
  s_mov_b32 s44, s30
  s_mov_b32 s45, s31
  s_mov_b32 s46, 8388608
  s_mov_b32 s47, 0x20000
  s_waitcnt vmcnt(16)
  s_barrier
  ds_read_b64_tr_b16 v[108:109], v12 offset:0
  ds_read_b64_tr_b16 v[110:111], v13 offset:0
  ds_read_b64_tr_b16 v[112:113], v12 offset:2048
  ds_read_b64_tr_b16 v[114:115], v13 offset:2048
  ds_read_b64_tr_b16 v[116:117], v12 offset:4096
  ds_read_b64_tr_b16 v[118:119], v13 offset:4096
  ds_read_b64_tr_b16 v[120:121], v12 offset:6144
  ds_read_b64_tr_b16 v[122:123], v13 offset:6144
  ds_read_b64_tr_b16 v[124:125], v12 offset:256
  ds_read_b64_tr_b16 v[126:127], v13 offset:256
  ds_read_b64_tr_b16 v[136:137], v12 offset:2304
  ds_read_b64_tr_b16 v[138:139], v13 offset:2304
  ds_read_b64_tr_b16 v[140:141], v12 offset:4352
  ds_read_b64_tr_b16 v[142:143], v13 offset:4352
  ds_read_b64_tr_b16 v[144:145], v12 offset:6400
  ds_read_b64_tr_b16 v[146:147], v13 offset:6400
  s_waitcnt lgkmcnt(0)
  v_mfma_f32_16x16x32_bf16 v[16:19], v[108:111], a[0:3], v[16:19]
  ds_read_b64_tr_b16 v[148:149], v12 offset:16384
  ds_read_b64_tr_b16 v[150:151], v13 offset:16384
  v_mfma_f32_16x16x32_bf16 v[40:43], v[108:111], a[8:11], v[40:43]
  ds_read_b64_tr_b16 v[152:153], v12 offset:18432
  ds_read_b64_tr_b16 v[154:155], v13 offset:18432
  v_mfma_f32_16x16x32_bf16 v[44:47], v[112:115], a[8:11], v[44:47]
  ds_read_b64_tr_b16 v[156:157], v12 offset:20480
  ds_read_b64_tr_b16 v[158:159], v13 offset:20480
  v_mfma_f32_16x16x32_bf16 v[20:23], v[112:115], a[0:3], v[20:23]
  ds_read_b64_tr_b16 v[160:161], v12 offset:22528
  ds_read_b64_tr_b16 v[162:163], v13 offset:22528
  v_mfma_f32_16x16x32_bf16 v[32:35], v[116:119], a[0:3], 0
  ds_read_b64_tr_b16 v[164:165], v12 offset:16640
  ds_read_b64_tr_b16 v[166:167], v13 offset:16640
  v_mfma_f32_16x16x32_bf16 v[48:51], v[116:119], a[8:11], 0
  ds_read_b64_tr_b16 v[168:169], v12 offset:18688
  ds_read_b64_tr_b16 v[170:171], v13 offset:18688
  v_mfma_f32_16x16x32_bf16 v[52:55], v[120:123], a[8:11], 0
  ds_read_b64_tr_b16 v[172:173], v12 offset:20736
  ds_read_b64_tr_b16 v[174:175], v13 offset:20736
  v_mfma_f32_16x16x32_bf16 v[36:39], v[120:123], a[0:3], 0
  ds_read_b64_tr_b16 v[176:177], v12 offset:22784
  ds_read_b64_tr_b16 v[178:179], v13 offset:22784
  v_mfma_f32_16x16x32_bf16 v[16:19], v[124:127], a[4:7], v[16:19]
  s_add_u32 m0, s7, 98304
  s_nop 0
  buffer_load_dwordx4 v10, s[8:11], s6 offen offset:0 sc1 lds
  s_lshl_b32 s17, s3, 12
  s_add_u32 s17, s17, 147456
  v_mfma_f32_16x16x32_bf16 v[40:43], v[124:127], a[12:15], v[40:43]
  v_lshl_add_u32 v2, v4, 4, s17
  v_lshrrev_b32 v8, 5, v4
  v_mfma_f32_16x16x32_bf16 v[44:47], v[136:139], a[12:15], v[44:47]
  buffer_load_dwordx4 v10, s[8:11], s6 offen offset:1024 sc1 lds
  v_lshlrev_b32 v8, 9, v8
  v_bfe_u32 v26, v4, 3, 2
  v_mfma_f32_16x16x32_bf16 v[20:23], v[136:139], a[4:7], v[20:23]
  v_lshl_or_b32 v8, v26, 6, v8
  v_and_b32 v26, 3, v4
  v_mfma_f32_16x16x32_bf16 v[32:35], v[140:143], a[4:7], v[32:35]
  buffer_load_dwordx4 v10, s[8:11], s6 offen offset:2048 sc1 lds
  v_lshl_or_b32 v8, v26, 4, v8
  v_bfe_u32 v26, v4, 2, 1
  v_mfma_f32_16x16x32_bf16 v[48:51], v[140:143], a[12:15], v[48:51]
  v_lshl_or_b32 v8, v26, 3, v8
  s_lshr_b32 s17, s3, 1
  v_mfma_f32_16x16x32_bf16 v[52:55], v[144:147], a[12:15], v[52:55]
  buffer_load_dwordx4 v10, s[8:11], s6 offen offset:3072 sc1 lds
  s_lshl_b32 s17, s17, 13
  s_add_u32 s17, s17, 131072
  v_mfma_f32_16x16x32_bf16 v[36:39], v[144:147], a[4:7], v[36:39]
  v_add_u32 v8, s17, v8
  v_lshlrev_b32 v9, 18, v6
  s_waitcnt vmcnt(12) lgkmcnt(0)
  s_barrier
  v_mfma_f32_16x16x32_bf16 v[16:19], v[148:151], a[16:19], v[16:19]
  ds_read_b64_tr_b16 v[108:109], v12 offset:32768
  ds_read_b64_tr_b16 v[110:111], v13 offset:32768
  v_mfma_f32_16x16x32_bf16 v[40:43], v[148:151], a[24:27], v[40:43]
  ds_read_b64_tr_b16 v[112:113], v12 offset:34816
  ds_read_b64_tr_b16 v[114:115], v13 offset:34816
  v_mfma_f32_16x16x32_bf16 v[44:47], v[152:155], a[24:27], v[44:47]
  ds_read_b64_tr_b16 v[116:117], v12 offset:36864
  ds_read_b64_tr_b16 v[118:119], v13 offset:36864
  v_mfma_f32_16x16x32_bf16 v[20:23], v[152:155], a[16:19], v[20:23]
  ds_read_b64_tr_b16 v[120:121], v12 offset:38912
  ds_read_b64_tr_b16 v[122:123], v13 offset:38912
  v_mfma_f32_16x16x32_bf16 v[32:35], v[156:159], a[16:19], v[32:35]
  ds_read_b64_tr_b16 v[124:125], v12 offset:33024
  ds_read_b64_tr_b16 v[126:127], v13 offset:33024
  v_mfma_f32_16x16x32_bf16 v[48:51], v[156:159], a[24:27], v[48:51]
  ds_read_b64_tr_b16 v[136:137], v12 offset:35072
  ds_read_b64_tr_b16 v[138:139], v13 offset:35072
  v_mfma_f32_16x16x32_bf16 v[52:55], v[160:163], a[24:27], v[52:55]
  ds_read_b64_tr_b16 v[140:141], v12 offset:37120
  ds_read_b64_tr_b16 v[142:143], v13 offset:37120
  v_mfma_f32_16x16x32_bf16 v[36:39], v[160:163], a[16:19], v[36:39]
  ds_read_b64_tr_b16 v[144:145], v12 offset:39168
  ds_read_b64_tr_b16 v[146:147], v13 offset:39168
  v_mfma_f32_16x16x32_bf16 v[16:19], v[164:167], a[20:23], v[16:19]
  s_add_u32 m0, s7, 102400
  s_nop 0
  buffer_load_dwordx4 v11, s[8:11], s6 offen offset:0 sc1 lds
  v_lshl_or_b32 v9, v5, 2, v9
  s_and_b32 s16, s3, 1
  v_mfma_f32_16x16x32_bf16 v[40:43], v[164:167], a[28:31], v[40:43]
  s_cmp_lg_u32 s3, 0
  s_cbranch_scc1 gated_mix__spectral_gfnet__ssm_conv_s5__prompt_kernel_skip41
  s_mov_b64 exec, 1
  buffer_store_dword v7, v24, s[48:51], s4 offen sc1
  s_mov_b64 exec, -1
gated_mix__spectral_gfnet__ssm_conv_s5__prompt_kernel_skip41:
  s_lshl_b32 s16, s16, 21
  s_lshl_b32 s17, s42, 12
  v_mfma_f32_16x16x32_bf16 v[44:47], v[168:171], a[28:31], v[44:47]
  buffer_load_dwordx4 v11, s[8:11], s6 offen offset:1024 sc1 lds
  s_add_u32 s16, s16, s17
  s_lshl_b32 s17, s43, 6
  v_mfma_f32_16x16x32_bf16 v[20:23], v[168:171], a[20:23], v[20:23]
  s_add_u32 s16, s16, s17
  s_lshr_b32 s17, s3, 1
  v_mfma_f32_16x16x32_bf16 v[32:35], v[172:175], a[20:23], v[32:35]
  buffer_load_dwordx4 v11, s[8:11], s6 offen offset:2048 sc1 lds
  s_lshl_b32 s17, s17, 11
  s_add_u32 s16, s16, s17
  v_mfma_f32_16x16x32_bf16 v[48:51], v[172:175], a[28:31], v[48:51]
  v_mfma_f32_16x16x32_bf16 v[52:55], v[176:179], a[28:31], v[52:55]
  buffer_load_dwordx4 v11, s[8:11], s6 offen offset:3072 sc1 lds
  s_add_u32 s6, s6, 65536
  s_and_b32 s6, s6, 0x7ffff
  v_mfma_f32_16x16x32_bf16 v[36:39], v[176:179], a[20:23], v[36:39]
  s_waitcnt lgkmcnt(0)
  v_mfma_f32_16x16x32_bf16 v[16:19], v[108:111], a[32:35], v[16:19]
  ds_read_b64_tr_b16 v[148:149], v12 offset:49152
  ds_read_b64_tr_b16 v[150:151], v13 offset:49152
  v_mfma_f32_16x16x32_bf16 v[40:43], v[108:111], a[40:43], v[40:43]
  ds_read_b64_tr_b16 v[152:153], v12 offset:51200
  ds_read_b64_tr_b16 v[154:155], v13 offset:51200
  v_mfma_f32_16x16x32_bf16 v[44:47], v[112:115], a[40:43], v[44:47]
  ds_read_b64_tr_b16 v[156:157], v12 offset:53248
  ds_read_b64_tr_b16 v[158:159], v13 offset:53248
  v_mfma_f32_16x16x32_bf16 v[20:23], v[112:115], a[32:35], v[20:23]
  ds_read_b64_tr_b16 v[160:161], v12 offset:55296
  ds_read_b64_tr_b16 v[162:163], v13 offset:55296
  v_mfma_f32_16x16x32_bf16 v[32:35], v[116:119], a[32:35], v[32:35]
  ds_read_b64_tr_b16 v[164:165], v12 offset:49408
  ds_read_b64_tr_b16 v[166:167], v13 offset:49408
  v_mfma_f32_16x16x32_bf16 v[48:51], v[116:119], a[40:43], v[48:51]
  ds_read_b64_tr_b16 v[168:169], v12 offset:51456
  ds_read_b64_tr_b16 v[170:171], v13 offset:51456
  v_mfma_f32_16x16x32_bf16 v[52:55], v[120:123], a[40:43], v[52:55]
  ds_read_b64_tr_b16 v[172:173], v12 offset:53504
  ds_read_b64_tr_b16 v[174:175], v13 offset:53504
  v_mfma_f32_16x16x32_bf16 v[36:39], v[120:123], a[32:35], v[36:39]
  ds_read_b64_tr_b16 v[176:177], v12 offset:55552
  ds_read_b64_tr_b16 v[178:179], v13 offset:55552
  v_mfma_f32_16x16x32_bf16 v[16:19], v[124:127], a[36:39], v[16:19]
  s_add_u32 m0, s7, 0
  s_nop 0
  buffer_load_dwordx4 v10, s[8:11], s6 offen offset:0 sc1 lds
  v_mfma_f32_16x16x32_bf16 v[40:43], v[124:127], a[44:47], v[40:43]
  v_mfma_f32_16x16x32_bf16 v[44:47], v[136:139], a[44:47], v[44:47]
  buffer_load_dwordx4 v10, s[8:11], s6 offen offset:1024 sc1 lds
  v_mfma_f32_16x16x32_bf16 v[20:23], v[136:139], a[36:39], v[20:23]
  v_mfma_f32_16x16x32_bf16 v[32:35], v[140:143], a[36:39], v[32:35]
  buffer_load_dwordx4 v10, s[8:11], s6 offen offset:2048 sc1 lds
  v_mfma_f32_16x16x32_bf16 v[48:51], v[140:143], a[44:47], v[48:51]
  v_mfma_f32_16x16x32_bf16 v[52:55], v[144:147], a[44:47], v[52:55]
  buffer_load_dwordx4 v10, s[8:11], s6 offen offset:3072 sc1 lds
  v_mfma_f32_16x16x32_bf16 v[36:39], v[144:147], a[36:39], v[36:39]
  s_waitcnt vmcnt(12) lgkmcnt(0)
  s_barrier
  v_mfma_f32_16x16x32_bf16 v[16:19], v[148:151], a[48:51], v[16:19]
  ds_read_b64_tr_b16 v[108:109], v14 offset:0
  ds_read_b64_tr_b16 v[110:111], v15 offset:0
  v_mfma_f32_16x16x32_bf16 v[40:43], v[148:151], a[56:59], v[40:43]
  ds_read_b64_tr_b16 v[112:113], v14 offset:2048
  ds_read_b64_tr_b16 v[114:115], v15 offset:2048
  v_mfma_f32_16x16x32_bf16 v[44:47], v[152:155], a[56:59], v[44:47]
  ds_read_b64_tr_b16 v[116:117], v14 offset:4096
  ds_read_b64_tr_b16 v[118:119], v15 offset:4096
  v_mfma_f32_16x16x32_bf16 v[20:23], v[152:155], a[48:51], v[20:23]
  ds_read_b64_tr_b16 v[120:121], v14 offset:6144
  ds_read_b64_tr_b16 v[122:123], v15 offset:6144
  v_mfma_f32_16x16x32_bf16 v[32:35], v[156:159], a[48:51], v[32:35]
  ds_read_b64_tr_b16 v[124:125], v14 offset:256
  ds_read_b64_tr_b16 v[126:127], v15 offset:256
  v_mfma_f32_16x16x32_bf16 v[48:51], v[156:159], a[56:59], v[48:51]
  ds_read_b64_tr_b16 v[136:137], v14 offset:2304
  ds_read_b64_tr_b16 v[138:139], v15 offset:2304
  v_mfma_f32_16x16x32_bf16 v[52:55], v[160:163], a[56:59], v[52:55]
  ds_read_b64_tr_b16 v[140:141], v14 offset:4352
  ds_read_b64_tr_b16 v[142:143], v15 offset:4352
  v_mfma_f32_16x16x32_bf16 v[36:39], v[160:163], a[48:51], v[36:39]
  ds_read_b64_tr_b16 v[144:145], v14 offset:6400
  ds_read_b64_tr_b16 v[146:147], v15 offset:6400
  v_mfma_f32_16x16x32_bf16 v[16:19], v[164:167], a[52:55], v[16:19]
  s_add_u32 m0, s7, 4096
  s_nop 0
  buffer_load_dwordx4 v11, s[8:11], s6 offen offset:0 sc1 lds
  v_mfma_f32_16x16x32_bf16 v[40:43], v[164:167], a[60:63], v[40:43]
  v_mfma_f32_16x16x32_bf16 v[44:47], v[168:171], a[60:63], v[44:47]
  buffer_load_dwordx4 v11, s[8:11], s6 offen offset:1024 sc1 lds
  v_mfma_f32_16x16x32_bf16 v[20:23], v[168:171], a[52:55], v[20:23]
  v_mfma_f32_16x16x32_bf16 v[32:35], v[172:175], a[52:55], v[32:35]
  buffer_load_dwordx4 v11, s[8:11], s6 offen offset:2048 sc1 lds
  v_mfma_f32_16x16x32_bf16 v[48:51], v[172:175], a[60:63], v[48:51]
  v_mfma_f32_16x16x32_bf16 v[52:55], v[176:179], a[60:63], v[52:55]
  buffer_load_dwordx4 v11, s[8:11], s6 offen offset:3072 sc1 lds
  s_add_u32 s6, s6, 65536
  s_and_b32 s6, s6, 0x7ffff
  v_mfma_f32_16x16x32_bf16 v[36:39], v[176:179], a[52:55], v[36:39]
  s_add_u32 m0, s20, 147456
  s_nop 0
  buffer_load_dwordx4 v128, s[68:71], s19 offen offset:0 lds
  buffer_load_dwordx4 v129, s[68:71], s19 offen offset:1024 lds
  buffer_load_dwordx4 v130, s[68:71], s19 offen offset:2048 lds
  buffer_load_dwordx4 v131, s[68:71], s19 offen offset:3072 lds
  s_add_u32 s19, s19, 128
  s_and_b32 s19, s19, 0x7ff
  s_waitcnt lgkmcnt(0)
  v_mfma_f32_16x16x32_bf16 v[16:19], v[108:111], a[64:67], v[16:19]
  ds_read_b64_tr_b16 v[148:149], v14 offset:16384
  ds_read_b64_tr_b16 v[150:151], v15 offset:16384
  v_mfma_f32_16x16x32_bf16 v[40:43], v[108:111], a[72:75], v[40:43]
  ds_read_b64_tr_b16 v[152:153], v14 offset:18432
  ds_read_b64_tr_b16 v[154:155], v15 offset:18432
  v_mfma_f32_16x16x32_bf16 v[44:47], v[112:115], a[72:75], v[44:47]
  ds_read_b64_tr_b16 v[156:157], v14 offset:20480
  ds_read_b64_tr_b16 v[158:159], v15 offset:20480
  v_mfma_f32_16x16x32_bf16 v[20:23], v[112:115], a[64:67], v[20:23]
  ds_read_b64_tr_b16 v[160:161], v14 offset:22528
  ds_read_b64_tr_b16 v[162:163], v15 offset:22528
  v_mfma_f32_16x16x32_bf16 v[32:35], v[116:119], a[64:67], v[32:35]
  ds_read_b64_tr_b16 v[164:165], v14 offset:16640
  ds_read_b64_tr_b16 v[166:167], v15 offset:16640
  v_mfma_f32_16x16x32_bf16 v[48:51], v[116:119], a[72:75], v[48:51]
  ds_read_b64_tr_b16 v[168:169], v14 offset:18688
  ds_read_b64_tr_b16 v[170:171], v15 offset:18688
  v_mfma_f32_16x16x32_bf16 v[52:55], v[120:123], a[72:75], v[52:55]
  ds_read_b64_tr_b16 v[172:173], v14 offset:20736
  ds_read_b64_tr_b16 v[174:175], v15 offset:20736
  v_mfma_f32_16x16x32_bf16 v[36:39], v[120:123], a[64:67], v[36:39]
  ds_read_b64_tr_b16 v[176:177], v14 offset:22784
  ds_read_b64_tr_b16 v[178:179], v15 offset:22784
  v_mfma_f32_16x16x32_bf16 v[16:19], v[124:127], a[68:71], v[16:19]
  s_add_u32 m0, s7, 32768
  s_nop 0
  buffer_load_dwordx4 v10, s[8:11], s6 offen offset:0 sc1 lds
  v_mfma_f32_16x16x32_bf16 v[40:43], v[124:127], a[76:79], v[40:43]
  v_mfma_f32_16x16x32_bf16 v[44:47], v[136:139], a[76:79], v[44:47]
  buffer_load_dwordx4 v10, s[8:11], s6 offen offset:1024 sc1 lds
  v_mfma_f32_16x16x32_bf16 v[20:23], v[136:139], a[68:71], v[20:23]
  v_mfma_f32_16x16x32_bf16 v[32:35], v[140:143], a[68:71], v[32:35]
  buffer_load_dwordx4 v10, s[8:11], s6 offen offset:2048 sc1 lds
  v_mfma_f32_16x16x32_bf16 v[48:51], v[140:143], a[76:79], v[48:51]
  v_mfma_f32_16x16x32_bf16 v[52:55], v[144:147], a[76:79], v[52:55]
  buffer_load_dwordx4 v10, s[8:11], s6 offen offset:3072 sc1 lds
  v_mfma_f32_16x16x32_bf16 v[36:39], v[144:147], a[68:71], v[36:39]
  s_waitcnt vmcnt(16) lgkmcnt(0)
  s_barrier
  v_mfma_f32_16x16x32_bf16 v[16:19], v[148:151], a[80:83], v[16:19]
  ds_read_b64_tr_b16 v[108:109], v14 offset:32768
  ds_read_b64_tr_b16 v[110:111], v15 offset:32768
  v_mfma_f32_16x16x32_bf16 v[40:43], v[148:151], a[88:91], v[40:43]
  ds_read_b64_tr_b16 v[112:113], v14 offset:34816
  ds_read_b64_tr_b16 v[114:115], v15 offset:34816
  v_mfma_f32_16x16x32_bf16 v[44:47], v[152:155], a[88:91], v[44:47]
  ds_read_b64_tr_b16 v[116:117], v14 offset:36864
  ds_read_b64_tr_b16 v[118:119], v15 offset:36864
  v_mfma_f32_16x16x32_bf16 v[20:23], v[152:155], a[80:83], v[20:23]
  ds_read_b64_tr_b16 v[120:121], v14 offset:38912
  ds_read_b64_tr_b16 v[122:123], v15 offset:38912
  v_mfma_f32_16x16x32_bf16 v[32:35], v[156:159], a[80:83], v[32:35]
  ds_read_b64_tr_b16 v[124:125], v14 offset:33024
  ds_read_b64_tr_b16 v[126:127], v15 offset:33024
  v_mfma_f32_16x16x32_bf16 v[48:51], v[156:159], a[88:91], v[48:51]
  ds_read_b64_tr_b16 v[136:137], v14 offset:35072
  ds_read_b64_tr_b16 v[138:139], v15 offset:35072
  v_mfma_f32_16x16x32_bf16 v[52:55], v[160:163], a[88:91], v[52:55]
  ds_read_b64_tr_b16 v[140:141], v14 offset:37120
  ds_read_b64_tr_b16 v[142:143], v15 offset:37120
  v_mfma_f32_16x16x32_bf16 v[36:39], v[160:163], a[80:83], v[36:39]
  ds_read_b64_tr_b16 v[144:145], v14 offset:39168
  ds_read_b64_tr_b16 v[146:147], v15 offset:39168
  v_mfma_f32_16x16x32_bf16 v[16:19], v[164:167], a[84:87], v[16:19]
  s_add_u32 m0, s7, 36864
  s_nop 0
  buffer_load_dwordx4 v11, s[8:11], s6 offen offset:0 sc1 lds
  v_mfma_f32_16x16x32_bf16 v[40:43], v[164:167], a[92:95], v[40:43]
  v_mfma_f32_16x16x32_bf16 v[44:47], v[168:171], a[92:95], v[44:47]
  buffer_load_dwordx4 v11, s[8:11], s6 offen offset:1024 sc1 lds
  v_mfma_f32_16x16x32_bf16 v[20:23], v[168:171], a[84:87], v[20:23]
  v_mfma_f32_16x16x32_bf16 v[32:35], v[172:175], a[84:87], v[32:35]
  buffer_load_dwordx4 v11, s[8:11], s6 offen offset:2048 sc1 lds
  v_mfma_f32_16x16x32_bf16 v[48:51], v[172:175], a[92:95], v[48:51]
  v_mfma_f32_16x16x32_bf16 v[52:55], v[176:179], a[92:95], v[52:55]
  buffer_load_dwordx4 v11, s[8:11], s6 offen offset:3072 sc1 lds
  s_add_u32 s6, s6, 65536
  s_and_b32 s6, s6, 0x7ffff
  v_mfma_f32_16x16x32_bf16 v[36:39], v[176:179], a[84:87], v[36:39]
  s_add_u32 m0, s20, 131072
  s_nop 0
  buffer_load_dwordx4 v128, s[68:71], s19 offen offset:0 lds
  buffer_load_dwordx4 v129, s[68:71], s19 offen offset:1024 lds
  buffer_load_dwordx4 v130, s[68:71], s19 offen offset:2048 lds
  buffer_load_dwordx4 v131, s[68:71], s19 offen offset:3072 lds
  s_add_u32 s19, s19, 128
  s_and_b32 s19, s19, 0x7ff
  s_waitcnt lgkmcnt(0)
  v_mfma_f32_16x16x32_bf16 v[16:19], v[108:111], a[96:99], v[16:19]
  ds_read_b64_tr_b16 v[148:149], v14 offset:49152
  ds_read_b64_tr_b16 v[150:151], v15 offset:49152
  v_mfma_f32_16x16x32_bf16 v[40:43], v[108:111], a[104:107], v[40:43]
  ds_read_b64_tr_b16 v[152:153], v14 offset:51200
  ds_read_b64_tr_b16 v[154:155], v15 offset:51200
  v_mfma_f32_16x16x32_bf16 v[44:47], v[112:115], a[104:107], v[44:47]
  ds_read_b64_tr_b16 v[156:157], v14 offset:53248
  ds_read_b64_tr_b16 v[158:159], v15 offset:53248
  v_mfma_f32_16x16x32_bf16 v[20:23], v[112:115], a[96:99], v[20:23]
  ds_read_b64_tr_b16 v[160:161], v14 offset:55296
  ds_read_b64_tr_b16 v[162:163], v15 offset:55296
  v_mfma_f32_16x16x32_bf16 v[32:35], v[116:119], a[96:99], v[32:35]
  ds_read_b64_tr_b16 v[164:165], v14 offset:49408
  ds_read_b64_tr_b16 v[166:167], v15 offset:49408
  v_mfma_f32_16x16x32_bf16 v[48:51], v[116:119], a[104:107], v[48:51]
  ds_read_b64_tr_b16 v[168:169], v14 offset:51456
  ds_read_b64_tr_b16 v[170:171], v15 offset:51456
  v_mfma_f32_16x16x32_bf16 v[52:55], v[120:123], a[104:107], v[52:55]
  ds_read_b64_tr_b16 v[172:173], v14 offset:53504
  ds_read_b64_tr_b16 v[174:175], v15 offset:53504
  v_mfma_f32_16x16x32_bf16 v[36:39], v[120:123], a[96:99], v[36:39]
  ds_read_b64_tr_b16 v[176:177], v14 offset:55552
  ds_read_b64_tr_b16 v[178:179], v15 offset:55552
  v_mfma_f32_16x16x32_bf16 v[16:19], v[124:127], a[100:103], v[16:19]
  s_add_u32 m0, s7, 65536
  s_nop 0
  buffer_load_dwordx4 v10, s[8:11], s6 offen offset:0 sc1 lds
  v_mfma_f32_16x16x32_bf16 v[40:43], v[124:127], a[108:111], v[40:43]
  v_mfma_f32_16x16x32_bf16 v[44:47], v[136:139], a[108:111], v[44:47]
  buffer_load_dwordx4 v10, s[8:11], s6 offen offset:1024 sc1 lds
  v_mfma_f32_16x16x32_bf16 v[20:23], v[136:139], a[100:103], v[20:23]
  v_mfma_f32_16x16x32_bf16 v[32:35], v[140:143], a[100:103], v[32:35]
  buffer_load_dwordx4 v10, s[8:11], s6 offen offset:2048 sc1 lds
  v_mfma_f32_16x16x32_bf16 v[48:51], v[140:143], a[108:111], v[48:51]
  v_mfma_f32_16x16x32_bf16 v[52:55], v[144:147], a[108:111], v[52:55]
  buffer_load_dwordx4 v10, s[8:11], s6 offen offset:3072 sc1 lds
  v_mfma_f32_16x16x32_bf16 v[36:39], v[144:147], a[100:103], v[36:39]
  v_xor_b32 v134, 0x30000, v134
  v_xor_b32 v135, 0x30000, v135
  s_waitcnt vmcnt(16)
  ds_read_b128 a[224:227], v134 offset:16384
  ds_read_b128 a[228:231], v135 offset:16384
  ds_read_b128 a[232:235], v134 offset:18432
  ds_read_b128 a[236:239], v135 offset:18432
  s_waitcnt lgkmcnt(4)
  s_barrier
  v_mfma_f32_16x16x32_bf16 v[16:19], v[148:151], a[112:115], v[16:19]
  ds_read_b64_tr_b16 v[108:109], v12 offset:0
  ds_read_b64_tr_b16 v[110:111], v13 offset:0
  v_mfma_f32_16x16x32_bf16 v[40:43], v[148:151], a[120:123], v[40:43]
  ds_read_b64_tr_b16 v[112:113], v12 offset:2048
  ds_read_b64_tr_b16 v[114:115], v13 offset:2048
  v_mfma_f32_16x16x32_bf16 v[44:47], v[152:155], a[120:123], v[44:47]
  ds_read_b64_tr_b16 v[116:117], v12 offset:4096
  ds_read_b64_tr_b16 v[118:119], v13 offset:4096
  v_mfma_f32_16x16x32_bf16 v[20:23], v[152:155], a[112:115], v[20:23]
  ds_read_b64_tr_b16 v[120:121], v12 offset:6144
  ds_read_b64_tr_b16 v[122:123], v13 offset:6144
  v_mfma_f32_16x16x32_bf16 v[32:35], v[156:159], a[112:115], v[32:35]
  ds_read_b64_tr_b16 v[124:125], v12 offset:256
  ds_read_b64_tr_b16 v[126:127], v13 offset:256
  v_mfma_f32_16x16x32_bf16 v[48:51], v[156:159], a[120:123], v[48:51]
  ds_read_b64_tr_b16 v[136:137], v12 offset:2304
  ds_read_b64_tr_b16 v[138:139], v13 offset:2304
  v_mfma_f32_16x16x32_bf16 v[52:55], v[160:163], a[120:123], v[52:55]
  ds_read_b64_tr_b16 v[140:141], v12 offset:4352
  ds_read_b64_tr_b16 v[142:143], v13 offset:4352
  v_mfma_f32_16x16x32_bf16 v[36:39], v[160:163], a[112:115], v[36:39]
  ds_read_b64_tr_b16 v[144:145], v12 offset:6400
  ds_read_b64_tr_b16 v[146:147], v13 offset:6400
  v_mfma_f32_16x16x32_bf16 v[16:19], v[164:167], a[116:119], v[16:19]
  s_add_u32 m0, s7, 69632
  s_nop 0
  buffer_load_dwordx4 v11, s[8:11], s6 offen offset:0 sc1 lds
  v_mfma_f32_16x16x32_bf16 v[40:43], v[164:167], a[124:127], v[40:43]
  v_mfma_f32_16x16x32_bf16 v[44:47], v[168:171], a[124:127], v[44:47]
  buffer_load_dwordx4 v11, s[8:11], s6 offen offset:1024 sc1 lds
  v_mfma_f32_16x16x32_bf16 v[20:23], v[168:171], a[116:119], v[20:23]
  v_mfma_f32_16x16x32_bf16 v[32:35], v[172:175], a[116:119], v[32:35]
  buffer_load_dwordx4 v11, s[8:11], s6 offen offset:2048 sc1 lds
  v_mfma_f32_16x16x32_bf16 v[48:51], v[172:175], a[124:127], v[48:51]
  v_mfma_f32_16x16x32_bf16 v[52:55], v[176:179], a[124:127], v[52:55]
  buffer_load_dwordx4 v11, s[8:11], s6 offen offset:3072 sc1 lds
  s_add_u32 s6, s6, 65536
  s_and_b32 s6, s6, 0x7ffff
  v_mfma_f32_16x16x32_bf16 v[36:39], v[176:179], a[116:119], v[36:39]
  s_waitcnt lgkmcnt(0)
  v_mfma_f32_16x16x32_bf16 v[16:19], v[108:111], a[128:131], v[16:19]
  ds_read_b64_tr_b16 v[148:149], v12 offset:16384
  ds_read_b64_tr_b16 v[150:151], v13 offset:16384
  v_mfma_f32_16x16x32_bf16 v[40:43], v[108:111], a[136:139], v[40:43]
  ds_read_b64_tr_b16 v[152:153], v12 offset:18432
  ds_read_b64_tr_b16 v[154:155], v13 offset:18432
  v_mfma_f32_16x16x32_bf16 v[44:47], v[112:115], a[136:139], v[44:47]
  ds_read_b64_tr_b16 v[156:157], v12 offset:20480
  ds_read_b64_tr_b16 v[158:159], v13 offset:20480
  v_mfma_f32_16x16x32_bf16 v[20:23], v[112:115], a[128:131], v[20:23]
  ds_read_b64_tr_b16 v[160:161], v12 offset:22528
  ds_read_b64_tr_b16 v[162:163], v13 offset:22528
  v_mfma_f32_16x16x32_bf16 v[32:35], v[116:119], a[128:131], v[32:35]
  ds_read_b64_tr_b16 v[164:165], v12 offset:16640
  ds_read_b64_tr_b16 v[166:167], v13 offset:16640
  v_mfma_f32_16x16x32_bf16 v[48:51], v[116:119], a[136:139], v[48:51]
  ds_read_b64_tr_b16 v[168:169], v12 offset:18688
  ds_read_b64_tr_b16 v[170:171], v13 offset:18688
  v_mfma_f32_16x16x32_bf16 v[52:55], v[120:123], a[136:139], v[52:55]
  ds_read_b64_tr_b16 v[172:173], v12 offset:20736
  ds_read_b64_tr_b16 v[174:175], v13 offset:20736
  v_mfma_f32_16x16x32_bf16 v[36:39], v[120:123], a[128:131], v[36:39]
  ds_read_b64_tr_b16 v[176:177], v12 offset:22784
  ds_read_b64_tr_b16 v[178:179], v13 offset:22784
  v_mfma_f32_16x16x32_bf16 v[16:19], v[124:127], a[132:135], v[16:19]
  s_add_u32 m0, s7, 98304
  s_nop 0
  buffer_load_dwordx4 v10, s[8:11], s6 offen offset:0 sc1 lds
  v_mfma_f32_16x16x32_bf16 v[40:43], v[124:127], a[140:143], v[40:43]
  v_mfma_f32_16x16x32_bf16 v[44:47], v[136:139], a[140:143], v[44:47]
  buffer_load_dwordx4 v10, s[8:11], s6 offen offset:1024 sc1 lds
  v_mfma_f32_16x16x32_bf16 v[20:23], v[136:139], a[132:135], v[20:23]
  v_mfma_f32_16x16x32_bf16 v[32:35], v[140:143], a[132:135], v[32:35]
  buffer_load_dwordx4 v10, s[8:11], s6 offen offset:2048 sc1 lds
  v_mfma_f32_16x16x32_bf16 v[48:51], v[140:143], a[140:143], v[48:51]
  v_mfma_f32_16x16x32_bf16 v[52:55], v[144:147], a[140:143], v[52:55]
  buffer_load_dwordx4 v10, s[8:11], s6 offen offset:3072 sc1 lds
  v_mfma_f32_16x16x32_bf16 v[36:39], v[144:147], a[132:135], v[36:39]
  s_waitcnt vmcnt(12)
  ds_read_b128 a[240:243], v134 offset:0
  ds_read_b128 a[244:247], v135 offset:0
  ds_read_b128 a[248:251], v134 offset:2048
  ds_read_b128 a[252:255], v135 offset:2048
  s_waitcnt lgkmcnt(4)
  s_barrier
  v_mfma_f32_16x16x32_bf16 v[16:19], v[148:151], a[144:147], v[16:19]
  ds_read_b64_tr_b16 v[108:109], v12 offset:32768
  ds_read_b64_tr_b16 v[110:111], v13 offset:32768
  v_mfma_f32_16x16x32_bf16 v[40:43], v[148:151], a[152:155], v[40:43]
  ds_read_b64_tr_b16 v[112:113], v12 offset:34816
  ds_read_b64_tr_b16 v[114:115], v13 offset:34816
  v_mfma_f32_16x16x32_bf16 v[44:47], v[152:155], a[152:155], v[44:47]
  ds_read_b64_tr_b16 v[116:117], v12 offset:36864
  ds_read_b64_tr_b16 v[118:119], v13 offset:36864
  v_mfma_f32_16x16x32_bf16 v[20:23], v[152:155], a[144:147], v[20:23]
  ds_read_b64_tr_b16 v[120:121], v12 offset:38912
  ds_read_b64_tr_b16 v[122:123], v13 offset:38912
  v_mfma_f32_16x16x32_bf16 v[32:35], v[156:159], a[144:147], v[32:35]
  ds_read_b64_tr_b16 v[124:125], v12 offset:33024
  ds_read_b64_tr_b16 v[126:127], v13 offset:33024
  v_mfma_f32_16x16x32_bf16 v[48:51], v[156:159], a[152:155], v[48:51]
  ds_read_b64_tr_b16 v[136:137], v12 offset:35072
  ds_read_b64_tr_b16 v[138:139], v13 offset:35072
  v_mfma_f32_16x16x32_bf16 v[52:55], v[160:163], a[152:155], v[52:55]
  ds_read_b64_tr_b16 v[140:141], v12 offset:37120
  ds_read_b64_tr_b16 v[142:143], v13 offset:37120
  v_mfma_f32_16x16x32_bf16 v[36:39], v[160:163], a[144:147], v[36:39]
  ds_read_b64_tr_b16 v[144:145], v12 offset:39168
  ds_read_b64_tr_b16 v[146:147], v13 offset:39168
  v_mfma_f32_16x16x32_bf16 v[16:19], v[164:167], a[148:151], v[16:19]
  s_add_u32 m0, s7, 102400
  s_nop 0
  buffer_load_dwordx4 v11, s[8:11], s6 offen offset:0 sc1 lds
  v_mfma_f32_16x16x32_bf16 v[40:43], v[164:167], a[156:159], v[40:43]
  s_cmp_lg_u32 s3, 1
  s_cbranch_scc1 gated_mix__spectral_gfnet__ssm_conv_s5__prompt_kernel_skip43
  s_getpc_b64 s[20:21]
gated_mix__spectral_gfnet__ssm_conv_s5__prompt_kernel_pc42:
  s_lshr_b32 s19, s2, 3
  s_mul_i32 s19, s19, 512
  v_min_u32 v128, 3, v4
  v_lshl_add_u32 v128, v128, 7, s19
  v_min_u32 v128, gated_mix__spectral_gfnet__ssm_conv_s5__prompt_kernel_end-gated_mix__spectral_gfnet__ssm_conv_s5__prompt_kernel_pc42, v128
  v_mov_b32 v129, 0
  v_lshl_add_u64 v[128:129], v[128:129], 0, s[20:21]
  global_load_dword v1, v[128:129], off
gated_mix__spectral_gfnet__ssm_conv_s5__prompt_kernel_skip43:
  v_mfma_f32_16x16x32_bf16 v[44:47], v[168:171], a[156:159], v[44:47]
  buffer_load_dwordx4 v11, s[8:11], s6 offen offset:1024 sc1 lds
  v_mfma_f32_16x16x32_bf16 v[20:23], v[168:171], a[148:151], v[20:23]
  v_mfma_f32_16x16x32_bf16 v[32:35], v[172:175], a[148:151], v[32:35]
  buffer_load_dwordx4 v11, s[8:11], s6 offen offset:2048 sc1 lds
  v_mfma_f32_16x16x32_bf16 v[48:51], v[172:175], a[156:159], v[48:51]
  v_mfma_f32_16x16x32_bf16 v[52:55], v[176:179], a[156:159], v[52:55]
  buffer_load_dwordx4 v11, s[8:11], s6 offen offset:3072 sc1 lds
  s_add_u32 s6, s6, 73728
  s_and_b32 s6, s6, 0x7ffff
  v_mfma_f32_16x16x32_bf16 v[36:39], v[176:179], a[148:151], v[36:39]
  s_waitcnt lgkmcnt(0)
  v_mfma_f32_16x16x32_bf16 v[16:19], v[108:111], a[160:163], v[16:19]
  ds_read_b64_tr_b16 v[148:149], v12 offset:49152
  ds_read_b64_tr_b16 v[150:151], v13 offset:49152
  v_mfma_f32_16x16x32_bf16 v[40:43], v[108:111], a[168:171], v[40:43]
  ds_read_b64_tr_b16 v[152:153], v12 offset:51200
  ds_read_b64_tr_b16 v[154:155], v13 offset:51200
  v_mfma_f32_16x16x32_bf16 v[44:47], v[112:115], a[168:171], v[44:47]
  ds_read_b64_tr_b16 v[156:157], v12 offset:53248
  ds_read_b64_tr_b16 v[158:159], v13 offset:53248
  v_mfma_f32_16x16x32_bf16 v[20:23], v[112:115], a[160:163], v[20:23]
  ds_read_b64_tr_b16 v[160:161], v12 offset:55296
  ds_read_b64_tr_b16 v[162:163], v13 offset:55296
  v_mfma_f32_16x16x32_bf16 v[32:35], v[116:119], a[160:163], v[32:35]
  ds_read_b64_tr_b16 v[164:165], v12 offset:49408
  ds_read_b64_tr_b16 v[166:167], v13 offset:49408
  v_mfma_f32_16x16x32_bf16 v[48:51], v[116:119], a[168:171], v[48:51]
  ds_read_b64_tr_b16 v[168:169], v12 offset:51456
  ds_read_b64_tr_b16 v[170:171], v13 offset:51456
  v_mfma_f32_16x16x32_bf16 v[52:55], v[120:123], a[168:171], v[52:55]
  ds_read_b64_tr_b16 v[172:173], v12 offset:53504
  ds_read_b64_tr_b16 v[174:175], v13 offset:53504
  v_mfma_f32_16x16x32_bf16 v[36:39], v[120:123], a[160:163], v[36:39]
  ds_read_b64_tr_b16 v[176:177], v12 offset:55552
  ds_read_b64_tr_b16 v[178:179], v13 offset:55552
  v_mfma_f32_16x16x32_bf16 v[16:19], v[124:127], a[164:167], v[16:19]
  s_add_u32 m0, s7, 0
  s_nop 0
  buffer_load_dwordx4 v10, s[8:11], s6 offen offset:0 sc1 lds
  v_mfma_f32_16x16x32_bf16 v[40:43], v[124:127], a[172:175], v[40:43]
  v_mfma_f32_16x16x32_bf16 v[44:47], v[136:139], a[172:175], v[44:47]
  buffer_load_dwordx4 v10, s[8:11], s6 offen offset:1024 sc1 lds
  v_mfma_f32_16x16x32_bf16 v[20:23], v[136:139], a[164:167], v[20:23]
  v_mfma_f32_16x16x32_bf16 v[32:35], v[140:143], a[164:167], v[32:35]
  buffer_load_dwordx4 v10, s[8:11], s6 offen offset:2048 sc1 lds
  v_mfma_f32_16x16x32_bf16 v[48:51], v[140:143], a[172:175], v[48:51]
  v_mfma_f32_16x16x32_bf16 v[52:55], v[144:147], a[172:175], v[52:55]
  buffer_load_dwordx4 v10, s[8:11], s6 offen offset:3072 sc1 lds
  v_mfma_f32_16x16x32_bf16 v[36:39], v[144:147], a[164:167], v[36:39]
  s_waitcnt vmcnt(12) lgkmcnt(0)
  s_barrier
  v_mfma_f32_16x16x32_bf16 v[16:19], v[148:151], a[176:179], v[16:19]
  ds_read_b64_tr_b16 v[108:109], v14 offset:0
  ds_read_b64_tr_b16 v[110:111], v15 offset:0
  v_mfma_f32_16x16x32_bf16 v[40:43], v[148:151], a[184:187], v[40:43]
  ds_read_b64_tr_b16 v[112:113], v14 offset:2048
  ds_read_b64_tr_b16 v[114:115], v15 offset:2048
  v_mfma_f32_16x16x32_bf16 v[44:47], v[152:155], a[184:187], v[44:47]
  ds_read_b64_tr_b16 v[116:117], v14 offset:4096
  ds_read_b64_tr_b16 v[118:119], v15 offset:4096
  v_mfma_f32_16x16x32_bf16 v[20:23], v[152:155], a[176:179], v[20:23]
  ds_read_b64_tr_b16 v[120:121], v14 offset:6144
  ds_read_b64_tr_b16 v[122:123], v15 offset:6144
  v_mfma_f32_16x16x32_bf16 v[32:35], v[156:159], a[176:179], v[32:35]
  ds_read_b64_tr_b16 v[124:125], v14 offset:256
  ds_read_b64_tr_b16 v[126:127], v15 offset:256
  v_mfma_f32_16x16x32_bf16 v[48:51], v[156:159], a[184:187], v[48:51]
  ds_read_b64_tr_b16 v[136:137], v14 offset:2304
  ds_read_b64_tr_b16 v[138:139], v15 offset:2304
  v_mfma_f32_16x16x32_bf16 v[52:55], v[160:163], a[184:187], v[52:55]
  ds_read_b64_tr_b16 v[140:141], v14 offset:4352
  ds_read_b64_tr_b16 v[142:143], v15 offset:4352
  v_mfma_f32_16x16x32_bf16 v[36:39], v[160:163], a[176:179], v[36:39]
  ds_read_b64_tr_b16 v[144:145], v14 offset:6400
  ds_read_b64_tr_b16 v[146:147], v15 offset:6400
  v_mfma_f32_16x16x32_bf16 v[16:19], v[164:167], a[180:183], v[16:19]
  s_add_u32 m0, s7, 4096
  s_nop 0
  buffer_load_dwordx4 v11, s[8:11], s6 offen offset:0 sc1 lds
  v_mfma_f32_16x16x32_bf16 v[40:43], v[164:167], a[188:191], v[40:43]
  buffer_load_dword v27, v3, s[48:51], s4 offen sc1
  v_mfma_f32_16x16x32_bf16 v[44:47], v[168:171], a[188:191], v[44:47]
  buffer_load_dwordx4 v11, s[8:11], s6 offen offset:1024 sc1 lds
  v_mfma_f32_16x16x32_bf16 v[20:23], v[168:171], a[180:183], v[20:23]
  v_mfma_f32_16x16x32_bf16 v[32:35], v[172:175], a[180:183], v[32:35]
  buffer_load_dwordx4 v11, s[8:11], s6 offen offset:2048 sc1 lds
  v_mfma_f32_16x16x32_bf16 v[48:51], v[172:175], a[188:191], v[48:51]
  v_mfma_f32_16x16x32_bf16 v[52:55], v[176:179], a[188:191], v[52:55]
  buffer_load_dwordx4 v11, s[8:11], s6 offen offset:3072 sc1 lds
  s_add_u32 s6, s6, 65536
  s_and_b32 s6, s6, 0x7ffff
  v_mfma_f32_16x16x32_bf16 v[36:39], v[176:179], a[180:183], v[36:39]
  s_waitcnt lgkmcnt(0)
  v_mfma_f32_16x16x32_bf16 v[16:19], v[108:111], a[192:195], v[16:19]
  ds_read_b64_tr_b16 v[148:149], v14 offset:16384
  ds_read_b64_tr_b16 v[150:151], v15 offset:16384
  v_mfma_f32_16x16x32_bf16 v[40:43], v[108:111], a[200:203], v[40:43]
  ds_read_b64_tr_b16 v[152:153], v14 offset:18432
  ds_read_b64_tr_b16 v[154:155], v15 offset:18432
  v_mfma_f32_16x16x32_bf16 v[44:47], v[112:115], a[200:203], v[44:47]
  ds_read_b64_tr_b16 v[156:157], v14 offset:20480
  ds_read_b64_tr_b16 v[158:159], v15 offset:20480
  v_mfma_f32_16x16x32_bf16 v[20:23], v[112:115], a[192:195], v[20:23]
  ds_read_b64_tr_b16 v[160:161], v14 offset:22528
  ds_read_b64_tr_b16 v[162:163], v15 offset:22528
  v_mfma_f32_16x16x32_bf16 v[32:35], v[116:119], a[192:195], v[32:35]
  ds_read_b64_tr_b16 v[164:165], v14 offset:16640
  ds_read_b64_tr_b16 v[166:167], v15 offset:16640
  v_mfma_f32_16x16x32_bf16 v[48:51], v[116:119], a[200:203], v[48:51]
  ds_read_b64_tr_b16 v[168:169], v14 offset:18688
  ds_read_b64_tr_b16 v[170:171], v15 offset:18688
  v_mfma_f32_16x16x32_bf16 v[52:55], v[120:123], a[200:203], v[52:55]
  ds_read_b64_tr_b16 v[172:173], v14 offset:20736
  ds_read_b64_tr_b16 v[174:175], v15 offset:20736
  v_mfma_f32_16x16x32_bf16 v[36:39], v[120:123], a[192:195], v[36:39]
  ds_read_b64_tr_b16 v[176:177], v14 offset:22784
  ds_read_b64_tr_b16 v[178:179], v15 offset:22784
  v_mfma_f32_16x16x32_bf16 v[16:19], v[124:127], a[196:199], v[16:19]
  s_add_u32 m0, s7, 32768
  s_nop 0
  buffer_load_dwordx4 v10, s[8:11], s6 offen offset:0 sc1 lds
  v_mfma_f32_16x16x32_bf16 v[40:43], v[124:127], a[204:207], v[40:43]
  v_mfma_f32_16x16x32_bf16 v[44:47], v[136:139], a[204:207], v[44:47]
  buffer_load_dwordx4 v10, s[8:11], s6 offen offset:1024 sc1 lds
  v_mfma_f32_16x16x32_bf16 v[20:23], v[136:139], a[196:199], v[20:23]
  v_mfma_f32_16x16x32_bf16 v[32:35], v[140:143], a[196:199], v[32:35]
  buffer_load_dwordx4 v10, s[8:11], s6 offen offset:2048 sc1 lds
  v_mfma_f32_16x16x32_bf16 v[48:51], v[140:143], a[204:207], v[48:51]
  v_mfma_f32_16x16x32_bf16 v[52:55], v[144:147], a[204:207], v[52:55]
  buffer_load_dwordx4 v10, s[8:11], s6 offen offset:3072 sc1 lds
  v_mfma_f32_16x16x32_bf16 v[36:39], v[144:147], a[196:199], v[36:39]
  s_waitcnt vmcnt(13) lgkmcnt(0)
  s_barrier
  v_mfma_f32_16x16x32_bf16 v[16:19], v[148:151], a[208:211], v[16:19]
  ds_read_b64_tr_b16 v[108:109], v14 offset:32768
  ds_read_b64_tr_b16 v[110:111], v15 offset:32768
  v_mfma_f32_16x16x32_bf16 v[40:43], v[148:151], a[216:219], v[40:43]
  ds_read_b64_tr_b16 v[112:113], v14 offset:34816
  ds_read_b64_tr_b16 v[114:115], v15 offset:34816
  v_mfma_f32_16x16x32_bf16 v[44:47], v[152:155], a[216:219], v[44:47]
  ds_read_b64_tr_b16 v[116:117], v14 offset:36864
  ds_read_b64_tr_b16 v[118:119], v15 offset:36864
  v_mfma_f32_16x16x32_bf16 v[20:23], v[152:155], a[208:211], v[20:23]
  ds_read_b64_tr_b16 v[120:121], v14 offset:38912
  ds_read_b64_tr_b16 v[122:123], v15 offset:38912
  v_mfma_f32_16x16x32_bf16 v[32:35], v[156:159], a[208:211], v[32:35]
  ds_read_b64_tr_b16 v[124:125], v14 offset:33024
  ds_read_b64_tr_b16 v[126:127], v15 offset:33024
  v_mfma_f32_16x16x32_bf16 v[48:51], v[156:159], a[216:219], v[48:51]
  ds_read_b64_tr_b16 v[136:137], v14 offset:35072
  ds_read_b64_tr_b16 v[138:139], v15 offset:35072
  v_mfma_f32_16x16x32_bf16 v[52:55], v[160:163], a[216:219], v[52:55]
  ds_read_b64_tr_b16 v[140:141], v14 offset:37120
  ds_read_b64_tr_b16 v[142:143], v15 offset:37120
  v_mfma_f32_16x16x32_bf16 v[36:39], v[160:163], a[208:211], v[36:39]
  ds_read_b64_tr_b16 v[144:145], v14 offset:39168
  ds_read_b64_tr_b16 v[146:147], v15 offset:39168
  v_mfma_f32_16x16x32_bf16 v[16:19], v[164:167], a[212:215], v[16:19]
  s_add_u32 m0, s7, 36864
  s_nop 0
  buffer_load_dwordx4 v11, s[8:11], s6 offen offset:0 sc1 lds
  v_mfma_f32_16x16x32_bf16 v[40:43], v[164:167], a[220:223], v[40:43]
  v_mfma_f32_16x16x32_bf16 v[44:47], v[168:171], a[220:223], v[44:47]
  buffer_load_dwordx4 v11, s[8:11], s6 offen offset:1024 sc1 lds
  v_mfma_f32_16x16x32_bf16 v[20:23], v[168:171], a[212:215], v[20:23]
  v_mfma_f32_16x16x32_bf16 v[32:35], v[172:175], a[212:215], v[32:35]
  buffer_load_dwordx4 v11, s[8:11], s6 offen offset:2048 sc1 lds
  v_mfma_f32_16x16x32_bf16 v[48:51], v[172:175], a[220:223], v[48:51]
  v_mfma_f32_16x16x32_bf16 v[52:55], v[176:179], a[220:223], v[52:55]
  buffer_load_dwordx4 v11, s[8:11], s6 offen offset:3072 sc1 lds
  s_add_u32 s6, s6, 65536
  s_and_b32 s6, s6, 0x7ffff
  v_mfma_f32_16x16x32_bf16 v[36:39], v[176:179], a[212:215], v[36:39]
  s_waitcnt lgkmcnt(0)
  v_mfma_f32_16x16x32_bf16 v[16:19], v[108:111], a[224:227], v[16:19]
  ds_read_b64_tr_b16 v[148:149], v14 offset:49152
  ds_read_b64_tr_b16 v[150:151], v15 offset:49152
  v_mfma_f32_16x16x32_bf16 v[40:43], v[108:111], a[232:235], v[40:43]
  ds_read_b64_tr_b16 v[152:153], v14 offset:51200
  ds_read_b64_tr_b16 v[154:155], v15 offset:51200
  v_mfma_f32_16x16x32_bf16 v[44:47], v[112:115], a[232:235], v[44:47]
  ds_read_b64_tr_b16 v[156:157], v14 offset:53248
  ds_read_b64_tr_b16 v[158:159], v15 offset:53248
  v_mfma_f32_16x16x32_bf16 v[20:23], v[112:115], a[224:227], v[20:23]
  ds_read_b64_tr_b16 v[160:161], v14 offset:55296
  ds_read_b64_tr_b16 v[162:163], v15 offset:55296
  v_mfma_f32_16x16x32_bf16 v[32:35], v[116:119], a[224:227], v[32:35]
  ds_read_b64_tr_b16 v[164:165], v14 offset:49408
  ds_read_b64_tr_b16 v[166:167], v15 offset:49408
  v_mfma_f32_16x16x32_bf16 v[48:51], v[116:119], a[232:235], v[48:51]
  ds_read_b64_tr_b16 v[168:169], v14 offset:51456
  ds_read_b64_tr_b16 v[170:171], v15 offset:51456
  v_mfma_f32_16x16x32_bf16 v[52:55], v[120:123], a[232:235], v[52:55]
  ds_read_b64_tr_b16 v[172:173], v14 offset:53504
  ds_read_b64_tr_b16 v[174:175], v15 offset:53504
  v_mfma_f32_16x16x32_bf16 v[36:39], v[120:123], a[224:227], v[36:39]
  ds_read_b64_tr_b16 v[176:177], v14 offset:55552
  ds_read_b64_tr_b16 v[178:179], v15 offset:55552
  v_mfma_f32_16x16x32_bf16 v[16:19], v[124:127], a[228:231], v[16:19]
  s_add_u32 m0, s7, 65536
  s_nop 0
  buffer_load_dwordx4 v10, s[8:11], s6 offen offset:0 sc1 lds
  v_mfma_f32_16x16x32_bf16 v[40:43], v[124:127], a[236:239], v[40:43]
  v_mfma_f32_16x16x32_bf16 v[44:47], v[136:139], a[236:239], v[44:47]
  buffer_load_dwordx4 v10, s[8:11], s6 offen offset:1024 sc1 lds
  v_mfma_f32_16x16x32_bf16 v[20:23], v[136:139], a[228:231], v[20:23]
  v_mfma_f32_16x16x32_bf16 v[32:35], v[140:143], a[228:231], v[32:35]
  buffer_load_dwordx4 v10, s[8:11], s6 offen offset:2048 sc1 lds
  v_mfma_f32_16x16x32_bf16 v[48:51], v[140:143], a[236:239], v[48:51]
  v_mfma_f32_16x16x32_bf16 v[52:55], v[144:147], a[236:239], v[52:55]
  buffer_load_dwordx4 v10, s[8:11], s6 offen offset:3072 sc1 lds
  v_mfma_f32_16x16x32_bf16 v[36:39], v[144:147], a[228:231], v[36:39]
  s_waitcnt vmcnt(15)
  v_cmp_ne_u32 vcc, 1, v27
  s_nop 0
  s_cbranch_vccz gated_mix__spectral_gfnet__ssm_conv_s5__prompt_kernel_skip44
  s_mov_b32 s17, 0
gated_mix__spectral_gfnet__ssm_conv_s5__prompt_kernel_poll45:
  s_sleep 16
  buffer_load_dword v27, v3, s[48:51], s4 offen sc1
  s_waitcnt vmcnt(0)
  v_cmp_ne_u32 vcc, 1, v27
  s_nop 0
  s_cbranch_vccz gated_mix__spectral_gfnet__ssm_conv_s5__prompt_kernel_pollout46
  s_add_u32 s17, s17, 1
  s_cmp_lt_u32 s17, 1048576
  s_cbranch_scc1 gated_mix__spectral_gfnet__ssm_conv_s5__prompt_kernel_poll45
gated_mix__spectral_gfnet__ssm_conv_s5__prompt_kernel_pollout46:
gated_mix__spectral_gfnet__ssm_conv_s5__prompt_kernel_skip44:
  s_waitcnt vmcnt(12) lgkmcnt(0)
  s_barrier
  v_mfma_f32_16x16x32_bf16 v[32:35], v[156:159], a[240:243], v[32:35]
  ds_read_b64_tr_b16 v[108:109], v12 offset:0
  ds_read_b64_tr_b16 v[110:111], v13 offset:0
  v_mfma_f32_16x16x32_bf16 v[48:51], v[156:159], a[248:251], v[48:51]
  ds_read_b64_tr_b16 v[112:113], v12 offset:2048
  ds_read_b64_tr_b16 v[114:115], v13 offset:2048
  v_mfma_f32_16x16x32_bf16 v[52:55], v[160:163], a[248:251], v[52:55]
  ds_read_b64_tr_b16 v[116:117], v12 offset:4096
  ds_read_b64_tr_b16 v[118:119], v13 offset:4096
  v_mfma_f32_16x16x32_bf16 v[36:39], v[160:163], a[240:243], v[36:39]
  ds_read_b64_tr_b16 v[120:121], v12 offset:6144
  ds_read_b64_tr_b16 v[122:123], v13 offset:6144
  v_mfma_f32_16x16x32_bf16 v[32:35], v[172:175], a[244:247], v[32:35]
  ds_read_b64_tr_b16 v[124:125], v12 offset:256
  ds_read_b64_tr_b16 v[126:127], v13 offset:256
  v_mfma_f32_16x16x32_bf16 v[48:51], v[172:175], a[252:255], v[48:51]
  ds_read_b64_tr_b16 v[136:137], v12 offset:2304
  ds_read_b64_tr_b16 v[138:139], v13 offset:2304
  v_mfma_f32_16x16x32_bf16 v[52:55], v[176:179], a[252:255], v[52:55]
  ds_read_b64_tr_b16 v[140:141], v12 offset:4352
  ds_read_b64_tr_b16 v[142:143], v13 offset:4352
  v_mfma_f32_16x16x32_bf16 v[36:39], v[176:179], a[244:247], v[36:39]
  ds_read_b64_tr_b16 v[144:145], v12 offset:6400
  ds_read_b64_tr_b16 v[146:147], v13 offset:6400
  v_mfma_f32_16x16x32_bf16 v[16:19], v[148:151], a[240:243], v[16:19]
  s_add_u32 m0, s7, 69632
  s_nop 0
  buffer_load_dwordx4 v11, s[8:11], s6 offen offset:0 sc1 lds
  v_mfma_f32_16x16x32_bf16 v[40:43], v[148:151], a[248:251], v[40:43]
  v_lshlrev_b32 v26, 4, v4
  s_lshl_b32 s17, s42, 4
  s_add_u32 s17, s17, s43
  s_mul_i32 s17, s17, 16384
  s_lshl_b32 s19, s3, 12
  s_add_u32 s17, s17, s19
  buffer_load_dwordx4 v[128:131], v26, s[24:27], s17 offen offset:0 sc1
  buffer_load_dwordx4 v[132:135], v26, s[24:27], s17 offen offset:1024 sc1
  buffer_load_dwordx4 v[188:191], v26, s[24:27], s17 offen offset:2048 sc1
  buffer_load_dwordx4 v[192:195], v26, s[24:27], s17 offen offset:3072 sc1
  v_lshrrev_b32 v26, 1, v6
  v_lshlrev_b32 v26, 7, v26
  v_and_b32 v27, 1, v6
  v_lshl_or_b32 v26, v27, 4, v26
  s_lshl_b32 s17, s42, 11
  s_and_b32 s19, s3, 1
  s_lshl_b32 s19, s19, 9
  s_add_u32 s17, s17, s19
  buffer_load_dwordx4 v[196:199], v26, s[84:87], s17 offen offset:0 sc1
  buffer_load_dwordx4 v[200:203], v26, s[84:87], s17 offen offset:256 sc1
  buffer_load_dwordx4 v[204:207], v26, s[84:87], s17 offen offset:1024 sc1
  buffer_load_dwordx4 v[208:211], v26, s[84:87], s17 offen offset:1280 sc1
  v_mfma_f32_16x16x32_bf16 v[44:47], v[152:155], a[248:251], v[44:47]
  buffer_load_dwordx4 v11, s[8:11], s6 offen offset:1024 sc1 lds
  v_mfma_f32_16x16x32_bf16 v[20:23], v[152:155], a[240:243], v[20:23]
  v_mfma_f32_16x16x32_bf16 v[16:19], v[164:167], a[244:247], v[16:19]
  buffer_load_dwordx4 v11, s[8:11], s6 offen offset:2048 sc1 lds
  v_mfma_f32_16x16x32_bf16 v[40:43], v[164:167], a[252:255], v[40:43]
  v_mfma_f32_16x16x32_bf16 v[44:47], v[168:171], a[252:255], v[44:47]
  buffer_load_dwordx4 v11, s[8:11], s6 offen offset:3072 sc1 lds
  s_add_u32 s6, s6, 65536
  s_and_b32 s6, s6, 0x7ffff
  v_mfma_f32_16x16x32_bf16 v[20:23], v[168:171], a[244:247], v[20:23]
  s_waitcnt lgkmcnt(0)
  v_mfma_f32_16x16x32_bf16 v[76:79], v[108:111], a[0:3], v[76:79]
  ds_read_b64_tr_b16 v[148:149], v12 offset:16384
  ds_read_b64_tr_b16 v[150:151], v13 offset:16384
  v_mfma_f32_16x16x32_bf16 v[92:95], v[108:111], a[8:11], v[92:95]
  ds_read_b64_tr_b16 v[152:153], v12 offset:18432
  ds_read_b64_tr_b16 v[154:155], v13 offset:18432
  v_mfma_f32_16x16x32_bf16 v[96:99], v[112:115], a[8:11], v[96:99]
  ds_read_b64_tr_b16 v[156:157], v12 offset:20480
  ds_read_b64_tr_b16 v[158:159], v13 offset:20480
  v_mfma_f32_16x16x32_bf16 v[80:83], v[112:115], a[0:3], v[80:83]
  ds_read_b64_tr_b16 v[160:161], v12 offset:22528
  ds_read_b64_tr_b16 v[162:163], v13 offset:22528
  v_mfma_f32_16x16x32_bf16 v[84:87], v[116:119], a[0:3], 0
  ds_read_b64_tr_b16 v[164:165], v12 offset:16640
  ds_read_b64_tr_b16 v[166:167], v13 offset:16640
  v_mfma_f32_16x16x32_bf16 v[100:103], v[116:119], a[8:11], 0
  ds_read_b64_tr_b16 v[168:169], v12 offset:18688
  ds_read_b64_tr_b16 v[170:171], v13 offset:18688
  v_mfma_f32_16x16x32_bf16 v[104:107], v[120:123], a[8:11], 0
  ds_read_b64_tr_b16 v[172:173], v12 offset:20736
  ds_read_b64_tr_b16 v[174:175], v13 offset:20736
  v_mfma_f32_16x16x32_bf16 v[88:91], v[120:123], a[0:3], 0
  ds_read_b64_tr_b16 v[176:177], v12 offset:22784
  ds_read_b64_tr_b16 v[178:179], v13 offset:22784
  v_mfma_f32_16x16x32_bf16 v[76:79], v[124:127], a[4:7], v[76:79]
  s_add_u32 m0, s7, 98304
  s_nop 0
  buffer_load_dwordx4 v10, s[8:11], s6 offen offset:0 sc1 lds
  v_mfma_f32_16x16x32_bf16 v[92:95], v[124:127], a[12:15], v[92:95]
  ds_write_b128 v2, v[32:35] offset:0
  v_mfma_f32_16x16x32_bf16 v[96:99], v[136:139], a[12:15], v[96:99]
  buffer_load_dwordx4 v10, s[8:11], s6 offen offset:1024 sc1 lds
  v_mfma_f32_16x16x32_bf16 v[80:83], v[136:139], a[4:7], v[80:83]
  ds_write_b128 v2, v[36:39] offset:1024
  v_mfma_f32_16x16x32_bf16 v[84:87], v[140:143], a[4:7], v[84:87]
  buffer_load_dwordx4 v10, s[8:11], s6 offen offset:2048 sc1 lds
  v_mfma_f32_16x16x32_bf16 v[100:103], v[140:143], a[12:15], v[100:103]
  ds_write_b128 v2, v[48:51] offset:2048
  v_mfma_f32_16x16x32_bf16 v[104:107], v[144:147], a[12:15], v[104:107]
  buffer_load_dwordx4 v10, s[8:11], s6 offen offset:3072 sc1 lds
  v_mfma_f32_16x16x32_bf16 v[88:91], v[144:147], a[4:7], v[88:91]
  ds_write_b128 v2, v[52:55] offset:3072
  s_waitcnt lgkmcnt(0)
  s_waitcnt vmcnt(20)
  s_barrier
  v_mfma_f32_16x16x32_bf16 v[76:79], v[148:151], a[16:19], v[76:79]
  ds_read_b64_tr_b16 v[108:109], v12 offset:32768
  ds_read_b64_tr_b16 v[110:111], v13 offset:32768
  v_mfma_f32_16x16x32_bf16 v[92:95], v[148:151], a[24:27], v[92:95]
  ds_read_b64_tr_b16 v[112:113], v12 offset:34816
  ds_read_b64_tr_b16 v[114:115], v13 offset:34816
  v_mfma_f32_16x16x32_bf16 v[96:99], v[152:155], a[24:27], v[96:99]
  ds_read_b64_tr_b16 v[116:117], v12 offset:36864
  ds_read_b64_tr_b16 v[118:119], v13 offset:36864
  v_mfma_f32_16x16x32_bf16 v[80:83], v[152:155], a[16:19], v[80:83]
  ds_read_b64_tr_b16 v[120:121], v12 offset:38912
  ds_read_b64_tr_b16 v[122:123], v13 offset:38912
  v_mfma_f32_16x16x32_bf16 v[84:87], v[156:159], a[16:19], v[84:87]
  ds_read_b64_tr_b16 v[124:125], v12 offset:33024
  ds_read_b64_tr_b16 v[126:127], v13 offset:33024
  v_mfma_f32_16x16x32_bf16 v[100:103], v[156:159], a[24:27], v[100:103]
  ds_read_b64_tr_b16 v[136:137], v12 offset:35072
  ds_read_b64_tr_b16 v[138:139], v13 offset:35072
  v_mfma_f32_16x16x32_bf16 v[104:107], v[160:163], a[24:27], v[104:107]
  ds_read_b64_tr_b16 v[140:141], v12 offset:37120
  ds_read_b64_tr_b16 v[142:143], v13 offset:37120
  v_mfma_f32_16x16x32_bf16 v[88:91], v[160:163], a[16:19], v[88:91]
  ds_read_b64_tr_b16 v[144:145], v12 offset:39168
  ds_read_b64_tr_b16 v[146:147], v13 offset:39168
  v_mfma_f32_16x16x32_bf16 v[76:79], v[164:167], a[20:23], v[76:79]
  s_add_u32 m0, s7, 102400
  s_nop 0
  buffer_load_dwordx4 v11, s[8:11], s6 offen offset:0 sc1 lds
  v_mfma_f32_16x16x32_bf16 v[92:95], v[164:167], a[28:31], v[92:95]
  v_xor_b32 v2, 0x1000, v2
  ds_read_b128 v[32:35], v2 offset:0
  ds_read_b128 v[36:39], v2 offset:1024
  ds_read_b128 v[48:51], v2 offset:2048
  ds_read_b128 v[52:55], v2 offset:3072
  v_xor_b32 v2, 0x1000, v2
  v_mfma_f32_16x16x32_bf16 v[96:99], v[168:171], a[28:31], v[96:99]
  buffer_load_dwordx4 v11, s[8:11], s6 offen offset:1024 sc1 lds
  v_mfma_f32_16x16x32_bf16 v[80:83], v[168:171], a[20:23], v[80:83]
  v_mfma_f32_16x16x32_bf16 v[84:87], v[172:175], a[20:23], v[84:87]
  buffer_load_dwordx4 v11, s[8:11], s6 offen offset:2048 sc1 lds
  v_mfma_f32_16x16x32_bf16 v[100:103], v[172:175], a[28:31], v[100:103]
  v_mfma_f32_16x16x32_bf16 v[104:107], v[176:179], a[28:31], v[104:107]
  buffer_load_dwordx4 v11, s[8:11], s6 offen offset:3072 sc1 lds
  s_add_u32 s6, s6, 65536
  s_and_b32 s6, s6, 0x7ffff
  v_mfma_f32_16x16x32_bf16 v[88:91], v[176:179], a[20:23], v[88:91]
  s_waitcnt lgkmcnt(4)
  v_mfma_f32_16x16x32_bf16 v[76:79], v[108:111], a[32:35], v[76:79]
  ds_read_b64_tr_b16 v[148:149], v12 offset:49152
  ds_read_b64_tr_b16 v[150:151], v13 offset:49152
  v_mfma_f32_16x16x32_bf16 v[92:95], v[108:111], a[40:43], v[92:95]
  ds_read_b64_tr_b16 v[152:153], v12 offset:51200
  ds_read_b64_tr_b16 v[154:155], v13 offset:51200
  v_mfma_f32_16x16x32_bf16 v[96:99], v[112:115], a[40:43], v[96:99]
  ds_read_b64_tr_b16 v[156:157], v12 offset:53248
  ds_read_b64_tr_b16 v[158:159], v13 offset:53248
  v_mfma_f32_16x16x32_bf16 v[80:83], v[112:115], a[32:35], v[80:83]
  ds_read_b64_tr_b16 v[160:161], v12 offset:55296
  ds_read_b64_tr_b16 v[162:163], v13 offset:55296
  v_mfma_f32_16x16x32_bf16 v[84:87], v[116:119], a[32:35], v[84:87]
  ds_read_b64_tr_b16 v[164:165], v12 offset:49408
  ds_read_b64_tr_b16 v[166:167], v13 offset:49408
  v_mfma_f32_16x16x32_bf16 v[100:103], v[116:119], a[40:43], v[100:103]
  ds_read_b64_tr_b16 v[168:169], v12 offset:51456
  ds_read_b64_tr_b16 v[170:171], v13 offset:51456
  v_mfma_f32_16x16x32_bf16 v[104:107], v[120:123], a[40:43], v[104:107]
  ds_read_b64_tr_b16 v[172:173], v12 offset:53504
  ds_read_b64_tr_b16 v[174:175], v13 offset:53504
  v_mfma_f32_16x16x32_bf16 v[88:91], v[120:123], a[32:35], v[88:91]
  ds_read_b64_tr_b16 v[176:177], v12 offset:55552
  ds_read_b64_tr_b16 v[178:179], v13 offset:55552
  v_mfma_f32_16x16x32_bf16 v[76:79], v[124:127], a[36:39], v[76:79]
  s_add_u32 m0, s7, 0
  s_nop 0
  buffer_load_dwordx4 v10, s[8:11], s6 offen offset:0 sc1 lds
  s_waitcnt lgkmcnt(15)
  v_pk_add_f32 v[16:17], v[16:17], v[32:33]
  v_pk_add_f32 v[18:19], v[18:19], v[34:35]
  s_waitcnt lgkmcnt(15)
  v_pk_add_f32 v[20:21], v[20:21], v[36:37]
  v_pk_add_f32 v[22:23], v[22:23], v[38:39]
  s_waitcnt lgkmcnt(15)
  v_pk_add_f32 v[40:41], v[40:41], v[48:49]
  v_pk_add_f32 v[42:43], v[42:43], v[50:51]
  s_waitcnt lgkmcnt(15)
  v_pk_add_f32 v[44:45], v[44:45], v[52:53]
  v_pk_add_f32 v[46:47], v[46:47], v[54:55]
  v_mfma_f32_16x16x32_bf16 v[92:95], v[124:127], a[44:47], v[92:95]
  v_mfma_f32_16x16x32_bf16 v[96:99], v[136:139], a[44:47], v[96:99]
  buffer_load_dwordx4 v10, s[8:11], s6 offen offset:1024 sc1 lds
  v_mfma_f32_16x16x32_bf16 v[80:83], v[136:139], a[36:39], v[80:83]
  v_mfma_f32_16x16x32_bf16 v[84:87], v[140:143], a[36:39], v[84:87]
  buffer_load_dwordx4 v10, s[8:11], s6 offen offset:2048 sc1 lds
  v_mfma_f32_16x16x32_bf16 v[100:103], v[140:143], a[44:47], v[100:103]
  v_mfma_f32_16x16x32_bf16 v[104:107], v[144:147], a[44:47], v[104:107]
  buffer_load_dwordx4 v10, s[8:11], s6 offen offset:3072 sc1 lds
  v_mfma_f32_16x16x32_bf16 v[88:91], v[144:147], a[36:39], v[88:91]
  s_waitcnt vmcnt(12) lgkmcnt(0)
  s_barrier
  v_mfma_f32_16x16x32_bf16 v[76:79], v[148:151], a[48:51], v[76:79]
  ds_read_b64_tr_b16 v[108:109], v14 offset:0
  ds_read_b64_tr_b16 v[110:111], v15 offset:0
  v_mfma_f32_16x16x32_bf16 v[92:95], v[148:151], a[56:59], v[92:95]
  ds_read_b64_tr_b16 v[112:113], v14 offset:2048
  ds_read_b64_tr_b16 v[114:115], v15 offset:2048
  v_mfma_f32_16x16x32_bf16 v[96:99], v[152:155], a[56:59], v[96:99]
  ds_read_b64_tr_b16 v[116:117], v14 offset:4096
  ds_read_b64_tr_b16 v[118:119], v15 offset:4096
  v_mfma_f32_16x16x32_bf16 v[80:83], v[152:155], a[48:51], v[80:83]
  ds_read_b64_tr_b16 v[120:121], v14 offset:6144
  ds_read_b64_tr_b16 v[122:123], v15 offset:6144
  v_mfma_f32_16x16x32_bf16 v[84:87], v[156:159], a[48:51], v[84:87]
  ds_read_b64_tr_b16 v[124:125], v14 offset:256
  ds_read_b64_tr_b16 v[126:127], v15 offset:256
  v_mfma_f32_16x16x32_bf16 v[100:103], v[156:159], a[56:59], v[100:103]
  ds_read_b64_tr_b16 v[136:137], v14 offset:2304
  ds_read_b64_tr_b16 v[138:139], v15 offset:2304
  v_mfma_f32_16x16x32_bf16 v[104:107], v[160:163], a[56:59], v[104:107]
  ds_read_b64_tr_b16 v[140:141], v14 offset:4352
  ds_read_b64_tr_b16 v[142:143], v15 offset:4352
  v_mfma_f32_16x16x32_bf16 v[88:91], v[160:163], a[48:51], v[88:91]
  ds_read_b64_tr_b16 v[144:145], v14 offset:6400
  ds_read_b64_tr_b16 v[146:147], v15 offset:6400
  v_mfma_f32_16x16x32_bf16 v[76:79], v[164:167], a[52:55], v[76:79]
  s_add_u32 m0, s7, 4096
  s_nop 0
  buffer_load_dwordx4 v11, s[8:11], s6 offen offset:0 sc1 lds
  v_mfma_f32_16x16x32_bf16 v[92:95], v[164:167], a[60:63], v[92:95]
  v_mfma_f32_16x16x32_bf16 v[96:99], v[168:171], a[60:63], v[96:99]
  buffer_load_dwordx4 v11, s[8:11], s6 offen offset:1024 sc1 lds
  v_mfma_f32_16x16x32_bf16 v[80:83], v[168:171], a[52:55], v[80:83]
  v_mfma_f32_16x16x32_bf16 v[84:87], v[172:175], a[52:55], v[84:87]
  buffer_load_dwordx4 v11, s[8:11], s6 offen offset:2048 sc1 lds
  v_mfma_f32_16x16x32_bf16 v[100:103], v[172:175], a[60:63], v[100:103]
  v_mfma_f32_16x16x32_bf16 v[104:107], v[176:179], a[60:63], v[104:107]
  buffer_load_dwordx4 v11, s[8:11], s6 offen offset:3072 sc1 lds
  s_add_u32 s6, s6, 65536
  s_and_b32 s6, s6, 0x7ffff
  v_mfma_f32_16x16x32_bf16 v[88:91], v[176:179], a[52:55], v[88:91]
  s_waitcnt lgkmcnt(0)
  v_mfma_f32_16x16x32_bf16 v[76:79], v[108:111], a[64:67], v[76:79]
  ds_read_b64_tr_b16 v[148:149], v14 offset:16384
  ds_read_b64_tr_b16 v[150:151], v15 offset:16384
  v_mfma_f32_16x16x32_bf16 v[92:95], v[108:111], a[72:75], v[92:95]
  ds_read_b64_tr_b16 v[152:153], v14 offset:18432
  ds_read_b64_tr_b16 v[154:155], v15 offset:18432
  v_mfma_f32_16x16x32_bf16 v[96:99], v[112:115], a[72:75], v[96:99]
  ds_read_b64_tr_b16 v[156:157], v14 offset:20480
  ds_read_b64_tr_b16 v[158:159], v15 offset:20480
  v_mfma_f32_16x16x32_bf16 v[80:83], v[112:115], a[64:67], v[80:83]
  ds_read_b64_tr_b16 v[160:161], v14 offset:22528
  ds_read_b64_tr_b16 v[162:163], v15 offset:22528
  v_mfma_f32_16x16x32_bf16 v[84:87], v[116:119], a[64:67], v[84:87]
  ds_read_b64_tr_b16 v[164:165], v14 offset:16640
  ds_read_b64_tr_b16 v[166:167], v15 offset:16640
  v_mfma_f32_16x16x32_bf16 v[100:103], v[116:119], a[72:75], v[100:103]
  ds_read_b64_tr_b16 v[168:169], v14 offset:18688
  ds_read_b64_tr_b16 v[170:171], v15 offset:18688
  v_mfma_f32_16x16x32_bf16 v[104:107], v[120:123], a[72:75], v[104:107]
  ds_read_b64_tr_b16 v[172:173], v14 offset:20736
  ds_read_b64_tr_b16 v[174:175], v15 offset:20736
  v_mfma_f32_16x16x32_bf16 v[88:91], v[120:123], a[64:67], v[88:91]
  ds_read_b64_tr_b16 v[176:177], v14 offset:22784
  ds_read_b64_tr_b16 v[178:179], v15 offset:22784
  v_mfma_f32_16x16x32_bf16 v[76:79], v[124:127], a[68:71], v[76:79]
  s_add_u32 m0, s7, 32768
  s_nop 0
  buffer_load_dwordx4 v10, s[8:11], s6 offen offset:0 sc1 lds
  v_mfma_f32_16x16x32_bf16 v[92:95], v[124:127], a[76:79], v[92:95]
  v_mfma_f32_16x16x32_bf16 v[96:99], v[136:139], a[76:79], v[96:99]
  buffer_load_dwordx4 v10, s[8:11], s6 offen offset:1024 sc1 lds
  v_mfma_f32_16x16x32_bf16 v[80:83], v[136:139], a[68:71], v[80:83]
  v_mfma_f32_16x16x32_bf16 v[84:87], v[140:143], a[68:71], v[84:87]
  buffer_load_dwordx4 v10, s[8:11], s6 offen offset:2048 sc1 lds
  v_mfma_f32_16x16x32_bf16 v[100:103], v[140:143], a[76:79], v[100:103]
  v_mfma_f32_16x16x32_bf16 v[104:107], v[144:147], a[76:79], v[104:107]
  buffer_load_dwordx4 v10, s[8:11], s6 offen offset:3072 sc1 lds
  v_mfma_f32_16x16x32_bf16 v[88:91], v[144:147], a[68:71], v[88:91]
  s_waitcnt vmcnt(12) lgkmcnt(0)
  s_barrier
  v_mfma_f32_16x16x32_bf16 v[76:79], v[148:151], a[80:83], v[76:79]
  ds_read_b64_tr_b16 v[108:109], v14 offset:32768
  ds_read_b64_tr_b16 v[110:111], v15 offset:32768
  v_mfma_f32_16x16x32_bf16 v[92:95], v[148:151], a[88:91], v[92:95]
  ds_read_b64_tr_b16 v[112:113], v14 offset:34816
  ds_read_b64_tr_b16 v[114:115], v15 offset:34816
  v_mfma_f32_16x16x32_bf16 v[96:99], v[152:155], a[88:91], v[96:99]
  ds_read_b64_tr_b16 v[116:117], v14 offset:36864
  ds_read_b64_tr_b16 v[118:119], v15 offset:36864
  v_mfma_f32_16x16x32_bf16 v[80:83], v[152:155], a[80:83], v[80:83]
  ds_read_b64_tr_b16 v[120:121], v14 offset:38912
  ds_read_b64_tr_b16 v[122:123], v15 offset:38912
  v_mfma_f32_16x16x32_bf16 v[84:87], v[156:159], a[80:83], v[84:87]
  ds_read_b64_tr_b16 v[124:125], v14 offset:33024
  ds_read_b64_tr_b16 v[126:127], v15 offset:33024
  v_mfma_f32_16x16x32_bf16 v[100:103], v[156:159], a[88:91], v[100:103]
  ds_read_b64_tr_b16 v[136:137], v14 offset:35072
  ds_read_b64_tr_b16 v[138:139], v15 offset:35072
  v_mfma_f32_16x16x32_bf16 v[104:107], v[160:163], a[88:91], v[104:107]
  ds_read_b64_tr_b16 v[140:141], v14 offset:37120
  ds_read_b64_tr_b16 v[142:143], v15 offset:37120
  v_mfma_f32_16x16x32_bf16 v[88:91], v[160:163], a[80:83], v[88:91]
  ds_read_b64_tr_b16 v[144:145], v14 offset:39168
  ds_read_b64_tr_b16 v[146:147], v15 offset:39168
  v_mfma_f32_16x16x32_bf16 v[76:79], v[164:167], a[84:87], v[76:79]
  s_add_u32 m0, s7, 36864
  s_nop 0
  buffer_load_dwordx4 v11, s[8:11], s6 offen offset:0 sc1 lds
  s_lshl_b32 s17, s3, 10
  s_add_u32 s17, s17, 131072
  v_lshl_add_u32 v242, v4, 4, s17
  v_lshlrev_b32 v26, 16, v128
  v_and_b32 v212, 0xffff0000, v128
  v_lshlrev_b32 v27, 16, v129
  v_and_b32 v213, 0xffff0000, v129
  v_lshlrev_b32 v214, 16, v132
  v_and_b32 v216, 0xffff0000, v132
  v_lshlrev_b32 v215, 16, v133
  v_and_b32 v217, 0xffff0000, v133
  v_lshlrev_b32 v218, 16, v188
  v_and_b32 v220, 0xffff0000, v188
  v_lshlrev_b32 v219, 16, v189
  v_and_b32 v221, 0xffff0000, v189
  v_lshlrev_b32 v222, 16, v192
  v_and_b32 v224, 0xffff0000, v192
  v_lshlrev_b32 v223, 16, v193
  v_and_b32 v225, 0xffff0000, v193
  v_pk_add_f32 v[226:227], v[26:27], v[218:219]
  v_pk_add_f32 v[230:231], v[26:27], v[218:219] neg_lo:[0,1] neg_hi:[0,1]
  v_pk_add_f32 v[234:235], v[214:215], v[222:223]
  v_pk_add_f32 v[228:229], v[212:213], v[220:221]
  v_pk_add_f32 v[232:233], v[212:213], v[220:221] neg_lo:[0,1] neg_hi:[0,1]
  v_pk_add_f32 v[236:237], v[216:217], v[224:225]
  v_pk_add_f32 v[238:239], v[224:225], v[216:217] neg_lo:[0,1] neg_hi:[0,1]
  v_pk_add_f32 v[240:241], v[214:215], v[222:223] neg_lo:[0,1] neg_hi:[0,1]
  s_cmp_lg_u32 s3, 0
  s_cbranch_scc1 gated_mix__spectral_gfnet__ssm_conv_s5__prompt_kernel_skip47
  s_mov_b64 exec, 15
  v_pk_add_f32 v[234:235], v[214:215], v[214:215]
  v_pk_add_f32 v[236:237], v[222:223], v[222:223]
  v_pk_add_f32 v[238:239], v[216:217], v[216:217] neg_lo:[1,1] neg_hi:[1,1]
  v_pk_add_f32 v[240:241], v[224:225], v[224:225] neg_lo:[1,1] neg_hi:[1,1]
  s_mov_b64 exec, -1
gated_mix__spectral_gfnet__ssm_conv_s5__prompt_kernel_skip47:
  v_pk_add_f32 v[26:27], v[226:227], v[234:235]
  v_cvt_pk_bf16_f32 v244, v26, v27
  v_pk_add_f32 v[212:213], v[228:229], v[236:237]
  v_cvt_pk_bf16_f32 v245, v212, v213
  v_pk_add_f32 v[214:215], v[230:231], v[238:239]
  v_cvt_pk_bf16_f32 v246, v214, v215
  v_pk_add_f32 v[216:217], v[232:233], v[240:241]
  v_cvt_pk_bf16_f32 v247, v216, v217
  v_pk_add_f32 v[218:219], v[226:227], v[234:235] neg_lo:[0,1] neg_hi:[0,1]
  v_cvt_pk_bf16_f32 v248, v218, v219
  v_pk_add_f32 v[220:221], v[228:229], v[236:237] neg_lo:[0,1] neg_hi:[0,1]
  v_cvt_pk_bf16_f32 v249, v220, v221
  v_pk_add_f32 v[222:223], v[230:231], v[238:239] neg_lo:[0,1] neg_hi:[0,1]
  v_cvt_pk_bf16_f32 v250, v222, v223
  v_pk_add_f32 v[224:225], v[232:233], v[240:241] neg_lo:[0,1] neg_hi:[0,1]
  v_cvt_pk_bf16_f32 v251, v224, v225
  v_lshlrev_b32 v26, 16, v130
  v_and_b32 v212, 0xffff0000, v130
  v_lshlrev_b32 v27, 16, v131
  v_and_b32 v213, 0xffff0000, v131
  v_lshlrev_b32 v214, 16, v134
  v_and_b32 v216, 0xffff0000, v134
  v_lshlrev_b32 v215, 16, v135
  v_and_b32 v217, 0xffff0000, v135
  v_lshlrev_b32 v218, 16, v190
  v_and_b32 v220, 0xffff0000, v190
  v_lshlrev_b32 v219, 16, v191
  v_and_b32 v221, 0xffff0000, v191
  v_lshlrev_b32 v222, 16, v194
  v_and_b32 v224, 0xffff0000, v194
  v_lshlrev_b32 v223, 16, v195
  v_and_b32 v225, 0xffff0000, v195
  v_pk_add_f32 v[226:227], v[26:27], v[218:219]
  v_pk_add_f32 v[230:231], v[26:27], v[218:219] neg_lo:[0,1] neg_hi:[0,1]
  v_pk_add_f32 v[234:235], v[214:215], v[222:223]
  v_pk_add_f32 v[228:229], v[212:213], v[220:221]
  v_pk_add_f32 v[232:233], v[212:213], v[220:221] neg_lo:[0,1] neg_hi:[0,1]
  v_pk_add_f32 v[236:237], v[216:217], v[224:225]
  v_pk_add_f32 v[238:239], v[224:225], v[216:217] neg_lo:[0,1] neg_hi:[0,1]
  v_pk_add_f32 v[240:241], v[214:215], v[222:223] neg_lo:[0,1] neg_hi:[0,1]
  s_cmp_lg_u32 s3, 0
  s_cbranch_scc1 gated_mix__spectral_gfnet__ssm_conv_s5__prompt_kernel_skip48
  s_mov_b64 exec, 15
  v_pk_add_f32 v[234:235], v[214:215], v[214:215]
  v_pk_add_f32 v[236:237], v[222:223], v[222:223]
  v_pk_add_f32 v[238:239], v[216:217], v[216:217] neg_lo:[1,1] neg_hi:[1,1]
  v_pk_add_f32 v[240:241], v[224:225], v[224:225] neg_lo:[1,1] neg_hi:[1,1]
  s_mov_b64 exec, -1
gated_mix__spectral_gfnet__ssm_conv_s5__prompt_kernel_skip48:
  v_pk_add_f32 v[26:27], v[226:227], v[234:235]
  v_cvt_pk_bf16_f32 v129, v26, v27
  v_pk_add_f32 v[212:213], v[228:229], v[236:237]
  v_cvt_pk_bf16_f32 v131, v212, v213
  v_pk_add_f32 v[214:215], v[230:231], v[238:239]
  v_cvt_pk_bf16_f32 v133, v214, v215
  v_pk_add_f32 v[216:217], v[232:233], v[240:241]
  v_cvt_pk_bf16_f32 v135, v216, v217
  v_pk_add_f32 v[218:219], v[226:227], v[234:235] neg_lo:[0,1] neg_hi:[0,1]
  v_cvt_pk_bf16_f32 v189, v218, v219
  v_pk_add_f32 v[220:221], v[228:229], v[236:237] neg_lo:[0,1] neg_hi:[0,1]
  v_cvt_pk_bf16_f32 v191, v220, v221
  v_pk_add_f32 v[222:223], v[230:231], v[238:239] neg_lo:[0,1] neg_hi:[0,1]
  v_cvt_pk_bf16_f32 v193, v222, v223
  v_pk_add_f32 v[224:225], v[232:233], v[240:241] neg_lo:[0,1] neg_hi:[0,1]
  v_cvt_pk_bf16_f32 v195, v224, v225
  v_mov_b32 v128, v244
  v_mov_b32 v130, v245
  ds_write_b128 v242, v[128:131] offset:0
  v_mov_b32 v132, v246
  v_mov_b32 v134, v247
  ds_write_b128 v242, v[132:135] offset:4096
  v_mov_b32 v188, v248
  v_mov_b32 v190, v249
  ds_write_b128 v242, v[188:191] offset:8192
  v_mov_b32 v192, v250
  v_mov_b32 v194, v251
  ds_write_b128 v242, v[192:195] offset:12288
  v_mfma_f32_16x16x32_bf16 v[92:95], v[164:167], a[92:95], v[92:95]
  v_mfma_f32_16x16x32_bf16 v[96:99], v[168:171], a[92:95], v[96:99]
  buffer_load_dwordx4 v11, s[8:11], s6 offen offset:1024 sc1 lds
  v_mfma_f32_16x16x32_bf16 v[80:83], v[168:171], a[84:87], v[80:83]
  v_mfma_f32_16x16x32_bf16 v[84:87], v[172:175], a[84:87], v[84:87]
  buffer_load_dwordx4 v11, s[8:11], s6 offen offset:2048 sc1 lds
  v_mfma_f32_16x16x32_bf16 v[100:103], v[172:175], a[92:95], v[100:103]
  v_mfma_f32_16x16x32_bf16 v[104:107], v[176:179], a[92:95], v[104:107]
  buffer_load_dwordx4 v11, s[8:11], s6 offen offset:3072 sc1 lds
  s_add_u32 s6, s6, 65536
  s_and_b32 s6, s6, 0x7ffff
  v_mfma_f32_16x16x32_bf16 v[88:91], v[176:179], a[84:87], v[88:91]
  s_waitcnt lgkmcnt(4)
  v_mfma_f32_16x16x32_bf16 v[76:79], v[108:111], a[96:99], v[76:79]
  ds_read_b64_tr_b16 v[148:149], v14 offset:49152
  ds_read_b64_tr_b16 v[150:151], v15 offset:49152
  v_mfma_f32_16x16x32_bf16 v[92:95], v[108:111], a[104:107], v[92:95]
  ds_read_b64_tr_b16 v[152:153], v14 offset:51200
  ds_read_b64_tr_b16 v[154:155], v15 offset:51200
  v_mfma_f32_16x16x32_bf16 v[96:99], v[112:115], a[104:107], v[96:99]
  ds_read_b64_tr_b16 v[156:157], v14 offset:53248
  ds_read_b64_tr_b16 v[158:159], v15 offset:53248
  v_mfma_f32_16x16x32_bf16 v[80:83], v[112:115], a[96:99], v[80:83]
  ds_read_b64_tr_b16 v[160:161], v14 offset:55296
  ds_read_b64_tr_b16 v[162:163], v15 offset:55296
  v_mfma_f32_16x16x32_bf16 v[84:87], v[116:119], a[96:99], v[84:87]
  ds_read_b64_tr_b16 v[164:165], v14 offset:49408
  ds_read_b64_tr_b16 v[166:167], v15 offset:49408
  v_mfma_f32_16x16x32_bf16 v[100:103], v[116:119], a[104:107], v[100:103]
  ds_read_b64_tr_b16 v[168:169], v14 offset:51456
  ds_read_b64_tr_b16 v[170:171], v15 offset:51456
  v_mfma_f32_16x16x32_bf16 v[104:107], v[120:123], a[104:107], v[104:107]
  ds_read_b64_tr_b16 v[172:173], v14 offset:53504
  ds_read_b64_tr_b16 v[174:175], v15 offset:53504
  v_mfma_f32_16x16x32_bf16 v[88:91], v[120:123], a[96:99], v[88:91]
  ds_read_b64_tr_b16 v[176:177], v14 offset:55552
  ds_read_b64_tr_b16 v[178:179], v15 offset:55552
  v_mfma_f32_16x16x32_bf16 v[76:79], v[124:127], a[100:103], v[76:79]
  s_add_u32 m0, s7, 65536
  s_nop 0
  buffer_load_dwordx4 v10, s[8:11], s6 offen offset:0 sc1 lds
  v_mfma_f32_16x16x32_bf16 v[92:95], v[124:127], a[108:111], v[92:95]
  v_mfma_f32_16x16x32_bf16 v[96:99], v[136:139], a[108:111], v[96:99]
  buffer_load_dwordx4 v10, s[8:11], s6 offen offset:1024 sc1 lds
  v_mfma_f32_16x16x32_bf16 v[80:83], v[136:139], a[100:103], v[80:83]
  v_mfma_f32_16x16x32_bf16 v[84:87], v[140:143], a[100:103], v[84:87]
  buffer_load_dwordx4 v10, s[8:11], s6 offen offset:2048 sc1 lds
  v_mfma_f32_16x16x32_bf16 v[100:103], v[140:143], a[108:111], v[100:103]
  v_mfma_f32_16x16x32_bf16 v[104:107], v[144:147], a[108:111], v[104:107]
  buffer_load_dwordx4 v10, s[8:11], s6 offen offset:3072 sc1 lds
  v_mfma_f32_16x16x32_bf16 v[88:91], v[144:147], a[100:103], v[88:91]
  s_waitcnt lgkmcnt(15)
  s_waitcnt vmcnt(12) lgkmcnt(0)
  s_barrier
  v_mfma_f32_16x16x32_bf16 v[76:79], v[148:151], a[112:115], v[76:79]
  ds_read_b64_tr_b16 v[108:109], v12 offset:0
  ds_read_b64_tr_b16 v[110:111], v13 offset:0
  v_mfma_f32_16x16x32_bf16 v[92:95], v[148:151], a[120:123], v[92:95]
  ds_read_b64_tr_b16 v[112:113], v12 offset:2048
  ds_read_b64_tr_b16 v[114:115], v13 offset:2048
  v_mfma_f32_16x16x32_bf16 v[96:99], v[152:155], a[120:123], v[96:99]
  ds_read_b64_tr_b16 v[116:117], v12 offset:4096
  ds_read_b64_tr_b16 v[118:119], v13 offset:4096
  v_mfma_f32_16x16x32_bf16 v[80:83], v[152:155], a[112:115], v[80:83]
  ds_read_b64_tr_b16 v[120:121], v12 offset:6144
  ds_read_b64_tr_b16 v[122:123], v13 offset:6144
  v_mfma_f32_16x16x32_bf16 v[84:87], v[156:159], a[112:115], v[84:87]
  ds_read_b64_tr_b16 v[124:125], v12 offset:256
  ds_read_b64_tr_b16 v[126:127], v13 offset:256
  v_mfma_f32_16x16x32_bf16 v[100:103], v[156:159], a[120:123], v[100:103]
  ds_read_b64_tr_b16 v[136:137], v12 offset:2304
  ds_read_b64_tr_b16 v[138:139], v13 offset:2304
  v_mfma_f32_16x16x32_bf16 v[104:107], v[160:163], a[120:123], v[104:107]
  ds_read_b64_tr_b16 v[140:141], v12 offset:4352
  ds_read_b64_tr_b16 v[142:143], v13 offset:4352
  v_mfma_f32_16x16x32_bf16 v[88:91], v[160:163], a[112:115], v[88:91]
  ds_read_b64_tr_b16 v[144:145], v12 offset:6400
  ds_read_b64_tr_b16 v[146:147], v13 offset:6400
  v_mfma_f32_16x16x32_bf16 v[76:79], v[164:167], a[116:119], v[76:79]
  s_add_u32 m0, s7, 69632
  s_nop 0
  buffer_load_dwordx4 v11, s[8:11], s6 offen offset:0 sc1 lds
  v_mfma_f32_16x16x32_bf16 v[92:95], v[164:167], a[124:127], v[92:95]
  ds_read_b64_tr_b16 v[128:129], v8 offset:0
  ds_read_b64_tr_b16 v[130:131], v8 offset:256
  ds_read_b64_tr_b16 v[212:213], v8 offset:4096
  v_mfma_f32_16x16x32_bf16 v[96:99], v[168:171], a[124:127], v[96:99]
  buffer_load_dwordx4 v11, s[8:11], s6 offen offset:1024 sc1 lds
  ds_read_b64_tr_b16 v[214:215], v8 offset:4352
  ds_read_b64_tr_b16 v[132:133], v8 offset:1024
  ds_read_b64_tr_b16 v[134:135], v8 offset:1280
  v_mfma_f32_16x16x32_bf16 v[80:83], v[168:171], a[116:119], v[80:83]
  ds_read_b64_tr_b16 v[216:217], v8 offset:5120
  ds_read_b64_tr_b16 v[218:219], v8 offset:5376
  ds_read_b64_tr_b16 v[188:189], v8 offset:2048
  v_mfma_f32_16x16x32_bf16 v[84:87], v[172:175], a[116:119], v[84:87]
  buffer_load_dwordx4 v11, s[8:11], s6 offen offset:2048 sc1 lds
  ds_read_b64_tr_b16 v[190:191], v8 offset:2304
  ds_read_b64_tr_b16 v[220:221], v8 offset:6144
  ds_read_b64_tr_b16 v[222:223], v8 offset:6400
  v_mfma_f32_16x16x32_bf16 v[100:103], v[172:175], a[124:127], v[100:103]
  ds_read_b64_tr_b16 v[192:193], v8 offset:3072
  ds_read_b64_tr_b16 v[194:195], v8 offset:3328
  ds_read_b64_tr_b16 v[224:225], v8 offset:7168
  v_mfma_f32_16x16x32_bf16 v[104:107], v[176:179], a[124:127], v[104:107]
  buffer_load_dwordx4 v11, s[8:11], s6 offen offset:3072 sc1 lds
  s_add_u32 s6, s6, 65536
  s_and_b32 s6, s6, 0x7ffff
  ds_read_b64_tr_b16 v[226:227], v8 offset:7424
  v_mfma_f32_16x16x32_bf16 v[88:91], v[176:179], a[116:119], v[88:91]
  s_waitcnt lgkmcnt(15)
  v_mfma_f32_16x16x32_bf16 v[76:79], v[108:111], a[128:131], v[76:79]
  ds_read_b64_tr_b16 v[148:149], v12 offset:16384
  ds_read_b64_tr_b16 v[150:151], v13 offset:16384
  v_mfma_f32_16x16x32_bf16 v[92:95], v[108:111], a[136:139], v[92:95]
  ds_read_b64_tr_b16 v[152:153], v12 offset:18432
  ds_read_b64_tr_b16 v[154:155], v13 offset:18432
  v_mfma_f32_16x16x32_bf16 v[96:99], v[112:115], a[136:139], v[96:99]
  ds_read_b64_tr_b16 v[156:157], v12 offset:20480
  ds_read_b64_tr_b16 v[158:159], v13 offset:20480
  v_mfma_f32_16x16x32_bf16 v[80:83], v[112:115], a[128:131], v[80:83]
  ds_read_b64_tr_b16 v[160:161], v12 offset:22528
  ds_read_b64_tr_b16 v[162:163], v13 offset:22528
  v_mfma_f32_16x16x32_bf16 v[84:87], v[116:119], a[128:131], v[84:87]
  ds_read_b64_tr_b16 v[164:165], v12 offset:16640
  ds_read_b64_tr_b16 v[166:167], v13 offset:16640
  v_mfma_f32_16x16x32_bf16 v[100:103], v[116:119], a[136:139], v[100:103]
  ds_read_b64_tr_b16 v[168:169], v12 offset:18688
  ds_read_b64_tr_b16 v[170:171], v13 offset:18688
  v_mfma_f32_16x16x32_bf16 v[104:107], v[120:123], a[136:139], v[104:107]
  ds_read_b64_tr_b16 v[172:173], v12 offset:20736
  ds_read_b64_tr_b16 v[174:175], v13 offset:20736
  v_mfma_f32_16x16x32_bf16 v[88:91], v[120:123], a[128:131], v[88:91]
  ds_read_b64_tr_b16 v[176:177], v12 offset:22784
  ds_read_b64_tr_b16 v[178:179], v13 offset:22784
  v_mfma_f32_16x16x32_bf16 v[76:79], v[124:127], a[132:135], v[76:79]
  s_add_u32 m0, s7, 98304
  s_nop 0
  buffer_load_dwordx4 v10, s[8:11], s6 offen offset:0 sc1 lds
  s_waitcnt lgkmcnt(15)
  v_mfma_f32_16x16x32_bf16 v[32:35], v[28:31], v[128:131], 0
  s_waitcnt lgkmcnt(15)
  v_mfma_f32_16x16x32_bf16 v[48:51], v[28:31], v[212:215], 0
  v_mfma_f32_16x16x32_bf16 v[92:95], v[124:127], a[140:143], v[92:95]
  v_mfma_f32_16x16x32_bf16 v[36:39], v[68:71], v[128:131], 0
  v_mfma_f32_16x16x32_bf16 v[52:55], v[68:71], v[212:215], 0
  v_mfma_f32_16x16x32_bf16 v[96:99], v[136:139], a[140:143], v[96:99]
  buffer_load_dwordx4 v10, s[8:11], s6 offen offset:1024 sc1 lds
  s_waitcnt lgkmcnt(15)
  v_mfma_f32_16x16x32_bf16 v[32:35], v[56:59], v[132:135], v[32:35]
  s_waitcnt lgkmcnt(15)
  v_mfma_f32_16x16x32_bf16 v[48:51], v[56:59], v[216:219], v[48:51]
  v_mfma_f32_16x16x32_bf16 v[80:83], v[136:139], a[132:135], v[80:83]
  v_mfma_f32_16x16x32_bf16 v[36:39], v[72:75], v[132:135], v[36:39]
  v_mfma_f32_16x16x32_bf16 v[52:55], v[72:75], v[216:219], v[52:55]
  v_mfma_f32_16x16x32_bf16 v[84:87], v[140:143], a[132:135], v[84:87]
  buffer_load_dwordx4 v10, s[8:11], s6 offen offset:2048 sc1 lds
  s_waitcnt lgkmcnt(15)
  v_mfma_f32_16x16x32_bf16 v[32:35], v[60:63], v[188:191], v[32:35]
  s_waitcnt lgkmcnt(15)
  v_mfma_f32_16x16x32_bf16 v[48:51], v[60:63], v[220:223], v[48:51]
  v_mfma_f32_16x16x32_bf16 v[100:103], v[140:143], a[140:143], v[100:103]
  v_mfma_f32_16x16x32_bf16 v[36:39], v[180:183], v[188:191], v[36:39]
  v_mfma_f32_16x16x32_bf16 v[52:55], v[180:183], v[220:223], v[52:55]
  v_mfma_f32_16x16x32_bf16 v[104:107], v[144:147], a[140:143], v[104:107]
  buffer_load_dwordx4 v10, s[8:11], s6 offen offset:3072 sc1 lds
  s_waitcnt lgkmcnt(15)
  v_mfma_f32_16x16x32_bf16 v[32:35], v[64:67], v[192:195], v[32:35]
  s_waitcnt lgkmcnt(15)
  v_mfma_f32_16x16x32_bf16 v[48:51], v[64:67], v[224:227], v[48:51]
  v_mfma_f32_16x16x32_bf16 v[88:91], v[144:147], a[132:135], v[88:91]
  v_mfma_f32_16x16x32_bf16 v[36:39], v[184:187], v[192:195], v[36:39]
  v_mfma_f32_16x16x32_bf16 v[52:55], v[184:187], v[224:227], v[52:55]
  s_waitcnt vmcnt(12) lgkmcnt(0)
  s_barrier
  v_mfma_f32_16x16x32_bf16 v[76:79], v[148:151], a[144:147], v[76:79]
  ds_read_b64_tr_b16 v[108:109], v12 offset:32768
  ds_read_b64_tr_b16 v[110:111], v13 offset:32768
  v_mfma_f32_16x16x32_bf16 v[92:95], v[148:151], a[152:155], v[92:95]
  ds_read_b64_tr_b16 v[112:113], v12 offset:34816
  ds_read_b64_tr_b16 v[114:115], v13 offset:34816
  v_mfma_f32_16x16x32_bf16 v[96:99], v[152:155], a[152:155], v[96:99]
  ds_read_b64_tr_b16 v[116:117], v12 offset:36864
  ds_read_b64_tr_b16 v[118:119], v13 offset:36864
  v_mfma_f32_16x16x32_bf16 v[80:83], v[152:155], a[144:147], v[80:83]
  ds_read_b64_tr_b16 v[120:121], v12 offset:38912
  ds_read_b64_tr_b16 v[122:123], v13 offset:38912
  v_mfma_f32_16x16x32_bf16 v[84:87], v[156:159], a[144:147], v[84:87]
  ds_read_b64_tr_b16 v[124:125], v12 offset:33024
  ds_read_b64_tr_b16 v[126:127], v13 offset:33024
  v_mfma_f32_16x16x32_bf16 v[100:103], v[156:159], a[152:155], v[100:103]
  ds_read_b64_tr_b16 v[136:137], v12 offset:35072
  ds_read_b64_tr_b16 v[138:139], v13 offset:35072
  v_mfma_f32_16x16x32_bf16 v[104:107], v[160:163], a[152:155], v[104:107]
  ds_read_b64_tr_b16 v[140:141], v12 offset:37120
  ds_read_b64_tr_b16 v[142:143], v13 offset:37120
  v_mfma_f32_16x16x32_bf16 v[88:91], v[160:163], a[144:147], v[88:91]
  ds_read_b64_tr_b16 v[144:145], v12 offset:39168
  ds_read_b64_tr_b16 v[146:147], v13 offset:39168
  v_mfma_f32_16x16x32_bf16 v[76:79], v[164:167], a[148:151], v[76:79]
  s_add_u32 m0, s7, 102400
  s_nop 0
  buffer_load_dwordx4 v11, s[8:11], s6 offen offset:0 sc1 lds
  v_mfma_f32_16x16x32_bf16 v[92:95], v[164:167], a[156:159], v[92:95]
  v_mfma_f32_16x16x32_bf16 v[96:99], v[168:171], a[156:159], v[96:99]
  buffer_load_dwordx4 v11, s[8:11], s6 offen offset:1024 sc1 lds
  v_mfma_f32_16x16x32_bf16 v[80:83], v[168:171], a[148:151], v[80:83]
  v_mfma_f32_16x16x32_bf16 v[84:87], v[172:175], a[148:151], v[84:87]
  buffer_load_dwordx4 v11, s[8:11], s6 offen offset:2048 sc1 lds
  v_mfma_f32_16x16x32_bf16 v[100:103], v[172:175], a[156:159], v[100:103]
  v_mfma_f32_16x16x32_bf16 v[104:107], v[176:179], a[156:159], v[104:107]
  buffer_load_dwordx4 v11, s[8:11], s6 offen offset:3072 sc1 lds
  s_add_u32 s6, s6, 65536
  s_and_b32 s6, s6, 0x7ffff
  v_mfma_f32_16x16x32_bf16 v[88:91], v[176:179], a[148:151], v[88:91]
  s_waitcnt lgkmcnt(0)
  v_mfma_f32_16x16x32_bf16 v[76:79], v[108:111], a[160:163], v[76:79]
  ds_read_b64_tr_b16 v[148:149], v12 offset:49152
  ds_read_b64_tr_b16 v[150:151], v13 offset:49152
  v_mfma_f32_16x16x32_bf16 v[92:95], v[108:111], a[168:171], v[92:95]
  ds_read_b64_tr_b16 v[152:153], v12 offset:51200
  ds_read_b64_tr_b16 v[154:155], v13 offset:51200
  v_mfma_f32_16x16x32_bf16 v[96:99], v[112:115], a[168:171], v[96:99]
  ds_read_b64_tr_b16 v[156:157], v12 offset:53248
  ds_read_b64_tr_b16 v[158:159], v13 offset:53248
  v_mfma_f32_16x16x32_bf16 v[80:83], v[112:115], a[160:163], v[80:83]
  ds_read_b64_tr_b16 v[160:161], v12 offset:55296
  ds_read_b64_tr_b16 v[162:163], v13 offset:55296
  v_mfma_f32_16x16x32_bf16 v[84:87], v[116:119], a[160:163], v[84:87]
  ds_read_b64_tr_b16 v[164:165], v12 offset:49408
  ds_read_b64_tr_b16 v[166:167], v13 offset:49408
  v_mfma_f32_16x16x32_bf16 v[100:103], v[116:119], a[168:171], v[100:103]
  ds_read_b64_tr_b16 v[168:169], v12 offset:51456
  ds_read_b64_tr_b16 v[170:171], v13 offset:51456
  v_mfma_f32_16x16x32_bf16 v[104:107], v[120:123], a[168:171], v[104:107]
  ds_read_b64_tr_b16 v[172:173], v12 offset:53504
  ds_read_b64_tr_b16 v[174:175], v13 offset:53504
  v_mfma_f32_16x16x32_bf16 v[88:91], v[120:123], a[160:163], v[88:91]
  ds_read_b64_tr_b16 v[176:177], v12 offset:55552
  ds_read_b64_tr_b16 v[178:179], v13 offset:55552
  v_mfma_f32_16x16x32_bf16 v[76:79], v[124:127], a[164:167], v[76:79]
  v_mfma_f32_16x16x32_bf16 v[92:95], v[124:127], a[172:175], v[92:95]
  v_mfma_f32_16x16x32_bf16 v[96:99], v[136:139], a[172:175], v[96:99]
  v_mfma_f32_16x16x32_bf16 v[80:83], v[136:139], a[164:167], v[80:83]
  v_mfma_f32_16x16x32_bf16 v[84:87], v[140:143], a[164:167], v[84:87]
  v_mfma_f32_16x16x32_bf16 v[100:103], v[140:143], a[172:175], v[100:103]
  v_mfma_f32_16x16x32_bf16 v[104:107], v[144:147], a[172:175], v[104:107]
  v_mfma_f32_16x16x32_bf16 v[88:91], v[144:147], a[164:167], v[88:91]
  s_waitcnt vmcnt(8) lgkmcnt(0)
  s_barrier
  v_mfma_f32_16x16x32_bf16 v[76:79], v[148:151], a[176:179], v[76:79]
  ds_read_b64_tr_b16 v[108:109], v14 offset:0
  ds_read_b64_tr_b16 v[110:111], v15 offset:0
  v_sub_f32 v228, 1.0, v196
  v_sub_f32 v229, 1.0, v197
  v_cvt_pk_bf16_f32 v229, v228, v229
  v_lshlrev_b32 v228, 16, v229
  v_and_b32 v229, 0xffff0000, v229
  v_sub_f32 v230, 1.0, v198
  v_sub_f32 v231, 1.0, v199
  v_cvt_pk_bf16_f32 v231, v230, v231
  v_lshlrev_b32 v230, 16, v231
  v_and_b32 v231, 0xffff0000, v231
  v_pk_mul_f32 v[32:33], v[196:197], v[32:33]
  v_pk_fma_f32 v[16:17], v[228:229], v[16:17], v[32:33]
  v_pk_mul_f32 v[48:49], v[196:197], v[48:49]
  v_pk_fma_f32 v[40:41], v[228:229], v[40:41], v[48:49]
  buffer_store_dword v16, v9, s[44:47], s16 offen offset:0 sc1
  buffer_store_dword v40, v9, s[44:47], s16 offen offset:1024 sc1
  s_add_u32 s16, s16, 65536
  buffer_store_dword v17, v9, s[44:47], s16 offen offset:0 sc1
  buffer_store_dword v41, v9, s[44:47], s16 offen offset:1024 sc1
  s_add_u32 s16, s16, 65536
  v_pk_mul_f32 v[34:35], v[198:199], v[34:35]
  v_pk_fma_f32 v[18:19], v[230:231], v[18:19], v[34:35]
  v_pk_mul_f32 v[50:51], v[198:199], v[50:51]
  v_pk_fma_f32 v[42:43], v[230:231], v[42:43], v[50:51]
  v_mfma_f32_16x16x32_bf16 v[92:95], v[148:151], a[184:187], v[92:95]
  ds_read_b64_tr_b16 v[112:113], v14 offset:2048
  ds_read_b64_tr_b16 v[114:115], v15 offset:2048
  buffer_store_dword v18, v9, s[44:47], s16 offen offset:0 sc1
  buffer_store_dword v42, v9, s[44:47], s16 offen offset:1024 sc1
  s_add_u32 s16, s16, 65536
  buffer_store_dword v19, v9, s[44:47], s16 offen offset:0 sc1
  buffer_store_dword v43, v9, s[44:47], s16 offen offset:1024 sc1
  s_add_u32 s16, s16, 851968
  v_sub_f32 v228, 1.0, v200
  v_sub_f32 v229, 1.0, v201
  v_cvt_pk_bf16_f32 v229, v228, v229
  v_lshlrev_b32 v228, 16, v229
  v_and_b32 v229, 0xffff0000, v229
  v_sub_f32 v230, 1.0, v202
  v_sub_f32 v231, 1.0, v203
  v_cvt_pk_bf16_f32 v231, v230, v231
  v_lshlrev_b32 v230, 16, v231
  v_and_b32 v231, 0xffff0000, v231
  v_pk_mul_f32 v[36:37], v[200:201], v[36:37]
  v_pk_fma_f32 v[20:21], v[228:229], v[20:21], v[36:37]
  v_pk_mul_f32 v[52:53], v[200:201], v[52:53]
  v_pk_fma_f32 v[44:45], v[228:229], v[44:45], v[52:53]
  buffer_store_dword v20, v9, s[44:47], s16 offen offset:0 sc1
  buffer_store_dword v44, v9, s[44:47], s16 offen offset:1024 sc1
  s_add_u32 s16, s16, 65536
  buffer_store_dword v21, v9, s[44:47], s16 offen offset:0 sc1
  v_mfma_f32_16x16x32_bf16 v[96:99], v[152:155], a[184:187], v[96:99]
  ds_read_b64_tr_b16 v[116:117], v14 offset:4096
  ds_read_b64_tr_b16 v[118:119], v15 offset:4096
  buffer_store_dword v45, v9, s[44:47], s16 offen offset:1024 sc1
  s_add_u32 s16, s16, 65536
  v_pk_mul_f32 v[38:39], v[202:203], v[38:39]
  v_pk_fma_f32 v[22:23], v[230:231], v[22:23], v[38:39]
  v_pk_mul_f32 v[54:55], v[202:203], v[54:55]
  v_pk_fma_f32 v[46:47], v[230:231], v[46:47], v[54:55]
  buffer_store_dword v22, v9, s[44:47], s16 offen offset:0 sc1
  buffer_store_dword v46, v9, s[44:47], s16 offen offset:1024 sc1
  s_add_u32 s16, s16, 65536
  buffer_store_dword v23, v9, s[44:47], s16 offen offset:0 sc1
  buffer_store_dword v47, v9, s[44:47], s16 offen offset:1024 sc1
  s_add_u32 s16, s16, 2949120
  v_xor_b32 v29, 0x80008000, v29
  v_xor_b32 v31, 0x80008000, v31
  v_xor_b32 v57, 0x80008000, v57
  v_xor_b32 v59, 0x80008000, v59
  v_xor_b32 v61, 0x80008000, v61
  v_xor_b32 v63, 0x80008000, v63
  v_xor_b32 v65, 0x80008000, v65
  v_xor_b32 v67, 0x80008000, v67
  v_xor_b32 v69, 0x80008000, v69
  v_xor_b32 v71, 0x80008000, v71
  v_xor_b32 v73, 0x80008000, v73
  v_xor_b32 v75, 0x80008000, v75
  v_mfma_f32_16x16x32_bf16 v[80:83], v[152:155], a[176:179], v[80:83]
  ds_read_b64_tr_b16 v[120:121], v14 offset:6144
  ds_read_b64_tr_b16 v[122:123], v15 offset:6144
  v_xor_b32 v181, 0x80008000, v181
  v_xor_b32 v183, 0x80008000, v183
  v_xor_b32 v185, 0x80008000, v185
  v_xor_b32 v187, 0x80008000, v187
  v_mfma_f32_16x16x32_bf16 v[84:87], v[156:159], a[176:179], v[84:87]
  ds_read_b64_tr_b16 v[124:125], v14 offset:256
  ds_read_b64_tr_b16 v[126:127], v15 offset:256
  v_mfma_f32_16x16x32_bf16 v[100:103], v[156:159], a[184:187], v[100:103]
  ds_read_b64_tr_b16 v[136:137], v14 offset:2304
  ds_read_b64_tr_b16 v[138:139], v15 offset:2304
  v_mfma_f32_16x16x32_bf16 v[104:107], v[160:163], a[184:187], v[104:107]
  ds_read_b64_tr_b16 v[140:141], v14 offset:4352
  ds_read_b64_tr_b16 v[142:143], v15 offset:4352
  v_mfma_f32_16x16x32_bf16 v[88:91], v[160:163], a[176:179], v[88:91]
  ds_read_b64_tr_b16 v[144:145], v14 offset:6400
  ds_read_b64_tr_b16 v[146:147], v15 offset:6400
  v_mfma_f32_16x16x32_bf16 v[76:79], v[164:167], a[180:183], v[76:79]
  v_mfma_f32_16x16x32_bf16 v[92:95], v[164:167], a[188:191], v[92:95]
  v_mfma_f32_16x16x32_bf16 v[96:99], v[168:171], a[188:191], v[96:99]
  v_mfma_f32_16x16x32_bf16 v[80:83], v[168:171], a[180:183], v[80:83]
  v_mfma_f32_16x16x32_bf16 v[84:87], v[172:175], a[180:183], v[84:87]
  v_mfma_f32_16x16x32_bf16 v[100:103], v[172:175], a[188:191], v[100:103]
  v_mfma_f32_16x16x32_bf16 v[104:107], v[176:179], a[188:191], v[104:107]
  v_mfma_f32_16x16x32_bf16 v[88:91], v[176:179], a[180:183], v[88:91]
  s_waitcnt lgkmcnt(0)
  v_mfma_f32_16x16x32_bf16 v[76:79], v[108:111], a[192:195], v[76:79]
  ds_read_b64_tr_b16 v[148:149], v14 offset:16384
  ds_read_b64_tr_b16 v[150:151], v15 offset:16384
  v_mfma_f32_16x16x32_bf16 v[92:95], v[108:111], a[200:203], v[92:95]
  ds_read_b64_tr_b16 v[152:153], v14 offset:18432
  ds_read_b64_tr_b16 v[154:155], v15 offset:18432
  v_mfma_f32_16x16x32_bf16 v[96:99], v[112:115], a[200:203], v[96:99]
  ds_read_b64_tr_b16 v[156:157], v14 offset:20480
  ds_read_b64_tr_b16 v[158:159], v15 offset:20480
  v_mfma_f32_16x16x32_bf16 v[80:83], v[112:115], a[192:195], v[80:83]
  ds_read_b64_tr_b16 v[160:161], v14 offset:22528
  ds_read_b64_tr_b16 v[162:163], v15 offset:22528
  v_mfma_f32_16x16x32_bf16 v[84:87], v[116:119], a[192:195], v[84:87]
  ds_read_b64_tr_b16 v[164:165], v14 offset:16640
  ds_read_b64_tr_b16 v[166:167], v15 offset:16640
  v_mfma_f32_16x16x32_bf16 v[100:103], v[116:119], a[200:203], v[100:103]
  ds_read_b64_tr_b16 v[168:169], v14 offset:18688
  ds_read_b64_tr_b16 v[170:171], v15 offset:18688
  v_mfma_f32_16x16x32_bf16 v[104:107], v[120:123], a[200:203], v[104:107]
  ds_read_b64_tr_b16 v[172:173], v14 offset:20736
  ds_read_b64_tr_b16 v[174:175], v15 offset:20736
  v_mfma_f32_16x16x32_bf16 v[88:91], v[120:123], a[192:195], v[88:91]
  ds_read_b64_tr_b16 v[176:177], v14 offset:22784
  ds_read_b64_tr_b16 v[178:179], v15 offset:22784
  v_mfma_f32_16x16x32_bf16 v[76:79], v[124:127], a[196:199], v[76:79]
  v_mfma_f32_16x16x32_bf16 v[92:95], v[124:127], a[204:207], v[92:95]
  v_mfma_f32_16x16x32_bf16 v[96:99], v[136:139], a[204:207], v[96:99]
  v_mfma_f32_16x16x32_bf16 v[80:83], v[136:139], a[196:199], v[80:83]
  v_mfma_f32_16x16x32_bf16 v[84:87], v[140:143], a[196:199], v[84:87]
  v_mfma_f32_16x16x32_bf16 v[100:103], v[140:143], a[204:207], v[100:103]
  v_mfma_f32_16x16x32_bf16 v[104:107], v[144:147], a[204:207], v[104:107]
  v_mfma_f32_16x16x32_bf16 v[88:91], v[144:147], a[196:199], v[88:91]
  s_waitcnt vmcnt(16) lgkmcnt(0)
  s_barrier
  v_mfma_f32_16x16x32_bf16 v[76:79], v[148:151], a[208:211], v[76:79]
  ds_read_b64_tr_b16 v[108:109], v14 offset:32768
  ds_read_b64_tr_b16 v[110:111], v15 offset:32768
  v_mfma_f32_16x16x32_bf16 v[92:95], v[148:151], a[216:219], v[92:95]
  ds_read_b64_tr_b16 v[112:113], v14 offset:34816
  ds_read_b64_tr_b16 v[114:115], v15 offset:34816
  v_mfma_f32_16x16x32_bf16 v[96:99], v[152:155], a[216:219], v[96:99]
  ds_read_b64_tr_b16 v[116:117], v14 offset:36864
  ds_read_b64_tr_b16 v[118:119], v15 offset:36864
  v_mfma_f32_16x16x32_bf16 v[80:83], v[152:155], a[208:211], v[80:83]
  ds_read_b64_tr_b16 v[120:121], v14 offset:38912
  ds_read_b64_tr_b16 v[122:123], v15 offset:38912
  v_mfma_f32_16x16x32_bf16 v[84:87], v[156:159], a[208:211], v[84:87]
  ds_read_b64_tr_b16 v[124:125], v14 offset:33024
  ds_read_b64_tr_b16 v[126:127], v15 offset:33024
  v_mfma_f32_16x16x32_bf16 v[100:103], v[156:159], a[216:219], v[100:103]
  ds_read_b64_tr_b16 v[136:137], v14 offset:35072
  ds_read_b64_tr_b16 v[138:139], v15 offset:35072
  v_mfma_f32_16x16x32_bf16 v[104:107], v[160:163], a[216:219], v[104:107]
  ds_read_b64_tr_b16 v[140:141], v14 offset:37120
  ds_read_b64_tr_b16 v[142:143], v15 offset:37120
  v_mfma_f32_16x16x32_bf16 v[88:91], v[160:163], a[208:211], v[88:91]
  ds_read_b64_tr_b16 v[144:145], v14 offset:39168
  ds_read_b64_tr_b16 v[146:147], v15 offset:39168
  v_mfma_f32_16x16x32_bf16 v[76:79], v[164:167], a[212:215], v[76:79]
  v_mfma_f32_16x16x32_bf16 v[92:95], v[164:167], a[220:223], v[92:95]
  v_mfma_f32_16x16x32_bf16 v[96:99], v[168:171], a[220:223], v[96:99]
  v_mfma_f32_16x16x32_bf16 v[80:83], v[168:171], a[212:215], v[80:83]
  v_mfma_f32_16x16x32_bf16 v[84:87], v[172:175], a[212:215], v[84:87]
  v_mfma_f32_16x16x32_bf16 v[100:103], v[172:175], a[220:223], v[100:103]
  v_mfma_f32_16x16x32_bf16 v[104:107], v[176:179], a[220:223], v[104:107]
  v_mfma_f32_16x16x32_bf16 v[88:91], v[176:179], a[212:215], v[88:91]
  s_waitcnt lgkmcnt(0)
  v_mfma_f32_16x16x32_bf16 v[76:79], v[108:111], a[224:227], v[76:79]
  ds_read_b64_tr_b16 v[148:149], v14 offset:49152
  ds_read_b64_tr_b16 v[150:151], v15 offset:49152
  v_mfma_f32_16x16x32_bf16 v[92:95], v[108:111], a[232:235], v[92:95]
  ds_read_b64_tr_b16 v[152:153], v14 offset:51200
  ds_read_b64_tr_b16 v[154:155], v15 offset:51200
  v_mfma_f32_16x16x32_bf16 v[96:99], v[112:115], a[232:235], v[96:99]
  ds_read_b64_tr_b16 v[156:157], v14 offset:53248
  ds_read_b64_tr_b16 v[158:159], v15 offset:53248
  v_mfma_f32_16x16x32_bf16 v[80:83], v[112:115], a[224:227], v[80:83]
  ds_read_b64_tr_b16 v[160:161], v14 offset:55296
  ds_read_b64_tr_b16 v[162:163], v15 offset:55296
  v_mfma_f32_16x16x32_bf16 v[84:87], v[116:119], a[224:227], v[84:87]
  ds_read_b64_tr_b16 v[164:165], v14 offset:49408
  ds_read_b64_tr_b16 v[166:167], v15 offset:49408
  v_mfma_f32_16x16x32_bf16 v[100:103], v[116:119], a[232:235], v[100:103]
  ds_read_b64_tr_b16 v[168:169], v14 offset:51456
  ds_read_b64_tr_b16 v[170:171], v15 offset:51456
  v_mfma_f32_16x16x32_bf16 v[104:107], v[120:123], a[232:235], v[104:107]
  ds_read_b64_tr_b16 v[172:173], v14 offset:53504
  ds_read_b64_tr_b16 v[174:175], v15 offset:53504
  v_mfma_f32_16x16x32_bf16 v[88:91], v[120:123], a[224:227], v[88:91]
  ds_read_b64_tr_b16 v[176:177], v14 offset:55552
  ds_read_b64_tr_b16 v[178:179], v15 offset:55552
  v_mfma_f32_16x16x32_bf16 v[76:79], v[124:127], a[228:231], v[76:79]
  v_mfma_f32_16x16x32_bf16 v[92:95], v[124:127], a[236:239], v[92:95]
  v_mfma_f32_16x16x32_bf16 v[96:99], v[136:139], a[236:239], v[96:99]
  v_mfma_f32_16x16x32_bf16 v[80:83], v[136:139], a[228:231], v[80:83]
  v_mfma_f32_16x16x32_bf16 v[84:87], v[140:143], a[228:231], v[84:87]
  v_mfma_f32_16x16x32_bf16 v[100:103], v[140:143], a[236:239], v[100:103]
  v_mfma_f32_16x16x32_bf16 v[104:107], v[144:147], a[236:239], v[104:107]
  v_mfma_f32_16x16x32_bf16 v[88:91], v[144:147], a[228:231], v[88:91]
  s_waitcnt lgkmcnt(0)
  v_mfma_f32_16x16x32_bf16 v[84:87], v[156:159], a[240:243], v[84:87]
  v_mfma_f32_16x16x32_bf16 v[100:103], v[156:159], a[248:251], v[100:103]
  v_mfma_f32_16x16x32_bf16 v[104:107], v[160:163], a[248:251], v[104:107]
  v_mfma_f32_16x16x32_bf16 v[88:91], v[160:163], a[240:243], v[88:91]
  v_mfma_f32_16x16x32_bf16 v[84:87], v[172:175], a[244:247], v[84:87]
  v_mfma_f32_16x16x32_bf16 v[100:103], v[172:175], a[252:255], v[100:103]
  v_mfma_f32_16x16x32_bf16 v[104:107], v[176:179], a[252:255], v[104:107]
  v_mfma_f32_16x16x32_bf16 v[88:91], v[176:179], a[244:247], v[88:91]
  v_mfma_f32_16x16x32_bf16 v[76:79], v[148:151], a[240:243], v[76:79]
  v_mfma_f32_16x16x32_bf16 v[92:95], v[148:151], a[248:251], v[92:95]
  v_mfma_f32_16x16x32_bf16 v[96:99], v[152:155], a[248:251], v[96:99]
  v_mfma_f32_16x16x32_bf16 v[80:83], v[152:155], a[240:243], v[80:83]
  v_mfma_f32_16x16x32_bf16 v[76:79], v[164:167], a[244:247], v[76:79]
  v_mfma_f32_16x16x32_bf16 v[92:95], v[164:167], a[252:255], v[92:95]
  v_mfma_f32_16x16x32_bf16 v[96:99], v[168:171], a[252:255], v[96:99]
  v_mfma_f32_16x16x32_bf16 v[80:83], v[168:171], a[244:247], v[80:83]
  v_mfma_f32_16x16x32_bf16 v[32:35], v[28:31], v[128:131], 0
  ds_write_b128 v2, v[84:87] offset:0
  v_mfma_f32_16x16x32_bf16 v[48:51], v[28:31], v[212:215], 0
  v_mfma_f32_16x16x32_bf16 v[36:39], v[68:71], v[128:131], 0
  ds_write_b128 v2, v[100:103] offset:2048
  v_mfma_f32_16x16x32_bf16 v[52:55], v[68:71], v[212:215], 0
  v_mfma_f32_16x16x32_bf16 v[32:35], v[56:59], v[132:135], v[32:35]
  ds_write_b128 v2, v[88:91] offset:1024
  v_mfma_f32_16x16x32_bf16 v[48:51], v[56:59], v[216:219], v[48:51]
  v_mfma_f32_16x16x32_bf16 v[36:39], v[72:75], v[132:135], v[36:39]
  ds_write_b128 v2, v[104:107] offset:3072
  v_mfma_f32_16x16x32_bf16 v[52:55], v[72:75], v[216:219], v[52:55]
  v_xor_b32 v2, 0x1000, v2
  s_waitcnt lgkmcnt(0)
  s_barrier
  v_mfma_f32_16x16x32_bf16 v[32:35], v[60:63], v[188:191], v[32:35]
  ds_read_b128 v[84:87], v2 offset:0
  v_mfma_f32_16x16x32_bf16 v[48:51], v[60:63], v[220:223], v[48:51]
  ds_read_b128 v[100:103], v2 offset:2048
  v_mfma_f32_16x16x32_bf16 v[36:39], v[180:183], v[188:191], v[36:39]
  ds_read_b128 v[88:91], v2 offset:1024
  v_mfma_f32_16x16x32_bf16 v[52:55], v[180:183], v[220:223], v[52:55]
  ds_read_b128 v[104:107], v2 offset:3072
  v_mfma_f32_16x16x32_bf16 v[32:35], v[64:67], v[192:195], v[32:35]
  v_mfma_f32_16x16x32_bf16 v[48:51], v[64:67], v[224:227], v[48:51]
  v_mfma_f32_16x16x32_bf16 v[36:39], v[184:187], v[192:195], v[36:39]
  v_mfma_f32_16x16x32_bf16 v[52:55], v[184:187], v[224:227], v[52:55]
  v_sub_f32 v12, 1.0, v204
  v_sub_f32 v13, 1.0, v205
  v_cvt_pk_bf16_f32 v13, v12, v13
  v_lshlrev_b32 v12, 16, v13
  v_and_b32 v13, 0xffff0000, v13
  v_sub_f32 v14, 1.0, v206
  v_sub_f32 v15, 1.0, v207
  v_cvt_pk_bf16_f32 v15, v14, v15
  v_lshlrev_b32 v14, 16, v15
  v_and_b32 v15, 0xffff0000, v15
  v_pk_mul_f32 v[32:33], v[204:205], v[32:33]
  s_waitcnt lgkmcnt(3)
  v_pk_add_f32 v[76:77], v[76:77], v[84:85]
  v_pk_fma_f32 v[76:77], v[12:13], v[76:77], v[32:33]
  v_pk_mul_f32 v[48:49], v[204:205], v[48:49]
  s_waitcnt lgkmcnt(2)
  v_pk_add_f32 v[92:93], v[92:93], v[100:101]
  v_pk_fma_f32 v[92:93], v[12:13], v[92:93], v[48:49]
  buffer_store_dword v76, v9, s[44:47], s16 offen offset:0 sc1
  buffer_store_dword v92, v9, s[44:47], s16 offen offset:1024 sc1
  s_add_u32 s16, s16, 65536
  buffer_store_dword v77, v9, s[44:47], s16 offen offset:0 sc1
  buffer_store_dword v93, v9, s[44:47], s16 offen offset:1024 sc1
  s_add_u32 s16, s16, 65536
  v_pk_mul_f32 v[34:35], v[206:207], v[34:35]
  v_pk_add_f32 v[78:79], v[78:79], v[86:87]
  v_pk_fma_f32 v[78:79], v[14:15], v[78:79], v[34:35]
  v_pk_mul_f32 v[50:51], v[206:207], v[50:51]
  v_pk_add_f32 v[94:95], v[94:95], v[102:103]
  v_pk_fma_f32 v[94:95], v[14:15], v[94:95], v[50:51]
  buffer_store_dword v78, v9, s[44:47], s16 offen offset:0 sc1
  buffer_store_dword v94, v9, s[44:47], s16 offen offset:1024 sc1
  s_add_u32 s16, s16, 65536
  buffer_store_dword v79, v9, s[44:47], s16 offen offset:0 sc1
  buffer_store_dword v95, v9, s[44:47], s16 offen offset:1024 sc1
  s_add_u32 s16, s16, 851968
  v_sub_f32 v12, 1.0, v208
  v_sub_f32 v13, 1.0, v209
  v_cvt_pk_bf16_f32 v13, v12, v13
  v_lshlrev_b32 v12, 16, v13
  v_and_b32 v13, 0xffff0000, v13
  v_sub_f32 v14, 1.0, v210
  v_sub_f32 v15, 1.0, v211
  v_cvt_pk_bf16_f32 v15, v14, v15
  v_lshlrev_b32 v14, 16, v15
  v_and_b32 v15, 0xffff0000, v15
  v_pk_mul_f32 v[36:37], v[208:209], v[36:37]
  s_waitcnt lgkmcnt(1)
  v_pk_add_f32 v[80:81], v[80:81], v[88:89]
  v_pk_fma_f32 v[80:81], v[12:13], v[80:81], v[36:37]
  v_pk_mul_f32 v[52:53], v[208:209], v[52:53]
  s_waitcnt lgkmcnt(0)
  v_pk_add_f32 v[96:97], v[96:97], v[104:105]
  v_pk_fma_f32 v[96:97], v[12:13], v[96:97], v[52:53]
  buffer_store_dword v80, v9, s[44:47], s16 offen offset:0 sc1
  buffer_store_dword v96, v9, s[44:47], s16 offen offset:1024 sc1
  s_add_u32 s16, s16, 65536
  buffer_store_dword v81, v9, s[44:47], s16 offen offset:0 sc1
  buffer_store_dword v97, v9, s[44:47], s16 offen offset:1024 sc1
  s_add_u32 s16, s16, 65536
  v_pk_mul_f32 v[38:39], v[210:211], v[38:39]
  v_pk_add_f32 v[82:83], v[82:83], v[90:91]
  v_pk_fma_f32 v[82:83], v[14:15], v[82:83], v[38:39]
  v_pk_mul_f32 v[54:55], v[210:211], v[54:55]
  v_pk_add_f32 v[98:99], v[98:99], v[106:107]
  v_pk_fma_f32 v[98:99], v[14:15], v[98:99], v[54:55]
  buffer_store_dword v82, v9, s[44:47], s16 offen offset:0 sc1
  buffer_store_dword v98, v9, s[44:47], s16 offen offset:1024 sc1
  s_add_u32 s16, s16, 65536
  buffer_store_dword v83, v9, s[44:47], s16 offen offset:0 sc1
  buffer_store_dword v99, v9, s[44:47], s16 offen offset:1024 sc1
gated_mix__spectral_gfnet__ssm_conv_s5__prompt_kernel_end:
  s_endpgm
.section .rodata,"a"
.p2align 6
.amdhsa_kernel gated_mix__spectral_gfnet__ssm_conv_s5__prompt_kernel
  .amdhsa_next_free_vgpr 508
  .amdhsa_next_free_sgpr 102
  .amdhsa_accum_offset 252
  .amdhsa_group_segment_fixed_size 0
  .amdhsa_kernarg_size 128
  .amdhsa_user_sgpr_count 2
  .amdhsa_user_sgpr_kernarg_segment_ptr 1
  .amdhsa_system_sgpr_workgroup_id_x 1
  .amdhsa_float_denorm_mode_32 3
.end_amdhsa_kernel
```

```asm
; @launch grid=(256,1,1) block=(256,1,1) lds=163840
.amdgcn_target "amdgcn-amd-amdhsa--gfx950"
.text
.p2align 8
.globl gated_mix__spectral_gfnet__ssm_conv_s5__prompt_kernel
.type gated_mix__spectral_gfnet__ssm_conv_s5__prompt_kernel,@function
gated_mix__spectral_gfnet__ssm_conv_s5__prompt_kernel:
  s_cmp_ge_u32 s2, 256
  s_cbranch_scc1 gated_mix__spectral_gfnet__ssm_conv_s5__prompt_kernel_end
  s_load_dwordx16 s[4:19], s[0:1], 0
  s_load_dwordx16 s[20:35], s[0:1], 64
  v_readfirstlane_b32 s3, v0
  v_and_b32 v1, 63, v0
  v_and_b32 v2, 15, v0
  v_bfe_u32 v3, v0, 4, 2
  s_bfe_u32 s36, s2, 0x20003
  s_lshr_b32 s43, s2, 5
  s_lshr_b32 s3, s3, 6
  s_and_b32 s38, s2, 3
  s_lshl2_add_u32 s38, s38, s36
  s_bfe_u32 s39, s2, 0x10002
  s_lshl3_add_u32 s39, s39, s43
  s_and_b32 s42, s2, 1
  s_lshl3_add_u32 s40, s42, s43
  s_lshl1_add_u32 s42, s43, s42
  s_bfe_u32 s41, s2, 0x20001
  s_lshl2_add_u32 s41, s41, s36
  s_and_b32 s37, s2, 7
  s_lshl3_add_u32 s37, s37, s43
  s_cmp_lg_u32 s3, 0
  s_cbranch_scc1 gated_mix__spectral_gfnet__ssm_conv_s5__prompt_kernel_skip2
  s_getpc_b64 s[44:45]
gated_mix__spectral_gfnet__ssm_conv_s5__prompt_kernel_pc1:
  s_lshr_b32 s43, s2, 3
  s_mul_i32 s43, s43, 1280
  v_min_u32 v6, 9, v1
  v_lshl_add_u32 v6, v6, 7, s43
  v_min_u32 v6, gated_mix__spectral_gfnet__ssm_conv_s5__prompt_kernel_end-gated_mix__spectral_gfnet__ssm_conv_s5__prompt_kernel_pc1, v6
  v_mov_b32 v7, 0
  v_lshl_add_u64 v[6:7], v[6:7], 0, s[44:45]
  global_load_dword v4, v[6:7], off
gated_mix__spectral_gfnet__ssm_conv_s5__prompt_kernel_skip2:
  s_mov_b32 s46, 4194304
  s_mov_b32 s47, 0x20000
  s_mov_b32 s50, 2097152
  s_mov_b32 s51, 0x20000
  v_bfe_u32 v6, v1, 1, 2
  v_xor_b32 v6, v6, v3
  v_lshlrev_b32 v5, 9, v6
  v_and_b32 v6, 1, v1
  v_lshl_or_b32 v5, v6, 4, v5
  v_lshrrev_b32 v6, 3, v1
  v_lshl_or_b32 v5, v6, 15, v5
  s_lshl_b32 s43, s3, 9
  s_add_u32 s43, s43, s40
  s_lshl_b32 s43, s43, 6
  s_add_u32 s43, s43, s41
  s_lshl_b32 s43, s43, 5
  s_lshl_b32 m0, s3, 12
  s_add_u32 m0, m0, 131072
  v_and_b32 v6, 7, v1
  v_xor_b32 v6, v6, v3
  v_lshlrev_b32 v6, 4, v6
  v_lshrrev_b32 v7, 3, v1
  v_lshl_or_b32 v12, v7, 11, v6
  v_and_b32 v7, 32, v1
  v_lshl_or_b32 v8, v7, 11, v6
  v_and_b32 v7, 8, v1
  v_lshl_or_b32 v8, v7, 12, v8
  v_and_b32 v7, 16, v1
  v_lshl_or_b32 v8, v7, 7, v8
  s_lshr_b32 s53, s3, 1
  s_lshl1_add_u32 s54, s39, s53
  s_lshl_b32 s54, s54, 16
  v_add_u32 v12, s54, v12
  s_lshl1_add_u32 s54, s38, s53
  s_and_b32 s53, s3, 1
  s_lshl3_add_u32 s54, s54, s53
  s_lshl_b32 s54, s54, 14
  v_add_u32 v8, s54, v8
  v_xor_b32 v9, 64, v8
  v_xor_b32 v13, 64, v12
  v_add_u32 v9, 3072, v9
  v_add_u32 v13, 15360, v13
  v_add_u32 v10, 6144, v8
  v_add_u32 v14, 30720, v12
  v_add_u32 v11, 6144, v9
  v_add_u32 v15, 30720, v13
  s_lshl_b32 s54, s3, 12
  s_add_u32 s55, s54, 65536
  s_lshl_b32 s52, s38, 7
  v_bfe_u32 v6, v1, 1, 3
  v_lshrrev_b32 v7, 5, v1
  v_xor_b32 v6, v6, v7
  v_lshlrev_b32 v6, 4, v6
  v_and_b32 v7, 31, v1
  v_lshl_or_b32 v6, v7, 7, v6
  s_lshr_b32 s53, s3, 1
  v_lshl_add_u32 v16, s53, 13, v6
  s_and_b32 s53, s3, 1
  s_or_b32 s53, s53, 8
  v_lshl_add_u32 v20, s53, 13, v6
  v_xor_b32 v17, 32, v16
  v_xor_b32 v21, 32, v20
  v_xor_b32 v18, 64, v16
  v_xor_b32 v22, 64, v20
  v_xor_b32 v19, 96, v16
  v_xor_b32 v23, 96, v20
  s_waitcnt lgkmcnt(0)
  s_mov_b64 s[44:45], s[4:5]
  buffer_load_dwordx4 v5, s[44:47], s43 offen offset:0 lds
  s_add_u32 s43, s43, 261120
  buffer_load_dwordx4 v5, s[44:47], s43 offen offset:1024 lds
  s_add_u32 s43, s43, 261120
  buffer_load_dwordx4 v5, s[44:47], s43 offen offset:2048 lds
  s_add_u32 s43, s43, 261120
  buffer_load_dwordx4 v5, s[44:47], s43 offen offset:3072 lds
  s_bitcmp1_b32 s3, 0
  s_cselect_b64 s[48:49], s[18:19], s[16:17]
  s_lshl_b32 s11, s37, 2
  s_add_u32 s11, s11, s36
  s_cmp_eq_u32 s11, 3
  s_cselect_b32 s4, 1, s36
  s_cselect_b32 s5, 64, s37
  s_and_b32 s10, s11, 0xfd
  s_cmp_eq_u32 s10, 0
  s_cselect_b32 s10, 1, 0
  v_cvt_f32_u32 v6, v2
  v_cvt_f32_u32 v7, v3
  v_mul_f32 v7, 4.0, v7
  s_cmp_lg_u32 s3, 0
  s_cbranch_scc1 gated_mix__spectral_gfnet__ssm_conv_s5__prompt_kernel_skip3
  v_cvt_f32_u32 v51, s10
  v_mul_f32 v51, 0xc4700000, v51
  v_cmp_lt_u32 vcc, 7, v2
  v_cvt_f32_u32 v50, s5
  s_nop 0
  v_cndmask_b32 v51, 0, v51, vcc
  v_add_f32 v50, v50, v51
  v_fmamk_f32 v48, v6, 0x43000000, v50
  v_mul_f32 v48, 0x3a000000, v48
  v_mul_f32 v49, v48, v7
  v_fmamk_f32 v40, v48, 0x0, v49
  v_fmamk_f32 v41, v48, 0x3f800000, v49
  v_fmamk_f32 v42, v48, 0x40000000, v49
  v_fmamk_f32 v43, v48, 0x40400000, v49
  v_cos_f32 v44, v40
  v_cos_f32 v45, v41
  v_cos_f32 v46, v42
  v_cos_f32 v47, v43
  v_sin_f32 v40, v40
  v_sin_f32 v41, v41
  v_sin_f32 v42, v42
  v_sin_f32 v43, v43
  v_cvt_pk_bf16_f32 v24, v44, v40
  v_cvt_pk_bf16_f32 v28, -v40, v44
  v_cvt_pk_bf16_f32 v25, v45, v41
  v_cvt_pk_bf16_f32 v29, -v41, v45
  v_cvt_pk_bf16_f32 v26, v46, v42
  v_cvt_pk_bf16_f32 v30, -v42, v46
  v_cvt_pk_bf16_f32 v27, v47, v43
  v_cvt_pk_bf16_f32 v31, -v43, v47
  v_xor_b32 v50, 3, v2
  v_cndmask_b32 v50, v2, v50, vcc
  v_cvt_f32_u32 v48, v50
  v_mul_f32 v48, 0x3d800000, v48
  v_mul_f32 v49, v48, v7
  v_fmamk_f32 v40, v48, 0x0, v49
  v_fmamk_f32 v41, v48, 0x3f800000, v49
  v_fmamk_f32 v42, v48, 0x40000000, v49
  v_fmamk_f32 v43, v48, 0x40400000, v49
  v_cos_f32 v44, v40
  v_cos_f32 v45, v41
  v_cos_f32 v46, v42
  v_cos_f32 v47, v43
  v_sin_f32 v40, v40
  v_sin_f32 v41, v41
  v_sin_f32 v42, v42
  v_sin_f32 v43, v43
  v_cvt_pk_bf16_f32 v32, v44, v40
  v_cvt_pk_bf16_f32 v36, -v40, v44
  v_cvt_pk_bf16_f32 v33, v45, v41
  v_cvt_pk_bf16_f32 v37, -v41, v45
  v_cvt_pk_bf16_f32 v34, v46, v42
  v_cvt_pk_bf16_f32 v38, -v42, v46
  v_cvt_pk_bf16_f32 v35, v47, v43
  v_cvt_pk_bf16_f32 v39, -v43, v47
  s_cmp_eq_u32 s10, 0
  s_cbranch_scc1 gated_mix__spectral_gfnet__ssm_conv_s5__prompt_kernel_skip4
  v_cndmask_b32 v50, 0, 16, vcc
  v_and_b32 v24, 0xffff, v24
  v_lshlrev_b32 v24, v50, v24
  v_and_b32 v25, 0xffff, v25
  v_lshlrev_b32 v25, v50, v25
  v_and_b32 v26, 0xffff, v26
  v_lshlrev_b32 v26, v50, v26
  v_and_b32 v27, 0xffff, v27
  v_lshlrev_b32 v27, v50, v27
  v_and_b32 v28, 0xffff, v28
  v_lshlrev_b32 v28, v50, v28
  v_and_b32 v29, 0xffff, v29
  v_lshlrev_b32 v29, v50, v29
  v_and_b32 v30, 0xffff, v30
  v_lshlrev_b32 v30, v50, v30
  v_and_b32 v31, 0xffff, v31
  v_lshlrev_b32 v31, v50, v31
  v_cmp_eq_u32 vcc, 0, v2
  v_mov_b32 v50, 0x3f80
  s_nop 0
  v_cndmask_b32 v28, v28, v50, vcc
  v_mov_b32 v50, 0xbf80
  v_cndmask_b32 v29, v29, v50, vcc
  v_mov_b32 v50, 0x3f80
  v_cndmask_b32 v30, v30, v50, vcc
  v_mov_b32 v50, 0xbf80
  v_cndmask_b32 v31, v31, v50, vcc
gated_mix__spectral_gfnet__ssm_conv_s5__prompt_kernel_skip4:
gated_mix__spectral_gfnet__ssm_conv_s5__prompt_kernel_skip3:
  s_cmp_lg_u32 s3, 1
  s_cbranch_scc1 gated_mix__spectral_gfnet__ssm_conv_s5__prompt_kernel_skip5
  v_cvt_f32_u32 v51, s10
  v_mul_f32 v51, 0xc4700000, v51
  v_cmp_lt_u32 vcc, 1, v3
  v_cvt_f32_u32 v50, s5
  s_nop 0
  v_cndmask_b32 v51, 0, v51, vcc
  v_add_f32 v50, v50, v51
  v_fmamk_f32 v50, v7, 0x43000000, v50
  v_mul_f32 v49, v50, v6
  v_mul_f32 v49, 0x3a000000, v49
  v_mul_f32 v48, 0x3d800000, v6
  v_fmamk_f32 v40, v48, 0x0, v49
  v_fmamk_f32 v41, v48, 0x3f800000, v49
  v_fmamk_f32 v42, v48, 0x40000000, v49
  v_fmamk_f32 v43, v48, 0x40400000, v49
  v_cos_f32 v44, v40
  v_cos_f32 v45, v41
  v_cos_f32 v46, v42
  v_cos_f32 v47, v43
  v_sin_f32 v40, v40
  v_sin_f32 v41, v41
  v_sin_f32 v42, v42
  v_sin_f32 v43, v43
  v_cvt_pk_bf16_f32 v24, v44, -v40
  v_cvt_pk_bf16_f32 v28, v40, v44
  v_cvt_pk_bf16_f32 v25, v45, -v41
  v_cvt_pk_bf16_f32 v29, v41, v45
  v_cvt_pk_bf16_f32 v26, v46, -v42
  v_cvt_pk_bf16_f32 v30, v42, v46
  v_cvt_pk_bf16_f32 v27, v47, -v43
  v_cvt_pk_bf16_f32 v31, v43, v47
  v_add_f32 v50, 0x40400000, v7
  v_cndmask_b32 v50, v7, v50, vcc
  v_mul_f32 v49, v48, v50
  v_cndmask_b32 v48, v48, -v48, vcc
  v_fmamk_f32 v40, v48, 0x0, v49
  v_fmamk_f32 v41, v48, 0x3f800000, v49
  v_fmamk_f32 v42, v48, 0x40000000, v49
  v_fmamk_f32 v43, v48, 0x40400000, v49
  v_cos_f32 v44, v40
  v_cos_f32 v45, v41
  v_cos_f32 v46, v42
  v_cos_f32 v47, v43
  v_sin_f32 v40, v40
  v_sin_f32 v41, v41
  v_sin_f32 v42, v42
  v_sin_f32 v43, v43
  v_cvt_pk_bf16_f32 v32, v44, -v40
  v_cvt_pk_bf16_f32 v36, v40, v44
  v_cvt_pk_bf16_f32 v33, v45, -v41
  v_cvt_pk_bf16_f32 v37, v41, v45
  v_cvt_pk_bf16_f32 v34, v46, -v42
  v_cvt_pk_bf16_f32 v38, v42, v46
  v_cvt_pk_bf16_f32 v35, v47, -v43
  v_cvt_pk_bf16_f32 v39, v43, v47
  s_cmp_eq_u32 s10, 0
  s_cbranch_scc1 gated_mix__spectral_gfnet__ssm_conv_s5__prompt_kernel_skip6
  v_lshlrev_b32 v50, 16, v24
  v_and_b32 v51, 0xffff0000, v24
  v_add_f32 v50, v50, v50
  v_add_f32 v51, v51, v51
  v_cvt_pk_bf16_f32 v50, v50, v51
  v_cndmask_b32 v24, v50, 0, vcc
  v_cndmask_b32 v28, 0, v50, vcc
  v_lshlrev_b32 v50, 16, v25
  v_and_b32 v51, 0xffff0000, v25
  v_add_f32 v50, v50, v50
  v_add_f32 v51, v51, v51
  v_cvt_pk_bf16_f32 v50, v50, v51
  v_cndmask_b32 v25, v50, 0, vcc
  v_cndmask_b32 v29, 0, v50, vcc
  v_lshlrev_b32 v50, 16, v26
  v_and_b32 v51, 0xffff0000, v26
  v_add_f32 v50, v50, v50
  v_add_f32 v51, v51, v51
  v_cvt_pk_bf16_f32 v50, v50, v51
  v_cndmask_b32 v26, v50, 0, vcc
  v_cndmask_b32 v30, 0, v50, vcc
  v_lshlrev_b32 v50, 16, v27
  v_and_b32 v51, 0xffff0000, v27
  v_add_f32 v50, v50, v50
  v_add_f32 v51, v51, v51
  v_cvt_pk_bf16_f32 v50, v50, v51
  v_cndmask_b32 v27, v50, 0, vcc
  v_cndmask_b32 v31, 0, v50, vcc
  v_lshlrev_b32 v50, 31, v2
  v_or_b32 v50, 0x3f803f80, v50
  v_cmp_eq_u32 vcc, 0, v3
  s_nop 1
  v_cndmask_b32 v24, v24, v50, vcc
gated_mix__spectral_gfnet__ssm_conv_s5__prompt_kernel_skip6:
gated_mix__spectral_gfnet__ssm_conv_s5__prompt_kernel_skip5:
  s_cmp_lg_u32 s3, 2
  s_cbranch_scc1 gated_mix__spectral_gfnet__ssm_conv_s5__prompt_kernel_skip7
  v_cvt_f32_u32 v51, s4
  v_fma_f32 v50, v6, 4.0, v51
  v_mul_f32 v48, 0x3c800000, v50
  v_mul_f32 v49, v48, v7
  v_fmamk_f32 v40, v48, 0x0, v49
  v_fmamk_f32 v41, v48, 0x3f800000, v49
  v_fmamk_f32 v42, v48, 0x40000000, v49
  v_fmamk_f32 v43, v48, 0x40400000, v49
  v_cos_f32 v44, v40
  v_cos_f32 v45, v41
  v_cos_f32 v46, v42
  v_cos_f32 v47, v43
  v_sin_f32 v40, v40
  v_sin_f32 v41, v41
  v_sin_f32 v42, v42
  v_sin_f32 v43, v43
  v_cvt_pk_bf16_f32 v24, v44, v40
  v_cvt_pk_bf16_f32 v28, -v40, v44
  v_cvt_pk_bf16_f32 v25, v45, v41
  v_cvt_pk_bf16_f32 v29, -v41, v45
  v_cvt_pk_bf16_f32 v26, v46, v42
  v_cvt_pk_bf16_f32 v30, -v42, v46
  v_cvt_pk_bf16_f32 v27, v47, v43
  v_cvt_pk_bf16_f32 v31, -v43, v47
  v_mul_f32 v48, 0x3d800000, v48
  v_mul_f32 v49, 0x3d800000, v49
  v_fmamk_f32 v40, v48, 0x0, v49
  v_fmamk_f32 v41, v48, 0x3f800000, v49
  v_fmamk_f32 v42, v48, 0x40000000, v49
  v_fmamk_f32 v43, v48, 0x40400000, v49
  v_cos_f32 v32, v40
  v_cos_f32 v33, v41
  v_cos_f32 v34, v42
  v_cos_f32 v35, v43
  v_sin_f32 v36, v40
  v_sin_f32 v37, v41
  v_sin_f32 v38, v42
  v_sin_f32 v39, v43
gated_mix__spectral_gfnet__ssm_conv_s5__prompt_kernel_skip7:
  s_cmp_lg_u32 s3, 3
  s_cbranch_scc1 gated_mix__spectral_gfnet__ssm_conv_s5__prompt_kernel_skip8
  v_cvt_f32_u32 v51, s4
  v_fma_f32 v50, v7, 4.0, v51
  v_mul_f32 v49, v50, v6
  v_mul_f32 v49, 0x3c800000, v49
  v_mul_f32 v48, 0x3d800000, v6
  v_fmamk_f32 v40, v48, 0x0, v49
  v_fmamk_f32 v41, v48, 0x3f800000, v49
  v_fmamk_f32 v42, v48, 0x40000000, v49
  v_fmamk_f32 v43, v48, 0x40400000, v49
  v_cos_f32 v44, v40
  v_cos_f32 v45, v41
  v_cos_f32 v46, v42
  v_cos_f32 v47, v43
  v_sin_f32 v40, v40
  v_sin_f32 v41, v41
  v_sin_f32 v42, v42
  v_sin_f32 v43, v43
  v_cvt_pk_bf16_f32 v24, v44, -v40
  v_cvt_pk_bf16_f32 v28, v40, v44
  v_cvt_pk_bf16_f32 v25, v45, -v41
  v_cvt_pk_bf16_f32 v29, v41, v45
  v_cvt_pk_bf16_f32 v26, v46, -v42
  v_cvt_pk_bf16_f32 v30, v42, v46
  v_cvt_pk_bf16_f32 v27, v47, -v43
  v_cvt_pk_bf16_f32 v31, v43, v47
  v_mul_f32 v48, 0x3d800000, v48
  v_mul_f32 v49, 0x3d800000, v49
  v_fmamk_f32 v40, v48, 0x0, v49
  v_fmamk_f32 v41, v48, 0x3f800000, v49
  v_fmamk_f32 v42, v48, 0x40000000, v49
  v_fmamk_f32 v43, v48, 0x40400000, v49
  v_cos_f32 v32, v40
  v_cos_f32 v33, v41
  v_cos_f32 v34, v42
  v_cos_f32 v35, v43
  v_sin_f32 v36, v40
  v_sin_f32 v37, v41
  v_sin_f32 v38, v42
  v_sin_f32 v39, v43
  v_mul_f32 v32, 0x35800000, v32
  v_mul_f32 v33, 0x35800000, v33
  v_mul_f32 v34, 0x35800000, v34
  v_mul_f32 v35, 0x35800000, v35
  v_mul_f32 v36, 0x35800000, v36
  v_mul_f32 v37, 0x35800000, v37
  v_mul_f32 v38, 0x35800000, v38
  v_mul_f32 v39, 0x35800000, v39
gated_mix__spectral_gfnet__ssm_conv_s5__prompt_kernel_skip8:
  s_lshl_b32 s16, s3, 12
  s_add_u32 s16, s16, 147456
  v_lshl_add_u32 v50, v1, 4, s16
  ds_write_b128 v50, v[24:27] offset:0
  ds_write_b128 v50, v[28:31] offset:1024
  ds_write_b128 v50, v[32:35] offset:2048
  ds_write_b128 v50, v[36:39] offset:3072
  s_add_u32 s16, s34, 20316160
  s_addc_u32 s17, s35, 0
  s_mov_b32 s18, 262144
  s_mov_b32 s19, 0x20000
  v_mov_b32 v6, 0
  v_lshlrev_b32 v7, 4, v0
  s_mov_b32 s56, 4096
  s_cmp_lg_u32 s2, 0
  s_cbranch_scc1 gated_mix__spectral_gfnet__ssm_conv_s5__prompt_kernel_skip9
  v_mov_b32 v24, 0
  v_mov_b32 v25, 0
  v_mov_b32 v26, 0
  v_mov_b32 v27, 0
  buffer_store_dwordx4 v[24:27], v7, s[16:19], 0 offen sc1
  buffer_store_dwordx4 v[24:27], v7, s[16:19], s56 offen sc1
gated_mix__spectral_gfnet__ssm_conv_s5__prompt_kernel_skip9:
  s_mov_b32 s60, s28
  s_mov_b32 s61, s29
  s_mov_b32 s62, 2048
  s_mov_b32 s63, 0x20000
  s_mov_b32 s64, s12
  s_mov_b32 s65, s13
  s_mov_b32 s66, 2048
  s_mov_b32 s67, 0x20000
  s_mov_b32 s68, s14
  s_mov_b32 s69, s15
  s_mov_b32 s70, 2048
  s_mov_b32 s71, 0x20000
  s_mov_b32 s72, s24
  s_mov_b32 s73, s25
  s_mov_b32 s74, 2048
  s_mov_b32 s75, 0x20000
  s_mov_b32 s76, s26
  s_mov_b32 s77, s27
  s_mov_b32 s78, 2048
  s_mov_b32 s79, 0x20000
  s_mov_b32 s12, s34
  s_mov_b32 s13, s35
  s_mov_b32 s14, 4194304
  s_mov_b32 s15, 0x20000
  s_lshl_b32 s28, s3, 4
  v_add_u32 v76, s28, v2
  v_cvt_f32_u32 v72, v76
  v_mul_f32 v72, 0x3c000000, v72
  v_lshrrev_b32 v74, 1, v3
  v_lshlrev_b32 v74, 4, v74
  v_and_b32 v75, 1, v3
  v_lshl_add_u32 v74, v75, 2, v74
  v_cvt_f32_u32 v73, v74
  v_mul_f32 v73, v73, v72
  v_cmp_eq_u32 vcc, 0, v76
  v_fmamk_f32 v56, v72, 0x0, v73
  v_fmamk_f32 v57, v72, 0x3f800000, v73
  v_fmamk_f32 v58, v72, 0x40000000, v73
  v_fmamk_f32 v59, v72, 0x40400000, v73
  v_fmamk_f32 v60, v72, 0x41000000, v73
  v_fmamk_f32 v61, v72, 0x41100000, v73
  v_fmamk_f32 v62, v72, 0x41200000, v73
  v_fmamk_f32 v63, v72, 0x41300000, v73
  v_cos_f32 v64, v56
  v_cos_f32 v65, v57
  v_cos_f32 v66, v58
  v_cos_f32 v67, v59
  v_cos_f32 v68, v60
  v_cos_f32 v69, v61
  v_cos_f32 v70, v62
  v_cos_f32 v71, v63
  v_sin_f32 v56, v56
  v_sin_f32 v57, v57
  v_sin_f32 v58, v58
  v_sin_f32 v59, v59
  s_add_u32 m0, s55, 0
  s_nop 0
  buffer_load_dwordx4 v12, s[48:51], s52 offen offset:0 lds
  v_sin_f32 v60, v60
  v_sin_f32 v61, v61
  v_sin_f32 v62, v62
  v_sin_f32 v63, v63
  buffer_load_dwordx4 v13, s[48:51], s52 offen offset:1024 lds
  v_mov_b32 v73, 0x80008000
  v_bfe_i32 v75, v2, 0, 1
  v_bfe_i32 v74, v2, 1, 1
  v_cmp_ne_u32 s[58:59], 0, v75
  v_and_b32 v75, v73, v75
  v_and_b32 v74, v73, v74
  v_xor_b32 v76, v74, v75
  v_mov_b32 v72, 0xbf803f80
  buffer_load_dwordx4 v14, s[48:51], s52 offen offset:2048 lds
  v_cvt_pk_bf16_f32 v24, v64, v65
  v_cvt_pk_bf16_f32 v40, -v56, -v57
  v_cndmask_b32 v40, v40, v72, vcc
  v_cvt_pk_bf16_f32 v25, v66, v67
  v_cvt_pk_bf16_f32 v41, -v58, -v59
  v_cndmask_b32 v41, v41, v72, vcc
  v_cvt_pk_bf16_f32 v26, v68, v69
  v_cvt_pk_bf16_f32 v42, -v60, -v61
  buffer_load_dwordx4 v15, s[48:51], s52 offen offset:3072 lds
  v_cndmask_b32 v42, v42, v72, vcc
  v_cvt_pk_bf16_f32 v27, v70, v71
  v_cvt_pk_bf16_f32 v43, -v62, -v63
  v_cndmask_b32 v43, v43, v72, vcc
  v_cndmask_b32 v28, v24, v40, s[58:59]
  v_cndmask_b32 v44, v40, v24, s[58:59]
  v_xor_b32 v32, v75, v24
  v_xor_b32 v48, v75, v40
  s_add_u32 m0, s54, 0
  s_nop 0
  buffer_load_dwordx4 v8, s[44:47], s52 offen offset:0 lds
  v_xor_b32 v36, v76, v28
  v_xor_b32 v52, v74, v44
  v_xor_b32 v28, v74, v28
  v_xor_b32 v44, v76, v44
  v_cndmask_b32 v29, v25, v41, s[58:59]
  v_cndmask_b32 v45, v41, v25, s[58:59]
  v_xor_b32 v33, v75, v25
  v_xor_b32 v49, v75, v41
  buffer_load_dwordx4 v9, s[44:47], s52 offen offset:1024 lds
  v_xor_b32 v37, v76, v29
  v_xor_b32 v53, v74, v45
  v_xor_b32 v29, v74, v29
  v_xor_b32 v45, v76, v45
  v_cndmask_b32 v30, v26, v42, s[58:59]
  v_cndmask_b32 v46, v42, v26, s[58:59]
  v_xor_b32 v34, v75, v26
  v_xor_b32 v50, v75, v42
  buffer_load_dwordx4 v10, s[44:47], s52 offen offset:2048 lds
  v_xor_b32 v38, v76, v30
  v_xor_b32 v54, v74, v46
  v_xor_b32 v30, v74, v30
  v_xor_b32 v46, v76, v46
  v_cndmask_b32 v31, v27, v43, s[58:59]
  v_cndmask_b32 v47, v43, v27, s[58:59]
  v_xor_b32 v35, v75, v27
  v_xor_b32 v51, v75, v43
  buffer_load_dwordx4 v11, s[44:47], s52 offen offset:3072 lds
  s_add_u32 s52, s52, 128
  s_and_b32 s52, s52, 0x7ff
  v_xor_b32 v39, v76, v31
  v_xor_b32 v55, v74, v47
  v_xor_b32 v31, v74, v31
  v_xor_b32 v47, v76, v47
  v_and_b32 v5, 31, v1
  v_lshlrev_b32 v5, 1, v5
  s_lshl_b32 s43, s39, 7
  s_and_b32 s28, s3, 1
  s_lshl_b32 s28, s28, 6
  s_add_u32 s43, s43, s28
  buffer_load_ushort v56, v5, s[64:67], s43 offen
  buffer_load_ushort v57, v5, s[68:71], s43 offen
  buffer_load_ushort v58, v5, s[72:75], s43 offen
  v_lshlrev_b32 v5, 1, v2
  s_lshl4_add_u32 s43, s3, s41
  s_lshl_b32 s43, s43, 5
  buffer_load_short_d16_hi v60, v5, s[76:79], s43 offen
  s_add_u32 m0, s55, 16384
  s_nop 0
  buffer_load_dwordx4 v12, s[48:51], s52 offen offset:0 lds
  buffer_load_dwordx4 v13, s[48:51], s52 offen offset:1024 lds
  buffer_load_dwordx4 v14, s[48:51], s52 offen offset:2048 lds
  buffer_load_dwordx4 v15, s[48:51], s52 offen offset:3072 lds
  s_add_u32 m0, s54, 16384
  s_nop 0
  buffer_load_dwordx4 v8, s[44:47], s52 offen offset:0 lds
  buffer_load_dwordx4 v9, s[44:47], s52 offen offset:1024 lds
  buffer_load_dwordx4 v10, s[44:47], s52 offen offset:2048 lds
  buffer_load_dwordx4 v11, s[44:47], s52 offen offset:3072 lds
  s_add_u32 s52, s52, 128
  s_and_b32 s52, s52, 0x7ff
  s_waitcnt vmcnt(20) lgkmcnt(0)
  s_barrier
  v_bfe_u32 v5, v1, 2, 3
  v_lshrrev_b32 v62, 5, v1
  v_lshl_or_b32 v5, v62, 4, v5
  v_lshlrev_b32 v5, 7, v5
  v_and_b32 v62, 3, v1
  v_lshl_or_b32 v5, v62, 3, v5
  v_add_u32 v5, 131072, v5
  v_bfe_u32 v62, v1, 3, 2
  v_xor_b32 v88, 0, v62
  v_lshl_add_u32 v88, v88, 5, v5
  v_xor_b32 v89, 1, v62
  v_lshl_add_u32 v89, v89, 5, v5
  v_xor_b32 v90, 2, v62
  v_lshl_add_u32 v90, v90, 5, v5
  v_xor_b32 v91, 3, v62
  s_add_u32 m0, s55, 32768
  s_nop 0
  buffer_load_dwordx4 v12, s[48:51], s52 offen offset:0 lds
  v_lshl_add_u32 v91, v91, 5, v5
  ds_read_b64_tr_b16 v[124:125], v88 offset:0
  ds_read_b64_tr_b16 v[126:127], v88 offset:1024
  ds_read_b64_tr_b16 v[128:129], v88 offset:4096
  ds_read_b64_tr_b16 v[130:131], v88 offset:5120
  ds_read_b64_tr_b16 v[132:133], v88 offset:8192
  ds_read_b64_tr_b16 v[134:135], v88 offset:9216
  ds_read_b64_tr_b16 v[136:137], v88 offset:12288
  ds_read_b64_tr_b16 v[138:139], v88 offset:13312
  ds_read_b64_tr_b16 v[140:141], v90 offset:0
  ds_read_b64_tr_b16 v[142:143], v90 offset:1024
  ds_read_b64_tr_b16 v[144:145], v90 offset:4096
  ds_read_b64_tr_b16 v[146:147], v90 offset:5120
  ds_read_b64_tr_b16 v[148:149], v90 offset:8192
  buffer_load_dwordx4 v13, s[48:51], s52 offen offset:1024 lds
  ds_read_b64_tr_b16 v[150:151], v90 offset:9216
  ds_read_b64_tr_b16 v[152:153], v90 offset:12288
  ds_read_b64_tr_b16 v[154:155], v90 offset:13312
  ds_read_b64_tr_b16 v[156:157], v89 offset:0
  ds_read_b64_tr_b16 v[158:159], v89 offset:1024
  ds_read_b64_tr_b16 v[160:161], v89 offset:4096
  ds_read_b64_tr_b16 v[162:163], v89 offset:5120
  ds_read_b64_tr_b16 v[164:165], v89 offset:8192
  ds_read_b64_tr_b16 v[166:167], v89 offset:9216
  ds_read_b64_tr_b16 v[168:169], v89 offset:12288
  ds_read_b64_tr_b16 v[170:171], v89 offset:13312
  s_waitcnt lgkmcnt(15)
  v_mfma_f32_16x16x32_bf16 v[92:95], v[24:27], v[124:127], 0
  buffer_load_dwordx4 v14, s[48:51], s52 offen offset:2048 lds
  v_mfma_f32_16x16x32_bf16 v[96:99], v[40:43], v[124:127], 0
  s_waitcnt lgkmcnt(15)
  v_mfma_f32_16x16x32_bf16 v[92:95], v[28:31], v[128:131], v[92:95]
  v_mfma_f32_16x16x32_bf16 v[96:99], v[44:47], v[128:131], v[96:99]
  s_waitcnt lgkmcnt(15)
  v_mfma_f32_16x16x32_bf16 v[92:95], v[32:35], v[132:135], v[92:95]
  buffer_load_dwordx4 v15, s[48:51], s52 offen offset:3072 lds
  v_mfma_f32_16x16x32_bf16 v[96:99], v[48:51], v[132:135], v[96:99]
  s_waitcnt lgkmcnt(15)
  v_mfma_f32_16x16x32_bf16 v[92:95], v[36:39], v[136:139], v[92:95]
  v_mfma_f32_16x16x32_bf16 v[96:99], v[52:55], v[136:139], v[96:99]
  ds_read_b64_tr_b16 v[124:125], v91 offset:0
  ds_read_b64_tr_b16 v[126:127], v91 offset:1024
  s_add_u32 m0, s54, 32768
  s_nop 0
  buffer_load_dwordx4 v8, s[44:47], s52 offen offset:0 lds
  ds_read_b64_tr_b16 v[128:129], v91 offset:4096
  ds_read_b64_tr_b16 v[130:131], v91 offset:5120
  ds_read_b64_tr_b16 v[132:133], v91 offset:8192
  ds_read_b64_tr_b16 v[134:135], v91 offset:9216
  ds_read_b64_tr_b16 v[136:137], v91 offset:12288
  ds_read_b64_tr_b16 v[138:139], v91 offset:13312
  s_waitcnt lgkmcnt(15)
  v_mfma_f32_16x16x32_bf16 v[108:111], v[24:27], v[140:143], 0
  v_mfma_f32_16x16x32_bf16 v[112:115], v[40:43], v[140:143], 0
  buffer_load_dwordx4 v9, s[44:47], s52 offen offset:1024 lds
  s_waitcnt lgkmcnt(15)
  v_mfma_f32_16x16x32_bf16 v[108:111], v[28:31], v[144:147], v[108:111]
  v_mfma_f32_16x16x32_bf16 v[112:115], v[44:47], v[144:147], v[112:115]
  s_waitcnt lgkmcnt(15)
  v_mfma_f32_16x16x32_bf16 v[108:111], v[32:35], v[148:151], v[108:111]
  v_mfma_f32_16x16x32_bf16 v[112:115], v[48:51], v[148:151], v[112:115]
  buffer_load_dwordx4 v10, s[44:47], s52 offen offset:2048 lds
  s_waitcnt lgkmcnt(15)
  v_mfma_f32_16x16x32_bf16 v[108:111], v[36:39], v[152:155], v[108:111]
  v_mfma_f32_16x16x32_bf16 v[112:115], v[52:55], v[152:155], v[112:115]
  s_waitcnt lgkmcnt(14)
  v_mfma_f32_16x16x32_bf16 v[100:103], v[24:27], v[156:159], 0
  v_mfma_f32_16x16x32_bf16 v[104:107], v[40:43], v[156:159], 0
  buffer_load_dwordx4 v11, s[44:47], s52 offen offset:3072 lds
  s_add_u32 s52, s52, 128
  s_and_b32 s52, s52, 0x7ff
  s_waitcnt lgkmcnt(12)
  v_mfma_f32_16x16x32_bf16 v[100:103], v[28:31], v[160:163], v[100:103]
  v_mfma_f32_16x16x32_bf16 v[104:107], v[44:47], v[160:163], v[104:107]
  s_waitcnt lgkmcnt(10)
  v_mfma_f32_16x16x32_bf16 v[100:103], v[32:35], v[164:167], v[100:103]
  v_mfma_f32_16x16x32_bf16 v[104:107], v[48:51], v[164:167], v[104:107]
  s_add_u32 m0, s55, 49152
  s_nop 0
  buffer_load_dwordx4 v12, s[48:51], s52 offen offset:0 lds
  s_waitcnt lgkmcnt(8)
  v_mfma_f32_16x16x32_bf16 v[100:103], v[36:39], v[168:171], v[100:103]
  v_mfma_f32_16x16x32_bf16 v[104:107], v[52:55], v[168:171], v[104:107]
  s_waitcnt lgkmcnt(6)
  v_mfma_f32_16x16x32_bf16 v[116:119], v[24:27], v[124:127], 0
  v_mfma_f32_16x16x32_bf16 v[120:123], v[40:43], v[124:127], 0
  buffer_load_dwordx4 v13, s[48:51], s52 offen offset:1024 lds
  s_waitcnt lgkmcnt(4)
  v_mfma_f32_16x16x32_bf16 v[116:119], v[28:31], v[128:131], v[116:119]
  v_mfma_f32_16x16x32_bf16 v[120:123], v[44:47], v[128:131], v[120:123]
  s_waitcnt lgkmcnt(2)
  v_mfma_f32_16x16x32_bf16 v[116:119], v[32:35], v[132:135], v[116:119]
  v_mfma_f32_16x16x32_bf16 v[120:123], v[48:51], v[132:135], v[120:123]
  buffer_load_dwordx4 v14, s[48:51], s52 offen offset:2048 lds
  s_waitcnt lgkmcnt(0)
  v_mfma_f32_16x16x32_bf16 v[116:119], v[36:39], v[136:139], v[116:119]
  v_mfma_f32_16x16x32_bf16 v[120:123], v[52:55], v[136:139], v[120:123]
  v_pk_add_f32 v[140:141], v[92:93], v[108:109]
  v_pk_add_f32 v[148:149], v[92:93], v[108:109] neg_lo:[0,1] neg_hi:[0,1]
  v_pk_add_f32 v[142:143], v[94:95], v[110:111]
  v_pk_add_f32 v[150:151], v[94:95], v[110:111] neg_lo:[0,1] neg_hi:[0,1]
  v_pk_add_f32 v[144:145], v[96:97], v[112:113]
  v_pk_add_f32 v[152:153], v[96:97], v[112:113] neg_lo:[0,1] neg_hi:[0,1]
  buffer_load_dwordx4 v15, s[48:51], s52 offen offset:3072 lds
  v_pk_add_f32 v[146:147], v[98:99], v[114:115]
  v_pk_add_f32 v[154:155], v[98:99], v[114:115] neg_lo:[0,1] neg_hi:[0,1]
  v_pk_add_f32 v[156:157], v[100:101], v[116:117]
  v_pk_add_f32 v[164:165], v[100:101], v[116:117] neg_lo:[0,1] neg_hi:[0,1]
  v_pk_add_f32 v[158:159], v[102:103], v[118:119]
  v_pk_add_f32 v[166:167], v[102:103], v[118:119] neg_lo:[0,1] neg_hi:[0,1]
  v_pk_add_f32 v[160:161], v[104:105], v[120:121]
  v_pk_add_f32 v[168:169], v[104:105], v[120:121] neg_lo:[0,1] neg_hi:[0,1]
  v_pk_add_f32 v[162:163], v[106:107], v[122:123]
  v_pk_add_f32 v[170:171], v[106:107], v[122:123] neg_lo:[0,1] neg_hi:[0,1]
  v_pk_add_f32 v[92:93], v[140:141], v[156:157]
  v_pk_add_f32 v[108:109], v[140:141], v[156:157] neg_lo:[0,1] neg_hi:[0,1]
  v_pk_add_f32 v[96:97], v[144:145], v[160:161]
  v_pk_add_f32 v[112:113], v[144:145], v[160:161] neg_lo:[0,1] neg_hi:[0,1]
  s_add_u32 m0, s54, 49152
  s_nop 0
  buffer_load_dwordx4 v8, s[44:47], s52 offen offset:0 lds
  v_pk_add_f32 v[100:101], v[148:149], v[168:169]
  v_pk_add_f32 v[104:105], v[152:153], v[164:165] neg_lo:[0,1] neg_hi:[0,1]
  v_pk_add_f32 v[116:117], v[148:149], v[168:169] neg_lo:[0,1] neg_hi:[0,1]
  v_pk_add_f32 v[120:121], v[152:153], v[164:165]
  v_pk_add_f32 v[94:95], v[142:143], v[158:159]
  v_pk_add_f32 v[110:111], v[142:143], v[158:159] neg_lo:[0,1] neg_hi:[0,1]
  v_pk_add_f32 v[98:99], v[146:147], v[162:163]
  v_pk_add_f32 v[114:115], v[146:147], v[162:163] neg_lo:[0,1] neg_hi:[0,1]
  v_pk_add_f32 v[102:103], v[150:151], v[170:171]
  v_pk_add_f32 v[106:107], v[154:155], v[166:167] neg_lo:[0,1] neg_hi:[0,1]
  v_pk_add_f32 v[118:119], v[150:151], v[170:171] neg_lo:[0,1] neg_hi:[0,1]
  v_pk_add_f32 v[122:123], v[154:155], v[166:167]
  v_cmp_gt_u32 vcc, 16, v0
  s_nop 1
  v_cndmask_b32 v100, v100, v148, vcc
  buffer_load_dwordx4 v9, s[44:47], s52 offen offset:1024 lds
  v_cndmask_b32 v104, v104, -v164, vcc
  v_cndmask_b32 v116, v116, v152, vcc
  v_cndmask_b32 v120, v120, -v168, vcc
  v_cvt_pk_bf16_f32 v124, v92, v96
  v_cvt_pk_bf16_f32 v125, v100, v104
  v_cvt_pk_bf16_f32 v126, v108, v112
  v_cvt_pk_bf16_f32 v127, v116, v120
  v_cvt_pk_bf16_f32 v128, v93, v97
  v_cvt_pk_bf16_f32 v129, v101, v105
  v_cvt_pk_bf16_f32 v130, v109, v113
  v_cvt_pk_bf16_f32 v131, v117, v121
  v_cvt_pk_bf16_f32 v132, v94, v98
  v_cvt_pk_bf16_f32 v133, v102, v106
  v_cvt_pk_bf16_f32 v134, v110, v114
  buffer_load_dwordx4 v10, s[44:47], s52 offen offset:2048 lds
  v_cvt_pk_bf16_f32 v135, v118, v122
  v_cvt_pk_bf16_f32 v136, v95, v99
  v_cvt_pk_bf16_f32 v137, v103, v107
  v_cvt_pk_bf16_f32 v138, v111, v115
  v_cvt_pk_bf16_f32 v139, v119, v123
  v_and_b32 v124, -2, v124
  v_and_b32 v125, -2, v125
  v_and_b32 v126, -2, v126
  v_and_b32 v127, -2, v127
  v_and_b32 v128, -2, v128
  v_and_b32 v129, -2, v129
  v_and_b32 v130, -2, v130
  v_and_b32 v131, -2, v131
  v_and_b32 v132, -2, v132
  buffer_load_dwordx4 v11, s[44:47], s52 offen offset:3072 lds
  s_add_u32 s52, s52, 128
  s_and_b32 s52, s52, 0x7ff
  v_and_b32 v133, -2, v133
  v_and_b32 v134, -2, v134
  v_and_b32 v135, -2, v135
  v_and_b32 v136, -2, v136
  v_and_b32 v137, -2, v137
  v_and_b32 v138, -2, v138
  v_and_b32 v139, -2, v139
  s_mov_b32 s28, 262144
  v_mul_lo_u32 v5, v3, s28
  v_lshl_add_u32 v5, v2, 2, v5
  s_mul_i32 s28, s3, 1048576
  s_lshl_b32 s43, s40, 10
  s_add_u32 s28, s28, s43
  s_lshl_b32 s43, s41, 6
  s_add_u32 s28, s28, s43
  s_lshr_b32 s43, s41, 3
  s_lshl_b32 s43, s43, 13
  s_add_u32 s43, s43, 131072
  v_lshrrev_b32 v40, 2, v1
  v_lshl_add_u32 v40, v40, 7, s43
  v_and_b32 v41, 3, v1
  v_lshl_add_u32 v40, v41, 3, v40
  v_bfe_u32 v41, v1, 3, 2
  v_xor_b32 v41, s3, v41
  v_lshl_add_u32 v39, v41, 5, v40
  v_xor_b32 v38, 8192, v39
  ds_read_b64_tr_b16 v[62:63], v38 offset:0
  ds_read_b64_tr_b16 v[24:25], v38 offset:2048
  ds_read_b64_tr_b16 v[26:27], v38 offset:4096
  ds_read_b64_tr_b16 v[28:29], v38 offset:6144
  ds_read_b64_tr_b16 v[30:31], v39 offset:0
  ds_read_b64_tr_b16 v[32:33], v39 offset:2048
  ds_read_b64_tr_b16 v[34:35], v39 offset:4096
  ds_read_b64_tr_b16 v[36:37], v39 offset:6144
  v_lshlrev_b32 v59, 4, v1
  s_lshl_b32 s29, s38, 18
  s_lshl_b32 s58, s39, 11
  s_add_u32 s29, s29, s58
  s_lshl_b32 s58, s3, 16
  s_add_u32 s29, s29, s58
  s_add_u32 s58, s29, 32768
  buffer_load_dwordx4 v[64:67], v59, s[44:47], s29 offen offset:0
  buffer_load_dwordx4 v[68:71], v59, s[44:47], s29 offen offset:1024
  buffer_load_dwordx4 v[72:75], v59, s[44:47], s58 offen offset:0
  buffer_load_dwordx4 v[76:79], v59, s[44:47], s58 offen offset:1024
  buffer_load_dwordx4 v[80:83], v59, s[60:63], 0 offen offset:0
  buffer_load_dwordx4 v[84:87], v59, s[60:63], 0 offen offset:1024
  s_waitcnt vmcnt(34)
  s_barrier
  ds_read_b128 v[120:123], v16 offset:0
  ds_read_b128 v[160:163], v20 offset:0
  ds_read_b128 v[156:159], v16 offset:4096
  ds_read_b128 v[164:167], v20 offset:4096
  s_waitcnt lgkmcnt(2)
  v_mfma_f32_32x32x16_bf16 v[40:55], v[120:123], v[160:163], 0
  ds_read_b128 v[168:171], v17 offset:0
  ds_read_b128 v[176:179], v21 offset:0
  buffer_store_dword v124, v5, s[12:15], s28 offen sc1
  s_add_u32 s28, s28, 16384
  buffer_store_dword v125, v5, s[12:15], s28 offen sc1
  s_waitcnt lgkmcnt(2)
  v_mfma_f32_32x32x16_bf16 v[88:103], v[120:123], v[164:167], 0
  ds_read_b128 v[172:175], v17 offset:4096
  ds_read_b128 v[180:183], v21 offset:4096
  s_add_u32 s28, s28, 16384
  buffer_store_dword v126, v5, s[12:15], s28 offen sc1
  v_mfma_f32_32x32x16_bf16 v[140:155], v[156:159], v[164:167], 0
  s_add_u32 s28, s28, 16384
  buffer_store_dword v127, v5, s[12:15], s28 offen sc1
  v_mfma_f32_32x32x16_bf16 v[104:119], v[156:159], v[160:163], 0
  s_add_u32 s28, s28, 16384
  buffer_store_dword v128, v5, s[12:15], s28 offen sc1
  s_waitcnt lgkmcnt(2)
  v_mfma_f32_32x32x16_bf16 v[40:55], v[168:171], v[176:179], v[40:55]
  ds_read_b128 v[120:123], v18 offset:0
  ds_read_b128 v[160:163], v22 offset:0
  s_add_u32 s28, s28, 16384
  buffer_store_dword v129, v5, s[12:15], s28 offen sc1
  s_waitcnt lgkmcnt(2)
  v_mfma_f32_32x32x16_bf16 v[88:103], v[168:171], v[180:183], v[88:103]
  ds_read_b128 v[156:159], v18 offset:4096
  ds_read_b128 v[164:167], v22 offset:4096
  s_add_u32 s28, s28, 16384
  buffer_store_dword v130, v5, s[12:15], s28 offen sc1
  v_mfma_f32_32x32x16_bf16 v[140:155], v[172:175], v[180:183], v[140:155]
  s_add_u32 s28, s28, 16384
  buffer_store_dword v131, v5, s[12:15], s28 offen sc1
  v_mfma_f32_32x32x16_bf16 v[104:119], v[172:175], v[176:179], v[104:119]
  s_add_u32 s28, s28, 16384
  buffer_store_dword v132, v5, s[12:15], s28 offen sc1
  s_waitcnt lgkmcnt(2)
  v_mfma_f32_32x32x16_bf16 v[40:55], v[120:123], v[160:163], v[40:55]
  ds_read_b128 v[168:171], v19 offset:0
  ds_read_b128 v[176:179], v23 offset:0
  s_add_u32 s28, s28, 16384
  buffer_store_dword v133, v5, s[12:15], s28 offen sc1
  s_add_u32 s28, s28, 16384
  s_waitcnt lgkmcnt(2)
  v_mfma_f32_32x32x16_bf16 v[88:103], v[120:123], v[164:167], v[88:103]
  ds_read_b128 v[172:175], v19 offset:4096
  ds_read_b128 v[180:183], v23 offset:4096
  buffer_store_dword v134, v5, s[12:15], s28 offen sc1
  s_add_u32 s28, s28, 16384
  v_mfma_f32_32x32x16_bf16 v[140:155], v[156:159], v[164:167], v[140:155]
  buffer_store_dword v135, v5, s[12:15], s28 offen sc1
  s_add_u32 s28, s28, 16384
  v_mfma_f32_32x32x16_bf16 v[104:119], v[156:159], v[160:163], v[104:119]
  buffer_store_dword v136, v5, s[12:15], s28 offen sc1
  s_add_u32 s28, s28, 16384
  s_waitcnt vmcnt(35) lgkmcnt(0)
  s_barrier
  v_mfma_f32_32x32x16_bf16 v[40:55], v[168:171], v[176:179], v[40:55]
  ds_read_b128 v[120:123], v16 offset:16384
  ds_read_b128 v[160:163], v20 offset:16384
  buffer_store_dword v137, v5, s[12:15], s28 offen sc1
  s_add_u32 s28, s28, 16384
  v_mfma_f32_32x32x16_bf16 v[88:103], v[168:171], v[180:183], v[88:103]
  ds_read_b128 v[156:159], v16 offset:20480
  ds_read_b128 v[164:167], v20 offset:20480
  buffer_store_dword v138, v5, s[12:15], s28 offen sc1
  s_add_u32 s28, s28, 16384
  v_mfma_f32_32x32x16_bf16 v[140:155], v[172:175], v[180:183], v[140:155]
  s_add_u32 m0, s55, 0
  s_nop 0
  buffer_load_dwordx4 v12, s[48:51], s52 offen offset:0 lds
  buffer_store_dword v139, v5, s[12:15], s28 offen sc1
  s_mov_b32 s24, s32
  v_mfma_f32_32x32x16_bf16 v[104:119], v[172:175], v[176:179], v[104:119]
  buffer_load_dwordx4 v13, s[48:51], s52 offen offset:1024 lds
  s_mov_b32 s25, s33
  s_mov_b32 s26, 256
  s_waitcnt lgkmcnt(2)
  v_mfma_f32_32x32x16_bf16 v[40:55], v[120:123], v[160:163], v[40:55]
  ds_read_b128 v[168:171], v17 offset:16384
  ds_read_b128 v[176:179], v21 offset:16384
  s_mov_b32 s27, 0x20000
  s_and_b32 s57, s2, 7
  s_lshl_b32 s57, s57, 8
  s_add_u32 s57, s57, s2
  s_and_b32 s57, s57, -8
  s_lshl_b32 s57, s57, 1
  s_waitcnt lgkmcnt(2)
  v_mfma_f32_32x32x16_bf16 v[88:103], v[120:123], v[164:167], v[88:103]
  ds_read_b128 v[172:175], v17 offset:20480
  ds_read_b128 v[180:183], v21 offset:20480
  v_mov_b32 v38, s57
  s_lshl4_add_u32 s57, s39, s38
  s_lshl_b32 s57, s57, 7
  v_lshl_add_u32 v39, v2, 2, s57
  s_mov_b32 s57, 8192
  v_mfma_f32_32x32x16_bf16 v[140:155], v[156:159], v[164:167], v[140:155]
  buffer_load_dwordx4 v14, s[48:51], s52 offen offset:2048 lds
  v_mov_b32 v5, 1
  s_lshl_b32 s28, s39, 14
  s_add_u32 s66, s28, 19988480
  s_add_u32 s64, s34, s66
  s_addc_u32 s65, s35, 0
  s_mov_b32 s66, 8192
  v_mfma_f32_32x32x16_bf16 v[104:119], v[156:159], v[160:163], v[104:119]
  buffer_load_dwordx4 v15, s[48:51], s52 offen offset:3072 lds
  s_mov_b32 s67, 0x20000
  s_sub_u32 s28, 15, s38
  s_lshl_b32 s28, s28, 9
  v_lshl_add_u32 v124, v0, 2, s28
  v_mov_b32 v125, -1
  s_waitcnt lgkmcnt(2)
  v_mfma_f32_32x32x16_bf16 v[40:55], v[168:171], v[176:179], v[40:55]
  ds_read_b128 v[120:123], v18 offset:16384
  ds_read_b128 v[160:163], v22 offset:16384
  s_cmp_ge_u32 s3, 2
  s_cbranch_scc1 gated_mix__spectral_gfnet__ssm_conv_s5__prompt_kernel_skip10
  buffer_store_dword v125, v124, s[64:67], 0 offen sc1
gated_mix__spectral_gfnet__ssm_conv_s5__prompt_kernel_skip10:
  s_cmp_lg_u32 s3, 0
  s_cbranch_scc1 gated_mix__spectral_gfnet__ssm_conv_s5__prompt_kernel_skip11
  s_mov_b64 exec, 65535
  buffer_store_dword v6, v39, s[16:19], s57 offen sc1
  s_mov_b64 exec, -1
gated_mix__spectral_gfnet__ssm_conv_s5__prompt_kernel_skip11:
  s_waitcnt lgkmcnt(2)
  v_mfma_f32_32x32x16_bf16 v[88:103], v[168:171], v[180:183], v[88:103]
  ds_read_b128 v[156:159], v18 offset:20480
  ds_read_b128 v[164:167], v22 offset:20480
  s_or_b32 s28, s3, s2
  v_mfma_f32_32x32x16_bf16 v[140:155], v[172:175], v[180:183], v[140:155]
  s_add_u32 m0, s54, 0
  s_nop 0
  buffer_load_dwordx4 v8, s[44:47], s52 offen offset:0 lds
  s_cmp_lg_u32 s28, 0
  s_cbranch_scc1 gated_mix__spectral_gfnet__ssm_conv_s5__prompt_kernel_skip12
  s_mov_b64 exec, 1
  buffer_store_dword v5, v6, s[24:27], 0 offen sc1
  s_mov_b64 exec, -1
gated_mix__spectral_gfnet__ssm_conv_s5__prompt_kernel_skip12:
  v_mfma_f32_32x32x16_bf16 v[104:119], v[172:175], v[176:179], v[104:119]
  buffer_load_dwordx4 v9, s[44:47], s52 offen offset:1024 lds
  s_mov_b32 s68, s20
  s_mov_b32 s69, s21
  s_mov_b32 s70, 2097152
  s_mov_b32 s71, 0x20000
  s_mov_b32 s72, s22
  s_waitcnt lgkmcnt(2)
  v_mfma_f32_32x32x16_bf16 v[40:55], v[120:123], v[160:163], v[40:55]
  ds_read_b128 v[168:171], v19 offset:16384
  ds_read_b128 v[176:179], v23 offset:16384
  s_mov_b32 s73, s23
  s_mov_b32 s74, 2097152
  s_mov_b32 s75, 0x20000
  v_and_b32 v132, 7, v1
  v_xor_b32 v132, v132, v3
  s_waitcnt lgkmcnt(2)
  v_mfma_f32_32x32x16_bf16 v[88:103], v[120:123], v[164:167], v[88:103]
  ds_read_b128 v[172:175], v19 offset:20480
  ds_read_b128 v[180:183], v23 offset:20480
  v_and_b32 v133, 4, v132
  v_lshlrev_b32 v124, 4, v133
  v_and_b32 v133, 1, v132
  v_lshl_or_b32 v124, v133, 5, v124
  v_and_b32 v133, 2, v132
  v_lshl_or_b32 v124, v133, 3, v124
  v_mfma_f32_32x32x16_bf16 v[140:155], v[156:159], v[164:167], v[140:155]
  buffer_load_dwordx4 v10, s[44:47], s52 offen offset:2048 lds
  v_lshrrev_b32 v133, 3, v1
  v_lshl_or_b32 v124, v133, 11, v124
  s_lshl4_add_u32 s59, s3, s41
  s_lshl_b32 s59, s59, 15
  s_lshr_b32 s28, s41, 3
  v_mfma_f32_32x32x16_bf16 v[104:119], v[156:159], v[160:163], v[104:119]
  buffer_load_dwordx4 v11, s[44:47], s52 offen offset:3072 lds
  s_add_u32 s52, s52, 128
  s_and_b32 s52, s52, 0x7ff
  s_lshl_b32 s28, s28, 10
  s_add_u32 s59, s59, s28
  v_add_u32 v124, s59, v124
  v_xor_b32 v126, 262144, v124
  v_xor_b32 v125, 64, v124
  v_xor_b32 v127, 64, v126
  s_waitcnt vmcnt(38) lgkmcnt(0)
  s_barrier
  v_mfma_f32_32x32x16_bf16 v[40:55], v[168:171], v[176:179], v[40:55]
  ds_read_b128 v[120:123], v16 offset:32768
  ds_read_b128 v[160:163], v20 offset:32768
  v_add_u32 v125, 15360, v125
  v_add_u32 v127, 15360, v127
  s_and_b32 s28, s40, 7
  s_lshl_b32 s28, s28, 7
  s_lshl_b32 s43, s3, 12
  v_mfma_f32_32x32x16_bf16 v[88:103], v[168:171], v[180:183], v[88:103]
  ds_read_b128 v[156:159], v16 offset:36864
  ds_read_b128 v[164:167], v20 offset:36864
  v_lshrrev_b32 v132, 1, v2
  v_xor_b32 v132, v132, v3
  v_lshlrev_b32 v132, 4, v132
  v_lshl_or_b32 v132, v2, 7, v132
  v_add_u32 v128, s43, v132
  v_xor_b32 v129, 64, v128
  v_mfma_f32_32x32x16_bf16 v[140:155], v[172:175], v[180:183], v[140:155]
  s_add_u32 m0, s55, 16384
  s_nop 0
  buffer_load_dwordx4 v12, s[48:51], s52 offen offset:0 lds
  v_add_u32 v130, 0x10000, v128
  v_add_u32 v131, 0x10000, v129
  s_mov_b32 s20, s6
  s_mov_b32 s21, s7
  s_mov_b32 s22, 2101248
  v_mfma_f32_32x32x16_bf16 v[104:119], v[172:175], v[176:179], v[104:119]
  buffer_load_dwordx4 v13, s[48:51], s52 offen offset:1024 lds
  s_mov_b32 s23, 0x20000
  s_sub_u32 s76, s8, 1024
  s_subb_u32 s77, s9, 0
  s_mov_b32 s78, 2102272
  s_mov_b32 s79, 0x20000
  s_waitcnt lgkmcnt(2)
  v_mfma_f32_32x32x16_bf16 v[40:55], v[120:123], v[160:163], v[40:55]
  ds_read_b128 v[168:171], v17 offset:32768
  ds_read_b128 v[176:179], v21 offset:32768
  s_waitcnt lgkmcnt(2)
  v_mfma_f32_32x32x16_bf16 v[88:103], v[120:123], v[164:167], v[88:103]
  ds_read_b128 v[172:175], v17 offset:36864
  ds_read_b128 v[180:183], v21 offset:36864
  v_mfma_f32_32x32x16_bf16 v[140:155], v[156:159], v[164:167], v[140:155]
  buffer_load_dwordx4 v14, s[48:51], s52 offen offset:2048 lds
  v_mfma_f32_32x32x16_bf16 v[104:119], v[156:159], v[160:163], v[104:119]
  buffer_load_dwordx4 v15, s[48:51], s52 offen offset:3072 lds
  s_waitcnt lgkmcnt(2)
  v_mfma_f32_32x32x16_bf16 v[40:55], v[168:171], v[176:179], v[40:55]
  ds_read_b128 v[120:123], v18 offset:32768
  ds_read_b128 v[160:163], v22 offset:32768
  s_waitcnt lgkmcnt(2)
  v_mfma_f32_32x32x16_bf16 v[88:103], v[168:171], v[180:183], v[88:103]
  ds_read_b128 v[156:159], v18 offset:36864
  ds_read_b128 v[164:167], v22 offset:36864
  v_mfma_f32_32x32x16_bf16 v[140:155], v[172:175], v[180:183], v[140:155]
  s_add_u32 m0, s54, 16384
  s_nop 0
  buffer_load_dwordx4 v8, s[44:47], s52 offen offset:0 lds
  v_mfma_f32_32x32x16_bf16 v[104:119], v[172:175], v[176:179], v[104:119]
  buffer_load_dwordx4 v9, s[44:47], s52 offen offset:1024 lds
  s_waitcnt lgkmcnt(2)
  v_mfma_f32_32x32x16_bf16 v[40:55], v[120:123], v[160:163], v[40:55]
  ds_read_b128 v[168:171], v19 offset:32768
  ds_read_b128 v[176:179], v23 offset:32768
  s_waitcnt lgkmcnt(2)
  v_mfma_f32_32x32x16_bf16 v[88:103], v[120:123], v[164:167], v[88:103]
  ds_read_b128 v[172:175], v19 offset:36864
  ds_read_b128 v[180:183], v23 offset:36864
  v_mfma_f32_32x32x16_bf16 v[140:155], v[156:159], v[164:167], v[140:155]
  buffer_load_dwordx4 v10, s[44:47], s52 offen offset:2048 lds
  v_mfma_f32_32x32x16_bf16 v[104:119], v[156:159], v[160:163], v[104:119]
  buffer_load_dwordx4 v11, s[44:47], s52 offen offset:3072 lds
  s_add_u32 s52, s52, 128
  s_and_b32 s52, s52, 0x7ff
  s_waitcnt vmcnt(38) lgkmcnt(0)
  s_barrier
  v_mfma_f32_32x32x16_bf16 v[40:55], v[168:171], v[176:179], v[40:55]
  ds_read_b128 v[120:123], v16 offset:49152
  ds_read_b128 v[160:163], v20 offset:49152
  v_mfma_f32_32x32x16_bf16 v[88:103], v[168:171], v[180:183], v[88:103]
  ds_read_b128 v[156:159], v16 offset:53248
  ds_read_b128 v[164:167], v20 offset:53248
  v_mfma_f32_32x32x16_bf16 v[140:155], v[172:175], v[180:183], v[140:155]
  s_add_u32 m0, s55, 32768
  s_nop 0
  buffer_load_dwordx4 v12, s[48:51], s52 offen offset:0 lds
  v_mfma_f32_32x32x16_bf16 v[104:119], v[172:175], v[176:179], v[104:119]
  buffer_load_dwordx4 v13, s[48:51], s52 offen offset:1024 lds
  s_waitcnt lgkmcnt(2)
  v_mfma_f32_32x32x16_bf16 v[40:55], v[120:123], v[160:163], v[40:55]
  ds_read_b128 v[168:171], v17 offset:49152
  ds_read_b128 v[176:179], v21 offset:49152
  s_add_u32 s80, s34, 19922944
  s_addc_u32 s81, s35, 0
  s_waitcnt lgkmcnt(2)
  v_mfma_f32_32x32x16_bf16 v[88:103], v[120:123], v[164:167], v[88:103]
  ds_read_b128 v[172:175], v17 offset:53248
  ds_read_b128 v[180:183], v21 offset:53248
  s_mov_b32 s82, 32768
  s_mov_b32 s83, 0x20000
  v_mfma_f32_32x32x16_bf16 v[140:155], v[156:159], v[164:167], v[140:155]
  buffer_load_dwordx4 v14, s[48:51], s52 offen offset:2048 lds
  v_mov_b32 v132, 0
  v_mfma_f32_32x32x16_bf16 v[104:119], v[156:159], v[160:163], v[104:119]
  buffer_load_dwordx4 v15, s[48:51], s52 offen offset:3072 lds
  v_mov_b32 v133, 0
  s_waitcnt vmcnt(37)
  v_dot2c_f32_bf16 v132, v64, v80
  s_waitcnt lgkmcnt(2)
  v_mfma_f32_32x32x16_bf16 v[40:55], v[168:171], v[176:179], v[40:55]
  ds_read_b128 v[120:123], v18 offset:49152
  ds_read_b128 v[160:163], v22 offset:49152
  v_dot2c_f32_bf16 v133, v72, v80
  s_waitcnt lgkmcnt(2)
  v_mfma_f32_32x32x16_bf16 v[88:103], v[168:171], v[180:183], v[88:103]
  ds_read_b128 v[156:159], v18 offset:53248
  ds_read_b128 v[164:167], v22 offset:53248
  v_dot2c_f32_bf16 v132, v65, v81
  v_dot2c_f32_bf16 v133, v73, v81
  v_mfma_f32_32x32x16_bf16 v[140:155], v[172:175], v[180:183], v[140:155]
  s_add_u32 m0, s54, 32768
  s_nop 0
  buffer_load_dwordx4 v8, s[44:47], s52 offen offset:0 lds
  v_dot2c_f32_bf16 v132, v66, v82
  v_dot2c_f32_bf16 v133, v74, v82
  v_mfma_f32_32x32x16_bf16 v[104:119], v[172:175], v[176:179], v[104:119]
  buffer_load_dwordx4 v9, s[44:47], s52 offen offset:1024 lds
  v_dot2c_f32_bf16 v132, v67, v83
  s_waitcnt lgkmcnt(2)
  v_mfma_f32_32x32x16_bf16 v[40:55], v[120:123], v[160:163], v[40:55]
  ds_read_b128 v[168:171], v19 offset:49152
  ds_read_b128 v[176:179], v23 offset:49152
  v_dot2c_f32_bf16 v133, v75, v83
  s_waitcnt vmcnt(38)
  v_dot2c_f32_bf16 v132, v68, v84
  s_waitcnt lgkmcnt(2)
  v_mfma_f32_32x32x16_bf16 v[88:103], v[120:123], v[164:167], v[88:103]
  ds_read_b128 v[172:175], v19 offset:53248
  ds_read_b128 v[180:183], v23 offset:53248
  v_dot2c_f32_bf16 v133, v76, v84
  v_mfma_f32_32x32x16_bf16 v[140:155], v[156:159], v[164:167], v[140:155]
  buffer_load_dwordx4 v10, s[44:47], s52 offen offset:2048 lds
  v_dot2c_f32_bf16 v132, v69, v85
  v_dot2c_f32_bf16 v133, v77, v85
  v_mfma_f32_32x32x16_bf16 v[104:119], v[156:159], v[160:163], v[104:119]
  buffer_load_dwordx4 v11, s[44:47], s52 offen offset:3072 lds
  s_add_u32 s52, s52, 128
  s_and_b32 s52, s52, 0x7ff
  v_dot2c_f32_bf16 v132, v70, v86
  v_dot2c_f32_bf16 v133, v78, v86
  s_waitcnt vmcnt(16) lgkmcnt(0)
  s_barrier
  v_mfma_f32_32x32x16_bf16 v[40:55], v[168:171], v[176:179], v[40:55]
  ds_read_b128 v[120:123], v16 offset:0
  ds_read_b128 v[160:163], v20 offset:0
  v_dot2c_f32_bf16 v132, v71, v87
  v_mfma_f32_32x32x16_bf16 v[88:103], v[168:171], v[180:183], v[88:103]
  ds_read_b128 v[156:159], v16 offset:4096
  ds_read_b128 v[164:167], v20 offset:4096
  v_dot2c_f32_bf16 v133, v79, v87
  s_lshl_b32 s59, s39, 11
  v_mfma_f32_32x32x16_bf16 v[140:155], v[172:175], v[180:183], v[140:155]
  s_add_u32 m0, s55, 49152
  s_nop 0
  buffer_load_dwordx4 v12, s[48:51], s52 offen offset:0 lds
  s_lshl_b32 s6, s38, 7
  v_mfma_f32_32x32x16_bf16 v[104:119], v[172:175], v[176:179], v[104:119]
  buffer_load_dwordx4 v13, s[48:51], s52 offen offset:1024 lds
  s_add_u32 s59, s59, s6
  v_permlane32_swap_b32 v132, v133
  s_waitcnt lgkmcnt(2)
  v_mfma_f32_32x32x16_bf16 v[40:55], v[120:123], v[160:163], v[40:55]
  ds_read_b128 v[168:171], v17 offset:0
  ds_read_b128 v[176:179], v21 offset:0
  v_add_f32 v132, v132, v133
  v_mov_b32 v133, v132
  s_waitcnt lgkmcnt(2)
  v_mfma_f32_32x32x16_bf16 v[88:103], v[120:123], v[164:167], v[88:103]
  ds_read_b128 v[172:175], v17 offset:4096
  ds_read_b128 v[180:183], v21 offset:4096
  s_lshl_b32 s6, s3, 3
  v_mfma_f32_32x32x16_bf16 v[140:155], v[156:159], v[164:167], v[140:155]
  buffer_load_dwordx4 v14, s[48:51], s52 offen offset:2048 lds
  s_add_u32 s59, s59, s6
  v_permlane16_swap_b32 v132, v133
  v_mfma_f32_32x32x16_bf16 v[104:119], v[156:159], v[160:163], v[104:119]
  buffer_load_dwordx4 v15, s[48:51], s52 offen offset:3072 lds
  v_add_f32 v132, v132, v133
  s_waitcnt lgkmcnt(2)
  v_mfma_f32_32x32x16_bf16 v[40:55], v[168:171], v[176:179], v[40:55]
  ds_read_b128 v[120:123], v18 offset:0
  ds_read_b128 v[160:163], v22 offset:0
  v_add_f32 v132, v132, v132 row_ror:8 row_mask:0xf bank_mask:0xf
  s_nop 1
  v_add_f32 v132, v132, v132 row_ror:4 row_mask:0xf bank_mask:0xf
  s_waitcnt lgkmcnt(2)
  v_mfma_f32_32x32x16_bf16 v[88:103], v[168:171], v[180:183], v[88:103]
  ds_read_b128 v[156:159], v18 offset:4096
  ds_read_b128 v[164:167], v22 offset:4096
  v_add_f32 v132, v132, v132 row_ror:2 row_mask:0xf bank_mask:0xf
  s_nop 1
  v_add_f32 v132, v132, v132 row_ror:1 row_mask:0xf bank_mask:0xf
  v_mfma_f32_32x32x16_bf16 v[140:155], v[172:175], v[180:183], v[140:155]
  s_add_u32 m0, s54, 49152
  s_nop 0
  buffer_load_dwordx4 v8, s[44:47], s52 offen offset:0 lds
  v_cvt_pk_bf16_f32 v132, v132, v132
  v_mfma_f32_32x32x16_bf16 v[104:119], v[172:175], v[176:179], v[104:119]
  buffer_load_dwordx4 v9, s[44:47], s52 offen offset:1024 lds
  v_and_b32 v132, 0xffff0000, v132
  v_mul_f32 v132, 0xbfb8aa3b, v132
  s_waitcnt lgkmcnt(2)
  v_mfma_f32_32x32x16_bf16 v[40:55], v[120:123], v[160:163], v[40:55]
  ds_read_b128 v[168:171], v19 offset:0
  ds_read_b128 v[176:179], v23 offset:0
  v_exp_f32 v132, v132
  s_waitcnt lgkmcnt(2)
  v_mfma_f32_32x32x16_bf16 v[88:103], v[120:123], v[164:167], v[88:103]
  ds_read_b128 v[172:175], v19 offset:4096
  ds_read_b128 v[180:183], v23 offset:4096
  v_lshrrev_b32 v134, 3, v1
  v_add_f32 v132, 1.0, v132
  v_mfma_f32_32x32x16_bf16 v[140:155], v[156:159], v[164:167], v[140:155]
  buffer_load_dwordx4 v10, s[44:47], s52 offen offset:2048 lds
  v_rcp_f32 v132, v132
  s_mov_b32 exec_lo, 1
  s_mov_b32 exec_hi, 1
  v_cvt_pk_bf16_f32 v132, v132, v132
  v_and_b32 v132, 0xffff0000, v132
  s_add_u32 s6, s6, 131072
  v_add_u32 v134, s6, v134
  ds_write_b32 v134, v132
  s_mov_b64 exec, -1
  v_mfma_f32_32x32x16_bf16 v[104:119], v[156:159], v[160:163], v[104:119]
  buffer_load_dwordx4 v11, s[44:47], s52 offen offset:3072 lds
  s_add_u32 s52, s52, 128
  s_and_b32 s52, s52, 0x7ff
  s_waitcnt vmcnt(16) lgkmcnt(1)
  s_barrier
  v_mfma_f32_32x32x16_bf16 v[40:55], v[168:171], v[176:179], v[40:55]
  ds_read_b128 v[120:123], v16 offset:16384
  ds_read_b128 v[160:163], v20 offset:16384
  v_mfma_f32_32x32x16_bf16 v[88:103], v[168:171], v[180:183], v[88:103]
  ds_read_b128 v[156:159], v16 offset:20480
  ds_read_b128 v[164:167], v20 offset:20480
  s_cmp_lg_u32 s3, 1
  s_cbranch_scc1 gated_mix__spectral_gfnet__ssm_conv_s5__prompt_kernel_skip15
  s_getpc_b64 s[90:91]
gated_mix__spectral_gfnet__ssm_conv_s5__prompt_kernel_pc14:
  s_lshr_b32 s29, s2, 3
  s_mul_i32 s29, s29, 512
  v_min_u32 v210, 3, v1
  v_lshl_add_u32 v210, v210, 7, s29
  v_min_u32 v210, gated_mix__spectral_gfnet__ssm_conv_s5__prompt_kernel_end-gated_mix__spectral_gfnet__ssm_conv_s5__prompt_kernel_pc14, v210
  v_mov_b32 v211, 0
  v_lshl_add_u64 v[210:211], v[210:211], 0, s[90:91]
  global_load_dword v4, v[210:211], off
gated_mix__spectral_gfnet__ssm_conv_s5__prompt_kernel_skip15:
  v_mfma_f32_32x32x16_bf16 v[140:155], v[172:175], v[180:183], v[140:155]
  s_add_u32 m0, s55, 0
  s_nop 0
  buffer_load_dwordx4 v12, s[48:51], s52 offen offset:0 lds
  v_mfma_f32_32x32x16_bf16 v[104:119], v[172:175], v[176:179], v[104:119]
  buffer_load_dwordx4 v13, s[48:51], s52 offen offset:1024 lds
  s_waitcnt lgkmcnt(2)
  v_mfma_f32_32x32x16_bf16 v[40:55], v[120:123], v[160:163], v[40:55]
  ds_read_b128 v[168:171], v17 offset:16384
  ds_read_b128 v[176:179], v21 offset:16384
  v_lshlrev_b32 v64, 4, v1
  v_add_u32 v64, 147456, v64
  s_waitcnt lgkmcnt(2)
  v_mfma_f32_32x32x16_bf16 v[88:103], v[120:123], v[164:167], v[88:103]
  ds_read_b128 v[172:175], v17 offset:20480
  ds_read_b128 v[180:183], v21 offset:20480
  ds_read_b128 v[68:71], v64 offset:0
  v_mfma_f32_32x32x16_bf16 v[140:155], v[156:159], v[164:167], v[140:155]
  buffer_load_dwordx4 v14, s[48:51], s52 offen offset:2048 lds
  ds_read_b128 v[72:75], v64 offset:1024
  v_mfma_f32_32x32x16_bf16 v[104:119], v[156:159], v[160:163], v[104:119]
  buffer_load_dwordx4 v15, s[48:51], s52 offen offset:3072 lds
  ds_read_b128 a[224:227], v64 offset:2048
  s_waitcnt lgkmcnt(5)
  v_mfma_f32_32x32x16_bf16 v[40:55], v[168:171], v[176:179], v[40:55]
  ds_read_b128 v[120:123], v18 offset:16384
  ds_read_b128 v[160:163], v22 offset:16384
  ds_read_b128 a[228:231], v64 offset:3072
  s_waitcnt lgkmcnt(6)
  v_mfma_f32_32x32x16_bf16 v[88:103], v[168:171], v[180:183], v[88:103]
  ds_read_b128 v[156:159], v18 offset:20480
  ds_read_b128 v[164:167], v22 offset:20480
  ds_read_b128 a[248:251], v64 offset:4096
  v_mfma_f32_32x32x16_bf16 v[140:155], v[172:175], v[180:183], v[140:155]
  s_add_u32 m0, s54, 0
  s_nop 0
  buffer_load_dwordx4 v8, s[44:47], s52 offen offset:0 lds
  ds_read_b128 a[252:255], v64 offset:5120
  v_mfma_f32_32x32x16_bf16 v[104:119], v[172:175], v[176:179], v[104:119]
  buffer_load_dwordx4 v9, s[44:47], s52 offen offset:1024 lds
  ds_read_b128 a[232:235], v64 offset:6144
  s_waitcnt lgkmcnt(6)
  v_mfma_f32_32x32x16_bf16 v[40:55], v[120:123], v[160:163], v[40:55]
  ds_read_b128 v[168:171], v19 offset:16384
  ds_read_b128 v[176:179], v23 offset:16384
  ds_read_b128 a[236:239], v64 offset:7168
  s_waitcnt lgkmcnt(6)
  v_mfma_f32_32x32x16_bf16 v[88:103], v[120:123], v[164:167], v[88:103]
  ds_read_b128 v[172:175], v19 offset:20480
  ds_read_b128 v[180:183], v23 offset:20480
  ds_read_b128 v[76:79], v64 offset:8192
  v_mfma_f32_32x32x16_bf16 v[140:155], v[156:159], v[164:167], v[140:155]
  buffer_load_dwordx4 v10, s[44:47], s52 offen offset:2048 lds
  ds_read_b128 v[80:83], v64 offset:9216
  v_mfma_f32_32x32x16_bf16 v[104:119], v[156:159], v[160:163], v[104:119]
  buffer_load_dwordx4 v11, s[44:47], s52 offen offset:3072 lds
  s_add_u32 s52, s52, 128
  s_and_b32 s52, s52, 0x7ff
  ds_read_b128 v[84:87], v64 offset:10240
  s_waitcnt vmcnt(16) lgkmcnt(3)
  s_barrier
  v_mfma_f32_32x32x16_bf16 v[40:55], v[168:171], v[176:179], v[40:55]
  ds_read_b128 v[120:123], v16 offset:32768
  ds_read_b128 v[160:163], v20 offset:32768
  ds_read_b128 v[132:135], v64 offset:11264
  v_mfma_f32_32x32x16_bf16 v[88:103], v[168:171], v[180:183], v[88:103]
  ds_read_b128 v[156:159], v16 offset:36864
  ds_read_b128 v[164:167], v20 offset:36864
  s_cmp_lg_u32 s3, 0
  s_cbranch_scc1 gated_mix__spectral_gfnet__ssm_conv_s5__prompt_kernel_skip16
  v_lshlrev_b32 v210, 2, v2
  v_add_u32 v211, 131072, v210
  ds_read_b32 v211, v211
  s_lshl_b32 s29, s39, 11
  s_lshl_b32 s58, s38, 7
  s_add_u32 s29, s29, s58
  s_mov_b64 exec, 0xffff
  s_waitcnt lgkmcnt(0)
  buffer_store_dword v211, v210, s[80:83], s29 offen sc1
  s_mov_b64 exec, -1
gated_mix__spectral_gfnet__ssm_conv_s5__prompt_kernel_skip16:
  buffer_load_dword v208, v6, s[24:27], 0 offen sc1
  ds_read_b128 a[240:243], v64 offset:12288
  v_mfma_f32_32x32x16_bf16 v[140:155], v[172:175], v[180:183], v[140:155]
  s_add_u32 m0, s55, 16384
  s_nop 0
  buffer_load_dwordx4 v12, s[48:51], s52 offen offset:0 lds
  ds_read_b128 a[244:247], v64 offset:13312
  v_mfma_f32_32x32x16_bf16 v[104:119], v[172:175], v[176:179], v[104:119]
  buffer_load_dwordx4 v13, s[48:51], s52 offen offset:1024 lds
  ds_read_b128 v[136:139], v64 offset:14336
  s_waitcnt lgkmcnt(6)
  v_mfma_f32_32x32x16_bf16 v[40:55], v[120:123], v[160:163], v[40:55]
  ds_read_b128 v[168:171], v17 offset:32768
  ds_read_b128 v[176:179], v21 offset:32768
  ds_read_b128 v[184:187], v64 offset:15360
  s_lshl_b32 s59, s3, 9
  s_waitcnt lgkmcnt(6)
  v_mfma_f32_32x32x16_bf16 v[88:103], v[120:123], v[164:167], v[88:103]
  ds_read_b128 v[172:175], v17 offset:36864
  ds_read_b128 v[180:183], v21 offset:36864
  s_add_u32 s59, s59, s5
  v_mfma_f32_32x32x16_bf16 v[140:155], v[156:159], v[164:167], v[140:155]
  buffer_load_dwordx4 v14, s[48:51], s52 offen offset:2048 lds
  s_lshr_b32 s87, s3, 1
  v_mfma_f32_32x32x16_bf16 v[104:119], v[156:159], v[160:163], v[104:119]
  buffer_load_dwordx4 v15, s[48:51], s52 offen offset:3072 lds
  s_and_b32 s87, s87, s10
  s_waitcnt lgkmcnt(3)
  v_mfma_f32_32x32x16_bf16 v[40:55], v[168:171], v[176:179], v[40:55]
  ds_read_b128 v[120:123], v18 offset:32768
  ds_read_b128 v[160:163], v22 offset:32768
  s_mul_i32 s87, s87, 960
  s_waitcnt lgkmcnt(2)
  v_mfma_f32_32x32x16_bf16 v[88:103], v[168:171], v[180:183], v[88:103]
  ds_read_b128 v[156:159], v18 offset:36864
  ds_read_b128 v[164:167], v22 offset:36864
  s_sub_u32 s87, s59, s87
  v_mfma_f32_32x32x16_bf16 v[140:155], v[172:175], v[180:183], v[140:155]
  s_add_u32 m0, s54, 16384
  s_nop 0
  buffer_load_dwordx4 v8, s[44:47], s52 offen offset:0 lds
  s_mul_i32 s59, s87, 1026
  v_mfma_f32_32x32x16_bf16 v[104:119], v[172:175], v[176:179], v[104:119]
  buffer_load_dwordx4 v9, s[44:47], s52 offen offset:1024 lds
  s_lshl1_add_u32 s59, s4, s59
  s_waitcnt lgkmcnt(2)
  v_mfma_f32_32x32x16_bf16 v[40:55], v[120:123], v[160:163], v[40:55]
  ds_read_b128 v[168:171], v19 offset:32768
  ds_read_b128 v[176:179], v23 offset:32768
  s_sub_u32 s6, 2101256, s59
  s_waitcnt lgkmcnt(2)
  v_mfma_f32_32x32x16_bf16 v[88:103], v[120:123], v[164:167], v[88:103]
  ds_read_b128 v[172:175], v19 offset:36864
  ds_read_b128 v[180:183], v23 offset:36864
  s_and_b32 s88, s59, 2
  v_mfma_f32_32x32x16_bf16 v[140:155], v[156:159], v[164:167], v[140:155]
  buffer_load_dwordx4 v10, s[44:47], s52 offen offset:2048 lds
  s_and_b32 s59, s59, -4
  v_mfma_f32_32x32x16_bf16 v[104:119], v[156:159], v[160:163], v[104:119]
  buffer_load_dwordx4 v11, s[44:47], s52 offen offset:3072 lds
  s_add_u32 s52, s52, 128
  s_and_b32 s52, s52, 0x7ff
  s_and_b32 s6, s6, -4
  s_waitcnt vmcnt(17) lgkmcnt(0)
  s_barrier
  v_mfma_f32_32x32x16_bf16 v[40:55], v[168:171], v[176:179], v[40:55]
  ds_read_b128 v[120:123], v16 offset:49152
  ds_read_b128 v[160:163], v20 offset:49152
  s_add_u32 s7, s59, 131328
  v_mfma_f32_32x32x16_bf16 v[88:103], v[168:171], v[180:183], v[88:103]
  ds_read_b128 v[156:159], v16 offset:53248
  ds_read_b128 v[164:167], v20 offset:53248
  s_sub_u32 s8, s6, 131328
  v_mfma_f32_32x32x16_bf16 v[140:155], v[172:175], v[180:183], v[140:155]
  s_add_u32 m0, s55, 32768
  s_nop 0
  buffer_load_dwordx4 v12, s[48:51], s52 offen offset:0 lds
  s_add_u32 s9, s59, 262656
  v_mfma_f32_32x32x16_bf16 v[104:119], v[172:175], v[176:179], v[104:119]
  buffer_load_dwordx4 v13, s[48:51], s52 offen offset:1024 lds
  s_sub_u32 s32, s6, 262656
  s_waitcnt lgkmcnt(2)
  v_mfma_f32_32x32x16_bf16 v[40:55], v[120:123], v[160:163], v[40:55]
  ds_read_b128 v[168:171], v17 offset:49152
  ds_read_b128 v[176:179], v21 offset:49152
  s_add_u32 s33, s59, 393984
  s_sub_u32 s84, s6, 393984
  s_waitcnt lgkmcnt(2)
  v_mfma_f32_32x32x16_bf16 v[88:103], v[120:123], v[164:167], v[88:103]
  ds_read_b128 v[172:175], v17 offset:53248
  ds_read_b128 v[180:183], v21 offset:53248
  s_cmp_eq_u32 s87, 0
  s_cselect_b32 s87, 2101248, 0
  s_cselect_b32 s86, s10, 0
  v_mfma_f32_32x32x16_bf16 v[140:155], v[156:159], v[164:167], v[140:155]
  buffer_load_dwordx4 v14, s[48:51], s52 offen offset:2048 lds
  v_mfma_f32_32x32x16_bf16 v[104:119], v[156:159], v[160:163], v[104:119]
  buffer_load_dwordx4 v15, s[48:51], s52 offen offset:3072 lds
  s_waitcnt lgkmcnt(2)
  v_mfma_f32_32x32x16_bf16 v[40:55], v[168:171], v[176:179], v[40:55]
  ds_read_b128 v[120:123], v18 offset:49152
  ds_read_b128 v[160:163], v22 offset:49152
  s_sub_u32 s6, s6, s87
  s_waitcnt lgkmcnt(2)
  v_mfma_f32_32x32x16_bf16 v[88:103], v[168:171], v[180:183], v[88:103]
  ds_read_b128 v[156:159], v18 offset:53248
  ds_read_b128 v[164:167], v22 offset:53248
  s_lshl_b32 s85, s3, 12
  v_mfma_f32_32x32x16_bf16 v[140:155], v[172:175], v[180:183], v[140:155]
  s_add_u32 m0, s54, 32768
  s_nop 0
  buffer_load_dwordx4 v8, s[44:47], s52 offen offset:0 lds
  s_add_u32 s88, s88, s85
  v_mfma_f32_32x32x16_bf16 v[104:119], v[172:175], v[176:179], v[104:119]
  buffer_load_dwordx4 v9, s[44:47], s52 offen offset:1024 lds
  v_lshlrev_b32 v64, 4, v1
  s_waitcnt lgkmcnt(2)
  v_mfma_f32_32x32x16_bf16 v[40:55], v[120:123], v[160:163], v[40:55]
  ds_read_b128 v[168:171], v19 offset:49152
  ds_read_b128 v[176:179], v23 offset:49152
  v_lshlrev_b32 v65, 9, v3
  s_waitcnt lgkmcnt(2)
  v_mfma_f32_32x32x16_bf16 v[88:103], v[120:123], v[164:167], v[88:103]
  ds_read_b128 v[172:175], v19 offset:53248
  ds_read_b128 v[180:183], v23 offset:53248
  v_lshl_add_u32 v65, v2, 3, v65
  v_mfma_f32_32x32x16_bf16 v[140:155], v[156:159], v[164:167], v[140:155]
  buffer_load_dwordx4 v10, s[44:47], s52 offen offset:2048 lds
  v_sub_u32 v67, 3704, v65
  v_mfma_f32_32x32x16_bf16 v[104:119], v[156:159], v[160:163], v[104:119]
  buffer_load_dwordx4 v11, s[44:47], s52 offen offset:3072 lds
  s_add_u32 s52, s52, 128
  s_and_b32 s52, s52, 0x7ff
  v_cmp_lt_u32 vcc, 1, v3
  s_waitcnt vmcnt(17) lgkmcnt(0)
  s_barrier
  v_mfma_f32_32x32x16_bf16 v[40:55], v[168:171], v[176:179], v[40:55]
  ds_read_b128 v[120:123], v16 offset:0
  ds_read_b128 v[160:163], v20 offset:0
  v_cndmask_b32 v65, v65, v67, vcc
  v_mfma_f32_32x32x16_bf16 v[88:103], v[168:171], v[180:183], v[88:103]
  ds_read_b128 v[156:159], v16 offset:4096
  ds_read_b128 v[164:167], v20 offset:4096
  v_cndmask_b32 v66, 1.0, -1.0, vcc
  v_mfma_f32_32x32x16_bf16 v[140:155], v[172:175], v[180:183], v[140:155]
  s_add_u32 m0, s55, 49152
  s_nop 0
  buffer_load_dwordx4 v12, s[48:51], s52 offen offset:0 lds
  v_add_u32 v65, s88, v65
  v_mfma_f32_32x32x16_bf16 v[104:119], v[172:175], v[176:179], v[104:119]
  buffer_load_dwordx4 v13, s[48:51], s52 offen offset:1024 lds
  v_mov_b32 v188, 1050624
  s_waitcnt lgkmcnt(2)
  v_mfma_f32_32x32x16_bf16 v[40:55], v[120:123], v[160:163], v[40:55]
  ds_read_b128 v[168:171], v17 offset:0
  ds_read_b128 v[176:179], v21 offset:0
  v_mov_b32 v189, 147456
  s_cmp_lg_u32 s4, 0
  s_cbranch_scc1 gated_mix__spectral_gfnet__ssm_conv_s5__prompt_kernel_skip13
  s_sub_u32 s87, s6, 8
  v_writelane_b32 v188, s87, 0
  v_writelane_b32 v188, s59, 1
  s_mov_b32 s87, 131072
  v_writelane_b32 v189, s87, 0
  v_writelane_b32 v189, s87, 1
  s_sub_u32 s87, s8, 8
  v_writelane_b32 v188, s87, 2
  v_writelane_b32 v188, s7, 3
  s_mov_b32 s87, 0
  v_writelane_b32 v189, s87, 2
  v_writelane_b32 v189, s87, 3
  s_sub_u32 s87, s32, 8
  v_writelane_b32 v188, s87, 4
  v_writelane_b32 v188, s9, 5
  s_mov_b32 s87, 65536
  v_writelane_b32 v189, s87, 4
  v_writelane_b32 v189, s87, 5
  s_sub_u32 s87, s84, 8
  v_writelane_b32 v188, s87, 6
  v_writelane_b32 v188, s33, 7
  s_mov_b32 s87, 16384
  v_writelane_b32 v189, s87, 6
  v_writelane_b32 v189, s87, 7
  v_and_b32 v67, 1, v1
  v_lshl_add_u32 v188, v67, 10, v188
  s_and_b32 s87, s88, 2
  v_add_u32 v188, s87, v188
  v_mul_u32_u24 v67, 3064, v67
  v_add3_u32 v189, v189, v67, s88
gated_mix__spectral_gfnet__ssm_conv_s5__prompt_kernel_skip13:
  s_waitcnt lgkmcnt(2)
  v_mfma_f32_32x32x16_bf16 v[88:103], v[120:123], v[164:167], v[88:103]
  ds_read_b128 v[172:175], v17 offset:4096
  ds_read_b128 v[180:183], v21 offset:4096
  v_mfma_f32_32x32x16_bf16 v[140:155], v[156:159], v[164:167], v[140:155]
  buffer_load_dwordx4 v14, s[48:51], s52 offen offset:2048 lds
  v_mfma_f32_32x32x16_bf16 v[104:119], v[156:159], v[160:163], v[104:119]
  buffer_load_dwordx4 v15, s[48:51], s52 offen offset:3072 lds
  s_waitcnt lgkmcnt(2)
  v_mfma_f32_32x32x16_bf16 v[40:55], v[168:171], v[176:179], v[40:55]
  ds_read_b128 v[120:123], v18 offset:0
  ds_read_b128 v[160:163], v22 offset:0
  s_waitcnt lgkmcnt(2)
  v_mfma_f32_32x32x16_bf16 v[88:103], v[168:171], v[180:183], v[88:103]
  ds_read_b128 v[156:159], v18 offset:4096
  ds_read_b128 v[164:167], v22 offset:4096
  v_mfma_f32_32x32x16_bf16 v[140:155], v[172:175], v[180:183], v[140:155]
  s_add_u32 m0, s54, 49152
  s_nop 0
  buffer_load_dwordx4 v8, s[44:47], s52 offen offset:0 lds
  v_mfma_f32_32x32x16_bf16 v[104:119], v[172:175], v[176:179], v[104:119]
  buffer_load_dwordx4 v9, s[44:47], s52 offen offset:1024 lds
  s_waitcnt lgkmcnt(2)
  v_mfma_f32_32x32x16_bf16 v[40:55], v[120:123], v[160:163], v[40:55]
  ds_read_b128 v[168:171], v19 offset:0
  ds_read_b128 v[176:179], v23 offset:0
  s_waitcnt lgkmcnt(2)
  v_mfma_f32_32x32x16_bf16 v[88:103], v[120:123], v[164:167], v[88:103]
  ds_read_b128 v[172:175], v19 offset:4096
  ds_read_b128 v[180:183], v23 offset:4096
  v_mfma_f32_32x32x16_bf16 v[140:155], v[156:159], v[164:167], v[140:155]
  buffer_load_dwordx4 v10, s[44:47], s52 offen offset:2048 lds
  v_mfma_f32_32x32x16_bf16 v[104:119], v[156:159], v[160:163], v[104:119]
  buffer_load_dwordx4 v11, s[44:47], s52 offen offset:3072 lds
  s_add_u32 s52, s52, 128
  s_and_b32 s52, s52, 0x7ff
  s_waitcnt vmcnt(25)
  s_waitcnt vmcnt(16) lgkmcnt(0)
  s_barrier
  v_mfma_f32_32x32x16_bf16 v[40:55], v[168:171], v[176:179], v[40:55]
  ds_read_b128 v[120:123], v16 offset:16384
  ds_read_b128 v[160:163], v20 offset:16384
  v_mfma_f32_32x32x16_bf16 v[88:103], v[168:171], v[180:183], v[88:103]
  ds_read_b128 v[156:159], v16 offset:20480
  ds_read_b128 v[164:167], v20 offset:20480
  v_cmp_ne_u32 vcc, 1, v208
  s_nop 0
  s_cbranch_vccz gated_mix__spectral_gfnet__ssm_conv_s5__prompt_kernel_skip17
  s_mov_b32 s29, 0
gated_mix__spectral_gfnet__ssm_conv_s5__prompt_kernel_poll18:
  s_sleep 16
  buffer_load_dword v208, v6, s[24:27], 0 offen sc1
  s_waitcnt vmcnt(0)
  v_cmp_ne_u32 vcc, 1, v208
  s_nop 0
  s_cbranch_vccz gated_mix__spectral_gfnet__ssm_conv_s5__prompt_kernel_pollout19
  s_add_u32 s29, s29, 1
  s_cmp_lt_u32 s29, 1048576
  s_cbranch_scc1 gated_mix__spectral_gfnet__ssm_conv_s5__prompt_kernel_poll18
gated_mix__spectral_gfnet__ssm_conv_s5__prompt_kernel_pollout19:
gated_mix__spectral_gfnet__ssm_conv_s5__prompt_kernel_skip17:
  s_cmp_lg_u32 s3, 0
  s_cbranch_scc1 gated_mix__spectral_gfnet__ssm_conv_s5__prompt_kernel_skip20
  s_mov_b64 exec, 1
  buffer_store_dword v5, v38, s[16:19], 0 offen sc1
  s_mov_b64 exec, -1
gated_mix__spectral_gfnet__ssm_conv_s5__prompt_kernel_skip20:
  v_mfma_f32_32x32x16_bf16 v[140:155], v[172:175], v[180:183], v[140:155]
  s_add_u32 m0, s55, 0
  s_nop 0
  buffer_load_dwordx4 v12, s[48:51], s52 offen offset:0 lds
  v_mfma_f32_32x32x16_bf16 v[104:119], v[172:175], v[176:179], v[104:119]
  buffer_load_dwordx4 v13, s[48:51], s52 offen offset:1024 lds
  s_waitcnt lgkmcnt(2)
  v_mfma_f32_32x32x16_bf16 v[40:55], v[120:123], v[160:163], v[40:55]
  ds_read_b128 v[168:171], v17 offset:16384
  ds_read_b128 v[176:179], v21 offset:16384
  s_waitcnt lgkmcnt(2)
  v_mfma_f32_32x32x16_bf16 v[88:103], v[120:123], v[164:167], v[88:103]
  ds_read_b128 v[172:175], v17 offset:20480
  ds_read_b128 v[180:183], v21 offset:20480
  v_mfma_f32_32x32x16_bf16 v[140:155], v[156:159], v[164:167], v[140:155]
  buffer_load_dwordx4 v14, s[48:51], s52 offen offset:2048 lds
  v_mfma_f32_32x32x16_bf16 v[104:119], v[156:159], v[160:163], v[104:119]
  buffer_load_dwordx4 v15, s[48:51], s52 offen offset:3072 lds
  s_waitcnt lgkmcnt(2)
  v_mfma_f32_32x32x16_bf16 v[40:55], v[168:171], v[176:179], v[40:55]
  ds_read_b128 v[120:123], v18 offset:16384
  ds_read_b128 v[160:163], v22 offset:16384
  s_waitcnt lgkmcnt(2)
  v_mfma_f32_32x32x16_bf16 v[88:103], v[168:171], v[180:183], v[88:103]
  ds_read_b128 v[156:159], v18 offset:20480
  ds_read_b128 v[164:167], v22 offset:20480
  v_mfma_f32_32x32x16_bf16 v[140:155], v[172:175], v[180:183], v[140:155]
  s_add_u32 m0, s54, 0
  s_nop 0
  buffer_load_dwordx4 v8, s[44:47], s52 offen offset:0 lds
  v_mfma_f32_32x32x16_bf16 v[104:119], v[172:175], v[176:179], v[104:119]
  buffer_load_dwordx4 v9, s[44:47], s52 offen offset:1024 lds
  s_waitcnt lgkmcnt(2)
  v_mfma_f32_32x32x16_bf16 v[40:55], v[120:123], v[160:163], v[40:55]
  ds_read_b128 v[168:171], v19 offset:16384
  ds_read_b128 v[176:179], v23 offset:16384
  s_waitcnt lgkmcnt(2)
  v_mfma_f32_32x32x16_bf16 v[88:103], v[120:123], v[164:167], v[88:103]
  ds_read_b128 v[172:175], v19 offset:20480
  ds_read_b128 v[180:183], v23 offset:20480
  v_mfma_f32_32x32x16_bf16 v[140:155], v[156:159], v[164:167], v[140:155]
  buffer_load_dwordx4 v10, s[44:47], s52 offen offset:2048 lds
  v_mfma_f32_32x32x16_bf16 v[104:119], v[156:159], v[160:163], v[104:119]
  buffer_load_dwordx4 v11, s[44:47], s52 offen offset:3072 lds
  s_add_u32 s52, s52, 128
  s_and_b32 s52, s52, 0x7ff
  s_waitcnt vmcnt(16) lgkmcnt(0)
  s_barrier
  v_mfma_f32_32x32x16_bf16 v[40:55], v[168:171], v[176:179], v[40:55]
  ds_read_b128 v[120:123], v16 offset:32768
  ds_read_b128 v[160:163], v20 offset:32768
  v_mfma_f32_32x32x16_bf16 v[88:103], v[168:171], v[180:183], v[88:103]
  ds_read_b128 v[156:159], v16 offset:36864
  ds_read_b128 v[164:167], v20 offset:36864
  v_mfma_f32_32x32x16_bf16 v[140:155], v[172:175], v[180:183], v[140:155]
  s_add_u32 m0, s55, 16384
  s_nop 0
  buffer_load_dwordx4 v12, s[48:51], s52 offen offset:0 lds
  v_mfma_f32_32x32x16_bf16 v[104:119], v[172:175], v[176:179], v[104:119]
  buffer_load_dwordx4 v13, s[48:51], s52 offen offset:1024 lds
  s_waitcnt lgkmcnt(2)
  v_mfma_f32_32x32x16_bf16 v[40:55], v[120:123], v[160:163], v[40:55]
  ds_read_b128 v[168:171], v17 offset:32768
  ds_read_b128 v[176:179], v21 offset:32768
  v_lshlrev_b32 v56, 16, v56
  v_lshlrev_b32 v57, 16, v57
  s_waitcnt lgkmcnt(2)
  v_mfma_f32_32x32x16_bf16 v[88:103], v[120:123], v[164:167], v[88:103]
  ds_read_b128 v[172:175], v17 offset:36864
  ds_read_b128 v[180:183], v21 offset:36864
  v_lshlrev_b32 v58, 16, v58
  v_mfma_f32_32x32x16_bf16 v[140:155], v[156:159], v[164:167], v[140:155]
  buffer_load_dwordx4 v14, s[48:51], s52 offen offset:2048 lds
  v_mul_f32 v58, 0x3fb8aa3b, v58
  v_mfma_f32_32x32x16_bf16 v[104:119], v[156:159], v[160:163], v[104:119]
  buffer_load_dwordx4 v15, s[48:51], s52 offen offset:3072 lds
  v_exp_f32 v58, v58
  s_waitcnt lgkmcnt(2)
  v_mfma_f32_32x32x16_bf16 v[40:55], v[168:171], v[176:179], v[40:55]
  ds_read_b128 v[120:123], v18 offset:32768
  ds_read_b128 v[160:163], v22 offset:32768
  v_cvt_pk_bf16_f32 v58, v58, v58
  s_waitcnt lgkmcnt(2)
  v_mfma_f32_32x32x16_bf16 v[88:103], v[168:171], v[180:183], v[88:103]
  ds_read_b128 v[156:159], v18 offset:36864
  ds_read_b128 v[164:167], v22 offset:36864
  v_and_b32 v58, 0xffff0000, v58
  v_mul_f32 v204, v58, v56
  v_mfma_f32_32x32x16_bf16 v[140:155], v[172:175], v[180:183], v[140:155]
  s_add_u32 m0, s54, 16384
  s_nop 0
  buffer_load_dwordx4 v8, s[44:47], s52 offen offset:0 lds
  v_mul_f32 v205, v58, v57
  v_mfma_f32_32x32x16_bf16 v[104:119], v[172:175], v[176:179], v[104:119]
  buffer_load_dwordx4 v9, s[44:47], s52 offen offset:1024 lds
  v_mul_f32 v204, 0x3fb8aa3b, v204
  s_waitcnt lgkmcnt(2)
  v_mfma_f32_32x32x16_bf16 v[40:55], v[120:123], v[160:163], v[40:55]
  ds_read_b128 v[168:171], v19 offset:32768
  ds_read_b128 v[176:179], v23 offset:32768
  v_mul_f32 v205, 0.15915494, v205
  s_waitcnt lgkmcnt(2)
  v_mfma_f32_32x32x16_bf16 v[88:103], v[120:123], v[164:167], v[88:103]
  ds_read_b128 v[172:175], v19 offset:36864
  ds_read_b128 v[180:183], v23 offset:36864
  v_exp_f32 v204, v204
  v_mfma_f32_32x32x16_bf16 v[140:155], v[156:159], v[164:167], v[140:155]
  buffer_load_dwordx4 v10, s[44:47], s52 offen offset:2048 lds
  v_rndne_f32 v206, v205
  v_sub_f32 v205, v205, v206
  v_mfma_f32_32x32x16_bf16 v[104:119], v[156:159], v[160:163], v[104:119]
  buffer_load_dwordx4 v11, s[44:47], s52 offen offset:3072 lds
  s_add_u32 s52, s52, 128
  s_and_b32 s52, s52, 0x7ff
  v_cos_f32 v206, v205
  s_waitcnt vmcnt(16) lgkmcnt(0)
  s_barrier
  v_mfma_f32_32x32x16_bf16 v[40:55], v[168:171], v[176:179], v[40:55]
  ds_read_b128 v[120:123], v16 offset:49152
  ds_read_b128 v[160:163], v20 offset:49152
  v_sin_f32 v207, v205
  v_mfma_f32_32x32x16_bf16 v[88:103], v[168:171], v[180:183], v[88:103]
  ds_read_b128 v[156:159], v16 offset:53248
  ds_read_b128 v[164:167], v20 offset:53248
  v_mul_f32 v190, v204, v206
  v_mfma_f32_32x32x16_bf16 v[140:155], v[172:175], v[180:183], v[140:155]
  s_add_u32 m0, s55, 32768
  s_nop 0
  buffer_load_dwordx4 v12, s[48:51], s52 offen offset:0 lds
  v_mul_f32 v191, v204, v207
  v_mfma_f32_32x32x16_bf16 v[104:119], v[172:175], v[176:179], v[104:119]
  buffer_load_dwordx4 v13, s[48:51], s52 offen offset:1024 lds
  v_mul_f32 v204, v56, v56
  s_waitcnt lgkmcnt(2)
  v_mfma_f32_32x32x16_bf16 v[40:55], v[120:123], v[160:163], v[40:55]
  ds_read_b128 v[168:171], v17 offset:49152
  ds_read_b128 v[176:179], v21 offset:49152
  v_fma_f32 v204, v57, v57, v204
  v_rcp_f32 v204, v204
  s_waitcnt lgkmcnt(2)
  v_mfma_f32_32x32x16_bf16 v[88:103], v[120:123], v[164:167], v[88:103]
  ds_read_b128 v[172:175], v17 offset:53248
  ds_read_b128 v[180:183], v21 offset:53248
  v_add_f32 v205, -1.0, v190
  v_mfma_f32_32x32x16_bf16 v[140:155], v[156:159], v[164:167], v[140:155]
  buffer_load_dwordx4 v14, s[48:51], s52 offen offset:2048 lds
  v_add_f32 v204, v204, v204
  v_mfma_f32_32x32x16_bf16 v[104:119], v[156:159], v[160:163], v[104:119]
  buffer_load_dwordx4 v15, s[48:51], s52 offen offset:3072 lds
  v_mul_f32 v206, v205, v56
  s_waitcnt lgkmcnt(2)
  v_mfma_f32_32x32x16_bf16 v[40:55], v[168:171], v[176:179], v[40:55]
  ds_read_b128 v[120:123], v18 offset:49152
  ds_read_b128 v[160:163], v22 offset:49152
  v_fma_f32 v206, v191, v57, v206
  s_waitcnt lgkmcnt(2)
  v_mfma_f32_32x32x16_bf16 v[88:103], v[168:171], v[180:183], v[88:103]
  ds_read_b128 v[156:159], v18 offset:53248
  ds_read_b128 v[164:167], v22 offset:53248
  v_mul_f32 v207, v191, v56
  v_fma_f32 v207, -v205, v57, v207
  v_mfma_f32_32x32x16_bf16 v[140:155], v[172:175], v[180:183], v[140:155]
  s_add_u32 m0, s54, 32768
  s_nop 0
  buffer_load_dwordx4 v8, s[44:47], s52 offen offset:0 lds
  v_mul_f32 v200, v206, v204
  v_mfma_f32_32x32x16_bf16 v[104:119], v[172:175], v[176:179], v[104:119]
  buffer_load_dwordx4 v9, s[44:47], s52 offen offset:1024 lds
  v_mul_f32 v201, v207, v204
  s_waitcnt lgkmcnt(2)
  v_mfma_f32_32x32x16_bf16 v[40:55], v[120:123], v[160:163], v[40:55]
  ds_read_b128 v[168:171], v19 offset:49152
  ds_read_b128 v[176:179], v23 offset:49152
  v_mul_f32 v204, v191, v191
  s_waitcnt lgkmcnt(2)
  v_mfma_f32_32x32x16_bf16 v[88:103], v[120:123], v[164:167], v[88:103]
  ds_read_b128 v[172:175], v19 offset:53248
  ds_read_b128 v[180:183], v23 offset:53248
  v_mul_f32 v193, v190, v191
  v_mfma_f32_32x32x16_bf16 v[140:155], v[156:159], v[164:167], v[140:155]
  buffer_load_dwordx4 v10, s[44:47], s52 offen offset:2048 lds
  v_fma_f32 v192, v190, v190, -v204
  v_add_f32 v193, v193, v193
  v_mfma_f32_32x32x16_bf16 v[104:119], v[156:159], v[160:163], v[104:119]
  buffer_load_dwordx4 v11, s[44:47], s52 offen offset:3072 lds
  s_add_u32 s52, s52, 128
  s_and_b32 s52, s52, 0x7ff
  v_mul_f32 v204, v193, v193
  s_waitcnt vmcnt(16) lgkmcnt(0)
  s_barrier
  v_mfma_f32_32x32x16_bf16 v[40:55], v[168:171], v[176:179], v[40:55]
  ds_read_b128 v[120:123], v16 offset:0
  ds_read_b128 v[160:163], v20 offset:0
  v_mul_f32 v193, v192, v193
  v_mfma_f32_32x32x16_bf16 v[88:103], v[168:171], v[180:183], v[88:103]
  ds_read_b128 v[156:159], v16 offset:4096
  ds_read_b128 v[164:167], v20 offset:4096
  s_cmp_lg_u32 s3, 2
  s_cbranch_scc1 gated_mix__spectral_gfnet__ssm_conv_s5__prompt_kernel_skip22
  s_getpc_b64 s[90:91]
gated_mix__spectral_gfnet__ssm_conv_s5__prompt_kernel_pc21:
  s_lshr_b32 s29, s2, 3
  s_mul_i32 s29, s29, 512
  v_min_u32 v210, 3, v1
  v_lshl_add_u32 v210, v210, 7, s29
  v_min_u32 v210, gated_mix__spectral_gfnet__ssm_conv_s5__prompt_kernel_end-gated_mix__spectral_gfnet__ssm_conv_s5__prompt_kernel_pc21, v210
  v_mov_b32 v211, 0
  v_lshl_add_u64 v[210:211], v[210:211], 0, s[90:91]
  global_load_dword v4, v[210:211], off
gated_mix__spectral_gfnet__ssm_conv_s5__prompt_kernel_skip22:
  s_lshl_b32 s29, s36, 2
  s_add_u32 s29, s29, s3
  s_lshl_b32 s29, s29, 7
  s_add_u32 s29, s29, s37
  s_sub_u32 s58, 2048, s29
  s_and_b32 s58, s58, 2047
  s_mul_i32 s29, s29, 1026
  s_mul_i32 s58, s58, 1026
  s_sub_u32 s58, s58, s29
  v_and_b32 v208, 1, v3
  v_mul_lo_u32 v208, v208, s58
  v_lshl_add_u32 v59, v2, 7, s29
  v_add_u32 v59, v59, v208
  v_and_b32 v59, -4, v59
  s_mov_b64 exec, 0x01ff01ff
  buffer_load_dword v4, v59, s[20:23], 0 offen
  buffer_load_dword v4, v59, s[76:79], 0 offen offset:1024
  s_mov_b64 exec, -1
  v_fma_f32 v192, v192, v192, -v204
  v_mfma_f32_32x32x16_bf16 v[140:155], v[172:175], v[180:183], v[140:155]
  s_add_u32 m0, s55, 49152
  s_nop 0
  buffer_load_dwordx4 v12, s[48:51], s52 offen offset:0 lds
  v_add_f32 v193, v193, v193
  v_mfma_f32_32x32x16_bf16 v[104:119], v[172:175], v[176:179], v[104:119]
  buffer_load_dwordx4 v13, s[48:51], s52 offen offset:1024 lds
  v_mul_f32 v204, v193, v193
  s_waitcnt lgkmcnt(2)
  v_mfma_f32_32x32x16_bf16 v[40:55], v[120:123], v[160:163], v[40:55]
  ds_read_b128 v[168:171], v17 offset:0
  ds_read_b128 v[176:179], v21 offset:0
  v_mul_f32 v193, v192, v193
  v_fma_f32 v192, v192, v192, -v204
  s_waitcnt lgkmcnt(2)
  v_mfma_f32_32x32x16_bf16 v[88:103], v[120:123], v[164:167], v[88:103]
  ds_read_b128 v[172:175], v17 offset:4096
  ds_read_b128 v[180:183], v21 offset:4096
  v_add_f32 v193, v193, v193
  v_mfma_f32_32x32x16_bf16 v[140:155], v[156:159], v[164:167], v[140:155]
  buffer_load_dwordx4 v14, s[48:51], s52 offen offset:2048 lds
  v_mul_f32 v204, v193, v193
  v_mfma_f32_32x32x16_bf16 v[104:119], v[156:159], v[160:163], v[104:119]
  buffer_load_dwordx4 v15, s[48:51], s52 offen offset:3072 lds
  v_mul_f32 v193, v192, v193
  s_waitcnt lgkmcnt(2)
  v_mfma_f32_32x32x16_bf16 v[40:55], v[168:171], v[176:179], v[40:55]
  ds_read_b128 v[120:123], v18 offset:0
  ds_read_b128 v[160:163], v22 offset:0
  v_fma_f32 v192, v192, v192, -v204
  s_waitcnt lgkmcnt(2)
  v_mfma_f32_32x32x16_bf16 v[88:103], v[168:171], v[180:183], v[88:103]
  ds_read_b128 v[156:159], v18 offset:4096
  ds_read_b128 v[164:167], v22 offset:4096
  v_add_f32 v193, v193, v193
  v_mul_f32 v204, v193, v193
  v_mfma_f32_32x32x16_bf16 v[140:155], v[172:175], v[180:183], v[140:155]
  s_add_u32 m0, s54, 49152
  s_nop 0
  buffer_load_dwordx4 v8, s[44:47], s52 offen offset:0 lds
  v_mul_f32 v195, v192, v193
  v_mfma_f32_32x32x16_bf16 v[104:119], v[172:175], v[176:179], v[104:119]
  buffer_load_dwordx4 v9, s[44:47], s52 offen offset:1024 lds
  v_fma_f32 v194, v192, v192, -v204
  s_waitcnt lgkmcnt(2)
  v_mfma_f32_32x32x16_bf16 v[40:55], v[120:123], v[160:163], v[40:55]
  ds_read_b128 v[168:171], v19 offset:0
  ds_read_b128 v[176:179], v23 offset:0
  v_add_f32 v195, v195, v195
  s_waitcnt lgkmcnt(2)
  v_mfma_f32_32x32x16_bf16 v[88:103], v[120:123], v[164:167], v[88:103]
  ds_read_b128 v[172:175], v19 offset:4096
  ds_read_b128 v[180:183], v23 offset:4096
  v_mul_f32 v204, v195, v195
  v_mfma_f32_32x32x16_bf16 v[140:155], v[156:159], v[164:167], v[140:155]
  buffer_load_dwordx4 v10, s[44:47], s52 offen offset:2048 lds
  v_mul_f32 v197, v194, v195
  v_fma_f32 v196, v194, v194, -v204
  v_mfma_f32_32x32x16_bf16 v[104:119], v[156:159], v[160:163], v[104:119]
  buffer_load_dwordx4 v11, s[44:47], s52 offen offset:3072 lds
  s_add_u32 s52, s52, 128
  s_and_b32 s52, s52, 0x7ff
  v_add_f32 v197, v197, v197
  s_waitcnt vmcnt(18) lgkmcnt(0)
  s_barrier
  v_mfma_f32_32x32x16_bf16 v[40:55], v[168:171], v[176:179], v[40:55]
  ds_read_b128 v[120:123], v16 offset:16384
  ds_read_b128 v[160:163], v20 offset:16384
  v_mul_f32 v204, v197, v197
  v_mfma_f32_32x32x16_bf16 v[88:103], v[168:171], v[180:183], v[88:103]
  ds_read_b128 v[156:159], v16 offset:20480
  ds_read_b128 v[164:167], v20 offset:20480
  v_mul_f32 v203, v196, v197
  v_mfma_f32_32x32x16_bf16 v[140:155], v[172:175], v[180:183], v[140:155]
  buffer_load_dword v209, v7, s[16:19], 0 offen sc1
  s_cmp_eq_u32 s86, 0
  s_cbranch_scc1 gated_mix__spectral_gfnet__ssm_conv_s5__prompt_kernel_skip23
  s_add_u32 s29, s59, 1050624
  s_mov_b32 m0, 147456
  s_nop 0
  buffer_load_dwordx4 v64, s[20:23], s29 offen lds
  buffer_load_dwordx4 v64, s[76:79], s29 offen offset:1024 lds
  s_add_u32 s29, s6, 1050624
  s_mov_b32 m0, 149504
  s_nop 0
  buffer_load_dwordx4 v64, s[20:23], s29 offen lds
  buffer_load_dwordx4 v64, s[76:79], s29 offen offset:1024 lds
gated_mix__spectral_gfnet__ssm_conv_s5__prompt_kernel_skip23:
  s_cmp_lg_u32 s4, 0
  s_cbranch_scc1 gated_mix__spectral_gfnet__ssm_conv_s5__prompt_kernel_skip24
  s_mov_b64 exec, 0x3ff
  buffer_load_short_d16_hi v210, v188, s[20:23], 0 offen
  buffer_load_short_d16_hi v211, v188, s[76:79], 0 offen offset:1024
  s_mov_b64 exec, -1
gated_mix__spectral_gfnet__ssm_conv_s5__prompt_kernel_skip24:
  v_fma_f32 v202, v196, v196, -v204
  v_mfma_f32_32x32x16_bf16 v[104:119], v[172:175], v[176:179], v[104:119]
  s_add_u32 m0, s85, 131072
  s_nop 0
  buffer_load_dwordx4 v64, s[20:23], s59 offen offset:0 lds
  v_add_f32 v203, v203, v203
  s_waitcnt lgkmcnt(2)
  v_mfma_f32_32x32x16_bf16 v[40:55], v[120:123], v[160:163], v[40:55]
  ds_read_b128 v[168:171], v17 offset:16384
  ds_read_b128 v[176:179], v21 offset:16384
  v_mul_f32 v204, v203, v203
  v_mul_f32 v199, v202, v203
  s_waitcnt lgkmcnt(2)
  v_mfma_f32_32x32x16_bf16 v[88:103], v[120:123], v[164:167], v[88:103]
  ds_read_b128 v[172:175], v17 offset:20480
  ds_read_b128 v[180:183], v21 offset:20480
  v_fma_f32 v198, v202, v202, -v204
  v_mfma_f32_32x32x16_bf16 v[140:155], v[156:159], v[164:167], v[140:155]
  buffer_load_dwordx4 v64, s[76:79], s59 offen offset:1024 lds
  v_add_f32 v199, v199, v199
  v_mfma_f32_32x32x16_bf16 v[104:119], v[156:159], v[160:163], v[104:119]
  s_add_u32 m0, s85, 133120
  s_nop 0
  buffer_load_dwordx4 v64, s[20:23], s6 offen offset:0 lds
  v_mul_f32 v204, v199, v199
  s_waitcnt lgkmcnt(2)
  v_mfma_f32_32x32x16_bf16 v[40:55], v[168:171], v[176:179], v[40:55]
  ds_read_b128 v[120:123], v18 offset:16384
  ds_read_b128 v[160:163], v22 offset:16384
  v_mul_f32 v199, v198, v199
  s_waitcnt lgkmcnt(2)
  v_mfma_f32_32x32x16_bf16 v[88:103], v[168:171], v[180:183], v[88:103]
  ds_read_b128 v[156:159], v18 offset:20480
  ds_read_b128 v[164:167], v22 offset:20480
  v_fma_f32 v198, v198, v198, -v204
  v_add_f32 v199, v199, v199
  v_mfma_f32_32x32x16_bf16 v[140:155], v[172:175], v[180:183], v[140:155]
  buffer_load_dwordx4 v64, s[76:79], s6 offen offset:1024 lds
  v_mul_f32 v204, v199, v199
  v_mfma_f32_32x32x16_bf16 v[104:119], v[172:175], v[176:179], v[104:119]
  s_add_u32 m0, s85, 0
  s_nop 0
  buffer_load_dwordx4 v64, s[20:23], s7 offen offset:0 lds
  v_mul_f32 v199, v198, v199
  s_waitcnt lgkmcnt(2)
  v_mfma_f32_32x32x16_bf16 v[40:55], v[120:123], v[160:163], v[40:55]
  ds_read_b128 v[168:171], v19 offset:16384
  ds_read_b128 v[176:179], v23 offset:16384
  v_fma_f32 v198, v198, v198, -v204
  s_waitcnt lgkmcnt(2)
  v_mfma_f32_32x32x16_bf16 v[88:103], v[120:123], v[164:167], v[88:103]
  ds_read_b128 v[172:175], v19 offset:20480
  ds_read_b128 v[180:183], v23 offset:20480
  v_add_f32 v199, v199, v199
  v_mfma_f32_32x32x16_bf16 v[140:155], v[156:159], v[164:167], v[140:155]
  buffer_load_dwordx4 v64, s[76:79], s7 offen offset:1024 lds
  v_lshlrev_b32 v56, 3, v0
  v_add_u32 v56, 151552, v56
  v_mfma_f32_32x32x16_bf16 v[104:119], v[156:159], v[160:163], v[104:119]
  s_add_u32 m0, s85, 2048
  s_nop 0
  buffer_load_dwordx4 v64, s[20:23], s8 offen offset:0 lds
  s_sub_u32 s87, 15, s38
  s_waitcnt vmcnt(18) lgkmcnt(0)
  s_barrier
  v_mfma_f32_32x32x16_bf16 v[40:55], v[168:171], v[176:179], v[40:55]
  ds_read_b128 v[120:123], v16 offset:32768
  ds_read_b128 v[160:163], v20 offset:32768
  s_lshl_b32 s87, s87, 9
  v_mfma_f32_32x32x16_bf16 v[88:103], v[168:171], v[180:183], v[88:103]
  ds_read_b128 v[156:159], v16 offset:36864
  ds_read_b128 v[164:167], v20 offset:36864
  s_and_b32 s88, s3, 1
  v_mfma_f32_32x32x16_bf16 v[140:155], v[172:175], v[180:183], v[140:155]
  buffer_load_dwordx4 v64, s[76:79], s8 offen offset:1024 lds
  s_lshl_b32 s88, s88, 8
  v_mfma_f32_32x32x16_bf16 v[104:119], v[172:175], v[176:179], v[104:119]
  s_add_u32 m0, s85, 65536
  s_nop 0
  buffer_load_dwordx4 v64, s[20:23], s9 offen offset:0 lds
  s_add_u32 s87, s87, s88
  s_waitcnt lgkmcnt(2)
  v_mfma_f32_32x32x16_bf16 v[40:55], v[120:123], v[160:163], v[40:55]
  ds_read_b128 v[168:171], v17 offset:32768
  ds_read_b128 v[176:179], v21 offset:32768
  v_and_b32 v57, 31, v1
  v_lshl_add_u32 v57, v57, 3, s87
  s_waitcnt lgkmcnt(2)
  v_mfma_f32_32x32x16_bf16 v[88:103], v[120:123], v[164:167], v[88:103]
  ds_read_b128 v[172:175], v17 offset:36864
  ds_read_b128 v[180:183], v21 offset:36864
  s_lshl_b32 s88, s38, 1
  v_mfma_f32_32x32x16_bf16 v[140:155], v[156:159], v[164:167], v[140:155]
  buffer_load_dwordx4 v64, s[76:79], s9 offen offset:1024 lds
  s_lshr_b32 s89, s3, 1
  v_mfma_f32_32x32x16_bf16 v[104:119], v[156:159], v[160:163], v[104:119]
  s_add_u32 m0, s85, 67584
  s_nop 0
  buffer_load_dwordx4 v64, s[20:23], s32 offen offset:0 lds
  s_add_u32 s88, s88, s89
  s_waitcnt lgkmcnt(2)
  v_mfma_f32_32x32x16_bf16 v[40:55], v[168:171], v[176:179], v[40:55]
  ds_read_b128 v[120:123], v18 offset:32768
  ds_read_b128 v[160:163], v22 offset:32768
  s_lshl_b32 s87, s88, 9
  s_waitcnt lgkmcnt(2)
  v_mfma_f32_32x32x16_bf16 v[88:103], v[168:171], v[180:183], v[88:103]
  ds_read_b128 v[156:159], v18 offset:36864
  ds_read_b128 v[164:167], v22 offset:36864
  s_and_b32 s88, s88, 3
  s_lshl_b32 s88, s88, 2
  v_mfma_f32_32x32x16_bf16 v[140:155], v[172:175], v[180:183], v[140:155]
  buffer_load_dwordx4 v64, s[76:79], s32 offen offset:1024 lds
  v_xor_b32 v58, s88, v2
  v_mfma_f32_32x32x16_bf16 v[104:119], v[172:175], v[176:179], v[104:119]
  s_add_u32 m0, s85, 16384
  s_nop 0
  buffer_load_dwordx4 v64, s[20:23], s33 offen offset:0 lds
  v_lshlrev_b32 v58, 4, v58
  s_waitcnt lgkmcnt(2)
  v_mfma_f32_32x32x16_bf16 v[40:55], v[120:123], v[160:163], v[40:55]
  ds_read_b128 v[168:171], v19 offset:32768
  ds_read_b128 v[176:179], v23 offset:32768
  v_lshrrev_b32 v204, 1, v3
  s_waitcnt lgkmcnt(2)
  v_mfma_f32_32x32x16_bf16 v[88:103], v[120:123], v[164:167], v[88:103]
  ds_read_b128 v[172:175], v19 offset:36864
  ds_read_b128 v[180:183], v23 offset:36864
  v_lshl_or_b32 v58, v204, 14, v58
  v_mfma_f32_32x32x16_bf16 v[140:155], v[156:159], v[164:167], v[140:155]
  buffer_load_dwordx4 v64, s[76:79], s33 offen offset:1024 lds
  v_and_b32 v204, 1, v3
  v_lshl_or_b32 v58, v204, 19, v58
  v_mfma_f32_32x32x16_bf16 v[104:119], v[156:159], v[160:163], v[104:119]
  s_add_u32 m0, s85, 18432
  s_nop 0
  buffer_load_dwordx4 v64, s[20:23], s84 offen offset:0 lds
  s_and_b32 s89, s3, 1
  s_waitcnt vmcnt(16) lgkmcnt(0)
  s_barrier
  v_mfma_f32_32x32x16_bf16 v[40:55], v[168:171], v[176:179], v[40:55]
  ds_read_b128 v[120:123], v16 offset:49152
  ds_read_b128 v[160:163], v20 offset:49152
  s_lshl_b32 s89, s89, 8
  v_mfma_f32_32x32x16_bf16 v[88:103], v[168:171], v[180:183], v[88:103]
  ds_read_b128 v[156:159], v16 offset:53248
  ds_read_b128 v[164:167], v20 offset:53248
  s_add_u32 s87, s87, s89
  v_mfma_f32_32x32x16_bf16 v[140:155], v[172:175], v[180:183], v[140:155]
  buffer_load_dwordx4 v64, s[76:79], s84 offen offset:1024 lds
  s_lshl_b32 s89, s39, 15
  v_mfma_f32_32x32x16_bf16 v[104:119], v[172:175], v[176:179], v[104:119]
  s_add_u32 m0, s43, 81920
  s_nop 0
  buffer_load_dwordx4 v124, s[68:71], s28 offen offset:0 lds
  s_add_u32 s87, s87, s89
  s_waitcnt lgkmcnt(2)
  v_mfma_f32_32x32x16_bf16 v[40:55], v[120:123], v[160:163], v[40:55]
  ds_read_b128 v[168:171], v17 offset:49152
  ds_read_b128 v[176:179], v21 offset:49152
  s_waitcnt lgkmcnt(2)
  v_mfma_f32_32x32x16_bf16 v[88:103], v[120:123], v[164:167], v[88:103]
  ds_read_b128 v[172:175], v17 offset:53248
  ds_read_b128 v[180:183], v21 offset:53248
  v_mfma_f32_32x32x16_bf16 v[140:155], v[156:159], v[164:167], v[140:155]
  buffer_load_dwordx4 v125, s[68:71], s28 offen offset:1024 lds
  v_mfma_f32_32x32x16_bf16 v[104:119], v[156:159], v[160:163], v[104:119]
  s_add_u32 m0, s43, 83968
  s_nop 0
  buffer_load_dwordx4 v126, s[68:71], s28 offen offset:0 lds
  s_waitcnt lgkmcnt(2)
  v_mfma_f32_32x32x16_bf16 v[40:55], v[168:171], v[176:179], v[40:55]
  ds_read_b128 v[120:123], v18 offset:49152
  ds_read_b128 v[160:163], v22 offset:49152
  s_waitcnt lgkmcnt(2)
  v_mfma_f32_32x32x16_bf16 v[88:103], v[168:171], v[180:183], v[88:103]
  ds_read_b128 v[156:159], v18 offset:53248
  ds_read_b128 v[164:167], v22 offset:53248
  v_mfma_f32_32x32x16_bf16 v[140:155], v[172:175], v[180:183], v[140:155]
  buffer_load_dwordx4 v127, s[68:71], s28 offen offset:1024 lds
  v_mfma_f32_32x32x16_bf16 v[104:119], v[172:175], v[176:179], v[104:119]
  s_add_u32 m0, s43, 32768
  s_nop 0
  buffer_load_dwordx4 v124, s[72:75], s28 offen offset:0 lds
  s_waitcnt lgkmcnt(2)
  v_mfma_f32_32x32x16_bf16 v[40:55], v[120:123], v[160:163], v[40:55]
  ds_read_b128 v[168:171], v19 offset:49152
  ds_read_b128 v[176:179], v23 offset:49152
  s_waitcnt lgkmcnt(2)
  v_mfma_f32_32x32x16_bf16 v[88:103], v[120:123], v[164:167], v[88:103]
  ds_read_b128 v[172:175], v19 offset:53248
  ds_read_b128 v[180:183], v23 offset:53248
  v_mfma_f32_32x32x16_bf16 v[140:155], v[156:159], v[164:167], v[140:155]
  buffer_load_dwordx4 v125, s[72:75], s28 offen offset:1024 lds
  v_mfma_f32_32x32x16_bf16 v[104:119], v[156:159], v[160:163], v[104:119]
  s_add_u32 m0, s43, 34816
  s_nop 0
  buffer_load_dwordx4 v126, s[72:75], s28 offen offset:0 lds
  s_waitcnt lgkmcnt(2)
  v_mfma_f32_32x32x16_bf16 v[40:55], v[168:171], v[176:179], v[40:55]
  s_waitcnt lgkmcnt(0)
  v_mfma_f32_32x32x16_bf16 v[88:103], v[168:171], v[180:183], v[88:103]
  v_mfma_f32_32x32x16_bf16 v[140:155], v[172:175], v[180:183], v[140:155]
  buffer_load_dwordx4 v127, s[72:75], s28 offen offset:1024 lds
  s_add_u32 s28, s28, 128
  s_and_b32 s28, s28, 0x3ff
  v_mfma_f32_32x32x16_bf16 v[104:119], v[172:175], v[176:179], v[104:119]
  s_add_u32 m0, s43, 98304
  s_nop 0
  buffer_load_dwordx4 v124, s[68:71], s28 offen offset:0 lds
  buffer_load_dwordx4 v125, s[68:71], s28 offen offset:1024 lds
  s_nop 0
  v_pk_fma_f32 v[8:9], v[190:191], v[40:41], v[42:43] op_sel:[0,0,0] op_sel_hi:[0,1,1]
  s_nop 0
  v_pk_fma_f32 v[10:11], v[190:191], v[88:89], v[90:91] op_sel:[0,0,0] op_sel_hi:[0,1,1]
  v_pk_fma_f32 v[8:9], v[190:191], v[88:89], v[8:9] op_sel:[1,0,0] op_sel_hi:[1,1,1] neg_lo:[1,0,0] neg_hi:[1,0,0]
  v_pk_fma_f32 v[10:11], v[190:191], v[40:41], v[10:11] op_sel:[1,0,0] op_sel_hi:[1,1,1]
  v_pk_fma_f32 v[12:13], v[190:191], v[8:9], v[44:45] op_sel:[0,0,0] op_sel_hi:[0,1,1]
  v_pk_fma_f32 v[14:15], v[190:191], v[10:11], v[92:93] op_sel:[0,0,0] op_sel_hi:[0,1,1]
  v_pk_fma_f32 v[12:13], v[190:191], v[10:11], v[12:13] op_sel:[1,0,0] op_sel_hi:[1,1,1] neg_lo:[1,0,0] neg_hi:[1,0,0]
  v_pk_fma_f32 v[14:15], v[190:191], v[8:9], v[14:15] op_sel:[1,0,0] op_sel_hi:[1,1,1]
  v_pk_fma_f32 v[8:9], v[190:191], v[12:13], v[46:47] op_sel:[0,0,0] op_sel_hi:[0,1,1]
  v_pk_fma_f32 v[10:11], v[190:191], v[14:15], v[94:95] op_sel:[0,0,0] op_sel_hi:[0,1,1]
  v_pk_fma_f32 v[8:9], v[190:191], v[14:15], v[8:9] op_sel:[1,0,0] op_sel_hi:[1,1,1] neg_lo:[1,0,0] neg_hi:[1,0,0]
  v_pk_fma_f32 v[10:11], v[190:191], v[12:13], v[10:11] op_sel:[1,0,0] op_sel_hi:[1,1,1]
  v_pk_fma_f32 v[12:13], v[190:191], v[8:9], v[48:49] op_sel:[0,0,0] op_sel_hi:[0,1,1]
  v_pk_fma_f32 v[14:15], v[190:191], v[10:11], v[96:97] op_sel:[0,0,0] op_sel_hi:[0,1,1]
  v_pk_fma_f32 v[12:13], v[190:191], v[10:11], v[12:13] op_sel:[1,0,0] op_sel_hi:[1,1,1] neg_lo:[1,0,0] neg_hi:[1,0,0]
  v_pk_fma_f32 v[14:15], v[190:191], v[8:9], v[14:15] op_sel:[1,0,0] op_sel_hi:[1,1,1]
  s_add_u32 m0, s43, 100352
  s_nop 0
  buffer_load_dwordx4 v126, s[68:71], s28 offen offset:0 lds
  v_pk_fma_f32 v[8:9], v[190:191], v[12:13], v[50:51] op_sel:[0,0,0] op_sel_hi:[0,1,1]
  v_pk_fma_f32 v[10:11], v[190:191], v[14:15], v[98:99] op_sel:[0,0,0] op_sel_hi:[0,1,1]
  v_pk_fma_f32 v[8:9], v[190:191], v[14:15], v[8:9] op_sel:[1,0,0] op_sel_hi:[1,1,1] neg_lo:[1,0,0] neg_hi:[1,0,0]
  v_pk_fma_f32 v[10:11], v[190:191], v[12:13], v[10:11] op_sel:[1,0,0] op_sel_hi:[1,1,1]
  v_pk_fma_f32 v[12:13], v[190:191], v[8:9], v[52:53] op_sel:[0,0,0] op_sel_hi:[0,1,1]
  v_pk_fma_f32 v[14:15], v[190:191], v[10:11], v[100:101] op_sel:[0,0,0] op_sel_hi:[0,1,1]
  v_pk_fma_f32 v[12:13], v[190:191], v[10:11], v[12:13] op_sel:[1,0,0] op_sel_hi:[1,1,1] neg_lo:[1,0,0] neg_hi:[1,0,0]
  v_pk_fma_f32 v[14:15], v[190:191], v[8:9], v[14:15] op_sel:[1,0,0] op_sel_hi:[1,1,1]
  v_pk_fma_f32 v[8:9], v[190:191], v[12:13], v[54:55] op_sel:[0,0,0] op_sel_hi:[0,1,1]
  v_pk_fma_f32 v[10:11], v[190:191], v[14:15], v[102:103] op_sel:[0,0,0] op_sel_hi:[0,1,1]
  v_pk_fma_f32 v[8:9], v[190:191], v[14:15], v[8:9] op_sel:[1,0,0] op_sel_hi:[1,1,1] neg_lo:[1,0,0] neg_hi:[1,0,0]
  v_pk_fma_f32 v[10:11], v[190:191], v[12:13], v[10:11] op_sel:[1,0,0] op_sel_hi:[1,1,1]
  v_pk_fma_f32 v[12:13], v[190:191], v[8:9], v[104:105] op_sel:[0,0,0] op_sel_hi:[0,1,1]
  v_pk_fma_f32 v[14:15], v[190:191], v[10:11], v[140:141] op_sel:[0,0,0] op_sel_hi:[0,1,1]
  v_pk_fma_f32 v[12:13], v[190:191], v[10:11], v[12:13] op_sel:[1,0,0] op_sel_hi:[1,1,1] neg_lo:[1,0,0] neg_hi:[1,0,0]
  v_pk_fma_f32 v[14:15], v[190:191], v[8:9], v[14:15] op_sel:[1,0,0] op_sel_hi:[1,1,1]
  buffer_load_dwordx4 v127, s[68:71], s28 offen offset:1024 lds
  v_pk_fma_f32 v[8:9], v[190:191], v[12:13], v[106:107] op_sel:[0,0,0] op_sel_hi:[0,1,1]
  v_pk_fma_f32 v[10:11], v[190:191], v[14:15], v[142:143] op_sel:[0,0,0] op_sel_hi:[0,1,1]
  v_pk_fma_f32 v[8:9], v[190:191], v[14:15], v[8:9] op_sel:[1,0,0] op_sel_hi:[1,1,1] neg_lo:[1,0,0] neg_hi:[1,0,0]
  v_pk_fma_f32 v[10:11], v[190:191], v[12:13], v[10:11] op_sel:[1,0,0] op_sel_hi:[1,1,1]
  v_pk_fma_f32 v[12:13], v[190:191], v[8:9], v[108:109] op_sel:[0,0,0] op_sel_hi:[0,1,1]
  v_pk_fma_f32 v[14:15], v[190:191], v[10:11], v[144:145] op_sel:[0,0,0] op_sel_hi:[0,1,1]
  v_pk_fma_f32 v[12:13], v[190:191], v[10:11], v[12:13] op_sel:[1,0,0] op_sel_hi:[1,1,1] neg_lo:[1,0,0] neg_hi:[1,0,0]
  v_pk_fma_f32 v[14:15], v[190:191], v[8:9], v[14:15] op_sel:[1,0,0] op_sel_hi:[1,1,1]
  v_pk_fma_f32 v[8:9], v[190:191], v[12:13], v[110:111] op_sel:[0,0,0] op_sel_hi:[0,1,1]
  v_pk_fma_f32 v[10:11], v[190:191], v[14:15], v[146:147] op_sel:[0,0,0] op_sel_hi:[0,1,1]
  v_pk_fma_f32 v[8:9], v[190:191], v[14:15], v[8:9] op_sel:[1,0,0] op_sel_hi:[1,1,1] neg_lo:[1,0,0] neg_hi:[1,0,0]
  v_pk_fma_f32 v[10:11], v[190:191], v[12:13], v[10:11] op_sel:[1,0,0] op_sel_hi:[1,1,1]
  v_pk_fma_f32 v[12:13], v[190:191], v[8:9], v[112:113] op_sel:[0,0,0] op_sel_hi:[0,1,1]
  v_pk_fma_f32 v[14:15], v[190:191], v[10:11], v[148:149] op_sel:[0,0,0] op_sel_hi:[0,1,1]
  v_pk_fma_f32 v[12:13], v[190:191], v[10:11], v[12:13] op_sel:[1,0,0] op_sel_hi:[1,1,1] neg_lo:[1,0,0] neg_hi:[1,0,0]
  v_pk_fma_f32 v[14:15], v[190:191], v[8:9], v[14:15] op_sel:[1,0,0] op_sel_hi:[1,1,1]
  v_pk_fma_f32 v[8:9], v[190:191], v[12:13], v[114:115] op_sel:[0,0,0] op_sel_hi:[0,1,1]
  v_pk_fma_f32 v[10:11], v[190:191], v[14:15], v[150:151] op_sel:[0,0,0] op_sel_hi:[0,1,1]
  v_pk_fma_f32 v[8:9], v[190:191], v[14:15], v[8:9] op_sel:[1,0,0] op_sel_hi:[1,1,1] neg_lo:[1,0,0] neg_hi:[1,0,0]
  v_pk_fma_f32 v[10:11], v[190:191], v[12:13], v[10:11] op_sel:[1,0,0] op_sel_hi:[1,1,1]
  v_pk_fma_f32 v[12:13], v[190:191], v[8:9], v[116:117] op_sel:[0,0,0] op_sel_hi:[0,1,1]
  v_pk_fma_f32 v[14:15], v[190:191], v[10:11], v[152:153] op_sel:[0,0,0] op_sel_hi:[0,1,1]
  v_pk_fma_f32 v[12:13], v[190:191], v[10:11], v[12:13] op_sel:[1,0,0] op_sel_hi:[1,1,1] neg_lo:[1,0,0] neg_hi:[1,0,0]
  v_pk_fma_f32 v[14:15], v[190:191], v[8:9], v[14:15] op_sel:[1,0,0] op_sel_hi:[1,1,1]
  v_pk_fma_f32 v[8:9], v[190:191], v[12:13], v[118:119] op_sel:[0,0,0] op_sel_hi:[0,1,1]
  v_pk_fma_f32 v[10:11], v[190:191], v[14:15], v[154:155] op_sel:[0,0,0] op_sel_hi:[0,1,1]
  v_pk_fma_f32 v[8:9], v[190:191], v[14:15], v[8:9] op_sel:[1,0,0] op_sel_hi:[1,1,1] neg_lo:[1,0,0] neg_hi:[1,0,0]
  v_pk_fma_f32 v[10:11], v[190:191], v[12:13], v[10:11] op_sel:[1,0,0] op_sel_hi:[1,1,1]
  v_fma_f32 v12, v192, v8, v9
  v_fma_f32 v13, v192, v10, v11
  v_fma_f32 v12, -v193, v10, v12
  v_fma_f32 v13, v193, v8, v13
  v_mov_b32 v14, v12
  v_mov_b32 v15, v13
  s_nop 0
  v_permlane32_swap_b32 v12, v14
  v_permlane32_swap_b32 v13, v15
  v_fma_f32 v14, v194, v12, v14
  v_fma_f32 v15, v194, v13, v15
  v_fma_f32 v14, -v195, v13, v14
  v_fma_f32 v15, v195, v12, v15
  ds_write_b64 v56, v[14:15]
  s_waitcnt vmcnt(28)
  v_cmp_ne_u32 vcc, 1, v209
  s_nop 0
  s_cbranch_vccz gated_mix__spectral_gfnet__ssm_conv_s5__prompt_kernel_skip25
  s_mov_b32 s29, 0
gated_mix__spectral_gfnet__ssm_conv_s5__prompt_kernel_poll26:
  s_sleep 16
  buffer_load_dword v209, v7, s[16:19], 0 offen sc1
  s_waitcnt vmcnt(0)
  v_cmp_ne_u32 vcc, 1, v209
  s_nop 0
  s_cbranch_vccz gated_mix__spectral_gfnet__ssm_conv_s5__prompt_kernel_pollout27
  s_add_u32 s29, s29, 1
  s_cmp_lt_u32 s29, 1048576
  s_cbranch_scc1 gated_mix__spectral_gfnet__ssm_conv_s5__prompt_kernel_poll26
gated_mix__spectral_gfnet__ssm_conv_s5__prompt_kernel_pollout27:
gated_mix__spectral_gfnet__ssm_conv_s5__prompt_kernel_skip25:
  s_waitcnt lgkmcnt(0)
  s_barrier
  v_and_b32 v56, 0xfffffbff, v56
  ds_read_b64 v[208:209], v56
  s_cmp_lt_u32 s3, 2
  s_cbranch_scc1 gated_mix__spectral_gfnet__ssm_conv_s5__prompt_kernel_skip28
  s_waitcnt lgkmcnt(0)
  v_fma_f32 v14, v196, v208, v14
  s_waitcnt lgkmcnt(0)
  v_fma_f32 v15, v196, v209, v15
  s_waitcnt lgkmcnt(0)
  v_fma_f32 v14, -v197, v209, v14
  s_waitcnt lgkmcnt(0)
  v_fma_f32 v15, v197, v208, v15
  v_min_u32 v14, -2, v14
  v_min_u32 v15, -2, v15
  s_mov_b32 exec_hi, 0
  buffer_store_dwordx2 v[14:15], v57, s[64:67], 0 offen sc1
  s_mov_b64 exec, -1
gated_mix__spectral_gfnet__ssm_conv_s5__prompt_kernel_skip28:
  v_lshrrev_b32 v6, 5, v1
  v_lshl_add_u32 v57, v6, 12, v57
  v_add_u32 v57, 512, v57
  v_and_b32 v14, 3, v2
  v_lshlrev_b32 v6, 6, v14
  v_lshrrev_b32 v14, 2, v2
  v_lshl_or_b32 v6, v14, 4, v6
  v_lshl_or_b32 v6, v3, 12, v6
  s_mul_i32 s29, s11, 16384
  s_lshl_b32 s58, s3, 8
  s_add_u32 s29, s29, s58
  buffer_load_dwordx4 v[16:19], v6, s[12:15], s29 offen offset:0 sc1
  buffer_load_dwordx4 v[20:23], v6, s[12:15], s29 offen offset:1024 sc1
  buffer_load_dwordx4 v[120:123], v6, s[12:15], s29 offen offset:2048 sc1
  buffer_load_dwordx4 v[156:159], v6, s[12:15], s29 offen offset:3072 sc1
  s_waitcnt vmcnt(16)
  s_cmp_lg_u32 s4, 0
  s_cbranch_scc1 gated_mix__spectral_gfnet__ssm_conv_s5__prompt_kernel_skip29
  s_mul_i32 exec_lo, s86, 0x300
  s_or_b32 exec_lo, exec_lo, 0xff
  s_mov_b32 exec_hi, 0
  ds_read_u16_d16_hi v216, v189
  ds_read_u16_d16_hi v217, v189 offset:1024
  s_waitcnt lgkmcnt(1)
  v_add_f32 v216, v216, v210
  s_waitcnt lgkmcnt(0)
  v_sub_f32 v217, v217, v211
  v_mul_f32 v216, 0.5, v216
  v_mul_f32 v217, 0.5, v217
  v_cvt_pk_bf16_f32 v216, v216, v217
  ds_write_b16 v189, v216
  ds_write_b16_d16_hi v189, v216 offset:1024
  s_mov_b64 exec, -1
gated_mix__spectral_gfnet__ssm_conv_s5__prompt_kernel_skip29:
  s_cmp_eq_u32 s86, 0
  s_cbranch_scc1 gated_mix__spectral_gfnet__ssm_conv_s5__prompt_kernel_skip30
  v_add_u32 v64, 147456, v65
  ds_read_u16_d16_hi v216, v64 offset:0
  ds_read_u16_d16_hi v220, v64 offset:1024
  ds_read_u16_d16_hi v217, v64 offset:128
  ds_read_u16_d16_hi v221, v64 offset:1152
  ds_read_u16_d16_hi v218, v64 offset:256
  ds_read_u16_d16_hi v222, v64 offset:1280
  ds_read_u16_d16_hi v219, v64 offset:384
  ds_read_u16_d16_hi v223, v64 offset:1408
gated_mix__spectral_gfnet__ssm_conv_s5__prompt_kernel_skip30:
  v_add_u32 v64, 131072, v65
  ds_read_u16_d16_hi v160, v64 offset:0
  ds_read_u16_d16_hi v164, v64 offset:1024
  ds_read_u16_d16_hi v161, v64 offset:128
  ds_read_u16_d16_hi v165, v64 offset:1152
  ds_read_u16_d16_hi v162, v64 offset:256
  ds_read_u16_d16_hi v166, v64 offset:1280
  ds_read_u16_d16_hi v163, v64 offset:384
  ds_read_u16_d16_hi v167, v64 offset:1408
  ds_read_u16_d16_hi v168, v65 offset:0
  ds_read_u16_d16_hi v172, v65 offset:1024
  ds_read_u16_d16_hi v169, v65 offset:128
  ds_read_u16_d16_hi v173, v65 offset:1152
  ds_read_u16_d16_hi v170, v65 offset:256
  ds_read_u16_d16_hi v174, v65 offset:1280
  ds_read_u16_d16_hi v171, v65 offset:384
  ds_read_u16_d16_hi v175, v65 offset:1408
  v_add_u32 v64, 65536, v65
  ds_read_u16_d16_hi v176, v64 offset:0
  ds_read_u16_d16_hi v180, v64 offset:1024
  ds_read_u16_d16_hi v177, v64 offset:128
  s_waitcnt vmcnt(12)
  ds_read_b128 a[0:3], v130 offset:16384
  ds_read_b128 a[4:7], v131 offset:16384
  ds_read_b128 a[8:11], v130 offset:18432
  ds_read_b128 a[12:15], v131 offset:18432
  s_add_u32 m0, s43, 114688
  s_nop 0
  buffer_load_dwordx4 v124, s[72:75], s28 offen offset:0 lds
  ds_read_u16_d16_hi v181, v64 offset:1152
  ds_read_u16_d16_hi v178, v64 offset:256
  ds_read_u16_d16_hi v182, v64 offset:1280
  ds_read_u16_d16_hi v179, v64 offset:384
  ds_read_u16_d16_hi v183, v64 offset:1408
  ds_read_u16_d16_hi v204, v65 offset:16384
  ds_read_u16_d16_hi v212, v65 offset:17408
  ds_read_u16_d16_hi v205, v65 offset:16512
  ds_read_u16_d16_hi v213, v65 offset:17536
  ds_read_u16_d16_hi v206, v65 offset:16640
  ds_read_u16_d16_hi v214, v65 offset:17664
  ds_read_u16_d16_hi v207, v65 offset:16768
  ds_read_u16_d16_hi v215, v65 offset:17792
  v_pk_mul_f32 v[226:227], v[200:201], v[40:41] op_sel:[1,0] op_sel_hi:[1,1]
  v_pk_mul_f32 v[40:41], v[200:201], v[40:41] op_sel:[0,0] op_sel_hi:[0,1]
  v_pk_fma_f32 v[40:41], v[200:201], v[88:89], v[40:41] op_sel:[1,0,0] op_sel_hi:[1,1,1] neg_lo:[1,0,0] neg_hi:[1,0,0]
  v_pk_fma_f32 v[88:89], v[200:201], v[88:89], v[226:227] op_sel:[0,0,0] op_sel_hi:[0,1,1]
  v_pk_mul_f32 v[224:225], v[200:201], v[42:43] op_sel:[1,0] op_sel_hi:[1,1]
  buffer_load_dwordx4 v125, s[72:75], s28 offen offset:1024 lds
  v_pk_mul_f32 v[42:43], v[200:201], v[42:43] op_sel:[0,0] op_sel_hi:[0,1]
  v_pk_fma_f32 v[42:43], v[200:201], v[90:91], v[42:43] op_sel:[1,0,0] op_sel_hi:[1,1,1] neg_lo:[1,0,0] neg_hi:[1,0,0]
  v_pk_fma_f32 v[90:91], v[200:201], v[90:91], v[224:225] op_sel:[0,0,0] op_sel_hi:[0,1,1]
  v_pk_mul_f32 v[226:227], v[200:201], v[44:45] op_sel:[1,0] op_sel_hi:[1,1]
  v_pk_mul_f32 v[44:45], v[200:201], v[44:45] op_sel:[0,0] op_sel_hi:[0,1]
  v_pk_fma_f32 v[44:45], v[200:201], v[92:93], v[44:45] op_sel:[1,0,0] op_sel_hi:[1,1,1] neg_lo:[1,0,0] neg_hi:[1,0,0]
  v_pk_fma_f32 v[92:93], v[200:201], v[92:93], v[226:227] op_sel:[0,0,0] op_sel_hi:[0,1,1]
  v_pk_mul_f32 v[224:225], v[200:201], v[46:47] op_sel:[1,0] op_sel_hi:[1,1]
  v_pk_mul_f32 v[46:47], v[200:201], v[46:47] op_sel:[0,0] op_sel_hi:[0,1]
  v_pk_fma_f32 v[46:47], v[200:201], v[94:95], v[46:47] op_sel:[1,0,0] op_sel_hi:[1,1,1] neg_lo:[1,0,0] neg_hi:[1,0,0]
  v_pk_fma_f32 v[94:95], v[200:201], v[94:95], v[224:225] op_sel:[0,0,0] op_sel_hi:[0,1,1]
  v_pk_mul_f32 v[226:227], v[200:201], v[48:49] op_sel:[1,0] op_sel_hi:[1,1]
  v_pk_mul_f32 v[48:49], v[200:201], v[48:49] op_sel:[0,0] op_sel_hi:[0,1]
  v_pk_fma_f32 v[48:49], v[200:201], v[96:97], v[48:49] op_sel:[1,0,0] op_sel_hi:[1,1,1] neg_lo:[1,0,0] neg_hi:[1,0,0]
  v_pk_fma_f32 v[96:97], v[200:201], v[96:97], v[226:227] op_sel:[0,0,0] op_sel_hi:[0,1,1]
  v_pk_mul_f32 v[224:225], v[200:201], v[50:51] op_sel:[1,0] op_sel_hi:[1,1]
  v_pk_mul_f32 v[50:51], v[200:201], v[50:51] op_sel:[0,0] op_sel_hi:[0,1]
  v_pk_fma_f32 v[50:51], v[200:201], v[98:99], v[50:51] op_sel:[1,0,0] op_sel_hi:[1,1,1] neg_lo:[1,0,0] neg_hi:[1,0,0]
  s_add_u32 m0, s43, 116736
  s_nop 0
  buffer_load_dwordx4 v126, s[72:75], s28 offen offset:0 lds
  v_pk_fma_f32 v[98:99], v[200:201], v[98:99], v[224:225] op_sel:[0,0,0] op_sel_hi:[0,1,1]
  v_pk_mul_f32 v[226:227], v[200:201], v[52:53] op_sel:[1,0] op_sel_hi:[1,1]
  v_pk_mul_f32 v[52:53], v[200:201], v[52:53] op_sel:[0,0] op_sel_hi:[0,1]
  v_pk_fma_f32 v[52:53], v[200:201], v[100:101], v[52:53] op_sel:[1,0,0] op_sel_hi:[1,1,1] neg_lo:[1,0,0] neg_hi:[1,0,0]
  v_pk_fma_f32 v[100:101], v[200:201], v[100:101], v[226:227] op_sel:[0,0,0] op_sel_hi:[0,1,1]
  v_pk_mul_f32 v[224:225], v[200:201], v[54:55] op_sel:[1,0] op_sel_hi:[1,1]
  v_pk_mul_f32 v[54:55], v[200:201], v[54:55] op_sel:[0,0] op_sel_hi:[0,1]
  v_pk_fma_f32 v[54:55], v[200:201], v[102:103], v[54:55] op_sel:[1,0,0] op_sel_hi:[1,1,1] neg_lo:[1,0,0] neg_hi:[1,0,0]
  v_pk_fma_f32 v[102:103], v[200:201], v[102:103], v[224:225] op_sel:[0,0,0] op_sel_hi:[0,1,1]
  v_pk_mul_f32 v[226:227], v[200:201], v[104:105] op_sel:[1,0] op_sel_hi:[1,1]
  v_pk_mul_f32 v[104:105], v[200:201], v[104:105] op_sel:[0,0] op_sel_hi:[0,1]
  v_pk_fma_f32 v[104:105], v[200:201], v[140:141], v[104:105] op_sel:[1,0,0] op_sel_hi:[1,1,1] neg_lo:[1,0,0] neg_hi:[1,0,0]
  v_pk_fma_f32 v[140:141], v[200:201], v[140:141], v[226:227] op_sel:[0,0,0] op_sel_hi:[0,1,1]
  v_pk_mul_f32 v[224:225], v[200:201], v[106:107] op_sel:[1,0] op_sel_hi:[1,1]
  v_pk_mul_f32 v[106:107], v[200:201], v[106:107] op_sel:[0,0] op_sel_hi:[0,1]
  v_pk_fma_f32 v[106:107], v[200:201], v[142:143], v[106:107] op_sel:[1,0,0] op_sel_hi:[1,1,1] neg_lo:[1,0,0] neg_hi:[1,0,0]
  v_pk_fma_f32 v[142:143], v[200:201], v[142:143], v[224:225] op_sel:[0,0,0] op_sel_hi:[0,1,1]
  v_pk_mul_f32 v[226:227], v[200:201], v[108:109] op_sel:[1,0] op_sel_hi:[1,1]
  buffer_load_dwordx4 v127, s[72:75], s28 offen offset:1024 lds
  s_add_u32 s28, s28, 128
  s_and_b32 s28, s28, 0x3ff
  v_pk_mul_f32 v[108:109], v[200:201], v[108:109] op_sel:[0,0] op_sel_hi:[0,1]
  v_pk_fma_f32 v[108:109], v[200:201], v[144:145], v[108:109] op_sel:[1,0,0] op_sel_hi:[1,1,1] neg_lo:[1,0,0] neg_hi:[1,0,0]
  v_pk_fma_f32 v[144:145], v[200:201], v[144:145], v[226:227] op_sel:[0,0,0] op_sel_hi:[0,1,1]
  v_pk_mul_f32 v[224:225], v[200:201], v[110:111] op_sel:[1,0] op_sel_hi:[1,1]
  v_pk_mul_f32 v[110:111], v[200:201], v[110:111] op_sel:[0,0] op_sel_hi:[0,1]
  v_pk_fma_f32 v[110:111], v[200:201], v[146:147], v[110:111] op_sel:[1,0,0] op_sel_hi:[1,1,1] neg_lo:[1,0,0] neg_hi:[1,0,0]
  v_pk_fma_f32 v[146:147], v[200:201], v[146:147], v[224:225] op_sel:[0,0,0] op_sel_hi:[0,1,1]
  v_pk_mul_f32 v[226:227], v[200:201], v[112:113] op_sel:[1,0] op_sel_hi:[1,1]
  v_pk_mul_f32 v[112:113], v[200:201], v[112:113] op_sel:[0,0] op_sel_hi:[0,1]
  v_pk_fma_f32 v[112:113], v[200:201], v[148:149], v[112:113] op_sel:[1,0,0] op_sel_hi:[1,1,1] neg_lo:[1,0,0] neg_hi:[1,0,0]
  v_pk_fma_f32 v[148:149], v[200:201], v[148:149], v[226:227] op_sel:[0,0,0] op_sel_hi:[0,1,1]
  v_pk_mul_f32 v[224:225], v[200:201], v[114:115] op_sel:[1,0] op_sel_hi:[1,1]
  v_pk_mul_f32 v[114:115], v[200:201], v[114:115] op_sel:[0,0] op_sel_hi:[0,1]
  v_pk_fma_f32 v[114:115], v[200:201], v[150:151], v[114:115] op_sel:[1,0,0] op_sel_hi:[1,1,1] neg_lo:[1,0,0] neg_hi:[1,0,0]
  v_pk_fma_f32 v[150:151], v[200:201], v[150:151], v[224:225] op_sel:[0,0,0] op_sel_hi:[0,1,1]
  v_pk_mul_f32 v[226:227], v[200:201], v[116:117] op_sel:[1,0] op_sel_hi:[1,1]
  v_pk_mul_f32 v[116:117], v[200:201], v[116:117] op_sel:[0,0] op_sel_hi:[0,1]
  v_pk_fma_f32 v[116:117], v[200:201], v[152:153], v[116:117] op_sel:[1,0,0] op_sel_hi:[1,1,1] neg_lo:[1,0,0] neg_hi:[1,0,0]
  s_waitcnt vmcnt(12)
  ds_read_b128 a[16:19], v128 offset:32768
  ds_read_b128 a[20:23], v129 offset:32768
  ds_read_b128 a[24:27], v128 offset:34816
  ds_read_b128 a[28:31], v129 offset:34816
  s_waitcnt lgkmcnt(15)
  s_add_u32 m0, s43, 81920
  s_nop 0
  buffer_load_dwordx4 v124, s[68:71], s28 offen offset:0 lds
  v_pk_fma_f32 v[152:153], v[200:201], v[152:153], v[226:227] op_sel:[0,0,0] op_sel_hi:[0,1,1]
  v_pk_mul_f32 v[224:225], v[200:201], v[118:119] op_sel:[1,0] op_sel_hi:[1,1]
  v_pk_mul_f32 v[118:119], v[200:201], v[118:119] op_sel:[0,0] op_sel_hi:[0,1]
  v_pk_fma_f32 v[118:119], v[200:201], v[154:155], v[118:119] op_sel:[1,0,0] op_sel_hi:[1,1,1] neg_lo:[1,0,0] neg_hi:[1,0,0]
  v_pk_fma_f32 v[154:155], v[200:201], v[154:155], v[224:225] op_sel:[0,0,0] op_sel_hi:[0,1,1]
  v_pk_mul_f32 v[14:15], v[200:201], v[196:197] op_sel:[0,0] op_sel_hi:[0,1]
  v_pk_fma_f32 v[14:15], v[200:201], v[196:197], v[14:15] op_sel:[1,1,0] op_sel_hi:[1,0,1] neg_lo:[1,0,0]
  s_cmp_ge_u32 s3, 2
  s_cbranch_scc1 gated_mix__spectral_gfnet__ssm_conv_s5__prompt_kernel_skip31
  v_mov_b32 v14, v200
  v_mov_b32 v15, v201
  v_mov_b32 v208, 0
  v_mov_b32 v209, 0
gated_mix__spectral_gfnet__ssm_conv_s5__prompt_kernel_skip31:
  v_pk_mul_f32 v[210:211], v[194:195], v[14:15] op_sel:[0,0] op_sel_hi:[0,1]
  v_pk_fma_f32 v[210:211], v[194:195], v[14:15], v[210:211] op_sel:[1,1,0] op_sel_hi:[1,0,1] neg_lo:[1,0,0]
  v_pk_fma_f32 v[12:13], v[194:195], v[208:209], v[12:13] op_sel:[0,0,0] op_sel_hi:[0,1,1]
  v_pk_fma_f32 v[12:13], v[194:195], v[208:209], v[12:13] op_sel:[1,1,0] op_sel_hi:[1,0,1] neg_lo:[1,0,0]
  s_mov_b32 exec_lo, 0
  v_mov_b32 v14, v210
  v_mov_b32 v15, v211
  v_mov_b32 v208, v12
  v_mov_b32 v209, v13
  s_mov_b64 exec, -1
  buffer_load_dwordx4 v125, s[68:71], s28 offen offset:1024 lds
  v_mov_b32 v9, v10
  v_pk_mul_f32 v[64:65], v[192:193], v[14:15] op_sel:[0,0] op_sel_hi:[0,1]
  v_pk_fma_f32 v[64:65], v[192:193], v[14:15], v[64:65] op_sel:[1,1,0] op_sel_hi:[1,0,1] neg_lo:[1,0,0]
  v_pk_fma_f32 v[8:9], v[192:193], v[208:209], v[8:9] op_sel:[0,0,0] op_sel_hi:[0,1,1]
  v_pk_fma_f32 v[8:9], v[192:193], v[208:209], v[8:9] op_sel:[1,1,0] op_sel_hi:[1,0,1] neg_lo:[1,0,0]
  v_pk_mul_f32 v[188:189], v[200:201], v[8:9] op_sel:[0,0] op_sel_hi:[0,1]
  v_pk_fma_f32 v[188:189], v[200:201], v[8:9], v[188:189] op_sel:[1,1,0] op_sel_hi:[1,0,1] neg_lo:[1,0,0]
  v_pk_mul_f32 v[210:211], v[200:201], v[208:209] op_sel:[0,0] op_sel_hi:[0,1]
  v_pk_fma_f32 v[210:211], v[200:201], v[208:209], v[210:211] op_sel:[1,1,0] op_sel_hi:[1,0,1] neg_lo:[1,0,0]
  s_waitcnt lgkmcnt(4)
  v_pk_mul_f32 v[164:165], v[66:67], v[164:165] op_sel_hi:[0,1]
  v_pk_mul_f32 v[166:167], v[66:67], v[166:167] op_sel_hi:[0,1]
  v_pk_mul_f32 v[172:173], v[66:67], v[172:173] op_sel_hi:[0,1]
  v_pk_mul_f32 v[174:175], v[66:67], v[174:175] op_sel_hi:[0,1]
  v_pk_mul_f32 v[180:181], v[66:67], v[180:181] op_sel_hi:[0,1]
  v_pk_mul_f32 v[182:183], v[66:67], v[182:183] op_sel_hi:[0,1]
  v_pk_mul_f32 v[212:213], v[66:67], v[212:213] op_sel_hi:[0,1]
  v_pk_mul_f32 v[214:215], v[66:67], v[214:215] op_sel_hi:[0,1]
  v_pk_mul_f32 v[220:221], v[66:67], v[220:221] op_sel_hi:[0,1]
  s_add_u32 m0, s43, 83968
  s_nop 0
  buffer_load_dwordx4 v126, s[68:71], s28 offen offset:0 lds
  v_pk_mul_f32 v[222:223], v[66:67], v[222:223] op_sel_hi:[0,1]
  buffer_load_dwordx4 v127, s[68:71], s28 offen offset:1024 lds
  buffer_load_dwordx2 v[12:13], v57, s[64:67], 0 offen offset:0 sc1
  buffer_load_dwordx2 v[66:67], v57, s[64:67], 0 offen offset:512 sc1
  buffer_load_dwordx2 v[196:197], v57, s[64:67], 0 offen offset:1024 sc1
  buffer_load_dwordx2 v[208:209], v57, s[64:67], 0 offen offset:1536 sc1
  buffer_load_dwordx2 v[8:9], v57, s[64:67], 0 offen offset:2048 sc1
  buffer_load_dwordx2 v[10:11], v57, s[64:67], 0 offen offset:2560 sc1
  buffer_load_dwordx2 v[192:193], v57, s[64:67], 0 offen offset:3072 sc1
  buffer_load_dwordx2 v[194:195], v57, s[64:67], 0 offen offset:3584 sc1
  s_waitcnt lgkmcnt(0)
  s_add_u32 m0, s43, 32768
  s_nop 0
  buffer_load_dwordx4 v124, s[72:75], s28 offen offset:0 lds
  v_and_b32 v6, 7, v2
  v_lshlrev_b32 v56, 2, v3
  v_xor_b32 v6, v6, v56
  v_lshlrev_b32 v6, 4, v6
  v_lshl_or_b32 v6, v2, 10, v6
  s_lshl_b32 s29, s3, 8
  s_add_u32 s29, s29, 49152
  v_add_u32 v6, s29, v6
  s_waitcnt vmcnt(20)
  v_mov_b32 v224, v16
  s_waitcnt vmcnt(19)
  v_mov_b32 v225, v20
  s_waitcnt vmcnt(18)
  v_mov_b32 v226, v120
  s_waitcnt vmcnt(17)
  v_mov_b32 v227, v156
  v_mov_b32 v228, v17
  v_mov_b32 v229, v21
  v_mov_b32 v230, v121
  v_mov_b32 v231, v157
  v_mfma_f32_16x16x32_bf16 v[232:235], v[224:227], v[68:71], 0
  buffer_load_dwordx4 v125, s[72:75], s28 offen offset:1024 lds
  v_mfma_f32_16x16x32_bf16 v[236:239], v[224:227], v[72:75], 0
  v_mfma_f32_16x16x32_bf16 v[240:243], v[228:231], v[68:71], 0
  v_mfma_f32_16x16x32_bf16 v[244:247], v[228:231], v[72:75], 0
  v_mov_b32 v224, v18
  v_mov_b32 v225, v22
  v_mov_b32 v226, v122
  v_mov_b32 v227, v158
  v_mov_b32 v228, v19
  v_mov_b32 v229, v23
  s_add_u32 m0, s43, 34816
  s_nop 0
  buffer_load_dwordx4 v126, s[72:75], s28 offen offset:0 lds
  v_mov_b32 v230, v123
  v_mov_b32 v231, v159
  v_xor_b32 v56, 0, v6
  v_cvt_pk_bf16_f32 v156, v232, v236
  v_cvt_pk_bf16_f32 v157, v233, v237
  v_cvt_pk_bf16_f32 v158, v234, v238
  v_cvt_pk_bf16_f32 v159, v235, v239
  ds_write_b128 v56, v[156:159]
  v_mfma_f32_16x16x32_bf16 v[232:235], v[224:227], v[68:71], 0
  v_mfma_f32_16x16x32_bf16 v[236:239], v[224:227], v[72:75], 0
  v_xor_b32 v56, 16, v6
  v_cvt_pk_bf16_f32 v16, v240, v244
  buffer_load_dwordx4 v127, s[72:75], s28 offen offset:1024 lds
  s_add_u32 s28, s28, 128
  s_and_b32 s28, s28, 0x3ff
  v_cvt_pk_bf16_f32 v17, v241, v245
  v_cvt_pk_bf16_f32 v18, v242, v246
  v_cvt_pk_bf16_f32 v19, v243, v247
  ds_write_b128 v56, v[16:19]
  v_mfma_f32_16x16x32_bf16 v[240:243], v[228:231], v[68:71], 0
  v_mfma_f32_16x16x32_bf16 v[244:247], v[228:231], v[72:75], 0
  v_xor_b32 v56, 32, v6
  v_cvt_pk_bf16_f32 v20, v232, v236
  v_cvt_pk_bf16_f32 v21, v233, v237
  v_cvt_pk_bf16_f32 v22, v234, v238
  v_cvt_pk_bf16_f32 v23, v235, v239
  ds_write_b128 v56, v[20:23]
  v_xor_b32 v56, 48, v6
  s_nop 0
  v_cvt_pk_bf16_f32 v120, v240, v244
  v_cvt_pk_bf16_f32 v121, v241, v245
  v_cvt_pk_bf16_f32 v122, v242, v246
  v_cvt_pk_bf16_f32 v123, v243, v247
  ds_write_b128 v56, v[120:123]
  s_waitcnt vmcnt(4)
  v_max_u32 v6, v12, v13
  v_max3_u32 v6, v6, v66, v67
  v_max3_u32 v6, v6, v196, v197
  v_max3_u32 v6, v6, v208, v209
  v_max3_u32 v6, v6, v8, v9
  v_max3_u32 v6, v6, v10, v11
  v_max3_u32 v6, v6, v192, v193
  v_max3_u32 v6, v6, v194, v195
  v_cmp_eq_u32 vcc, -1, v6
  s_nop 0
  s_cbranch_vccz gated_mix__spectral_gfnet__ssm_conv_s5__prompt_kernel_skip32
  s_mov_b32 s29, 0
gated_mix__spectral_gfnet__ssm_conv_s5__prompt_kernel_lb33:
  buffer_load_dwordx2 v[12:13], v57, s[64:67], 0 offen offset:0 sc1
  buffer_load_dwordx2 v[66:67], v57, s[64:67], 0 offen offset:512 sc1
  buffer_load_dwordx2 v[196:197], v57, s[64:67], 0 offen offset:1024 sc1
  buffer_load_dwordx2 v[208:209], v57, s[64:67], 0 offen offset:1536 sc1
  buffer_load_dwordx2 v[8:9], v57, s[64:67], 0 offen offset:2048 sc1
  buffer_load_dwordx2 v[10:11], v57, s[64:67], 0 offen offset:2560 sc1
  buffer_load_dwordx2 v[192:193], v57, s[64:67], 0 offen offset:3072 sc1
  buffer_load_dwordx2 v[194:195], v57, s[64:67], 0 offen offset:3584 sc1
  s_waitcnt vmcnt(0)
  v_max_u32 v6, v12, v13
  v_max3_u32 v6, v6, v66, v67
  v_max3_u32 v6, v6, v196, v197
  v_max3_u32 v6, v6, v208, v209
  v_max3_u32 v6, v6, v8, v9
  v_max3_u32 v6, v6, v10, v11
  v_max3_u32 v6, v6, v192, v193
  v_max3_u32 v6, v6, v194, v195
  v_cmp_eq_u32 vcc, -1, v6
  s_nop 0
  s_cbranch_vccz gated_mix__spectral_gfnet__ssm_conv_s5__prompt_kernel_lbout34
  s_add_u32 s29, s29, 1
  s_cmp_lt_u32 s29, 1048576
  s_cbranch_scc1 gated_mix__spectral_gfnet__ssm_conv_s5__prompt_kernel_lb33
gated_mix__spectral_gfnet__ssm_conv_s5__prompt_kernel_lbout34:
gated_mix__spectral_gfnet__ssm_conv_s5__prompt_kernel_skip32:
  s_add_u32 s12, s34, 10485760
  s_addc_u32 s13, s35, 0
  s_mov_b32 s14, 8388608
  s_mov_b32 s15, 0x20000
  v_pk_fma_f32 v[192:193], v[202:203], v[194:195], v[192:193] op_sel:[0,0,0] op_sel_hi:[0,1,1]
  v_pk_fma_f32 v[192:193], v[202:203], v[194:195], v[192:193] op_sel:[1,1,0] op_sel_hi:[1,0,1] neg_lo:[1,0,0]
  v_pk_fma_f32 v[10:11], v[202:203], v[192:193], v[10:11] op_sel:[0,0,0] op_sel_hi:[0,1,1]
  v_pk_fma_f32 v[10:11], v[202:203], v[192:193], v[10:11] op_sel:[1,1,0] op_sel_hi:[1,0,1] neg_lo:[1,0,0]
  v_pk_fma_f32 v[8:9], v[202:203], v[10:11], v[8:9] op_sel:[0,0,0] op_sel_hi:[0,1,1]
  v_pk_fma_f32 v[8:9], v[202:203], v[10:11], v[8:9] op_sel:[1,1,0] op_sel_hi:[1,0,1] neg_lo:[1,0,0]
  v_pk_fma_f32 v[208:209], v[202:203], v[8:9], v[208:209] op_sel:[0,0,0] op_sel_hi:[0,1,1]
  v_pk_fma_f32 v[208:209], v[202:203], v[8:9], v[208:209] op_sel:[1,1,0] op_sel_hi:[1,0,1] neg_lo:[1,0,0]
  v_pk_fma_f32 v[196:197], v[202:203], v[208:209], v[196:197] op_sel:[0,0,0] op_sel_hi:[0,1,1]
  v_pk_fma_f32 v[196:197], v[202:203], v[208:209], v[196:197] op_sel:[1,1,0] op_sel_hi:[1,0,1] neg_lo:[1,0,0]
  v_pk_fma_f32 v[66:67], v[202:203], v[196:197], v[66:67] op_sel:[0,0,0] op_sel_hi:[0,1,1]
  v_pk_fma_f32 v[66:67], v[202:203], v[196:197], v[66:67] op_sel:[1,1,0] op_sel_hi:[1,0,1] neg_lo:[1,0,0]
  v_pk_fma_f32 v[12:13], v[202:203], v[66:67], v[12:13] op_sel:[0,0,0] op_sel_hi:[0,1,1]
  v_pk_fma_f32 v[12:13], v[202:203], v[66:67], v[12:13] op_sel:[1,1,0] op_sel_hi:[1,0,1] neg_lo:[1,0,0]
  v_mov_b32 v66, v12
  v_mov_b32 v67, v13
  s_nop 0
  v_permlane32_swap_b32 v12, v66
  v_permlane32_swap_b32 v13, v67
  v_pk_fma_f32 v[12:13], v[198:199], v[66:67], v[12:13] op_sel:[0,0,0] op_sel_hi:[0,1,1]
  v_pk_fma_f32 v[12:13], v[198:199], v[66:67], v[12:13] op_sel:[1,1,0] op_sel_hi:[1,0,1] neg_lo:[1,0,0]
  v_pk_fma_f32 v[210:211], v[14:15], v[12:13], v[210:211] op_sel:[0,0,0] op_sel_hi:[0,1,1]
  v_pk_fma_f32 v[210:211], v[14:15], v[12:13], v[210:211] op_sel:[1,1,0] op_sel_hi:[1,0,1] neg_lo:[1,0,0]
  v_pk_fma_f32 v[188:189], v[64:65], v[12:13], v[188:189] op_sel:[0,0,0] op_sel_hi:[0,1,1]
  v_pk_fma_f32 v[188:189], v[64:65], v[12:13], v[188:189] op_sel:[1,1,0] op_sel_hi:[1,0,1] neg_lo:[1,0,0]
  v_swap_b32 v211, v188
  v_pk_fma_f32 v[40:41], v[190:191], v[210:211], v[40:41] op_sel:[0,0,0] op_sel_hi:[0,1,1]
  v_pk_fma_f32 v[88:89], v[190:191], v[188:189], v[88:89] op_sel:[0,0,0] op_sel_hi:[0,1,1]
  v_pk_fma_f32 v[40:41], v[190:191], v[188:189], v[40:41] op_sel:[1,0,0] op_sel_hi:[1,1,1] neg_lo:[1,0,0] neg_hi:[1,0,0]
  v_pk_fma_f32 v[88:89], v[190:191], v[210:211], v[88:89] op_sel:[1,0,0] op_sel_hi:[1,1,1]
  v_cvt_pk_bf16_f32 v16, v40, v41
  v_cvt_pk_bf16_f32 v17, -v88, -v89
  v_pk_fma_f32 v[42:43], v[190:191], v[40:41], v[42:43] op_sel:[0,0,0] op_sel_hi:[0,1,1]
  v_pk_fma_f32 v[90:91], v[190:191], v[88:89], v[90:91] op_sel:[0,0,0] op_sel_hi:[0,1,1]
  v_pk_fma_f32 v[42:43], v[190:191], v[88:89], v[42:43] op_sel:[1,0,0] op_sel_hi:[1,1,1] neg_lo:[1,0,0] neg_hi:[1,0,0]
  v_pk_fma_f32 v[90:91], v[190:191], v[40:41], v[90:91] op_sel:[1,0,0] op_sel_hi:[1,1,1]
  v_cvt_pk_bf16_f32 v18, v42, v43
  v_cvt_pk_bf16_f32 v19, -v90, -v91
  v_pk_fma_f32 v[44:45], v[190:191], v[42:43], v[44:45] op_sel:[0,0,0] op_sel_hi:[0,1,1]
  v_pk_fma_f32 v[92:93], v[190:191], v[90:91], v[92:93] op_sel:[0,0,0] op_sel_hi:[0,1,1]
  v_permlane32_swap_b32 v16, v17
  v_permlane32_swap_b32 v18, v19
  v_pk_fma_f32 v[44:45], v[190:191], v[90:91], v[44:45] op_sel:[1,0,0] op_sel_hi:[1,1,1] neg_lo:[1,0,0] neg_hi:[1,0,0]
  v_pk_fma_f32 v[92:93], v[190:191], v[42:43], v[92:93] op_sel:[1,0,0] op_sel_hi:[1,1,1]
  v_permlane16_swap_b32 v16, v18
  v_permlane16_swap_b32 v17, v19
  buffer_store_dwordx4 v[16:19], v58, s[12:15], s87 offen sc1
  s_add_u32 s87, s87, 1048576
  v_cvt_pk_bf16_f32 v20, v44, v45
  v_cvt_pk_bf16_f32 v21, -v92, -v93
  v_pk_fma_f32 v[46:47], v[190:191], v[44:45], v[46:47] op_sel:[0,0,0] op_sel_hi:[0,1,1]
  v_pk_fma_f32 v[94:95], v[190:191], v[92:93], v[94:95] op_sel:[0,0,0] op_sel_hi:[0,1,1]
  v_pk_fma_f32 v[46:47], v[190:191], v[92:93], v[46:47] op_sel:[1,0,0] op_sel_hi:[1,1,1] neg_lo:[1,0,0] neg_hi:[1,0,0]
  v_pk_fma_f32 v[94:95], v[190:191], v[44:45], v[94:95] op_sel:[1,0,0] op_sel_hi:[1,1,1]
  v_cvt_pk_bf16_f32 v22, v46, v47
  v_cvt_pk_bf16_f32 v23, -v94, -v95
  v_pk_fma_f32 v[48:49], v[190:191], v[46:47], v[48:49] op_sel:[0,0,0] op_sel_hi:[0,1,1]
  v_pk_fma_f32 v[96:97], v[190:191], v[94:95], v[96:97] op_sel:[0,0,0] op_sel_hi:[0,1,1]
  v_permlane32_swap_b32 v20, v21
  v_permlane32_swap_b32 v22, v23
  v_pk_fma_f32 v[48:49], v[190:191], v[94:95], v[48:49] op_sel:[1,0,0] op_sel_hi:[1,1,1] neg_lo:[1,0,0] neg_hi:[1,0,0]
  v_pk_fma_f32 v[96:97], v[190:191], v[46:47], v[96:97] op_sel:[1,0,0] op_sel_hi:[1,1,1]
  v_permlane16_swap_b32 v20, v22
  v_permlane16_swap_b32 v21, v23
  buffer_store_dwordx4 v[20:23], v58, s[12:15], s87 offen sc1
  s_add_u32 s87, s87, 1048576
  v_cvt_pk_bf16_f32 v68, v48, v49
  v_cvt_pk_bf16_f32 v69, -v96, -v97
  v_pk_fma_f32 v[50:51], v[190:191], v[48:49], v[50:51] op_sel:[0,0,0] op_sel_hi:[0,1,1]
  v_pk_fma_f32 v[98:99], v[190:191], v[96:97], v[98:99] op_sel:[0,0,0] op_sel_hi:[0,1,1]
  v_pk_fma_f32 v[50:51], v[190:191], v[96:97], v[50:51] op_sel:[1,0,0] op_sel_hi:[1,1,1] neg_lo:[1,0,0] neg_hi:[1,0,0]
  v_pk_fma_f32 v[98:99], v[190:191], v[48:49], v[98:99] op_sel:[1,0,0] op_sel_hi:[1,1,1]
  v_cvt_pk_bf16_f32 v70, v50, v51
  v_cvt_pk_bf16_f32 v71, -v98, -v99
  v_pk_fma_f32 v[52:53], v[190:191], v[50:51], v[52:53] op_sel:[0,0,0] op_sel_hi:[0,1,1]
  v_pk_fma_f32 v[100:101], v[190:191], v[98:99], v[100:101] op_sel:[0,0,0] op_sel_hi:[0,1,1]
  v_permlane32_swap_b32 v68, v69
  v_permlane32_swap_b32 v70, v71
  v_pk_fma_f32 v[52:53], v[190:191], v[98:99], v[52:53] op_sel:[1,0,0] op_sel_hi:[1,1,1] neg_lo:[1,0,0] neg_hi:[1,0,0]
  v_pk_fma_f32 v[100:101], v[190:191], v[50:51], v[100:101] op_sel:[1,0,0] op_sel_hi:[1,1,1]
  v_permlane16_swap_b32 v68, v70
  v_permlane16_swap_b32 v69, v71
  buffer_store_dwordx4 v[68:71], v58, s[12:15], s87 offen sc1
  s_add_u32 s87, s87, 1048576
  v_cvt_pk_bf16_f32 v16, v52, v53
  v_cvt_pk_bf16_f32 v17, -v100, -v101
  v_pk_fma_f32 v[54:55], v[190:191], v[52:53], v[54:55] op_sel:[0,0,0] op_sel_hi:[0,1,1]
  v_pk_fma_f32 v[102:103], v[190:191], v[100:101], v[102:103] op_sel:[0,0,0] op_sel_hi:[0,1,1]
  v_pk_fma_f32 v[54:55], v[190:191], v[100:101], v[54:55] op_sel:[1,0,0] op_sel_hi:[1,1,1] neg_lo:[1,0,0] neg_hi:[1,0,0]
  v_pk_fma_f32 v[102:103], v[190:191], v[52:53], v[102:103] op_sel:[1,0,0] op_sel_hi:[1,1,1]
  v_cvt_pk_bf16_f32 v18, v54, v55
  v_cvt_pk_bf16_f32 v19, -v102, -v103
  v_pk_fma_f32 v[104:105], v[190:191], v[54:55], v[104:105] op_sel:[0,0,0] op_sel_hi:[0,1,1]
  v_pk_fma_f32 v[140:141], v[190:191], v[102:103], v[140:141] op_sel:[0,0,0] op_sel_hi:[0,1,1]
  v_permlane32_swap_b32 v16, v17
  v_permlane32_swap_b32 v18, v19
  v_pk_fma_f32 v[104:105], v[190:191], v[102:103], v[104:105] op_sel:[1,0,0] op_sel_hi:[1,1,1] neg_lo:[1,0,0] neg_hi:[1,0,0]
  v_pk_fma_f32 v[140:141], v[190:191], v[54:55], v[140:141] op_sel:[1,0,0] op_sel_hi:[1,1,1]
  v_permlane16_swap_b32 v16, v18
  v_permlane16_swap_b32 v17, v19
  buffer_store_dwordx4 v[16:19], v58, s[12:15], s87 offen sc1
  s_add_u32 s87, s87, 1048576
  v_cvt_pk_bf16_f32 v20, v104, v105
  v_cvt_pk_bf16_f32 v21, -v140, -v141
  v_pk_fma_f32 v[106:107], v[190:191], v[104:105], v[106:107] op_sel:[0,0,0] op_sel_hi:[0,1,1]
  v_pk_fma_f32 v[142:143], v[190:191], v[140:141], v[142:143] op_sel:[0,0,0] op_sel_hi:[0,1,1]
  v_pk_fma_f32 v[106:107], v[190:191], v[140:141], v[106:107] op_sel:[1,0,0] op_sel_hi:[1,1,1] neg_lo:[1,0,0] neg_hi:[1,0,0]
  v_pk_fma_f32 v[142:143], v[190:191], v[104:105], v[142:143] op_sel:[1,0,0] op_sel_hi:[1,1,1]
  v_cvt_pk_bf16_f32 v22, v106, v107
  v_cvt_pk_bf16_f32 v23, -v142, -v143
  v_pk_fma_f32 v[108:109], v[190:191], v[106:107], v[108:109] op_sel:[0,0,0] op_sel_hi:[0,1,1]
  v_pk_fma_f32 v[144:145], v[190:191], v[142:143], v[144:145] op_sel:[0,0,0] op_sel_hi:[0,1,1]
  v_permlane32_swap_b32 v20, v21
  v_permlane32_swap_b32 v22, v23
  v_pk_fma_f32 v[108:109], v[190:191], v[142:143], v[108:109] op_sel:[1,0,0] op_sel_hi:[1,1,1] neg_lo:[1,0,0] neg_hi:[1,0,0]
  v_pk_fma_f32 v[144:145], v[190:191], v[106:107], v[144:145] op_sel:[1,0,0] op_sel_hi:[1,1,1]
  v_permlane16_swap_b32 v20, v22
  v_permlane16_swap_b32 v21, v23
  buffer_store_dwordx4 v[20:23], v58, s[12:15], s87 offen sc1
  s_add_u32 s87, s87, 1048576
  v_cvt_pk_bf16_f32 v68, v108, v109
  v_cvt_pk_bf16_f32 v69, -v144, -v145
  v_pk_fma_f32 v[110:111], v[190:191], v[108:109], v[110:111] op_sel:[0,0,0] op_sel_hi:[0,1,1]
  v_pk_fma_f32 v[146:147], v[190:191], v[144:145], v[146:147] op_sel:[0,0,0] op_sel_hi:[0,1,1]
  v_pk_fma_f32 v[110:111], v[190:191], v[144:145], v[110:111] op_sel:[1,0,0] op_sel_hi:[1,1,1] neg_lo:[1,0,0] neg_hi:[1,0,0]
  v_pk_fma_f32 v[146:147], v[190:191], v[108:109], v[146:147] op_sel:[1,0,0] op_sel_hi:[1,1,1]
  v_cvt_pk_bf16_f32 v70, v110, v111
  v_cvt_pk_bf16_f32 v71, -v146, -v147
  v_pk_fma_f32 v[112:113], v[190:191], v[110:111], v[112:113] op_sel:[0,0,0] op_sel_hi:[0,1,1]
  v_pk_fma_f32 v[148:149], v[190:191], v[146:147], v[148:149] op_sel:[0,0,0] op_sel_hi:[0,1,1]
  v_permlane32_swap_b32 v68, v69
  v_permlane32_swap_b32 v70, v71
  v_pk_fma_f32 v[112:113], v[190:191], v[146:147], v[112:113] op_sel:[1,0,0] op_sel_hi:[1,1,1] neg_lo:[1,0,0] neg_hi:[1,0,0]
  v_pk_fma_f32 v[148:149], v[190:191], v[110:111], v[148:149] op_sel:[1,0,0] op_sel_hi:[1,1,1]
  v_permlane16_swap_b32 v68, v70
  v_permlane16_swap_b32 v69, v71
  buffer_store_dwordx4 v[68:71], v58, s[12:15], s87 offen sc1
  s_add_u32 s87, s87, 1048576
  v_cvt_pk_bf16_f32 v16, v112, v113
  v_cvt_pk_bf16_f32 v17, -v148, -v149
  v_pk_fma_f32 v[114:115], v[190:191], v[112:113], v[114:115] op_sel:[0,0,0] op_sel_hi:[0,1,1]
  v_pk_fma_f32 v[150:151], v[190:191], v[148:149], v[150:151] op_sel:[0,0,0] op_sel_hi:[0,1,1]
  v_pk_fma_f32 v[114:115], v[190:191], v[148:149], v[114:115] op_sel:[1,0,0] op_sel_hi:[1,1,1] neg_lo:[1,0,0] neg_hi:[1,0,0]
  v_pk_fma_f32 v[150:151], v[190:191], v[112:113], v[150:151] op_sel:[1,0,0] op_sel_hi:[1,1,1]
  v_cvt_pk_bf16_f32 v18, v114, v115
  v_cvt_pk_bf16_f32 v19, -v150, -v151
  v_pk_fma_f32 v[116:117], v[190:191], v[114:115], v[116:117] op_sel:[0,0,0] op_sel_hi:[0,1,1]
  v_pk_fma_f32 v[152:153], v[190:191], v[150:151], v[152:153] op_sel:[0,0,0] op_sel_hi:[0,1,1]
  v_permlane32_swap_b32 v16, v17
  v_permlane32_swap_b32 v18, v19
  v_pk_fma_f32 v[116:117], v[190:191], v[150:151], v[116:117] op_sel:[1,0,0] op_sel_hi:[1,1,1] neg_lo:[1,0,0] neg_hi:[1,0,0]
  v_pk_fma_f32 v[152:153], v[190:191], v[114:115], v[152:153] op_sel:[1,0,0] op_sel_hi:[1,1,1]
  v_permlane16_swap_b32 v16, v18
  v_permlane16_swap_b32 v17, v19
  buffer_store_dwordx4 v[16:19], v58, s[12:15], s87 offen sc1
  s_add_u32 s87, s87, 1048576
  v_cvt_pk_bf16_f32 v20, v116, v117
  v_cvt_pk_bf16_f32 v21, -v152, -v153
  v_pk_fma_f32 v[118:119], v[190:191], v[116:117], v[118:119] op_sel:[0,0,0] op_sel_hi:[0,1,1]
  v_pk_fma_f32 v[154:155], v[190:191], v[152:153], v[154:155] op_sel:[0,0,0] op_sel_hi:[0,1,1]
  v_pk_fma_f32 v[118:119], v[190:191], v[152:153], v[118:119] op_sel:[1,0,0] op_sel_hi:[1,1,1] neg_lo:[1,0,0] neg_hi:[1,0,0]
  v_pk_fma_f32 v[154:155], v[190:191], v[116:117], v[154:155] op_sel:[1,0,0] op_sel_hi:[1,1,1]
  v_cvt_pk_bf16_f32 v22, v118, v119
  v_cvt_pk_bf16_f32 v23, -v154, -v155
  v_permlane32_swap_b32 v20, v21
  s_nop 0
  v_permlane32_swap_b32 v22, v23
  s_nop 1
  v_permlane16_swap_b32 v20, v22
  v_permlane16_swap_b32 v21, v23
  buffer_store_dwordx4 v[20:23], v58, s[12:15], s87 offen sc1
  ds_read_b128 a[32:35], v130 offset:32768
  ds_read_b128 a[36:39], v131 offset:32768
  ds_read_b128 a[40:43], v130 offset:34816
  ds_read_b128 a[44:47], v131 offset:34816
  ds_read_b128 a[48:51], v130 offset:49152
  ds_read_b128 a[52:55], v131 offset:49152
  ds_read_b128 a[56:59], v130 offset:51200
  ds_read_b128 a[60:63], v131 offset:51200
  ds_read_b128 a[64:67], v130 offset:16384
  ds_read_b128 a[68:71], v131 offset:16384
  ds_read_b128 a[72:75], v130 offset:18432
  ds_read_b128 a[76:79], v131 offset:18432
  s_waitcnt vmcnt(8)
  ds_read_b128 a[80:83], v128 offset:32768
  ds_read_b128 a[84:87], v129 offset:32768
  ds_read_b128 a[88:91], v128 offset:34816
  ds_read_b128 a[92:95], v129 offset:34816
  s_cmp_lg_u32 s3, 3
  s_cbranch_scc1 gated_mix__spectral_gfnet__ssm_conv_s5__prompt_kernel_skip36
  s_getpc_b64 s[6:7]
gated_mix__spectral_gfnet__ssm_conv_s5__prompt_kernel_pc35:
  s_lshr_b32 s29, s2, 3
  s_mul_i32 s29, s29, 512
  v_min_u32 v8, 3, v1
  v_lshl_add_u32 v8, v8, 7, s29
  v_min_u32 v8, gated_mix__spectral_gfnet__ssm_conv_s5__prompt_kernel_end-gated_mix__spectral_gfnet__ssm_conv_s5__prompt_kernel_pc35, v8
  v_mov_b32 v9, 0
  v_lshl_add_u64 v[8:9], v[8:9], 0, s[6:7]
  global_load_dword v4, v[8:9], off
gated_mix__spectral_gfnet__ssm_conv_s5__prompt_kernel_skip36:
  s_waitcnt lgkmcnt(15)
  s_barrier
  s_lshr_b32 s29, s41, 3
  s_lshl2_add_u32 s29, s29, s3
  s_lshl_b32 s29, s29, 12
  v_lshl_add_u32 v6, v1, 7, s29
  s_add_u32 m0, s43, 0
  s_nop 0
  buffer_load_dwordx4 v124, s[68:71], s28 offen offset:0 lds
  s_and_b32 s29, s3, 1
  s_lshl_b32 s29, s29, 2
  v_xor_b32 v9, s29, v1
  s_lshl_b32 s29, s3, 12
  s_add_u32 s29, s29, 49152
  v_lshl_add_u32 v10, v9, 4, s29
  v_xor_b32 v9, 0, v10
  ds_read_b128 v[12:15], v9 offset:0
  v_xor_b32 v9, 16, v10
  ds_read_b128 v[16:19], v9 offset:1024
  v_xor_b32 v9, 32, v10
  ds_read_b128 v[20:23], v9 offset:2048
  v_xor_b32 v9, 48, v10
  ds_read_b128 v[40:43], v9 offset:3072
  s_waitcnt lgkmcnt(3)
  v_mfma_f32_16x16x32_bf16 v[44:47], v[12:15], v[76:79], 0
  buffer_load_dwordx4 v125, s[68:71], s28 offen offset:1024 lds
  v_mfma_f32_16x16x32_bf16 v[48:51], v[12:15], v[80:83], 0
  s_waitcnt lgkmcnt(2)
  v_mfma_f32_16x16x32_bf16 v[52:55], v[16:19], v[76:79], 0
  v_mfma_f32_16x16x32_bf16 v[56:59], v[16:19], v[80:83], 0
  s_waitcnt lgkmcnt(1)
  v_mfma_f32_16x16x32_bf16 v[64:67], v[20:23], v[76:79], 0
  s_add_u32 m0, s43, 2048
  s_nop 0
  buffer_load_dwordx4 v126, s[68:71], s28 offen offset:0 lds
  v_mfma_f32_16x16x32_bf16 v[68:71], v[20:23], v[80:83], 0
  s_waitcnt lgkmcnt(0)
  v_mfma_f32_16x16x32_bf16 v[72:75], v[40:43], v[76:79], 0
  v_mfma_f32_16x16x32_bf16 v[88:91], v[40:43], v[80:83], 0
  v_pk_mul_f32 v[92:93], v[44:45], v[84:85]
  v_pk_mul_f32 v[94:95], v[48:49], v[84:85]
  v_pk_fma_f32 v[92:93], v[48:49], v[132:133], v[92:93]
  v_pk_fma_f32 v[94:95], v[44:45], v[132:133], v[94:95] neg_lo:[0,1,0] neg_hi:[0,1,0]
  buffer_load_dwordx4 v127, s[68:71], s28 offen offset:1024 lds
  v_cvt_pk_bf16_f32 v12, v92, v94
  v_cvt_pk_bf16_f32 v13, v93, v95
  v_pk_mul_f32 v[92:93], v[46:47], v[86:87]
  v_pk_mul_f32 v[94:95], v[50:51], v[86:87]
  v_pk_fma_f32 v[92:93], v[50:51], v[134:135], v[92:93]
  v_pk_fma_f32 v[94:95], v[46:47], v[134:135], v[94:95] neg_lo:[0,1,0] neg_hi:[0,1,0]
  v_cvt_pk_bf16_f32 v14, v92, v94
  v_cvt_pk_bf16_f32 v15, v93, v95
  v_pk_mul_f32 v[92:93], v[52:53], v[84:85]
  v_pk_mul_f32 v[94:95], v[56:57], v[84:85]
  v_pk_fma_f32 v[92:93], v[56:57], v[132:133], v[92:93]
  v_pk_fma_f32 v[94:95], v[52:53], v[132:133], v[94:95] neg_lo:[0,1,0] neg_hi:[0,1,0]
  v_cvt_pk_bf16_f32 v16, v92, v94
  v_cvt_pk_bf16_f32 v17, v93, v95
  v_pk_mul_f32 v[92:93], v[54:55], v[86:87]
  v_pk_mul_f32 v[94:95], v[58:59], v[86:87]
  s_add_u32 m0, s43, 65536
  s_nop 0
  buffer_load_dwordx4 v124, s[72:75], s28 offen offset:0 lds
  v_pk_fma_f32 v[92:93], v[58:59], v[134:135], v[92:93]
  v_pk_fma_f32 v[94:95], v[54:55], v[134:135], v[94:95] neg_lo:[0,1,0] neg_hi:[0,1,0]
  v_cvt_pk_bf16_f32 v18, v92, v94
  v_cvt_pk_bf16_f32 v19, v93, v95
  v_mfma_f32_16x16x32_bf16 v[44:47], a[224:227], v[12:15], 0
  v_mfma_f32_16x16x32_bf16 v[48:51], a[228:231], v[12:15], 0
  v_pk_mul_f32 v[92:93], v[64:65], v[84:85]
  v_pk_mul_f32 v[94:95], v[68:69], v[84:85]
  v_pk_fma_f32 v[92:93], v[68:69], v[132:133], v[92:93]
  v_pk_fma_f32 v[94:95], v[64:65], v[132:133], v[94:95] neg_lo:[0,1,0] neg_hi:[0,1,0]
  buffer_load_dwordx4 v125, s[72:75], s28 offen offset:1024 lds
  v_cvt_pk_bf16_f32 v20, v92, v94
  v_cvt_pk_bf16_f32 v21, v93, v95
  v_pk_mul_f32 v[92:93], v[66:67], v[86:87]
  v_pk_mul_f32 v[94:95], v[70:71], v[86:87]
  v_pk_fma_f32 v[92:93], v[70:71], v[134:135], v[92:93]
  v_pk_fma_f32 v[94:95], v[66:67], v[134:135], v[94:95] neg_lo:[0,1,0] neg_hi:[0,1,0]
  v_cvt_pk_bf16_f32 v22, v92, v94
  v_cvt_pk_bf16_f32 v23, v93, v95
  v_mfma_f32_16x16x32_bf16 v[52:55], a[224:227], v[16:19], 0
  v_mfma_f32_16x16x32_bf16 v[56:59], a[228:231], v[16:19], 0
  s_add_u32 m0, s43, 67584
  s_nop 0
  buffer_load_dwordx4 v126, s[72:75], s28 offen offset:0 lds
  v_pk_mul_f32 v[92:93], v[72:73], v[84:85]
  v_pk_mul_f32 v[94:95], v[88:89], v[84:85]
  v_pk_fma_f32 v[92:93], v[88:89], v[132:133], v[92:93]
  v_pk_fma_f32 v[94:95], v[72:73], v[132:133], v[94:95] neg_lo:[0,1,0] neg_hi:[0,1,0]
  v_cvt_pk_bf16_f32 v40, v92, v94
  v_cvt_pk_bf16_f32 v41, v93, v95
  v_pk_mul_f32 v[92:93], v[74:75], v[86:87]
  v_pk_mul_f32 v[94:95], v[90:91], v[86:87]
  v_pk_fma_f32 v[92:93], v[90:91], v[134:135], v[92:93]
  v_pk_fma_f32 v[94:95], v[74:75], v[134:135], v[94:95] neg_lo:[0,1,0] neg_hi:[0,1,0]
  v_cvt_pk_bf16_f32 v42, v92, v94
  v_cvt_pk_bf16_f32 v43, v93, v95
  v_mfma_f32_16x16x32_bf16 v[64:67], a[224:227], v[20:23], 0
  buffer_load_dwordx4 v127, s[72:75], s28 offen offset:1024 lds
  s_add_u32 s28, s28, 128
  s_and_b32 s28, s28, 0x3ff
  v_mfma_f32_16x16x32_bf16 v[68:71], a[228:231], v[20:23], 0
  v_mfma_f32_16x16x32_bf16 v[72:75], a[224:227], v[40:43], 0
  v_mfma_f32_16x16x32_bf16 v[88:91], a[228:231], v[40:43], 0
  s_waitcnt vmcnt(8)
  s_barrier
  s_cmp_lg_u32 s3, 0
  s_cbranch_scc1 gated_mix__spectral_gfnet__ssm_conv_s5__prompt_kernel_skip37
  s_mov_b64 exec, 65535
  buffer_store_dword v5, v39, s[16:19], s57 offen sc1
  s_mov_b64 exec, -1
gated_mix__spectral_gfnet__ssm_conv_s5__prompt_kernel_skip37:
  s_cmp_eq_u32 s10, 0
  s_cbranch_scc1 gated_mix__spectral_gfnet__ssm_conv_s5__prompt_kernel_skip38
  v_pk_mul_f32 v[92:93], v[44:45], v[216:217]
  v_pk_mul_f32 v[94:95], v[48:49], v[216:217]
  v_pk_fma_f32 v[92:93], v[48:49], v[220:221], v[92:93] neg_lo:[0,1,0] neg_hi:[0,1,0]
  v_pk_fma_f32 v[94:95], v[44:45], v[220:221], v[94:95]
  v_cvt_pk_bf16_f32 v96, v92, v94
  v_cvt_pk_bf16_f32 v97, v93, v95
  v_pk_mul_f32 v[92:93], v[46:47], v[218:219]
  v_pk_mul_f32 v[94:95], v[50:51], v[218:219]
  v_pk_fma_f32 v[92:93], v[50:51], v[222:223], v[92:93] neg_lo:[0,1,0] neg_hi:[0,1,0]
  v_pk_fma_f32 v[94:95], v[46:47], v[222:223], v[94:95]
  v_cvt_pk_bf16_f32 v98, v92, v94
  v_cvt_pk_bf16_f32 v99, v93, v95
  s_nop 1
  v_mfma_f32_16x16x32_bf16 v[216:219], v[96:99], a[232:235], 0
  v_mfma_f32_16x16x32_bf16 v[220:223], v[96:99], a[236:239], 0
  s_nop 6
  v_pk_mul_f32 v[92:93], v[216:217], v[136:137]
  v_pk_mul_f32 v[94:95], v[220:221], v[136:137]
  v_pk_fma_f32 v[92:93], v[220:221], v[184:185], v[92:93] neg_lo:[0,1,0] neg_hi:[0,1,0]
  v_pk_fma_f32 v[94:95], v[216:217], v[184:185], v[94:95]
  v_cvt_pk_bf16_f32 v96, v92, v94
  v_cvt_pk_bf16_f32 v97, v93, v95
  v_pk_mul_f32 v[92:93], v[218:219], v[138:139]
  v_pk_mul_f32 v[94:95], v[222:223], v[138:139]
  v_pk_fma_f32 v[92:93], v[222:223], v[186:187], v[92:93] neg_lo:[0,1,0] neg_hi:[0,1,0]
  v_pk_fma_f32 v[94:95], v[218:219], v[186:187], v[94:95]
  v_cvt_pk_bf16_f32 v98, v92, v94
  v_cvt_pk_bf16_f32 v99, v93, v95
  s_nop 1
  v_mfma_f32_16x16x32_bf16 v[216:219], a[240:243], v[96:99], 0
  v_mfma_f32_16x16x32_bf16 v[220:223], a[244:247], v[96:99], 0
gated_mix__spectral_gfnet__ssm_conv_s5__prompt_kernel_skip38:
  s_add_u32 m0, s43, 16384
  s_nop 0
  buffer_load_dwordx4 v124, s[68:71], s28 offen offset:0 lds
  v_pk_mul_f32 v[92:93], v[44:45], v[160:161]
  v_pk_mul_f32 v[94:95], v[48:49], v[160:161]
  v_pk_fma_f32 v[92:93], v[48:49], v[164:165], v[92:93] neg_lo:[0,1,0] neg_hi:[0,1,0]
  v_pk_fma_f32 v[94:95], v[44:45], v[164:165], v[94:95]
  v_cvt_pk_bf16_f32 v12, v92, v94
  v_cvt_pk_bf16_f32 v13, v93, v95
  v_pk_mul_f32 v[92:93], v[46:47], v[162:163]
  v_pk_mul_f32 v[94:95], v[50:51], v[162:163]
  v_pk_fma_f32 v[92:93], v[50:51], v[166:167], v[92:93] neg_lo:[0,1,0] neg_hi:[0,1,0]
  v_pk_fma_f32 v[94:95], v[46:47], v[166:167], v[94:95]
  v_cvt_pk_bf16_f32 v14, v92, v94
  v_cvt_pk_bf16_f32 v15, v93, v95
  v_pk_mul_f32 v[92:93], v[52:53], v[168:169]
  v_pk_mul_f32 v[94:95], v[56:57], v[168:169]
  v_pk_fma_f32 v[92:93], v[56:57], v[172:173], v[92:93] neg_lo:[0,1,0] neg_hi:[0,1,0]
  v_pk_fma_f32 v[94:95], v[52:53], v[172:173], v[94:95]
  buffer_load_dwordx4 v125, s[68:71], s28 offen offset:1024 lds
  v_cvt_pk_bf16_f32 v16, v92, v94
  v_cvt_pk_bf16_f32 v17, v93, v95
  v_pk_mul_f32 v[92:93], v[54:55], v[170:171]
  v_pk_mul_f32 v[94:95], v[58:59], v[170:171]
  v_pk_fma_f32 v[92:93], v[58:59], v[174:175], v[92:93] neg_lo:[0,1,0] neg_hi:[0,1,0]
  v_pk_fma_f32 v[94:95], v[54:55], v[174:175], v[94:95]
  v_cvt_pk_bf16_f32 v18, v92, v94
  v_cvt_pk_bf16_f32 v19, v93, v95
  v_mfma_f32_16x16x32_bf16 v[44:47], v[12:15], a[232:235], 0
  v_mfma_f32_16x16x32_bf16 v[48:51], v[12:15], a[236:239], 0
  s_add_u32 m0, s43, 18432
  s_nop 0
  buffer_load_dwordx4 v126, s[68:71], s28 offen offset:0 lds
  v_pk_mul_f32 v[92:93], v[64:65], v[176:177]
  v_pk_mul_f32 v[94:95], v[68:69], v[176:177]
  v_pk_fma_f32 v[92:93], v[68:69], v[180:181], v[92:93] neg_lo:[0,1,0] neg_hi:[0,1,0]
  v_pk_fma_f32 v[94:95], v[64:65], v[180:181], v[94:95]
  v_cvt_pk_bf16_f32 v20, v92, v94
  v_cvt_pk_bf16_f32 v21, v93, v95
  v_pk_mul_f32 v[92:93], v[66:67], v[178:179]
  v_pk_mul_f32 v[94:95], v[70:71], v[178:179]
  v_pk_fma_f32 v[92:93], v[70:71], v[182:183], v[92:93] neg_lo:[0,1,0] neg_hi:[0,1,0]
  v_pk_fma_f32 v[94:95], v[66:67], v[182:183], v[94:95]
  v_cvt_pk_bf16_f32 v22, v92, v94
  v_cvt_pk_bf16_f32 v23, v93, v95
  v_mfma_f32_16x16x32_bf16 v[52:55], v[16:19], a[232:235], 0
  buffer_load_dwordx4 v127, s[68:71], s28 offen offset:1024 lds
  v_mfma_f32_16x16x32_bf16 v[56:59], v[16:19], a[236:239], 0
  v_pk_mul_f32 v[92:93], v[72:73], v[204:205]
  v_pk_mul_f32 v[94:95], v[88:89], v[204:205]
  v_pk_fma_f32 v[92:93], v[88:89], v[212:213], v[92:93] neg_lo:[0,1,0] neg_hi:[0,1,0]
  v_pk_fma_f32 v[94:95], v[72:73], v[212:213], v[94:95]
  v_cvt_pk_bf16_f32 v40, v92, v94
  v_cvt_pk_bf16_f32 v41, v93, v95
  v_pk_mul_f32 v[92:93], v[74:75], v[206:207]
  v_pk_mul_f32 v[94:95], v[90:91], v[206:207]
  v_pk_fma_f32 v[92:93], v[90:91], v[214:215], v[92:93] neg_lo:[0,1,0] neg_hi:[0,1,0]
  v_pk_fma_f32 v[94:95], v[74:75], v[214:215], v[94:95]
  v_cvt_pk_bf16_f32 v42, v92, v94
  v_cvt_pk_bf16_f32 v43, v93, v95
  s_add_u32 m0, s43, 98304
  s_nop 0
  buffer_load_dwordx4 v124, s[72:75], s28 offen offset:0 lds
  v_mfma_f32_16x16x32_bf16 v[64:67], v[20:23], a[232:235], 0
  v_mfma_f32_16x16x32_bf16 v[68:71], v[20:23], a[236:239], 0
  v_mfma_f32_16x16x32_bf16 v[72:75], v[40:43], a[232:235], 0
  v_mfma_f32_16x16x32_bf16 v[88:91], v[40:43], a[236:239], 0
  buffer_load_dwordx4 v125, s[72:75], s28 offen offset:1024 lds
  v_pk_mul_f32 v[92:93], v[44:45], v[136:137]
  v_pk_mul_f32 v[94:95], v[48:49], v[136:137]
  v_pk_fma_f32 v[92:93], v[48:49], v[184:185], v[92:93] neg_lo:[0,1,0] neg_hi:[0,1,0]
  v_pk_fma_f32 v[94:95], v[44:45], v[184:185], v[94:95]
  v_cvt_pk_bf16_f32 v12, v92, v94
  v_cvt_pk_bf16_f32 v13, v93, v95
  v_pk_mul_f32 v[92:93], v[46:47], v[138:139]
  v_pk_mul_f32 v[94:95], v[50:51], v[138:139]
  v_pk_fma_f32 v[92:93], v[50:51], v[186:187], v[92:93] neg_lo:[0,1,0] neg_hi:[0,1,0]
  v_pk_fma_f32 v[94:95], v[46:47], v[186:187], v[94:95]
  v_cvt_pk_bf16_f32 v14, v92, v94
  v_cvt_pk_bf16_f32 v15, v93, v95
  v_pk_mul_f32 v[92:93], v[52:53], v[136:137]
  v_pk_mul_f32 v[94:95], v[56:57], v[136:137]
  v_pk_fma_f32 v[92:93], v[56:57], v[184:185], v[92:93] neg_lo:[0,1,0] neg_hi:[0,1,0]
  v_pk_fma_f32 v[94:95], v[52:53], v[184:185], v[94:95]
  s_add_u32 m0, s43, 100352
  s_nop 0
  buffer_load_dwordx4 v126, s[72:75], s28 offen offset:0 lds
  v_cvt_pk_bf16_f32 v16, v92, v94
  v_cvt_pk_bf16_f32 v17, v93, v95
  v_pk_mul_f32 v[92:93], v[54:55], v[138:139]
  v_pk_mul_f32 v[94:95], v[58:59], v[138:139]
  v_pk_fma_f32 v[92:93], v[58:59], v[186:187], v[92:93] neg_lo:[0,1,0] neg_hi:[0,1,0]
  v_pk_fma_f32 v[94:95], v[54:55], v[186:187], v[94:95]
  v_cvt_pk_bf16_f32 v18, v92, v94
  v_cvt_pk_bf16_f32 v19, v93, v95
  v_mfma_f32_16x16x32_bf16 v[44:47], a[240:243], v[12:15], 0
  v_mfma_f32_16x16x32_bf16 v[48:51], a[244:247], v[12:15], 0
  buffer_load_dwordx4 v127, s[72:75], s28 offen offset:1024 lds
  s_add_u32 s28, s28, 128
  s_and_b32 s28, s28, 0x3ff
  v_pk_mul_f32 v[92:93], v[64:65], v[136:137]
  v_pk_mul_f32 v[94:95], v[68:69], v[136:137]
  v_pk_fma_f32 v[92:93], v[68:69], v[184:185], v[92:93] neg_lo:[0,1,0] neg_hi:[0,1,0]
  v_pk_fma_f32 v[94:95], v[64:65], v[184:185], v[94:95]
  v_cvt_pk_bf16_f32 v20, v92, v94
  v_cvt_pk_bf16_f32 v21, v93, v95
  v_pk_mul_f32 v[92:93], v[66:67], v[138:139]
  v_pk_mul_f32 v[94:95], v[70:71], v[138:139]
  v_pk_fma_f32 v[92:93], v[70:71], v[186:187], v[92:93] neg_lo:[0,1,0] neg_hi:[0,1,0]
  v_pk_fma_f32 v[94:95], v[66:67], v[186:187], v[94:95]
  v_cvt_pk_bf16_f32 v22, v92, v94
  v_cvt_pk_bf16_f32 v23, v93, v95
  v_mfma_f32_16x16x32_bf16 v[52:55], a[240:243], v[16:19], 0
  s_add_u32 m0, s43, 114688
  s_nop 0
  buffer_load_dwordx4 v124, s[68:71], s28 offen offset:0 lds
  v_mfma_f32_16x16x32_bf16 v[56:59], a[244:247], v[16:19], 0
  v_pk_mul_f32 v[92:93], v[72:73], v[136:137]
  v_pk_mul_f32 v[94:95], v[88:89], v[136:137]
  v_pk_fma_f32 v[92:93], v[88:89], v[184:185], v[92:93] neg_lo:[0,1,0] neg_hi:[0,1,0]
  v_pk_fma_f32 v[94:95], v[72:73], v[184:185], v[94:95]
  v_cvt_pk_bf16_f32 v40, v92, v94
  v_cvt_pk_bf16_f32 v41, v93, v95
  v_pk_mul_f32 v[92:93], v[74:75], v[138:139]
  v_pk_mul_f32 v[94:95], v[90:91], v[138:139]
  v_pk_fma_f32 v[92:93], v[90:91], v[186:187], v[92:93] neg_lo:[0,1,0] neg_hi:[0,1,0]
  v_pk_fma_f32 v[94:95], v[74:75], v[186:187], v[94:95]
  v_cvt_pk_bf16_f32 v42, v92, v94
  v_cvt_pk_bf16_f32 v43, v93, v95
  buffer_load_dwordx4 v125, s[68:71], s28 offen offset:1024 lds
  v_mfma_f32_16x16x32_bf16 v[64:67], a[240:243], v[20:23], 0
  v_mfma_f32_16x16x32_bf16 v[68:71], a[244:247], v[20:23], 0
  v_mfma_f32_16x16x32_bf16 v[72:75], a[240:243], v[40:43], 0
  v_mfma_f32_16x16x32_bf16 v[88:91], a[244:247], v[40:43], 0
  s_add_u32 m0, s43, 116736
  s_nop 0
  buffer_load_dwordx4 v126, s[68:71], s28 offen offset:0 lds
  v_lshlrev_b32 v9, 12, v3
  v_lshl_add_u32 v9, v2, 4, v9
  s_lshl_b32 s29, s3, 8
  s_add_u32 s29, s29, 147456
  v_add_u32 v9, s29, v9
  s_sub_u32 s29, s10, 1
  s_or_b32 s29, s29, s3
  s_cmp_lg_u32 s29, 0
  s_cbranch_scc1 gated_mix__spectral_gfnet__ssm_conv_s5__prompt_kernel_skip39
  v_mov_b32 v48, v220
  v_mov_b32 v49, v221
  v_mov_b32 v50, v222
  v_mov_b32 v51, v223
gated_mix__spectral_gfnet__ssm_conv_s5__prompt_kernel_skip39:
  v_cvt_pk_bf16_f32 v12, v44, v48
  v_cvt_pk_bf16_f32 v13, v52, v56
  v_cvt_pk_bf16_f32 v14, v64, v68
  v_cvt_pk_bf16_f32 v15, v72, v88
  ds_write_b128 v9, v[12:15] offset:0
  v_cvt_pk_bf16_f32 v16, v45, v49
  v_cvt_pk_bf16_f32 v17, v53, v57
  buffer_load_dwordx4 v127, s[68:71], s28 offen offset:1024 lds
  v_cvt_pk_bf16_f32 v18, v65, v69
  v_cvt_pk_bf16_f32 v19, v73, v89
  ds_write_b128 v9, v[16:19] offset:1024
  v_cvt_pk_bf16_f32 v20, v46, v50
  v_cvt_pk_bf16_f32 v21, v54, v58
  v_cvt_pk_bf16_f32 v22, v66, v70
  v_cvt_pk_bf16_f32 v23, v74, v90
  ds_write_b128 v9, v[20:23] offset:2048
  v_cvt_pk_bf16_f32 v40, v47, v51
  v_cvt_pk_bf16_f32 v41, v55, v59
  v_cvt_pk_bf16_f32 v42, v67, v71
  v_cvt_pk_bf16_f32 v43, v75, v91
  ds_write_b128 v9, v[40:43] offset:3072
  s_add_u32 m0, s43, 81920
  s_nop 0
  buffer_load_dwordx4 v124, s[72:75], s28 offen offset:0 lds
  buffer_load_dwordx4 v125, s[72:75], s28 offen offset:1024 lds
  s_add_u32 m0, s43, 83968
  s_nop 0
  buffer_load_dwordx4 v126, s[72:75], s28 offen offset:0 lds
  buffer_load_dwordx4 v127, s[72:75], s28 offen offset:1024 lds
  s_add_u32 s28, s28, 128
  s_and_b32 s28, s28, 0x3ff
  s_waitcnt vmcnt(20)
  ds_read_b128 a[96:99], v128 offset:0
  ds_read_b128 a[100:103], v129 offset:0
  ds_read_b128 a[104:107], v128 offset:2048
  ds_read_b128 a[108:111], v129 offset:2048
  s_add_u32 m0, s43, 32768
  s_nop 0
  buffer_load_dwordx4 v124, s[68:71], s28 offen offset:0 lds
  buffer_load_dwordx4 v125, s[68:71], s28 offen offset:1024 lds
  s_add_u32 m0, s43, 34816
  s_nop 0
  buffer_load_dwordx4 v126, s[68:71], s28 offen offset:0 lds
  buffer_load_dwordx4 v127, s[68:71], s28 offen offset:1024 lds
  s_waitcnt lgkmcnt(0)
  s_barrier
  s_lshl_b32 s29, s3, 12
  s_add_u32 s29, s29, 147456
  v_lshl_add_u32 v9, v1, 4, s29
  ds_read_b128 v[12:15], v9 offset:0
  ds_read_b128 v[16:19], v9 offset:1024
  ds_read_b128 v[20:23], v9 offset:2048
  ds_read_b128 v[40:43], v9 offset:3072
  s_mov_b32 s29, 1048576
  v_mul_lo_u32 v9, v3, s29
  v_lshl_add_u32 v9, v2, 2, v9
  s_mul_i32 s6, s3, 65536
  s_lshr_b32 s29, s37, 4
  s_lshl_b32 s29, s29, 12
  s_add_u32 s6, s6, s29
  s_lshl_b32 s29, s36, 10
  s_add_u32 s6, s6, s29
  s_and_b32 s29, s37, 15
  s_lshl_b32 s29, s29, 6
  s_add_u32 s6, s6, s29
  s_waitcnt lgkmcnt(3)
  v_mfma_f32_16x16x32_bf16 v[44:47], a[248:251], v[12:15], 0
  v_mfma_f32_16x16x32_bf16 v[48:51], a[252:255], v[12:15], 0
  s_waitcnt lgkmcnt(2)
  v_mfma_f32_16x16x32_bf16 v[52:55], a[248:251], v[16:19], 0
  v_mfma_f32_16x16x32_bf16 v[56:59], a[252:255], v[16:19], 0
  s_waitcnt lgkmcnt(1)
  v_mfma_f32_16x16x32_bf16 v[64:67], a[248:251], v[20:23], 0
  v_mfma_f32_16x16x32_bf16 v[68:71], a[252:255], v[20:23], 0
  s_waitcnt lgkmcnt(0)
  v_mfma_f32_16x16x32_bf16 v[72:75], a[248:251], v[40:43], 0
  v_mfma_f32_16x16x32_bf16 v[76:79], a[252:255], v[40:43], 0
  v_cvt_pk_bf16_f32 v12, v44, v48
  v_cvt_pk_bf16_f32 v13, v45, v49
  v_cvt_pk_bf16_f32 v14, v46, v50
  v_cvt_pk_bf16_f32 v15, v47, v51
  v_cvt_pk_bf16_f32 v16, v52, v56
  v_cvt_pk_bf16_f32 v17, v53, v57
  v_cvt_pk_bf16_f32 v18, v54, v58
  v_cvt_pk_bf16_f32 v19, v55, v59
  v_cvt_pk_bf16_f32 v20, v64, v68
  v_cvt_pk_bf16_f32 v21, v65, v69
  v_cvt_pk_bf16_f32 v22, v66, v70
  v_cvt_pk_bf16_f32 v23, v67, v71
  v_cvt_pk_bf16_f32 v40, v72, v76
  v_cvt_pk_bf16_f32 v41, v73, v77
  v_cvt_pk_bf16_f32 v42, v74, v78
  v_cvt_pk_bf16_f32 v43, v75, v79
  s_mov_b64 exec, 0xffffffff
  buffer_load_dword v8, v6, s[16:19], s57 offen sc1
  s_mov_b64 exec, -1
  s_add_u32 s20, s34, 5242880
  s_addc_u32 s21, s35, 0
  s_mov_b32 s22, 4194304
  s_mov_b32 s23, 0x20000
  s_waitcnt vmcnt(21)
  ds_read_b128 a[112:115], v130 offset:0
  ds_read_b128 a[116:119], v131 offset:0
  ds_read_b128 a[120:123], v130 offset:2048
  ds_read_b128 a[124:127], v131 offset:2048
  s_waitcnt vmcnt(17)
  ds_read_b128 a[128:131], v128 offset:16384
  ds_read_b128 a[132:135], v129 offset:16384
  ds_read_b128 a[136:139], v128 offset:18432
  ds_read_b128 a[140:143], v129 offset:18432
  s_waitcnt vmcnt(13)
  ds_read_b128 a[144:147], v130 offset:32768
  ds_read_b128 a[148:151], v131 offset:32768
  ds_read_b128 a[152:155], v130 offset:34816
  ds_read_b128 a[156:159], v131 offset:34816
  s_waitcnt vmcnt(9)
  ds_read_b128 a[160:163], v130 offset:49152
  ds_read_b128 a[164:167], v131 offset:49152
  ds_read_b128 a[168:171], v130 offset:51200
  ds_read_b128 a[172:175], v131 offset:51200
  s_waitcnt vmcnt(5)
  ds_read_b128 a[176:179], v130 offset:16384
  ds_read_b128 a[180:183], v131 offset:16384
  ds_read_b128 a[184:187], v130 offset:18432
  ds_read_b128 a[188:191], v131 offset:18432
  s_waitcnt vmcnt(1)
  ds_read_b128 a[192:195], v128 offset:32768
  ds_read_b128 a[196:199], v129 offset:32768
  ds_read_b128 a[200:203], v128 offset:34816
  ds_read_b128 a[204:207], v129 offset:34816
  buffer_store_dword v12, v9, s[20:23], s6 offen sc1
  s_add_u32 s6, s6, 262144
  buffer_store_dword v13, v9, s[20:23], s6 offen sc1
  s_add_u32 s6, s6, 262144
  buffer_store_dword v14, v9, s[20:23], s6 offen sc1
  s_add_u32 s6, s6, 262144
  buffer_store_dword v15, v9, s[20:23], s6 offen sc1
  s_sub_u32 s6, s6, 770048
  buffer_store_dword v16, v9, s[20:23], s6 offen sc1
  s_add_u32 s6, s6, 262144
  buffer_store_dword v17, v9, s[20:23], s6 offen sc1
  s_add_u32 s6, s6, 262144
  buffer_store_dword v18, v9, s[20:23], s6 offen sc1
  s_add_u32 s6, s6, 262144
  buffer_store_dword v19, v9, s[20:23], s6 offen sc1
  s_sub_u32 s6, s6, 770048
  buffer_store_dword v20, v9, s[20:23], s6 offen sc1
  s_add_u32 s6, s6, 262144
  buffer_store_dword v21, v9, s[20:23], s6 offen sc1
  s_add_u32 s6, s6, 262144
  buffer_store_dword v22, v9, s[20:23], s6 offen sc1
  s_add_u32 s6, s6, 262144
  buffer_store_dword v23, v9, s[20:23], s6 offen sc1
  s_sub_u32 s6, s6, 770048
  buffer_store_dword v40, v9, s[20:23], s6 offen sc1
  s_add_u32 s6, s6, 262144
  buffer_store_dword v41, v9, s[20:23], s6 offen sc1
  s_add_u32 s6, s6, 262144
  buffer_store_dword v42, v9, s[20:23], s6 offen sc1
  s_add_u32 s6, s6, 262144
  buffer_store_dword v43, v9, s[20:23], s6 offen sc1
  s_lshr_b32 s7, s41, 3
  s_mul_i32 s6, s7, 253952
  s_lshl_b32 s29, s40, 19
  s_add_u32 s6, s6, s29
  s_lshr_b32 s7, s3, 1
  s_lshl1_add_u32 s7, s7, s3
  s_add_u32 s7, s7, 2
  s_lshl_b32 s7, s7, 12
  s_add_u32 s6, s6, s7
  v_lshl_add_u32 v9, v1, 4, s6
  s_and_b32 s29, s40, 7
  s_lshl_b32 s29, s29, 15
  s_lshl_b32 s6, s3, 12
  v_and_b32 v10, 3, v1
  v_and_b32 v11, 2, v3
  v_xor_b32 v11, v11, v10
  v_lshlrev_b32 v10, 9, v10
  v_lshl_or_b32 v10, v11, 6, v10
  v_bfe_u32 v11, v1, 2, 2
  v_lshl_or_b32 v10, v11, 4, v10
  v_and_b32 v11, 1, v3
  v_lshl_or_b32 v12, v11, 3, v10
  v_xor_b32 v13, 64, v12
  v_add_u32 v14, 0x10000, v12
  v_add_u32 v15, 0x10000, v13
  v_lshlrev_b32 v16, 16, v62
  v_and_b32 v17, 0xffff0000, v62
  v_lshlrev_b32 v18, 16, v63
  v_and_b32 v19, 0xffff0000, v63
  v_pk_mul_f32 v[16:17], v[60:61], v[16:17] op_sel_hi:[0,1]
  v_pk_mul_f32 v[18:19], v[60:61], v[18:19] op_sel_hi:[0,1]
  v_lshlrev_b32 v20, 16, v24
  v_and_b32 v21, 0xffff0000, v24
  v_lshlrev_b32 v22, 16, v25
  v_and_b32 v23, 0xffff0000, v25
  v_pk_mul_f32 v[20:21], v[60:61], v[20:21] op_sel_hi:[0,1]
  v_pk_mul_f32 v[22:23], v[60:61], v[22:23] op_sel_hi:[0,1]
  v_lshlrev_b32 v40, 16, v26
  v_and_b32 v41, 0xffff0000, v26
  v_lshlrev_b32 v42, 16, v27
  v_and_b32 v43, 0xffff0000, v27
  v_pk_mul_f32 v[40:41], v[60:61], v[40:41] op_sel_hi:[0,1]
  v_pk_mul_f32 v[42:43], v[60:61], v[42:43] op_sel_hi:[0,1]
  v_lshlrev_b32 v44, 16, v28
  v_and_b32 v45, 0xffff0000, v28
  v_lshlrev_b32 v46, 16, v29
  v_and_b32 v47, 0xffff0000, v29
  v_pk_mul_f32 v[44:45], v[60:61], v[44:45] op_sel_hi:[0,1]
  v_pk_mul_f32 v[46:47], v[60:61], v[46:47] op_sel_hi:[0,1]
  v_lshlrev_b32 v68, 16, v30
  v_and_b32 v69, 0xffff0000, v30
  v_lshlrev_b32 v70, 16, v31
  v_and_b32 v71, 0xffff0000, v31
  v_pk_mul_f32 v[68:69], v[60:61], v[68:69] op_sel_hi:[0,1]
  v_pk_mul_f32 v[70:71], v[60:61], v[70:71] op_sel_hi:[0,1]
  v_lshlrev_b32 v72, 16, v32
  v_and_b32 v73, 0xffff0000, v32
  v_lshlrev_b32 v74, 16, v33
  v_and_b32 v75, 0xffff0000, v33
  v_pk_mul_f32 v[72:73], v[60:61], v[72:73] op_sel_hi:[0,1]
  v_pk_mul_f32 v[74:75], v[60:61], v[74:75] op_sel_hi:[0,1]
  v_lshlrev_b32 v76, 16, v34
  v_and_b32 v77, 0xffff0000, v34
  v_lshlrev_b32 v78, 16, v35
  v_and_b32 v79, 0xffff0000, v35
  v_pk_mul_f32 v[76:77], v[60:61], v[76:77] op_sel_hi:[0,1]
  v_pk_mul_f32 v[78:79], v[60:61], v[78:79] op_sel_hi:[0,1]
  v_lshlrev_b32 v80, 16, v36
  v_and_b32 v81, 0xffff0000, v36
  v_lshlrev_b32 v82, 16, v37
  v_and_b32 v83, 0xffff0000, v37
  v_pk_mul_f32 v[80:81], v[60:61], v[80:81] op_sel_hi:[0,1]
  v_pk_mul_f32 v[82:83], v[60:61], v[82:83] op_sel_hi:[0,1]
  s_waitcnt vmcnt(16)
  v_cmp_ne_u32 vcc, 1, v8
  s_nop 0
  s_and_b64 vcc, vcc, 0xffffffff
  s_cbranch_vccz gated_mix__spectral_gfnet__ssm_conv_s5__prompt_kernel_skip40
  s_mov_b32 s7, 0
gated_mix__spectral_gfnet__ssm_conv_s5__prompt_kernel_poll41:
  s_sleep 5
  s_mov_b64 exec, 0xffffffff
  buffer_load_dword v8, v6, s[16:19], s57 offen sc1
  s_mov_b64 exec, -1
  s_waitcnt vmcnt(0)
  v_cmp_ne_u32 vcc, 1, v8
  s_nop 0
  s_and_b64 vcc, vcc, 0xffffffff
  s_cbranch_vccz gated_mix__spectral_gfnet__ssm_conv_s5__prompt_kernel_pollout42
  s_add_u32 s7, s7, 1
  s_cmp_lt_u32 s7, 1048576
  s_cbranch_scc1 gated_mix__spectral_gfnet__ssm_conv_s5__prompt_kernel_poll41
gated_mix__spectral_gfnet__ssm_conv_s5__prompt_kernel_pollout42:
gated_mix__spectral_gfnet__ssm_conv_s5__prompt_kernel_skip40:
  s_waitcnt lgkmcnt(0)
  s_barrier
  s_add_u32 m0, s6, 0
  s_nop 0
  buffer_load_dwordx4 v9, s[12:15], s29 offen offset:0 sc1 lds
  buffer_load_dwordx4 v9, s[12:15], s29 offen offset:1024 sc1 lds
  buffer_load_dwordx4 v9, s[12:15], s29 offen offset:2048 sc1 lds
  s_and_b32 s7, s41, 8
  s_lshl_b32 s7, s7, 2
  v_lshrrev_b32 v6, 1, v3
  v_lshl_add_u32 v6, v6, 3, s7
  v_and_b32 v36, 1, v3
  v_lshl_add_u32 v6, v36, 1, v6
  v_cmp_eq_u32 vcc, 0, v6
  v_cvt_f32_u32 v37, v6
  v_bfe_i32 v10, v3, 0, 1
  v_and_b32 v10, 0x80008000, v10
  v_xor_b32 v11, 0x80000000, v10
  s_lshl_b32 s7, s7, 1
  buffer_load_dwordx4 v9, s[12:15], s29 offen offset:3072 sc1 lds
  s_add_u32 s29, s29, 32768
  s_and_b32 s29, s29, 0x3ffff
  s_xor_b32 s7, s7, 64
  v_add_u32 v6, s7, v2
  v_cvt_f32_u32 v6, v6
  v_mul_f32 v6, 0x3c000000, v6
  v_mul_f32 v36, v6, v37
  v_fmamk_f32 v188, v6, 0x0, v36
  v_fmamk_f32 v189, v6, 0x3f800000, v36
  v_fmamk_f32 v190, v6, 0x40800000, v36
  v_fmamk_f32 v191, v6, 0x40a00000, v36
  v_fmamk_f32 v192, v6, 0x41800000, v36
  v_fmamk_f32 v193, v6, 0x41880000, v36
  v_fmamk_f32 v194, v6, 0x41a00000, v36
  s_add_u32 m0, s6, 16384
  s_nop 0
  buffer_load_dwordx4 v9, s[12:15], s29 offen offset:0 sc1 lds
  v_fmamk_f32 v195, v6, 0x41a80000, v36
  v_cos_f32 v196, v188
  v_cos_f32 v197, v189
  v_cos_f32 v198, v190
  v_cos_f32 v199, v191
  v_cos_f32 v200, v192
  v_cos_f32 v201, v193
  buffer_load_dwordx4 v9, s[12:15], s29 offen offset:1024 sc1 lds
  v_cos_f32 v202, v194
  v_cos_f32 v203, v195
  v_sin_f32 v188, v188
  v_sin_f32 v189, v189
  v_sin_f32 v190, v190
  v_sin_f32 v191, v191
  buffer_load_dwordx4 v9, s[12:15], s29 offen offset:2048 sc1 lds
  v_sin_f32 v192, v192
  v_sin_f32 v193, v193
  v_sin_f32 v194, v194
  v_sin_f32 v195, v195
  v_lshlrev_b32 v36, 31, v2
  v_or_b32 v36, 0x3f003f00, v36
  v_cvt_pk_bf16_f32 v24, v196, -v188
  v_cvt_pk_bf16_f32 v25, v197, -v189
  buffer_load_dwordx4 v9, s[12:15], s29 offen offset:3072 sc1 lds
  s_add_u32 s29, s29, 32768
  s_and_b32 s29, s29, 0x3ffff
  v_cvt_pk_bf16_f32 v26, v198, -v190
  v_cvt_pk_bf16_f32 v27, v199, -v191
  v_cvt_pk_bf16_f32 v28, v200, -v192
  v_cvt_pk_bf16_f32 v29, v201, -v193
  v_cvt_pk_bf16_f32 v30, v202, -v194
  v_cvt_pk_bf16_f32 v31, v203, -v195
  v_cndmask_b32 v24, v24, v36, vcc
  v_xor_b32 v172, v10, v24
  v_alignbit_b32 v173, v25, v25, 16
  v_xor_b32 v173, v11, v173
  v_xor_b32 v174, v10, v26
  v_alignbit_b32 v175, v27, v27, 16
  s_add_u32 m0, s43, 98304
  s_nop 0
  buffer_load_dwordx4 v124, s[72:75], s28 offen offset:0 lds
  v_xor_b32 v175, v11, v175
  v_xor_b32 v176, v10, v28
  v_alignbit_b32 v177, v29, v29, 16
  v_xor_b32 v177, v11, v177
  v_xor_b32 v178, v10, v30
  v_alignbit_b32 v179, v31, v31, 16
  v_xor_b32 v179, v11, v179
  v_add_f32 v6, 0x3e000000, v6
  v_mul_f32 v36, v6, v37
  v_fmamk_f32 v188, v6, 0x0, v36
  v_fmamk_f32 v189, v6, 0x3f800000, v36
  v_fmamk_f32 v190, v6, 0x40800000, v36
  buffer_load_dwordx4 v125, s[72:75], s28 offen offset:1024 lds
  v_fmamk_f32 v191, v6, 0x40a00000, v36
  v_fmamk_f32 v192, v6, 0x41800000, v36
  v_fmamk_f32 v193, v6, 0x41880000, v36
  v_fmamk_f32 v194, v6, 0x41a00000, v36
  v_fmamk_f32 v195, v6, 0x41a80000, v36
  v_cos_f32 v196, v188
  v_cos_f32 v197, v189
  v_cos_f32 v198, v190
  v_cos_f32 v199, v191
  s_add_u32 m0, s43, 100352
  s_nop 0
  buffer_load_dwordx4 v126, s[72:75], s28 offen offset:0 lds
  v_cos_f32 v200, v192
  v_cos_f32 v201, v193
  v_cos_f32 v202, v194
  v_cos_f32 v203, v195
  v_sin_f32 v188, v188
  v_sin_f32 v189, v189
  buffer_load_dwordx4 v127, s[72:75], s28 offen offset:1024 lds
  s_add_u32 s28, s28, 128
  s_and_b32 s28, s28, 0x3ff
  v_sin_f32 v190, v190
  v_sin_f32 v191, v191
  v_sin_f32 v192, v192
  v_sin_f32 v193, v193
  v_sin_f32 v194, v194
  v_sin_f32 v195, v195
  v_lshlrev_b32 v36, 31, v2
  v_or_b32 v36, 0x3f003f00, v36
  v_cvt_pk_bf16_f32 v32, v196, -v188
  v_cvt_pk_bf16_f32 v33, v197, -v189
  v_cvt_pk_bf16_f32 v34, v198, -v190
  v_cvt_pk_bf16_f32 v35, v199, -v191
  v_cvt_pk_bf16_f32 v60, v200, -v192
  v_cvt_pk_bf16_f32 v61, v201, -v193
  v_cvt_pk_bf16_f32 v62, v202, -v194
  v_cvt_pk_bf16_f32 v63, v203, -v195
  v_cndmask_b32 v32, v32, v36, vcc
  v_xor_b32 v180, v10, v32
  v_alignbit_b32 v181, v33, v33, 16
  v_xor_b32 v181, v11, v181
  v_xor_b32 v182, v10, v34
  v_alignbit_b32 v183, v35, v35, 16
  v_xor_b32 v183, v11, v183
  v_xor_b32 v184, v10, v60
  v_alignbit_b32 v185, v61, v61, 16
  v_xor_b32 v185, v11, v185
  v_xor_b32 v186, v10, v62
  v_alignbit_b32 v187, v63, v63, 16
  v_xor_b32 v187, v11, v187
  s_waitcnt vmcnt(12)
  s_waitcnt vmcnt(8)
  s_barrier
  ds_read_b64_tr_b16 v[100:101], v12 offset:0
  ds_read_b64_tr_b16 v[102:103], v13 offset:0
  ds_read_b64_tr_b16 v[104:105], v12 offset:2048
  ds_read_b64_tr_b16 v[106:107], v13 offset:2048
  ds_read_b64_tr_b16 v[108:109], v12 offset:4096
  ds_read_b64_tr_b16 v[110:111], v13 offset:4096
  ds_read_b64_tr_b16 v[112:113], v12 offset:6144
  ds_read_b64_tr_b16 v[114:115], v13 offset:6144
  ds_read_b64_tr_b16 v[116:117], v12 offset:256
  ds_read_b64_tr_b16 v[118:119], v13 offset:256
  ds_read_b64_tr_b16 v[120:121], v12 offset:2304
  ds_read_b64_tr_b16 v[122:123], v13 offset:2304
  ds_read_b64_tr_b16 v[132:133], v12 offset:4352
  ds_read_b64_tr_b16 v[134:135], v13 offset:4352
  ds_read_b64_tr_b16 v[136:137], v12 offset:6400
  ds_read_b64_tr_b16 v[138:139], v13 offset:6400
  s_cmp_lg_u32 s3, 0
  s_cbranch_scc1 gated_mix__spectral_gfnet__ssm_conv_s5__prompt_kernel_skip43
  s_mov_b64 exec, 1
  buffer_store_dword v5, v38, s[16:19], s56 offen sc1
  s_mov_b64 exec, -1
gated_mix__spectral_gfnet__ssm_conv_s5__prompt_kernel_skip43:
  s_waitcnt lgkmcnt(0)
  v_mfma_f32_16x16x32_bf16 v[16:19], v[100:103], a[0:3], v[16:19]
  ds_read_b64_tr_b16 v[140:141], v12 offset:8192
  ds_read_b64_tr_b16 v[142:143], v13 offset:8192
  v_mfma_f32_16x16x32_bf16 v[48:51], v[100:103], a[8:11], 0
  ds_read_b64_tr_b16 v[144:145], v12 offset:10240
  ds_read_b64_tr_b16 v[146:147], v13 offset:10240
  v_mfma_f32_16x16x32_bf16 v[52:55], v[104:107], a[8:11], 0
  ds_read_b64_tr_b16 v[148:149], v12 offset:12288
  ds_read_b64_tr_b16 v[150:151], v13 offset:12288
  v_mfma_f32_16x16x32_bf16 v[20:23], v[104:107], a[0:3], v[20:23]
  ds_read_b64_tr_b16 v[152:153], v12 offset:14336
  ds_read_b64_tr_b16 v[154:155], v13 offset:14336
  v_mfma_f32_16x16x32_bf16 v[40:43], v[108:111], a[0:3], v[40:43]
  ds_read_b64_tr_b16 v[156:157], v12 offset:8448
  ds_read_b64_tr_b16 v[158:159], v13 offset:8448
  v_mfma_f32_16x16x32_bf16 v[56:59], v[108:111], a[8:11], 0
  ds_read_b64_tr_b16 v[160:161], v12 offset:10496
  ds_read_b64_tr_b16 v[162:163], v13 offset:10496
  v_mfma_f32_16x16x32_bf16 v[64:67], v[112:115], a[8:11], 0
  ds_read_b64_tr_b16 v[164:165], v12 offset:12544
  ds_read_b64_tr_b16 v[166:167], v13 offset:12544
  v_mfma_f32_16x16x32_bf16 v[44:47], v[112:115], a[0:3], v[44:47]
  ds_read_b64_tr_b16 v[168:169], v12 offset:14592
  ds_read_b64_tr_b16 v[170:171], v13 offset:14592
  v_mfma_f32_16x16x32_bf16 v[16:19], v[116:119], a[4:7], v[16:19]
  s_add_u32 m0, s6, 32768
  s_nop 0
  buffer_load_dwordx4 v9, s[12:15], s29 offen offset:0 sc1 lds
  s_mov_b32 s24, s30
  s_mov_b32 s25, s31
  v_mfma_f32_16x16x32_bf16 v[48:51], v[116:119], a[12:15], v[48:51]
  s_mov_b32 s26, 8388608
  s_mov_b32 s27, 0x20000
  v_mfma_f32_16x16x32_bf16 v[52:55], v[120:123], a[12:15], v[52:55]
  buffer_load_dwordx4 v9, s[12:15], s29 offen offset:1024 sc1 lds
  s_mov_b32 s44, s34
  s_mov_b32 s45, s35
  v_mfma_f32_16x16x32_bf16 v[20:23], v[120:123], a[4:7], v[20:23]
  s_mov_b32 s46, 4194304
  s_mov_b32 s47, 0x20000
  v_mfma_f32_16x16x32_bf16 v[40:43], v[132:135], a[4:7], v[40:43]
  buffer_load_dwordx4 v9, s[12:15], s29 offen offset:2048 sc1 lds
  v_lshlrev_b32 v8, 4, v1
  v_lshrrev_b32 v11, 5, v1
  v_mfma_f32_16x16x32_bf16 v[56:59], v[132:135], a[12:15], v[56:59]
  v_lshlrev_b32 v6, 9, v11
  v_lshlrev_b32 v10, 7, v11
  v_mfma_f32_16x16x32_bf16 v[64:67], v[136:139], a[12:15], v[64:67]
  buffer_load_dwordx4 v9, s[12:15], s29 offen offset:3072 sc1 lds
  s_add_u32 s29, s29, 32768
  s_and_b32 s29, s29, 0x3ffff
  v_bfe_u32 v11, v1, 3, 2
  v_lshl_or_b32 v6, v11, 6, v6
  v_mfma_f32_16x16x32_bf16 v[44:47], v[136:139], a[4:7], v[44:47]
  v_and_b32 v11, 3, v1
  v_lshl_or_b32 v6, v11, 4, v6
  s_waitcnt vmcnt(8) lgkmcnt(0)
  s_barrier
  v_mfma_f32_16x16x32_bf16 v[16:19], v[140:143], a[16:19], v[16:19]
  ds_read_b64_tr_b16 v[100:101], v12 offset:16384
  ds_read_b64_tr_b16 v[102:103], v13 offset:16384
  v_mfma_f32_16x16x32_bf16 v[48:51], v[140:143], a[24:27], v[48:51]
  ds_read_b64_tr_b16 v[104:105], v12 offset:18432
  ds_read_b64_tr_b16 v[106:107], v13 offset:18432
  v_mfma_f32_16x16x32_bf16 v[52:55], v[144:147], a[24:27], v[52:55]
  ds_read_b64_tr_b16 v[108:109], v12 offset:20480
  ds_read_b64_tr_b16 v[110:111], v13 offset:20480
  v_mfma_f32_16x16x32_bf16 v[20:23], v[144:147], a[16:19], v[20:23]
  ds_read_b64_tr_b16 v[112:113], v12 offset:22528
  ds_read_b64_tr_b16 v[114:115], v13 offset:22528
  v_mfma_f32_16x16x32_bf16 v[40:43], v[148:151], a[16:19], v[40:43]
  ds_read_b64_tr_b16 v[116:117], v12 offset:16640
  ds_read_b64_tr_b16 v[118:119], v13 offset:16640
  v_mfma_f32_16x16x32_bf16 v[56:59], v[148:151], a[24:27], v[56:59]
  ds_read_b64_tr_b16 v[120:121], v12 offset:18688
  ds_read_b64_tr_b16 v[122:123], v13 offset:18688
  v_mfma_f32_16x16x32_bf16 v[64:67], v[152:155], a[24:27], v[64:67]
  ds_read_b64_tr_b16 v[132:133], v12 offset:20736
  ds_read_b64_tr_b16 v[134:135], v13 offset:20736
  v_mfma_f32_16x16x32_bf16 v[44:47], v[152:155], a[16:19], v[44:47]
  ds_read_b64_tr_b16 v[136:137], v12 offset:22784
  ds_read_b64_tr_b16 v[138:139], v13 offset:22784
  v_mfma_f32_16x16x32_bf16 v[16:19], v[156:159], a[20:23], v[16:19]
  s_add_u32 m0, s43, 114688
  s_nop 0
  buffer_load_dwordx4 v124, s[68:71], s28 offen offset:0 lds
  v_and_b32 v11, 4, v1
  v_lshl_or_b32 v6, v11, 1, v6
  v_mfma_f32_16x16x32_bf16 v[48:51], v[156:159], a[28:31], v[48:51]
  s_lshl_b32 s33, s3, 12
  s_add_u32 s33, s33, 131072
  v_mfma_f32_16x16x32_bf16 v[52:55], v[160:163], a[28:31], v[52:55]
  buffer_load_dwordx4 v125, s[68:71], s28 offen offset:1024 lds
  v_add_u32 v6, s33, v6
  v_and_or_b32 v10, v1, 16, v10
  v_mfma_f32_16x16x32_bf16 v[20:23], v[160:163], a[20:23], v[20:23]
  s_lshl_b32 s33, s41, 6
  v_lshl_add_u32 v36, v2, 2, s33
  v_mfma_f32_16x16x32_bf16 v[40:43], v[164:167], a[20:23], v[40:43]
  s_add_u32 m0, s43, 116736
  s_nop 0
  buffer_load_dwordx4 v126, s[68:71], s28 offen offset:0 lds
  v_lshl_or_b32 v36, v3, 18, v36
  v_xor_b32 v37, 512, v36
  v_mfma_f32_16x16x32_bf16 v[56:59], v[164:167], a[28:31], v[56:59]
  s_lshr_b32 s33, s41, 3
  s_lshl_b32 s7, s33, 10
  v_mfma_f32_16x16x32_bf16 v[64:67], v[168:171], a[28:31], v[64:67]
  buffer_load_dwordx4 v127, s[68:71], s28 offen offset:1024 lds
  s_add_u32 s7, s7, s40
  s_lshl2_add_u32 s7, s7, s3
  v_mfma_f32_16x16x32_bf16 v[44:47], v[168:171], a[20:23], v[44:47]
  s_lshl_b32 s7, s7, 10
  s_xor_b32 s8, s33, 1
  s_waitcnt lgkmcnt(0)
  v_mfma_f32_16x16x32_bf16 v[16:19], v[100:103], a[32:35], v[16:19]
  ds_read_b64_tr_b16 v[140:141], v12 offset:24576
  ds_read_b64_tr_b16 v[142:143], v13 offset:24576
  v_mfma_f32_16x16x32_bf16 v[48:51], v[100:103], a[40:43], v[48:51]
  ds_read_b64_tr_b16 v[144:145], v12 offset:26624
  ds_read_b64_tr_b16 v[146:147], v13 offset:26624
  v_mfma_f32_16x16x32_bf16 v[52:55], v[104:107], a[40:43], v[52:55]
  ds_read_b64_tr_b16 v[148:149], v12 offset:28672
  ds_read_b64_tr_b16 v[150:151], v13 offset:28672
  v_mfma_f32_16x16x32_bf16 v[20:23], v[104:107], a[32:35], v[20:23]
  ds_read_b64_tr_b16 v[152:153], v12 offset:30720
  ds_read_b64_tr_b16 v[154:155], v13 offset:30720
  v_mfma_f32_16x16x32_bf16 v[40:43], v[108:111], a[32:35], v[40:43]
  ds_read_b64_tr_b16 v[156:157], v12 offset:24832
  ds_read_b64_tr_b16 v[158:159], v13 offset:24832
  v_mfma_f32_16x16x32_bf16 v[56:59], v[108:111], a[40:43], v[56:59]
  ds_read_b64_tr_b16 v[160:161], v12 offset:26880
  ds_read_b64_tr_b16 v[162:163], v13 offset:26880
  v_mfma_f32_16x16x32_bf16 v[64:67], v[112:115], a[40:43], v[64:67]
  ds_read_b64_tr_b16 v[164:165], v12 offset:28928
  ds_read_b64_tr_b16 v[166:167], v13 offset:28928
  v_mfma_f32_16x16x32_bf16 v[44:47], v[112:115], a[32:35], v[44:47]
  ds_read_b64_tr_b16 v[168:169], v12 offset:30976
  ds_read_b64_tr_b16 v[170:171], v13 offset:30976
  v_mfma_f32_16x16x32_bf16 v[16:19], v[116:119], a[36:39], v[16:19]
  s_add_u32 m0, s6, 49152
  s_nop 0
  buffer_load_dwordx4 v9, s[12:15], s29 offen offset:0 sc1 lds
  s_lshl1_add_u32 s8, s40, s8
  s_lshl_b32 s8, s8, 10
  v_mfma_f32_16x16x32_bf16 v[48:51], v[116:119], a[44:47], v[48:51]
  s_lshl4_add_u32 s9, s40, s41
  s_and_b32 s32, s3, 2
  v_mfma_f32_16x16x32_bf16 v[52:55], v[120:123], a[44:47], v[52:55]
  buffer_load_dwordx4 v9, s[12:15], s29 offen offset:1024 sc1 lds
  s_lshl_b32 s32, s32, 2
  s_xor_b32 s32, s32, s9
  v_mfma_f32_16x16x32_bf16 v[20:23], v[120:123], a[36:39], v[20:23]
  s_lshl1_add_u32 s32, s32, s33
  s_and_b32 s33, s3, 1
  v_mfma_f32_16x16x32_bf16 v[40:43], v[132:135], a[36:39], v[40:43]
  buffer_load_dwordx4 v9, s[12:15], s29 offen offset:2048 sc1 lds
  s_lshl1_add_u32 s32, s32, s33
  s_lshl_b32 s32, s32, 12
  v_mfma_f32_16x16x32_bf16 v[56:59], v[132:135], a[44:47], v[56:59]
  s_lshl2_add_u32 s9, s9, s3
  s_lshl_b32 s9, s9, 13
  v_mfma_f32_16x16x32_bf16 v[64:67], v[136:139], a[44:47], v[64:67]
  buffer_load_dwordx4 v9, s[12:15], s29 offen offset:3072 sc1 lds
  s_add_u32 s29, s29, 32768
  s_and_b32 s29, s29, 0x3ffff
  s_lshr_b32 s33, s41, 3
  s_or_b32 s33, s33, s3
  v_mfma_f32_16x16x32_bf16 v[44:47], v[136:139], a[36:39], v[44:47]
  s_and_b32 s33, s33, 1
  s_lshr_b32 s9, s9, 1
  s_waitcnt vmcnt(12)
  ds_read_b128 a[208:211], v130 offset:32768
  ds_read_b128 a[212:215], v131 offset:32768
  ds_read_b128 a[216:219], v130 offset:34816
  ds_read_b128 a[220:223], v131 offset:34816
  s_waitcnt vmcnt(8) lgkmcnt(4)
  s_barrier
  v_mfma_f32_16x16x32_bf16 v[16:19], v[140:143], a[48:51], v[16:19]
  ds_read_b64_tr_b16 v[100:101], v12 offset:32768
  ds_read_b64_tr_b16 v[102:103], v13 offset:32768
  v_mfma_f32_16x16x32_bf16 v[48:51], v[140:143], a[56:59], v[48:51]
  ds_read_b64_tr_b16 v[104:105], v12 offset:34816
  ds_read_b64_tr_b16 v[106:107], v13 offset:34816
  v_mfma_f32_16x16x32_bf16 v[52:55], v[144:147], a[56:59], v[52:55]
  ds_read_b64_tr_b16 v[108:109], v12 offset:36864
  ds_read_b64_tr_b16 v[110:111], v13 offset:36864
  v_mfma_f32_16x16x32_bf16 v[20:23], v[144:147], a[48:51], v[20:23]
  ds_read_b64_tr_b16 v[112:113], v12 offset:38912
  ds_read_b64_tr_b16 v[114:115], v13 offset:38912
  v_mfma_f32_16x16x32_bf16 v[40:43], v[148:151], a[48:51], v[40:43]
  ds_read_b64_tr_b16 v[116:117], v12 offset:33024
  ds_read_b64_tr_b16 v[118:119], v13 offset:33024
  v_mfma_f32_16x16x32_bf16 v[56:59], v[148:151], a[56:59], v[56:59]
  ds_read_b64_tr_b16 v[120:121], v12 offset:35072
  ds_read_b64_tr_b16 v[122:123], v13 offset:35072
  v_mfma_f32_16x16x32_bf16 v[64:67], v[152:155], a[56:59], v[64:67]
  ds_read_b64_tr_b16 v[132:133], v12 offset:37120
  ds_read_b64_tr_b16 v[134:135], v13 offset:37120
  v_mfma_f32_16x16x32_bf16 v[44:47], v[152:155], a[48:51], v[44:47]
  ds_read_b64_tr_b16 v[136:137], v12 offset:39168
  ds_read_b64_tr_b16 v[138:139], v13 offset:39168
  v_mfma_f32_16x16x32_bf16 v[16:19], v[156:159], a[52:55], v[16:19]
  s_add_u32 m0, s43, 147456
  s_nop 0
  buffer_load_dwordx4 v124, s[72:75], s28 offen offset:0 lds
  s_mov_b32 s58, 0x07060302
  v_mfma_f32_16x16x32_bf16 v[48:51], v[156:159], a[60:63], v[48:51]
  v_mfma_f32_16x16x32_bf16 v[52:55], v[160:163], a[60:63], v[52:55]
  buffer_load_dwordx4 v125, s[72:75], s28 offen offset:1024 lds
  v_mfma_f32_16x16x32_bf16 v[20:23], v[160:163], a[52:55], v[20:23]
  v_mfma_f32_16x16x32_bf16 v[40:43], v[164:167], a[52:55], v[40:43]
  s_add_u32 m0, s43, 149504
  s_nop 0
  buffer_load_dwordx4 v126, s[72:75], s28 offen offset:0 lds
  v_mfma_f32_16x16x32_bf16 v[56:59], v[164:167], a[60:63], v[56:59]
  v_mfma_f32_16x16x32_bf16 v[64:67], v[168:171], a[60:63], v[64:67]
  buffer_load_dwordx4 v127, s[72:75], s28 offen offset:1024 lds
  s_add_u32 s28, s28, 128
  s_and_b32 s28, s28, 0x3ff
  v_mfma_f32_16x16x32_bf16 v[44:47], v[168:171], a[52:55], v[44:47]
  s_waitcnt lgkmcnt(0)
  v_mfma_f32_16x16x32_bf16 v[16:19], v[100:103], a[64:67], v[16:19]
  ds_read_b64_tr_b16 v[140:141], v12 offset:40960
  ds_read_b64_tr_b16 v[142:143], v13 offset:40960
  v_mfma_f32_16x16x32_bf16 v[48:51], v[100:103], a[72:75], v[48:51]
  ds_read_b64_tr_b16 v[144:145], v12 offset:43008
  ds_read_b64_tr_b16 v[146:147], v13 offset:43008
  v_mfma_f32_16x16x32_bf16 v[52:55], v[104:107], a[72:75], v[52:55]
  ds_read_b64_tr_b16 v[148:149], v12 offset:45056
  ds_read_b64_tr_b16 v[150:151], v13 offset:45056
  v_mfma_f32_16x16x32_bf16 v[20:23], v[104:107], a[64:67], v[20:23]
  ds_read_b64_tr_b16 v[152:153], v12 offset:47104
  ds_read_b64_tr_b16 v[154:155], v13 offset:47104
  v_mfma_f32_16x16x32_bf16 v[40:43], v[108:111], a[64:67], v[40:43]
  ds_read_b64_tr_b16 v[156:157], v12 offset:41216
  ds_read_b64_tr_b16 v[158:159], v13 offset:41216
  v_mfma_f32_16x16x32_bf16 v[56:59], v[108:111], a[72:75], v[56:59]
  ds_read_b64_tr_b16 v[160:161], v12 offset:43264
  ds_read_b64_tr_b16 v[162:163], v13 offset:43264
  v_mfma_f32_16x16x32_bf16 v[64:67], v[112:115], a[72:75], v[64:67]
  ds_read_b64_tr_b16 v[164:165], v12 offset:45312
  ds_read_b64_tr_b16 v[166:167], v13 offset:45312
  v_mfma_f32_16x16x32_bf16 v[44:47], v[112:115], a[64:67], v[44:47]
  ds_read_b64_tr_b16 v[168:169], v12 offset:47360
  ds_read_b64_tr_b16 v[170:171], v13 offset:47360
  v_mfma_f32_16x16x32_bf16 v[16:19], v[116:119], a[68:71], v[16:19]
  s_add_u32 m0, s6, 65536
  s_nop 0
  buffer_load_dwordx4 v9, s[12:15], s29 offen offset:0 sc1 lds
  v_mfma_f32_16x16x32_bf16 v[48:51], v[116:119], a[76:79], v[48:51]
  v_mfma_f32_16x16x32_bf16 v[52:55], v[120:123], a[76:79], v[52:55]
  buffer_load_dwordx4 v9, s[12:15], s29 offen offset:1024 sc1 lds
  v_mfma_f32_16x16x32_bf16 v[20:23], v[120:123], a[68:71], v[20:23]
  v_mfma_f32_16x16x32_bf16 v[40:43], v[132:135], a[68:71], v[40:43]
  buffer_load_dwordx4 v9, s[12:15], s29 offen offset:2048 sc1 lds
  v_mfma_f32_16x16x32_bf16 v[56:59], v[132:135], a[76:79], v[56:59]
  v_mfma_f32_16x16x32_bf16 v[64:67], v[136:139], a[76:79], v[64:67]
  buffer_load_dwordx4 v9, s[12:15], s29 offen offset:3072 sc1 lds
  s_add_u32 s29, s29, 32768
  s_and_b32 s29, s29, 0x3ffff
  v_mfma_f32_16x16x32_bf16 v[44:47], v[136:139], a[68:71], v[44:47]
  s_waitcnt vmcnt(12)
  ds_read_b128 a[224:227], v130 offset:49152
  ds_read_b128 a[228:231], v131 offset:49152
  ds_read_b128 a[232:235], v130 offset:51200
  ds_read_b128 a[236:239], v131 offset:51200
  s_waitcnt vmcnt(8) lgkmcnt(4)
  s_barrier
  v_mfma_f32_16x16x32_bf16 v[16:19], v[140:143], a[80:83], v[16:19]
  ds_read_b64_tr_b16 v[100:101], v12 offset:49152
  ds_read_b64_tr_b16 v[102:103], v13 offset:49152
  v_mfma_f32_16x16x32_bf16 v[48:51], v[140:143], a[88:91], v[48:51]
  ds_read_b64_tr_b16 v[104:105], v12 offset:51200
  ds_read_b64_tr_b16 v[106:107], v13 offset:51200
  v_mfma_f32_16x16x32_bf16 v[52:55], v[144:147], a[88:91], v[52:55]
  ds_read_b64_tr_b16 v[108:109], v12 offset:53248
  ds_read_b64_tr_b16 v[110:111], v13 offset:53248
  v_mfma_f32_16x16x32_bf16 v[20:23], v[144:147], a[80:83], v[20:23]
  ds_read_b64_tr_b16 v[112:113], v12 offset:55296
  ds_read_b64_tr_b16 v[114:115], v13 offset:55296
  v_mfma_f32_16x16x32_bf16 v[40:43], v[148:151], a[80:83], v[40:43]
  ds_read_b64_tr_b16 v[116:117], v12 offset:49408
  ds_read_b64_tr_b16 v[118:119], v13 offset:49408
  v_mfma_f32_16x16x32_bf16 v[56:59], v[148:151], a[88:91], v[56:59]
  ds_read_b64_tr_b16 v[120:121], v12 offset:51456
  ds_read_b64_tr_b16 v[122:123], v13 offset:51456
  v_mfma_f32_16x16x32_bf16 v[64:67], v[152:155], a[88:91], v[64:67]
  ds_read_b64_tr_b16 v[132:133], v12 offset:53504
  ds_read_b64_tr_b16 v[134:135], v13 offset:53504
  v_mfma_f32_16x16x32_bf16 v[44:47], v[152:155], a[80:83], v[44:47]
  ds_read_b64_tr_b16 v[136:137], v12 offset:55552
  ds_read_b64_tr_b16 v[138:139], v13 offset:55552
  v_mfma_f32_16x16x32_bf16 v[16:19], v[156:159], a[84:87], v[16:19]
  s_add_u32 m0, s6, 81920
  s_nop 0
  buffer_load_dwordx4 v9, s[12:15], s29 offen offset:0 sc1 lds
  v_mfma_f32_16x16x32_bf16 v[48:51], v[156:159], a[92:95], v[48:51]
  v_mfma_f32_16x16x32_bf16 v[52:55], v[160:163], a[92:95], v[52:55]
  buffer_load_dwordx4 v9, s[12:15], s29 offen offset:1024 sc1 lds
  v_mfma_f32_16x16x32_bf16 v[20:23], v[160:163], a[84:87], v[20:23]
  v_mfma_f32_16x16x32_bf16 v[40:43], v[164:167], a[84:87], v[40:43]
  buffer_load_dwordx4 v9, s[12:15], s29 offen offset:2048 sc1 lds
  v_mfma_f32_16x16x32_bf16 v[56:59], v[164:167], a[92:95], v[56:59]
  v_mfma_f32_16x16x32_bf16 v[64:67], v[168:171], a[92:95], v[64:67]
  buffer_load_dwordx4 v9, s[12:15], s29 offen offset:3072 sc1 lds
  s_add_u32 s29, s29, 32768
  s_and_b32 s29, s29, 0x3ffff
  v_mfma_f32_16x16x32_bf16 v[44:47], v[168:171], a[84:87], v[44:47]
  s_waitcnt lgkmcnt(0)
  v_mfma_f32_16x16x32_bf16 v[16:19], v[100:103], a[96:99], v[16:19]
  ds_read_b64_tr_b16 v[140:141], v12 offset:57344
  ds_read_b64_tr_b16 v[142:143], v13 offset:57344
  v_mfma_f32_16x16x32_bf16 v[48:51], v[100:103], a[104:107], v[48:51]
  ds_read_b64_tr_b16 v[144:145], v12 offset:59392
  ds_read_b64_tr_b16 v[146:147], v13 offset:59392
  v_mfma_f32_16x16x32_bf16 v[52:55], v[104:107], a[104:107], v[52:55]
  ds_read_b64_tr_b16 v[148:149], v12 offset:61440
  ds_read_b64_tr_b16 v[150:151], v13 offset:61440
  v_mfma_f32_16x16x32_bf16 v[20:23], v[104:107], a[96:99], v[20:23]
  ds_read_b64_tr_b16 v[152:153], v12 offset:63488
  ds_read_b64_tr_b16 v[154:155], v13 offset:63488
  v_mfma_f32_16x16x32_bf16 v[40:43], v[108:111], a[96:99], v[40:43]
  ds_read_b64_tr_b16 v[156:157], v12 offset:57600
  ds_read_b64_tr_b16 v[158:159], v13 offset:57600
  v_mfma_f32_16x16x32_bf16 v[56:59], v[108:111], a[104:107], v[56:59]
  ds_read_b64_tr_b16 v[160:161], v12 offset:59648
  ds_read_b64_tr_b16 v[162:163], v13 offset:59648
  v_mfma_f32_16x16x32_bf16 v[64:67], v[112:115], a[104:107], v[64:67]
  ds_read_b64_tr_b16 v[164:165], v12 offset:61696
  ds_read_b64_tr_b16 v[166:167], v13 offset:61696
  v_mfma_f32_16x16x32_bf16 v[44:47], v[112:115], a[96:99], v[44:47]
  ds_read_b64_tr_b16 v[168:169], v12 offset:63744
  ds_read_b64_tr_b16 v[170:171], v13 offset:63744
  v_mfma_f32_16x16x32_bf16 v[16:19], v[116:119], a[100:103], v[16:19]
  s_add_u32 m0, s6, 0
  s_nop 0
  buffer_load_dwordx4 v9, s[12:15], s29 offen offset:0 sc1 lds
  v_mfma_f32_16x16x32_bf16 v[48:51], v[116:119], a[108:111], v[48:51]
  v_mfma_f32_16x16x32_bf16 v[52:55], v[120:123], a[108:111], v[52:55]
  buffer_load_dwordx4 v9, s[12:15], s29 offen offset:1024 sc1 lds
  v_mfma_f32_16x16x32_bf16 v[20:23], v[120:123], a[100:103], v[20:23]
  v_mfma_f32_16x16x32_bf16 v[40:43], v[132:135], a[100:103], v[40:43]
  buffer_load_dwordx4 v9, s[12:15], s29 offen offset:2048 sc1 lds
  v_mfma_f32_16x16x32_bf16 v[56:59], v[132:135], a[108:111], v[56:59]
  v_mfma_f32_16x16x32_bf16 v[64:67], v[136:139], a[108:111], v[64:67]
  buffer_load_dwordx4 v9, s[12:15], s29 offen offset:3072 sc1 lds
  s_add_u32 s29, s29, 32768
  s_and_b32 s29, s29, 0x3ffff
  v_mfma_f32_16x16x32_bf16 v[44:47], v[136:139], a[100:103], v[44:47]
  v_xor_b32 v130, 0x30000, v130
  v_xor_b32 v131, 0x30000, v131
  s_waitcnt vmcnt(12)
  ds_read_b128 a[240:243], v130 offset:16384
  ds_read_b128 a[244:247], v131 offset:16384
  ds_read_b128 a[248:251], v130 offset:18432
  ds_read_b128 a[252:255], v131 offset:18432
  s_waitcnt vmcnt(8) lgkmcnt(4)
  s_barrier
  v_mfma_f32_16x16x32_bf16 v[16:19], v[140:143], a[112:115], v[16:19]
  ds_read_b64_tr_b16 v[100:101], v14 offset:0
  ds_read_b64_tr_b16 v[102:103], v15 offset:0
  v_mfma_f32_16x16x32_bf16 v[48:51], v[140:143], a[120:123], v[48:51]
  ds_read_b64_tr_b16 v[104:105], v14 offset:2048
  ds_read_b64_tr_b16 v[106:107], v15 offset:2048
  v_mfma_f32_16x16x32_bf16 v[52:55], v[144:147], a[120:123], v[52:55]
  ds_read_b64_tr_b16 v[108:109], v14 offset:4096
  ds_read_b64_tr_b16 v[110:111], v15 offset:4096
  v_mfma_f32_16x16x32_bf16 v[20:23], v[144:147], a[112:115], v[20:23]
  ds_read_b64_tr_b16 v[112:113], v14 offset:6144
  ds_read_b64_tr_b16 v[114:115], v15 offset:6144
  v_mfma_f32_16x16x32_bf16 v[40:43], v[148:151], a[112:115], v[40:43]
  ds_read_b64_tr_b16 v[116:117], v14 offset:256
  ds_read_b64_tr_b16 v[118:119], v15 offset:256
  v_mfma_f32_16x16x32_bf16 v[56:59], v[148:151], a[120:123], v[56:59]
  ds_read_b64_tr_b16 v[120:121], v14 offset:2304
  ds_read_b64_tr_b16 v[122:123], v15 offset:2304
  v_mfma_f32_16x16x32_bf16 v[64:67], v[152:155], a[120:123], v[64:67]
  ds_read_b64_tr_b16 v[132:133], v14 offset:4352
  ds_read_b64_tr_b16 v[134:135], v15 offset:4352
  v_mfma_f32_16x16x32_bf16 v[44:47], v[152:155], a[112:115], v[44:47]
  ds_read_b64_tr_b16 v[136:137], v14 offset:6400
  ds_read_b64_tr_b16 v[138:139], v15 offset:6400
  v_mfma_f32_16x16x32_bf16 v[16:19], v[156:159], a[116:119], v[16:19]
  s_add_u32 m0, s6, 16384
  s_nop 0
  buffer_load_dwordx4 v9, s[12:15], s29 offen offset:0 sc1 lds
  v_mfma_f32_16x16x32_bf16 v[48:51], v[156:159], a[124:127], v[48:51]
  v_mfma_f32_16x16x32_bf16 v[52:55], v[160:163], a[124:127], v[52:55]
  buffer_load_dwordx4 v9, s[12:15], s29 offen offset:1024 sc1 lds
  v_mfma_f32_16x16x32_bf16 v[20:23], v[160:163], a[116:119], v[20:23]
  v_mfma_f32_16x16x32_bf16 v[40:43], v[164:167], a[116:119], v[40:43]
  buffer_load_dwordx4 v9, s[12:15], s29 offen offset:2048 sc1 lds
  v_mfma_f32_16x16x32_bf16 v[56:59], v[164:167], a[124:127], v[56:59]
  v_mfma_f32_16x16x32_bf16 v[64:67], v[168:171], a[124:127], v[64:67]
  buffer_load_dwordx4 v9, s[12:15], s29 offen offset:3072 sc1 lds
  s_add_u32 s29, s29, 32768
  s_and_b32 s29, s29, 0x3ffff
  v_xor_b32 v9, 8192, v9
  v_mfma_f32_16x16x32_bf16 v[44:47], v[168:171], a[116:119], v[44:47]
  buffer_load_dword v188, v7, s[16:19], s56 offen sc1
  s_waitcnt lgkmcnt(0)
  v_mfma_f32_16x16x32_bf16 v[16:19], v[100:103], a[128:131], v[16:19]
  ds_read_b64_tr_b16 v[140:141], v14 offset:8192
  ds_read_b64_tr_b16 v[142:143], v15 offset:8192
  v_mfma_f32_16x16x32_bf16 v[48:51], v[100:103], a[136:139], v[48:51]
  ds_read_b64_tr_b16 v[144:145], v14 offset:10240
  ds_read_b64_tr_b16 v[146:147], v15 offset:10240
  v_mfma_f32_16x16x32_bf16 v[52:55], v[104:107], a[136:139], v[52:55]
  ds_read_b64_tr_b16 v[148:149], v14 offset:12288
  ds_read_b64_tr_b16 v[150:151], v15 offset:12288
  v_mfma_f32_16x16x32_bf16 v[20:23], v[104:107], a[128:131], v[20:23]
  ds_read_b64_tr_b16 v[152:153], v14 offset:14336
  ds_read_b64_tr_b16 v[154:155], v15 offset:14336
  v_mfma_f32_16x16x32_bf16 v[40:43], v[108:111], a[128:131], v[40:43]
  ds_read_b64_tr_b16 v[156:157], v14 offset:8448
  ds_read_b64_tr_b16 v[158:159], v15 offset:8448
  v_mfma_f32_16x16x32_bf16 v[56:59], v[108:111], a[136:139], v[56:59]
  ds_read_b64_tr_b16 v[160:161], v14 offset:10496
  ds_read_b64_tr_b16 v[162:163], v15 offset:10496
  v_mfma_f32_16x16x32_bf16 v[64:67], v[112:115], a[136:139], v[64:67]
  ds_read_b64_tr_b16 v[164:165], v14 offset:12544
  ds_read_b64_tr_b16 v[166:167], v15 offset:12544
  v_mfma_f32_16x16x32_bf16 v[44:47], v[112:115], a[128:131], v[44:47]
  ds_read_b64_tr_b16 v[168:169], v14 offset:14592
  ds_read_b64_tr_b16 v[170:171], v15 offset:14592
  v_mfma_f32_16x16x32_bf16 v[16:19], v[116:119], a[132:135], v[16:19]
  s_lshr_b32 m0, s3, 1
  s_lshl_b32 m0, m0, 15
  s_add_u32 s29, s29, m0
  s_and_b32 s29, s29, 0x3ffff
  s_and_b32 m0, s3, 1
  s_lshl_b32 m0, m0, 14
  v_and_b32 v9, 0xffffafff, v9
  v_or_b32 v9, m0, v9
  s_add_u32 m0, s6, 32768
  s_nop 0
  buffer_load_dwordx4 v9, s[12:15], s29 offen offset:0 sc1 lds
  v_mfma_f32_16x16x32_bf16 v[48:51], v[116:119], a[140:143], v[48:51]
  v_mfma_f32_16x16x32_bf16 v[52:55], v[120:123], a[140:143], v[52:55]
  buffer_load_dwordx4 v9, s[12:15], s29 offen offset:1024 sc1 lds
  v_mfma_f32_16x16x32_bf16 v[20:23], v[120:123], a[132:135], v[20:23]
  v_mfma_f32_16x16x32_bf16 v[40:43], v[132:135], a[132:135], v[40:43]
  buffer_load_dwordx4 v9, s[12:15], s29 offen offset:2048 sc1 lds
  v_mfma_f32_16x16x32_bf16 v[56:59], v[132:135], a[140:143], v[56:59]
  v_mfma_f32_16x16x32_bf16 v[64:67], v[136:139], a[140:143], v[64:67]
  buffer_load_dwordx4 v9, s[12:15], s29 offen offset:3072 sc1 lds
  s_add_u32 s29, s29, 65536
  s_and_b32 s29, s29, 0x3ffff
  v_mfma_f32_16x16x32_bf16 v[44:47], v[136:139], a[132:135], v[44:47]
  s_waitcnt vmcnt(13) lgkmcnt(0)
  s_barrier
  v_mfma_f32_16x16x32_bf16 v[16:19], v[140:143], a[144:147], v[16:19]
  ds_read_b64_tr_b16 v[100:101], v14 offset:16384
  ds_read_b64_tr_b16 v[102:103], v15 offset:16384
  v_mfma_f32_16x16x32_bf16 v[48:51], v[140:143], a[152:155], v[48:51]
  ds_read_b64_tr_b16 v[104:105], v14 offset:18432
  ds_read_b64_tr_b16 v[106:107], v15 offset:18432
  v_mfma_f32_16x16x32_bf16 v[52:55], v[144:147], a[152:155], v[52:55]
  ds_read_b64_tr_b16 v[108:109], v14 offset:20480
  ds_read_b64_tr_b16 v[110:111], v15 offset:20480
  v_mfma_f32_16x16x32_bf16 v[20:23], v[144:147], a[144:147], v[20:23]
  ds_read_b64_tr_b16 v[112:113], v14 offset:22528
  ds_read_b64_tr_b16 v[114:115], v15 offset:22528
  v_mfma_f32_16x16x32_bf16 v[40:43], v[148:151], a[144:147], v[40:43]
  ds_read_b64_tr_b16 v[116:117], v14 offset:16640
  ds_read_b64_tr_b16 v[118:119], v15 offset:16640
  v_mfma_f32_16x16x32_bf16 v[56:59], v[148:151], a[152:155], v[56:59]
  ds_read_b64_tr_b16 v[120:121], v14 offset:18688
  ds_read_b64_tr_b16 v[122:123], v15 offset:18688
  v_mfma_f32_16x16x32_bf16 v[64:67], v[152:155], a[152:155], v[64:67]
  ds_read_b64_tr_b16 v[132:133], v14 offset:20736
  ds_read_b64_tr_b16 v[134:135], v15 offset:20736
  v_mfma_f32_16x16x32_bf16 v[44:47], v[152:155], a[144:147], v[44:47]
  ds_read_b64_tr_b16 v[136:137], v14 offset:22784
  ds_read_b64_tr_b16 v[138:139], v15 offset:22784
  v_mfma_f32_16x16x32_bf16 v[16:19], v[156:159], a[148:151], v[16:19]
  s_add_u32 m0, s6, 49152
  s_nop 0
  buffer_load_dwordx4 v9, s[12:15], s29 offen offset:0 sc1 lds
  v_mfma_f32_16x16x32_bf16 v[48:51], v[156:159], a[156:159], v[48:51]
  v_mfma_f32_16x16x32_bf16 v[52:55], v[160:163], a[156:159], v[52:55]
  buffer_load_dwordx4 v9, s[12:15], s29 offen offset:1024 sc1 lds
  v_mfma_f32_16x16x32_bf16 v[20:23], v[160:163], a[148:151], v[20:23]
  v_mfma_f32_16x16x32_bf16 v[40:43], v[164:167], a[148:151], v[40:43]
  buffer_load_dwordx4 v9, s[12:15], s29 offen offset:2048 sc1 lds
  v_mfma_f32_16x16x32_bf16 v[56:59], v[164:167], a[156:159], v[56:59]
  v_mfma_f32_16x16x32_bf16 v[64:67], v[168:171], a[156:159], v[64:67]
  buffer_load_dwordx4 v9, s[12:15], s29 offen offset:3072 sc1 lds
  s_add_u32 s29, s29, 65536
  s_and_b32 s29, s29, 0x3ffff
  v_mfma_f32_16x16x32_bf16 v[44:47], v[168:171], a[148:151], v[44:47]
  s_cmp_lg_u32 s3, 1
  s_cbranch_scc1 gated_mix__spectral_gfnet__ssm_conv_s5__prompt_kernel_skip45
  s_getpc_b64 s[48:49]
gated_mix__spectral_gfnet__ssm_conv_s5__prompt_kernel_pc44:
  s_lshr_b32 s28, s2, 3
  s_mul_i32 s28, s28, 512
  v_min_u32 v190, 3, v1
  v_lshl_add_u32 v190, v190, 7, s28
  v_min_u32 v190, gated_mix__spectral_gfnet__ssm_conv_s5__prompt_kernel_end-gated_mix__spectral_gfnet__ssm_conv_s5__prompt_kernel_pc44, v190
  v_mov_b32 v191, 0
  v_lshl_add_u64 v[190:191], v[190:191], 0, s[48:49]
  global_load_dword v4, v[190:191], off
gated_mix__spectral_gfnet__ssm_conv_s5__prompt_kernel_skip45:
  s_waitcnt lgkmcnt(0)
  v_mfma_f32_16x16x32_bf16 v[16:19], v[100:103], a[160:163], v[16:19]
  ds_read_b64_tr_b16 v[140:141], v14 offset:24576
  ds_read_b64_tr_b16 v[142:143], v15 offset:24576
  v_mfma_f32_16x16x32_bf16 v[48:51], v[100:103], a[168:171], v[48:51]
  ds_read_b64_tr_b16 v[144:145], v14 offset:26624
  ds_read_b64_tr_b16 v[146:147], v15 offset:26624
  v_mfma_f32_16x16x32_bf16 v[52:55], v[104:107], a[168:171], v[52:55]
  ds_read_b64_tr_b16 v[148:149], v14 offset:28672
  ds_read_b64_tr_b16 v[150:151], v15 offset:28672
  v_mfma_f32_16x16x32_bf16 v[20:23], v[104:107], a[160:163], v[20:23]
  ds_read_b64_tr_b16 v[152:153], v14 offset:30720
  ds_read_b64_tr_b16 v[154:155], v15 offset:30720
  v_mfma_f32_16x16x32_bf16 v[40:43], v[108:111], a[160:163], v[40:43]
  ds_read_b64_tr_b16 v[156:157], v14 offset:24832
  ds_read_b64_tr_b16 v[158:159], v15 offset:24832
  v_mfma_f32_16x16x32_bf16 v[56:59], v[108:111], a[168:171], v[56:59]
  ds_read_b64_tr_b16 v[160:161], v14 offset:26880
  ds_read_b64_tr_b16 v[162:163], v15 offset:26880
  v_mfma_f32_16x16x32_bf16 v[64:67], v[112:115], a[168:171], v[64:67]
  ds_read_b64_tr_b16 v[164:165], v14 offset:28928
  ds_read_b64_tr_b16 v[166:167], v15 offset:28928
  v_mfma_f32_16x16x32_bf16 v[44:47], v[112:115], a[160:163], v[44:47]
  ds_read_b64_tr_b16 v[168:169], v14 offset:30976
  ds_read_b64_tr_b16 v[170:171], v15 offset:30976
  v_mfma_f32_16x16x32_bf16 v[16:19], v[116:119], a[164:167], v[16:19]
  s_add_u32 m0, s6, 65536
  s_nop 0
  buffer_load_dwordx4 v9, s[12:15], s29 offen offset:0 sc1 lds
  v_mfma_f32_16x16x32_bf16 v[48:51], v[116:119], a[172:175], v[48:51]
  v_mfma_f32_16x16x32_bf16 v[52:55], v[120:123], a[172:175], v[52:55]
  buffer_load_dwordx4 v9, s[12:15], s29 offen offset:1024 sc1 lds
  v_mfma_f32_16x16x32_bf16 v[20:23], v[120:123], a[164:167], v[20:23]
  v_mfma_f32_16x16x32_bf16 v[40:43], v[132:135], a[164:167], v[40:43]
  buffer_load_dwordx4 v9, s[12:15], s29 offen offset:2048 sc1 lds
  v_mfma_f32_16x16x32_bf16 v[56:59], v[132:135], a[172:175], v[56:59]
  v_mfma_f32_16x16x32_bf16 v[64:67], v[136:139], a[172:175], v[64:67]
  buffer_load_dwordx4 v9, s[12:15], s29 offen offset:3072 sc1 lds
  s_add_u32 s29, s29, 65536
  s_and_b32 s29, s29, 0x3ffff
  v_mfma_f32_16x16x32_bf16 v[44:47], v[136:139], a[164:167], v[44:47]
  s_waitcnt vmcnt(12)
  v_cmp_ne_u32 vcc, 1, v188
  s_nop 0
  s_cbranch_vccz gated_mix__spectral_gfnet__ssm_conv_s5__prompt_kernel_skip46
  s_mov_b32 s28, 0
gated_mix__spectral_gfnet__ssm_conv_s5__prompt_kernel_poll47:
  s_sleep 16
  buffer_load_dword v188, v7, s[16:19], s56 offen sc1
  s_waitcnt vmcnt(0)
  v_cmp_ne_u32 vcc, 1, v188
  s_nop 0
  s_cbranch_vccz gated_mix__spectral_gfnet__ssm_conv_s5__prompt_kernel_pollout48
  s_add_u32 s28, s28, 1
  s_cmp_lt_u32 s28, 1048576
  s_cbranch_scc1 gated_mix__spectral_gfnet__ssm_conv_s5__prompt_kernel_poll47
gated_mix__spectral_gfnet__ssm_conv_s5__prompt_kernel_pollout48:
gated_mix__spectral_gfnet__ssm_conv_s5__prompt_kernel_skip46:
  s_waitcnt lgkmcnt(0)
  s_barrier
  v_mfma_f32_16x16x32_bf16 v[16:19], v[140:143], a[176:179], v[16:19]
  ds_read_b64_tr_b16 v[100:101], v12 offset:0
  ds_read_b64_tr_b16 v[102:103], v13 offset:0
  v_mfma_f32_16x16x32_bf16 v[48:51], v[140:143], a[184:187], v[48:51]
  ds_read_b64_tr_b16 v[104:105], v12 offset:2048
  ds_read_b64_tr_b16 v[106:107], v13 offset:2048
  v_mfma_f32_16x16x32_bf16 v[52:55], v[144:147], a[184:187], v[52:55]
  ds_read_b64_tr_b16 v[108:109], v12 offset:4096
  ds_read_b64_tr_b16 v[110:111], v13 offset:4096
  v_mfma_f32_16x16x32_bf16 v[20:23], v[144:147], a[176:179], v[20:23]
  ds_read_b64_tr_b16 v[112:113], v12 offset:6144
  ds_read_b64_tr_b16 v[114:115], v13 offset:6144
  v_mfma_f32_16x16x32_bf16 v[40:43], v[148:151], a[176:179], v[40:43]
  ds_read_b64_tr_b16 v[116:117], v12 offset:256
  ds_read_b64_tr_b16 v[118:119], v13 offset:256
  v_mfma_f32_16x16x32_bf16 v[56:59], v[148:151], a[184:187], v[56:59]
  ds_read_b64_tr_b16 v[120:121], v12 offset:2304
  ds_read_b64_tr_b16 v[122:123], v13 offset:2304
  v_mfma_f32_16x16x32_bf16 v[64:67], v[152:155], a[184:187], v[64:67]
  ds_read_b64_tr_b16 v[132:133], v12 offset:4352
  ds_read_b64_tr_b16 v[134:135], v13 offset:4352
  v_mfma_f32_16x16x32_bf16 v[44:47], v[152:155], a[176:179], v[44:47]
  ds_read_b64_tr_b16 v[136:137], v12 offset:6400
  ds_read_b64_tr_b16 v[138:139], v13 offset:6400
  v_mfma_f32_16x16x32_bf16 v[16:19], v[156:159], a[180:183], v[16:19]
  v_mfma_f32_16x16x32_bf16 v[48:51], v[156:159], a[188:191], v[48:51]
  v_mfma_f32_16x16x32_bf16 v[52:55], v[160:163], a[188:191], v[52:55]
  v_mfma_f32_16x16x32_bf16 v[20:23], v[160:163], a[180:183], v[20:23]
  v_mfma_f32_16x16x32_bf16 v[40:43], v[164:167], a[180:183], v[40:43]
  v_mfma_f32_16x16x32_bf16 v[56:59], v[164:167], a[188:191], v[56:59]
  v_mfma_f32_16x16x32_bf16 v[64:67], v[168:171], a[188:191], v[64:67]
  v_mfma_f32_16x16x32_bf16 v[44:47], v[168:171], a[180:183], v[44:47]
  buffer_load_dwordx4 v[124:127], v8, s[20:23], s32 offen offset:0 sc1
  buffer_load_dwordx4 v[128:131], v8, s[20:23], s32 offen offset:1024 sc1
  buffer_load_dwordx4 v[188:191], v8, s[20:23], s32 offen offset:2048 sc1
  buffer_load_dwordx4 v[192:195], v8, s[20:23], s32 offen offset:3072 sc1
  s_waitcnt lgkmcnt(0)
  v_mfma_f32_16x16x32_bf16 v[16:19], v[100:103], a[192:195], v[16:19]
  ds_read_b64_tr_b16 v[140:141], v12 offset:8192
  ds_read_b64_tr_b16 v[142:143], v13 offset:8192
  v_mfma_f32_16x16x32_bf16 v[48:51], v[100:103], a[200:203], v[48:51]
  ds_read_b64_tr_b16 v[144:145], v12 offset:10240
  ds_read_b64_tr_b16 v[146:147], v13 offset:10240
  v_mfma_f32_16x16x32_bf16 v[52:55], v[104:107], a[200:203], v[52:55]
  ds_read_b64_tr_b16 v[148:149], v12 offset:12288
  ds_read_b64_tr_b16 v[150:151], v13 offset:12288
  v_mfma_f32_16x16x32_bf16 v[20:23], v[104:107], a[192:195], v[20:23]
  ds_read_b64_tr_b16 v[152:153], v12 offset:14336
  ds_read_b64_tr_b16 v[154:155], v13 offset:14336
  v_mfma_f32_16x16x32_bf16 v[40:43], v[108:111], a[192:195], v[40:43]
  ds_read_b64_tr_b16 v[156:157], v12 offset:8448
  ds_read_b64_tr_b16 v[158:159], v13 offset:8448
  v_mfma_f32_16x16x32_bf16 v[56:59], v[108:111], a[200:203], v[56:59]
  ds_read_b64_tr_b16 v[160:161], v12 offset:10496
  ds_read_b64_tr_b16 v[162:163], v13 offset:10496
  v_mfma_f32_16x16x32_bf16 v[64:67], v[112:115], a[200:203], v[64:67]
  ds_read_b64_tr_b16 v[164:165], v12 offset:12544
  ds_read_b64_tr_b16 v[166:167], v13 offset:12544
  v_mfma_f32_16x16x32_bf16 v[44:47], v[112:115], a[192:195], v[44:47]
  ds_read_b64_tr_b16 v[168:169], v12 offset:14592
  ds_read_b64_tr_b16 v[170:171], v13 offset:14592
  v_mfma_f32_16x16x32_bf16 v[16:19], v[116:119], a[196:199], v[16:19]
  s_add_u32 m0, s6, 81920
  s_nop 0
  buffer_load_dwordx4 v9, s[12:15], s29 offen offset:0 sc1 lds
  v_mfma_f32_16x16x32_bf16 v[48:51], v[116:119], a[204:207], v[48:51]
  v_mfma_f32_16x16x32_bf16 v[52:55], v[120:123], a[204:207], v[52:55]
  buffer_load_dwordx4 v9, s[12:15], s29 offen offset:1024 sc1 lds
  v_mfma_f32_16x16x32_bf16 v[20:23], v[120:123], a[196:199], v[20:23]
  v_mfma_f32_16x16x32_bf16 v[40:43], v[132:135], a[196:199], v[40:43]
  buffer_load_dwordx4 v9, s[12:15], s29 offen offset:2048 sc1 lds
  v_mfma_f32_16x16x32_bf16 v[56:59], v[132:135], a[204:207], v[56:59]
  v_mfma_f32_16x16x32_bf16 v[64:67], v[136:139], a[204:207], v[64:67]
  buffer_load_dwordx4 v9, s[12:15], s29 offen offset:3072 sc1 lds
  s_add_u32 s29, s29, 65536
  s_and_b32 s29, s29, 0x3ffff
  v_xor_b32 v9, 4096, v9
  v_mfma_f32_16x16x32_bf16 v[44:47], v[136:139], a[196:199], v[44:47]
  s_waitcnt lgkmcnt(0)
  s_barrier
  v_mfma_f32_16x16x32_bf16 v[16:19], v[140:143], a[208:211], v[16:19]
  ds_read_b64_tr_b16 v[100:101], v12 offset:16384
  ds_read_b64_tr_b16 v[102:103], v13 offset:16384
  v_mfma_f32_16x16x32_bf16 v[48:51], v[140:143], a[216:219], v[48:51]
  ds_read_b64_tr_b16 v[104:105], v12 offset:18432
  ds_read_b64_tr_b16 v[106:107], v13 offset:18432
  v_mfma_f32_16x16x32_bf16 v[52:55], v[144:147], a[216:219], v[52:55]
  ds_read_b64_tr_b16 v[108:109], v12 offset:20480
  ds_read_b64_tr_b16 v[110:111], v13 offset:20480
  v_mfma_f32_16x16x32_bf16 v[20:23], v[144:147], a[208:211], v[20:23]
  ds_read_b64_tr_b16 v[112:113], v12 offset:22528
  ds_read_b64_tr_b16 v[114:115], v13 offset:22528
  v_mfma_f32_16x16x32_bf16 v[40:43], v[148:151], a[208:211], v[40:43]
  ds_read_b64_tr_b16 v[116:117], v12 offset:16640
  ds_read_b64_tr_b16 v[118:119], v13 offset:16640
  v_mfma_f32_16x16x32_bf16 v[56:59], v[148:151], a[216:219], v[56:59]
  ds_read_b64_tr_b16 v[120:121], v12 offset:18688
  ds_read_b64_tr_b16 v[122:123], v13 offset:18688
  v_mfma_f32_16x16x32_bf16 v[64:67], v[152:155], a[216:219], v[64:67]
  ds_read_b64_tr_b16 v[132:133], v12 offset:20736
  ds_read_b64_tr_b16 v[134:135], v13 offset:20736
  v_mfma_f32_16x16x32_bf16 v[44:47], v[152:155], a[208:211], v[44:47]
  ds_read_b64_tr_b16 v[136:137], v12 offset:22784
  ds_read_b64_tr_b16 v[138:139], v13 offset:22784
  v_mfma_f32_16x16x32_bf16 v[16:19], v[156:159], a[212:215], v[16:19]
  s_lshl_b32 s28, s3, 10
  s_add_u32 s28, s28, 131072
  v_lshl_add_u32 v11, v1, 4, s28
  s_waitcnt vmcnt(7)
  v_lshlrev_b32 v196, 16, v124
  v_and_b32 v198, 0xffff0000, v124
  v_lshlrev_b32 v197, 16, v125
  v_and_b32 v199, 0xffff0000, v125
  s_waitcnt vmcnt(6)
  v_lshlrev_b32 v200, 16, v128
  v_and_b32 v202, 0xffff0000, v128
  v_lshlrev_b32 v201, 16, v129
  v_and_b32 v203, 0xffff0000, v129
  s_waitcnt vmcnt(5)
  v_lshlrev_b32 v204, 16, v188
  v_and_b32 v206, 0xffff0000, v188
  v_lshlrev_b32 v205, 16, v189
  v_and_b32 v207, 0xffff0000, v189
  s_waitcnt vmcnt(4)
  v_lshlrev_b32 v208, 16, v192
  v_and_b32 v210, 0xffff0000, v192
  v_lshlrev_b32 v209, 16, v193
  v_and_b32 v211, 0xffff0000, v193
  v_pk_add_f32 v[212:213], v[196:197], v[204:205]
  v_pk_add_f32 v[216:217], v[196:197], v[204:205] neg_lo:[0,1] neg_hi:[0,1]
  v_pk_add_f32 v[220:221], v[200:201], v[208:209]
  v_pk_add_f32 v[214:215], v[198:199], v[206:207]
  v_pk_add_f32 v[218:219], v[198:199], v[206:207] neg_lo:[0,1] neg_hi:[0,1]
  v_pk_add_f32 v[222:223], v[202:203], v[210:211]
  v_pk_add_f32 v[224:225], v[210:211], v[202:203] neg_lo:[0,1] neg_hi:[0,1]
  v_pk_add_f32 v[226:227], v[200:201], v[208:209] neg_lo:[0,1] neg_hi:[0,1]
  s_cmp_lg_u32 s33, 0
  s_cbranch_scc1 gated_mix__spectral_gfnet__ssm_conv_s5__prompt_kernel_skip49
  s_mov_b64 exec, 15
  v_pk_add_f32 v[220:221], v[200:201], v[200:201]
  v_pk_add_f32 v[222:223], v[208:209], v[208:209]
  v_pk_add_f32 v[224:225], v[202:203], v[202:203] neg_lo:[1,1] neg_hi:[1,1]
  v_pk_add_f32 v[226:227], v[210:211], v[210:211] neg_lo:[1,1] neg_hi:[1,1]
  s_mov_b64 exec, -1
gated_mix__spectral_gfnet__ssm_conv_s5__prompt_kernel_skip49:
  v_pk_add_f32 v[196:197], v[212:213], v[220:221]
  v_cvt_pk_bf16_f32 v228, v196, v197
  v_pk_add_f32 v[198:199], v[214:215], v[222:223]
  v_cvt_pk_bf16_f32 v229, v198, v199
  v_pk_add_f32 v[200:201], v[216:217], v[224:225]
  v_cvt_pk_bf16_f32 v230, v200, v201
  v_pk_add_f32 v[202:203], v[218:219], v[226:227]
  v_cvt_pk_bf16_f32 v231, v202, v203
  v_pk_add_f32 v[204:205], v[212:213], v[220:221] neg_lo:[0,1] neg_hi:[0,1]
  v_cvt_pk_bf16_f32 v232, v204, v205
  v_pk_add_f32 v[206:207], v[214:215], v[222:223] neg_lo:[0,1] neg_hi:[0,1]
  v_cvt_pk_bf16_f32 v233, v206, v207
  v_pk_add_f32 v[208:209], v[216:217], v[224:225] neg_lo:[0,1] neg_hi:[0,1]
  v_cvt_pk_bf16_f32 v234, v208, v209
  v_pk_add_f32 v[210:211], v[218:219], v[226:227] neg_lo:[0,1] neg_hi:[0,1]
  v_cvt_pk_bf16_f32 v235, v210, v211
  v_lshlrev_b32 v196, 16, v126
  v_and_b32 v198, 0xffff0000, v126
  v_lshlrev_b32 v197, 16, v127
  v_and_b32 v199, 0xffff0000, v127
  v_lshlrev_b32 v200, 16, v130
  v_and_b32 v202, 0xffff0000, v130
  v_lshlrev_b32 v201, 16, v131
  v_and_b32 v203, 0xffff0000, v131
  v_lshlrev_b32 v204, 16, v190
  v_and_b32 v206, 0xffff0000, v190
  v_lshlrev_b32 v205, 16, v191
  v_and_b32 v207, 0xffff0000, v191
  v_lshlrev_b32 v208, 16, v194
  v_and_b32 v210, 0xffff0000, v194
  v_lshlrev_b32 v209, 16, v195
  v_and_b32 v211, 0xffff0000, v195
  v_pk_add_f32 v[212:213], v[196:197], v[204:205]
  v_pk_add_f32 v[216:217], v[196:197], v[204:205] neg_lo:[0,1] neg_hi:[0,1]
  v_pk_add_f32 v[220:221], v[200:201], v[208:209]
  v_pk_add_f32 v[214:215], v[198:199], v[206:207]
  v_pk_add_f32 v[218:219], v[198:199], v[206:207] neg_lo:[0,1] neg_hi:[0,1]
  v_pk_add_f32 v[222:223], v[202:203], v[210:211]
  v_pk_add_f32 v[224:225], v[210:211], v[202:203] neg_lo:[0,1] neg_hi:[0,1]
  v_pk_add_f32 v[226:227], v[200:201], v[208:209] neg_lo:[0,1] neg_hi:[0,1]
  s_cmp_lg_u32 s33, 0
  s_cbranch_scc1 gated_mix__spectral_gfnet__ssm_conv_s5__prompt_kernel_skip50
  s_mov_b64 exec, 15
  v_pk_add_f32 v[220:221], v[200:201], v[200:201]
  v_pk_add_f32 v[222:223], v[208:209], v[208:209]
  v_pk_add_f32 v[224:225], v[202:203], v[202:203] neg_lo:[1,1] neg_hi:[1,1]
  v_pk_add_f32 v[226:227], v[210:211], v[210:211] neg_lo:[1,1] neg_hi:[1,1]
  s_mov_b64 exec, -1
gated_mix__spectral_gfnet__ssm_conv_s5__prompt_kernel_skip50:
  v_pk_add_f32 v[196:197], v[212:213], v[220:221]
  v_cvt_pk_bf16_f32 v125, v196, v197
  v_pk_add_f32 v[198:199], v[214:215], v[222:223]
  v_cvt_pk_bf16_f32 v127, v198, v199
  v_pk_add_f32 v[200:201], v[216:217], v[224:225]
  v_cvt_pk_bf16_f32 v129, v200, v201
  v_pk_add_f32 v[202:203], v[218:219], v[226:227]
  v_cvt_pk_bf16_f32 v131, v202, v203
  v_pk_add_f32 v[204:205], v[212:213], v[220:221] neg_lo:[0,1] neg_hi:[0,1]
  v_cvt_pk_bf16_f32 v189, v204, v205
  v_pk_add_f32 v[206:207], v[214:215], v[222:223] neg_lo:[0,1] neg_hi:[0,1]
  v_cvt_pk_bf16_f32 v191, v206, v207
  v_pk_add_f32 v[208:209], v[216:217], v[224:225] neg_lo:[0,1] neg_hi:[0,1]
  v_cvt_pk_bf16_f32 v193, v208, v209
  v_pk_add_f32 v[210:211], v[218:219], v[226:227] neg_lo:[0,1] neg_hi:[0,1]
  v_cvt_pk_bf16_f32 v195, v210, v211
  v_mov_b32 v124, v228
  v_mov_b32 v126, v229
  ds_write_b128 v11, v[124:127] offset:0
  v_mov_b32 v128, v230
  v_mov_b32 v130, v231
  ds_write_b128 v11, v[128:131] offset:4096
  v_mov_b32 v188, v232
  v_mov_b32 v190, v233
  ds_write_b128 v11, v[188:191] offset:8192
  v_mov_b32 v192, v234
  v_mov_b32 v194, v235
  ds_write_b128 v11, v[192:195] offset:12288
  v_mfma_f32_16x16x32_bf16 v[48:51], v[156:159], a[220:223], v[48:51]
  v_mfma_f32_16x16x32_bf16 v[52:55], v[160:163], a[220:223], v[52:55]
  v_mfma_f32_16x16x32_bf16 v[20:23], v[160:163], a[212:215], v[20:23]
  v_mfma_f32_16x16x32_bf16 v[40:43], v[164:167], a[212:215], v[40:43]
  v_mfma_f32_16x16x32_bf16 v[56:59], v[164:167], a[220:223], v[56:59]
  v_mfma_f32_16x16x32_bf16 v[64:67], v[168:171], a[220:223], v[64:67]
  v_mfma_f32_16x16x32_bf16 v[44:47], v[168:171], a[212:215], v[44:47]
  s_waitcnt lgkmcnt(4)
  v_mfma_f32_16x16x32_bf16 v[16:19], v[100:103], a[224:227], v[16:19]
  ds_read_b64_tr_b16 v[140:141], v12 offset:24576
  ds_read_b64_tr_b16 v[142:143], v13 offset:24576
  v_mfma_f32_16x16x32_bf16 v[48:51], v[100:103], a[232:235], v[48:51]
  ds_read_b64_tr_b16 v[144:145], v12 offset:26624
  ds_read_b64_tr_b16 v[146:147], v13 offset:26624
  v_mfma_f32_16x16x32_bf16 v[52:55], v[104:107], a[232:235], v[52:55]
  ds_read_b64_tr_b16 v[148:149], v12 offset:28672
  ds_read_b64_tr_b16 v[150:151], v13 offset:28672
  v_mfma_f32_16x16x32_bf16 v[20:23], v[104:107], a[224:227], v[20:23]
  ds_read_b64_tr_b16 v[152:153], v12 offset:30720
  ds_read_b64_tr_b16 v[154:155], v13 offset:30720
  v_mfma_f32_16x16x32_bf16 v[40:43], v[108:111], a[224:227], v[40:43]
  ds_read_b64_tr_b16 v[156:157], v12 offset:24832
  ds_read_b64_tr_b16 v[158:159], v13 offset:24832
  v_mfma_f32_16x16x32_bf16 v[56:59], v[108:111], a[232:235], v[56:59]
  ds_read_b64_tr_b16 v[160:161], v12 offset:26880
  ds_read_b64_tr_b16 v[162:163], v13 offset:26880
  v_mfma_f32_16x16x32_bf16 v[64:67], v[112:115], a[232:235], v[64:67]
  ds_read_b64_tr_b16 v[164:165], v12 offset:28928
  ds_read_b64_tr_b16 v[166:167], v13 offset:28928
  v_mfma_f32_16x16x32_bf16 v[44:47], v[112:115], a[224:227], v[44:47]
  ds_read_b64_tr_b16 v[168:169], v12 offset:30976
  ds_read_b64_tr_b16 v[170:171], v13 offset:30976
  v_mfma_f32_16x16x32_bf16 v[16:19], v[116:119], a[228:231], v[16:19]
  s_add_u32 m0, s6, 0
  s_nop 0
  buffer_load_dwordx4 v9, s[12:15], s29 offen offset:0 sc1 lds
  v_mfma_f32_16x16x32_bf16 v[48:51], v[116:119], a[236:239], v[48:51]
  v_mfma_f32_16x16x32_bf16 v[52:55], v[120:123], a[236:239], v[52:55]
  buffer_load_dwordx4 v9, s[12:15], s29 offen offset:1024 sc1 lds
  v_mfma_f32_16x16x32_bf16 v[20:23], v[120:123], a[228:231], v[20:23]
  v_mfma_f32_16x16x32_bf16 v[40:43], v[132:135], a[228:231], v[40:43]
  buffer_load_dwordx4 v9, s[12:15], s29 offen offset:2048 sc1 lds
  v_mfma_f32_16x16x32_bf16 v[56:59], v[132:135], a[236:239], v[56:59]
  v_mfma_f32_16x16x32_bf16 v[64:67], v[136:139], a[236:239], v[64:67]
  buffer_load_dwordx4 v9, s[12:15], s29 offen offset:3072 sc1 lds
  s_add_u32 s29, s29, 65536
  s_and_b32 s29, s29, 0x3ffff
  v_mfma_f32_16x16x32_bf16 v[44:47], v[136:139], a[228:231], v[44:47]
  s_waitcnt lgkmcnt(15)
  s_waitcnt lgkmcnt(0)
  s_barrier
  v_mfma_f32_16x16x32_bf16 v[16:19], v[140:143], a[240:243], v[16:19]
  ds_read_b64_tr_b16 v[100:101], v12 offset:32768
  ds_read_b64_tr_b16 v[102:103], v13 offset:32768
  v_mfma_f32_16x16x32_bf16 v[48:51], v[140:143], a[248:251], v[48:51]
  ds_read_b64_tr_b16 v[104:105], v12 offset:34816
  ds_read_b64_tr_b16 v[106:107], v13 offset:34816
  v_mfma_f32_16x16x32_bf16 v[52:55], v[144:147], a[248:251], v[52:55]
  ds_read_b64_tr_b16 v[108:109], v12 offset:36864
  ds_read_b64_tr_b16 v[110:111], v13 offset:36864
  v_mfma_f32_16x16x32_bf16 v[20:23], v[144:147], a[240:243], v[20:23]
  ds_read_b64_tr_b16 v[112:113], v12 offset:38912
  ds_read_b64_tr_b16 v[114:115], v13 offset:38912
  v_mfma_f32_16x16x32_bf16 v[40:43], v[148:151], a[240:243], v[40:43]
  ds_read_b64_tr_b16 v[116:117], v12 offset:33024
  ds_read_b64_tr_b16 v[118:119], v13 offset:33024
  v_mfma_f32_16x16x32_bf16 v[56:59], v[148:151], a[248:251], v[56:59]
  ds_read_b64_tr_b16 v[120:121], v12 offset:35072
  ds_read_b64_tr_b16 v[122:123], v13 offset:35072
  v_mfma_f32_16x16x32_bf16 v[64:67], v[152:155], a[248:251], v[64:67]
  ds_read_b64_tr_b16 v[132:133], v12 offset:37120
  ds_read_b64_tr_b16 v[134:135], v13 offset:37120
  v_mfma_f32_16x16x32_bf16 v[44:47], v[152:155], a[240:243], v[44:47]
  ds_read_b64_tr_b16 v[136:137], v12 offset:39168
  ds_read_b64_tr_b16 v[138:139], v13 offset:39168
  v_mfma_f32_16x16x32_bf16 v[16:19], v[156:159], a[244:247], v[16:19]
  v_mfma_f32_16x16x32_bf16 v[48:51], v[156:159], a[252:255], v[48:51]
  v_mfma_f32_16x16x32_bf16 v[52:55], v[160:163], a[252:255], v[52:55]
  v_mfma_f32_16x16x32_bf16 v[20:23], v[160:163], a[244:247], v[20:23]
  v_mfma_f32_16x16x32_bf16 v[40:43], v[164:167], a[244:247], v[40:43]
  v_mfma_f32_16x16x32_bf16 v[56:59], v[164:167], a[252:255], v[56:59]
  v_mfma_f32_16x16x32_bf16 v[64:67], v[168:171], a[252:255], v[64:67]
  v_mfma_f32_16x16x32_bf16 v[44:47], v[168:171], a[244:247], v[44:47]
  buffer_load_dwordx4 v[228:231], v10, s[80:83], s8 offen offset:0 sc1
  buffer_load_dwordx4 v[232:235], v10, s[80:83], s8 offen offset:256 sc1
  buffer_load_dwordx4 v[236:239], v10, s[80:83], s8 offen offset:512 sc1
  buffer_load_dwordx4 v[240:243], v10, s[80:83], s8 offen offset:768 sc1
  ds_read_b64_tr_b16 v[124:125], v6 offset:0
  ds_read_b64_tr_b16 v[126:127], v6 offset:256
  ds_read_b64_tr_b16 v[128:129], v6 offset:1024
  ds_read_b64_tr_b16 v[130:131], v6 offset:1280
  ds_read_b64_tr_b16 v[188:189], v6 offset:2048
  ds_read_b64_tr_b16 v[190:191], v6 offset:2304
  ds_read_b64_tr_b16 v[192:193], v6 offset:3072
  ds_read_b64_tr_b16 v[194:195], v6 offset:3328
  s_waitcnt lgkmcnt(8)
  v_mfma_f32_16x16x32_bf16 v[68:71], v[100:103], a[0:3], v[68:71]
  ds_read_b64_tr_b16 v[140:141], v12 offset:40960
  ds_read_b64_tr_b16 v[142:143], v13 offset:40960
  v_mfma_f32_16x16x32_bf16 v[84:87], v[100:103], a[8:11], 0
  ds_read_b64_tr_b16 v[144:145], v12 offset:43008
  ds_read_b64_tr_b16 v[146:147], v13 offset:43008
  v_mfma_f32_16x16x32_bf16 v[88:91], v[104:107], a[8:11], 0
  ds_read_b64_tr_b16 v[148:149], v12 offset:45056
  ds_read_b64_tr_b16 v[150:151], v13 offset:45056
  v_mfma_f32_16x16x32_bf16 v[72:75], v[104:107], a[0:3], v[72:75]
  ds_read_b64_tr_b16 v[152:153], v12 offset:47104
  ds_read_b64_tr_b16 v[154:155], v13 offset:47104
  v_mfma_f32_16x16x32_bf16 v[68:71], v[108:111], a[16:19], v[68:71]
  ds_read_b64_tr_b16 v[156:157], v12 offset:41216
  ds_read_b64_tr_b16 v[158:159], v13 offset:41216
  v_mfma_f32_16x16x32_bf16 v[84:87], v[108:111], a[24:27], v[84:87]
  ds_read_b64_tr_b16 v[160:161], v12 offset:43264
  ds_read_b64_tr_b16 v[162:163], v13 offset:43264
  v_mfma_f32_16x16x32_bf16 v[88:91], v[112:115], a[24:27], v[88:91]
  ds_read_b64_tr_b16 v[164:165], v12 offset:45312
  ds_read_b64_tr_b16 v[166:167], v13 offset:45312
  v_mfma_f32_16x16x32_bf16 v[72:75], v[112:115], a[16:19], v[72:75]
  ds_read_b64_tr_b16 v[168:169], v12 offset:47360
  ds_read_b64_tr_b16 v[170:171], v13 offset:47360
  v_mfma_f32_16x16x32_bf16 v[68:71], v[116:119], a[4:7], v[68:71]
  s_add_u32 m0, s6, 16384
  s_nop 0
  buffer_load_dwordx4 v9, s[12:15], s29 offen offset:0 sc1 lds
  s_waitcnt lgkmcnt(15)
  v_mfma_f32_16x16x32_bf16 v[196:199], v[24:27], v[124:127], 0
  s_waitcnt lgkmcnt(15)
  v_mfma_f32_16x16x32_bf16 v[212:215], v[24:27], v[188:191], 0
  v_mfma_f32_16x16x32_bf16 v[84:87], v[116:119], a[12:15], v[84:87]
  v_mfma_f32_16x16x32_bf16 v[200:203], v[32:35], v[124:127], 0
  v_mfma_f32_16x16x32_bf16 v[216:219], v[32:35], v[188:191], 0
  v_mfma_f32_16x16x32_bf16 v[88:91], v[120:123], a[12:15], v[88:91]
  buffer_load_dwordx4 v9, s[12:15], s29 offen offset:1024 sc1 lds
  v_mfma_f32_16x16x32_bf16 v[204:207], v[172:175], v[124:127], 0
  v_mfma_f32_16x16x32_bf16 v[220:223], v[172:175], v[188:191], 0
  v_mfma_f32_16x16x32_bf16 v[72:75], v[120:123], a[4:7], v[72:75]
  v_mfma_f32_16x16x32_bf16 v[208:211], v[180:183], v[124:127], 0
  v_mfma_f32_16x16x32_bf16 v[224:227], v[180:183], v[188:191], 0
  v_mfma_f32_16x16x32_bf16 v[68:71], v[132:135], a[20:23], v[68:71]
  buffer_load_dwordx4 v9, s[12:15], s29 offen offset:2048 sc1 lds
  v_mfma_f32_16x16x32_bf16 v[196:199], v[28:31], v[128:131], v[196:199]
  s_waitcnt lgkmcnt(15)
  v_mfma_f32_16x16x32_bf16 v[212:215], v[28:31], v[192:195], v[212:215]
  v_mfma_f32_16x16x32_bf16 v[84:87], v[132:135], a[28:31], v[84:87]
  v_mfma_f32_16x16x32_bf16 v[200:203], v[60:63], v[128:131], v[200:203]
  v_mfma_f32_16x16x32_bf16 v[216:219], v[60:63], v[192:195], v[216:219]
  v_mfma_f32_16x16x32_bf16 v[88:91], v[136:139], a[28:31], v[88:91]
  buffer_load_dwordx4 v9, s[12:15], s29 offen offset:3072 sc1 lds
  s_add_u32 s29, s29, 65536
  s_and_b32 s29, s29, 0x3ffff
  v_mfma_f32_16x16x32_bf16 v[204:207], v[176:179], v[128:131], v[204:207]
  v_mfma_f32_16x16x32_bf16 v[220:223], v[176:179], v[192:195], v[220:223]
  v_mfma_f32_16x16x32_bf16 v[72:75], v[136:139], a[20:23], v[72:75]
  v_mfma_f32_16x16x32_bf16 v[208:211], v[184:187], v[128:131], v[208:211]
  v_mfma_f32_16x16x32_bf16 v[224:227], v[184:187], v[192:195], v[224:227]
  s_waitcnt lgkmcnt(0)
  s_barrier
  v_mfma_f32_16x16x32_bf16 v[68:71], v[140:143], a[32:35], v[68:71]
  ds_read_b64_tr_b16 v[100:101], v12 offset:49152
  ds_read_b64_tr_b16 v[102:103], v13 offset:49152
  v_mfma_f32_16x16x32_bf16 v[84:87], v[140:143], a[40:43], v[84:87]
  ds_read_b64_tr_b16 v[104:105], v12 offset:51200
  ds_read_b64_tr_b16 v[106:107], v13 offset:51200
  v_mfma_f32_16x16x32_bf16 v[88:91], v[144:147], a[40:43], v[88:91]
  ds_read_b64_tr_b16 v[108:109], v12 offset:53248
  ds_read_b64_tr_b16 v[110:111], v13 offset:53248
  v_mfma_f32_16x16x32_bf16 v[72:75], v[144:147], a[32:35], v[72:75]
  ds_read_b64_tr_b16 v[112:113], v12 offset:55296
  ds_read_b64_tr_b16 v[114:115], v13 offset:55296
  v_mfma_f32_16x16x32_bf16 v[68:71], v[148:151], a[48:51], v[68:71]
  ds_read_b64_tr_b16 v[116:117], v12 offset:49408
  ds_read_b64_tr_b16 v[118:119], v13 offset:49408
  v_mfma_f32_16x16x32_bf16 v[84:87], v[148:151], a[56:59], v[84:87]
  ds_read_b64_tr_b16 v[120:121], v12 offset:51456
  ds_read_b64_tr_b16 v[122:123], v13 offset:51456
  v_mfma_f32_16x16x32_bf16 v[88:91], v[152:155], a[56:59], v[88:91]
  ds_read_b64_tr_b16 v[132:133], v12 offset:53504
  ds_read_b64_tr_b16 v[134:135], v13 offset:53504
  v_mfma_f32_16x16x32_bf16 v[72:75], v[152:155], a[48:51], v[72:75]
  ds_read_b64_tr_b16 v[136:137], v12 offset:55552
  ds_read_b64_tr_b16 v[138:139], v13 offset:55552
  v_mfma_f32_16x16x32_bf16 v[68:71], v[156:159], a[36:39], v[68:71]
  v_xor_b32 v25, 0x80008000, v25
  v_xor_b32 v27, 0x80008000, v27
  v_xor_b32 v29, 0x80008000, v29
  v_xor_b32 v31, 0x80008000, v31
  v_xor_b32 v33, 0x80008000, v33
  v_xor_b32 v35, 0x80008000, v35
  v_xor_b32 v61, 0x80008000, v61
  v_xor_b32 v63, 0x80008000, v63
  v_xor_b32 v173, 0x80008000, v173
  v_xor_b32 v175, 0x80008000, v175
  v_xor_b32 v177, 0x80008000, v177
  v_xor_b32 v179, 0x80008000, v179
  v_xor_b32 v181, 0x80008000, v181
  v_xor_b32 v183, 0x80008000, v183
  v_xor_b32 v185, 0x80008000, v185
  v_xor_b32 v187, 0x80008000, v187
  v_pk_add_f32 v[196:197], v[196:197], v[16:17] neg_lo:[0,1] neg_hi:[0,1]
  v_pk_add_f32 v[198:199], v[198:199], v[18:19] neg_lo:[0,1] neg_hi:[0,1]
  s_waitcnt vmcnt(7)
  v_pk_fma_f32 v[16:17], v[228:229], v[196:197], v[16:17]
  v_pk_fma_f32 v[18:19], v[230:231], v[198:199], v[18:19]
  v_perm_b32 v16, v17, v16, s58
  v_perm_b32 v17, v19, v18, s58
  v_or_b32 v16, 0x10001, v16
  v_or_b32 v17, 0x10001, v17
  v_mfma_f32_16x16x32_bf16 v[84:87], v[156:159], a[44:47], v[84:87]
  v_pk_add_f32 v[200:201], v[200:201], v[20:21] neg_lo:[0,1] neg_hi:[0,1]
  v_pk_add_f32 v[202:203], v[202:203], v[22:23] neg_lo:[0,1] neg_hi:[0,1]
  s_waitcnt vmcnt(6)
  v_pk_fma_f32 v[20:21], v[232:233], v[200:201], v[20:21]
  v_pk_fma_f32 v[22:23], v[234:235], v[202:203], v[22:23]
  v_perm_b32 v18, v21, v20, s58
  v_perm_b32 v19, v23, v22, s58
  v_or_b32 v18, 0x10001, v18
  v_or_b32 v19, 0x10001, v19
  buffer_store_dwordx4 v[16:19], v8, s[44:47], s9 offen offset:0 sc1
  v_pk_add_f32 v[204:205], v[204:205], v[40:41] neg_lo:[0,1] neg_hi:[0,1]
  v_pk_add_f32 v[206:207], v[206:207], v[42:43] neg_lo:[0,1] neg_hi:[0,1]
  s_waitcnt vmcnt(6)
  v_pk_fma_f32 v[40:41], v[236:237], v[204:205], v[40:41]
  v_pk_fma_f32 v[42:43], v[238:239], v[206:207], v[42:43]
  v_perm_b32 v20, v41, v40, s58
  v_perm_b32 v21, v43, v42, s58
  v_or_b32 v20, 0x10001, v20
  v_or_b32 v21, 0x10001, v21
  v_pk_add_f32 v[208:209], v[208:209], v[44:45] neg_lo:[0,1] neg_hi:[0,1]
  v_pk_add_f32 v[210:211], v[210:211], v[46:47] neg_lo:[0,1] neg_hi:[0,1]
  s_waitcnt vmcnt(5)
  v_pk_fma_f32 v[44:45], v[240:241], v[208:209], v[44:45]
  v_pk_fma_f32 v[46:47], v[242:243], v[210:211], v[46:47]
  v_perm_b32 v22, v45, v44, s58
  v_perm_b32 v23, v47, v46, s58
  v_or_b32 v22, 0x10001, v22
  v_mfma_f32_16x16x32_bf16 v[88:91], v[160:163], a[44:47], v[88:91]
  v_or_b32 v23, 0x10001, v23
  buffer_store_dwordx4 v[20:23], v8, s[44:47], s9 offen offset:1024 sc1
  v_pk_add_f32 v[212:213], v[212:213], v[48:49] neg_lo:[0,1] neg_hi:[0,1]
  v_pk_add_f32 v[214:215], v[214:215], v[50:51] neg_lo:[0,1] neg_hi:[0,1]
  v_pk_fma_f32 v[48:49], v[228:229], v[212:213], v[48:49]
  v_pk_fma_f32 v[50:51], v[230:231], v[214:215], v[50:51]
  v_perm_b32 v40, v49, v48, s58
  v_perm_b32 v41, v51, v50, s58
  v_or_b32 v40, 0x10001, v40
  v_or_b32 v41, 0x10001, v41
  v_pk_add_f32 v[216:217], v[216:217], v[52:53] neg_lo:[0,1] neg_hi:[0,1]
  v_pk_add_f32 v[218:219], v[218:219], v[54:55] neg_lo:[0,1] neg_hi:[0,1]
  v_pk_fma_f32 v[52:53], v[232:233], v[216:217], v[52:53]
  v_pk_fma_f32 v[54:55], v[234:235], v[218:219], v[54:55]
  v_perm_b32 v42, v53, v52, s58
  v_perm_b32 v43, v55, v54, s58
  v_or_b32 v42, 0x10001, v42
  v_or_b32 v43, 0x10001, v43
  buffer_store_dwordx4 v[40:43], v8, s[44:47], s9 offen offset:2048 sc1
  v_pk_add_f32 v[220:221], v[220:221], v[56:57] neg_lo:[0,1] neg_hi:[0,1]
  v_pk_add_f32 v[222:223], v[222:223], v[58:59] neg_lo:[0,1] neg_hi:[0,1]
  v_pk_fma_f32 v[56:57], v[236:237], v[220:221], v[56:57]
  v_pk_fma_f32 v[58:59], v[238:239], v[222:223], v[58:59]
  v_perm_b32 v44, v57, v56, s58
  v_mfma_f32_16x16x32_bf16 v[72:75], v[160:163], a[36:39], v[72:75]
  v_perm_b32 v45, v59, v58, s58
  v_or_b32 v44, 0x10001, v44
  v_or_b32 v45, 0x10001, v45
  v_pk_add_f32 v[224:225], v[224:225], v[64:65] neg_lo:[0,1] neg_hi:[0,1]
  v_pk_add_f32 v[226:227], v[226:227], v[66:67] neg_lo:[0,1] neg_hi:[0,1]
  v_pk_fma_f32 v[64:65], v[240:241], v[224:225], v[64:65]
  v_pk_fma_f32 v[66:67], v[242:243], v[226:227], v[66:67]
  v_perm_b32 v46, v65, v64, s58
  v_perm_b32 v47, v67, v66, s58
  v_or_b32 v46, 0x10001, v46
  v_or_b32 v47, 0x10001, v47
  buffer_store_dwordx4 v[44:47], v8, s[44:47], s9 offen offset:3072 sc1
  s_xor_b32 s8, s8, 1024
  s_xor_b32 s9, s9, 131072
  v_mfma_f32_16x16x32_bf16 v[68:71], v[164:167], a[52:55], v[68:71]
  v_mfma_f32_16x16x32_bf16 v[84:87], v[164:167], a[60:63], v[84:87]
  v_mfma_f32_16x16x32_bf16 v[88:91], v[168:171], a[60:63], v[88:91]
  v_mfma_f32_16x16x32_bf16 v[72:75], v[168:171], a[52:55], v[72:75]
  s_waitcnt lgkmcnt(0)
  v_mfma_f32_16x16x32_bf16 v[68:71], v[100:103], a[64:67], v[68:71]
  ds_read_b64_tr_b16 v[140:141], v12 offset:57344
  ds_read_b64_tr_b16 v[142:143], v13 offset:57344
  v_mfma_f32_16x16x32_bf16 v[84:87], v[100:103], a[72:75], v[84:87]
  ds_read_b64_tr_b16 v[144:145], v12 offset:59392
  ds_read_b64_tr_b16 v[146:147], v13 offset:59392
  v_mfma_f32_16x16x32_bf16 v[88:91], v[104:107], a[72:75], v[88:91]
  ds_read_b64_tr_b16 v[148:149], v12 offset:61440
  ds_read_b64_tr_b16 v[150:151], v13 offset:61440
  v_mfma_f32_16x16x32_bf16 v[72:75], v[104:107], a[64:67], v[72:75]
  ds_read_b64_tr_b16 v[152:153], v12 offset:63488
  ds_read_b64_tr_b16 v[154:155], v13 offset:63488
  v_mfma_f32_16x16x32_bf16 v[68:71], v[108:111], a[80:83], v[68:71]
  ds_read_b64_tr_b16 v[156:157], v12 offset:57600
  ds_read_b64_tr_b16 v[158:159], v13 offset:57600
  v_mfma_f32_16x16x32_bf16 v[84:87], v[108:111], a[88:91], v[84:87]
  ds_read_b64_tr_b16 v[160:161], v12 offset:59648
  ds_read_b64_tr_b16 v[162:163], v13 offset:59648
  v_mfma_f32_16x16x32_bf16 v[88:91], v[112:115], a[88:91], v[88:91]
  ds_read_b64_tr_b16 v[164:165], v12 offset:61696
  ds_read_b64_tr_b16 v[166:167], v13 offset:61696
  v_mfma_f32_16x16x32_bf16 v[72:75], v[112:115], a[80:83], v[72:75]
  ds_read_b64_tr_b16 v[168:169], v12 offset:63744
  ds_read_b64_tr_b16 v[170:171], v13 offset:63744
  v_mfma_f32_16x16x32_bf16 v[68:71], v[116:119], a[68:71], v[68:71]
  s_add_u32 m0, s6, 32768
  s_nop 0
  buffer_load_dwordx4 v9, s[12:15], s29 offen offset:0 sc1 lds
  v_mfma_f32_16x16x32_bf16 v[84:87], v[116:119], a[76:79], v[84:87]
  v_mfma_f32_16x16x32_bf16 v[88:91], v[120:123], a[76:79], v[88:91]
  buffer_load_dwordx4 v9, s[12:15], s29 offen offset:1024 sc1 lds
  v_mfma_f32_16x16x32_bf16 v[72:75], v[120:123], a[68:71], v[72:75]
  v_mfma_f32_16x16x32_bf16 v[68:71], v[132:135], a[84:87], v[68:71]
  buffer_load_dwordx4 v9, s[12:15], s29 offen offset:2048 sc1 lds
  v_mfma_f32_16x16x32_bf16 v[84:87], v[132:135], a[92:95], v[84:87]
  v_mfma_f32_16x16x32_bf16 v[88:91], v[136:139], a[92:95], v[88:91]
  buffer_load_dwordx4 v9, s[12:15], s29 offen offset:3072 sc1 lds
  s_add_u32 s29, s29, 65536
  s_and_b32 s29, s29, 0x3ffff
  v_mfma_f32_16x16x32_bf16 v[72:75], v[136:139], a[84:87], v[72:75]
  s_waitcnt lgkmcnt(0)
  s_barrier
  v_mfma_f32_16x16x32_bf16 v[68:71], v[140:143], a[96:99], v[68:71]
  ds_read_b64_tr_b16 v[100:101], v14 offset:0
  ds_read_b64_tr_b16 v[102:103], v15 offset:0
  v_mfma_f32_16x16x32_bf16 v[84:87], v[140:143], a[104:107], v[84:87]
  ds_read_b64_tr_b16 v[104:105], v14 offset:2048
  ds_read_b64_tr_b16 v[106:107], v15 offset:2048
  v_mfma_f32_16x16x32_bf16 v[88:91], v[144:147], a[104:107], v[88:91]
  ds_read_b64_tr_b16 v[108:109], v14 offset:4096
  ds_read_b64_tr_b16 v[110:111], v15 offset:4096
  v_mfma_f32_16x16x32_bf16 v[72:75], v[144:147], a[96:99], v[72:75]
  ds_read_b64_tr_b16 v[112:113], v14 offset:6144
  ds_read_b64_tr_b16 v[114:115], v15 offset:6144
  v_mfma_f32_16x16x32_bf16 v[68:71], v[148:151], a[112:115], v[68:71]
  ds_read_b64_tr_b16 v[116:117], v14 offset:256
  ds_read_b64_tr_b16 v[118:119], v15 offset:256
  v_mfma_f32_16x16x32_bf16 v[84:87], v[148:151], a[120:123], v[84:87]
  ds_read_b64_tr_b16 v[120:121], v14 offset:2304
  ds_read_b64_tr_b16 v[122:123], v15 offset:2304
  v_mfma_f32_16x16x32_bf16 v[88:91], v[152:155], a[120:123], v[88:91]
  ds_read_b64_tr_b16 v[132:133], v14 offset:4352
  ds_read_b64_tr_b16 v[134:135], v15 offset:4352
  v_mfma_f32_16x16x32_bf16 v[72:75], v[152:155], a[112:115], v[72:75]
  ds_read_b64_tr_b16 v[136:137], v14 offset:6400
  ds_read_b64_tr_b16 v[138:139], v15 offset:6400
  v_mfma_f32_16x16x32_bf16 v[68:71], v[156:159], a[100:103], v[68:71]
  v_mfma_f32_16x16x32_bf16 v[84:87], v[156:159], a[108:111], v[84:87]
  v_mfma_f32_16x16x32_bf16 v[88:91], v[160:163], a[108:111], v[88:91]
  v_mfma_f32_16x16x32_bf16 v[72:75], v[160:163], a[100:103], v[72:75]
  v_mfma_f32_16x16x32_bf16 v[68:71], v[164:167], a[116:119], v[68:71]
  v_mfma_f32_16x16x32_bf16 v[84:87], v[164:167], a[124:127], v[84:87]
  v_mfma_f32_16x16x32_bf16 v[88:91], v[168:171], a[124:127], v[88:91]
  v_mfma_f32_16x16x32_bf16 v[72:75], v[168:171], a[116:119], v[72:75]
  s_waitcnt lgkmcnt(0)
  v_mfma_f32_16x16x32_bf16 v[68:71], v[100:103], a[128:131], v[68:71]
  ds_read_b64_tr_b16 v[140:141], v14 offset:8192
  ds_read_b64_tr_b16 v[142:143], v15 offset:8192
  v_mfma_f32_16x16x32_bf16 v[84:87], v[100:103], a[136:139], v[84:87]
  ds_read_b64_tr_b16 v[144:145], v14 offset:10240
  ds_read_b64_tr_b16 v[146:147], v15 offset:10240
  v_mfma_f32_16x16x32_bf16 v[88:91], v[104:107], a[136:139], v[88:91]
  ds_read_b64_tr_b16 v[148:149], v14 offset:12288
  ds_read_b64_tr_b16 v[150:151], v15 offset:12288
  v_mfma_f32_16x16x32_bf16 v[72:75], v[104:107], a[128:131], v[72:75]
  ds_read_b64_tr_b16 v[152:153], v14 offset:14336
  ds_read_b64_tr_b16 v[154:155], v15 offset:14336
  v_mfma_f32_16x16x32_bf16 v[68:71], v[108:111], a[144:147], v[68:71]
  ds_read_b64_tr_b16 v[156:157], v14 offset:8448
  ds_read_b64_tr_b16 v[158:159], v15 offset:8448
  v_mfma_f32_16x16x32_bf16 v[84:87], v[108:111], a[152:155], v[84:87]
  ds_read_b64_tr_b16 v[160:161], v14 offset:10496
  ds_read_b64_tr_b16 v[162:163], v15 offset:10496
  v_mfma_f32_16x16x32_bf16 v[88:91], v[112:115], a[152:155], v[88:91]
  ds_read_b64_tr_b16 v[164:165], v14 offset:12544
  ds_read_b64_tr_b16 v[166:167], v15 offset:12544
  v_mfma_f32_16x16x32_bf16 v[72:75], v[112:115], a[144:147], v[72:75]
  ds_read_b64_tr_b16 v[168:169], v14 offset:14592
  ds_read_b64_tr_b16 v[170:171], v15 offset:14592
  v_mfma_f32_16x16x32_bf16 v[68:71], v[116:119], a[132:135], v[68:71]
  s_add_u32 m0, s6, 49152
  s_nop 0
  buffer_load_dwordx4 v9, s[12:15], s29 offen offset:0 sc1 lds
  v_mfma_f32_16x16x32_bf16 v[196:199], v[24:27], v[124:127], 0
  v_mfma_f32_16x16x32_bf16 v[212:215], v[24:27], v[188:191], 0
  v_mfma_f32_16x16x32_bf16 v[84:87], v[116:119], a[140:143], v[84:87]
  v_mfma_f32_16x16x32_bf16 v[200:203], v[32:35], v[124:127], 0
  v_mfma_f32_16x16x32_bf16 v[216:219], v[32:35], v[188:191], 0
  v_mfma_f32_16x16x32_bf16 v[88:91], v[120:123], a[140:143], v[88:91]
  buffer_load_dwordx4 v9, s[12:15], s29 offen offset:1024 sc1 lds
  v_mfma_f32_16x16x32_bf16 v[204:207], v[172:175], v[124:127], 0
  v_mfma_f32_16x16x32_bf16 v[220:223], v[172:175], v[188:191], 0
  v_mfma_f32_16x16x32_bf16 v[72:75], v[120:123], a[132:135], v[72:75]
  v_mfma_f32_16x16x32_bf16 v[208:211], v[180:183], v[124:127], 0
  v_mfma_f32_16x16x32_bf16 v[224:227], v[180:183], v[188:191], 0
  v_mfma_f32_16x16x32_bf16 v[68:71], v[132:135], a[148:151], v[68:71]
  buffer_load_dwordx4 v9, s[12:15], s29 offen offset:2048 sc1 lds
  v_mfma_f32_16x16x32_bf16 v[196:199], v[28:31], v[128:131], v[196:199]
  v_mfma_f32_16x16x32_bf16 v[212:215], v[28:31], v[192:195], v[212:215]
  v_mfma_f32_16x16x32_bf16 v[84:87], v[132:135], a[156:159], v[84:87]
  v_mfma_f32_16x16x32_bf16 v[200:203], v[60:63], v[128:131], v[200:203]
  v_mfma_f32_16x16x32_bf16 v[216:219], v[60:63], v[192:195], v[216:219]
  v_mfma_f32_16x16x32_bf16 v[88:91], v[136:139], a[156:159], v[88:91]
  buffer_load_dwordx4 v9, s[12:15], s29 offen offset:3072 sc1 lds
  s_add_u32 s29, s29, 65536
  s_and_b32 s29, s29, 0x3ffff
  v_mfma_f32_16x16x32_bf16 v[204:207], v[176:179], v[128:131], v[204:207]
  v_mfma_f32_16x16x32_bf16 v[220:223], v[176:179], v[192:195], v[220:223]
  v_mfma_f32_16x16x32_bf16 v[72:75], v[136:139], a[148:151], v[72:75]
  v_mfma_f32_16x16x32_bf16 v[208:211], v[184:187], v[128:131], v[208:211]
  v_mfma_f32_16x16x32_bf16 v[224:227], v[184:187], v[192:195], v[224:227]
  s_waitcnt lgkmcnt(0)
  s_barrier
  v_mfma_f32_16x16x32_bf16 v[68:71], v[140:143], a[160:163], v[68:71]
  ds_read_b64_tr_b16 v[100:101], v14 offset:16384
  ds_read_b64_tr_b16 v[102:103], v15 offset:16384
  v_mfma_f32_16x16x32_bf16 v[84:87], v[140:143], a[168:171], v[84:87]
  ds_read_b64_tr_b16 v[104:105], v14 offset:18432
  ds_read_b64_tr_b16 v[106:107], v15 offset:18432
  v_mfma_f32_16x16x32_bf16 v[88:91], v[144:147], a[168:171], v[88:91]
  ds_read_b64_tr_b16 v[108:109], v14 offset:20480
  ds_read_b64_tr_b16 v[110:111], v15 offset:20480
  v_mfma_f32_16x16x32_bf16 v[72:75], v[144:147], a[160:163], v[72:75]
  ds_read_b64_tr_b16 v[112:113], v14 offset:22528
  ds_read_b64_tr_b16 v[114:115], v15 offset:22528
  v_mfma_f32_16x16x32_bf16 v[68:71], v[148:151], a[176:179], v[68:71]
  ds_read_b64_tr_b16 v[116:117], v14 offset:16640
  ds_read_b64_tr_b16 v[118:119], v15 offset:16640
  v_mfma_f32_16x16x32_bf16 v[84:87], v[148:151], a[184:187], v[84:87]
  ds_read_b64_tr_b16 v[120:121], v14 offset:18688
  ds_read_b64_tr_b16 v[122:123], v15 offset:18688
  v_mfma_f32_16x16x32_bf16 v[88:91], v[152:155], a[184:187], v[88:91]
  ds_read_b64_tr_b16 v[132:133], v14 offset:20736
  ds_read_b64_tr_b16 v[134:135], v15 offset:20736
  v_mfma_f32_16x16x32_bf16 v[72:75], v[152:155], a[176:179], v[72:75]
  ds_read_b64_tr_b16 v[136:137], v14 offset:22784
  ds_read_b64_tr_b16 v[138:139], v15 offset:22784
  v_mfma_f32_16x16x32_bf16 v[68:71], v[156:159], a[164:167], v[68:71]
  v_mfma_f32_16x16x32_bf16 v[84:87], v[156:159], a[172:175], v[84:87]
  v_mfma_f32_16x16x32_bf16 v[88:91], v[160:163], a[172:175], v[88:91]
  v_mfma_f32_16x16x32_bf16 v[72:75], v[160:163], a[164:167], v[72:75]
  v_mfma_f32_16x16x32_bf16 v[68:71], v[164:167], a[180:183], v[68:71]
  v_mfma_f32_16x16x32_bf16 v[84:87], v[164:167], a[188:191], v[84:87]
  v_mfma_f32_16x16x32_bf16 v[88:91], v[168:171], a[188:191], v[88:91]
  v_mfma_f32_16x16x32_bf16 v[72:75], v[168:171], a[180:183], v[72:75]
  s_waitcnt lgkmcnt(0)
  v_mfma_f32_16x16x32_bf16 v[68:71], v[100:103], a[192:195], v[68:71]
  ds_read_b64_tr_b16 v[140:141], v14 offset:24576
  ds_read_b64_tr_b16 v[142:143], v15 offset:24576
  v_mfma_f32_16x16x32_bf16 v[84:87], v[100:103], a[200:203], v[84:87]
  ds_read_b64_tr_b16 v[144:145], v14 offset:26624
  ds_read_b64_tr_b16 v[146:147], v15 offset:26624
  v_mfma_f32_16x16x32_bf16 v[88:91], v[104:107], a[200:203], v[88:91]
  ds_read_b64_tr_b16 v[148:149], v14 offset:28672
  ds_read_b64_tr_b16 v[150:151], v15 offset:28672
  v_mfma_f32_16x16x32_bf16 v[72:75], v[104:107], a[192:195], v[72:75]
  ds_read_b64_tr_b16 v[152:153], v14 offset:30720
  ds_read_b64_tr_b16 v[154:155], v15 offset:30720
  v_mfma_f32_16x16x32_bf16 v[68:71], v[108:111], a[208:211], v[68:71]
  ds_read_b64_tr_b16 v[156:157], v14 offset:24832
  ds_read_b64_tr_b16 v[158:159], v15 offset:24832
  v_mfma_f32_16x16x32_bf16 v[84:87], v[108:111], a[216:219], v[84:87]
  ds_read_b64_tr_b16 v[160:161], v14 offset:26880
  ds_read_b64_tr_b16 v[162:163], v15 offset:26880
  v_mfma_f32_16x16x32_bf16 v[88:91], v[112:115], a[216:219], v[88:91]
  ds_read_b64_tr_b16 v[164:165], v14 offset:28928
  ds_read_b64_tr_b16 v[166:167], v15 offset:28928
  v_mfma_f32_16x16x32_bf16 v[72:75], v[112:115], a[208:211], v[72:75]
  ds_read_b64_tr_b16 v[168:169], v14 offset:30976
  ds_read_b64_tr_b16 v[170:171], v15 offset:30976
  v_mfma_f32_16x16x32_bf16 v[68:71], v[116:119], a[196:199], v[68:71]
  v_mfma_f32_16x16x32_bf16 v[84:87], v[116:119], a[204:207], v[84:87]
  v_mfma_f32_16x16x32_bf16 v[88:91], v[120:123], a[204:207], v[88:91]
  v_mfma_f32_16x16x32_bf16 v[72:75], v[120:123], a[196:199], v[72:75]
  v_mfma_f32_16x16x32_bf16 v[68:71], v[132:135], a[212:215], v[68:71]
  v_mfma_f32_16x16x32_bf16 v[84:87], v[132:135], a[220:223], v[84:87]
  v_mfma_f32_16x16x32_bf16 v[88:91], v[136:139], a[220:223], v[88:91]
  v_mfma_f32_16x16x32_bf16 v[72:75], v[136:139], a[212:215], v[72:75]
  buffer_load_dwordx4 v[228:231], v10, s[80:83], s8 offen offset:0 sc1
  buffer_load_dwordx4 v[232:235], v10, s[80:83], s8 offen offset:256 sc1
  buffer_load_dwordx4 v[236:239], v10, s[80:83], s8 offen offset:512 sc1
  buffer_load_dwordx4 v[240:243], v10, s[80:83], s8 offen offset:768 sc1
  s_waitcnt lgkmcnt(0)
  s_barrier
  v_mfma_f32_16x16x32_bf16 v[68:71], v[140:143], a[224:227], v[68:71]
  ds_read_b64_tr_b16 v[100:101], v12 offset:0
  ds_read_b64_tr_b16 v[102:103], v13 offset:0
  v_mfma_f32_16x16x32_bf16 v[84:87], v[140:143], a[232:235], v[84:87]
  ds_read_b64_tr_b16 v[104:105], v12 offset:2048
  ds_read_b64_tr_b16 v[106:107], v13 offset:2048
  v_mfma_f32_16x16x32_bf16 v[88:91], v[144:147], a[232:235], v[88:91]
  ds_read_b64_tr_b16 v[108:109], v12 offset:4096
  ds_read_b64_tr_b16 v[110:111], v13 offset:4096
  v_mfma_f32_16x16x32_bf16 v[72:75], v[144:147], a[224:227], v[72:75]
  ds_read_b64_tr_b16 v[112:113], v12 offset:6144
  ds_read_b64_tr_b16 v[114:115], v13 offset:6144
  v_mfma_f32_16x16x32_bf16 v[68:71], v[148:151], a[240:243], v[68:71]
  ds_read_b64_tr_b16 v[116:117], v12 offset:256
  ds_read_b64_tr_b16 v[118:119], v13 offset:256
  v_mfma_f32_16x16x32_bf16 v[84:87], v[148:151], a[248:251], v[84:87]
  ds_read_b64_tr_b16 v[120:121], v12 offset:2304
  ds_read_b64_tr_b16 v[122:123], v13 offset:2304
  v_mfma_f32_16x16x32_bf16 v[88:91], v[152:155], a[248:251], v[88:91]
  ds_read_b64_tr_b16 v[132:133], v12 offset:4352
  ds_read_b64_tr_b16 v[134:135], v13 offset:4352
  v_mfma_f32_16x16x32_bf16 v[72:75], v[152:155], a[240:243], v[72:75]
  ds_read_b64_tr_b16 v[136:137], v12 offset:6400
  ds_read_b64_tr_b16 v[138:139], v13 offset:6400
  v_mfma_f32_16x16x32_bf16 v[68:71], v[156:159], a[228:231], v[68:71]
  v_mfma_f32_16x16x32_bf16 v[84:87], v[156:159], a[236:239], v[84:87]
  buffer_load_dwordx4 v[40:43], v8, s[44:47], s9 offen offset:0 sc1
  v_mfma_f32_16x16x32_bf16 v[88:91], v[160:163], a[236:239], v[88:91]
  v_mfma_f32_16x16x32_bf16 v[72:75], v[160:163], a[228:231], v[72:75]
  buffer_load_dwordx4 v[44:47], v8, s[44:47], s9 offen offset:1024 sc1
  v_mfma_f32_16x16x32_bf16 v[68:71], v[164:167], a[244:247], v[68:71]
  v_mfma_f32_16x16x32_bf16 v[84:87], v[164:167], a[252:255], v[84:87]
  buffer_load_dwordx4 v[16:19], v8, s[44:47], s9 offen offset:2048 sc1
  v_mfma_f32_16x16x32_bf16 v[88:91], v[168:171], a[252:255], v[88:91]
  v_mfma_f32_16x16x32_bf16 v[72:75], v[168:171], a[244:247], v[72:75]
  buffer_load_dwordx4 v[20:23], v8, s[44:47], s9 offen offset:3072 sc1
  s_waitcnt lgkmcnt(0)
  v_mfma_f32_16x16x32_bf16 v[76:79], v[100:103], a[0:3], v[76:79]
  ds_read_b64_tr_b16 v[140:141], v12 offset:8192
  ds_read_b64_tr_b16 v[142:143], v13 offset:8192
  v_mfma_f32_16x16x32_bf16 v[92:95], v[100:103], a[8:11], 0
  ds_read_b64_tr_b16 v[144:145], v12 offset:10240
  ds_read_b64_tr_b16 v[146:147], v13 offset:10240
  v_mfma_f32_16x16x32_bf16 v[96:99], v[104:107], a[8:11], 0
  ds_read_b64_tr_b16 v[148:149], v12 offset:12288
  ds_read_b64_tr_b16 v[150:151], v13 offset:12288
  v_mfma_f32_16x16x32_bf16 v[80:83], v[104:107], a[0:3], v[80:83]
  ds_read_b64_tr_b16 v[152:153], v12 offset:14336
  ds_read_b64_tr_b16 v[154:155], v13 offset:14336
  v_mfma_f32_16x16x32_bf16 v[76:79], v[108:111], a[16:19], v[76:79]
  ds_read_b64_tr_b16 v[156:157], v12 offset:8448
  ds_read_b64_tr_b16 v[158:159], v13 offset:8448
  v_mfma_f32_16x16x32_bf16 v[92:95], v[108:111], a[24:27], v[92:95]
  ds_read_b64_tr_b16 v[160:161], v12 offset:10496
  ds_read_b64_tr_b16 v[162:163], v13 offset:10496
  v_mfma_f32_16x16x32_bf16 v[96:99], v[112:115], a[24:27], v[96:99]
  ds_read_b64_tr_b16 v[164:165], v12 offset:12544
  ds_read_b64_tr_b16 v[166:167], v13 offset:12544
  v_mfma_f32_16x16x32_bf16 v[80:83], v[112:115], a[16:19], v[80:83]
  ds_read_b64_tr_b16 v[168:169], v12 offset:14592
  ds_read_b64_tr_b16 v[170:171], v13 offset:14592
  v_mfma_f32_16x16x32_bf16 v[76:79], v[116:119], a[4:7], v[76:79]
  v_mfma_f32_16x16x32_bf16 v[92:95], v[116:119], a[12:15], v[92:95]
  v_mfma_f32_16x16x32_bf16 v[96:99], v[120:123], a[12:15], v[96:99]
  v_mfma_f32_16x16x32_bf16 v[80:83], v[120:123], a[4:7], v[80:83]
  v_mfma_f32_16x16x32_bf16 v[76:79], v[132:135], a[20:23], v[76:79]
  v_mfma_f32_16x16x32_bf16 v[92:95], v[132:135], a[28:31], v[92:95]
  v_mfma_f32_16x16x32_bf16 v[96:99], v[136:139], a[28:31], v[96:99]
  v_mfma_f32_16x16x32_bf16 v[80:83], v[136:139], a[20:23], v[80:83]
  s_waitcnt vmcnt(20) lgkmcnt(0)
  s_barrier
  v_mfma_f32_16x16x32_bf16 v[76:79], v[140:143], a[32:35], v[76:79]
  ds_read_b64_tr_b16 v[100:101], v12 offset:16384
  ds_read_b64_tr_b16 v[102:103], v13 offset:16384
  v_mfma_f32_16x16x32_bf16 v[92:95], v[140:143], a[40:43], v[92:95]
  ds_read_b64_tr_b16 v[104:105], v12 offset:18432
  ds_read_b64_tr_b16 v[106:107], v13 offset:18432
  v_mfma_f32_16x16x32_bf16 v[96:99], v[144:147], a[40:43], v[96:99]
  ds_read_b64_tr_b16 v[108:109], v12 offset:20480
  ds_read_b64_tr_b16 v[110:111], v13 offset:20480
  v_mfma_f32_16x16x32_bf16 v[80:83], v[144:147], a[32:35], v[80:83]
  ds_read_b64_tr_b16 v[112:113], v12 offset:22528
  ds_read_b64_tr_b16 v[114:115], v13 offset:22528
  v_mfma_f32_16x16x32_bf16 v[76:79], v[148:151], a[48:51], v[76:79]
  ds_read_b64_tr_b16 v[116:117], v12 offset:16640
  ds_read_b64_tr_b16 v[118:119], v13 offset:16640
  v_mfma_f32_16x16x32_bf16 v[92:95], v[148:151], a[56:59], v[92:95]
  ds_read_b64_tr_b16 v[120:121], v12 offset:18688
  ds_read_b64_tr_b16 v[122:123], v13 offset:18688
  v_mfma_f32_16x16x32_bf16 v[96:99], v[152:155], a[56:59], v[96:99]
  ds_read_b64_tr_b16 v[132:133], v12 offset:20736
  ds_read_b64_tr_b16 v[134:135], v13 offset:20736
  v_mfma_f32_16x16x32_bf16 v[80:83], v[152:155], a[48:51], v[80:83]
  ds_read_b64_tr_b16 v[136:137], v12 offset:22784
  ds_read_b64_tr_b16 v[138:139], v13 offset:22784
  v_mfma_f32_16x16x32_bf16 v[76:79], v[156:159], a[36:39], v[76:79]
  s_waitcnt vmcnt(0)
  v_and_b32 v48, 1, v16
  v_bitop3_b32 v48, v48, v17, v18 bitop3:0x80
  v_bitop3_b32 v48, v48, v19, v20 bitop3:0x80
  v_bitop3_b32 v48, v48, v21, v22 bitop3:0x80
  v_bitop3_b32 v48, v48, v23, v40 bitop3:0x80
  v_bitop3_b32 v48, v48, v41, v42 bitop3:0x80
  v_bitop3_b32 v48, v48, v43, v44 bitop3:0x80
  v_bitop3_b32 v48, v48, v45, v46 bitop3:0x80
  v_and_b32 v48, v48, v47
  v_cmp_eq_u32 vcc, 0, v48
  s_nop 0
  s_cbranch_vccz gated_mix__spectral_gfnet__ssm_conv_s5__prompt_kernel_skip51
  s_mov_b32 s28, 0
gated_mix__spectral_gfnet__ssm_conv_s5__prompt_kernel_px52:
  s_sleep 2
  buffer_load_dwordx4 v[40:43], v8, s[44:47], s9 offen offset:0 sc1
  buffer_load_dwordx4 v[44:47], v8, s[44:47], s9 offen offset:1024 sc1
  buffer_load_dwordx4 v[16:19], v8, s[44:47], s9 offen offset:2048 sc1
  buffer_load_dwordx4 v[20:23], v8, s[44:47], s9 offen offset:3072 sc1
  s_waitcnt vmcnt(0)
  v_and_b32 v48, 1, v16
  v_bitop3_b32 v48, v48, v17, v18 bitop3:0x80
  v_bitop3_b32 v48, v48, v19, v20 bitop3:0x80
  v_bitop3_b32 v48, v48, v21, v22 bitop3:0x80
  v_bitop3_b32 v48, v48, v23, v40 bitop3:0x80
  v_bitop3_b32 v48, v48, v41, v42 bitop3:0x80
  v_bitop3_b32 v48, v48, v43, v44 bitop3:0x80
  v_bitop3_b32 v48, v48, v45, v46 bitop3:0x80
  v_and_b32 v48, v48, v47
  v_cmp_eq_u32 vcc, 0, v48
  s_nop 0
  s_cbranch_vccz gated_mix__spectral_gfnet__ssm_conv_s5__prompt_kernel_pxout53
  s_add_u32 s28, s28, 1
  s_cmp_lt_u32 s28, 1048576
  s_cbranch_scc1 gated_mix__spectral_gfnet__ssm_conv_s5__prompt_kernel_px52
gated_mix__spectral_gfnet__ssm_conv_s5__prompt_kernel_pxout53:
gated_mix__spectral_gfnet__ssm_conv_s5__prompt_kernel_skip51:
  v_mfma_f32_16x16x32_bf16 v[92:95], v[156:159], a[44:47], v[92:95]
  v_mfma_f32_16x16x32_bf16 v[96:99], v[160:163], a[44:47], v[96:99]
  v_mfma_f32_16x16x32_bf16 v[80:83], v[160:163], a[36:39], v[80:83]
  v_mfma_f32_16x16x32_bf16 v[76:79], v[164:167], a[52:55], v[76:79]
  v_mfma_f32_16x16x32_bf16 v[92:95], v[164:167], a[60:63], v[92:95]
  v_mfma_f32_16x16x32_bf16 v[96:99], v[168:171], a[60:63], v[96:99]
  v_mfma_f32_16x16x32_bf16 v[80:83], v[168:171], a[52:55], v[80:83]
  s_waitcnt lgkmcnt(0)
  v_mfma_f32_16x16x32_bf16 v[76:79], v[100:103], a[64:67], v[76:79]
  ds_read_b64_tr_b16 v[140:141], v12 offset:24576
  ds_read_b64_tr_b16 v[142:143], v13 offset:24576
  v_mfma_f32_16x16x32_bf16 v[92:95], v[100:103], a[72:75], v[92:95]
  ds_read_b64_tr_b16 v[144:145], v12 offset:26624
  ds_read_b64_tr_b16 v[146:147], v13 offset:26624
  v_mfma_f32_16x16x32_bf16 v[96:99], v[104:107], a[72:75], v[96:99]
  ds_read_b64_tr_b16 v[148:149], v12 offset:28672
  ds_read_b64_tr_b16 v[150:151], v13 offset:28672
  v_mfma_f32_16x16x32_bf16 v[80:83], v[104:107], a[64:67], v[80:83]
  ds_read_b64_tr_b16 v[152:153], v12 offset:30720
  ds_read_b64_tr_b16 v[154:155], v13 offset:30720
  v_mfma_f32_16x16x32_bf16 v[76:79], v[108:111], a[80:83], v[76:79]
  ds_read_b64_tr_b16 v[156:157], v12 offset:24832
  ds_read_b64_tr_b16 v[158:159], v13 offset:24832
  v_mfma_f32_16x16x32_bf16 v[92:95], v[108:111], a[88:91], v[92:95]
  ds_read_b64_tr_b16 v[160:161], v12 offset:26880
  ds_read_b64_tr_b16 v[162:163], v13 offset:26880
  v_mfma_f32_16x16x32_bf16 v[96:99], v[112:115], a[88:91], v[96:99]
  ds_read_b64_tr_b16 v[164:165], v12 offset:28928
  ds_read_b64_tr_b16 v[166:167], v13 offset:28928
  v_mfma_f32_16x16x32_bf16 v[80:83], v[112:115], a[80:83], v[80:83]
  ds_read_b64_tr_b16 v[168:169], v12 offset:30976
  ds_read_b64_tr_b16 v[170:171], v13 offset:30976
  v_mfma_f32_16x16x32_bf16 v[76:79], v[116:119], a[68:71], v[76:79]
  v_pk_add_f32 v[196:197], v[196:197], v[68:69] neg_lo:[0,1] neg_hi:[0,1]
  v_pk_add_f32 v[198:199], v[198:199], v[70:71] neg_lo:[0,1] neg_hi:[0,1]
  v_pk_fma_f32 v[68:69], v[228:229], v[196:197], v[68:69]
  v_pk_fma_f32 v[70:71], v[230:231], v[198:199], v[70:71]
  v_lshlrev_b32 v48, 16, v16
  v_and_b32 v49, 0xffff0000, v16
  v_pk_add_f32 v[68:69], v[68:69], v[48:49]
  v_lshlrev_b32 v50, 16, v17
  v_and_b32 v51, 0xffff0000, v17
  v_pk_add_f32 v[70:71], v[70:71], v[50:51]
  v_pk_add_f32 v[212:213], v[212:213], v[84:85] neg_lo:[0,1] neg_hi:[0,1]
  v_pk_add_f32 v[214:215], v[214:215], v[86:87] neg_lo:[0,1] neg_hi:[0,1]
  v_pk_fma_f32 v[84:85], v[228:229], v[212:213], v[84:85]
  v_pk_fma_f32 v[86:87], v[230:231], v[214:215], v[86:87]
  v_lshlrev_b32 v52, 16, v40
  v_and_b32 v53, 0xffff0000, v40
  v_pk_add_f32 v[84:85], v[84:85], v[52:53]
  v_lshlrev_b32 v54, 16, v41
  v_and_b32 v55, 0xffff0000, v41
  v_pk_add_f32 v[86:87], v[86:87], v[54:55]
  v_mfma_f32_16x16x32_bf16 v[92:95], v[116:119], a[76:79], v[92:95]
  v_mfma_f32_16x16x32_bf16 v[96:99], v[120:123], a[76:79], v[96:99]
  v_mfma_f32_16x16x32_bf16 v[80:83], v[120:123], a[68:71], v[80:83]
  v_mfma_f32_16x16x32_bf16 v[76:79], v[132:135], a[84:87], v[76:79]
  buffer_store_dword v68, v36, s[24:27], s7 offen sc1
  v_mfma_f32_16x16x32_bf16 v[92:95], v[132:135], a[92:95], v[92:95]
  v_mfma_f32_16x16x32_bf16 v[96:99], v[136:139], a[92:95], v[96:99]
  v_mfma_f32_16x16x32_bf16 v[80:83], v[136:139], a[84:87], v[80:83]
  s_waitcnt lgkmcnt(0)
  s_barrier
  v_mfma_f32_16x16x32_bf16 v[76:79], v[140:143], a[96:99], v[76:79]
  ds_read_b64_tr_b16 v[100:101], v12 offset:32768
  ds_read_b64_tr_b16 v[102:103], v13 offset:32768
  buffer_store_dword v84, v37, s[24:27], s7 offen sc1
  v_mfma_f32_16x16x32_bf16 v[92:95], v[140:143], a[104:107], v[92:95]
  ds_read_b64_tr_b16 v[104:105], v12 offset:34816
  ds_read_b64_tr_b16 v[106:107], v13 offset:34816
  s_add_u32 s7, s7, 65536
  v_mfma_f32_16x16x32_bf16 v[96:99], v[144:147], a[104:107], v[96:99]
  ds_read_b64_tr_b16 v[108:109], v12 offset:36864
  ds_read_b64_tr_b16 v[110:111], v13 offset:36864
  v_mfma_f32_16x16x32_bf16 v[80:83], v[144:147], a[96:99], v[80:83]
  ds_read_b64_tr_b16 v[112:113], v12 offset:38912
  ds_read_b64_tr_b16 v[114:115], v13 offset:38912
  v_mfma_f32_16x16x32_bf16 v[76:79], v[148:151], a[112:115], v[76:79]
  ds_read_b64_tr_b16 v[116:117], v12 offset:33024
  ds_read_b64_tr_b16 v[118:119], v13 offset:33024
  buffer_store_dword v69, v36, s[24:27], s7 offen sc1
  v_mfma_f32_16x16x32_bf16 v[92:95], v[148:151], a[120:123], v[92:95]
  ds_read_b64_tr_b16 v[120:121], v12 offset:35072
  ds_read_b64_tr_b16 v[122:123], v13 offset:35072
  v_mfma_f32_16x16x32_bf16 v[96:99], v[152:155], a[120:123], v[96:99]
  ds_read_b64_tr_b16 v[132:133], v12 offset:37120
  ds_read_b64_tr_b16 v[134:135], v13 offset:37120
  v_mfma_f32_16x16x32_bf16 v[80:83], v[152:155], a[112:115], v[80:83]
  ds_read_b64_tr_b16 v[136:137], v12 offset:39168
  ds_read_b64_tr_b16 v[138:139], v13 offset:39168
  v_mfma_f32_16x16x32_bf16 v[76:79], v[156:159], a[100:103], v[76:79]
  buffer_store_dword v85, v37, s[24:27], s7 offen sc1
  v_mfma_f32_16x16x32_bf16 v[92:95], v[156:159], a[108:111], v[92:95]
  s_add_u32 s7, s7, 65536
  v_mfma_f32_16x16x32_bf16 v[96:99], v[160:163], a[108:111], v[96:99]
  v_mfma_f32_16x16x32_bf16 v[80:83], v[160:163], a[100:103], v[80:83]
  v_mfma_f32_16x16x32_bf16 v[76:79], v[164:167], a[116:119], v[76:79]
  buffer_store_dword v70, v36, s[24:27], s7 offen sc1
  v_mfma_f32_16x16x32_bf16 v[92:95], v[164:167], a[124:127], v[92:95]
  v_mfma_f32_16x16x32_bf16 v[96:99], v[168:171], a[124:127], v[96:99]
  v_mfma_f32_16x16x32_bf16 v[80:83], v[168:171], a[116:119], v[80:83]
  s_waitcnt lgkmcnt(0)
  v_mfma_f32_16x16x32_bf16 v[76:79], v[100:103], a[128:131], v[76:79]
  ds_read_b64_tr_b16 v[140:141], v12 offset:40960
  ds_read_b64_tr_b16 v[142:143], v13 offset:40960
  buffer_store_dword v86, v37, s[24:27], s7 offen sc1
  v_mfma_f32_16x16x32_bf16 v[92:95], v[100:103], a[136:139], v[92:95]
  ds_read_b64_tr_b16 v[144:145], v12 offset:43008
  ds_read_b64_tr_b16 v[146:147], v13 offset:43008
  s_add_u32 s7, s7, 65536
  v_mfma_f32_16x16x32_bf16 v[96:99], v[104:107], a[136:139], v[96:99]
  ds_read_b64_tr_b16 v[148:149], v12 offset:45056
  ds_read_b64_tr_b16 v[150:151], v13 offset:45056
  v_mfma_f32_16x16x32_bf16 v[80:83], v[104:107], a[128:131], v[80:83]
  ds_read_b64_tr_b16 v[152:153], v12 offset:47104
  ds_read_b64_tr_b16 v[154:155], v13 offset:47104
  v_mfma_f32_16x16x32_bf16 v[76:79], v[108:111], a[144:147], v[76:79]
  ds_read_b64_tr_b16 v[156:157], v12 offset:41216
  ds_read_b64_tr_b16 v[158:159], v13 offset:41216
  buffer_store_dword v71, v36, s[24:27], s7 offen sc1
  v_mfma_f32_16x16x32_bf16 v[92:95], v[108:111], a[152:155], v[92:95]
  ds_read_b64_tr_b16 v[160:161], v12 offset:43264
  ds_read_b64_tr_b16 v[162:163], v13 offset:43264
  v_mfma_f32_16x16x32_bf16 v[96:99], v[112:115], a[152:155], v[96:99]
  ds_read_b64_tr_b16 v[164:165], v12 offset:45312
  ds_read_b64_tr_b16 v[166:167], v13 offset:45312
  v_mfma_f32_16x16x32_bf16 v[80:83], v[112:115], a[144:147], v[80:83]
  ds_read_b64_tr_b16 v[168:169], v12 offset:47360
  ds_read_b64_tr_b16 v[170:171], v13 offset:47360
  v_mfma_f32_16x16x32_bf16 v[76:79], v[116:119], a[132:135], v[76:79]
  buffer_store_dword v87, v37, s[24:27], s7 offen sc1
  v_mfma_f32_16x16x32_bf16 v[92:95], v[116:119], a[140:143], v[92:95]
  s_add_u32 s7, s7, 851968
  v_pk_add_f32 v[200:201], v[200:201], v[72:73] neg_lo:[0,1] neg_hi:[0,1]
  v_pk_add_f32 v[202:203], v[202:203], v[74:75] neg_lo:[0,1] neg_hi:[0,1]
  v_pk_fma_f32 v[72:73], v[232:233], v[200:201], v[72:73]
  v_pk_fma_f32 v[74:75], v[234:235], v[202:203], v[74:75]
  v_lshlrev_b32 v56, 16, v18
  v_and_b32 v57, 0xffff0000, v18
  v_pk_add_f32 v[72:73], v[72:73], v[56:57]
  v_lshlrev_b32 v58, 16, v19
  v_and_b32 v59, 0xffff0000, v19
  v_pk_add_f32 v[74:75], v[74:75], v[58:59]
  v_pk_add_f32 v[216:217], v[216:217], v[88:89] neg_lo:[0,1] neg_hi:[0,1]
  v_pk_add_f32 v[218:219], v[218:219], v[90:91] neg_lo:[0,1] neg_hi:[0,1]
  v_pk_fma_f32 v[88:89], v[232:233], v[216:217], v[88:89]
  v_pk_fma_f32 v[90:91], v[234:235], v[218:219], v[90:91]
  v_lshlrev_b32 v64, 16, v42
  v_and_b32 v65, 0xffff0000, v42
  v_pk_add_f32 v[88:89], v[88:89], v[64:65]
  v_lshlrev_b32 v66, 16, v43
  v_and_b32 v67, 0xffff0000, v43
  v_pk_add_f32 v[90:91], v[90:91], v[66:67]
  v_mfma_f32_16x16x32_bf16 v[96:99], v[120:123], a[140:143], v[96:99]
  v_mfma_f32_16x16x32_bf16 v[80:83], v[120:123], a[132:135], v[80:83]
  v_mfma_f32_16x16x32_bf16 v[76:79], v[132:135], a[148:151], v[76:79]
  buffer_store_dword v72, v36, s[24:27], s7 offen sc1
  v_mfma_f32_16x16x32_bf16 v[92:95], v[132:135], a[156:159], v[92:95]
  v_mfma_f32_16x16x32_bf16 v[96:99], v[136:139], a[156:159], v[96:99]
  v_mfma_f32_16x16x32_bf16 v[80:83], v[136:139], a[148:151], v[80:83]
  s_waitcnt lgkmcnt(0)
  s_barrier
  v_mfma_f32_16x16x32_bf16 v[76:79], v[140:143], a[160:163], v[76:79]
  ds_read_b64_tr_b16 v[100:101], v12 offset:49152
  ds_read_b64_tr_b16 v[102:103], v13 offset:49152
  buffer_store_dword v88, v37, s[24:27], s7 offen sc1
  v_mfma_f32_16x16x32_bf16 v[92:95], v[140:143], a[168:171], v[92:95]
  ds_read_b64_tr_b16 v[104:105], v12 offset:51200
  ds_read_b64_tr_b16 v[106:107], v13 offset:51200
  s_add_u32 s7, s7, 65536
  v_mfma_f32_16x16x32_bf16 v[96:99], v[144:147], a[168:171], v[96:99]
  ds_read_b64_tr_b16 v[108:109], v12 offset:53248
  ds_read_b64_tr_b16 v[110:111], v13 offset:53248
  v_mfma_f32_16x16x32_bf16 v[80:83], v[144:147], a[160:163], v[80:83]
  ds_read_b64_tr_b16 v[112:113], v12 offset:55296
  ds_read_b64_tr_b16 v[114:115], v13 offset:55296
  v_mfma_f32_16x16x32_bf16 v[76:79], v[148:151], a[176:179], v[76:79]
  ds_read_b64_tr_b16 v[116:117], v12 offset:49408
  ds_read_b64_tr_b16 v[118:119], v13 offset:49408
  buffer_store_dword v73, v36, s[24:27], s7 offen sc1
  v_mfma_f32_16x16x32_bf16 v[92:95], v[148:151], a[184:187], v[92:95]
  ds_read_b64_tr_b16 v[120:121], v12 offset:51456
  ds_read_b64_tr_b16 v[122:123], v13 offset:51456
  v_mfma_f32_16x16x32_bf16 v[96:99], v[152:155], a[184:187], v[96:99]
  ds_read_b64_tr_b16 v[132:133], v12 offset:53504
  ds_read_b64_tr_b16 v[134:135], v13 offset:53504
  v_mfma_f32_16x16x32_bf16 v[80:83], v[152:155], a[176:179], v[80:83]
  ds_read_b64_tr_b16 v[136:137], v12 offset:55552
  ds_read_b64_tr_b16 v[138:139], v13 offset:55552
  v_mfma_f32_16x16x32_bf16 v[76:79], v[156:159], a[164:167], v[76:79]
  buffer_store_dword v89, v37, s[24:27], s7 offen sc1
  v_mfma_f32_16x16x32_bf16 v[92:95], v[156:159], a[172:175], v[92:95]
  s_add_u32 s7, s7, 65536
  v_mfma_f32_16x16x32_bf16 v[96:99], v[160:163], a[172:175], v[96:99]
  v_mfma_f32_16x16x32_bf16 v[80:83], v[160:163], a[164:167], v[80:83]
  v_mfma_f32_16x16x32_bf16 v[76:79], v[164:167], a[180:183], v[76:79]
  buffer_store_dword v74, v36, s[24:27], s7 offen sc1
  v_mfma_f32_16x16x32_bf16 v[92:95], v[164:167], a[188:191], v[92:95]
  v_mfma_f32_16x16x32_bf16 v[96:99], v[168:171], a[188:191], v[96:99]
  v_mfma_f32_16x16x32_bf16 v[80:83], v[168:171], a[180:183], v[80:83]
  s_waitcnt lgkmcnt(0)
  v_mfma_f32_16x16x32_bf16 v[76:79], v[100:103], a[192:195], v[76:79]
  ds_read_b64_tr_b16 v[140:141], v12 offset:57344
  ds_read_b64_tr_b16 v[142:143], v13 offset:57344
  buffer_store_dword v90, v37, s[24:27], s7 offen sc1
  v_mfma_f32_16x16x32_bf16 v[92:95], v[100:103], a[200:203], v[92:95]
  ds_read_b64_tr_b16 v[144:145], v12 offset:59392
  ds_read_b64_tr_b16 v[146:147], v13 offset:59392
  s_add_u32 s7, s7, 65536
  v_mfma_f32_16x16x32_bf16 v[96:99], v[104:107], a[200:203], v[96:99]
  ds_read_b64_tr_b16 v[148:149], v12 offset:61440
  ds_read_b64_tr_b16 v[150:151], v13 offset:61440
  v_mfma_f32_16x16x32_bf16 v[80:83], v[104:107], a[192:195], v[80:83]
  ds_read_b64_tr_b16 v[152:153], v12 offset:63488
  ds_read_b64_tr_b16 v[154:155], v13 offset:63488
  v_mfma_f32_16x16x32_bf16 v[76:79], v[108:111], a[208:211], v[76:79]
  ds_read_b64_tr_b16 v[156:157], v12 offset:57600
  ds_read_b64_tr_b16 v[158:159], v13 offset:57600
  buffer_store_dword v75, v36, s[24:27], s7 offen sc1
  v_mfma_f32_16x16x32_bf16 v[92:95], v[108:111], a[216:219], v[92:95]
  ds_read_b64_tr_b16 v[160:161], v12 offset:59648
  ds_read_b64_tr_b16 v[162:163], v13 offset:59648
  v_mfma_f32_16x16x32_bf16 v[96:99], v[112:115], a[216:219], v[96:99]
  ds_read_b64_tr_b16 v[164:165], v12 offset:61696
  ds_read_b64_tr_b16 v[166:167], v13 offset:61696
  v_mfma_f32_16x16x32_bf16 v[80:83], v[112:115], a[208:211], v[80:83]
  ds_read_b64_tr_b16 v[168:169], v12 offset:63744
  ds_read_b64_tr_b16 v[170:171], v13 offset:63744
  v_mfma_f32_16x16x32_bf16 v[76:79], v[116:119], a[196:199], v[76:79]
  buffer_store_dword v91, v37, s[24:27], s7 offen sc1
  v_mfma_f32_16x16x32_bf16 v[92:95], v[116:119], a[204:207], v[92:95]
  s_add_u32 s7, s7, 851968
  v_mfma_f32_16x16x32_bf16 v[96:99], v[120:123], a[204:207], v[96:99]
  v_mfma_f32_16x16x32_bf16 v[80:83], v[120:123], a[196:199], v[80:83]
  v_mfma_f32_16x16x32_bf16 v[76:79], v[132:135], a[212:215], v[76:79]
  v_mfma_f32_16x16x32_bf16 v[92:95], v[132:135], a[220:223], v[92:95]
  v_mfma_f32_16x16x32_bf16 v[96:99], v[136:139], a[220:223], v[96:99]
  v_mfma_f32_16x16x32_bf16 v[80:83], v[136:139], a[212:215], v[80:83]
  s_waitcnt lgkmcnt(0)
  v_mfma_f32_16x16x32_bf16 v[76:79], v[140:143], a[224:227], v[76:79]
  v_mfma_f32_16x16x32_bf16 v[92:95], v[140:143], a[232:235], v[92:95]
  v_mfma_f32_16x16x32_bf16 v[96:99], v[144:147], a[232:235], v[96:99]
  v_mfma_f32_16x16x32_bf16 v[80:83], v[144:147], a[224:227], v[80:83]
  v_mfma_f32_16x16x32_bf16 v[76:79], v[148:151], a[240:243], v[76:79]
  v_mfma_f32_16x16x32_bf16 v[92:95], v[148:151], a[248:251], v[92:95]
  v_mfma_f32_16x16x32_bf16 v[96:99], v[152:155], a[248:251], v[96:99]
  v_mfma_f32_16x16x32_bf16 v[80:83], v[152:155], a[240:243], v[80:83]
  v_mfma_f32_16x16x32_bf16 v[76:79], v[156:159], a[228:231], v[76:79]
  v_mfma_f32_16x16x32_bf16 v[92:95], v[156:159], a[236:239], v[92:95]
  v_mfma_f32_16x16x32_bf16 v[96:99], v[160:163], a[236:239], v[96:99]
  v_mfma_f32_16x16x32_bf16 v[80:83], v[160:163], a[228:231], v[80:83]
  v_mfma_f32_16x16x32_bf16 v[76:79], v[164:167], a[244:247], v[76:79]
  v_mfma_f32_16x16x32_bf16 v[92:95], v[164:167], a[252:255], v[92:95]
  v_mfma_f32_16x16x32_bf16 v[96:99], v[168:171], a[252:255], v[96:99]
  v_mfma_f32_16x16x32_bf16 v[80:83], v[168:171], a[244:247], v[80:83]
  s_nop 4
  v_pk_add_f32 v[204:205], v[204:205], v[76:77] neg_lo:[0,1] neg_hi:[0,1]
  v_pk_add_f32 v[206:207], v[206:207], v[78:79] neg_lo:[0,1] neg_hi:[0,1]
  v_pk_fma_f32 v[76:77], v[236:237], v[204:205], v[76:77]
  v_pk_fma_f32 v[78:79], v[238:239], v[206:207], v[78:79]
  v_lshlrev_b32 v48, 16, v20
  v_and_b32 v49, 0xffff0000, v20
  v_pk_add_f32 v[76:77], v[76:77], v[48:49]
  v_lshlrev_b32 v50, 16, v21
  v_and_b32 v51, 0xffff0000, v21
  v_pk_add_f32 v[78:79], v[78:79], v[50:51]
  v_pk_add_f32 v[220:221], v[220:221], v[92:93] neg_lo:[0,1] neg_hi:[0,1]
  v_pk_add_f32 v[222:223], v[222:223], v[94:95] neg_lo:[0,1] neg_hi:[0,1]
  v_pk_fma_f32 v[92:93], v[236:237], v[220:221], v[92:93]
  v_pk_fma_f32 v[94:95], v[238:239], v[222:223], v[94:95]
  v_lshlrev_b32 v52, 16, v44
  v_and_b32 v53, 0xffff0000, v44
  v_pk_add_f32 v[92:93], v[92:93], v[52:53]
  v_lshlrev_b32 v54, 16, v45
  v_and_b32 v55, 0xffff0000, v45
  v_pk_add_f32 v[94:95], v[94:95], v[54:55]
  buffer_store_dword v76, v36, s[24:27], s7 offen sc1
  buffer_store_dword v92, v37, s[24:27], s7 offen sc1
  s_add_u32 s7, s7, 65536
  buffer_store_dword v77, v36, s[24:27], s7 offen sc1
  buffer_store_dword v93, v37, s[24:27], s7 offen sc1
  s_add_u32 s7, s7, 65536
  buffer_store_dword v78, v36, s[24:27], s7 offen sc1
  buffer_store_dword v94, v37, s[24:27], s7 offen sc1
  s_add_u32 s7, s7, 65536
  buffer_store_dword v79, v36, s[24:27], s7 offen sc1
  buffer_store_dword v95, v37, s[24:27], s7 offen sc1
  s_add_u32 s7, s7, 851968
  v_pk_add_f32 v[208:209], v[208:209], v[80:81] neg_lo:[0,1] neg_hi:[0,1]
  v_pk_add_f32 v[210:211], v[210:211], v[82:83] neg_lo:[0,1] neg_hi:[0,1]
  v_pk_fma_f32 v[80:81], v[240:241], v[208:209], v[80:81]
  v_pk_fma_f32 v[82:83], v[242:243], v[210:211], v[82:83]
  v_lshlrev_b32 v56, 16, v22
  v_and_b32 v57, 0xffff0000, v22
  v_pk_add_f32 v[80:81], v[80:81], v[56:57]
  v_lshlrev_b32 v58, 16, v23
  v_and_b32 v59, 0xffff0000, v23
  v_pk_add_f32 v[82:83], v[82:83], v[58:59]
  v_pk_add_f32 v[224:225], v[224:225], v[96:97] neg_lo:[0,1] neg_hi:[0,1]
  v_pk_add_f32 v[226:227], v[226:227], v[98:99] neg_lo:[0,1] neg_hi:[0,1]
  v_pk_fma_f32 v[96:97], v[240:241], v[224:225], v[96:97]
  v_pk_fma_f32 v[98:99], v[242:243], v[226:227], v[98:99]
  v_lshlrev_b32 v64, 16, v46
  v_and_b32 v65, 0xffff0000, v46
  v_pk_add_f32 v[96:97], v[96:97], v[64:65]
  v_lshlrev_b32 v66, 16, v47
  v_and_b32 v67, 0xffff0000, v47
  v_pk_add_f32 v[98:99], v[98:99], v[66:67]
  buffer_store_dword v80, v36, s[24:27], s7 offen sc1
  buffer_store_dword v96, v37, s[24:27], s7 offen sc1
  s_add_u32 s7, s7, 65536
  buffer_store_dword v81, v36, s[24:27], s7 offen sc1
  buffer_store_dword v97, v37, s[24:27], s7 offen sc1
  s_add_u32 s7, s7, 65536
  buffer_store_dword v82, v36, s[24:27], s7 offen sc1
  buffer_store_dword v98, v37, s[24:27], s7 offen sc1
  s_add_u32 s7, s7, 65536
  buffer_store_dword v83, v36, s[24:27], s7 offen sc1
  buffer_store_dword v99, v37, s[24:27], s7 offen sc1
gated_mix__spectral_gfnet__ssm_conv_s5__prompt_kernel_end:
  s_endpgm
.section .rodata,"a"
.p2align 6
.amdhsa_kernel gated_mix__spectral_gfnet__ssm_conv_s5__prompt_kernel
  .amdhsa_next_free_vgpr 504
  .amdhsa_next_free_sgpr 102
  .amdhsa_accum_offset 248
  .amdhsa_group_segment_fixed_size 0
  .amdhsa_kernarg_size 128
  .amdhsa_user_sgpr_count 2
  .amdhsa_user_sgpr_kernarg_segment_ptr 1
  .amdhsa_system_sgpr_workgroup_id_x 1
  .amdhsa_float_denorm_mode_32 3
.end_amdhsa_kernel
```

```asm
; @launch grid=(256,1,1) block=(256,1,1) lds=163840
.amdgcn_target "amdgcn-amd-amdhsa--gfx950"
.text
.p2align 8
.globl gated_mix__spectral_gfnet__ssm_conv_s5__prompt_kernel
.type gated_mix__spectral_gfnet__ssm_conv_s5__prompt_kernel,@function
gated_mix__spectral_gfnet__ssm_conv_s5__prompt_kernel:
  s_cmp_ge_u32 s2, 256
  s_cbranch_scc1 gated_mix__spectral_gfnet__ssm_conv_s5__prompt_kernel_end
  s_load_dwordx16 s[4:19], s[0:1], 0
  s_load_dwordx16 s[20:35], s[0:1], 64
  v_readfirstlane_b32 s3, v0
  v_and_b32 v1, 63, v0
  v_and_b32 v2, 15, v0
  v_bfe_u32 v3, v0, 4, 2
  s_bfe_u32 s36, s2, 0x20003
  s_lshr_b32 s43, s2, 5
  s_lshr_b32 s3, s3, 6
  s_and_b32 s38, s2, 3
  s_lshl2_add_u32 s38, s38, s36
  s_bfe_u32 s39, s2, 0x10002
  s_lshl3_add_u32 s39, s39, s43
  s_and_b32 s42, s2, 1
  s_lshl3_add_u32 s40, s42, s43
  s_lshl1_add_u32 s42, s43, s42
  s_bfe_u32 s41, s2, 0x20001
  s_lshl2_add_u32 s41, s41, s36
  s_and_b32 s37, s2, 7
  s_lshl3_add_u32 s37, s37, s43
  s_cmp_lg_u32 s3, 0
  s_cbranch_scc1 gated_mix__spectral_gfnet__ssm_conv_s5__prompt_kernel_skip2
  s_getpc_b64 s[44:45]
gated_mix__spectral_gfnet__ssm_conv_s5__prompt_kernel_pc1:
  s_lshr_b32 s43, s2, 3
  s_mul_i32 s43, s43, 1280
  v_min_u32 v6, 9, v1
  v_lshl_add_u32 v6, v6, 7, s43
  v_min_u32 v6, gated_mix__spectral_gfnet__ssm_conv_s5__prompt_kernel_end-gated_mix__spectral_gfnet__ssm_conv_s5__prompt_kernel_pc1, v6
  v_mov_b32 v7, 0
  v_lshl_add_u64 v[6:7], v[6:7], 0, s[44:45]
  global_load_dword v4, v[6:7], off
gated_mix__spectral_gfnet__ssm_conv_s5__prompt_kernel_skip2:
  s_mov_b32 s46, 4194304
  s_mov_b32 s47, 0x20000
  s_mov_b32 s50, 2097152
  s_mov_b32 s51, 0x20000
  v_bfe_u32 v6, v1, 1, 2
  v_xor_b32 v6, v6, v3
  v_lshlrev_b32 v5, 9, v6
  v_and_b32 v6, 1, v1
  v_lshl_or_b32 v5, v6, 4, v5
  v_lshrrev_b32 v6, 3, v1
  v_lshl_or_b32 v5, v6, 15, v5
  s_lshl_b32 s43, s3, 9
  s_add_u32 s43, s43, s40
  s_lshl_b32 s43, s43, 6
  s_add_u32 s43, s43, s41
  s_lshl_b32 s43, s43, 5
  s_lshl_b32 m0, s3, 12
  s_add_u32 m0, m0, 131072
  s_waitcnt lgkmcnt(0)
  s_mov_b64 s[44:45], s[4:5]
  buffer_load_dwordx4 v5, s[44:47], s43 offen offset:0 lds
  s_add_u32 s43, s43, 261120
  buffer_load_dwordx4 v5, s[44:47], s43 offen offset:1024 lds
  s_add_u32 s43, s43, 261120
  buffer_load_dwordx4 v5, s[44:47], s43 offen offset:2048 lds
  s_add_u32 s43, s43, 261120
  buffer_load_dwordx4 v5, s[44:47], s43 offen offset:3072 lds
  v_and_b32 v6, 7, v1
  v_xor_b32 v6, v6, v3
  v_lshlrev_b32 v6, 4, v6
  v_lshrrev_b32 v7, 3, v1
  v_lshl_or_b32 v12, v7, 11, v6
  v_and_b32 v7, 32, v1
  v_lshl_or_b32 v8, v7, 11, v6
  v_and_b32 v7, 8, v1
  v_lshl_or_b32 v8, v7, 12, v8
  v_and_b32 v7, 16, v1
  v_lshl_or_b32 v8, v7, 7, v8
  s_lshr_b32 s53, s3, 1
  s_lshl1_add_u32 s54, s39, s53
  s_lshl_b32 s54, s54, 16
  v_add_u32 v12, s54, v12
  s_lshl1_add_u32 s54, s38, s53
  s_and_b32 s53, s3, 1
  s_lshl3_add_u32 s54, s54, s53
  s_lshl_b32 s54, s54, 14
  v_add_u32 v8, s54, v8
  v_xor_b32 v9, 64, v8
  v_xor_b32 v13, 64, v12
  v_add_u32 v9, 3072, v9
  v_add_u32 v13, 15360, v13
  v_add_u32 v10, 6144, v8
  v_add_u32 v14, 30720, v12
  v_add_u32 v11, 6144, v9
  v_add_u32 v15, 30720, v13
  s_lshl_b32 s54, s3, 12
  s_add_u32 s55, s54, 65536
  s_lshl_b32 s52, s38, 7
  s_bitcmp1_b32 s3, 0
  s_cselect_b64 s[48:49], s[18:19], s[16:17]
  s_lshl_b32 s11, s37, 2
  s_add_u32 s11, s11, s36
  s_cmp_eq_u32 s11, 3
  s_cselect_b32 s4, 1, s36
  s_cselect_b32 s5, 64, s37
  s_and_b32 s10, s11, 0xfd
  s_cmp_eq_u32 s10, 0
  s_cselect_b32 s10, 1, 0
  v_cvt_f32_u32 v6, v2
  v_cvt_f32_u32 v7, v3
  v_mul_f32 v7, 4.0, v7
  s_cmp_lg_u32 s3, 0
  s_cbranch_scc1 gated_mix__spectral_gfnet__ssm_conv_s5__prompt_kernel_skip3
  v_cvt_f32_u32 v43, s10
  v_mul_f32 v43, 0xc4700000, v43
  v_cmp_lt_u32 vcc, 7, v2
  v_cvt_f32_u32 v42, s5
  s_nop 0
  v_cndmask_b32 v43, 0, v43, vcc
  v_add_f32 v42, v42, v43
  v_fmamk_f32 v40, v6, 0x43000000, v42
  v_mul_f32 v40, 0x3a000000, v40
  v_mul_f32 v41, v40, v7
  v_fmamk_f32 v32, v40, 0x0, v41
  v_fmamk_f32 v33, v40, 0x3f800000, v41
  v_fmamk_f32 v34, v40, 0x40000000, v41
  v_fmamk_f32 v35, v40, 0x40400000, v41
  v_cos_f32 v36, v32
  v_cos_f32 v37, v33
  v_cos_f32 v38, v34
  v_cos_f32 v39, v35
  v_sin_f32 v32, v32
  v_sin_f32 v33, v33
  v_sin_f32 v34, v34
  v_sin_f32 v35, v35
  v_cvt_pk_bf16_f32 v16, v36, v32
  v_cvt_pk_bf16_f32 v20, -v32, v36
  v_cvt_pk_bf16_f32 v17, v37, v33
  v_cvt_pk_bf16_f32 v21, -v33, v37
  v_cvt_pk_bf16_f32 v18, v38, v34
  v_cvt_pk_bf16_f32 v22, -v34, v38
  v_cvt_pk_bf16_f32 v19, v39, v35
  v_cvt_pk_bf16_f32 v23, -v35, v39
  v_xor_b32 v42, 3, v2
  v_cndmask_b32 v42, v2, v42, vcc
  v_cvt_f32_u32 v40, v42
  v_mul_f32 v40, 0x3d800000, v40
  v_mul_f32 v41, v40, v7
  v_fmamk_f32 v32, v40, 0x0, v41
  v_fmamk_f32 v33, v40, 0x3f800000, v41
  v_fmamk_f32 v34, v40, 0x40000000, v41
  v_fmamk_f32 v35, v40, 0x40400000, v41
  v_cos_f32 v36, v32
  v_cos_f32 v37, v33
  v_cos_f32 v38, v34
  v_cos_f32 v39, v35
  v_sin_f32 v32, v32
  v_sin_f32 v33, v33
  v_sin_f32 v34, v34
  v_sin_f32 v35, v35
  v_cvt_pk_bf16_f32 v24, v36, v32
  v_cvt_pk_bf16_f32 v28, -v32, v36
  v_cvt_pk_bf16_f32 v25, v37, v33
  v_cvt_pk_bf16_f32 v29, -v33, v37
  v_cvt_pk_bf16_f32 v26, v38, v34
  v_cvt_pk_bf16_f32 v30, -v34, v38
  v_cvt_pk_bf16_f32 v27, v39, v35
  v_cvt_pk_bf16_f32 v31, -v35, v39
  s_cmp_eq_u32 s10, 0
  s_cbranch_scc1 gated_mix__spectral_gfnet__ssm_conv_s5__prompt_kernel_skip4
  v_cndmask_b32 v42, 0, 16, vcc
  v_and_b32 v16, 0xffff, v16
  v_lshlrev_b32 v16, v42, v16
  v_and_b32 v17, 0xffff, v17
  v_lshlrev_b32 v17, v42, v17
  v_and_b32 v18, 0xffff, v18
  v_lshlrev_b32 v18, v42, v18
  v_and_b32 v19, 0xffff, v19
  v_lshlrev_b32 v19, v42, v19
  v_and_b32 v20, 0xffff, v20
  v_lshlrev_b32 v20, v42, v20
  v_and_b32 v21, 0xffff, v21
  v_lshlrev_b32 v21, v42, v21
  v_and_b32 v22, 0xffff, v22
  v_lshlrev_b32 v22, v42, v22
  v_and_b32 v23, 0xffff, v23
  v_lshlrev_b32 v23, v42, v23
  v_cmp_eq_u32 vcc, 0, v2
  v_mov_b32 v42, 0x3f80
  s_nop 0
  v_cndmask_b32 v20, v20, v42, vcc
  v_mov_b32 v42, 0xbf80
  v_cndmask_b32 v21, v21, v42, vcc
  v_mov_b32 v42, 0x3f80
  v_cndmask_b32 v22, v22, v42, vcc
  v_mov_b32 v42, 0xbf80
  v_cndmask_b32 v23, v23, v42, vcc
gated_mix__spectral_gfnet__ssm_conv_s5__prompt_kernel_skip4:
gated_mix__spectral_gfnet__ssm_conv_s5__prompt_kernel_skip3:
  s_cmp_lg_u32 s3, 1
  s_cbranch_scc1 gated_mix__spectral_gfnet__ssm_conv_s5__prompt_kernel_skip5
  v_cvt_f32_u32 v43, s10
  v_mul_f32 v43, 0xc4700000, v43
  v_cmp_lt_u32 vcc, 1, v3
  v_cvt_f32_u32 v42, s5
  s_nop 0
  v_cndmask_b32 v43, 0, v43, vcc
  v_add_f32 v42, v42, v43
  v_fmamk_f32 v42, v7, 0x43000000, v42
  v_mul_f32 v41, v42, v6
  v_mul_f32 v41, 0x3a000000, v41
  v_mul_f32 v40, 0x3d800000, v6
  v_fmamk_f32 v32, v40, 0x0, v41
  v_fmamk_f32 v33, v40, 0x3f800000, v41
  v_fmamk_f32 v34, v40, 0x40000000, v41
  v_fmamk_f32 v35, v40, 0x40400000, v41
  v_cos_f32 v36, v32
  v_cos_f32 v37, v33
  v_cos_f32 v38, v34
  v_cos_f32 v39, v35
  v_sin_f32 v32, v32
  v_sin_f32 v33, v33
  v_sin_f32 v34, v34
  v_sin_f32 v35, v35
  v_cvt_pk_bf16_f32 v16, v36, -v32
  v_cvt_pk_bf16_f32 v20, v32, v36
  v_cvt_pk_bf16_f32 v17, v37, -v33
  v_cvt_pk_bf16_f32 v21, v33, v37
  v_cvt_pk_bf16_f32 v18, v38, -v34
  v_cvt_pk_bf16_f32 v22, v34, v38
  v_cvt_pk_bf16_f32 v19, v39, -v35
  v_cvt_pk_bf16_f32 v23, v35, v39
  v_add_f32 v42, 0x40400000, v7
  v_cndmask_b32 v42, v7, v42, vcc
  v_mul_f32 v41, v40, v42
  v_cndmask_b32 v40, v40, -v40, vcc
  v_fmamk_f32 v32, v40, 0x0, v41
  v_fmamk_f32 v33, v40, 0x3f800000, v41
  v_fmamk_f32 v34, v40, 0x40000000, v41
  v_fmamk_f32 v35, v40, 0x40400000, v41
  v_cos_f32 v36, v32
  v_cos_f32 v37, v33
  v_cos_f32 v38, v34
  v_cos_f32 v39, v35
  v_sin_f32 v32, v32
  v_sin_f32 v33, v33
  v_sin_f32 v34, v34
  v_sin_f32 v35, v35
  v_cvt_pk_bf16_f32 v24, v36, -v32
  v_cvt_pk_bf16_f32 v28, v32, v36
  v_cvt_pk_bf16_f32 v25, v37, -v33
  v_cvt_pk_bf16_f32 v29, v33, v37
  v_cvt_pk_bf16_f32 v26, v38, -v34
  v_cvt_pk_bf16_f32 v30, v34, v38
  v_cvt_pk_bf16_f32 v27, v39, -v35
  v_cvt_pk_bf16_f32 v31, v35, v39
  s_cmp_eq_u32 s10, 0
  s_cbranch_scc1 gated_mix__spectral_gfnet__ssm_conv_s5__prompt_kernel_skip6
  v_lshlrev_b32 v42, 16, v16
  v_and_b32 v43, 0xffff0000, v16
  v_add_f32 v42, v42, v42
  v_add_f32 v43, v43, v43
  v_cvt_pk_bf16_f32 v42, v42, v43
  v_cndmask_b32 v16, v42, 0, vcc
  v_cndmask_b32 v20, 0, v42, vcc
  v_lshlrev_b32 v42, 16, v17
  v_and_b32 v43, 0xffff0000, v17
  v_add_f32 v42, v42, v42
  v_add_f32 v43, v43, v43
  v_cvt_pk_bf16_f32 v42, v42, v43
  v_cndmask_b32 v17, v42, 0, vcc
  v_cndmask_b32 v21, 0, v42, vcc
  v_lshlrev_b32 v42, 16, v18
  v_and_b32 v43, 0xffff0000, v18
  v_add_f32 v42, v42, v42
  v_add_f32 v43, v43, v43
  v_cvt_pk_bf16_f32 v42, v42, v43
  v_cndmask_b32 v18, v42, 0, vcc
  v_cndmask_b32 v22, 0, v42, vcc
  v_lshlrev_b32 v42, 16, v19
  v_and_b32 v43, 0xffff0000, v19
  v_add_f32 v42, v42, v42
  v_add_f32 v43, v43, v43
  v_cvt_pk_bf16_f32 v42, v42, v43
  v_cndmask_b32 v19, v42, 0, vcc
  v_cndmask_b32 v23, 0, v42, vcc
  v_lshlrev_b32 v42, 31, v2
  v_or_b32 v42, 0x3f803f80, v42
  v_cmp_eq_u32 vcc, 0, v3
  s_nop 1
  v_cndmask_b32 v16, v16, v42, vcc
gated_mix__spectral_gfnet__ssm_conv_s5__prompt_kernel_skip6:
gated_mix__spectral_gfnet__ssm_conv_s5__prompt_kernel_skip5:
  s_cmp_lg_u32 s3, 2
  s_cbranch_scc1 gated_mix__spectral_gfnet__ssm_conv_s5__prompt_kernel_skip7
  v_cvt_f32_u32 v43, s4
  v_fma_f32 v42, v6, 4.0, v43
  v_mul_f32 v40, 0x3c800000, v42
  v_mul_f32 v41, v40, v7
  v_fmamk_f32 v32, v40, 0x0, v41
  v_fmamk_f32 v33, v40, 0x3f800000, v41
  v_fmamk_f32 v34, v40, 0x40000000, v41
  v_fmamk_f32 v35, v40, 0x40400000, v41
  v_cos_f32 v36, v32
  v_cos_f32 v37, v33
  v_cos_f32 v38, v34
  v_cos_f32 v39, v35
  v_sin_f32 v32, v32
  v_sin_f32 v33, v33
  v_sin_f32 v34, v34
  v_sin_f32 v35, v35
  v_cvt_pk_bf16_f32 v16, v36, v32
  v_cvt_pk_bf16_f32 v20, -v32, v36
  v_cvt_pk_bf16_f32 v17, v37, v33
  v_cvt_pk_bf16_f32 v21, -v33, v37
  v_cvt_pk_bf16_f32 v18, v38, v34
  v_cvt_pk_bf16_f32 v22, -v34, v38
  v_cvt_pk_bf16_f32 v19, v39, v35
  v_cvt_pk_bf16_f32 v23, -v35, v39
  v_mul_f32 v40, 0x3d800000, v40
  v_mul_f32 v41, 0x3d800000, v41
  v_fmamk_f32 v32, v40, 0x0, v41
  v_fmamk_f32 v33, v40, 0x3f800000, v41
  v_fmamk_f32 v34, v40, 0x40000000, v41
  v_fmamk_f32 v35, v40, 0x40400000, v41
  v_cos_f32 v24, v32
  v_cos_f32 v25, v33
  v_cos_f32 v26, v34
  v_cos_f32 v27, v35
  v_sin_f32 v28, v32
  v_sin_f32 v29, v33
  v_sin_f32 v30, v34
  v_sin_f32 v31, v35
gated_mix__spectral_gfnet__ssm_conv_s5__prompt_kernel_skip7:
  s_cmp_lg_u32 s3, 3
  s_cbranch_scc1 gated_mix__spectral_gfnet__ssm_conv_s5__prompt_kernel_skip8
  v_cvt_f32_u32 v43, s4
  v_fma_f32 v42, v7, 4.0, v43
  v_mul_f32 v41, v42, v6
  v_mul_f32 v41, 0x3c800000, v41
  v_mul_f32 v40, 0x3d800000, v6
  v_fmamk_f32 v32, v40, 0x0, v41
  v_fmamk_f32 v33, v40, 0x3f800000, v41
  v_fmamk_f32 v34, v40, 0x40000000, v41
  v_fmamk_f32 v35, v40, 0x40400000, v41
  v_cos_f32 v36, v32
  v_cos_f32 v37, v33
  v_cos_f32 v38, v34
  v_cos_f32 v39, v35
  v_sin_f32 v32, v32
  v_sin_f32 v33, v33
  v_sin_f32 v34, v34
  v_sin_f32 v35, v35
  v_cvt_pk_bf16_f32 v16, v36, -v32
  v_cvt_pk_bf16_f32 v20, v32, v36
  v_cvt_pk_bf16_f32 v17, v37, -v33
  v_cvt_pk_bf16_f32 v21, v33, v37
  v_cvt_pk_bf16_f32 v18, v38, -v34
  v_cvt_pk_bf16_f32 v22, v34, v38
  v_cvt_pk_bf16_f32 v19, v39, -v35
  v_cvt_pk_bf16_f32 v23, v35, v39
  v_mul_f32 v40, 0x3d800000, v40
  v_mul_f32 v41, 0x3d800000, v41
  v_fmamk_f32 v32, v40, 0x0, v41
  v_fmamk_f32 v33, v40, 0x3f800000, v41
  v_fmamk_f32 v34, v40, 0x40000000, v41
  v_fmamk_f32 v35, v40, 0x40400000, v41
  v_cos_f32 v24, v32
  v_cos_f32 v25, v33
  v_cos_f32 v26, v34
  v_cos_f32 v27, v35
  v_sin_f32 v28, v32
  v_sin_f32 v29, v33
  v_sin_f32 v30, v34
  v_sin_f32 v31, v35
  v_mul_f32 v24, 0x35800000, v24
  v_mul_f32 v25, 0x35800000, v25
  v_mul_f32 v26, 0x35800000, v26
  v_mul_f32 v27, 0x35800000, v27
  v_mul_f32 v28, 0x35800000, v28
  v_mul_f32 v29, 0x35800000, v29
  v_mul_f32 v30, 0x35800000, v30
  v_mul_f32 v31, 0x35800000, v31
gated_mix__spectral_gfnet__ssm_conv_s5__prompt_kernel_skip8:
  s_lshl_b32 s16, s3, 12
  s_add_u32 s16, s16, 147456
  v_lshl_add_u32 v42, v1, 4, s16
  ds_write_b128 v42, v[16:19] offset:0
  ds_write_b128 v42, v[20:23] offset:1024
  ds_write_b128 v42, v[24:27] offset:2048
  ds_write_b128 v42, v[28:31] offset:3072
  v_bfe_u32 v6, v1, 1, 3
  v_lshrrev_b32 v7, 5, v1
  v_xor_b32 v6, v6, v7
  v_lshlrev_b32 v6, 4, v6
  v_and_b32 v7, 31, v1
  v_lshl_or_b32 v6, v7, 7, v6
  s_lshr_b32 s53, s3, 1
  v_lshl_add_u32 v16, s53, 13, v6
  s_and_b32 s53, s3, 1
  s_or_b32 s53, s53, 8
  v_lshl_add_u32 v20, s53, 13, v6
  v_xor_b32 v17, 32, v16
  v_xor_b32 v21, 32, v20
  v_xor_b32 v18, 64, v16
  v_xor_b32 v22, 64, v20
  v_xor_b32 v19, 96, v16
  v_xor_b32 v23, 96, v20
  s_add_u32 s16, s34, 20316160
  s_addc_u32 s17, s35, 0
  s_mov_b32 s18, 262144
  s_mov_b32 s19, 0x20000
  v_mov_b32 v6, 0
  v_lshlrev_b32 v7, 4, v0
  s_mov_b32 s56, 4096
  s_cmp_lg_u32 s2, 0
  s_cbranch_scc1 gated_mix__spectral_gfnet__ssm_conv_s5__prompt_kernel_skip9
  v_mov_b32 v24, 0
  v_mov_b32 v25, 0
  v_mov_b32 v26, 0
  v_mov_b32 v27, 0
  buffer_store_dwordx4 v[24:27], v7, s[16:19], 0 offen sc1
  buffer_store_dwordx4 v[24:27], v7, s[16:19], s56 offen sc1
gated_mix__spectral_gfnet__ssm_conv_s5__prompt_kernel_skip9:
  s_mov_b32 s60, s28
  s_mov_b32 s61, s29
  s_mov_b32 s62, 2048
  s_mov_b32 s63, 0x20000
  s_mov_b32 s64, s12
  s_mov_b32 s65, s13
  s_mov_b32 s66, 2048
  s_mov_b32 s67, 0x20000
  s_mov_b32 s68, s14
  s_mov_b32 s69, s15
  s_mov_b32 s70, 2048
  s_mov_b32 s71, 0x20000
  s_mov_b32 s72, s24
  s_mov_b32 s73, s25
  s_mov_b32 s74, 2048
  s_mov_b32 s75, 0x20000
  s_mov_b32 s76, s26
  s_mov_b32 s77, s27
  s_mov_b32 s78, 2048
  s_mov_b32 s79, 0x20000
  s_mov_b32 s12, s34
  s_mov_b32 s13, s35
  s_mov_b32 s14, 4194304
  s_mov_b32 s15, 0x20000
  s_lshl_b32 s28, s3, 4
  v_add_u32 v76, s28, v2
  v_cvt_f32_u32 v72, v76
  v_mul_f32 v72, 0x3c000000, v72
  v_lshrrev_b32 v74, 1, v3
  v_lshlrev_b32 v74, 4, v74
  v_and_b32 v75, 1, v3
  v_lshl_add_u32 v74, v75, 2, v74
  v_cvt_f32_u32 v73, v74
  v_mul_f32 v73, v73, v72
  v_cmp_eq_u32 vcc, 0, v76
  v_fmamk_f32 v56, v72, 0x0, v73
  v_fmamk_f32 v57, v72, 0x3f800000, v73
  v_fmamk_f32 v58, v72, 0x40000000, v73
  v_fmamk_f32 v59, v72, 0x40400000, v73
  v_fmamk_f32 v60, v72, 0x41000000, v73
  v_fmamk_f32 v61, v72, 0x41100000, v73
  v_fmamk_f32 v62, v72, 0x41200000, v73
  v_fmamk_f32 v63, v72, 0x41300000, v73
  v_cos_f32 v64, v56
  v_cos_f32 v65, v57
  v_cos_f32 v66, v58
  s_add_u32 m0, s55, 0
  s_nop 0
  buffer_load_dwordx4 v12, s[48:51], s52 offen offset:0 lds
  v_cos_f32 v67, v59
  v_cos_f32 v68, v60
  v_cos_f32 v69, v61
  buffer_load_dwordx4 v13, s[48:51], s52 offen offset:1024 lds
  v_cos_f32 v70, v62
  v_cos_f32 v71, v63
  v_sin_f32 v56, v56
  buffer_load_dwordx4 v14, s[48:51], s52 offen offset:2048 lds
  v_sin_f32 v57, v57
  v_sin_f32 v58, v58
  v_sin_f32 v59, v59
  buffer_load_dwordx4 v15, s[48:51], s52 offen offset:3072 lds
  v_sin_f32 v60, v60
  v_sin_f32 v61, v61
  v_sin_f32 v62, v62
  s_add_u32 m0, s54, 0
  s_nop 0
  buffer_load_dwordx4 v8, s[44:47], s52 offen offset:0 lds
  v_sin_f32 v63, v63
  v_mov_b32 v73, 0x80008000
  v_bfe_i32 v75, v2, 0, 1
  v_bfe_i32 v74, v2, 1, 1
  buffer_load_dwordx4 v9, s[44:47], s52 offen offset:1024 lds
  v_cmp_ne_u32 s[58:59], 0, v75
  v_and_b32 v75, v73, v75
  v_and_b32 v74, v73, v74
  v_xor_b32 v76, v74, v75
  v_mov_b32 v72, 0xbf803f80
  buffer_load_dwordx4 v10, s[44:47], s52 offen offset:2048 lds
  v_cvt_pk_bf16_f32 v24, v64, v65
  v_cvt_pk_bf16_f32 v40, -v56, -v57
  v_cndmask_b32 v40, v40, v72, vcc
  v_cvt_pk_bf16_f32 v25, v66, v67
  v_cvt_pk_bf16_f32 v41, -v58, -v59
  buffer_load_dwordx4 v11, s[44:47], s52 offen offset:3072 lds
  s_add_u32 s52, s52, 128
  s_and_b32 s52, s52, 0x7ff
  v_cndmask_b32 v41, v41, v72, vcc
  v_cvt_pk_bf16_f32 v26, v68, v69
  v_cvt_pk_bf16_f32 v42, -v60, -v61
  v_cndmask_b32 v42, v42, v72, vcc
  v_cvt_pk_bf16_f32 v27, v70, v71
  v_cvt_pk_bf16_f32 v43, -v62, -v63
  v_cndmask_b32 v43, v43, v72, vcc
  v_cndmask_b32 v28, v24, v40, s[58:59]
  v_cndmask_b32 v44, v40, v24, s[58:59]
  v_xor_b32 v32, v75, v24
  v_xor_b32 v48, v75, v40
  v_xor_b32 v36, v76, v28
  v_xor_b32 v52, v74, v44
  v_xor_b32 v28, v74, v28
  v_xor_b32 v44, v76, v44
  v_cndmask_b32 v29, v25, v41, s[58:59]
  v_cndmask_b32 v45, v41, v25, s[58:59]
  v_xor_b32 v33, v75, v25
  v_xor_b32 v49, v75, v41
  v_xor_b32 v37, v76, v29
  v_xor_b32 v53, v74, v45
  v_xor_b32 v29, v74, v29
  v_xor_b32 v45, v76, v45
  v_cndmask_b32 v30, v26, v42, s[58:59]
  v_cndmask_b32 v46, v42, v26, s[58:59]
  v_xor_b32 v34, v75, v26
  v_xor_b32 v50, v75, v42
  v_xor_b32 v38, v76, v30
  v_xor_b32 v54, v74, v46
  v_xor_b32 v30, v74, v30
  v_xor_b32 v46, v76, v46
  v_cndmask_b32 v31, v27, v43, s[58:59]
  v_cndmask_b32 v47, v43, v27, s[58:59]
  v_xor_b32 v35, v75, v27
  v_xor_b32 v51, v75, v43
  v_xor_b32 v39, v76, v31
  v_xor_b32 v55, v74, v47
  v_xor_b32 v31, v74, v31
  v_xor_b32 v47, v76, v47
  v_and_b32 v5, 31, v1
  v_lshlrev_b32 v5, 1, v5
  s_lshl_b32 s43, s39, 7
  s_and_b32 s28, s3, 1
  s_lshl_b32 s28, s28, 6
  s_add_u32 s43, s43, s28
  buffer_load_ushort v56, v5, s[64:67], s43 offen
  buffer_load_ushort v57, v5, s[68:71], s43 offen
  buffer_load_ushort v58, v5, s[72:75], s43 offen
  v_lshlrev_b32 v5, 1, v2
  s_lshl4_add_u32 s43, s3, s41
  s_lshl_b32 s43, s43, 5
  buffer_load_short_d16_hi v60, v5, s[76:79], s43 offen
  v_lshlrev_b32 v59, 4, v1
  s_lshl_b32 s29, s38, 18
  s_lshl_b32 s58, s39, 11
  s_add_u32 s29, s29, s58
  s_lshl_b32 s58, s3, 16
  s_add_u32 s29, s29, s58
  s_add_u32 s58, s29, 32768
  buffer_load_dwordx4 v[64:67], v59, s[44:47], s29 offen offset:0
  buffer_load_dwordx4 v[68:71], v59, s[44:47], s29 offen offset:1024
  buffer_load_dwordx4 v[72:75], v59, s[44:47], s58 offen offset:0
  buffer_load_dwordx4 v[76:79], v59, s[44:47], s58 offen offset:1024
  buffer_load_dwordx4 v[80:83], v59, s[60:63], 0 offen offset:0
  buffer_load_dwordx4 v[84:87], v59, s[60:63], 0 offen offset:1024
  s_add_u32 m0, s55, 16384
  s_nop 0
  buffer_load_dwordx4 v12, s[48:51], s52 offen offset:0 lds
  buffer_load_dwordx4 v13, s[48:51], s52 offen offset:1024 lds
  buffer_load_dwordx4 v14, s[48:51], s52 offen offset:2048 lds
  buffer_load_dwordx4 v15, s[48:51], s52 offen offset:3072 lds
  s_add_u32 m0, s54, 16384
  s_nop 0
  buffer_load_dwordx4 v8, s[44:47], s52 offen offset:0 lds
  buffer_load_dwordx4 v9, s[44:47], s52 offen offset:1024 lds
  buffer_load_dwordx4 v10, s[44:47], s52 offen offset:2048 lds
  buffer_load_dwordx4 v11, s[44:47], s52 offen offset:3072 lds
  s_add_u32 s52, s52, 128
  s_and_b32 s52, s52, 0x7ff
  s_waitcnt vmcnt(26) lgkmcnt(0)
  s_barrier
  v_bfe_u32 v5, v1, 2, 3
  v_lshrrev_b32 v62, 5, v1
  v_lshl_or_b32 v5, v62, 4, v5
  v_lshlrev_b32 v5, 7, v5
  v_and_b32 v62, 3, v1
  v_lshl_or_b32 v5, v62, 3, v5
  v_add_u32 v5, 131072, v5
  v_bfe_u32 v62, v1, 3, 2
  v_xor_b32 v88, 0, v62
  v_lshl_add_u32 v88, v88, 5, v5
  v_xor_b32 v89, 1, v62
  v_lshl_add_u32 v89, v89, 5, v5
  v_xor_b32 v90, 2, v62
  v_lshl_add_u32 v90, v90, 5, v5
  v_xor_b32 v91, 3, v62
  v_lshl_add_u32 v91, v91, 5, v5
  ds_read_b64_tr_b16 v[124:125], v88 offset:0
  ds_read_b64_tr_b16 v[126:127], v88 offset:1024
  ds_read_b64_tr_b16 v[128:129], v88 offset:4096
  ds_read_b64_tr_b16 v[130:131], v88 offset:5120
  ds_read_b64_tr_b16 v[132:133], v88 offset:8192
  ds_read_b64_tr_b16 v[134:135], v88 offset:9216
  ds_read_b64_tr_b16 v[136:137], v88 offset:12288
  ds_read_b64_tr_b16 v[138:139], v88 offset:13312
  ds_read_b64_tr_b16 v[140:141], v90 offset:0
  ds_read_b64_tr_b16 v[142:143], v90 offset:1024
  ds_read_b64_tr_b16 v[144:145], v90 offset:4096
  ds_read_b64_tr_b16 v[146:147], v90 offset:5120
  ds_read_b64_tr_b16 v[148:149], v90 offset:8192
  ds_read_b64_tr_b16 v[150:151], v90 offset:9216
  ds_read_b64_tr_b16 v[152:153], v90 offset:12288
  ds_read_b64_tr_b16 v[154:155], v90 offset:13312
  ds_read_b64_tr_b16 v[156:157], v89 offset:0
  ds_read_b64_tr_b16 v[158:159], v89 offset:1024
  ds_read_b64_tr_b16 v[160:161], v89 offset:4096
  ds_read_b64_tr_b16 v[162:163], v89 offset:5120
  ds_read_b64_tr_b16 v[164:165], v89 offset:8192
  ds_read_b64_tr_b16 v[166:167], v89 offset:9216
  ds_read_b64_tr_b16 v[168:169], v89 offset:12288
  ds_read_b64_tr_b16 v[170:171], v89 offset:13312
  s_waitcnt lgkmcnt(15)
  v_mfma_f32_16x16x32_bf16 v[92:95], v[24:27], v[124:127], 0
  v_mfma_f32_16x16x32_bf16 v[96:99], v[40:43], v[124:127], 0
  s_waitcnt lgkmcnt(15)
  v_mfma_f32_16x16x32_bf16 v[92:95], v[28:31], v[128:131], v[92:95]
  v_mfma_f32_16x16x32_bf16 v[96:99], v[44:47], v[128:131], v[96:99]
  s_waitcnt lgkmcnt(15)
  v_mfma_f32_16x16x32_bf16 v[92:95], v[32:35], v[132:135], v[92:95]
  v_mfma_f32_16x16x32_bf16 v[96:99], v[48:51], v[132:135], v[96:99]
  s_waitcnt lgkmcnt(15)
  v_mfma_f32_16x16x32_bf16 v[92:95], v[36:39], v[136:139], v[92:95]
  v_mfma_f32_16x16x32_bf16 v[96:99], v[52:55], v[136:139], v[96:99]
  ds_read_b64_tr_b16 v[124:125], v91 offset:0
  ds_read_b64_tr_b16 v[126:127], v91 offset:1024
  ds_read_b64_tr_b16 v[128:129], v91 offset:4096
  ds_read_b64_tr_b16 v[130:131], v91 offset:5120
  ds_read_b64_tr_b16 v[132:133], v91 offset:8192
  ds_read_b64_tr_b16 v[134:135], v91 offset:9216
  ds_read_b64_tr_b16 v[136:137], v91 offset:12288
  ds_read_b64_tr_b16 v[138:139], v91 offset:13312
  s_waitcnt lgkmcnt(15)
  v_mfma_f32_16x16x32_bf16 v[108:111], v[24:27], v[140:143], 0
  v_mfma_f32_16x16x32_bf16 v[112:115], v[40:43], v[140:143], 0
  s_waitcnt lgkmcnt(15)
  v_mfma_f32_16x16x32_bf16 v[108:111], v[28:31], v[144:147], v[108:111]
  v_mfma_f32_16x16x32_bf16 v[112:115], v[44:47], v[144:147], v[112:115]
  s_waitcnt lgkmcnt(15)
  v_mfma_f32_16x16x32_bf16 v[108:111], v[32:35], v[148:151], v[108:111]
  s_add_u32 m0, s55, 32768
  s_nop 0
  buffer_load_dwordx4 v12, s[48:51], s52 offen offset:0 lds
  v_mfma_f32_16x16x32_bf16 v[112:115], v[48:51], v[148:151], v[112:115]
  s_waitcnt lgkmcnt(15)
  v_mfma_f32_16x16x32_bf16 v[108:111], v[36:39], v[152:155], v[108:111]
  v_mfma_f32_16x16x32_bf16 v[112:115], v[52:55], v[152:155], v[112:115]
  s_waitcnt lgkmcnt(14)
  v_mfma_f32_16x16x32_bf16 v[100:103], v[24:27], v[156:159], 0
  v_mfma_f32_16x16x32_bf16 v[104:107], v[40:43], v[156:159], 0
  buffer_load_dwordx4 v13, s[48:51], s52 offen offset:1024 lds
  s_waitcnt lgkmcnt(12)
  v_mfma_f32_16x16x32_bf16 v[100:103], v[28:31], v[160:163], v[100:103]
  v_mfma_f32_16x16x32_bf16 v[104:107], v[44:47], v[160:163], v[104:107]
  s_waitcnt lgkmcnt(10)
  v_mfma_f32_16x16x32_bf16 v[100:103], v[32:35], v[164:167], v[100:103]
  v_mfma_f32_16x16x32_bf16 v[104:107], v[48:51], v[164:167], v[104:107]
  s_waitcnt lgkmcnt(8)
  v_mfma_f32_16x16x32_bf16 v[100:103], v[36:39], v[168:171], v[100:103]
  buffer_load_dwordx4 v14, s[48:51], s52 offen offset:2048 lds
  v_mfma_f32_16x16x32_bf16 v[104:107], v[52:55], v[168:171], v[104:107]
  s_waitcnt lgkmcnt(6)
  v_mfma_f32_16x16x32_bf16 v[116:119], v[24:27], v[124:127], 0
  v_mfma_f32_16x16x32_bf16 v[120:123], v[40:43], v[124:127], 0
  s_waitcnt lgkmcnt(4)
  v_mfma_f32_16x16x32_bf16 v[116:119], v[28:31], v[128:131], v[116:119]
  v_mfma_f32_16x16x32_bf16 v[120:123], v[44:47], v[128:131], v[120:123]
  buffer_load_dwordx4 v15, s[48:51], s52 offen offset:3072 lds
  s_waitcnt lgkmcnt(2)
  v_mfma_f32_16x16x32_bf16 v[116:119], v[32:35], v[132:135], v[116:119]
  v_mfma_f32_16x16x32_bf16 v[120:123], v[48:51], v[132:135], v[120:123]
  s_waitcnt lgkmcnt(0)
  v_mfma_f32_16x16x32_bf16 v[116:119], v[36:39], v[136:139], v[116:119]
  v_mfma_f32_16x16x32_bf16 v[120:123], v[52:55], v[136:139], v[120:123]
  v_pk_add_f32 v[140:141], v[92:93], v[108:109]
  v_pk_add_f32 v[148:149], v[92:93], v[108:109] neg_lo:[0,1] neg_hi:[0,1]
  s_add_u32 m0, s54, 32768
  s_nop 0
  buffer_load_dwordx4 v8, s[44:47], s52 offen offset:0 lds
  v_pk_add_f32 v[142:143], v[94:95], v[110:111]
  v_pk_add_f32 v[150:151], v[94:95], v[110:111] neg_lo:[0,1] neg_hi:[0,1]
  v_pk_add_f32 v[144:145], v[96:97], v[112:113]
  v_pk_add_f32 v[152:153], v[96:97], v[112:113] neg_lo:[0,1] neg_hi:[0,1]
  v_pk_add_f32 v[146:147], v[98:99], v[114:115]
  v_pk_add_f32 v[154:155], v[98:99], v[114:115] neg_lo:[0,1] neg_hi:[0,1]
  v_pk_add_f32 v[156:157], v[100:101], v[116:117]
  v_pk_add_f32 v[164:165], v[100:101], v[116:117] neg_lo:[0,1] neg_hi:[0,1]
  v_pk_add_f32 v[158:159], v[102:103], v[118:119]
  v_pk_add_f32 v[166:167], v[102:103], v[118:119] neg_lo:[0,1] neg_hi:[0,1]
  v_pk_add_f32 v[160:161], v[104:105], v[120:121]
  v_pk_add_f32 v[168:169], v[104:105], v[120:121] neg_lo:[0,1] neg_hi:[0,1]
  v_pk_add_f32 v[162:163], v[106:107], v[122:123]
  v_pk_add_f32 v[170:171], v[106:107], v[122:123] neg_lo:[0,1] neg_hi:[0,1]
  v_pk_add_f32 v[92:93], v[140:141], v[156:157]
  v_pk_add_f32 v[108:109], v[140:141], v[156:157] neg_lo:[0,1] neg_hi:[0,1]
  v_pk_add_f32 v[96:97], v[144:145], v[160:161]
  v_pk_add_f32 v[112:113], v[144:145], v[160:161] neg_lo:[0,1] neg_hi:[0,1]
  buffer_load_dwordx4 v9, s[44:47], s52 offen offset:1024 lds
  v_pk_add_f32 v[100:101], v[148:149], v[168:169]
  v_pk_add_f32 v[104:105], v[152:153], v[164:165] neg_lo:[0,1] neg_hi:[0,1]
  v_pk_add_f32 v[116:117], v[148:149], v[168:169] neg_lo:[0,1] neg_hi:[0,1]
  v_pk_add_f32 v[120:121], v[152:153], v[164:165]
  v_pk_add_f32 v[94:95], v[142:143], v[158:159]
  v_pk_add_f32 v[110:111], v[142:143], v[158:159] neg_lo:[0,1] neg_hi:[0,1]
  v_pk_add_f32 v[98:99], v[146:147], v[162:163]
  v_pk_add_f32 v[114:115], v[146:147], v[162:163] neg_lo:[0,1] neg_hi:[0,1]
  v_pk_add_f32 v[102:103], v[150:151], v[170:171]
  v_pk_add_f32 v[106:107], v[154:155], v[166:167] neg_lo:[0,1] neg_hi:[0,1]
  v_pk_add_f32 v[118:119], v[150:151], v[170:171] neg_lo:[0,1] neg_hi:[0,1]
  v_pk_add_f32 v[122:123], v[154:155], v[166:167]
  v_cmp_gt_u32 vcc, 16, v0
  s_nop 1
  v_cndmask_b32 v100, v100, v148, vcc
  v_cndmask_b32 v104, v104, -v164, vcc
  v_cndmask_b32 v116, v116, v152, vcc
  v_cndmask_b32 v120, v120, -v168, vcc
  v_cvt_pk_bf16_f32 v124, v92, v96
  buffer_load_dwordx4 v10, s[44:47], s52 offen offset:2048 lds
  v_cvt_pk_bf16_f32 v125, v100, v104
  v_cvt_pk_bf16_f32 v126, v108, v112
  v_cvt_pk_bf16_f32 v127, v116, v120
  v_cvt_pk_bf16_f32 v128, v93, v97
  v_cvt_pk_bf16_f32 v129, v101, v105
  v_cvt_pk_bf16_f32 v130, v109, v113
  v_cvt_pk_bf16_f32 v131, v117, v121
  v_cvt_pk_bf16_f32 v132, v94, v98
  v_cvt_pk_bf16_f32 v133, v102, v106
  v_cvt_pk_bf16_f32 v134, v110, v114
  v_cvt_pk_bf16_f32 v135, v118, v122
  v_cvt_pk_bf16_f32 v136, v95, v99
  v_cvt_pk_bf16_f32 v137, v103, v107
  v_cvt_pk_bf16_f32 v138, v111, v115
  v_cvt_pk_bf16_f32 v139, v119, v123
  v_and_b32 v124, -2, v124
  v_and_b32 v125, -2, v125
  v_and_b32 v126, -2, v126
  buffer_load_dwordx4 v11, s[44:47], s52 offen offset:3072 lds
  s_add_u32 s52, s52, 128
  s_and_b32 s52, s52, 0x7ff
  v_and_b32 v127, -2, v127
  v_and_b32 v128, -2, v128
  v_and_b32 v129, -2, v129
  v_and_b32 v130, -2, v130
  v_and_b32 v131, -2, v131
  v_and_b32 v132, -2, v132
  v_and_b32 v133, -2, v133
  v_and_b32 v134, -2, v134
  v_and_b32 v135, -2, v135
  v_and_b32 v136, -2, v136
  v_and_b32 v137, -2, v137
  v_and_b32 v138, -2, v138
  v_and_b32 v139, -2, v139
  s_mov_b32 s28, 262144
  v_mul_lo_u32 v5, v3, s28
  v_lshl_add_u32 v5, v2, 2, v5
  s_mul_i32 s28, s3, 1048576
  s_lshl_b32 s43, s40, 10
  s_add_u32 m0, s55, 49152
  s_nop 0
  buffer_load_dwordx4 v12, s[48:51], s52 offen offset:0 lds
  s_add_u32 s28, s28, s43
  s_lshl_b32 s43, s41, 6
  s_add_u32 s28, s28, s43
  s_lshr_b32 s43, s41, 3
  s_lshl_b32 s43, s43, 13
  s_add_u32 s43, s43, 131072
  v_lshrrev_b32 v40, 2, v1
  v_lshl_add_u32 v40, v40, 7, s43
  v_and_b32 v41, 3, v1
  v_lshl_add_u32 v40, v41, 3, v40
  v_bfe_u32 v41, v1, 3, 2
  v_xor_b32 v41, s3, v41
  v_lshl_add_u32 v39, v41, 5, v40
  v_xor_b32 v38, 8192, v39
  ds_read_b64_tr_b16 v[62:63], v38 offset:0
  ds_read_b64_tr_b16 v[24:25], v38 offset:2048
  ds_read_b64_tr_b16 v[26:27], v38 offset:4096
  ds_read_b64_tr_b16 v[28:29], v38 offset:6144
  buffer_load_dwordx4 v13, s[48:51], s52 offen offset:1024 lds
  ds_read_b64_tr_b16 v[30:31], v39 offset:0
  ds_read_b64_tr_b16 v[32:33], v39 offset:2048
  ds_read_b64_tr_b16 v[34:35], v39 offset:4096
  ds_read_b64_tr_b16 v[36:37], v39 offset:6144
  buffer_load_dwordx4 v14, s[48:51], s52 offen offset:2048 lds
  buffer_load_dwordx4 v15, s[48:51], s52 offen offset:3072 lds
  s_add_u32 m0, s54, 49152
  s_nop 0
  buffer_load_dwordx4 v8, s[44:47], s52 offen offset:0 lds
  buffer_load_dwordx4 v9, s[44:47], s52 offen offset:1024 lds
  buffer_load_dwordx4 v10, s[44:47], s52 offen offset:2048 lds
  buffer_load_dwordx4 v11, s[44:47], s52 offen offset:3072 lds
  s_add_u32 s52, s52, 128
  s_and_b32 s52, s52, 0x7ff
  s_waitcnt vmcnt(34)
  s_barrier
  ds_read_b128 v[120:123], v16 offset:0
  ds_read_b128 v[160:163], v20 offset:0
  ds_read_b128 v[156:159], v16 offset:4096
  ds_read_b128 v[164:167], v20 offset:4096
  s_waitcnt lgkmcnt(2)
  v_mfma_f32_32x32x16_bf16 v[40:55], v[120:123], v[160:163], 0
  ds_read_b128 v[168:171], v17 offset:0
  ds_read_b128 v[176:179], v21 offset:0
  buffer_store_dword v124, v5, s[12:15], s28 offen sc1
  s_add_u32 s28, s28, 16384
  buffer_store_dword v125, v5, s[12:15], s28 offen sc1
  s_waitcnt lgkmcnt(2)
  v_mfma_f32_32x32x16_bf16 v[88:103], v[120:123], v[164:167], 0
  ds_read_b128 v[172:175], v17 offset:4096
  ds_read_b128 v[180:183], v21 offset:4096
  s_add_u32 s28, s28, 16384
  buffer_store_dword v126, v5, s[12:15], s28 offen sc1
  v_mfma_f32_32x32x16_bf16 v[140:155], v[156:159], v[164:167], 0
  s_add_u32 s28, s28, 16384
  buffer_store_dword v127, v5, s[12:15], s28 offen sc1
  v_mfma_f32_32x32x16_bf16 v[104:119], v[156:159], v[160:163], 0
  s_add_u32 s28, s28, 16384
  buffer_store_dword v128, v5, s[12:15], s28 offen sc1
  s_waitcnt lgkmcnt(2)
  v_mfma_f32_32x32x16_bf16 v[40:55], v[168:171], v[176:179], v[40:55]
  ds_read_b128 v[120:123], v18 offset:0
  ds_read_b128 v[160:163], v22 offset:0
  s_add_u32 s28, s28, 16384
  buffer_store_dword v129, v5, s[12:15], s28 offen sc1
  s_waitcnt lgkmcnt(2)
  v_mfma_f32_32x32x16_bf16 v[88:103], v[168:171], v[180:183], v[88:103]
  ds_read_b128 v[156:159], v18 offset:4096
  ds_read_b128 v[164:167], v22 offset:4096
  s_add_u32 s28, s28, 16384
  buffer_store_dword v130, v5, s[12:15], s28 offen sc1
  v_mfma_f32_32x32x16_bf16 v[140:155], v[172:175], v[180:183], v[140:155]
  s_add_u32 s28, s28, 16384
  buffer_store_dword v131, v5, s[12:15], s28 offen sc1
  v_mfma_f32_32x32x16_bf16 v[104:119], v[172:175], v[176:179], v[104:119]
  s_add_u32 s28, s28, 16384
  buffer_store_dword v132, v5, s[12:15], s28 offen sc1
  s_waitcnt lgkmcnt(2)
  v_mfma_f32_32x32x16_bf16 v[40:55], v[120:123], v[160:163], v[40:55]
  ds_read_b128 v[168:171], v19 offset:0
  ds_read_b128 v[176:179], v23 offset:0
  s_add_u32 s28, s28, 16384
  buffer_store_dword v133, v5, s[12:15], s28 offen sc1
  s_add_u32 s28, s28, 16384
  s_waitcnt lgkmcnt(2)
  v_mfma_f32_32x32x16_bf16 v[88:103], v[120:123], v[164:167], v[88:103]
  ds_read_b128 v[172:175], v19 offset:4096
  ds_read_b128 v[180:183], v23 offset:4096
  buffer_store_dword v134, v5, s[12:15], s28 offen sc1
  s_add_u32 s28, s28, 16384
  v_mfma_f32_32x32x16_bf16 v[140:155], v[156:159], v[164:167], v[140:155]
  buffer_store_dword v135, v5, s[12:15], s28 offen sc1
  s_add_u32 s28, s28, 16384
  v_mfma_f32_32x32x16_bf16 v[104:119], v[156:159], v[160:163], v[104:119]
  buffer_store_dword v136, v5, s[12:15], s28 offen sc1
  s_add_u32 s28, s28, 16384
  s_waitcnt vmcnt(29) lgkmcnt(0)
  s_barrier
  v_mfma_f32_32x32x16_bf16 v[40:55], v[168:171], v[176:179], v[40:55]
  ds_read_b128 v[120:123], v16 offset:16384
  ds_read_b128 v[160:163], v20 offset:16384
  buffer_store_dword v137, v5, s[12:15], s28 offen sc1
  s_add_u32 s28, s28, 16384
  v_mfma_f32_32x32x16_bf16 v[88:103], v[168:171], v[180:183], v[88:103]
  ds_read_b128 v[156:159], v16 offset:20480
  ds_read_b128 v[164:167], v20 offset:20480
  buffer_store_dword v138, v5, s[12:15], s28 offen sc1
  s_add_u32 s28, s28, 16384
  v_mfma_f32_32x32x16_bf16 v[140:155], v[172:175], v[180:183], v[140:155]
  s_add_u32 m0, s55, 0
  s_nop 0
  buffer_load_dwordx4 v12, s[48:51], s52 offen offset:0 lds
  buffer_store_dword v139, v5, s[12:15], s28 offen sc1
  s_mov_b32 s24, s32
  v_mfma_f32_32x32x16_bf16 v[104:119], v[172:175], v[176:179], v[104:119]
  buffer_load_dwordx4 v13, s[48:51], s52 offen offset:1024 lds
  s_mov_b32 s25, s33
  s_mov_b32 s26, 256
  s_waitcnt lgkmcnt(2)
  v_mfma_f32_32x32x16_bf16 v[40:55], v[120:123], v[160:163], v[40:55]
  ds_read_b128 v[168:171], v17 offset:16384
  ds_read_b128 v[176:179], v21 offset:16384
  s_mov_b32 s27, 0x20000
  s_and_b32 s57, s2, 7
  s_lshl_b32 s57, s57, 8
  s_add_u32 s57, s57, s2
  s_and_b32 s57, s57, -8
  s_lshl_b32 s57, s57, 1
  s_waitcnt lgkmcnt(2)
  v_mfma_f32_32x32x16_bf16 v[88:103], v[120:123], v[164:167], v[88:103]
  ds_read_b128 v[172:175], v17 offset:20480
  ds_read_b128 v[180:183], v21 offset:20480
  v_mov_b32 v38, s57
  s_lshl4_add_u32 s57, s39, s38
  s_lshl_b32 s57, s57, 7
  v_lshl_add_u32 v39, v2, 2, s57
  s_mov_b32 s57, 8192
  v_mfma_f32_32x32x16_bf16 v[140:155], v[156:159], v[164:167], v[140:155]
  buffer_load_dwordx4 v14, s[48:51], s52 offen offset:2048 lds
  v_mov_b32 v5, 1
  s_lshl_b32 s28, s39, 14
  s_add_u32 s66, s28, 19988480
  s_add_u32 s64, s34, s66
  s_addc_u32 s65, s35, 0
  s_mov_b32 s66, 8192
  v_mfma_f32_32x32x16_bf16 v[104:119], v[156:159], v[160:163], v[104:119]
  buffer_load_dwordx4 v15, s[48:51], s52 offen offset:3072 lds
  s_mov_b32 s67, 0x20000
  s_sub_u32 s28, 15, s38
  s_lshl_b32 s28, s28, 9
  v_lshl_add_u32 v124, v0, 2, s28
  v_mov_b32 v125, -1
  s_waitcnt lgkmcnt(2)
  v_mfma_f32_32x32x16_bf16 v[40:55], v[168:171], v[176:179], v[40:55]
  ds_read_b128 v[120:123], v18 offset:16384
  ds_read_b128 v[160:163], v22 offset:16384
  s_cmp_ge_u32 s3, 2
  s_cbranch_scc1 gated_mix__spectral_gfnet__ssm_conv_s5__prompt_kernel_skip10
  buffer_store_dword v125, v124, s[64:67], 0 offen sc1
gated_mix__spectral_gfnet__ssm_conv_s5__prompt_kernel_skip10:
  s_cmp_lg_u32 s3, 0
  s_cbranch_scc1 gated_mix__spectral_gfnet__ssm_conv_s5__prompt_kernel_skip11
  s_mov_b64 exec, 65535
  buffer_store_dword v6, v39, s[16:19], s57 offen sc1
  s_mov_b64 exec, -1
gated_mix__spectral_gfnet__ssm_conv_s5__prompt_kernel_skip11:
  s_waitcnt lgkmcnt(2)
  v_mfma_f32_32x32x16_bf16 v[88:103], v[168:171], v[180:183], v[88:103]
  ds_read_b128 v[156:159], v18 offset:20480
  ds_read_b128 v[164:167], v22 offset:20480
  s_or_b32 s28, s3, s2
  v_mfma_f32_32x32x16_bf16 v[140:155], v[172:175], v[180:183], v[140:155]
  s_add_u32 m0, s54, 0
  s_nop 0
  buffer_load_dwordx4 v8, s[44:47], s52 offen offset:0 lds
  s_cmp_lg_u32 s28, 0
  s_cbranch_scc1 gated_mix__spectral_gfnet__ssm_conv_s5__prompt_kernel_skip12
  s_mov_b64 exec, 1
  buffer_store_dword v5, v6, s[24:27], 0 offen sc1
  s_mov_b64 exec, -1
gated_mix__spectral_gfnet__ssm_conv_s5__prompt_kernel_skip12:
  v_mfma_f32_32x32x16_bf16 v[104:119], v[172:175], v[176:179], v[104:119]
  buffer_load_dwordx4 v9, s[44:47], s52 offen offset:1024 lds
  s_mov_b32 s68, s20
  s_mov_b32 s69, s21
  s_mov_b32 s70, 2097152
  s_mov_b32 s71, 0x20000
  s_mov_b32 s72, s22
  s_waitcnt lgkmcnt(2)
  v_mfma_f32_32x32x16_bf16 v[40:55], v[120:123], v[160:163], v[40:55]
  ds_read_b128 v[168:171], v19 offset:16384
  ds_read_b128 v[176:179], v23 offset:16384
  s_mov_b32 s73, s23
  s_mov_b32 s74, 2097152
  s_mov_b32 s75, 0x20000
  v_and_b32 v132, 7, v1
  v_xor_b32 v132, v132, v3
  s_waitcnt lgkmcnt(2)
  v_mfma_f32_32x32x16_bf16 v[88:103], v[120:123], v[164:167], v[88:103]
  ds_read_b128 v[172:175], v19 offset:20480
  ds_read_b128 v[180:183], v23 offset:20480
  v_and_b32 v133, 4, v132
  v_lshlrev_b32 v124, 4, v133
  v_and_b32 v133, 1, v132
  v_lshl_or_b32 v124, v133, 5, v124
  v_and_b32 v133, 2, v132
  v_lshl_or_b32 v124, v133, 3, v124
  v_mfma_f32_32x32x16_bf16 v[140:155], v[156:159], v[164:167], v[140:155]
  buffer_load_dwordx4 v10, s[44:47], s52 offen offset:2048 lds
  v_lshrrev_b32 v133, 3, v1
  v_lshl_or_b32 v124, v133, 11, v124
  s_lshl4_add_u32 s59, s3, s41
  s_lshl_b32 s59, s59, 15
  s_lshr_b32 s28, s41, 3
  v_mfma_f32_32x32x16_bf16 v[104:119], v[156:159], v[160:163], v[104:119]
  buffer_load_dwordx4 v11, s[44:47], s52 offen offset:3072 lds
  s_add_u32 s52, s52, 128
  s_and_b32 s52, s52, 0x7ff
  s_lshl_b32 s28, s28, 10
  s_add_u32 s59, s59, s28
  v_add_u32 v124, s59, v124
  v_xor_b32 v126, 262144, v124
  v_xor_b32 v125, 64, v124
  v_xor_b32 v127, 64, v126
  s_waitcnt vmcnt(32) lgkmcnt(0)
  s_barrier
  v_mfma_f32_32x32x16_bf16 v[40:55], v[168:171], v[176:179], v[40:55]
  ds_read_b128 v[120:123], v16 offset:32768
  ds_read_b128 v[160:163], v20 offset:32768
  v_add_u32 v125, 15360, v125
  v_add_u32 v127, 15360, v127
  s_and_b32 s28, s40, 7
  s_lshl_b32 s28, s28, 7
  s_lshl_b32 s43, s3, 12
  v_mfma_f32_32x32x16_bf16 v[88:103], v[168:171], v[180:183], v[88:103]
  ds_read_b128 v[156:159], v16 offset:36864
  ds_read_b128 v[164:167], v20 offset:36864
  v_lshrrev_b32 v132, 1, v2
  v_xor_b32 v132, v132, v3
  v_lshlrev_b32 v132, 4, v132
  v_lshl_or_b32 v132, v2, 7, v132
  v_add_u32 v128, s43, v132
  v_xor_b32 v129, 64, v128
  v_mfma_f32_32x32x16_bf16 v[140:155], v[172:175], v[180:183], v[140:155]
  s_add_u32 m0, s55, 16384
  s_nop 0
  buffer_load_dwordx4 v12, s[48:51], s52 offen offset:0 lds
  v_add_u32 v130, 0x10000, v128
  v_add_u32 v131, 0x10000, v129
  s_mov_b32 s20, s6
  s_mov_b32 s21, s7
  s_mov_b32 s22, 2101248
  v_mfma_f32_32x32x16_bf16 v[104:119], v[172:175], v[176:179], v[104:119]
  buffer_load_dwordx4 v13, s[48:51], s52 offen offset:1024 lds
  s_mov_b32 s23, 0x20000
  s_sub_u32 s76, s8, 1024
  s_subb_u32 s77, s9, 0
  s_mov_b32 s78, 2102272
  s_mov_b32 s79, 0x20000
  s_waitcnt lgkmcnt(2)
  v_mfma_f32_32x32x16_bf16 v[40:55], v[120:123], v[160:163], v[40:55]
  ds_read_b128 v[168:171], v17 offset:32768
  ds_read_b128 v[176:179], v21 offset:32768
  s_waitcnt lgkmcnt(2)
  v_mfma_f32_32x32x16_bf16 v[88:103], v[120:123], v[164:167], v[88:103]
  ds_read_b128 v[172:175], v17 offset:36864
  ds_read_b128 v[180:183], v21 offset:36864
  v_mfma_f32_32x32x16_bf16 v[140:155], v[156:159], v[164:167], v[140:155]
  buffer_load_dwordx4 v14, s[48:51], s52 offen offset:2048 lds
  v_mfma_f32_32x32x16_bf16 v[104:119], v[156:159], v[160:163], v[104:119]
  buffer_load_dwordx4 v15, s[48:51], s52 offen offset:3072 lds
  s_waitcnt lgkmcnt(2)
  v_mfma_f32_32x32x16_bf16 v[40:55], v[168:171], v[176:179], v[40:55]
  ds_read_b128 v[120:123], v18 offset:32768
  ds_read_b128 v[160:163], v22 offset:32768
  s_waitcnt lgkmcnt(2)
  v_mfma_f32_32x32x16_bf16 v[88:103], v[168:171], v[180:183], v[88:103]
  ds_read_b128 v[156:159], v18 offset:36864
  ds_read_b128 v[164:167], v22 offset:36864
  v_mfma_f32_32x32x16_bf16 v[140:155], v[172:175], v[180:183], v[140:155]
  s_add_u32 m0, s54, 16384
  s_nop 0
  buffer_load_dwordx4 v8, s[44:47], s52 offen offset:0 lds
  v_mfma_f32_32x32x16_bf16 v[104:119], v[172:175], v[176:179], v[104:119]
  buffer_load_dwordx4 v9, s[44:47], s52 offen offset:1024 lds
  s_waitcnt lgkmcnt(2)
  v_mfma_f32_32x32x16_bf16 v[40:55], v[120:123], v[160:163], v[40:55]
  ds_read_b128 v[168:171], v19 offset:32768
  ds_read_b128 v[176:179], v23 offset:32768
  s_waitcnt lgkmcnt(2)
  v_mfma_f32_32x32x16_bf16 v[88:103], v[120:123], v[164:167], v[88:103]
  ds_read_b128 v[172:175], v19 offset:36864
  ds_read_b128 v[180:183], v23 offset:36864
  v_mfma_f32_32x32x16_bf16 v[140:155], v[156:159], v[164:167], v[140:155]
  buffer_load_dwordx4 v10, s[44:47], s52 offen offset:2048 lds
  v_mfma_f32_32x32x16_bf16 v[104:119], v[156:159], v[160:163], v[104:119]
  buffer_load_dwordx4 v11, s[44:47], s52 offen offset:3072 lds
  s_add_u32 s52, s52, 128
  s_and_b32 s52, s52, 0x7ff
  s_waitcnt vmcnt(32) lgkmcnt(0)
  s_barrier
  v_mfma_f32_32x32x16_bf16 v[40:55], v[168:171], v[176:179], v[40:55]
  ds_read_b128 v[120:123], v16 offset:49152
  ds_read_b128 v[160:163], v20 offset:49152
  v_mfma_f32_32x32x16_bf16 v[88:103], v[168:171], v[180:183], v[88:103]
  ds_read_b128 v[156:159], v16 offset:53248
  ds_read_b128 v[164:167], v20 offset:53248
  v_mfma_f32_32x32x16_bf16 v[140:155], v[172:175], v[180:183], v[140:155]
  s_add_u32 m0, s55, 32768
  s_nop 0
  buffer_load_dwordx4 v12, s[48:51], s52 offen offset:0 lds
  v_mfma_f32_32x32x16_bf16 v[104:119], v[172:175], v[176:179], v[104:119]
  buffer_load_dwordx4 v13, s[48:51], s52 offen offset:1024 lds
  s_waitcnt lgkmcnt(2)
  v_mfma_f32_32x32x16_bf16 v[40:55], v[120:123], v[160:163], v[40:55]
  ds_read_b128 v[168:171], v17 offset:49152
  ds_read_b128 v[176:179], v21 offset:49152
  s_add_u32 s80, s34, 19922944
  s_addc_u32 s81, s35, 0
  s_waitcnt lgkmcnt(2)
  v_mfma_f32_32x32x16_bf16 v[88:103], v[120:123], v[164:167], v[88:103]
  ds_read_b128 v[172:175], v17 offset:53248
  ds_read_b128 v[180:183], v21 offset:53248
  s_mov_b32 s82, 32768
  s_mov_b32 s83, 0x20000
  v_mfma_f32_32x32x16_bf16 v[140:155], v[156:159], v[164:167], v[140:155]
  buffer_load_dwordx4 v14, s[48:51], s52 offen offset:2048 lds
  v_mov_b32 v132, 0
  v_mfma_f32_32x32x16_bf16 v[104:119], v[156:159], v[160:163], v[104:119]
  buffer_load_dwordx4 v15, s[48:51], s52 offen offset:3072 lds
  v_mov_b32 v133, 0
  v_dot2c_f32_bf16 v132, v64, v80
  s_waitcnt lgkmcnt(2)
  v_mfma_f32_32x32x16_bf16 v[40:55], v[168:171], v[176:179], v[40:55]
  ds_read_b128 v[120:123], v18 offset:49152
  ds_read_b128 v[160:163], v22 offset:49152
  v_dot2c_f32_bf16 v133, v72, v80
  s_waitcnt lgkmcnt(2)
  v_mfma_f32_32x32x16_bf16 v[88:103], v[168:171], v[180:183], v[88:103]
  ds_read_b128 v[156:159], v18 offset:53248
  ds_read_b128 v[164:167], v22 offset:53248
  v_dot2c_f32_bf16 v132, v65, v81
  v_dot2c_f32_bf16 v133, v73, v81
  v_mfma_f32_32x32x16_bf16 v[140:155], v[172:175], v[180:183], v[140:155]
  s_add_u32 m0, s54, 32768
  s_nop 0
  buffer_load_dwordx4 v8, s[44:47], s52 offen offset:0 lds
  v_dot2c_f32_bf16 v132, v66, v82
  v_dot2c_f32_bf16 v133, v74, v82
  v_mfma_f32_32x32x16_bf16 v[104:119], v[172:175], v[176:179], v[104:119]
  buffer_load_dwordx4 v9, s[44:47], s52 offen offset:1024 lds
  v_dot2c_f32_bf16 v132, v67, v83
  s_waitcnt lgkmcnt(2)
  v_mfma_f32_32x32x16_bf16 v[40:55], v[120:123], v[160:163], v[40:55]
  ds_read_b128 v[168:171], v19 offset:49152
  ds_read_b128 v[176:179], v23 offset:49152
  v_dot2c_f32_bf16 v133, v75, v83
  v_dot2c_f32_bf16 v132, v68, v84
  s_waitcnt lgkmcnt(2)
  v_mfma_f32_32x32x16_bf16 v[88:103], v[120:123], v[164:167], v[88:103]
  ds_read_b128 v[172:175], v19 offset:53248
  ds_read_b128 v[180:183], v23 offset:53248
  v_dot2c_f32_bf16 v133, v76, v84
  v_mfma_f32_32x32x16_bf16 v[140:155], v[156:159], v[164:167], v[140:155]
  buffer_load_dwordx4 v10, s[44:47], s52 offen offset:2048 lds
  v_dot2c_f32_bf16 v132, v69, v85
  v_dot2c_f32_bf16 v133, v77, v85
  v_mfma_f32_32x32x16_bf16 v[104:119], v[156:159], v[160:163], v[104:119]
  buffer_load_dwordx4 v11, s[44:47], s52 offen offset:3072 lds
  s_add_u32 s52, s52, 128
  s_and_b32 s52, s52, 0x7ff
  v_dot2c_f32_bf16 v132, v70, v86
  v_dot2c_f32_bf16 v133, v78, v86
  s_waitcnt vmcnt(16) lgkmcnt(0)
  s_barrier
  v_mfma_f32_32x32x16_bf16 v[40:55], v[168:171], v[176:179], v[40:55]
  ds_read_b128 v[120:123], v16 offset:0
  ds_read_b128 v[160:163], v20 offset:0
  v_dot2c_f32_bf16 v132, v71, v87
  v_mfma_f32_32x32x16_bf16 v[88:103], v[168:171], v[180:183], v[88:103]
  ds_read_b128 v[156:159], v16 offset:4096
  ds_read_b128 v[164:167], v20 offset:4096
  v_dot2c_f32_bf16 v133, v79, v87
  s_lshl_b32 s59, s39, 11
  v_mfma_f32_32x32x16_bf16 v[140:155], v[172:175], v[180:183], v[140:155]
  s_add_u32 m0, s55, 49152
  s_nop 0
  buffer_load_dwordx4 v12, s[48:51], s52 offen offset:0 lds
  s_lshl_b32 s6, s38, 7
  v_mfma_f32_32x32x16_bf16 v[104:119], v[172:175], v[176:179], v[104:119]
  buffer_load_dwordx4 v13, s[48:51], s52 offen offset:1024 lds
  s_add_u32 s59, s59, s6
  v_permlane32_swap_b32 v132, v133
  s_waitcnt lgkmcnt(2)
  v_mfma_f32_32x32x16_bf16 v[40:55], v[120:123], v[160:163], v[40:55]
  ds_read_b128 v[168:171], v17 offset:0
  ds_read_b128 v[176:179], v21 offset:0
  v_add_f32 v132, v132, v133
  v_mov_b32 v133, v132
  s_waitcnt lgkmcnt(2)
  v_mfma_f32_32x32x16_bf16 v[88:103], v[120:123], v[164:167], v[88:103]
  ds_read_b128 v[172:175], v17 offset:4096
  ds_read_b128 v[180:183], v21 offset:4096
  s_lshl_b32 s6, s3, 3
  v_mfma_f32_32x32x16_bf16 v[140:155], v[156:159], v[164:167], v[140:155]
  buffer_load_dwordx4 v14, s[48:51], s52 offen offset:2048 lds
  s_add_u32 s59, s59, s6
  v_permlane16_swap_b32 v132, v133
  v_mfma_f32_32x32x16_bf16 v[104:119], v[156:159], v[160:163], v[104:119]
  buffer_load_dwordx4 v15, s[48:51], s52 offen offset:3072 lds
  v_add_f32 v132, v132, v133
  s_waitcnt lgkmcnt(2)
  v_mfma_f32_32x32x16_bf16 v[40:55], v[168:171], v[176:179], v[40:55]
  ds_read_b128 v[120:123], v18 offset:0
  ds_read_b128 v[160:163], v22 offset:0
  v_add_f32 v132, v132, v132 row_ror:8 row_mask:0xf bank_mask:0xf
  s_nop 1
  v_add_f32 v132, v132, v132 row_ror:4 row_mask:0xf bank_mask:0xf
  s_waitcnt lgkmcnt(2)
  v_mfma_f32_32x32x16_bf16 v[88:103], v[168:171], v[180:183], v[88:103]
  ds_read_b128 v[156:159], v18 offset:4096
  ds_read_b128 v[164:167], v22 offset:4096
  v_add_f32 v132, v132, v132 row_ror:2 row_mask:0xf bank_mask:0xf
  s_nop 1
  v_add_f32 v132, v132, v132 row_ror:1 row_mask:0xf bank_mask:0xf
  v_mfma_f32_32x32x16_bf16 v[140:155], v[172:175], v[180:183], v[140:155]
  s_add_u32 m0, s54, 49152
  s_nop 0
  buffer_load_dwordx4 v8, s[44:47], s52 offen offset:0 lds
  v_cvt_pk_bf16_f32 v132, v132, v132
  v_mfma_f32_32x32x16_bf16 v[104:119], v[172:175], v[176:179], v[104:119]
  buffer_load_dwordx4 v9, s[44:47], s52 offen offset:1024 lds
  v_and_b32 v132, 0xffff0000, v132
  v_mul_f32 v132, 0xbfb8aa3b, v132
  s_waitcnt lgkmcnt(2)
  v_mfma_f32_32x32x16_bf16 v[40:55], v[120:123], v[160:163], v[40:55]
  ds_read_b128 v[168:171], v19 offset:0
  ds_read_b128 v[176:179], v23 offset:0
  v_exp_f32 v132, v132
  s_waitcnt lgkmcnt(2)
  v_mfma_f32_32x32x16_bf16 v[88:103], v[120:123], v[164:167], v[88:103]
  ds_read_b128 v[172:175], v19 offset:4096
  ds_read_b128 v[180:183], v23 offset:4096
  v_lshrrev_b32 v134, 3, v1
  v_add_f32 v132, 1.0, v132
  v_mfma_f32_32x32x16_bf16 v[140:155], v[156:159], v[164:167], v[140:155]
  buffer_load_dwordx4 v10, s[44:47], s52 offen offset:2048 lds
  v_rcp_f32 v132, v132
  s_mov_b32 exec_lo, 1
  s_mov_b32 exec_hi, 1
  v_cvt_pk_bf16_f32 v132, v132, v132
  v_and_b32 v132, 0xffff0000, v132
  s_add_u32 s6, s6, 131072
  v_add_u32 v134, s6, v134
  ds_write_b32 v134, v132
  s_mov_b64 exec, -1
  v_mfma_f32_32x32x16_bf16 v[104:119], v[156:159], v[160:163], v[104:119]
  buffer_load_dwordx4 v11, s[44:47], s52 offen offset:3072 lds
  s_add_u32 s52, s52, 128
  s_and_b32 s52, s52, 0x7ff
  s_waitcnt vmcnt(16) lgkmcnt(1)
  s_barrier
  v_mfma_f32_32x32x16_bf16 v[40:55], v[168:171], v[176:179], v[40:55]
  ds_read_b128 v[120:123], v16 offset:16384
  ds_read_b128 v[160:163], v20 offset:16384
  v_mfma_f32_32x32x16_bf16 v[88:103], v[168:171], v[180:183], v[88:103]
  ds_read_b128 v[156:159], v16 offset:20480
  ds_read_b128 v[164:167], v20 offset:20480
  s_cmp_lg_u32 s3, 1
  s_cbranch_scc1 gated_mix__spectral_gfnet__ssm_conv_s5__prompt_kernel_skip15
  s_getpc_b64 s[90:91]
gated_mix__spectral_gfnet__ssm_conv_s5__prompt_kernel_pc14:
  s_lshr_b32 s29, s2, 3
  s_mul_i32 s29, s29, 512
  v_min_u32 v210, 3, v1
  v_lshl_add_u32 v210, v210, 7, s29
  v_min_u32 v210, gated_mix__spectral_gfnet__ssm_conv_s5__prompt_kernel_end-gated_mix__spectral_gfnet__ssm_conv_s5__prompt_kernel_pc14, v210
  v_mov_b32 v211, 0
  v_lshl_add_u64 v[210:211], v[210:211], 0, s[90:91]
  global_load_dword v4, v[210:211], off
gated_mix__spectral_gfnet__ssm_conv_s5__prompt_kernel_skip15:
  v_mfma_f32_32x32x16_bf16 v[140:155], v[172:175], v[180:183], v[140:155]
  s_add_u32 m0, s55, 0
  s_nop 0
  buffer_load_dwordx4 v12, s[48:51], s52 offen offset:0 lds
  v_mfma_f32_32x32x16_bf16 v[104:119], v[172:175], v[176:179], v[104:119]
  buffer_load_dwordx4 v13, s[48:51], s52 offen offset:1024 lds
  s_waitcnt lgkmcnt(2)
  v_mfma_f32_32x32x16_bf16 v[40:55], v[120:123], v[160:163], v[40:55]
  ds_read_b128 v[168:171], v17 offset:16384
  ds_read_b128 v[176:179], v21 offset:16384
  v_lshlrev_b32 v64, 4, v1
  v_add_u32 v64, 147456, v64
  s_waitcnt lgkmcnt(2)
  v_mfma_f32_32x32x16_bf16 v[88:103], v[120:123], v[164:167], v[88:103]
  ds_read_b128 v[172:175], v17 offset:20480
  ds_read_b128 v[180:183], v21 offset:20480
  ds_read_b128 v[68:71], v64 offset:0
  v_mfma_f32_32x32x16_bf16 v[140:155], v[156:159], v[164:167], v[140:155]
  buffer_load_dwordx4 v14, s[48:51], s52 offen offset:2048 lds
  ds_read_b128 v[72:75], v64 offset:1024
  v_mfma_f32_32x32x16_bf16 v[104:119], v[156:159], v[160:163], v[104:119]
  buffer_load_dwordx4 v15, s[48:51], s52 offen offset:3072 lds
  ds_read_b128 a[224:227], v64 offset:2048
  s_waitcnt lgkmcnt(5)
  v_mfma_f32_32x32x16_bf16 v[40:55], v[168:171], v[176:179], v[40:55]
  ds_read_b128 v[120:123], v18 offset:16384
  ds_read_b128 v[160:163], v22 offset:16384
  ds_read_b128 a[228:231], v64 offset:3072
  s_waitcnt lgkmcnt(6)
  v_mfma_f32_32x32x16_bf16 v[88:103], v[168:171], v[180:183], v[88:103]
  ds_read_b128 v[156:159], v18 offset:20480
  ds_read_b128 v[164:167], v22 offset:20480
  ds_read_b128 a[248:251], v64 offset:4096
  v_mfma_f32_32x32x16_bf16 v[140:155], v[172:175], v[180:183], v[140:155]
  s_add_u32 m0, s54, 0
  s_nop 0
  buffer_load_dwordx4 v8, s[44:47], s52 offen offset:0 lds
  ds_read_b128 a[252:255], v64 offset:5120
  v_mfma_f32_32x32x16_bf16 v[104:119], v[172:175], v[176:179], v[104:119]
  buffer_load_dwordx4 v9, s[44:47], s52 offen offset:1024 lds
  ds_read_b128 a[232:235], v64 offset:6144
  s_waitcnt lgkmcnt(6)
  v_mfma_f32_32x32x16_bf16 v[40:55], v[120:123], v[160:163], v[40:55]
  ds_read_b128 v[168:171], v19 offset:16384
  ds_read_b128 v[176:179], v23 offset:16384
  ds_read_b128 a[236:239], v64 offset:7168
  s_waitcnt lgkmcnt(6)
  v_mfma_f32_32x32x16_bf16 v[88:103], v[120:123], v[164:167], v[88:103]
  ds_read_b128 v[172:175], v19 offset:20480
  ds_read_b128 v[180:183], v23 offset:20480
  ds_read_b128 v[76:79], v64 offset:8192
  v_mfma_f32_32x32x16_bf16 v[140:155], v[156:159], v[164:167], v[140:155]
  buffer_load_dwordx4 v10, s[44:47], s52 offen offset:2048 lds
  ds_read_b128 v[80:83], v64 offset:9216
  v_mfma_f32_32x32x16_bf16 v[104:119], v[156:159], v[160:163], v[104:119]
  buffer_load_dwordx4 v11, s[44:47], s52 offen offset:3072 lds
  s_add_u32 s52, s52, 128
  s_and_b32 s52, s52, 0x7ff
  ds_read_b128 v[84:87], v64 offset:10240
  s_waitcnt vmcnt(16) lgkmcnt(3)
  s_barrier
  v_mfma_f32_32x32x16_bf16 v[40:55], v[168:171], v[176:179], v[40:55]
  ds_read_b128 v[120:123], v16 offset:32768
  ds_read_b128 v[160:163], v20 offset:32768
  ds_read_b128 v[132:135], v64 offset:11264
  v_mfma_f32_32x32x16_bf16 v[88:103], v[168:171], v[180:183], v[88:103]
  ds_read_b128 v[156:159], v16 offset:36864
  ds_read_b128 v[164:167], v20 offset:36864
  s_cmp_lg_u32 s3, 0
  s_cbranch_scc1 gated_mix__spectral_gfnet__ssm_conv_s5__prompt_kernel_skip16
  v_lshlrev_b32 v210, 2, v2
  v_add_u32 v211, 131072, v210
  ds_read_b32 v211, v211
  s_lshl_b32 s29, s39, 11
  s_lshl_b32 s58, s38, 7
  s_add_u32 s29, s29, s58
  s_mov_b64 exec, 0xffff
  s_waitcnt lgkmcnt(0)
  buffer_store_dword v211, v210, s[80:83], s29 offen sc1
  s_mov_b64 exec, -1
gated_mix__spectral_gfnet__ssm_conv_s5__prompt_kernel_skip16:
  buffer_load_dword v208, v6, s[24:27], 0 offen sc1
  ds_read_b128 a[240:243], v64 offset:12288
  v_mfma_f32_32x32x16_bf16 v[140:155], v[172:175], v[180:183], v[140:155]
  s_add_u32 m0, s55, 16384
  s_nop 0
  buffer_load_dwordx4 v12, s[48:51], s52 offen offset:0 lds
  ds_read_b128 a[244:247], v64 offset:13312
  v_mfma_f32_32x32x16_bf16 v[104:119], v[172:175], v[176:179], v[104:119]
  buffer_load_dwordx4 v13, s[48:51], s52 offen offset:1024 lds
  ds_read_b128 v[136:139], v64 offset:14336
  s_waitcnt lgkmcnt(6)
  v_mfma_f32_32x32x16_bf16 v[40:55], v[120:123], v[160:163], v[40:55]
  ds_read_b128 v[168:171], v17 offset:32768
  ds_read_b128 v[176:179], v21 offset:32768
  ds_read_b128 v[184:187], v64 offset:15360
  s_lshl_b32 s59, s3, 9
  s_waitcnt lgkmcnt(6)
  v_mfma_f32_32x32x16_bf16 v[88:103], v[120:123], v[164:167], v[88:103]
  ds_read_b128 v[172:175], v17 offset:36864
  ds_read_b128 v[180:183], v21 offset:36864
  s_add_u32 s59, s59, s5
  v_mfma_f32_32x32x16_bf16 v[140:155], v[156:159], v[164:167], v[140:155]
  buffer_load_dwordx4 v14, s[48:51], s52 offen offset:2048 lds
  s_lshr_b32 s87, s3, 1
  v_mfma_f32_32x32x16_bf16 v[104:119], v[156:159], v[160:163], v[104:119]
  buffer_load_dwordx4 v15, s[48:51], s52 offen offset:3072 lds
  s_and_b32 s87, s87, s10
  s_waitcnt lgkmcnt(3)
  v_mfma_f32_32x32x16_bf16 v[40:55], v[168:171], v[176:179], v[40:55]
  ds_read_b128 v[120:123], v18 offset:32768
  ds_read_b128 v[160:163], v22 offset:32768
  s_mul_i32 s87, s87, 960
  s_waitcnt lgkmcnt(2)
  v_mfma_f32_32x32x16_bf16 v[88:103], v[168:171], v[180:183], v[88:103]
  ds_read_b128 v[156:159], v18 offset:36864
  ds_read_b128 v[164:167], v22 offset:36864
  s_sub_u32 s87, s59, s87
  v_mfma_f32_32x32x16_bf16 v[140:155], v[172:175], v[180:183], v[140:155]
  s_add_u32 m0, s54, 16384
  s_nop 0
  buffer_load_dwordx4 v8, s[44:47], s52 offen offset:0 lds
  s_mul_i32 s59, s87, 1026
  v_mfma_f32_32x32x16_bf16 v[104:119], v[172:175], v[176:179], v[104:119]
  buffer_load_dwordx4 v9, s[44:47], s52 offen offset:1024 lds
  s_lshl1_add_u32 s59, s4, s59
  s_waitcnt lgkmcnt(2)
  v_mfma_f32_32x32x16_bf16 v[40:55], v[120:123], v[160:163], v[40:55]
  ds_read_b128 v[168:171], v19 offset:32768
  ds_read_b128 v[176:179], v23 offset:32768
  s_sub_u32 s6, 2101256, s59
  s_waitcnt lgkmcnt(2)
  v_mfma_f32_32x32x16_bf16 v[88:103], v[120:123], v[164:167], v[88:103]
  ds_read_b128 v[172:175], v19 offset:36864
  ds_read_b128 v[180:183], v23 offset:36864
  s_and_b32 s88, s59, 2
  v_mfma_f32_32x32x16_bf16 v[140:155], v[156:159], v[164:167], v[140:155]
  buffer_load_dwordx4 v10, s[44:47], s52 offen offset:2048 lds
  s_and_b32 s59, s59, -4
  v_mfma_f32_32x32x16_bf16 v[104:119], v[156:159], v[160:163], v[104:119]
  buffer_load_dwordx4 v11, s[44:47], s52 offen offset:3072 lds
  s_add_u32 s52, s52, 128
  s_and_b32 s52, s52, 0x7ff
  s_and_b32 s6, s6, -4
  s_waitcnt vmcnt(17) lgkmcnt(0)
  s_barrier
  v_mfma_f32_32x32x16_bf16 v[40:55], v[168:171], v[176:179], v[40:55]
  ds_read_b128 v[120:123], v16 offset:49152
  ds_read_b128 v[160:163], v20 offset:49152
  s_add_u32 s7, s59, 131328
  v_mfma_f32_32x32x16_bf16 v[88:103], v[168:171], v[180:183], v[88:103]
  ds_read_b128 v[156:159], v16 offset:53248
  ds_read_b128 v[164:167], v20 offset:53248
  s_sub_u32 s8, s6, 131328
  v_mfma_f32_32x32x16_bf16 v[140:155], v[172:175], v[180:183], v[140:155]
  s_add_u32 m0, s55, 32768
  s_nop 0
  buffer_load_dwordx4 v12, s[48:51], s52 offen offset:0 lds
  s_add_u32 s9, s59, 262656
  v_mfma_f32_32x32x16_bf16 v[104:119], v[172:175], v[176:179], v[104:119]
  buffer_load_dwordx4 v13, s[48:51], s52 offen offset:1024 lds
  s_sub_u32 s32, s6, 262656
  s_waitcnt lgkmcnt(2)
  v_mfma_f32_32x32x16_bf16 v[40:55], v[120:123], v[160:163], v[40:55]
  ds_read_b128 v[168:171], v17 offset:49152
  ds_read_b128 v[176:179], v21 offset:49152
  s_add_u32 s33, s59, 393984
  s_sub_u32 s84, s6, 393984
  s_waitcnt lgkmcnt(2)
  v_mfma_f32_32x32x16_bf16 v[88:103], v[120:123], v[164:167], v[88:103]
  ds_read_b128 v[172:175], v17 offset:53248
  ds_read_b128 v[180:183], v21 offset:53248
  s_cmp_eq_u32 s87, 0
  s_cselect_b32 s87, 2101248, 0
  s_cselect_b32 s86, s10, 0
  v_mfma_f32_32x32x16_bf16 v[140:155], v[156:159], v[164:167], v[140:155]
  buffer_load_dwordx4 v14, s[48:51], s52 offen offset:2048 lds
  v_mfma_f32_32x32x16_bf16 v[104:119], v[156:159], v[160:163], v[104:119]
  buffer_load_dwordx4 v15, s[48:51], s52 offen offset:3072 lds
  s_waitcnt lgkmcnt(2)
  v_mfma_f32_32x32x16_bf16 v[40:55], v[168:171], v[176:179], v[40:55]
  ds_read_b128 v[120:123], v18 offset:49152
  ds_read_b128 v[160:163], v22 offset:49152
  s_sub_u32 s6, s6, s87
  s_waitcnt lgkmcnt(2)
  v_mfma_f32_32x32x16_bf16 v[88:103], v[168:171], v[180:183], v[88:103]
  ds_read_b128 v[156:159], v18 offset:53248
  ds_read_b128 v[164:167], v22 offset:53248
  s_lshl_b32 s85, s3, 12
  v_mfma_f32_32x32x16_bf16 v[140:155], v[172:175], v[180:183], v[140:155]
  s_add_u32 m0, s54, 32768
  s_nop 0
  buffer_load_dwordx4 v8, s[44:47], s52 offen offset:0 lds
  s_add_u32 s88, s88, s85
  v_mfma_f32_32x32x16_bf16 v[104:119], v[172:175], v[176:179], v[104:119]
  buffer_load_dwordx4 v9, s[44:47], s52 offen offset:1024 lds
  v_lshlrev_b32 v64, 4, v1
  s_waitcnt lgkmcnt(2)
  v_mfma_f32_32x32x16_bf16 v[40:55], v[120:123], v[160:163], v[40:55]
  ds_read_b128 v[168:171], v19 offset:49152
  ds_read_b128 v[176:179], v23 offset:49152
  v_lshlrev_b32 v65, 9, v3
  s_waitcnt lgkmcnt(2)
  v_mfma_f32_32x32x16_bf16 v[88:103], v[120:123], v[164:167], v[88:103]
  ds_read_b128 v[172:175], v19 offset:53248
  ds_read_b128 v[180:183], v23 offset:53248
  v_lshl_add_u32 v65, v2, 3, v65
  v_mfma_f32_32x32x16_bf16 v[140:155], v[156:159], v[164:167], v[140:155]
  buffer_load_dwordx4 v10, s[44:47], s52 offen offset:2048 lds
  v_sub_u32 v67, 3704, v65
  v_mfma_f32_32x32x16_bf16 v[104:119], v[156:159], v[160:163], v[104:119]
  buffer_load_dwordx4 v11, s[44:47], s52 offen offset:3072 lds
  s_add_u32 s52, s52, 128
  s_and_b32 s52, s52, 0x7ff
  v_cmp_lt_u32 vcc, 1, v3
  s_waitcnt vmcnt(17) lgkmcnt(0)
  s_barrier
  v_mfma_f32_32x32x16_bf16 v[40:55], v[168:171], v[176:179], v[40:55]
  ds_read_b128 v[120:123], v16 offset:0
  ds_read_b128 v[160:163], v20 offset:0
  v_cndmask_b32 v65, v65, v67, vcc
  v_mfma_f32_32x32x16_bf16 v[88:103], v[168:171], v[180:183], v[88:103]
  ds_read_b128 v[156:159], v16 offset:4096
  ds_read_b128 v[164:167], v20 offset:4096
  v_cndmask_b32 v66, 1.0, -1.0, vcc
  v_mfma_f32_32x32x16_bf16 v[140:155], v[172:175], v[180:183], v[140:155]
  s_add_u32 m0, s55, 49152
  s_nop 0
  buffer_load_dwordx4 v12, s[48:51], s52 offen offset:0 lds
  v_add_u32 v65, s88, v65
  v_mfma_f32_32x32x16_bf16 v[104:119], v[172:175], v[176:179], v[104:119]
  buffer_load_dwordx4 v13, s[48:51], s52 offen offset:1024 lds
  v_mov_b32 v188, 1050624
  s_waitcnt lgkmcnt(2)
  v_mfma_f32_32x32x16_bf16 v[40:55], v[120:123], v[160:163], v[40:55]
  ds_read_b128 v[168:171], v17 offset:0
  ds_read_b128 v[176:179], v21 offset:0
  v_mov_b32 v189, 147456
  s_cmp_lg_u32 s4, 0
  s_cbranch_scc1 gated_mix__spectral_gfnet__ssm_conv_s5__prompt_kernel_skip13
  s_sub_u32 s87, s6, 8
  v_writelane_b32 v188, s87, 0
  v_writelane_b32 v188, s59, 1
  s_mov_b32 s87, 0
  v_writelane_b32 v189, s87, 0
  v_writelane_b32 v189, s87, 1
  s_sub_u32 s87, s8, 8
  v_writelane_b32 v188, s87, 2
  v_writelane_b32 v188, s7, 3
  s_mov_b32 s87, 16384
  v_writelane_b32 v189, s87, 2
  v_writelane_b32 v189, s87, 3
  s_sub_u32 s87, s32, 8
  v_writelane_b32 v188, s87, 4
  v_writelane_b32 v188, s9, 5
  s_mov_b32 s87, 81920
  v_writelane_b32 v189, s87, 4
  v_writelane_b32 v189, s87, 5
  s_sub_u32 s87, s84, 8
  v_writelane_b32 v188, s87, 6
  v_writelane_b32 v188, s33, 7
  s_mov_b32 s87, 32768
  v_writelane_b32 v189, s87, 6
  v_writelane_b32 v189, s87, 7
  v_and_b32 v67, 1, v1
  v_lshl_add_u32 v188, v67, 10, v188
  s_and_b32 s87, s88, 2
  v_add_u32 v188, s87, v188
  v_mul_u32_u24 v67, 3064, v67
  v_add3_u32 v189, v189, v67, s88
gated_mix__spectral_gfnet__ssm_conv_s5__prompt_kernel_skip13:
  s_waitcnt lgkmcnt(2)
  v_mfma_f32_32x32x16_bf16 v[88:103], v[120:123], v[164:167], v[88:103]
  ds_read_b128 v[172:175], v17 offset:4096
  ds_read_b128 v[180:183], v21 offset:4096
  v_mfma_f32_32x32x16_bf16 v[140:155], v[156:159], v[164:167], v[140:155]
  buffer_load_dwordx4 v14, s[48:51], s52 offen offset:2048 lds
  v_mfma_f32_32x32x16_bf16 v[104:119], v[156:159], v[160:163], v[104:119]
  buffer_load_dwordx4 v15, s[48:51], s52 offen offset:3072 lds
  s_waitcnt lgkmcnt(2)
  v_mfma_f32_32x32x16_bf16 v[40:55], v[168:171], v[176:179], v[40:55]
  ds_read_b128 v[120:123], v18 offset:0
  ds_read_b128 v[160:163], v22 offset:0
  s_waitcnt lgkmcnt(2)
  v_mfma_f32_32x32x16_bf16 v[88:103], v[168:171], v[180:183], v[88:103]
  ds_read_b128 v[156:159], v18 offset:4096
  ds_read_b128 v[164:167], v22 offset:4096
  v_mfma_f32_32x32x16_bf16 v[140:155], v[172:175], v[180:183], v[140:155]
  s_add_u32 m0, s54, 49152
  s_nop 0
  buffer_load_dwordx4 v8, s[44:47], s52 offen offset:0 lds
  v_mfma_f32_32x32x16_bf16 v[104:119], v[172:175], v[176:179], v[104:119]
  buffer_load_dwordx4 v9, s[44:47], s52 offen offset:1024 lds
  s_waitcnt lgkmcnt(2)
  v_mfma_f32_32x32x16_bf16 v[40:55], v[120:123], v[160:163], v[40:55]
  ds_read_b128 v[168:171], v19 offset:0
  ds_read_b128 v[176:179], v23 offset:0
  s_waitcnt lgkmcnt(2)
  v_mfma_f32_32x32x16_bf16 v[88:103], v[120:123], v[164:167], v[88:103]
  ds_read_b128 v[172:175], v19 offset:4096
  ds_read_b128 v[180:183], v23 offset:4096
  v_mfma_f32_32x32x16_bf16 v[140:155], v[156:159], v[164:167], v[140:155]
  buffer_load_dwordx4 v10, s[44:47], s52 offen offset:2048 lds
  v_mfma_f32_32x32x16_bf16 v[104:119], v[156:159], v[160:163], v[104:119]
  buffer_load_dwordx4 v11, s[44:47], s52 offen offset:3072 lds
  s_add_u32 s52, s52, 128
  s_and_b32 s52, s52, 0x7ff
  s_waitcnt vmcnt(25)
  s_waitcnt vmcnt(16) lgkmcnt(0)
  s_barrier
  v_mfma_f32_32x32x16_bf16 v[40:55], v[168:171], v[176:179], v[40:55]
  ds_read_b128 v[120:123], v16 offset:16384
  ds_read_b128 v[160:163], v20 offset:16384
  v_mfma_f32_32x32x16_bf16 v[88:103], v[168:171], v[180:183], v[88:103]
  ds_read_b128 v[156:159], v16 offset:20480
  ds_read_b128 v[164:167], v20 offset:20480
  v_cmp_ne_u32 vcc, 1, v208
  s_nop 0
  s_cbranch_vccz gated_mix__spectral_gfnet__ssm_conv_s5__prompt_kernel_skip17
  s_mov_b32 s29, 0
gated_mix__spectral_gfnet__ssm_conv_s5__prompt_kernel_poll18:
  s_sleep 16
  buffer_load_dword v208, v6, s[24:27], 0 offen sc1
  s_waitcnt vmcnt(0)
  v_cmp_ne_u32 vcc, 1, v208
  s_nop 0
  s_cbranch_vccz gated_mix__spectral_gfnet__ssm_conv_s5__prompt_kernel_pollout19
  s_add_u32 s29, s29, 1
  s_cmp_lt_u32 s29, 1048576
  s_cbranch_scc1 gated_mix__spectral_gfnet__ssm_conv_s5__prompt_kernel_poll18
gated_mix__spectral_gfnet__ssm_conv_s5__prompt_kernel_pollout19:
gated_mix__spectral_gfnet__ssm_conv_s5__prompt_kernel_skip17:
  s_cmp_lg_u32 s3, 0
  s_cbranch_scc1 gated_mix__spectral_gfnet__ssm_conv_s5__prompt_kernel_skip20
  s_mov_b64 exec, 1
  buffer_store_dword v5, v38, s[16:19], 0 offen sc1
  s_mov_b64 exec, -1
gated_mix__spectral_gfnet__ssm_conv_s5__prompt_kernel_skip20:
  v_mfma_f32_32x32x16_bf16 v[140:155], v[172:175], v[180:183], v[140:155]
  s_add_u32 m0, s55, 0
  s_nop 0
  buffer_load_dwordx4 v12, s[48:51], s52 offen offset:0 lds
  v_mfma_f32_32x32x16_bf16 v[104:119], v[172:175], v[176:179], v[104:119]
  buffer_load_dwordx4 v13, s[48:51], s52 offen offset:1024 lds
  s_waitcnt lgkmcnt(2)
  v_mfma_f32_32x32x16_bf16 v[40:55], v[120:123], v[160:163], v[40:55]
  ds_read_b128 v[168:171], v17 offset:16384
  ds_read_b128 v[176:179], v21 offset:16384
  s_waitcnt lgkmcnt(2)
  v_mfma_f32_32x32x16_bf16 v[88:103], v[120:123], v[164:167], v[88:103]
  ds_read_b128 v[172:175], v17 offset:20480
  ds_read_b128 v[180:183], v21 offset:20480
  v_mfma_f32_32x32x16_bf16 v[140:155], v[156:159], v[164:167], v[140:155]
  buffer_load_dwordx4 v14, s[48:51], s52 offen offset:2048 lds
  v_mfma_f32_32x32x16_bf16 v[104:119], v[156:159], v[160:163], v[104:119]
  buffer_load_dwordx4 v15, s[48:51], s52 offen offset:3072 lds
  s_waitcnt lgkmcnt(2)
  v_mfma_f32_32x32x16_bf16 v[40:55], v[168:171], v[176:179], v[40:55]
  ds_read_b128 v[120:123], v18 offset:16384
  ds_read_b128 v[160:163], v22 offset:16384
  s_waitcnt lgkmcnt(2)
  v_mfma_f32_32x32x16_bf16 v[88:103], v[168:171], v[180:183], v[88:103]
  ds_read_b128 v[156:159], v18 offset:20480
  ds_read_b128 v[164:167], v22 offset:20480
  v_mfma_f32_32x32x16_bf16 v[140:155], v[172:175], v[180:183], v[140:155]
  s_add_u32 m0, s54, 0
  s_nop 0
  buffer_load_dwordx4 v8, s[44:47], s52 offen offset:0 lds
  v_mfma_f32_32x32x16_bf16 v[104:119], v[172:175], v[176:179], v[104:119]
  buffer_load_dwordx4 v9, s[44:47], s52 offen offset:1024 lds
  s_waitcnt lgkmcnt(2)
  v_mfma_f32_32x32x16_bf16 v[40:55], v[120:123], v[160:163], v[40:55]
  ds_read_b128 v[168:171], v19 offset:16384
  ds_read_b128 v[176:179], v23 offset:16384
  s_waitcnt lgkmcnt(2)
  v_mfma_f32_32x32x16_bf16 v[88:103], v[120:123], v[164:167], v[88:103]
  ds_read_b128 v[172:175], v19 offset:20480
  ds_read_b128 v[180:183], v23 offset:20480
  v_mfma_f32_32x32x16_bf16 v[140:155], v[156:159], v[164:167], v[140:155]
  buffer_load_dwordx4 v10, s[44:47], s52 offen offset:2048 lds
  v_mfma_f32_32x32x16_bf16 v[104:119], v[156:159], v[160:163], v[104:119]
  buffer_load_dwordx4 v11, s[44:47], s52 offen offset:3072 lds
  s_add_u32 s52, s52, 128
  s_and_b32 s52, s52, 0x7ff
  s_waitcnt vmcnt(16) lgkmcnt(0)
  s_barrier
  v_mfma_f32_32x32x16_bf16 v[40:55], v[168:171], v[176:179], v[40:55]
  ds_read_b128 v[120:123], v16 offset:32768
  ds_read_b128 v[160:163], v20 offset:32768
  v_mfma_f32_32x32x16_bf16 v[88:103], v[168:171], v[180:183], v[88:103]
  ds_read_b128 v[156:159], v16 offset:36864
  ds_read_b128 v[164:167], v20 offset:36864
  v_mfma_f32_32x32x16_bf16 v[140:155], v[172:175], v[180:183], v[140:155]
  s_add_u32 m0, s55, 16384
  s_nop 0
  buffer_load_dwordx4 v12, s[48:51], s52 offen offset:0 lds
  v_mfma_f32_32x32x16_bf16 v[104:119], v[172:175], v[176:179], v[104:119]
  buffer_load_dwordx4 v13, s[48:51], s52 offen offset:1024 lds
  s_waitcnt lgkmcnt(2)
  v_mfma_f32_32x32x16_bf16 v[40:55], v[120:123], v[160:163], v[40:55]
  ds_read_b128 v[168:171], v17 offset:32768
  ds_read_b128 v[176:179], v21 offset:32768
  v_lshlrev_b32 v56, 16, v56
  v_lshlrev_b32 v57, 16, v57
  s_waitcnt lgkmcnt(2)
  v_mfma_f32_32x32x16_bf16 v[88:103], v[120:123], v[164:167], v[88:103]
  ds_read_b128 v[172:175], v17 offset:36864
  ds_read_b128 v[180:183], v21 offset:36864
  v_lshlrev_b32 v58, 16, v58
  v_mfma_f32_32x32x16_bf16 v[140:155], v[156:159], v[164:167], v[140:155]
  buffer_load_dwordx4 v14, s[48:51], s52 offen offset:2048 lds
  v_mul_f32 v58, 0x3fb8aa3b, v58
  v_mfma_f32_32x32x16_bf16 v[104:119], v[156:159], v[160:163], v[104:119]
  buffer_load_dwordx4 v15, s[48:51], s52 offen offset:3072 lds
  v_exp_f32 v58, v58
  s_waitcnt lgkmcnt(2)
  v_mfma_f32_32x32x16_bf16 v[40:55], v[168:171], v[176:179], v[40:55]
  ds_read_b128 v[120:123], v18 offset:32768
  ds_read_b128 v[160:163], v22 offset:32768
  v_cvt_pk_bf16_f32 v58, v58, v58
  s_waitcnt lgkmcnt(2)
  v_mfma_f32_32x32x16_bf16 v[88:103], v[168:171], v[180:183], v[88:103]
  ds_read_b128 v[156:159], v18 offset:36864
  ds_read_b128 v[164:167], v22 offset:36864
  v_and_b32 v58, 0xffff0000, v58
  v_mul_f32 v204, v58, v56
  v_mfma_f32_32x32x16_bf16 v[140:155], v[172:175], v[180:183], v[140:155]
  s_add_u32 m0, s54, 16384
  s_nop 0
  buffer_load_dwordx4 v8, s[44:47], s52 offen offset:0 lds
  v_mul_f32 v205, v58, v57
  v_mfma_f32_32x32x16_bf16 v[104:119], v[172:175], v[176:179], v[104:119]
  buffer_load_dwordx4 v9, s[44:47], s52 offen offset:1024 lds
  v_mul_f32 v204, 0x3fb8aa3b, v204
  s_waitcnt lgkmcnt(2)
  v_mfma_f32_32x32x16_bf16 v[40:55], v[120:123], v[160:163], v[40:55]
  ds_read_b128 v[168:171], v19 offset:32768
  ds_read_b128 v[176:179], v23 offset:32768
  v_mul_f32 v205, 0.15915494, v205
  s_waitcnt lgkmcnt(2)
  v_mfma_f32_32x32x16_bf16 v[88:103], v[120:123], v[164:167], v[88:103]
  ds_read_b128 v[172:175], v19 offset:36864
  ds_read_b128 v[180:183], v23 offset:36864
  v_exp_f32 v204, v204
  v_mfma_f32_32x32x16_bf16 v[140:155], v[156:159], v[164:167], v[140:155]
  buffer_load_dwordx4 v10, s[44:47], s52 offen offset:2048 lds
  v_rndne_f32 v206, v205
  v_sub_f32 v205, v205, v206
  v_mfma_f32_32x32x16_bf16 v[104:119], v[156:159], v[160:163], v[104:119]
  buffer_load_dwordx4 v11, s[44:47], s52 offen offset:3072 lds
  s_add_u32 s52, s52, 128
  s_and_b32 s52, s52, 0x7ff
  v_cos_f32 v206, v205
  s_waitcnt vmcnt(16) lgkmcnt(0)
  s_barrier
  v_mfma_f32_32x32x16_bf16 v[40:55], v[168:171], v[176:179], v[40:55]
  ds_read_b128 v[120:123], v16 offset:49152
  ds_read_b128 v[160:163], v20 offset:49152
  v_sin_f32 v207, v205
  v_mfma_f32_32x32x16_bf16 v[88:103], v[168:171], v[180:183], v[88:103]
  ds_read_b128 v[156:159], v16 offset:53248
  ds_read_b128 v[164:167], v20 offset:53248
  s_lshl_b32 s29, s36, 2
  s_add_u32 s29, s29, s3
  s_lshl_b32 s29, s29, 7
  s_add_u32 s29, s29, s37
  s_sub_u32 s58, 2048, s29
  s_and_b32 s58, s58, 2047
  s_mul_i32 s29, s29, 1026
  s_mul_i32 s58, s58, 1026
  s_sub_u32 s58, s58, s29
  v_and_b32 v208, 1, v3
  v_mul_lo_u32 v208, v208, s58
  v_lshl_add_u32 v59, v2, 7, s29
  v_add_u32 v59, v59, v208
  v_and_b32 v59, -4, v59
  s_mov_b64 exec, 0x01ff01ff
  buffer_load_dword v4, v59, s[20:23], 0 offen
  buffer_load_dword v4, v59, s[76:79], 0 offen offset:1024
  s_mov_b64 exec, -1
  v_mul_f32 v190, v204, v206
  v_mfma_f32_32x32x16_bf16 v[140:155], v[172:175], v[180:183], v[140:155]
  s_add_u32 m0, s55, 32768
  s_nop 0
  buffer_load_dwordx4 v12, s[48:51], s52 offen offset:0 lds
  v_mul_f32 v191, v204, v207
  v_mfma_f32_32x32x16_bf16 v[104:119], v[172:175], v[176:179], v[104:119]
  buffer_load_dwordx4 v13, s[48:51], s52 offen offset:1024 lds
  v_mul_f32 v204, v56, v56
  s_waitcnt lgkmcnt(2)
  v_mfma_f32_32x32x16_bf16 v[40:55], v[120:123], v[160:163], v[40:55]
  ds_read_b128 v[168:171], v17 offset:49152
  ds_read_b128 v[176:179], v21 offset:49152
  v_fma_f32 v204, v57, v57, v204
  v_rcp_f32 v204, v204
  s_waitcnt lgkmcnt(2)
  v_mfma_f32_32x32x16_bf16 v[88:103], v[120:123], v[164:167], v[88:103]
  ds_read_b128 v[172:175], v17 offset:53248
  ds_read_b128 v[180:183], v21 offset:53248
  v_add_f32 v205, -1.0, v190
  v_mfma_f32_32x32x16_bf16 v[140:155], v[156:159], v[164:167], v[140:155]
  buffer_load_dwordx4 v14, s[48:51], s52 offen offset:2048 lds
  v_add_f32 v204, v204, v204
  v_mfma_f32_32x32x16_bf16 v[104:119], v[156:159], v[160:163], v[104:119]
  buffer_load_dwordx4 v15, s[48:51], s52 offen offset:3072 lds
  v_mul_f32 v206, v205, v56
  s_waitcnt lgkmcnt(2)
  v_mfma_f32_32x32x16_bf16 v[40:55], v[168:171], v[176:179], v[40:55]
  ds_read_b128 v[120:123], v18 offset:49152
  ds_read_b128 v[160:163], v22 offset:49152
  v_fma_f32 v206, v191, v57, v206
  s_waitcnt lgkmcnt(2)
  v_mfma_f32_32x32x16_bf16 v[88:103], v[168:171], v[180:183], v[88:103]
  ds_read_b128 v[156:159], v18 offset:53248
  ds_read_b128 v[164:167], v22 offset:53248
  v_mul_f32 v207, v191, v56
  v_fma_f32 v207, -v205, v57, v207
  v_mfma_f32_32x32x16_bf16 v[140:155], v[172:175], v[180:183], v[140:155]
  s_add_u32 m0, s54, 32768
  s_nop 0
  buffer_load_dwordx4 v8, s[44:47], s52 offen offset:0 lds
  v_mul_f32 v200, v206, v204
  v_mfma_f32_32x32x16_bf16 v[104:119], v[172:175], v[176:179], v[104:119]
  buffer_load_dwordx4 v9, s[44:47], s52 offen offset:1024 lds
  v_mul_f32 v201, v207, v204
  s_waitcnt lgkmcnt(2)
  v_mfma_f32_32x32x16_bf16 v[40:55], v[120:123], v[160:163], v[40:55]
  ds_read_b128 v[168:171], v19 offset:49152
  ds_read_b128 v[176:179], v23 offset:49152
  v_mul_f32 v204, v191, v191
  s_waitcnt lgkmcnt(2)
  v_mfma_f32_32x32x16_bf16 v[88:103], v[120:123], v[164:167], v[88:103]
  ds_read_b128 v[172:175], v19 offset:53248
  ds_read_b128 v[180:183], v23 offset:53248
  v_mul_f32 v193, v190, v191
  v_mfma_f32_32x32x16_bf16 v[140:155], v[156:159], v[164:167], v[140:155]
  buffer_load_dwordx4 v10, s[44:47], s52 offen offset:2048 lds
  v_fma_f32 v192, v190, v190, -v204
  v_add_f32 v193, v193, v193
  v_mfma_f32_32x32x16_bf16 v[104:119], v[156:159], v[160:163], v[104:119]
  buffer_load_dwordx4 v11, s[44:47], s52 offen offset:3072 lds
  s_add_u32 s52, s52, 128
  s_and_b32 s52, s52, 0x7ff
  v_mul_f32 v204, v193, v193
  s_waitcnt vmcnt(18) lgkmcnt(0)
  s_barrier
  v_mfma_f32_32x32x16_bf16 v[40:55], v[168:171], v[176:179], v[40:55]
  ds_read_b128 v[120:123], v16 offset:0
  ds_read_b128 v[160:163], v20 offset:0
  v_mul_f32 v193, v192, v193
  v_mfma_f32_32x32x16_bf16 v[88:103], v[168:171], v[180:183], v[88:103]
  ds_read_b128 v[156:159], v16 offset:4096
  ds_read_b128 v[164:167], v20 offset:4096
  s_cmp_lg_u32 s3, 2
  s_cbranch_scc1 gated_mix__spectral_gfnet__ssm_conv_s5__prompt_kernel_skip22
  s_getpc_b64 s[90:91]
gated_mix__spectral_gfnet__ssm_conv_s5__prompt_kernel_pc21:
  s_lshr_b32 s29, s2, 3
  s_mul_i32 s29, s29, 512
  v_min_u32 v210, 3, v1
  v_lshl_add_u32 v210, v210, 7, s29
  v_min_u32 v210, gated_mix__spectral_gfnet__ssm_conv_s5__prompt_kernel_end-gated_mix__spectral_gfnet__ssm_conv_s5__prompt_kernel_pc21, v210
  v_mov_b32 v211, 0
  v_lshl_add_u64 v[210:211], v[210:211], 0, s[90:91]
  global_load_dword v4, v[210:211], off
gated_mix__spectral_gfnet__ssm_conv_s5__prompt_kernel_skip22:
  v_fma_f32 v192, v192, v192, -v204
  v_mfma_f32_32x32x16_bf16 v[140:155], v[172:175], v[180:183], v[140:155]
  s_add_u32 m0, s55, 49152
  s_nop 0
  buffer_load_dwordx4 v12, s[48:51], s52 offen offset:0 lds
  v_add_f32 v193, v193, v193
  v_mfma_f32_32x32x16_bf16 v[104:119], v[172:175], v[176:179], v[104:119]
  buffer_load_dwordx4 v13, s[48:51], s52 offen offset:1024 lds
  v_mul_f32 v204, v193, v193
  s_waitcnt lgkmcnt(2)
  v_mfma_f32_32x32x16_bf16 v[40:55], v[120:123], v[160:163], v[40:55]
  ds_read_b128 v[168:171], v17 offset:0
  ds_read_b128 v[176:179], v21 offset:0
  v_mul_f32 v193, v192, v193
  v_fma_f32 v192, v192, v192, -v204
  s_waitcnt lgkmcnt(2)
  v_mfma_f32_32x32x16_bf16 v[88:103], v[120:123], v[164:167], v[88:103]
  ds_read_b128 v[172:175], v17 offset:4096
  ds_read_b128 v[180:183], v21 offset:4096
  v_add_f32 v193, v193, v193
  v_mfma_f32_32x32x16_bf16 v[140:155], v[156:159], v[164:167], v[140:155]
  buffer_load_dwordx4 v14, s[48:51], s52 offen offset:2048 lds
  v_mul_f32 v204, v193, v193
  v_mfma_f32_32x32x16_bf16 v[104:119], v[156:159], v[160:163], v[104:119]
  buffer_load_dwordx4 v15, s[48:51], s52 offen offset:3072 lds
  v_mul_f32 v193, v192, v193
  s_waitcnt lgkmcnt(2)
  v_mfma_f32_32x32x16_bf16 v[40:55], v[168:171], v[176:179], v[40:55]
  ds_read_b128 v[120:123], v18 offset:0
  ds_read_b128 v[160:163], v22 offset:0
  v_fma_f32 v192, v192, v192, -v204
  s_waitcnt lgkmcnt(2)
  v_mfma_f32_32x32x16_bf16 v[88:103], v[168:171], v[180:183], v[88:103]
  ds_read_b128 v[156:159], v18 offset:4096
  ds_read_b128 v[164:167], v22 offset:4096
  v_add_f32 v193, v193, v193
  v_mul_f32 v204, v193, v193
  v_mfma_f32_32x32x16_bf16 v[140:155], v[172:175], v[180:183], v[140:155]
  s_add_u32 m0, s54, 49152
  s_nop 0
  buffer_load_dwordx4 v8, s[44:47], s52 offen offset:0 lds
  v_mul_f32 v195, v192, v193
  v_mfma_f32_32x32x16_bf16 v[104:119], v[172:175], v[176:179], v[104:119]
  buffer_load_dwordx4 v9, s[44:47], s52 offen offset:1024 lds
  v_fma_f32 v194, v192, v192, -v204
  s_waitcnt lgkmcnt(2)
  v_mfma_f32_32x32x16_bf16 v[40:55], v[120:123], v[160:163], v[40:55]
  ds_read_b128 v[168:171], v19 offset:0
  ds_read_b128 v[176:179], v23 offset:0
  v_add_f32 v195, v195, v195
  s_waitcnt lgkmcnt(2)
  v_mfma_f32_32x32x16_bf16 v[88:103], v[120:123], v[164:167], v[88:103]
  ds_read_b128 v[172:175], v19 offset:4096
  ds_read_b128 v[180:183], v23 offset:4096
  v_mul_f32 v204, v195, v195
  v_mfma_f32_32x32x16_bf16 v[140:155], v[156:159], v[164:167], v[140:155]
  buffer_load_dwordx4 v10, s[44:47], s52 offen offset:2048 lds
  v_mul_f32 v197, v194, v195
  v_fma_f32 v196, v194, v194, -v204
  v_mfma_f32_32x32x16_bf16 v[104:119], v[156:159], v[160:163], v[104:119]
  buffer_load_dwordx4 v11, s[44:47], s52 offen offset:3072 lds
  s_add_u32 s52, s52, 128
  s_and_b32 s52, s52, 0x7ff
  v_add_f32 v197, v197, v197
  s_waitcnt vmcnt(18) lgkmcnt(0)
  s_barrier
  v_mfma_f32_32x32x16_bf16 v[40:55], v[168:171], v[176:179], v[40:55]
  ds_read_b128 v[120:123], v16 offset:16384
  ds_read_b128 v[160:163], v20 offset:16384
  v_mul_f32 v204, v197, v197
  v_mfma_f32_32x32x16_bf16 v[88:103], v[168:171], v[180:183], v[88:103]
  ds_read_b128 v[156:159], v16 offset:20480
  ds_read_b128 v[164:167], v20 offset:20480
  v_mul_f32 v203, v196, v197
  v_mfma_f32_32x32x16_bf16 v[140:155], v[172:175], v[180:183], v[140:155]
  buffer_load_dword v209, v7, s[16:19], 0 offen sc1
  s_cmp_eq_u32 s86, 0
  s_cbranch_scc1 gated_mix__spectral_gfnet__ssm_conv_s5__prompt_kernel_skip23
  s_add_u32 s29, s59, 1050624
  s_mov_b32 m0, 147456
  s_nop 0
  buffer_load_dwordx4 v64, s[20:23], s29 offen lds
  buffer_load_dwordx4 v64, s[76:79], s29 offen offset:1024 lds
  s_add_u32 s29, s6, 1050624
  s_mov_b32 m0, 149504
  s_nop 0
  buffer_load_dwordx4 v64, s[20:23], s29 offen lds
  buffer_load_dwordx4 v64, s[76:79], s29 offen offset:1024 lds
gated_mix__spectral_gfnet__ssm_conv_s5__prompt_kernel_skip23:
  s_cmp_lg_u32 s4, 0
  s_cbranch_scc1 gated_mix__spectral_gfnet__ssm_conv_s5__prompt_kernel_skip24
  s_mov_b64 exec, 0x3ff
  buffer_load_short_d16_hi v210, v188, s[20:23], 0 offen
  buffer_load_short_d16_hi v211, v188, s[76:79], 0 offen offset:1024
  s_mov_b64 exec, -1
gated_mix__spectral_gfnet__ssm_conv_s5__prompt_kernel_skip24:
  v_fma_f32 v202, v196, v196, -v204
  v_mfma_f32_32x32x16_bf16 v[104:119], v[172:175], v[176:179], v[104:119]
  s_add_u32 m0, s43, 131072
  s_nop 0
  buffer_load_dwordx4 v124, s[68:71], s28 offen offset:0 lds
  v_add_f32 v203, v203, v203
  s_waitcnt lgkmcnt(2)
  v_mfma_f32_32x32x16_bf16 v[40:55], v[120:123], v[160:163], v[40:55]
  ds_read_b128 v[168:171], v17 offset:16384
  ds_read_b128 v[176:179], v21 offset:16384
  v_mul_f32 v204, v203, v203
  v_mul_f32 v199, v202, v203
  s_waitcnt lgkmcnt(2)
  v_mfma_f32_32x32x16_bf16 v[88:103], v[120:123], v[164:167], v[88:103]
  ds_read_b128 v[172:175], v17 offset:20480
  ds_read_b128 v[180:183], v21 offset:20480
  v_fma_f32 v198, v202, v202, -v204
  v_mfma_f32_32x32x16_bf16 v[140:155], v[156:159], v[164:167], v[140:155]
  buffer_load_dwordx4 v125, s[68:71], s28 offen offset:1024 lds
  v_add_f32 v199, v199, v199
  v_mfma_f32_32x32x16_bf16 v[104:119], v[156:159], v[160:163], v[104:119]
  s_add_u32 m0, s43, 133120
  s_nop 0
  buffer_load_dwordx4 v126, s[68:71], s28 offen offset:0 lds
  v_mul_f32 v204, v199, v199
  s_waitcnt lgkmcnt(2)
  v_mfma_f32_32x32x16_bf16 v[40:55], v[168:171], v[176:179], v[40:55]
  ds_read_b128 v[120:123], v18 offset:16384
  ds_read_b128 v[160:163], v22 offset:16384
  v_mul_f32 v199, v198, v199
  s_waitcnt lgkmcnt(2)
  v_mfma_f32_32x32x16_bf16 v[88:103], v[168:171], v[180:183], v[88:103]
  ds_read_b128 v[156:159], v18 offset:20480
  ds_read_b128 v[164:167], v22 offset:20480
  v_fma_f32 v198, v198, v198, -v204
  v_add_f32 v199, v199, v199
  v_mfma_f32_32x32x16_bf16 v[140:155], v[172:175], v[180:183], v[140:155]
  buffer_load_dwordx4 v127, s[68:71], s28 offen offset:1024 lds
  v_mul_f32 v204, v199, v199
  v_mfma_f32_32x32x16_bf16 v[104:119], v[172:175], v[176:179], v[104:119]
  s_add_u32 m0, s43, 65536
  s_nop 0
  buffer_load_dwordx4 v124, s[72:75], s28 offen offset:0 lds
  v_mul_f32 v199, v198, v199
  s_waitcnt lgkmcnt(2)
  v_mfma_f32_32x32x16_bf16 v[40:55], v[120:123], v[160:163], v[40:55]
  ds_read_b128 v[168:171], v19 offset:16384
  ds_read_b128 v[176:179], v23 offset:16384
  v_fma_f32 v198, v198, v198, -v204
  s_waitcnt lgkmcnt(2)
  v_mfma_f32_32x32x16_bf16 v[88:103], v[120:123], v[164:167], v[88:103]
  ds_read_b128 v[172:175], v19 offset:20480
  ds_read_b128 v[180:183], v23 offset:20480
  v_add_f32 v199, v199, v199
  v_mfma_f32_32x32x16_bf16 v[140:155], v[156:159], v[164:167], v[140:155]
  buffer_load_dwordx4 v125, s[72:75], s28 offen offset:1024 lds
  v_lshlrev_b32 v56, 3, v0
  v_add_u32 v56, 151552, v56
  v_mfma_f32_32x32x16_bf16 v[104:119], v[156:159], v[160:163], v[104:119]
  s_add_u32 m0, s43, 67584
  s_nop 0
  buffer_load_dwordx4 v126, s[72:75], s28 offen offset:0 lds
  s_sub_u32 s87, 15, s38
  s_waitcnt vmcnt(16) lgkmcnt(0)
  s_barrier
  v_mfma_f32_32x32x16_bf16 v[40:55], v[168:171], v[176:179], v[40:55]
  ds_read_b128 v[120:123], v16 offset:32768
  ds_read_b128 v[160:163], v20 offset:32768
  s_lshl_b32 s87, s87, 9
  v_mfma_f32_32x32x16_bf16 v[88:103], v[168:171], v[180:183], v[88:103]
  ds_read_b128 v[156:159], v16 offset:36864
  ds_read_b128 v[164:167], v20 offset:36864
  s_and_b32 s88, s3, 1
  v_mfma_f32_32x32x16_bf16 v[140:155], v[172:175], v[180:183], v[140:155]
  buffer_load_dwordx4 v127, s[72:75], s28 offen offset:1024 lds
  s_add_u32 s28, s28, 128
  s_and_b32 s28, s28, 0x3ff
  s_lshl_b32 s88, s88, 8
  v_mfma_f32_32x32x16_bf16 v[104:119], v[172:175], v[176:179], v[104:119]
  s_add_u32 s87, s87, s88
  s_waitcnt lgkmcnt(2)
  v_mfma_f32_32x32x16_bf16 v[40:55], v[120:123], v[160:163], v[40:55]
  ds_read_b128 v[168:171], v17 offset:32768
  ds_read_b128 v[176:179], v21 offset:32768
  v_and_b32 v57, 31, v1
  v_lshl_add_u32 v57, v57, 3, s87
  s_waitcnt lgkmcnt(2)
  v_mfma_f32_32x32x16_bf16 v[88:103], v[120:123], v[164:167], v[88:103]
  ds_read_b128 v[172:175], v17 offset:36864
  ds_read_b128 v[180:183], v21 offset:36864
  s_lshl_b32 s88, s38, 1
  v_mfma_f32_32x32x16_bf16 v[140:155], v[156:159], v[164:167], v[140:155]
  s_lshr_b32 s89, s3, 1
  v_mfma_f32_32x32x16_bf16 v[104:119], v[156:159], v[160:163], v[104:119]
  s_add_u32 s88, s88, s89
  s_waitcnt lgkmcnt(2)
  v_mfma_f32_32x32x16_bf16 v[40:55], v[168:171], v[176:179], v[40:55]
  ds_read_b128 v[120:123], v18 offset:32768
  ds_read_b128 v[160:163], v22 offset:32768
  s_lshl_b32 s87, s88, 9
  s_waitcnt lgkmcnt(2)
  v_mfma_f32_32x32x16_bf16 v[88:103], v[168:171], v[180:183], v[88:103]
  ds_read_b128 v[156:159], v18 offset:36864
  ds_read_b128 v[164:167], v22 offset:36864
  s_and_b32 s88, s88, 3
  s_lshl_b32 s88, s88, 2
  v_mfma_f32_32x32x16_bf16 v[140:155], v[172:175], v[180:183], v[140:155]
  v_xor_b32 v58, s88, v2
  v_mfma_f32_32x32x16_bf16 v[104:119], v[172:175], v[176:179], v[104:119]
  v_lshlrev_b32 v58, 4, v58
  s_waitcnt lgkmcnt(2)
  v_mfma_f32_32x32x16_bf16 v[40:55], v[120:123], v[160:163], v[40:55]
  ds_read_b128 v[168:171], v19 offset:32768
  ds_read_b128 v[176:179], v23 offset:32768
  v_lshrrev_b32 v204, 1, v3
  s_waitcnt lgkmcnt(2)
  v_mfma_f32_32x32x16_bf16 v[88:103], v[120:123], v[164:167], v[88:103]
  ds_read_b128 v[172:175], v19 offset:36864
  ds_read_b128 v[180:183], v23 offset:36864
  v_lshl_or_b32 v58, v204, 14, v58
  v_mfma_f32_32x32x16_bf16 v[140:155], v[156:159], v[164:167], v[140:155]
  v_and_b32 v204, 1, v3
  v_lshl_or_b32 v58, v204, 19, v58
  v_mfma_f32_32x32x16_bf16 v[104:119], v[156:159], v[160:163], v[104:119]
  s_and_b32 s89, s3, 1
  s_waitcnt vmcnt(9) lgkmcnt(0)
  s_barrier
  v_mfma_f32_32x32x16_bf16 v[40:55], v[168:171], v[176:179], v[40:55]
  ds_read_b128 v[120:123], v16 offset:49152
  ds_read_b128 v[160:163], v20 offset:49152
  s_lshl_b32 s89, s89, 8
  v_mfma_f32_32x32x16_bf16 v[88:103], v[168:171], v[180:183], v[88:103]
  ds_read_b128 v[156:159], v16 offset:53248
  ds_read_b128 v[164:167], v20 offset:53248
  s_add_u32 s87, s87, s89
  v_mfma_f32_32x32x16_bf16 v[140:155], v[172:175], v[180:183], v[140:155]
  s_add_u32 m0, s85, 0
  s_nop 0
  buffer_load_dwordx4 v64, s[20:23], s59 offen offset:0 lds
  s_lshl_b32 s89, s39, 15
  v_mfma_f32_32x32x16_bf16 v[104:119], v[172:175], v[176:179], v[104:119]
  buffer_load_dwordx4 v64, s[76:79], s59 offen offset:1024 lds
  s_add_u32 s87, s87, s89
  s_waitcnt lgkmcnt(2)
  v_mfma_f32_32x32x16_bf16 v[40:55], v[120:123], v[160:163], v[40:55]
  ds_read_b128 v[168:171], v17 offset:49152
  ds_read_b128 v[176:179], v21 offset:49152
  s_waitcnt lgkmcnt(2)
  v_mfma_f32_32x32x16_bf16 v[88:103], v[120:123], v[164:167], v[88:103]
  ds_read_b128 v[172:175], v17 offset:53248
  ds_read_b128 v[180:183], v21 offset:53248
  s_add_u32 m0, s85, 2048
  s_nop 0
  buffer_load_dwordx4 v64, s[20:23], s6 offen offset:0 lds
  v_mfma_f32_32x32x16_bf16 v[140:155], v[156:159], v[164:167], v[140:155]
  buffer_load_dwordx4 v64, s[76:79], s6 offen offset:1024 lds
  v_mfma_f32_32x32x16_bf16 v[104:119], v[156:159], v[160:163], v[104:119]
  s_add_u32 m0, s85, 16384
  s_nop 0
  buffer_load_dwordx4 v64, s[20:23], s7 offen offset:0 lds
  s_waitcnt lgkmcnt(2)
  v_mfma_f32_32x32x16_bf16 v[40:55], v[168:171], v[176:179], v[40:55]
  ds_read_b128 v[120:123], v18 offset:49152
  ds_read_b128 v[160:163], v22 offset:49152
  s_waitcnt lgkmcnt(2)
  v_mfma_f32_32x32x16_bf16 v[88:103], v[168:171], v[180:183], v[88:103]
  ds_read_b128 v[156:159], v18 offset:53248
  ds_read_b128 v[164:167], v22 offset:53248
  buffer_load_dwordx4 v64, s[76:79], s7 offen offset:1024 lds
  v_mfma_f32_32x32x16_bf16 v[140:155], v[172:175], v[180:183], v[140:155]
  s_add_u32 m0, s85, 18432
  s_nop 0
  buffer_load_dwordx4 v64, s[20:23], s8 offen offset:0 lds
  v_mfma_f32_32x32x16_bf16 v[104:119], v[172:175], v[176:179], v[104:119]
  buffer_load_dwordx4 v64, s[76:79], s8 offen offset:1024 lds
  s_waitcnt lgkmcnt(2)
  v_mfma_f32_32x32x16_bf16 v[40:55], v[120:123], v[160:163], v[40:55]
  ds_read_b128 v[168:171], v19 offset:49152
  ds_read_b128 v[176:179], v23 offset:49152
  s_waitcnt lgkmcnt(2)
  v_mfma_f32_32x32x16_bf16 v[88:103], v[120:123], v[164:167], v[88:103]
  ds_read_b128 v[172:175], v19 offset:53248
  ds_read_b128 v[180:183], v23 offset:53248
  v_mfma_f32_32x32x16_bf16 v[140:155], v[156:159], v[164:167], v[140:155]
  v_mfma_f32_32x32x16_bf16 v[104:119], v[156:159], v[160:163], v[104:119]
  s_waitcnt lgkmcnt(2)
  v_mfma_f32_32x32x16_bf16 v[40:55], v[168:171], v[176:179], v[40:55]
  s_waitcnt lgkmcnt(0)
  v_mfma_f32_32x32x16_bf16 v[88:103], v[168:171], v[180:183], v[88:103]
  v_mfma_f32_32x32x16_bf16 v[140:155], v[172:175], v[180:183], v[140:155]
  v_mfma_f32_32x32x16_bf16 v[104:119], v[172:175], v[176:179], v[104:119]
  s_nop 7
  v_pk_fma_f32 v[8:9], v[190:191], v[40:41], v[42:43] op_sel:[0,0,0] op_sel_hi:[0,1,1]
  s_nop 0
  v_pk_fma_f32 v[10:11], v[190:191], v[88:89], v[90:91] op_sel:[0,0,0] op_sel_hi:[0,1,1]
  v_pk_fma_f32 v[8:9], v[190:191], v[88:89], v[8:9] op_sel:[1,0,0] op_sel_hi:[1,1,1] neg_lo:[1,0,0] neg_hi:[1,0,0]
  v_pk_fma_f32 v[10:11], v[190:191], v[40:41], v[10:11] op_sel:[1,0,0] op_sel_hi:[1,1,1]
  v_pk_fma_f32 v[12:13], v[190:191], v[8:9], v[44:45] op_sel:[0,0,0] op_sel_hi:[0,1,1]
  v_pk_fma_f32 v[14:15], v[190:191], v[10:11], v[92:93] op_sel:[0,0,0] op_sel_hi:[0,1,1]
  v_pk_fma_f32 v[12:13], v[190:191], v[10:11], v[12:13] op_sel:[1,0,0] op_sel_hi:[1,1,1] neg_lo:[1,0,0] neg_hi:[1,0,0]
  v_pk_fma_f32 v[14:15], v[190:191], v[8:9], v[14:15] op_sel:[1,0,0] op_sel_hi:[1,1,1]
  v_pk_fma_f32 v[8:9], v[190:191], v[12:13], v[46:47] op_sel:[0,0,0] op_sel_hi:[0,1,1]
  v_pk_fma_f32 v[10:11], v[190:191], v[14:15], v[94:95] op_sel:[0,0,0] op_sel_hi:[0,1,1]
  v_pk_fma_f32 v[8:9], v[190:191], v[14:15], v[8:9] op_sel:[1,0,0] op_sel_hi:[1,1,1] neg_lo:[1,0,0] neg_hi:[1,0,0]
  v_pk_fma_f32 v[10:11], v[190:191], v[12:13], v[10:11] op_sel:[1,0,0] op_sel_hi:[1,1,1]
  v_pk_fma_f32 v[12:13], v[190:191], v[8:9], v[48:49] op_sel:[0,0,0] op_sel_hi:[0,1,1]
  v_pk_fma_f32 v[14:15], v[190:191], v[10:11], v[96:97] op_sel:[0,0,0] op_sel_hi:[0,1,1]
  v_pk_fma_f32 v[12:13], v[190:191], v[10:11], v[12:13] op_sel:[1,0,0] op_sel_hi:[1,1,1] neg_lo:[1,0,0] neg_hi:[1,0,0]
  v_pk_fma_f32 v[14:15], v[190:191], v[8:9], v[14:15] op_sel:[1,0,0] op_sel_hi:[1,1,1]
  v_pk_fma_f32 v[8:9], v[190:191], v[12:13], v[50:51] op_sel:[0,0,0] op_sel_hi:[0,1,1]
  v_pk_fma_f32 v[10:11], v[190:191], v[14:15], v[98:99] op_sel:[0,0,0] op_sel_hi:[0,1,1]
  v_pk_fma_f32 v[8:9], v[190:191], v[14:15], v[8:9] op_sel:[1,0,0] op_sel_hi:[1,1,1] neg_lo:[1,0,0] neg_hi:[1,0,0]
  v_pk_fma_f32 v[10:11], v[190:191], v[12:13], v[10:11] op_sel:[1,0,0] op_sel_hi:[1,1,1]
  v_pk_fma_f32 v[12:13], v[190:191], v[8:9], v[52:53] op_sel:[0,0,0] op_sel_hi:[0,1,1]
  v_pk_fma_f32 v[14:15], v[190:191], v[10:11], v[100:101] op_sel:[0,0,0] op_sel_hi:[0,1,1]
  v_pk_fma_f32 v[12:13], v[190:191], v[10:11], v[12:13] op_sel:[1,0,0] op_sel_hi:[1,1,1] neg_lo:[1,0,0] neg_hi:[1,0,0]
  v_pk_fma_f32 v[14:15], v[190:191], v[8:9], v[14:15] op_sel:[1,0,0] op_sel_hi:[1,1,1]
  v_pk_fma_f32 v[8:9], v[190:191], v[12:13], v[54:55] op_sel:[0,0,0] op_sel_hi:[0,1,1]
  v_pk_fma_f32 v[10:11], v[190:191], v[14:15], v[102:103] op_sel:[0,0,0] op_sel_hi:[0,1,1]
  v_pk_fma_f32 v[8:9], v[190:191], v[14:15], v[8:9] op_sel:[1,0,0] op_sel_hi:[1,1,1] neg_lo:[1,0,0] neg_hi:[1,0,0]
  v_pk_fma_f32 v[10:11], v[190:191], v[12:13], v[10:11] op_sel:[1,0,0] op_sel_hi:[1,1,1]
  v_pk_fma_f32 v[12:13], v[190:191], v[8:9], v[104:105] op_sel:[0,0,0] op_sel_hi:[0,1,1]
  v_pk_fma_f32 v[14:15], v[190:191], v[10:11], v[140:141] op_sel:[0,0,0] op_sel_hi:[0,1,1]
  v_pk_fma_f32 v[12:13], v[190:191], v[10:11], v[12:13] op_sel:[1,0,0] op_sel_hi:[1,1,1] neg_lo:[1,0,0] neg_hi:[1,0,0]
  v_pk_fma_f32 v[14:15], v[190:191], v[8:9], v[14:15] op_sel:[1,0,0] op_sel_hi:[1,1,1]
  v_pk_fma_f32 v[8:9], v[190:191], v[12:13], v[106:107] op_sel:[0,0,0] op_sel_hi:[0,1,1]
  v_pk_fma_f32 v[10:11], v[190:191], v[14:15], v[142:143] op_sel:[0,0,0] op_sel_hi:[0,1,1]
  v_pk_fma_f32 v[8:9], v[190:191], v[14:15], v[8:9] op_sel:[1,0,0] op_sel_hi:[1,1,1] neg_lo:[1,0,0] neg_hi:[1,0,0]
  v_pk_fma_f32 v[10:11], v[190:191], v[12:13], v[10:11] op_sel:[1,0,0] op_sel_hi:[1,1,1]
  v_pk_fma_f32 v[12:13], v[190:191], v[8:9], v[108:109] op_sel:[0,0,0] op_sel_hi:[0,1,1]
  v_pk_fma_f32 v[14:15], v[190:191], v[10:11], v[144:145] op_sel:[0,0,0] op_sel_hi:[0,1,1]
  v_pk_fma_f32 v[12:13], v[190:191], v[10:11], v[12:13] op_sel:[1,0,0] op_sel_hi:[1,1,1] neg_lo:[1,0,0] neg_hi:[1,0,0]
  v_pk_fma_f32 v[14:15], v[190:191], v[8:9], v[14:15] op_sel:[1,0,0] op_sel_hi:[1,1,1]
  v_pk_fma_f32 v[8:9], v[190:191], v[12:13], v[110:111] op_sel:[0,0,0] op_sel_hi:[0,1,1]
  v_pk_fma_f32 v[10:11], v[190:191], v[14:15], v[146:147] op_sel:[0,0,0] op_sel_hi:[0,1,1]
  v_pk_fma_f32 v[8:9], v[190:191], v[14:15], v[8:9] op_sel:[1,0,0] op_sel_hi:[1,1,1] neg_lo:[1,0,0] neg_hi:[1,0,0]
  v_pk_fma_f32 v[10:11], v[190:191], v[12:13], v[10:11] op_sel:[1,0,0] op_sel_hi:[1,1,1]
  v_pk_fma_f32 v[12:13], v[190:191], v[8:9], v[112:113] op_sel:[0,0,0] op_sel_hi:[0,1,1]
  v_pk_fma_f32 v[14:15], v[190:191], v[10:11], v[148:149] op_sel:[0,0,0] op_sel_hi:[0,1,1]
  v_pk_fma_f32 v[12:13], v[190:191], v[10:11], v[12:13] op_sel:[1,0,0] op_sel_hi:[1,1,1] neg_lo:[1,0,0] neg_hi:[1,0,0]
  v_pk_fma_f32 v[14:15], v[190:191], v[8:9], v[14:15] op_sel:[1,0,0] op_sel_hi:[1,1,1]
  v_pk_fma_f32 v[8:9], v[190:191], v[12:13], v[114:115] op_sel:[0,0,0] op_sel_hi:[0,1,1]
  v_pk_fma_f32 v[10:11], v[190:191], v[14:15], v[150:151] op_sel:[0,0,0] op_sel_hi:[0,1,1]
  v_pk_fma_f32 v[8:9], v[190:191], v[14:15], v[8:9] op_sel:[1,0,0] op_sel_hi:[1,1,1] neg_lo:[1,0,0] neg_hi:[1,0,0]
  v_pk_fma_f32 v[10:11], v[190:191], v[12:13], v[10:11] op_sel:[1,0,0] op_sel_hi:[1,1,1]
  v_pk_fma_f32 v[12:13], v[190:191], v[8:9], v[116:117] op_sel:[0,0,0] op_sel_hi:[0,1,1]
  v_pk_fma_f32 v[14:15], v[190:191], v[10:11], v[152:153] op_sel:[0,0,0] op_sel_hi:[0,1,1]
  v_pk_fma_f32 v[12:13], v[190:191], v[10:11], v[12:13] op_sel:[1,0,0] op_sel_hi:[1,1,1] neg_lo:[1,0,0] neg_hi:[1,0,0]
  v_pk_fma_f32 v[14:15], v[190:191], v[8:9], v[14:15] op_sel:[1,0,0] op_sel_hi:[1,1,1]
  v_pk_fma_f32 v[8:9], v[190:191], v[12:13], v[118:119] op_sel:[0,0,0] op_sel_hi:[0,1,1]
  v_pk_fma_f32 v[10:11], v[190:191], v[14:15], v[154:155] op_sel:[0,0,0] op_sel_hi:[0,1,1]
  v_pk_fma_f32 v[8:9], v[190:191], v[14:15], v[8:9] op_sel:[1,0,0] op_sel_hi:[1,1,1] neg_lo:[1,0,0] neg_hi:[1,0,0]
  v_pk_fma_f32 v[10:11], v[190:191], v[12:13], v[10:11] op_sel:[1,0,0] op_sel_hi:[1,1,1]
  v_fma_f32 v12, v192, v8, v9
  v_fma_f32 v13, v192, v10, v11
  v_fma_f32 v12, -v193, v10, v12
  v_fma_f32 v13, v193, v8, v13
  v_mov_b32 v14, v12
  v_mov_b32 v15, v13
  s_nop 0
  v_permlane32_swap_b32 v12, v14
  v_permlane32_swap_b32 v13, v15
  v_fma_f32 v14, v194, v12, v14
  v_fma_f32 v15, v194, v13, v15
  v_fma_f32 v14, -v195, v13, v14
  v_fma_f32 v15, v195, v12, v15
  ds_write_b64 v56, v[14:15]
  s_waitcnt vmcnt(16)
  v_cmp_ne_u32 vcc, 1, v209
  s_nop 0
  s_cbranch_vccz gated_mix__spectral_gfnet__ssm_conv_s5__prompt_kernel_skip25
  s_mov_b32 s29, 0
gated_mix__spectral_gfnet__ssm_conv_s5__prompt_kernel_poll26:
  s_sleep 16
  buffer_load_dword v209, v7, s[16:19], 0 offen sc1
  s_waitcnt vmcnt(0)
  v_cmp_ne_u32 vcc, 1, v209
  s_nop 0
  s_cbranch_vccz gated_mix__spectral_gfnet__ssm_conv_s5__prompt_kernel_pollout27
  s_add_u32 s29, s29, 1
  s_cmp_lt_u32 s29, 1048576
  s_cbranch_scc1 gated_mix__spectral_gfnet__ssm_conv_s5__prompt_kernel_poll26
gated_mix__spectral_gfnet__ssm_conv_s5__prompt_kernel_pollout27:
gated_mix__spectral_gfnet__ssm_conv_s5__prompt_kernel_skip25:
  s_waitcnt lgkmcnt(0)
  s_barrier
  v_and_b32 v56, 0xfffffbff, v56
  ds_read_b64 v[208:209], v56
  s_cmp_lt_u32 s3, 2
  s_cbranch_scc1 gated_mix__spectral_gfnet__ssm_conv_s5__prompt_kernel_skip28
  s_waitcnt lgkmcnt(0)
  v_fma_f32 v14, v196, v208, v14
  s_waitcnt lgkmcnt(0)
  v_fma_f32 v15, v196, v209, v15
  s_waitcnt lgkmcnt(0)
  v_fma_f32 v14, -v197, v209, v14
  s_waitcnt lgkmcnt(0)
  v_fma_f32 v15, v197, v208, v15
  v_min_u32 v14, -2, v14
  v_min_u32 v15, -2, v15
  s_mov_b32 exec_hi, 0
  buffer_store_dwordx2 v[14:15], v57, s[64:67], 0 offen sc1
  s_mov_b64 exec, -1
gated_mix__spectral_gfnet__ssm_conv_s5__prompt_kernel_skip28:
  v_lshrrev_b32 v6, 5, v1
  v_lshl_add_u32 v57, v6, 12, v57
  v_add_u32 v57, 512, v57
  v_and_b32 v14, 3, v2
  v_lshlrev_b32 v6, 6, v14
  v_lshrrev_b32 v14, 2, v2
  v_lshl_or_b32 v6, v14, 4, v6
  v_lshl_or_b32 v6, v3, 12, v6
  s_mul_i32 s29, s11, 16384
  s_lshl_b32 s58, s3, 8
  s_add_u32 s29, s29, s58
  buffer_load_dwordx4 v[16:19], v6, s[12:15], s29 offen offset:0 sc1
  buffer_load_dwordx4 v[20:23], v6, s[12:15], s29 offen offset:1024 sc1
  buffer_load_dwordx4 v[120:123], v6, s[12:15], s29 offen offset:2048 sc1
  buffer_load_dwordx4 v[156:159], v6, s[12:15], s29 offen offset:3072 sc1
  v_pk_mul_f32 v[162:163], v[200:201], v[40:41] op_sel:[1,0] op_sel_hi:[1,1]
  v_pk_mul_f32 v[40:41], v[200:201], v[40:41] op_sel:[0,0] op_sel_hi:[0,1]
  v_pk_fma_f32 v[40:41], v[200:201], v[88:89], v[40:41] op_sel:[1,0,0] op_sel_hi:[1,1,1] neg_lo:[1,0,0] neg_hi:[1,0,0]
  v_pk_fma_f32 v[88:89], v[200:201], v[88:89], v[162:163] op_sel:[0,0,0] op_sel_hi:[0,1,1]
  v_pk_mul_f32 v[160:161], v[200:201], v[42:43] op_sel:[1,0] op_sel_hi:[1,1]
  v_pk_mul_f32 v[42:43], v[200:201], v[42:43] op_sel:[0,0] op_sel_hi:[0,1]
  v_pk_fma_f32 v[42:43], v[200:201], v[90:91], v[42:43] op_sel:[1,0,0] op_sel_hi:[1,1,1] neg_lo:[1,0,0] neg_hi:[1,0,0]
  v_pk_fma_f32 v[90:91], v[200:201], v[90:91], v[160:161] op_sel:[0,0,0] op_sel_hi:[0,1,1]
  v_pk_mul_f32 v[162:163], v[200:201], v[44:45] op_sel:[1,0] op_sel_hi:[1,1]
  v_pk_mul_f32 v[44:45], v[200:201], v[44:45] op_sel:[0,0] op_sel_hi:[0,1]
  v_pk_fma_f32 v[44:45], v[200:201], v[92:93], v[44:45] op_sel:[1,0,0] op_sel_hi:[1,1,1] neg_lo:[1,0,0] neg_hi:[1,0,0]
  v_pk_fma_f32 v[92:93], v[200:201], v[92:93], v[162:163] op_sel:[0,0,0] op_sel_hi:[0,1,1]
  v_pk_mul_f32 v[160:161], v[200:201], v[46:47] op_sel:[1,0] op_sel_hi:[1,1]
  v_pk_mul_f32 v[46:47], v[200:201], v[46:47] op_sel:[0,0] op_sel_hi:[0,1]
  v_pk_fma_f32 v[46:47], v[200:201], v[94:95], v[46:47] op_sel:[1,0,0] op_sel_hi:[1,1,1] neg_lo:[1,0,0] neg_hi:[1,0,0]
  v_pk_fma_f32 v[94:95], v[200:201], v[94:95], v[160:161] op_sel:[0,0,0] op_sel_hi:[0,1,1]
  v_pk_mul_f32 v[162:163], v[200:201], v[48:49] op_sel:[1,0] op_sel_hi:[1,1]
  v_pk_mul_f32 v[48:49], v[200:201], v[48:49] op_sel:[0,0] op_sel_hi:[0,1]
  v_pk_fma_f32 v[48:49], v[200:201], v[96:97], v[48:49] op_sel:[1,0,0] op_sel_hi:[1,1,1] neg_lo:[1,0,0] neg_hi:[1,0,0]
  v_pk_fma_f32 v[96:97], v[200:201], v[96:97], v[162:163] op_sel:[0,0,0] op_sel_hi:[0,1,1]
  v_pk_mul_f32 v[160:161], v[200:201], v[50:51] op_sel:[1,0] op_sel_hi:[1,1]
  v_pk_mul_f32 v[50:51], v[200:201], v[50:51] op_sel:[0,0] op_sel_hi:[0,1]
  v_pk_fma_f32 v[50:51], v[200:201], v[98:99], v[50:51] op_sel:[1,0,0] op_sel_hi:[1,1,1] neg_lo:[1,0,0] neg_hi:[1,0,0]
  v_pk_fma_f32 v[98:99], v[200:201], v[98:99], v[160:161] op_sel:[0,0,0] op_sel_hi:[0,1,1]
  v_pk_mul_f32 v[162:163], v[200:201], v[52:53] op_sel:[1,0] op_sel_hi:[1,1]
  s_add_u32 m0, s85, 81920
  s_nop 0
  buffer_load_dwordx4 v64, s[20:23], s9 offen offset:0 lds
  v_pk_mul_f32 v[52:53], v[200:201], v[52:53] op_sel:[0,0] op_sel_hi:[0,1]
  v_pk_fma_f32 v[52:53], v[200:201], v[100:101], v[52:53] op_sel:[1,0,0] op_sel_hi:[1,1,1] neg_lo:[1,0,0] neg_hi:[1,0,0]
  v_pk_fma_f32 v[100:101], v[200:201], v[100:101], v[162:163] op_sel:[0,0,0] op_sel_hi:[0,1,1]
  v_pk_mul_f32 v[160:161], v[200:201], v[54:55] op_sel:[1,0] op_sel_hi:[1,1]
  v_pk_mul_f32 v[54:55], v[200:201], v[54:55] op_sel:[0,0] op_sel_hi:[0,1]
  v_pk_fma_f32 v[54:55], v[200:201], v[102:103], v[54:55] op_sel:[1,0,0] op_sel_hi:[1,1,1] neg_lo:[1,0,0] neg_hi:[1,0,0]
  v_pk_fma_f32 v[102:103], v[200:201], v[102:103], v[160:161] op_sel:[0,0,0] op_sel_hi:[0,1,1]
  v_pk_mul_f32 v[162:163], v[200:201], v[104:105] op_sel:[1,0] op_sel_hi:[1,1]
  v_pk_mul_f32 v[104:105], v[200:201], v[104:105] op_sel:[0,0] op_sel_hi:[0,1]
  v_pk_fma_f32 v[104:105], v[200:201], v[140:141], v[104:105] op_sel:[1,0,0] op_sel_hi:[1,1,1] neg_lo:[1,0,0] neg_hi:[1,0,0]
  v_pk_fma_f32 v[140:141], v[200:201], v[140:141], v[162:163] op_sel:[0,0,0] op_sel_hi:[0,1,1]
  v_pk_mul_f32 v[160:161], v[200:201], v[106:107] op_sel:[1,0] op_sel_hi:[1,1]
  v_pk_mul_f32 v[106:107], v[200:201], v[106:107] op_sel:[0,0] op_sel_hi:[0,1]
  v_pk_fma_f32 v[106:107], v[200:201], v[142:143], v[106:107] op_sel:[1,0,0] op_sel_hi:[1,1,1] neg_lo:[1,0,0] neg_hi:[1,0,0]
  v_pk_fma_f32 v[142:143], v[200:201], v[142:143], v[160:161] op_sel:[0,0,0] op_sel_hi:[0,1,1]
  v_pk_mul_f32 v[162:163], v[200:201], v[108:109] op_sel:[1,0] op_sel_hi:[1,1]
  v_pk_mul_f32 v[108:109], v[200:201], v[108:109] op_sel:[0,0] op_sel_hi:[0,1]
  v_pk_fma_f32 v[108:109], v[200:201], v[144:145], v[108:109] op_sel:[1,0,0] op_sel_hi:[1,1,1] neg_lo:[1,0,0] neg_hi:[1,0,0]
  buffer_load_dwordx4 v64, s[76:79], s9 offen offset:1024 lds
  v_pk_fma_f32 v[144:145], v[200:201], v[144:145], v[162:163] op_sel:[0,0,0] op_sel_hi:[0,1,1]
  v_pk_mul_f32 v[160:161], v[200:201], v[110:111] op_sel:[1,0] op_sel_hi:[1,1]
  v_pk_mul_f32 v[110:111], v[200:201], v[110:111] op_sel:[0,0] op_sel_hi:[0,1]
  v_pk_fma_f32 v[110:111], v[200:201], v[146:147], v[110:111] op_sel:[1,0,0] op_sel_hi:[1,1,1] neg_lo:[1,0,0] neg_hi:[1,0,0]
  v_pk_fma_f32 v[146:147], v[200:201], v[146:147], v[160:161] op_sel:[0,0,0] op_sel_hi:[0,1,1]
  v_pk_mul_f32 v[162:163], v[200:201], v[112:113] op_sel:[1,0] op_sel_hi:[1,1]
  v_pk_mul_f32 v[112:113], v[200:201], v[112:113] op_sel:[0,0] op_sel_hi:[0,1]
  v_pk_fma_f32 v[112:113], v[200:201], v[148:149], v[112:113] op_sel:[1,0,0] op_sel_hi:[1,1,1] neg_lo:[1,0,0] neg_hi:[1,0,0]
  v_pk_fma_f32 v[148:149], v[200:201], v[148:149], v[162:163] op_sel:[0,0,0] op_sel_hi:[0,1,1]
  v_pk_mul_f32 v[160:161], v[200:201], v[114:115] op_sel:[1,0] op_sel_hi:[1,1]
  v_pk_mul_f32 v[114:115], v[200:201], v[114:115] op_sel:[0,0] op_sel_hi:[0,1]
  v_pk_fma_f32 v[114:115], v[200:201], v[150:151], v[114:115] op_sel:[1,0,0] op_sel_hi:[1,1,1] neg_lo:[1,0,0] neg_hi:[1,0,0]
  v_pk_fma_f32 v[150:151], v[200:201], v[150:151], v[160:161] op_sel:[0,0,0] op_sel_hi:[0,1,1]
  v_pk_mul_f32 v[162:163], v[200:201], v[116:117] op_sel:[1,0] op_sel_hi:[1,1]
  v_pk_mul_f32 v[116:117], v[200:201], v[116:117] op_sel:[0,0] op_sel_hi:[0,1]
  v_pk_fma_f32 v[116:117], v[200:201], v[152:153], v[116:117] op_sel:[1,0,0] op_sel_hi:[1,1,1] neg_lo:[1,0,0] neg_hi:[1,0,0]
  v_pk_fma_f32 v[152:153], v[200:201], v[152:153], v[162:163] op_sel:[0,0,0] op_sel_hi:[0,1,1]
  v_pk_mul_f32 v[160:161], v[200:201], v[118:119] op_sel:[1,0] op_sel_hi:[1,1]
  s_add_u32 m0, s85, 83968
  s_nop 0
  buffer_load_dwordx4 v64, s[20:23], s32 offen offset:0 lds
  v_pk_mul_f32 v[118:119], v[200:201], v[118:119] op_sel:[0,0] op_sel_hi:[0,1]
  v_pk_fma_f32 v[118:119], v[200:201], v[154:155], v[118:119] op_sel:[1,0,0] op_sel_hi:[1,1,1] neg_lo:[1,0,0] neg_hi:[1,0,0]
  v_pk_fma_f32 v[154:155], v[200:201], v[154:155], v[160:161] op_sel:[0,0,0] op_sel_hi:[0,1,1]
  v_pk_mul_f32 v[14:15], v[200:201], v[196:197] op_sel:[0,0] op_sel_hi:[0,1]
  v_pk_fma_f32 v[14:15], v[200:201], v[196:197], v[14:15] op_sel:[1,1,0] op_sel_hi:[1,0,1] neg_lo:[1,0,0]
  s_cmp_ge_u32 s3, 2
  s_cbranch_scc1 gated_mix__spectral_gfnet__ssm_conv_s5__prompt_kernel_skip29
  v_mov_b32 v14, v200
  v_mov_b32 v15, v201
  s_waitcnt lgkmcnt(0)
  v_mov_b32 v208, 0
  s_waitcnt lgkmcnt(0)
  v_mov_b32 v209, 0
gated_mix__spectral_gfnet__ssm_conv_s5__prompt_kernel_skip29:
  v_pk_mul_f32 v[164:165], v[194:195], v[14:15] op_sel:[0,0] op_sel_hi:[0,1]
  v_pk_fma_f32 v[164:165], v[194:195], v[14:15], v[164:165] op_sel:[1,1,0] op_sel_hi:[1,0,1] neg_lo:[1,0,0]
  s_waitcnt lgkmcnt(0)
  v_pk_fma_f32 v[12:13], v[194:195], v[208:209], v[12:13] op_sel:[0,0,0] op_sel_hi:[0,1,1]
  v_pk_fma_f32 v[12:13], v[194:195], v[208:209], v[12:13] op_sel:[1,1,0] op_sel_hi:[1,0,1] neg_lo:[1,0,0]
  s_mov_b32 exec_lo, 0
  v_mov_b32 v14, v164
  v_mov_b32 v15, v165
  v_mov_b32 v208, v12
  v_mov_b32 v209, v13
  s_mov_b64 exec, -1
  v_mov_b32 v9, v10
  buffer_load_dwordx4 v64, s[76:79], s32 offen offset:1024 lds
  v_pk_mul_f32 v[160:161], v[192:193], v[14:15] op_sel:[0,0] op_sel_hi:[0,1]
  v_pk_fma_f32 v[160:161], v[192:193], v[14:15], v[160:161] op_sel:[1,1,0] op_sel_hi:[1,0,1] neg_lo:[1,0,0]
  v_pk_fma_f32 v[8:9], v[192:193], v[208:209], v[8:9] op_sel:[0,0,0] op_sel_hi:[0,1,1]
  v_pk_fma_f32 v[8:9], v[192:193], v[208:209], v[8:9] op_sel:[1,1,0] op_sel_hi:[1,0,1] neg_lo:[1,0,0]
  v_pk_mul_f32 v[162:163], v[200:201], v[8:9] op_sel:[0,0] op_sel_hi:[0,1]
  v_pk_fma_f32 v[162:163], v[200:201], v[8:9], v[162:163] op_sel:[1,1,0] op_sel_hi:[1,0,1] neg_lo:[1,0,0]
  v_pk_mul_f32 v[164:165], v[200:201], v[208:209] op_sel:[0,0] op_sel_hi:[0,1]
  v_pk_fma_f32 v[164:165], v[200:201], v[208:209], v[164:165] op_sel:[1,1,0] op_sel_hi:[1,0,1] neg_lo:[1,0,0]
  s_add_u32 m0, s85, 32768
  s_nop 0
  buffer_load_dwordx4 v64, s[20:23], s33 offen offset:0 lds
  buffer_load_dwordx4 v64, s[76:79], s33 offen offset:1024 lds
  s_add_u32 m0, s85, 34816
  s_nop 0
  buffer_load_dwordx4 v64, s[20:23], s84 offen offset:0 lds
  buffer_load_dwordx4 v64, s[76:79], s84 offen offset:1024 lds
  buffer_load_dwordx2 v[12:13], v57, s[64:67], 0 offen offset:0 sc1
  buffer_load_dwordx2 v[166:167], v57, s[64:67], 0 offen offset:512 sc1
  buffer_load_dwordx2 v[196:197], v57, s[64:67], 0 offen offset:1024 sc1
  buffer_load_dwordx2 v[208:209], v57, s[64:67], 0 offen offset:1536 sc1
  buffer_load_dwordx2 v[8:9], v57, s[64:67], 0 offen offset:2048 sc1
  buffer_load_dwordx2 v[10:11], v57, s[64:67], 0 offen offset:2560 sc1
  buffer_load_dwordx2 v[168:169], v57, s[64:67], 0 offen offset:3072 sc1
  buffer_load_dwordx2 v[170:171], v57, s[64:67], 0 offen offset:3584 sc1
  s_add_u32 m0, s43, 114688
  s_nop 0
  buffer_load_dwordx4 v124, s[68:71], s28 offen offset:0 lds
  v_and_b32 v6, 7, v2
  v_lshlrev_b32 v56, 2, v3
  v_xor_b32 v6, v6, v56
  v_lshlrev_b32 v6, 4, v6
  v_lshl_or_b32 v6, v2, 10, v6
  s_lshl_b32 s29, s3, 8
  s_add_u32 s29, s29, 49152
  v_add_u32 v6, s29, v6
  s_waitcnt vmcnt(20)
  v_mov_b32 v172, v16
  s_waitcnt vmcnt(19)
  v_mov_b32 v173, v20
  s_waitcnt vmcnt(18)
  v_mov_b32 v174, v120
  s_waitcnt vmcnt(17)
  v_mov_b32 v175, v156
  v_mov_b32 v176, v17
  v_mov_b32 v177, v21
  v_mov_b32 v178, v121
  v_mov_b32 v179, v157
  v_mfma_f32_16x16x32_bf16 v[180:183], v[172:175], v[68:71], 0
  buffer_load_dwordx4 v125, s[68:71], s28 offen offset:1024 lds
  v_mfma_f32_16x16x32_bf16 v[192:195], v[172:175], v[72:75], 0
  v_mfma_f32_16x16x32_bf16 v[204:207], v[176:179], v[68:71], 0
  v_mfma_f32_16x16x32_bf16 v[212:215], v[176:179], v[72:75], 0
  v_mov_b32 v172, v18
  v_mov_b32 v173, v22
  v_mov_b32 v174, v122
  v_mov_b32 v175, v158
  v_mov_b32 v176, v19
  v_mov_b32 v177, v23
  s_add_u32 m0, s43, 116736
  s_nop 0
  buffer_load_dwordx4 v126, s[68:71], s28 offen offset:0 lds
  v_mov_b32 v178, v123
  v_mov_b32 v179, v159
  v_xor_b32 v56, 0, v6
  v_cvt_pk_bf16_f32 v156, v180, v192
  v_cvt_pk_bf16_f32 v157, v181, v193
  v_cvt_pk_bf16_f32 v158, v182, v194
  v_cvt_pk_bf16_f32 v159, v183, v195
  ds_write_b128 v56, v[156:159]
  v_mfma_f32_16x16x32_bf16 v[180:183], v[172:175], v[68:71], 0
  v_mfma_f32_16x16x32_bf16 v[192:195], v[172:175], v[72:75], 0
  v_xor_b32 v56, 16, v6
  v_cvt_pk_bf16_f32 v16, v204, v212
  buffer_load_dwordx4 v127, s[68:71], s28 offen offset:1024 lds
  v_cvt_pk_bf16_f32 v17, v205, v213
  v_cvt_pk_bf16_f32 v18, v206, v214
  v_cvt_pk_bf16_f32 v19, v207, v215
  ds_write_b128 v56, v[16:19]
  v_mfma_f32_16x16x32_bf16 v[204:207], v[176:179], v[68:71], 0
  v_mfma_f32_16x16x32_bf16 v[212:215], v[176:179], v[72:75], 0
  v_xor_b32 v56, 32, v6
  v_cvt_pk_bf16_f32 v20, v180, v192
  v_cvt_pk_bf16_f32 v21, v181, v193
  v_cvt_pk_bf16_f32 v22, v182, v194
  v_cvt_pk_bf16_f32 v23, v183, v195
  ds_write_b128 v56, v[20:23]
  v_xor_b32 v56, 48, v6
  s_nop 0
  v_cvt_pk_bf16_f32 v120, v204, v212
  v_cvt_pk_bf16_f32 v121, v205, v213
  v_cvt_pk_bf16_f32 v122, v206, v214
  v_cvt_pk_bf16_f32 v123, v207, v215
  ds_write_b128 v56, v[120:123]
  s_waitcnt vmcnt(4)
  v_max_u32 v6, v12, v13
  v_max3_u32 v6, v6, v166, v167
  v_max3_u32 v6, v6, v196, v197
  v_max3_u32 v6, v6, v208, v209
  v_max3_u32 v6, v6, v8, v9
  v_max3_u32 v6, v6, v10, v11
  v_max3_u32 v6, v6, v168, v169
  v_max3_u32 v6, v6, v170, v171
  v_cmp_eq_u32 vcc, -1, v6
  s_nop 0
  s_cbranch_vccz gated_mix__spectral_gfnet__ssm_conv_s5__prompt_kernel_skip30
  s_mov_b32 s29, 0
gated_mix__spectral_gfnet__ssm_conv_s5__prompt_kernel_lb31:
  buffer_load_dwordx2 v[12:13], v57, s[64:67], 0 offen offset:0 sc1
  buffer_load_dwordx2 v[166:167], v57, s[64:67], 0 offen offset:512 sc1
  buffer_load_dwordx2 v[196:197], v57, s[64:67], 0 offen offset:1024 sc1
  buffer_load_dwordx2 v[208:209], v57, s[64:67], 0 offen offset:1536 sc1
  buffer_load_dwordx2 v[8:9], v57, s[64:67], 0 offen offset:2048 sc1
  buffer_load_dwordx2 v[10:11], v57, s[64:67], 0 offen offset:2560 sc1
  buffer_load_dwordx2 v[168:169], v57, s[64:67], 0 offen offset:3072 sc1
  buffer_load_dwordx2 v[170:171], v57, s[64:67], 0 offen offset:3584 sc1
  s_waitcnt vmcnt(0)
  v_max_u32 v6, v12, v13
  v_max3_u32 v6, v6, v166, v167
  v_max3_u32 v6, v6, v196, v197
  v_max3_u32 v6, v6, v208, v209
  v_max3_u32 v6, v6, v8, v9
  v_max3_u32 v6, v6, v10, v11
  v_max3_u32 v6, v6, v168, v169
  v_max3_u32 v6, v6, v170, v171
  v_cmp_eq_u32 vcc, -1, v6
  s_nop 0
  s_cbranch_vccz gated_mix__spectral_gfnet__ssm_conv_s5__prompt_kernel_lbout32
  s_add_u32 s29, s29, 1
  s_cmp_lt_u32 s29, 1048576
  s_cbranch_scc1 gated_mix__spectral_gfnet__ssm_conv_s5__prompt_kernel_lb31
gated_mix__spectral_gfnet__ssm_conv_s5__prompt_kernel_lbout32:
gated_mix__spectral_gfnet__ssm_conv_s5__prompt_kernel_skip30:
  s_add_u32 s12, s34, 10485760
  s_addc_u32 s13, s35, 0
  s_mov_b32 s14, 8388608
  s_mov_b32 s15, 0x20000
  v_pk_fma_f32 v[168:169], v[202:203], v[170:171], v[168:169] op_sel:[0,0,0] op_sel_hi:[0,1,1]
  v_pk_fma_f32 v[168:169], v[202:203], v[170:171], v[168:169] op_sel:[1,1,0] op_sel_hi:[1,0,1] neg_lo:[1,0,0]
  v_pk_fma_f32 v[10:11], v[202:203], v[168:169], v[10:11] op_sel:[0,0,0] op_sel_hi:[0,1,1]
  v_pk_fma_f32 v[10:11], v[202:203], v[168:169], v[10:11] op_sel:[1,1,0] op_sel_hi:[1,0,1] neg_lo:[1,0,0]
  v_pk_fma_f32 v[8:9], v[202:203], v[10:11], v[8:9] op_sel:[0,0,0] op_sel_hi:[0,1,1]
  v_pk_fma_f32 v[8:9], v[202:203], v[10:11], v[8:9] op_sel:[1,1,0] op_sel_hi:[1,0,1] neg_lo:[1,0,0]
  v_pk_fma_f32 v[208:209], v[202:203], v[8:9], v[208:209] op_sel:[0,0,0] op_sel_hi:[0,1,1]
  v_pk_fma_f32 v[208:209], v[202:203], v[8:9], v[208:209] op_sel:[1,1,0] op_sel_hi:[1,0,1] neg_lo:[1,0,0]
  v_pk_fma_f32 v[196:197], v[202:203], v[208:209], v[196:197] op_sel:[0,0,0] op_sel_hi:[0,1,1]
  v_pk_fma_f32 v[196:197], v[202:203], v[208:209], v[196:197] op_sel:[1,1,0] op_sel_hi:[1,0,1] neg_lo:[1,0,0]
  v_pk_fma_f32 v[166:167], v[202:203], v[196:197], v[166:167] op_sel:[0,0,0] op_sel_hi:[0,1,1]
  v_pk_fma_f32 v[166:167], v[202:203], v[196:197], v[166:167] op_sel:[1,1,0] op_sel_hi:[1,0,1] neg_lo:[1,0,0]
  v_pk_fma_f32 v[12:13], v[202:203], v[166:167], v[12:13] op_sel:[0,0,0] op_sel_hi:[0,1,1]
  v_pk_fma_f32 v[12:13], v[202:203], v[166:167], v[12:13] op_sel:[1,1,0] op_sel_hi:[1,0,1] neg_lo:[1,0,0]
  v_mov_b32 v166, v12
  v_mov_b32 v167, v13
  s_nop 0
  v_permlane32_swap_b32 v12, v166
  v_permlane32_swap_b32 v13, v167
  v_pk_fma_f32 v[12:13], v[198:199], v[166:167], v[12:13] op_sel:[0,0,0] op_sel_hi:[0,1,1]
  v_pk_fma_f32 v[12:13], v[198:199], v[166:167], v[12:13] op_sel:[1,1,0] op_sel_hi:[1,0,1] neg_lo:[1,0,0]
  v_pk_fma_f32 v[164:165], v[14:15], v[12:13], v[164:165] op_sel:[0,0,0] op_sel_hi:[0,1,1]
  v_pk_fma_f32 v[164:165], v[14:15], v[12:13], v[164:165] op_sel:[1,1,0] op_sel_hi:[1,0,1] neg_lo:[1,0,0]
  v_pk_fma_f32 v[162:163], v[160:161], v[12:13], v[162:163] op_sel:[0,0,0] op_sel_hi:[0,1,1]
  v_pk_fma_f32 v[162:163], v[160:161], v[12:13], v[162:163] op_sel:[1,1,0] op_sel_hi:[1,0,1] neg_lo:[1,0,0]
  v_swap_b32 v165, v162
  v_pk_fma_f32 v[40:41], v[190:191], v[164:165], v[40:41] op_sel:[0,0,0] op_sel_hi:[0,1,1]
  v_pk_fma_f32 v[88:89], v[190:191], v[162:163], v[88:89] op_sel:[0,0,0] op_sel_hi:[0,1,1]
  v_pk_fma_f32 v[40:41], v[190:191], v[162:163], v[40:41] op_sel:[1,0,0] op_sel_hi:[1,1,1] neg_lo:[1,0,0] neg_hi:[1,0,0]
  v_pk_fma_f32 v[88:89], v[190:191], v[164:165], v[88:89] op_sel:[1,0,0] op_sel_hi:[1,1,1]
  v_cvt_pk_bf16_f32 v16, v40, v41
  v_cvt_pk_bf16_f32 v17, -v88, -v89
  v_pk_fma_f32 v[42:43], v[190:191], v[40:41], v[42:43] op_sel:[0,0,0] op_sel_hi:[0,1,1]
  v_pk_fma_f32 v[90:91], v[190:191], v[88:89], v[90:91] op_sel:[0,0,0] op_sel_hi:[0,1,1]
  v_pk_fma_f32 v[42:43], v[190:191], v[88:89], v[42:43] op_sel:[1,0,0] op_sel_hi:[1,1,1] neg_lo:[1,0,0] neg_hi:[1,0,0]
  v_pk_fma_f32 v[90:91], v[190:191], v[40:41], v[90:91] op_sel:[1,0,0] op_sel_hi:[1,1,1]
  v_cvt_pk_bf16_f32 v18, v42, v43
  v_cvt_pk_bf16_f32 v19, -v90, -v91
  v_pk_fma_f32 v[44:45], v[190:191], v[42:43], v[44:45] op_sel:[0,0,0] op_sel_hi:[0,1,1]
  v_pk_fma_f32 v[92:93], v[190:191], v[90:91], v[92:93] op_sel:[0,0,0] op_sel_hi:[0,1,1]
  v_permlane32_swap_b32 v16, v17
  v_permlane32_swap_b32 v18, v19
  v_pk_fma_f32 v[44:45], v[190:191], v[90:91], v[44:45] op_sel:[1,0,0] op_sel_hi:[1,1,1] neg_lo:[1,0,0] neg_hi:[1,0,0]
  v_pk_fma_f32 v[92:93], v[190:191], v[42:43], v[92:93] op_sel:[1,0,0] op_sel_hi:[1,1,1]
  v_permlane16_swap_b32 v16, v18
  v_permlane16_swap_b32 v17, v19
  buffer_store_dwordx4 v[16:19], v58, s[12:15], s87 offen sc1
  s_add_u32 s87, s87, 1048576
  v_cvt_pk_bf16_f32 v20, v44, v45
  v_cvt_pk_bf16_f32 v21, -v92, -v93
  v_pk_fma_f32 v[46:47], v[190:191], v[44:45], v[46:47] op_sel:[0,0,0] op_sel_hi:[0,1,1]
  v_pk_fma_f32 v[94:95], v[190:191], v[92:93], v[94:95] op_sel:[0,0,0] op_sel_hi:[0,1,1]
  v_pk_fma_f32 v[46:47], v[190:191], v[92:93], v[46:47] op_sel:[1,0,0] op_sel_hi:[1,1,1] neg_lo:[1,0,0] neg_hi:[1,0,0]
  v_pk_fma_f32 v[94:95], v[190:191], v[44:45], v[94:95] op_sel:[1,0,0] op_sel_hi:[1,1,1]
  v_cvt_pk_bf16_f32 v22, v46, v47
  v_cvt_pk_bf16_f32 v23, -v94, -v95
  v_pk_fma_f32 v[48:49], v[190:191], v[46:47], v[48:49] op_sel:[0,0,0] op_sel_hi:[0,1,1]
  v_pk_fma_f32 v[96:97], v[190:191], v[94:95], v[96:97] op_sel:[0,0,0] op_sel_hi:[0,1,1]
  v_permlane32_swap_b32 v20, v21
  v_permlane32_swap_b32 v22, v23
  v_pk_fma_f32 v[48:49], v[190:191], v[94:95], v[48:49] op_sel:[1,0,0] op_sel_hi:[1,1,1] neg_lo:[1,0,0] neg_hi:[1,0,0]
  v_pk_fma_f32 v[96:97], v[190:191], v[46:47], v[96:97] op_sel:[1,0,0] op_sel_hi:[1,1,1]
  v_permlane16_swap_b32 v20, v22
  v_permlane16_swap_b32 v21, v23
  buffer_store_dwordx4 v[20:23], v58, s[12:15], s87 offen sc1
  s_add_u32 s87, s87, 1048576
  v_cvt_pk_bf16_f32 v68, v48, v49
  v_cvt_pk_bf16_f32 v69, -v96, -v97
  v_pk_fma_f32 v[50:51], v[190:191], v[48:49], v[50:51] op_sel:[0,0,0] op_sel_hi:[0,1,1]
  v_pk_fma_f32 v[98:99], v[190:191], v[96:97], v[98:99] op_sel:[0,0,0] op_sel_hi:[0,1,1]
  v_pk_fma_f32 v[50:51], v[190:191], v[96:97], v[50:51] op_sel:[1,0,0] op_sel_hi:[1,1,1] neg_lo:[1,0,0] neg_hi:[1,0,0]
  v_pk_fma_f32 v[98:99], v[190:191], v[48:49], v[98:99] op_sel:[1,0,0] op_sel_hi:[1,1,1]
  v_cvt_pk_bf16_f32 v70, v50, v51
  v_cvt_pk_bf16_f32 v71, -v98, -v99
  v_pk_fma_f32 v[52:53], v[190:191], v[50:51], v[52:53] op_sel:[0,0,0] op_sel_hi:[0,1,1]
  v_pk_fma_f32 v[100:101], v[190:191], v[98:99], v[100:101] op_sel:[0,0,0] op_sel_hi:[0,1,1]
  v_permlane32_swap_b32 v68, v69
  v_permlane32_swap_b32 v70, v71
  v_pk_fma_f32 v[52:53], v[190:191], v[98:99], v[52:53] op_sel:[1,0,0] op_sel_hi:[1,1,1] neg_lo:[1,0,0] neg_hi:[1,0,0]
  v_pk_fma_f32 v[100:101], v[190:191], v[50:51], v[100:101] op_sel:[1,0,0] op_sel_hi:[1,1,1]
  v_permlane16_swap_b32 v68, v70
  v_permlane16_swap_b32 v69, v71
  buffer_store_dwordx4 v[68:71], v58, s[12:15], s87 offen sc1
  s_add_u32 s87, s87, 1048576
  v_cvt_pk_bf16_f32 v16, v52, v53
  v_cvt_pk_bf16_f32 v17, -v100, -v101
  v_pk_fma_f32 v[54:55], v[190:191], v[52:53], v[54:55] op_sel:[0,0,0] op_sel_hi:[0,1,1]
  v_pk_fma_f32 v[102:103], v[190:191], v[100:101], v[102:103] op_sel:[0,0,0] op_sel_hi:[0,1,1]
  v_pk_fma_f32 v[54:55], v[190:191], v[100:101], v[54:55] op_sel:[1,0,0] op_sel_hi:[1,1,1] neg_lo:[1,0,0] neg_hi:[1,0,0]
  v_pk_fma_f32 v[102:103], v[190:191], v[52:53], v[102:103] op_sel:[1,0,0] op_sel_hi:[1,1,1]
  v_cvt_pk_bf16_f32 v18, v54, v55
  v_cvt_pk_bf16_f32 v19, -v102, -v103
  v_pk_fma_f32 v[104:105], v[190:191], v[54:55], v[104:105] op_sel:[0,0,0] op_sel_hi:[0,1,1]
  v_pk_fma_f32 v[140:141], v[190:191], v[102:103], v[140:141] op_sel:[0,0,0] op_sel_hi:[0,1,1]
  v_permlane32_swap_b32 v16, v17
  v_permlane32_swap_b32 v18, v19
  v_pk_fma_f32 v[104:105], v[190:191], v[102:103], v[104:105] op_sel:[1,0,0] op_sel_hi:[1,1,1] neg_lo:[1,0,0] neg_hi:[1,0,0]
  v_pk_fma_f32 v[140:141], v[190:191], v[54:55], v[140:141] op_sel:[1,0,0] op_sel_hi:[1,1,1]
  v_permlane16_swap_b32 v16, v18
  v_permlane16_swap_b32 v17, v19
  buffer_store_dwordx4 v[16:19], v58, s[12:15], s87 offen sc1
  s_add_u32 s87, s87, 1048576
  v_cvt_pk_bf16_f32 v20, v104, v105
  v_cvt_pk_bf16_f32 v21, -v140, -v141
  v_pk_fma_f32 v[106:107], v[190:191], v[104:105], v[106:107] op_sel:[0,0,0] op_sel_hi:[0,1,1]
  v_pk_fma_f32 v[142:143], v[190:191], v[140:141], v[142:143] op_sel:[0,0,0] op_sel_hi:[0,1,1]
  v_pk_fma_f32 v[106:107], v[190:191], v[140:141], v[106:107] op_sel:[1,0,0] op_sel_hi:[1,1,1] neg_lo:[1,0,0] neg_hi:[1,0,0]
  v_pk_fma_f32 v[142:143], v[190:191], v[104:105], v[142:143] op_sel:[1,0,0] op_sel_hi:[1,1,1]
  v_cvt_pk_bf16_f32 v22, v106, v107
  v_cvt_pk_bf16_f32 v23, -v142, -v143
  v_pk_fma_f32 v[108:109], v[190:191], v[106:107], v[108:109] op_sel:[0,0,0] op_sel_hi:[0,1,1]
  v_pk_fma_f32 v[144:145], v[190:191], v[142:143], v[144:145] op_sel:[0,0,0] op_sel_hi:[0,1,1]
  v_permlane32_swap_b32 v20, v21
  v_permlane32_swap_b32 v22, v23
  v_pk_fma_f32 v[108:109], v[190:191], v[142:143], v[108:109] op_sel:[1,0,0] op_sel_hi:[1,1,1] neg_lo:[1,0,0] neg_hi:[1,0,0]
  v_pk_fma_f32 v[144:145], v[190:191], v[106:107], v[144:145] op_sel:[1,0,0] op_sel_hi:[1,1,1]
  v_permlane16_swap_b32 v20, v22
  v_permlane16_swap_b32 v21, v23
  buffer_store_dwordx4 v[20:23], v58, s[12:15], s87 offen sc1
  s_add_u32 s87, s87, 1048576
  v_cvt_pk_bf16_f32 v68, v108, v109
  v_cvt_pk_bf16_f32 v69, -v144, -v145
  v_pk_fma_f32 v[110:111], v[190:191], v[108:109], v[110:111] op_sel:[0,0,0] op_sel_hi:[0,1,1]
  v_pk_fma_f32 v[146:147], v[190:191], v[144:145], v[146:147] op_sel:[0,0,0] op_sel_hi:[0,1,1]
  v_pk_fma_f32 v[110:111], v[190:191], v[144:145], v[110:111] op_sel:[1,0,0] op_sel_hi:[1,1,1] neg_lo:[1,0,0] neg_hi:[1,0,0]
  v_pk_fma_f32 v[146:147], v[190:191], v[108:109], v[146:147] op_sel:[1,0,0] op_sel_hi:[1,1,1]
  v_cvt_pk_bf16_f32 v70, v110, v111
  v_cvt_pk_bf16_f32 v71, -v146, -v147
  v_pk_fma_f32 v[112:113], v[190:191], v[110:111], v[112:113] op_sel:[0,0,0] op_sel_hi:[0,1,1]
  v_pk_fma_f32 v[148:149], v[190:191], v[146:147], v[148:149] op_sel:[0,0,0] op_sel_hi:[0,1,1]
  v_permlane32_swap_b32 v68, v69
  v_permlane32_swap_b32 v70, v71
  v_pk_fma_f32 v[112:113], v[190:191], v[146:147], v[112:113] op_sel:[1,0,0] op_sel_hi:[1,1,1] neg_lo:[1,0,0] neg_hi:[1,0,0]
  v_pk_fma_f32 v[148:149], v[190:191], v[110:111], v[148:149] op_sel:[1,0,0] op_sel_hi:[1,1,1]
  v_permlane16_swap_b32 v68, v70
  v_permlane16_swap_b32 v69, v71
  buffer_store_dwordx4 v[68:71], v58, s[12:15], s87 offen sc1
  s_add_u32 s87, s87, 1048576
  v_cvt_pk_bf16_f32 v16, v112, v113
  v_cvt_pk_bf16_f32 v17, -v148, -v149
  v_pk_fma_f32 v[114:115], v[190:191], v[112:113], v[114:115] op_sel:[0,0,0] op_sel_hi:[0,1,1]
  v_pk_fma_f32 v[150:151], v[190:191], v[148:149], v[150:151] op_sel:[0,0,0] op_sel_hi:[0,1,1]
  v_pk_fma_f32 v[114:115], v[190:191], v[148:149], v[114:115] op_sel:[1,0,0] op_sel_hi:[1,1,1] neg_lo:[1,0,0] neg_hi:[1,0,0]
  v_pk_fma_f32 v[150:151], v[190:191], v[112:113], v[150:151] op_sel:[1,0,0] op_sel_hi:[1,1,1]
  v_cvt_pk_bf16_f32 v18, v114, v115
  v_cvt_pk_bf16_f32 v19, -v150, -v151
  v_pk_fma_f32 v[116:117], v[190:191], v[114:115], v[116:117] op_sel:[0,0,0] op_sel_hi:[0,1,1]
  v_pk_fma_f32 v[152:153], v[190:191], v[150:151], v[152:153] op_sel:[0,0,0] op_sel_hi:[0,1,1]
  v_permlane32_swap_b32 v16, v17
  v_permlane32_swap_b32 v18, v19
  v_pk_fma_f32 v[116:117], v[190:191], v[150:151], v[116:117] op_sel:[1,0,0] op_sel_hi:[1,1,1] neg_lo:[1,0,0] neg_hi:[1,0,0]
  v_pk_fma_f32 v[152:153], v[190:191], v[114:115], v[152:153] op_sel:[1,0,0] op_sel_hi:[1,1,1]
  v_permlane16_swap_b32 v16, v18
  v_permlane16_swap_b32 v17, v19
  buffer_store_dwordx4 v[16:19], v58, s[12:15], s87 offen sc1
  s_add_u32 s87, s87, 1048576
  v_cvt_pk_bf16_f32 v20, v116, v117
  v_cvt_pk_bf16_f32 v21, -v152, -v153
  v_pk_fma_f32 v[118:119], v[190:191], v[116:117], v[118:119] op_sel:[0,0,0] op_sel_hi:[0,1,1]
  v_pk_fma_f32 v[154:155], v[190:191], v[152:153], v[154:155] op_sel:[0,0,0] op_sel_hi:[0,1,1]
  v_pk_fma_f32 v[118:119], v[190:191], v[152:153], v[118:119] op_sel:[1,0,0] op_sel_hi:[1,1,1] neg_lo:[1,0,0] neg_hi:[1,0,0]
  v_pk_fma_f32 v[154:155], v[190:191], v[116:117], v[154:155] op_sel:[1,0,0] op_sel_hi:[1,1,1]
  v_cvt_pk_bf16_f32 v22, v118, v119
  v_cvt_pk_bf16_f32 v23, -v154, -v155
  v_permlane32_swap_b32 v20, v21
  s_nop 0
  v_permlane32_swap_b32 v22, v23
  s_nop 1
  v_permlane16_swap_b32 v20, v22
  v_permlane16_swap_b32 v21, v23
  buffer_store_dwordx4 v[20:23], v58, s[12:15], s87 offen sc1
  s_cmp_lg_u32 s4, 0
  s_cbranch_scc1 gated_mix__spectral_gfnet__ssm_conv_s5__prompt_kernel_skip33
  s_mul_i32 exec_lo, s86, 0x300
  s_or_b32 exec_lo, exec_lo, 0xff
  s_mov_b32 exec_hi, 0
  ds_read_u16_d16_hi v56, v189
  ds_read_u16_d16_hi v57, v189 offset:1024
  s_waitcnt lgkmcnt(1)
  v_add_f32 v56, v56, v210
  s_waitcnt lgkmcnt(0)
  v_sub_f32 v57, v57, v211
  v_mul_f32 v56, 0.5, v56
  v_mul_f32 v57, 0.5, v57
  v_cvt_pk_bf16_f32 v56, v56, v57
  ds_write_b16 v189, v56
  ds_write_b16_d16_hi v189, v56 offset:1024
  s_mov_b64 exec, -1
gated_mix__spectral_gfnet__ssm_conv_s5__prompt_kernel_skip33:
  s_cmp_eq_u32 s86, 0
  s_cbranch_scc1 gated_mix__spectral_gfnet__ssm_conv_s5__prompt_kernel_skip34
  v_add_u32 v64, 147456, v65
  ds_read_u16_d16_hi v56, v64 offset:0
  ds_read_u16_d16_hi v68, v64 offset:1024
  ds_read_u16_d16_hi v57, v64 offset:128
  ds_read_u16_d16_hi v69, v64 offset:1152
  ds_read_u16_d16_hi v58, v64 offset:256
  ds_read_u16_d16_hi v70, v64 offset:1280
  ds_read_u16_d16_hi v59, v64 offset:384
  ds_read_u16_d16_hi v71, v64 offset:1408
gated_mix__spectral_gfnet__ssm_conv_s5__prompt_kernel_skip34:
  ds_read_u16_d16_hi v8, v65 offset:0
  ds_read_u16_d16_hi v12, v65 offset:1024
  ds_read_u16_d16_hi v9, v65 offset:128
  ds_read_u16_d16_hi v13, v65 offset:1152
  ds_read_u16_d16_hi v10, v65 offset:256
  ds_read_u16_d16_hi v14, v65 offset:1280
  ds_read_u16_d16_hi v11, v65 offset:384
  ds_read_u16_d16_hi v15, v65 offset:1408
  ds_read_u16_d16_hi v16, v65 offset:16384
  ds_read_u16_d16_hi v20, v65 offset:17408
  ds_read_u16_d16_hi v17, v65 offset:16512
  ds_read_u16_d16_hi v21, v65 offset:17536
  ds_read_u16_d16_hi v18, v65 offset:16640
  ds_read_u16_d16_hi v22, v65 offset:17664
  ds_read_u16_d16_hi v19, v65 offset:16768
  ds_read_u16_d16_hi v23, v65 offset:17792
  v_add_u32 v64, 81920, v65
  ds_read_u16_d16_hi v40, v64 offset:0
  ds_read_u16_d16_hi v44, v64 offset:1024
  ds_read_u16_d16_hi v41, v64 offset:128
  ds_read_u16_d16_hi v45, v64 offset:1152
  ds_read_u16_d16_hi v42, v64 offset:256
  ds_read_u16_d16_hi v46, v64 offset:1280
  ds_read_u16_d16_hi v43, v64 offset:384
  ds_read_u16_d16_hi v47, v64 offset:1408
  ds_read_u16_d16_hi v48, v65 offset:32768
  ds_read_u16_d16_hi v52, v65 offset:33792
  ds_read_u16_d16_hi v49, v65 offset:32896
  ds_read_u16_d16_hi v53, v65 offset:33920
  ds_read_u16_d16_hi v50, v65 offset:33024
  ds_read_u16_d16_hi v54, v65 offset:34048
  ds_read_u16_d16_hi v51, v65 offset:33152
  ds_read_u16_d16_hi v55, v65 offset:34176
  v_xor_b32 v130, 0x30000, v130
  v_xor_b32 v131, 0x30000, v131
  ds_read_b128 a[0:3], v130 offset:0
  ds_read_b128 a[4:7], v131 offset:0
  ds_read_b128 a[8:11], v130 offset:2048
  ds_read_b128 a[12:15], v131 offset:2048
  v_xor_b32 v130, 0x30000, v130
  v_xor_b32 v131, 0x30000, v131
  ds_read_b128 a[16:19], v130 offset:0
  ds_read_b128 a[20:23], v131 offset:0
  ds_read_b128 a[24:27], v130 offset:2048
  ds_read_b128 a[28:31], v131 offset:2048
  s_waitcnt vmcnt(8)
  ds_read_b128 a[32:35], v130 offset:49152
  ds_read_b128 a[36:39], v131 offset:49152
  ds_read_b128 a[40:43], v130 offset:51200
  ds_read_b128 a[44:47], v131 offset:51200
  s_waitcnt lgkmcnt(12)
  v_pk_mul_f32 v[12:13], v[66:67], v[12:13] op_sel_hi:[0,1]
  v_pk_mul_f32 v[14:15], v[66:67], v[14:15] op_sel_hi:[0,1]
  v_pk_mul_f32 v[20:21], v[66:67], v[20:21] op_sel_hi:[0,1]
  v_pk_mul_f32 v[22:23], v[66:67], v[22:23] op_sel_hi:[0,1]
  v_pk_mul_f32 v[44:45], v[66:67], v[44:45] op_sel_hi:[0,1]
  v_pk_mul_f32 v[46:47], v[66:67], v[46:47] op_sel_hi:[0,1]
  v_pk_mul_f32 v[52:53], v[66:67], v[52:53] op_sel_hi:[0,1]
  v_pk_mul_f32 v[54:55], v[66:67], v[54:55] op_sel_hi:[0,1]
  v_pk_mul_f32 v[68:69], v[66:67], v[68:69] op_sel_hi:[0,1]
  v_pk_mul_f32 v[70:71], v[66:67], v[70:71] op_sel_hi:[0,1]
  s_cmp_lg_u32 s3, 3
  s_cbranch_scc1 gated_mix__spectral_gfnet__ssm_conv_s5__prompt_kernel_skip36
  s_getpc_b64 s[6:7]
gated_mix__spectral_gfnet__ssm_conv_s5__prompt_kernel_pc35:
  s_lshr_b32 s29, s2, 3
  s_mul_i32 s29, s29, 512
  v_min_u32 v64, 3, v1
  v_lshl_add_u32 v64, v64, 7, s29
  v_min_u32 v64, gated_mix__spectral_gfnet__ssm_conv_s5__prompt_kernel_end-gated_mix__spectral_gfnet__ssm_conv_s5__prompt_kernel_pc35, v64
  v_mov_b32 v65, 0
  v_lshl_add_u64 v[64:65], v[64:65], 0, s[6:7]
  global_load_dword v4, v[64:65], off
gated_mix__spectral_gfnet__ssm_conv_s5__prompt_kernel_skip36:
  s_barrier
  s_lshr_b32 s29, s41, 3
  s_lshl2_add_u32 s29, s29, s3
  s_lshl_b32 s29, s29, 12
  v_lshl_add_u32 v6, v1, 7, s29
  s_add_u32 m0, s43, 98304
  s_nop 0
  buffer_load_dwordx4 v124, s[72:75], s28 offen offset:0 lds
  s_and_b32 s29, s3, 1
  s_lshl_b32 s29, s29, 2
  v_xor_b32 v65, s29, v1
  s_lshl_b32 s29, s3, 12
  s_add_u32 s29, s29, 49152
  v_lshl_add_u32 v66, v65, 4, s29
  v_xor_b32 v65, 0, v66
  ds_read_b128 v[72:75], v65 offset:0
  v_xor_b32 v65, 16, v66
  ds_read_b128 v[88:91], v65 offset:1024
  v_xor_b32 v65, 32, v66
  ds_read_b128 v[92:95], v65 offset:2048
  v_xor_b32 v65, 48, v66
  ds_read_b128 v[96:99], v65 offset:3072
  s_waitcnt lgkmcnt(3)
  v_mfma_f32_16x16x32_bf16 v[100:103], v[72:75], v[76:79], 0
  v_mfma_f32_16x16x32_bf16 v[104:107], v[72:75], v[80:83], 0
  buffer_load_dwordx4 v125, s[72:75], s28 offen offset:1024 lds
  s_waitcnt lgkmcnt(2)
  v_mfma_f32_16x16x32_bf16 v[108:111], v[88:91], v[76:79], 0
  v_mfma_f32_16x16x32_bf16 v[112:115], v[88:91], v[80:83], 0
  s_waitcnt lgkmcnt(1)
  v_mfma_f32_16x16x32_bf16 v[116:119], v[92:95], v[76:79], 0
  v_mfma_f32_16x16x32_bf16 v[120:123], v[92:95], v[80:83], 0
  s_waitcnt lgkmcnt(0)
  v_mfma_f32_16x16x32_bf16 v[140:143], v[96:99], v[76:79], 0
  s_add_u32 m0, s43, 100352
  s_nop 0
  buffer_load_dwordx4 v126, s[72:75], s28 offen offset:0 lds
  v_mfma_f32_16x16x32_bf16 v[144:147], v[96:99], v[80:83], 0
  v_pk_mul_f32 v[148:149], v[100:101], v[84:85]
  v_pk_mul_f32 v[150:151], v[104:105], v[84:85]
  v_pk_fma_f32 v[148:149], v[104:105], v[132:133], v[148:149]
  v_pk_fma_f32 v[150:151], v[100:101], v[132:133], v[150:151] neg_lo:[0,1,0] neg_hi:[0,1,0]
  v_cvt_pk_bf16_f32 v72, v148, v150
  v_cvt_pk_bf16_f32 v73, v149, v151
  v_pk_mul_f32 v[148:149], v[102:103], v[86:87]
  v_pk_mul_f32 v[150:151], v[106:107], v[86:87]
  v_pk_fma_f32 v[148:149], v[106:107], v[134:135], v[148:149]
  v_pk_fma_f32 v[150:151], v[102:103], v[134:135], v[150:151] neg_lo:[0,1,0] neg_hi:[0,1,0]
  v_cvt_pk_bf16_f32 v74, v148, v150
  v_cvt_pk_bf16_f32 v75, v149, v151
  v_pk_mul_f32 v[148:149], v[108:109], v[84:85]
  v_pk_mul_f32 v[150:151], v[112:113], v[84:85]
  v_pk_fma_f32 v[148:149], v[112:113], v[132:133], v[148:149]
  v_pk_fma_f32 v[150:151], v[108:109], v[132:133], v[150:151] neg_lo:[0,1,0] neg_hi:[0,1,0]
  buffer_load_dwordx4 v127, s[72:75], s28 offen offset:1024 lds
  s_add_u32 s28, s28, 128
  s_and_b32 s28, s28, 0x3ff
  v_cvt_pk_bf16_f32 v88, v148, v150
  v_cvt_pk_bf16_f32 v89, v149, v151
  v_pk_mul_f32 v[148:149], v[110:111], v[86:87]
  v_pk_mul_f32 v[150:151], v[114:115], v[86:87]
  v_pk_fma_f32 v[148:149], v[114:115], v[134:135], v[148:149]
  v_pk_fma_f32 v[150:151], v[110:111], v[134:135], v[150:151] neg_lo:[0,1,0] neg_hi:[0,1,0]
  v_cvt_pk_bf16_f32 v90, v148, v150
  v_cvt_pk_bf16_f32 v91, v149, v151
  v_mfma_f32_16x16x32_bf16 v[100:103], a[224:227], v[72:75], 0
  v_mfma_f32_16x16x32_bf16 v[104:107], a[228:231], v[72:75], 0
  v_pk_mul_f32 v[148:149], v[116:117], v[84:85]
  v_pk_mul_f32 v[150:151], v[120:121], v[84:85]
  v_pk_fma_f32 v[148:149], v[120:121], v[132:133], v[148:149]
  v_pk_fma_f32 v[150:151], v[116:117], v[132:133], v[150:151] neg_lo:[0,1,0] neg_hi:[0,1,0]
  s_add_u32 m0, s43, 131072
  s_nop 0
  buffer_load_dwordx4 v124, s[68:71], s28 offen offset:0 lds
  v_cvt_pk_bf16_f32 v92, v148, v150
  v_cvt_pk_bf16_f32 v93, v149, v151
  v_pk_mul_f32 v[148:149], v[118:119], v[86:87]
  v_pk_mul_f32 v[150:151], v[122:123], v[86:87]
  v_pk_fma_f32 v[148:149], v[122:123], v[134:135], v[148:149]
  v_pk_fma_f32 v[150:151], v[118:119], v[134:135], v[150:151] neg_lo:[0,1,0] neg_hi:[0,1,0]
  v_cvt_pk_bf16_f32 v94, v148, v150
  v_cvt_pk_bf16_f32 v95, v149, v151
  v_mfma_f32_16x16x32_bf16 v[108:111], a[224:227], v[88:91], 0
  v_mfma_f32_16x16x32_bf16 v[112:115], a[228:231], v[88:91], 0
  v_pk_mul_f32 v[148:149], v[140:141], v[84:85]
  v_pk_mul_f32 v[150:151], v[144:145], v[84:85]
  v_pk_fma_f32 v[148:149], v[144:145], v[132:133], v[148:149]
  v_pk_fma_f32 v[150:151], v[140:141], v[132:133], v[150:151] neg_lo:[0,1,0] neg_hi:[0,1,0]
  buffer_load_dwordx4 v125, s[68:71], s28 offen offset:1024 lds
  v_cvt_pk_bf16_f32 v96, v148, v150
  v_cvt_pk_bf16_f32 v97, v149, v151
  v_pk_mul_f32 v[148:149], v[142:143], v[86:87]
  v_pk_mul_f32 v[150:151], v[146:147], v[86:87]
  v_pk_fma_f32 v[148:149], v[146:147], v[134:135], v[148:149]
  v_pk_fma_f32 v[150:151], v[142:143], v[134:135], v[150:151] neg_lo:[0,1,0] neg_hi:[0,1,0]
  v_cvt_pk_bf16_f32 v98, v148, v150
  v_cvt_pk_bf16_f32 v99, v149, v151
  v_mfma_f32_16x16x32_bf16 v[116:119], a[224:227], v[92:95], 0
  v_mfma_f32_16x16x32_bf16 v[120:123], a[228:231], v[92:95], 0
  v_mfma_f32_16x16x32_bf16 v[140:143], a[224:227], v[96:99], 0
  s_add_u32 m0, s43, 133120
  s_nop 0
  buffer_load_dwordx4 v126, s[68:71], s28 offen offset:0 lds
  v_mfma_f32_16x16x32_bf16 v[144:147], a[228:231], v[96:99], 0
  s_waitcnt vmcnt(7)
  s_barrier
  s_cmp_lg_u32 s3, 0
  s_cbranch_scc1 gated_mix__spectral_gfnet__ssm_conv_s5__prompt_kernel_skip37
  s_mov_b64 exec, 65535
  buffer_store_dword v5, v39, s[16:19], s57 offen sc1
  s_mov_b64 exec, -1
gated_mix__spectral_gfnet__ssm_conv_s5__prompt_kernel_skip37:
  s_cmp_eq_u32 s10, 0
  s_cbranch_scc1 gated_mix__spectral_gfnet__ssm_conv_s5__prompt_kernel_skip38
  v_pk_mul_f32 v[148:149], v[100:101], v[56:57]
  v_pk_mul_f32 v[150:151], v[104:105], v[56:57]
  v_pk_fma_f32 v[148:149], v[104:105], v[68:69], v[148:149] neg_lo:[0,1,0] neg_hi:[0,1,0]
  v_pk_fma_f32 v[150:151], v[100:101], v[68:69], v[150:151]
  v_cvt_pk_bf16_f32 v152, v148, v150
  v_cvt_pk_bf16_f32 v153, v149, v151
  v_pk_mul_f32 v[148:149], v[102:103], v[58:59]
  v_pk_mul_f32 v[150:151], v[106:107], v[58:59]
  v_pk_fma_f32 v[148:149], v[106:107], v[70:71], v[148:149] neg_lo:[0,1,0] neg_hi:[0,1,0]
  v_pk_fma_f32 v[150:151], v[102:103], v[70:71], v[150:151]
  v_cvt_pk_bf16_f32 v154, v148, v150
  v_cvt_pk_bf16_f32 v155, v149, v151
  s_nop 1
  v_mfma_f32_16x16x32_bf16 v[56:59], v[152:155], a[232:235], 0
  v_mfma_f32_16x16x32_bf16 v[68:71], v[152:155], a[236:239], 0
  s_nop 6
  v_pk_mul_f32 v[148:149], v[56:57], v[136:137]
  v_pk_mul_f32 v[150:151], v[68:69], v[136:137]
  v_pk_fma_f32 v[148:149], v[68:69], v[184:185], v[148:149] neg_lo:[0,1,0] neg_hi:[0,1,0]
  v_pk_fma_f32 v[150:151], v[56:57], v[184:185], v[150:151]
  v_cvt_pk_bf16_f32 v152, v148, v150
  v_cvt_pk_bf16_f32 v153, v149, v151
  v_pk_mul_f32 v[148:149], v[58:59], v[138:139]
  v_pk_mul_f32 v[150:151], v[70:71], v[138:139]
  v_pk_fma_f32 v[148:149], v[70:71], v[186:187], v[148:149] neg_lo:[0,1,0] neg_hi:[0,1,0]
  v_pk_fma_f32 v[150:151], v[58:59], v[186:187], v[150:151]
  v_cvt_pk_bf16_f32 v154, v148, v150
  v_cvt_pk_bf16_f32 v155, v149, v151
  s_nop 1
  v_mfma_f32_16x16x32_bf16 v[56:59], a[240:243], v[152:155], 0
  v_mfma_f32_16x16x32_bf16 v[68:71], a[244:247], v[152:155], 0
gated_mix__spectral_gfnet__ssm_conv_s5__prompt_kernel_skip38:
  v_pk_mul_f32 v[148:149], v[100:101], v[8:9]
  v_pk_mul_f32 v[150:151], v[104:105], v[8:9]
  v_pk_fma_f32 v[148:149], v[104:105], v[12:13], v[148:149] neg_lo:[0,1,0] neg_hi:[0,1,0]
  v_pk_fma_f32 v[150:151], v[100:101], v[12:13], v[150:151]
  v_cvt_pk_bf16_f32 v72, v148, v150
  v_cvt_pk_bf16_f32 v73, v149, v151
  v_pk_mul_f32 v[148:149], v[102:103], v[10:11]
  v_pk_mul_f32 v[150:151], v[106:107], v[10:11]
  v_pk_fma_f32 v[148:149], v[106:107], v[14:15], v[148:149] neg_lo:[0,1,0] neg_hi:[0,1,0]
  v_pk_fma_f32 v[150:151], v[102:103], v[14:15], v[150:151]
  v_cvt_pk_bf16_f32 v74, v148, v150
  buffer_load_dwordx4 v127, s[68:71], s28 offen offset:1024 lds
  v_cvt_pk_bf16_f32 v75, v149, v151
  v_pk_mul_f32 v[148:149], v[108:109], v[16:17]
  v_pk_mul_f32 v[150:151], v[112:113], v[16:17]
  v_pk_fma_f32 v[148:149], v[112:113], v[20:21], v[148:149] neg_lo:[0,1,0] neg_hi:[0,1,0]
  v_pk_fma_f32 v[150:151], v[108:109], v[20:21], v[150:151]
  v_cvt_pk_bf16_f32 v88, v148, v150
  v_cvt_pk_bf16_f32 v89, v149, v151
  v_pk_mul_f32 v[148:149], v[110:111], v[18:19]
  v_pk_mul_f32 v[150:151], v[114:115], v[18:19]
  v_pk_fma_f32 v[148:149], v[114:115], v[22:23], v[148:149] neg_lo:[0,1,0] neg_hi:[0,1,0]
  v_pk_fma_f32 v[150:151], v[110:111], v[22:23], v[150:151]
  v_cvt_pk_bf16_f32 v90, v148, v150
  v_cvt_pk_bf16_f32 v91, v149, v151
  v_mfma_f32_16x16x32_bf16 v[100:103], v[72:75], a[232:235], 0
  v_mfma_f32_16x16x32_bf16 v[104:107], v[72:75], a[236:239], 0
  s_add_u32 m0, s43, 65536
  s_nop 0
  buffer_load_dwordx4 v124, s[72:75], s28 offen offset:0 lds
  v_pk_mul_f32 v[148:149], v[116:117], v[40:41]
  v_pk_mul_f32 v[150:151], v[120:121], v[40:41]
  v_pk_fma_f32 v[148:149], v[120:121], v[44:45], v[148:149] neg_lo:[0,1,0] neg_hi:[0,1,0]
  v_pk_fma_f32 v[150:151], v[116:117], v[44:45], v[150:151]
  v_cvt_pk_bf16_f32 v92, v148, v150
  v_cvt_pk_bf16_f32 v93, v149, v151
  v_pk_mul_f32 v[148:149], v[118:119], v[42:43]
  v_pk_mul_f32 v[150:151], v[122:123], v[42:43]
  v_pk_fma_f32 v[148:149], v[122:123], v[46:47], v[148:149] neg_lo:[0,1,0] neg_hi:[0,1,0]
  v_pk_fma_f32 v[150:151], v[118:119], v[46:47], v[150:151]
  v_cvt_pk_bf16_f32 v94, v148, v150
  v_cvt_pk_bf16_f32 v95, v149, v151
  v_mfma_f32_16x16x32_bf16 v[108:111], v[88:91], a[232:235], 0
  v_mfma_f32_16x16x32_bf16 v[112:115], v[88:91], a[236:239], 0
  buffer_load_dwordx4 v125, s[72:75], s28 offen offset:1024 lds
  v_pk_mul_f32 v[148:149], v[140:141], v[48:49]
  v_pk_mul_f32 v[150:151], v[144:145], v[48:49]
  v_pk_fma_f32 v[148:149], v[144:145], v[52:53], v[148:149] neg_lo:[0,1,0] neg_hi:[0,1,0]
  v_pk_fma_f32 v[150:151], v[140:141], v[52:53], v[150:151]
  v_cvt_pk_bf16_f32 v96, v148, v150
  v_cvt_pk_bf16_f32 v97, v149, v151
  v_pk_mul_f32 v[148:149], v[142:143], v[50:51]
  v_pk_mul_f32 v[150:151], v[146:147], v[50:51]
  v_pk_fma_f32 v[148:149], v[146:147], v[54:55], v[148:149] neg_lo:[0,1,0] neg_hi:[0,1,0]
  v_pk_fma_f32 v[150:151], v[142:143], v[54:55], v[150:151]
  v_cvt_pk_bf16_f32 v98, v148, v150
  v_cvt_pk_bf16_f32 v99, v149, v151
  v_mfma_f32_16x16x32_bf16 v[116:119], v[92:95], a[232:235], 0
  v_mfma_f32_16x16x32_bf16 v[120:123], v[92:95], a[236:239], 0
  s_add_u32 m0, s43, 67584
  s_nop 0
  buffer_load_dwordx4 v126, s[72:75], s28 offen offset:0 lds
  v_mfma_f32_16x16x32_bf16 v[140:143], v[96:99], a[232:235], 0
  v_mfma_f32_16x16x32_bf16 v[144:147], v[96:99], a[236:239], 0
  v_pk_mul_f32 v[148:149], v[100:101], v[136:137]
  v_pk_mul_f32 v[150:151], v[104:105], v[136:137]
  v_pk_fma_f32 v[148:149], v[104:105], v[184:185], v[148:149] neg_lo:[0,1,0] neg_hi:[0,1,0]
  v_pk_fma_f32 v[150:151], v[100:101], v[184:185], v[150:151]
  v_cvt_pk_bf16_f32 v72, v148, v150
  v_cvt_pk_bf16_f32 v73, v149, v151
  v_pk_mul_f32 v[148:149], v[102:103], v[138:139]
  v_pk_mul_f32 v[150:151], v[106:107], v[138:139]
  v_pk_fma_f32 v[148:149], v[106:107], v[186:187], v[148:149] neg_lo:[0,1,0] neg_hi:[0,1,0]
  v_pk_fma_f32 v[150:151], v[102:103], v[186:187], v[150:151]
  v_cvt_pk_bf16_f32 v74, v148, v150
  v_cvt_pk_bf16_f32 v75, v149, v151
  buffer_load_dwordx4 v127, s[72:75], s28 offen offset:1024 lds
  s_add_u32 s28, s28, 128
  s_and_b32 s28, s28, 0x3ff
  v_pk_mul_f32 v[148:149], v[108:109], v[136:137]
  v_pk_mul_f32 v[150:151], v[112:113], v[136:137]
  v_pk_fma_f32 v[148:149], v[112:113], v[184:185], v[148:149] neg_lo:[0,1,0] neg_hi:[0,1,0]
  v_pk_fma_f32 v[150:151], v[108:109], v[184:185], v[150:151]
  v_cvt_pk_bf16_f32 v88, v148, v150
  v_cvt_pk_bf16_f32 v89, v149, v151
  v_pk_mul_f32 v[148:149], v[110:111], v[138:139]
  v_pk_mul_f32 v[150:151], v[114:115], v[138:139]
  v_pk_fma_f32 v[148:149], v[114:115], v[186:187], v[148:149] neg_lo:[0,1,0] neg_hi:[0,1,0]
  v_pk_fma_f32 v[150:151], v[110:111], v[186:187], v[150:151]
  v_cvt_pk_bf16_f32 v90, v148, v150
  v_cvt_pk_bf16_f32 v91, v149, v151
  v_mfma_f32_16x16x32_bf16 v[100:103], a[240:243], v[72:75], 0
  v_mfma_f32_16x16x32_bf16 v[104:107], a[244:247], v[72:75], 0
  s_add_u32 m0, s43, 114688
  s_nop 0
  buffer_load_dwordx4 v124, s[68:71], s28 offen offset:0 lds
  v_pk_mul_f32 v[148:149], v[116:117], v[136:137]
  v_pk_mul_f32 v[150:151], v[120:121], v[136:137]
  v_pk_fma_f32 v[148:149], v[120:121], v[184:185], v[148:149] neg_lo:[0,1,0] neg_hi:[0,1,0]
  v_pk_fma_f32 v[150:151], v[116:117], v[184:185], v[150:151]
  v_cvt_pk_bf16_f32 v92, v148, v150
  v_cvt_pk_bf16_f32 v93, v149, v151
  v_pk_mul_f32 v[148:149], v[118:119], v[138:139]
  v_pk_mul_f32 v[150:151], v[122:123], v[138:139]
  v_pk_fma_f32 v[148:149], v[122:123], v[186:187], v[148:149] neg_lo:[0,1,0] neg_hi:[0,1,0]
  v_pk_fma_f32 v[150:151], v[118:119], v[186:187], v[150:151]
  v_cvt_pk_bf16_f32 v94, v148, v150
  v_cvt_pk_bf16_f32 v95, v149, v151
  v_mfma_f32_16x16x32_bf16 v[108:111], a[240:243], v[88:91], 0
  v_mfma_f32_16x16x32_bf16 v[112:115], a[244:247], v[88:91], 0
  buffer_load_dwordx4 v125, s[68:71], s28 offen offset:1024 lds
  v_pk_mul_f32 v[148:149], v[140:141], v[136:137]
  v_pk_mul_f32 v[150:151], v[144:145], v[136:137]
  v_pk_fma_f32 v[148:149], v[144:145], v[184:185], v[148:149] neg_lo:[0,1,0] neg_hi:[0,1,0]
  v_pk_fma_f32 v[150:151], v[140:141], v[184:185], v[150:151]
  v_cvt_pk_bf16_f32 v96, v148, v150
  v_cvt_pk_bf16_f32 v97, v149, v151
  v_pk_mul_f32 v[148:149], v[142:143], v[138:139]
  v_pk_mul_f32 v[150:151], v[146:147], v[138:139]
  v_pk_fma_f32 v[148:149], v[146:147], v[186:187], v[148:149] neg_lo:[0,1,0] neg_hi:[0,1,0]
  v_pk_fma_f32 v[150:151], v[142:143], v[186:187], v[150:151]
  v_cvt_pk_bf16_f32 v98, v148, v150
  v_cvt_pk_bf16_f32 v99, v149, v151
  v_mfma_f32_16x16x32_bf16 v[116:119], a[240:243], v[92:95], 0
  v_mfma_f32_16x16x32_bf16 v[120:123], a[244:247], v[92:95], 0
  s_add_u32 m0, s43, 116736
  s_nop 0
  buffer_load_dwordx4 v126, s[68:71], s28 offen offset:0 lds
  v_mfma_f32_16x16x32_bf16 v[140:143], a[240:243], v[96:99], 0
  v_mfma_f32_16x16x32_bf16 v[144:147], a[244:247], v[96:99], 0
  v_lshlrev_b32 v65, 12, v3
  v_lshl_add_u32 v65, v2, 4, v65
  s_lshl_b32 s29, s3, 8
  s_add_u32 s29, s29, 147456
  v_add_u32 v65, s29, v65
  s_sub_u32 s29, s10, 1
  s_or_b32 s29, s29, s3
  s_cmp_lg_u32 s29, 0
  s_cbranch_scc1 gated_mix__spectral_gfnet__ssm_conv_s5__prompt_kernel_skip39
  v_mov_b32 v104, v68
  v_mov_b32 v105, v69
  v_mov_b32 v106, v70
  v_mov_b32 v107, v71
gated_mix__spectral_gfnet__ssm_conv_s5__prompt_kernel_skip39:
  v_cvt_pk_bf16_f32 v72, v100, v104
  v_cvt_pk_bf16_f32 v73, v108, v112
  v_cvt_pk_bf16_f32 v74, v116, v120
  buffer_load_dwordx4 v127, s[68:71], s28 offen offset:1024 lds
  v_cvt_pk_bf16_f32 v75, v140, v144
  ds_write_b128 v65, v[72:75] offset:0
  v_cvt_pk_bf16_f32 v88, v101, v105
  v_cvt_pk_bf16_f32 v89, v109, v113
  v_cvt_pk_bf16_f32 v90, v117, v121
  v_cvt_pk_bf16_f32 v91, v141, v145
  ds_write_b128 v65, v[88:91] offset:1024
  v_cvt_pk_bf16_f32 v92, v102, v106
  v_cvt_pk_bf16_f32 v93, v110, v114
  v_cvt_pk_bf16_f32 v94, v118, v122
  v_cvt_pk_bf16_f32 v95, v142, v146
  ds_write_b128 v65, v[92:95] offset:2048
  v_cvt_pk_bf16_f32 v96, v103, v107
  v_cvt_pk_bf16_f32 v97, v111, v115
  v_cvt_pk_bf16_f32 v98, v119, v123
  v_cvt_pk_bf16_f32 v99, v143, v147
  ds_write_b128 v65, v[96:99] offset:3072
  s_add_u32 m0, s43, 0
  s_nop 0
  buffer_load_dwordx4 v124, s[72:75], s28 offen offset:0 lds
  buffer_load_dwordx4 v125, s[72:75], s28 offen offset:1024 lds
  s_add_u32 m0, s43, 2048
  s_nop 0
  buffer_load_dwordx4 v126, s[72:75], s28 offen offset:0 lds
  buffer_load_dwordx4 v127, s[72:75], s28 offen offset:1024 lds
  s_add_u32 s28, s28, 128
  s_and_b32 s28, s28, 0x3ff
  s_add_u32 m0, s43, 16384
  s_nop 0
  buffer_load_dwordx4 v124, s[68:71], s28 offen offset:0 lds
  buffer_load_dwordx4 v125, s[68:71], s28 offen offset:1024 lds
  s_add_u32 m0, s43, 18432
  s_nop 0
  buffer_load_dwordx4 v126, s[68:71], s28 offen offset:0 lds
  buffer_load_dwordx4 v127, s[68:71], s28 offen offset:1024 lds
  s_waitcnt lgkmcnt(0)
  s_barrier
  s_lshl_b32 s29, s3, 12
  s_add_u32 s29, s29, 147456
  v_lshl_add_u32 v65, v1, 4, s29
  ds_read_b128 v[8:11], v65 offset:0
  ds_read_b128 v[12:15], v65 offset:1024
  ds_read_b128 v[16:19], v65 offset:2048
  ds_read_b128 v[20:23], v65 offset:3072
  s_mov_b32 s29, 1048576
  v_mul_lo_u32 v65, v3, s29
  v_lshl_add_u32 v65, v2, 2, v65
  s_mul_i32 s6, s3, 65536
  s_lshr_b32 s29, s37, 4
  s_lshl_b32 s29, s29, 12
  s_add_u32 s6, s6, s29
  s_lshl_b32 s29, s36, 10
  s_add_u32 s6, s6, s29
  s_and_b32 s29, s37, 15
  s_lshl_b32 s29, s29, 6
  s_add_u32 s6, s6, s29
  s_waitcnt lgkmcnt(3)
  v_mfma_f32_16x16x32_bf16 v[40:43], a[248:251], v[8:11], 0
  v_mfma_f32_16x16x32_bf16 v[44:47], a[252:255], v[8:11], 0
  s_waitcnt lgkmcnt(2)
  v_mfma_f32_16x16x32_bf16 v[48:51], a[248:251], v[12:15], 0
  v_mfma_f32_16x16x32_bf16 v[52:55], a[252:255], v[12:15], 0
  s_waitcnt lgkmcnt(1)
  v_mfma_f32_16x16x32_bf16 v[56:59], a[248:251], v[16:19], 0
  v_mfma_f32_16x16x32_bf16 v[68:71], a[252:255], v[16:19], 0
  s_waitcnt lgkmcnt(0)
  v_mfma_f32_16x16x32_bf16 v[72:75], a[248:251], v[20:23], 0
  v_mfma_f32_16x16x32_bf16 v[76:79], a[252:255], v[20:23], 0
  v_cvt_pk_bf16_f32 v8, v40, v44
  v_cvt_pk_bf16_f32 v9, v41, v45
  v_cvt_pk_bf16_f32 v10, v42, v46
  v_cvt_pk_bf16_f32 v11, v43, v47
  v_cvt_pk_bf16_f32 v12, v48, v52
  v_cvt_pk_bf16_f32 v13, v49, v53
  v_cvt_pk_bf16_f32 v14, v50, v54
  v_cvt_pk_bf16_f32 v15, v51, v55
  v_cvt_pk_bf16_f32 v16, v56, v68
  v_cvt_pk_bf16_f32 v17, v57, v69
  v_cvt_pk_bf16_f32 v18, v58, v70
  v_cvt_pk_bf16_f32 v19, v59, v71
  v_cvt_pk_bf16_f32 v20, v72, v76
  v_cvt_pk_bf16_f32 v21, v73, v77
  v_cvt_pk_bf16_f32 v22, v74, v78
  v_cvt_pk_bf16_f32 v23, v75, v79
  s_mov_b64 exec, 0xffffffff
  buffer_load_dword v64, v6, s[16:19], s57 offen sc1
  s_mov_b64 exec, -1
  s_add_u32 s20, s34, 5242880
  s_addc_u32 s21, s35, 0
  s_mov_b32 s22, 4194304
  s_mov_b32 s23, 0x20000
  s_waitcnt vmcnt(21)
  ds_read_b128 a[48:51], v130 offset:32768
  ds_read_b128 a[52:55], v131 offset:32768
  ds_read_b128 a[56:59], v130 offset:34816
  ds_read_b128 a[60:63], v131 offset:34816
  v_xor_b32 v130, 0x30000, v130
  v_xor_b32 v131, 0x30000, v131
  s_waitcnt vmcnt(17)
  ds_read_b128 a[64:67], v130 offset:0
  ds_read_b128 a[68:71], v131 offset:0
  ds_read_b128 a[72:75], v130 offset:2048
  ds_read_b128 a[76:79], v131 offset:2048
  v_xor_b32 v130, 0x30000, v130
  v_xor_b32 v131, 0x30000, v131
  s_waitcnt vmcnt(13)
  ds_read_b128 a[80:83], v130 offset:0
  ds_read_b128 a[84:87], v131 offset:0
  ds_read_b128 a[88:91], v130 offset:2048
  ds_read_b128 a[92:95], v131 offset:2048
  s_waitcnt vmcnt(9)
  ds_read_b128 a[96:99], v130 offset:49152
  ds_read_b128 a[100:103], v131 offset:49152
  ds_read_b128 a[104:107], v130 offset:51200
  ds_read_b128 a[108:111], v131 offset:51200
  s_waitcnt vmcnt(5)
  ds_read_b128 a[112:115], v128 offset:0
  ds_read_b128 a[116:119], v129 offset:0
  ds_read_b128 a[120:123], v128 offset:2048
  ds_read_b128 a[124:127], v129 offset:2048
  s_waitcnt vmcnt(1)
  ds_read_b128 a[128:131], v128 offset:16384
  ds_read_b128 a[132:135], v129 offset:16384
  ds_read_b128 a[136:139], v128 offset:18432
  ds_read_b128 a[140:143], v129 offset:18432
  buffer_store_dword v8, v65, s[20:23], s6 offen sc1
  s_add_u32 s6, s6, 262144
  buffer_store_dword v9, v65, s[20:23], s6 offen sc1
  s_add_u32 s6, s6, 262144
  buffer_store_dword v10, v65, s[20:23], s6 offen sc1
  s_add_u32 s6, s6, 262144
  buffer_store_dword v11, v65, s[20:23], s6 offen sc1
  s_sub_u32 s6, s6, 770048
  buffer_store_dword v12, v65, s[20:23], s6 offen sc1
  s_add_u32 s6, s6, 262144
  buffer_store_dword v13, v65, s[20:23], s6 offen sc1
  s_add_u32 s6, s6, 262144
  buffer_store_dword v14, v65, s[20:23], s6 offen sc1
  s_add_u32 s6, s6, 262144
  buffer_store_dword v15, v65, s[20:23], s6 offen sc1
  s_sub_u32 s6, s6, 770048
  buffer_store_dword v16, v65, s[20:23], s6 offen sc1
  s_add_u32 s6, s6, 262144
  buffer_store_dword v17, v65, s[20:23], s6 offen sc1
  s_add_u32 s6, s6, 262144
  buffer_store_dword v18, v65, s[20:23], s6 offen sc1
  s_add_u32 s6, s6, 262144
  buffer_store_dword v19, v65, s[20:23], s6 offen sc1
  s_sub_u32 s6, s6, 770048
  buffer_store_dword v20, v65, s[20:23], s6 offen sc1
  s_add_u32 s6, s6, 262144
  buffer_store_dword v21, v65, s[20:23], s6 offen sc1
  s_add_u32 s6, s6, 262144
  buffer_store_dword v22, v65, s[20:23], s6 offen sc1
  s_add_u32 s6, s6, 262144
  buffer_store_dword v23, v65, s[20:23], s6 offen sc1
  s_lshr_b32 s7, s41, 3
  s_mul_i32 s6, s7, 253952
  s_lshl_b32 s29, s40, 19
  s_add_u32 s6, s6, s29
  s_lshr_b32 s7, s3, 1
  s_lshl1_add_u32 s7, s7, s3
  s_add_u32 s7, s7, 2
  s_lshl_b32 s7, s7, 12
  s_add_u32 s6, s6, s7
  v_lshl_add_u32 v65, v1, 4, s6
  s_and_b32 s29, s40, 7
  s_lshl_b32 s29, s29, 15
  s_lshl_b32 s6, s3, 12
  v_and_b32 v66, 3, v1
  v_and_b32 v67, 2, v3
  v_xor_b32 v67, v67, v66
  v_lshlrev_b32 v66, 9, v66
  v_lshl_or_b32 v66, v67, 6, v66
  v_bfe_u32 v67, v1, 2, 2
  v_lshl_or_b32 v66, v67, 4, v66
  v_and_b32 v67, 1, v3
  v_lshl_or_b32 v8, v67, 3, v66
  v_xor_b32 v9, 64, v8
  v_add_u32 v10, 0x10000, v8
  v_add_u32 v11, 0x10000, v9
  v_lshlrev_b32 v12, 16, v62
  v_and_b32 v13, 0xffff0000, v62
  v_lshlrev_b32 v14, 16, v63
  v_and_b32 v15, 0xffff0000, v63
  v_pk_mul_f32 v[12:13], v[60:61], v[12:13] op_sel_hi:[0,1]
  v_pk_mul_f32 v[14:15], v[60:61], v[14:15] op_sel_hi:[0,1]
  v_lshlrev_b32 v16, 16, v24
  v_and_b32 v17, 0xffff0000, v24
  v_lshlrev_b32 v18, 16, v25
  v_and_b32 v19, 0xffff0000, v25
  v_pk_mul_f32 v[16:17], v[60:61], v[16:17] op_sel_hi:[0,1]
  v_pk_mul_f32 v[18:19], v[60:61], v[18:19] op_sel_hi:[0,1]
  v_lshlrev_b32 v20, 16, v26
  v_and_b32 v21, 0xffff0000, v26
  v_lshlrev_b32 v22, 16, v27
  v_and_b32 v23, 0xffff0000, v27
  v_pk_mul_f32 v[20:21], v[60:61], v[20:21] op_sel_hi:[0,1]
  v_pk_mul_f32 v[22:23], v[60:61], v[22:23] op_sel_hi:[0,1]
  v_lshlrev_b32 v40, 16, v28
  v_and_b32 v41, 0xffff0000, v28
  v_lshlrev_b32 v42, 16, v29
  v_and_b32 v43, 0xffff0000, v29
  v_pk_mul_f32 v[40:41], v[60:61], v[40:41] op_sel_hi:[0,1]
  v_pk_mul_f32 v[42:43], v[60:61], v[42:43] op_sel_hi:[0,1]
  v_lshlrev_b32 v68, 16, v30
  v_and_b32 v69, 0xffff0000, v30
  v_lshlrev_b32 v70, 16, v31
  v_and_b32 v71, 0xffff0000, v31
  v_pk_mul_f32 v[68:69], v[60:61], v[68:69] op_sel_hi:[0,1]
  v_pk_mul_f32 v[70:71], v[60:61], v[70:71] op_sel_hi:[0,1]
  v_lshlrev_b32 v72, 16, v32
  v_and_b32 v73, 0xffff0000, v32
  v_lshlrev_b32 v74, 16, v33
  v_and_b32 v75, 0xffff0000, v33
  v_pk_mul_f32 v[72:73], v[60:61], v[72:73] op_sel_hi:[0,1]
  v_pk_mul_f32 v[74:75], v[60:61], v[74:75] op_sel_hi:[0,1]
  v_lshlrev_b32 v76, 16, v34
  v_and_b32 v77, 0xffff0000, v34
  v_lshlrev_b32 v78, 16, v35
  v_and_b32 v79, 0xffff0000, v35
  v_pk_mul_f32 v[76:77], v[60:61], v[76:77] op_sel_hi:[0,1]
  v_pk_mul_f32 v[78:79], v[60:61], v[78:79] op_sel_hi:[0,1]
  v_lshlrev_b32 v80, 16, v36
  v_and_b32 v81, 0xffff0000, v36
  v_lshlrev_b32 v82, 16, v37
  v_and_b32 v83, 0xffff0000, v37
  v_pk_mul_f32 v[80:81], v[60:61], v[80:81] op_sel_hi:[0,1]
  v_pk_mul_f32 v[82:83], v[60:61], v[82:83] op_sel_hi:[0,1]
  s_waitcnt vmcnt(16)
  v_cmp_ne_u32 vcc, 1, v64
  s_nop 0
  s_and_b64 vcc, vcc, 0xffffffff
  s_cbranch_vccz gated_mix__spectral_gfnet__ssm_conv_s5__prompt_kernel_skip40
  s_mov_b32 s7, 0
gated_mix__spectral_gfnet__ssm_conv_s5__prompt_kernel_poll41:
  s_sleep 5
  s_mov_b64 exec, 0xffffffff
  buffer_load_dword v64, v6, s[16:19], s57 offen sc1
  s_mov_b64 exec, -1
  s_waitcnt vmcnt(0)
  v_cmp_ne_u32 vcc, 1, v64
  s_nop 0
  s_and_b64 vcc, vcc, 0xffffffff
  s_cbranch_vccz gated_mix__spectral_gfnet__ssm_conv_s5__prompt_kernel_pollout42
  s_add_u32 s7, s7, 1
  s_cmp_lt_u32 s7, 1048576
  s_cbranch_scc1 gated_mix__spectral_gfnet__ssm_conv_s5__prompt_kernel_poll41
gated_mix__spectral_gfnet__ssm_conv_s5__prompt_kernel_pollout42:
gated_mix__spectral_gfnet__ssm_conv_s5__prompt_kernel_skip40:
  s_waitcnt lgkmcnt(0)
  s_barrier
  s_add_u32 m0, s6, 0
  s_nop 0
  buffer_load_dwordx4 v65, s[12:15], s29 offen offset:0 sc1 lds
  buffer_load_dwordx4 v65, s[12:15], s29 offen offset:1024 sc1 lds
  buffer_load_dwordx4 v65, s[12:15], s29 offen offset:2048 sc1 lds
  s_and_b32 s7, s41, 8
  s_lshl_b32 s7, s7, 2
  v_lshrrev_b32 v6, 1, v3
  v_lshl_add_u32 v6, v6, 3, s7
  v_and_b32 v36, 1, v3
  v_lshl_add_u32 v6, v36, 1, v6
  v_cmp_eq_u32 vcc, 0, v6
  v_cvt_f32_u32 v37, v6
  v_bfe_i32 v66, v3, 0, 1
  v_and_b32 v66, 0x80008000, v66
  v_xor_b32 v67, 0x80000000, v66
  s_lshl_b32 s7, s7, 1
  buffer_load_dwordx4 v65, s[12:15], s29 offen offset:3072 sc1 lds
  s_add_u32 s29, s29, 32768
  s_and_b32 s29, s29, 0x3ffff
  s_xor_b32 s7, s7, 64
  v_add_u32 v6, s7, v2
  v_cvt_f32_u32 v6, v6
  v_mul_f32 v6, 0x3c000000, v6
  v_mul_f32 v36, v6, v37
  v_fmamk_f32 v188, v6, 0x0, v36
  v_fmamk_f32 v189, v6, 0x3f800000, v36
  v_fmamk_f32 v190, v6, 0x40800000, v36
  v_fmamk_f32 v191, v6, 0x40a00000, v36
  v_fmamk_f32 v192, v6, 0x41800000, v36
  v_fmamk_f32 v193, v6, 0x41880000, v36
  v_fmamk_f32 v194, v6, 0x41a00000, v36
  s_add_u32 m0, s6, 16384
  s_nop 0
  buffer_load_dwordx4 v65, s[12:15], s29 offen offset:0 sc1 lds
  v_fmamk_f32 v195, v6, 0x41a80000, v36
  v_cos_f32 v196, v188
  v_cos_f32 v197, v189
  v_cos_f32 v198, v190
  v_cos_f32 v199, v191
  v_cos_f32 v200, v192
  v_cos_f32 v201, v193
  buffer_load_dwordx4 v65, s[12:15], s29 offen offset:1024 sc1 lds
  v_cos_f32 v202, v194
  v_cos_f32 v203, v195
  v_sin_f32 v188, v188
  v_sin_f32 v189, v189
  v_sin_f32 v190, v190
  v_sin_f32 v191, v191
  buffer_load_dwordx4 v65, s[12:15], s29 offen offset:2048 sc1 lds
  v_sin_f32 v192, v192
  v_sin_f32 v193, v193
  v_sin_f32 v194, v194
  v_sin_f32 v195, v195
  v_lshlrev_b32 v36, 31, v2
  v_or_b32 v36, 0x3f003f00, v36
  v_cvt_pk_bf16_f32 v24, v196, -v188
  v_cvt_pk_bf16_f32 v25, v197, -v189
  buffer_load_dwordx4 v65, s[12:15], s29 offen offset:3072 sc1 lds
  s_add_u32 s29, s29, 32768
  s_and_b32 s29, s29, 0x3ffff
  v_cvt_pk_bf16_f32 v26, v198, -v190
  v_cvt_pk_bf16_f32 v27, v199, -v191
  v_cvt_pk_bf16_f32 v28, v200, -v192
  v_cvt_pk_bf16_f32 v29, v201, -v193
  v_cvt_pk_bf16_f32 v30, v202, -v194
  v_cvt_pk_bf16_f32 v31, v203, -v195
  v_cndmask_b32 v24, v24, v36, vcc
  v_xor_b32 v172, v66, v24
  v_alignbit_b32 v173, v25, v25, 16
  v_xor_b32 v173, v67, v173
  v_xor_b32 v174, v66, v26
  v_alignbit_b32 v175, v27, v27, 16
  s_add_u32 m0, s43, 98304
  s_nop 0
  buffer_load_dwordx4 v124, s[72:75], s28 offen offset:0 lds
  v_xor_b32 v175, v67, v175
  v_xor_b32 v176, v66, v28
  v_alignbit_b32 v177, v29, v29, 16
  v_xor_b32 v177, v67, v177
  v_xor_b32 v178, v66, v30
  v_alignbit_b32 v179, v31, v31, 16
  v_xor_b32 v179, v67, v179
  v_add_f32 v6, 0x3e000000, v6
  v_mul_f32 v36, v6, v37
  v_fmamk_f32 v188, v6, 0x0, v36
  v_fmamk_f32 v189, v6, 0x3f800000, v36
  v_fmamk_f32 v190, v6, 0x40800000, v36
  buffer_load_dwordx4 v125, s[72:75], s28 offen offset:1024 lds
  v_fmamk_f32 v191, v6, 0x40a00000, v36
  v_fmamk_f32 v192, v6, 0x41800000, v36
  v_fmamk_f32 v193, v6, 0x41880000, v36
  v_fmamk_f32 v194, v6, 0x41a00000, v36
  v_fmamk_f32 v195, v6, 0x41a80000, v36
  v_cos_f32 v196, v188
  v_cos_f32 v197, v189
  v_cos_f32 v198, v190
  v_cos_f32 v199, v191
  s_add_u32 m0, s43, 100352
  s_nop 0
  buffer_load_dwordx4 v126, s[72:75], s28 offen offset:0 lds
  v_cos_f32 v200, v192
  v_cos_f32 v201, v193
  v_cos_f32 v202, v194
  v_cos_f32 v203, v195
  v_sin_f32 v188, v188
  v_sin_f32 v189, v189
  buffer_load_dwordx4 v127, s[72:75], s28 offen offset:1024 lds
  s_add_u32 s28, s28, 128
  s_and_b32 s28, s28, 0x3ff
  v_sin_f32 v190, v190
  v_sin_f32 v191, v191
  v_sin_f32 v192, v192
  v_sin_f32 v193, v193
  v_sin_f32 v194, v194
  v_sin_f32 v195, v195
  v_lshlrev_b32 v36, 31, v2
  v_or_b32 v36, 0x3f003f00, v36
  v_cvt_pk_bf16_f32 v32, v196, -v188
  v_cvt_pk_bf16_f32 v33, v197, -v189
  v_cvt_pk_bf16_f32 v34, v198, -v190
  v_cvt_pk_bf16_f32 v35, v199, -v191
  v_cvt_pk_bf16_f32 v60, v200, -v192
  v_cvt_pk_bf16_f32 v61, v201, -v193
  v_cvt_pk_bf16_f32 v62, v202, -v194
  v_cvt_pk_bf16_f32 v63, v203, -v195
  v_cndmask_b32 v32, v32, v36, vcc
  v_xor_b32 v180, v66, v32
  v_alignbit_b32 v181, v33, v33, 16
  v_xor_b32 v181, v67, v181
  v_xor_b32 v182, v66, v34
  v_alignbit_b32 v183, v35, v35, 16
  v_xor_b32 v183, v67, v183
  v_xor_b32 v184, v66, v60
  v_alignbit_b32 v185, v61, v61, 16
  v_xor_b32 v185, v67, v185
  v_xor_b32 v186, v66, v62
  v_alignbit_b32 v187, v63, v63, 16
  v_xor_b32 v187, v67, v187
  s_waitcnt vmcnt(12)
  s_waitcnt vmcnt(8)
  s_barrier
  ds_read_b64_tr_b16 v[100:101], v8 offset:0
  ds_read_b64_tr_b16 v[102:103], v9 offset:0
  ds_read_b64_tr_b16 v[104:105], v8 offset:2048
  ds_read_b64_tr_b16 v[106:107], v9 offset:2048
  ds_read_b64_tr_b16 v[108:109], v8 offset:4096
  ds_read_b64_tr_b16 v[110:111], v9 offset:4096
  ds_read_b64_tr_b16 v[112:113], v8 offset:6144
  ds_read_b64_tr_b16 v[114:115], v9 offset:6144
  ds_read_b64_tr_b16 v[116:117], v8 offset:256
  ds_read_b64_tr_b16 v[118:119], v9 offset:256
  ds_read_b64_tr_b16 v[120:121], v8 offset:2304
  ds_read_b64_tr_b16 v[122:123], v9 offset:2304
  ds_read_b64_tr_b16 v[132:133], v8 offset:4352
  ds_read_b64_tr_b16 v[134:135], v9 offset:4352
  ds_read_b64_tr_b16 v[136:137], v8 offset:6400
  ds_read_b64_tr_b16 v[138:139], v9 offset:6400
  s_cmp_lg_u32 s3, 0
  s_cbranch_scc1 gated_mix__spectral_gfnet__ssm_conv_s5__prompt_kernel_skip43
  s_mov_b64 exec, 1
  buffer_store_dword v5, v38, s[16:19], s56 offen sc1
  s_mov_b64 exec, -1
gated_mix__spectral_gfnet__ssm_conv_s5__prompt_kernel_skip43:
  s_waitcnt lgkmcnt(0)
  v_mfma_f32_16x16x32_bf16 v[12:15], v[100:103], a[0:3], v[12:15]
  ds_read_b64_tr_b16 v[140:141], v8 offset:8192
  ds_read_b64_tr_b16 v[142:143], v9 offset:8192
  v_mfma_f32_16x16x32_bf16 v[44:47], v[100:103], a[8:11], 0
  ds_read_b64_tr_b16 v[144:145], v8 offset:10240
  ds_read_b64_tr_b16 v[146:147], v9 offset:10240
  v_mfma_f32_16x16x32_bf16 v[48:51], v[104:107], a[8:11], 0
  ds_read_b64_tr_b16 v[148:149], v8 offset:12288
  ds_read_b64_tr_b16 v[150:151], v9 offset:12288
  v_mfma_f32_16x16x32_bf16 v[16:19], v[104:107], a[0:3], v[16:19]
  ds_read_b64_tr_b16 v[152:153], v8 offset:14336
  ds_read_b64_tr_b16 v[154:155], v9 offset:14336
  v_mfma_f32_16x16x32_bf16 v[20:23], v[108:111], a[0:3], v[20:23]
  ds_read_b64_tr_b16 v[156:157], v8 offset:8448
  ds_read_b64_tr_b16 v[158:159], v9 offset:8448
  v_mfma_f32_16x16x32_bf16 v[52:55], v[108:111], a[8:11], 0
  ds_read_b64_tr_b16 v[160:161], v8 offset:10496
  ds_read_b64_tr_b16 v[162:163], v9 offset:10496
  v_mfma_f32_16x16x32_bf16 v[56:59], v[112:115], a[8:11], 0
  ds_read_b64_tr_b16 v[164:165], v8 offset:12544
  ds_read_b64_tr_b16 v[166:167], v9 offset:12544
  v_mfma_f32_16x16x32_bf16 v[40:43], v[112:115], a[0:3], v[40:43]
  ds_read_b64_tr_b16 v[168:169], v8 offset:14592
  ds_read_b64_tr_b16 v[170:171], v9 offset:14592
  v_mfma_f32_16x16x32_bf16 v[12:15], v[116:119], a[4:7], v[12:15]
  s_add_u32 m0, s6, 32768
  s_nop 0
  buffer_load_dwordx4 v65, s[12:15], s29 offen offset:0 sc1 lds
  s_mov_b32 s24, s30
  s_mov_b32 s25, s31
  v_mfma_f32_16x16x32_bf16 v[44:47], v[116:119], a[12:15], v[44:47]
  s_mov_b32 s26, 8388608
  s_mov_b32 s27, 0x20000
  v_mfma_f32_16x16x32_bf16 v[48:51], v[120:123], a[12:15], v[48:51]
  buffer_load_dwordx4 v65, s[12:15], s29 offen offset:1024 sc1 lds
  s_mov_b32 s44, s34
  s_mov_b32 s45, s35
  v_mfma_f32_16x16x32_bf16 v[16:19], v[120:123], a[4:7], v[16:19]
  s_mov_b32 s46, 4194304
  s_mov_b32 s47, 0x20000
  v_mfma_f32_16x16x32_bf16 v[20:23], v[132:135], a[4:7], v[20:23]
  buffer_load_dwordx4 v65, s[12:15], s29 offen offset:2048 sc1 lds
  v_lshlrev_b32 v64, 4, v1
  v_lshrrev_b32 v67, 5, v1
  v_mfma_f32_16x16x32_bf16 v[52:55], v[132:135], a[12:15], v[52:55]
  v_lshlrev_b32 v6, 9, v67
  v_lshlrev_b32 v66, 7, v67
  v_mfma_f32_16x16x32_bf16 v[56:59], v[136:139], a[12:15], v[56:59]
  buffer_load_dwordx4 v65, s[12:15], s29 offen offset:3072 sc1 lds
  s_add_u32 s29, s29, 32768
  s_and_b32 s29, s29, 0x3ffff
  v_bfe_u32 v67, v1, 3, 2
  v_lshl_or_b32 v6, v67, 6, v6
  v_mfma_f32_16x16x32_bf16 v[40:43], v[136:139], a[4:7], v[40:43]
  v_and_b32 v67, 3, v1
  v_lshl_or_b32 v6, v67, 4, v6
  s_waitcnt vmcnt(8) lgkmcnt(0)
  s_barrier
  v_mfma_f32_16x16x32_bf16 v[12:15], v[140:143], a[16:19], v[12:15]
  ds_read_b64_tr_b16 v[100:101], v8 offset:16384
  ds_read_b64_tr_b16 v[102:103], v9 offset:16384
  v_mfma_f32_16x16x32_bf16 v[44:47], v[140:143], a[24:27], v[44:47]
  ds_read_b64_tr_b16 v[104:105], v8 offset:18432
  ds_read_b64_tr_b16 v[106:107], v9 offset:18432
  v_mfma_f32_16x16x32_bf16 v[48:51], v[144:147], a[24:27], v[48:51]
  ds_read_b64_tr_b16 v[108:109], v8 offset:20480
  ds_read_b64_tr_b16 v[110:111], v9 offset:20480
  v_mfma_f32_16x16x32_bf16 v[16:19], v[144:147], a[16:19], v[16:19]
  ds_read_b64_tr_b16 v[112:113], v8 offset:22528
  ds_read_b64_tr_b16 v[114:115], v9 offset:22528
  v_mfma_f32_16x16x32_bf16 v[20:23], v[148:151], a[16:19], v[20:23]
  ds_read_b64_tr_b16 v[116:117], v8 offset:16640
  ds_read_b64_tr_b16 v[118:119], v9 offset:16640
  v_mfma_f32_16x16x32_bf16 v[52:55], v[148:151], a[24:27], v[52:55]
  ds_read_b64_tr_b16 v[120:121], v8 offset:18688
  ds_read_b64_tr_b16 v[122:123], v9 offset:18688
  v_mfma_f32_16x16x32_bf16 v[56:59], v[152:155], a[24:27], v[56:59]
  ds_read_b64_tr_b16 v[132:133], v8 offset:20736
  ds_read_b64_tr_b16 v[134:135], v9 offset:20736
  v_mfma_f32_16x16x32_bf16 v[40:43], v[152:155], a[16:19], v[40:43]
  ds_read_b64_tr_b16 v[136:137], v8 offset:22784
  ds_read_b64_tr_b16 v[138:139], v9 offset:22784
  v_mfma_f32_16x16x32_bf16 v[12:15], v[156:159], a[20:23], v[12:15]
  s_add_u32 m0, s43, 114688
  s_nop 0
  buffer_load_dwordx4 v124, s[68:71], s28 offen offset:0 lds
  v_and_b32 v67, 4, v1
  v_lshl_or_b32 v6, v67, 1, v6
  v_mfma_f32_16x16x32_bf16 v[44:47], v[156:159], a[28:31], v[44:47]
  s_lshl_b32 s33, s3, 12
  s_add_u32 s33, s33, 131072
  v_mfma_f32_16x16x32_bf16 v[48:51], v[160:163], a[28:31], v[48:51]
  buffer_load_dwordx4 v125, s[68:71], s28 offen offset:1024 lds
  v_add_u32 v6, s33, v6
  v_and_or_b32 v66, v1, 16, v66
  v_mfma_f32_16x16x32_bf16 v[16:19], v[160:163], a[20:23], v[16:19]
  s_lshl_b32 s33, s41, 6
  v_lshl_add_u32 v36, v2, 2, s33
  v_mfma_f32_16x16x32_bf16 v[20:23], v[164:167], a[20:23], v[20:23]
  s_add_u32 m0, s43, 116736
  s_nop 0
  buffer_load_dwordx4 v126, s[68:71], s28 offen offset:0 lds
  v_lshl_or_b32 v36, v3, 18, v36
  v_xor_b32 v37, 512, v36
  v_mfma_f32_16x16x32_bf16 v[52:55], v[164:167], a[28:31], v[52:55]
  s_lshr_b32 s33, s41, 3
  s_lshl_b32 s7, s33, 10
  v_mfma_f32_16x16x32_bf16 v[56:59], v[168:171], a[28:31], v[56:59]
  buffer_load_dwordx4 v127, s[68:71], s28 offen offset:1024 lds
  s_add_u32 s7, s7, s40
  s_lshl2_add_u32 s7, s7, s3
  v_mfma_f32_16x16x32_bf16 v[40:43], v[168:171], a[20:23], v[40:43]
  s_lshl_b32 s7, s7, 10
  s_xor_b32 s8, s33, 1
  s_waitcnt lgkmcnt(0)
  v_mfma_f32_16x16x32_bf16 v[12:15], v[100:103], a[32:35], v[12:15]
  ds_read_b64_tr_b16 v[140:141], v8 offset:24576
  ds_read_b64_tr_b16 v[142:143], v9 offset:24576
  v_mfma_f32_16x16x32_bf16 v[44:47], v[100:103], a[40:43], v[44:47]
  ds_read_b64_tr_b16 v[144:145], v8 offset:26624
  ds_read_b64_tr_b16 v[146:147], v9 offset:26624
  v_mfma_f32_16x16x32_bf16 v[48:51], v[104:107], a[40:43], v[48:51]
  ds_read_b64_tr_b16 v[148:149], v8 offset:28672
  ds_read_b64_tr_b16 v[150:151], v9 offset:28672
  v_mfma_f32_16x16x32_bf16 v[16:19], v[104:107], a[32:35], v[16:19]
  ds_read_b64_tr_b16 v[152:153], v8 offset:30720
  ds_read_b64_tr_b16 v[154:155], v9 offset:30720
  v_mfma_f32_16x16x32_bf16 v[20:23], v[108:111], a[32:35], v[20:23]
  ds_read_b64_tr_b16 v[156:157], v8 offset:24832
  ds_read_b64_tr_b16 v[158:159], v9 offset:24832
  v_mfma_f32_16x16x32_bf16 v[52:55], v[108:111], a[40:43], v[52:55]
  ds_read_b64_tr_b16 v[160:161], v8 offset:26880
  ds_read_b64_tr_b16 v[162:163], v9 offset:26880
  v_mfma_f32_16x16x32_bf16 v[56:59], v[112:115], a[40:43], v[56:59]
  ds_read_b64_tr_b16 v[164:165], v8 offset:28928
  ds_read_b64_tr_b16 v[166:167], v9 offset:28928
  v_mfma_f32_16x16x32_bf16 v[40:43], v[112:115], a[32:35], v[40:43]
  ds_read_b64_tr_b16 v[168:169], v8 offset:30976
  ds_read_b64_tr_b16 v[170:171], v9 offset:30976
  v_mfma_f32_16x16x32_bf16 v[12:15], v[116:119], a[36:39], v[12:15]
  s_add_u32 m0, s6, 49152
  s_nop 0
  buffer_load_dwordx4 v65, s[12:15], s29 offen offset:0 sc1 lds
  s_lshl1_add_u32 s8, s40, s8
  s_lshl_b32 s8, s8, 10
  v_mfma_f32_16x16x32_bf16 v[44:47], v[116:119], a[44:47], v[44:47]
  s_lshl4_add_u32 s9, s40, s41
  s_and_b32 s32, s3, 2
  v_mfma_f32_16x16x32_bf16 v[48:51], v[120:123], a[44:47], v[48:51]
  buffer_load_dwordx4 v65, s[12:15], s29 offen offset:1024 sc1 lds
  s_lshl_b32 s32, s32, 2
  s_xor_b32 s32, s32, s9
  v_mfma_f32_16x16x32_bf16 v[16:19], v[120:123], a[36:39], v[16:19]
  s_lshl1_add_u32 s32, s32, s33
  s_and_b32 s33, s3, 1
  v_mfma_f32_16x16x32_bf16 v[20:23], v[132:135], a[36:39], v[20:23]
  buffer_load_dwordx4 v65, s[12:15], s29 offen offset:2048 sc1 lds
  s_lshl1_add_u32 s32, s32, s33
  s_lshl_b32 s32, s32, 12
  v_mfma_f32_16x16x32_bf16 v[52:55], v[132:135], a[44:47], v[52:55]
  s_lshl2_add_u32 s9, s9, s3
  s_lshl_b32 s9, s9, 13
  v_mfma_f32_16x16x32_bf16 v[56:59], v[136:139], a[44:47], v[56:59]
  buffer_load_dwordx4 v65, s[12:15], s29 offen offset:3072 sc1 lds
  s_add_u32 s29, s29, 32768
  s_and_b32 s29, s29, 0x3ffff
  s_lshr_b32 s33, s41, 3
  s_or_b32 s33, s33, s3
  v_mfma_f32_16x16x32_bf16 v[40:43], v[136:139], a[36:39], v[40:43]
  s_and_b32 s33, s33, 1
  s_lshr_b32 s9, s9, 1
  s_waitcnt vmcnt(12)
  ds_read_b128 a[144:147], v130 offset:32768
  ds_read_b128 a[148:151], v131 offset:32768
  ds_read_b128 a[152:155], v130 offset:34816
  ds_read_b128 a[156:159], v131 offset:34816
  s_waitcnt vmcnt(8) lgkmcnt(4)
  s_barrier
  v_mfma_f32_16x16x32_bf16 v[12:15], v[140:143], a[48:51], v[12:15]
  ds_read_b64_tr_b16 v[100:101], v8 offset:32768
  ds_read_b64_tr_b16 v[102:103], v9 offset:32768
  v_mfma_f32_16x16x32_bf16 v[44:47], v[140:143], a[56:59], v[44:47]
  ds_read_b64_tr_b16 v[104:105], v8 offset:34816
  ds_read_b64_tr_b16 v[106:107], v9 offset:34816
  v_mfma_f32_16x16x32_bf16 v[48:51], v[144:147], a[56:59], v[48:51]
  ds_read_b64_tr_b16 v[108:109], v8 offset:36864
  ds_read_b64_tr_b16 v[110:111], v9 offset:36864
  v_mfma_f32_16x16x32_bf16 v[16:19], v[144:147], a[48:51], v[16:19]
  ds_read_b64_tr_b16 v[112:113], v8 offset:38912
  ds_read_b64_tr_b16 v[114:115], v9 offset:38912
  v_mfma_f32_16x16x32_bf16 v[20:23], v[148:151], a[48:51], v[20:23]
  ds_read_b64_tr_b16 v[116:117], v8 offset:33024
  ds_read_b64_tr_b16 v[118:119], v9 offset:33024
  v_mfma_f32_16x16x32_bf16 v[52:55], v[148:151], a[56:59], v[52:55]
  ds_read_b64_tr_b16 v[120:121], v8 offset:35072
  ds_read_b64_tr_b16 v[122:123], v9 offset:35072
  v_mfma_f32_16x16x32_bf16 v[56:59], v[152:155], a[56:59], v[56:59]
  ds_read_b64_tr_b16 v[132:133], v8 offset:37120
  ds_read_b64_tr_b16 v[134:135], v9 offset:37120
  v_mfma_f32_16x16x32_bf16 v[40:43], v[152:155], a[48:51], v[40:43]
  ds_read_b64_tr_b16 v[136:137], v8 offset:39168
  ds_read_b64_tr_b16 v[138:139], v9 offset:39168
  v_mfma_f32_16x16x32_bf16 v[12:15], v[156:159], a[52:55], v[12:15]
  s_add_u32 m0, s43, 147456
  s_nop 0
  buffer_load_dwordx4 v124, s[72:75], s28 offen offset:0 lds
  s_mov_b32 s58, 0x07060302
  v_mfma_f32_16x16x32_bf16 v[44:47], v[156:159], a[60:63], v[44:47]
  v_mfma_f32_16x16x32_bf16 v[48:51], v[160:163], a[60:63], v[48:51]
  buffer_load_dwordx4 v125, s[72:75], s28 offen offset:1024 lds
  v_mfma_f32_16x16x32_bf16 v[16:19], v[160:163], a[52:55], v[16:19]
  v_mfma_f32_16x16x32_bf16 v[20:23], v[164:167], a[52:55], v[20:23]
  s_add_u32 m0, s43, 149504
  s_nop 0
  buffer_load_dwordx4 v126, s[72:75], s28 offen offset:0 lds
  v_mfma_f32_16x16x32_bf16 v[52:55], v[164:167], a[60:63], v[52:55]
  v_mfma_f32_16x16x32_bf16 v[56:59], v[168:171], a[60:63], v[56:59]
  buffer_load_dwordx4 v127, s[72:75], s28 offen offset:1024 lds
  s_add_u32 s28, s28, 128
  s_and_b32 s28, s28, 0x3ff
  v_mfma_f32_16x16x32_bf16 v[40:43], v[168:171], a[52:55], v[40:43]
  s_waitcnt lgkmcnt(0)
  v_mfma_f32_16x16x32_bf16 v[12:15], v[100:103], a[64:67], v[12:15]
  ds_read_b64_tr_b16 v[140:141], v8 offset:40960
  ds_read_b64_tr_b16 v[142:143], v9 offset:40960
  v_mfma_f32_16x16x32_bf16 v[44:47], v[100:103], a[72:75], v[44:47]
  ds_read_b64_tr_b16 v[144:145], v8 offset:43008
  ds_read_b64_tr_b16 v[146:147], v9 offset:43008
  v_mfma_f32_16x16x32_bf16 v[48:51], v[104:107], a[72:75], v[48:51]
  ds_read_b64_tr_b16 v[148:149], v8 offset:45056
  ds_read_b64_tr_b16 v[150:151], v9 offset:45056
  v_mfma_f32_16x16x32_bf16 v[16:19], v[104:107], a[64:67], v[16:19]
  ds_read_b64_tr_b16 v[152:153], v8 offset:47104
  ds_read_b64_tr_b16 v[154:155], v9 offset:47104
  v_mfma_f32_16x16x32_bf16 v[20:23], v[108:111], a[64:67], v[20:23]
  ds_read_b64_tr_b16 v[156:157], v8 offset:41216
  ds_read_b64_tr_b16 v[158:159], v9 offset:41216
  v_mfma_f32_16x16x32_bf16 v[52:55], v[108:111], a[72:75], v[52:55]
  ds_read_b64_tr_b16 v[160:161], v8 offset:43264
  ds_read_b64_tr_b16 v[162:163], v9 offset:43264
  v_mfma_f32_16x16x32_bf16 v[56:59], v[112:115], a[72:75], v[56:59]
  ds_read_b64_tr_b16 v[164:165], v8 offset:45312
  ds_read_b64_tr_b16 v[166:167], v9 offset:45312
  v_mfma_f32_16x16x32_bf16 v[40:43], v[112:115], a[64:67], v[40:43]
  ds_read_b64_tr_b16 v[168:169], v8 offset:47360
  ds_read_b64_tr_b16 v[170:171], v9 offset:47360
  v_mfma_f32_16x16x32_bf16 v[12:15], v[116:119], a[68:71], v[12:15]
  s_add_u32 m0, s6, 65536
  s_nop 0
  buffer_load_dwordx4 v65, s[12:15], s29 offen offset:0 sc1 lds
  v_mfma_f32_16x16x32_bf16 v[44:47], v[116:119], a[76:79], v[44:47]
  v_mfma_f32_16x16x32_bf16 v[48:51], v[120:123], a[76:79], v[48:51]
  buffer_load_dwordx4 v65, s[12:15], s29 offen offset:1024 sc1 lds
  v_mfma_f32_16x16x32_bf16 v[16:19], v[120:123], a[68:71], v[16:19]
  v_mfma_f32_16x16x32_bf16 v[20:23], v[132:135], a[68:71], v[20:23]
  buffer_load_dwordx4 v65, s[12:15], s29 offen offset:2048 sc1 lds
  v_mfma_f32_16x16x32_bf16 v[52:55], v[132:135], a[76:79], v[52:55]
  v_mfma_f32_16x16x32_bf16 v[56:59], v[136:139], a[76:79], v[56:59]
  buffer_load_dwordx4 v65, s[12:15], s29 offen offset:3072 sc1 lds
  s_add_u32 s29, s29, 32768
  s_and_b32 s29, s29, 0x3ffff
  v_mfma_f32_16x16x32_bf16 v[40:43], v[136:139], a[68:71], v[40:43]
  s_waitcnt vmcnt(12)
  ds_read_b128 a[160:163], v130 offset:49152
  ds_read_b128 a[164:167], v131 offset:49152
  ds_read_b128 a[168:171], v130 offset:51200
  ds_read_b128 a[172:175], v131 offset:51200
  s_waitcnt vmcnt(8) lgkmcnt(4)
  s_barrier
  v_mfma_f32_16x16x32_bf16 v[12:15], v[140:143], a[80:83], v[12:15]
  ds_read_b64_tr_b16 v[100:101], v8 offset:49152
  ds_read_b64_tr_b16 v[102:103], v9 offset:49152
  v_mfma_f32_16x16x32_bf16 v[44:47], v[140:143], a[88:91], v[44:47]
  ds_read_b64_tr_b16 v[104:105], v8 offset:51200
  ds_read_b64_tr_b16 v[106:107], v9 offset:51200
  v_mfma_f32_16x16x32_bf16 v[48:51], v[144:147], a[88:91], v[48:51]
  ds_read_b64_tr_b16 v[108:109], v8 offset:53248
  ds_read_b64_tr_b16 v[110:111], v9 offset:53248
  v_mfma_f32_16x16x32_bf16 v[16:19], v[144:147], a[80:83], v[16:19]
  ds_read_b64_tr_b16 v[112:113], v8 offset:55296
  ds_read_b64_tr_b16 v[114:115], v9 offset:55296
  v_mfma_f32_16x16x32_bf16 v[20:23], v[148:151], a[80:83], v[20:23]
  ds_read_b64_tr_b16 v[116:117], v8 offset:49408
  ds_read_b64_tr_b16 v[118:119], v9 offset:49408
  v_mfma_f32_16x16x32_bf16 v[52:55], v[148:151], a[88:91], v[52:55]
  ds_read_b64_tr_b16 v[120:121], v8 offset:51456
  ds_read_b64_tr_b16 v[122:123], v9 offset:51456
  v_mfma_f32_16x16x32_bf16 v[56:59], v[152:155], a[88:91], v[56:59]
  ds_read_b64_tr_b16 v[132:133], v8 offset:53504
  ds_read_b64_tr_b16 v[134:135], v9 offset:53504
  v_mfma_f32_16x16x32_bf16 v[40:43], v[152:155], a[80:83], v[40:43]
  ds_read_b64_tr_b16 v[136:137], v8 offset:55552
  ds_read_b64_tr_b16 v[138:139], v9 offset:55552
  v_mfma_f32_16x16x32_bf16 v[12:15], v[156:159], a[84:87], v[12:15]
  s_add_u32 m0, s43, 98304
  s_nop 0
  buffer_load_dwordx4 v124, s[68:71], s28 offen offset:0 lds
  v_mfma_f32_16x16x32_bf16 v[44:47], v[156:159], a[92:95], v[44:47]
  v_mfma_f32_16x16x32_bf16 v[48:51], v[160:163], a[92:95], v[48:51]
  buffer_load_dwordx4 v125, s[68:71], s28 offen offset:1024 lds
  v_mfma_f32_16x16x32_bf16 v[16:19], v[160:163], a[84:87], v[16:19]
  v_mfma_f32_16x16x32_bf16 v[20:23], v[164:167], a[84:87], v[20:23]
  s_add_u32 m0, s43, 100352
  s_nop 0
  buffer_load_dwordx4 v126, s[68:71], s28 offen offset:0 lds
  v_mfma_f32_16x16x32_bf16 v[52:55], v[164:167], a[92:95], v[52:55]
  v_mfma_f32_16x16x32_bf16 v[56:59], v[168:171], a[92:95], v[56:59]
  buffer_load_dwordx4 v127, s[68:71], s28 offen offset:1024 lds
  v_mfma_f32_16x16x32_bf16 v[40:43], v[168:171], a[84:87], v[40:43]
  s_waitcnt lgkmcnt(0)
  v_mfma_f32_16x16x32_bf16 v[12:15], v[100:103], a[96:99], v[12:15]
  ds_read_b64_tr_b16 v[140:141], v8 offset:57344
  ds_read_b64_tr_b16 v[142:143], v9 offset:57344
  v_mfma_f32_16x16x32_bf16 v[44:47], v[100:103], a[104:107], v[44:47]
  ds_read_b64_tr_b16 v[144:145], v8 offset:59392
  ds_read_b64_tr_b16 v[146:147], v9 offset:59392
  v_mfma_f32_16x16x32_bf16 v[48:51], v[104:107], a[104:107], v[48:51]
  ds_read_b64_tr_b16 v[148:149], v8 offset:61440
  ds_read_b64_tr_b16 v[150:151], v9 offset:61440
  v_mfma_f32_16x16x32_bf16 v[16:19], v[104:107], a[96:99], v[16:19]
  ds_read_b64_tr_b16 v[152:153], v8 offset:63488
  ds_read_b64_tr_b16 v[154:155], v9 offset:63488
  v_mfma_f32_16x16x32_bf16 v[20:23], v[108:111], a[96:99], v[20:23]
  ds_read_b64_tr_b16 v[156:157], v8 offset:57600
  ds_read_b64_tr_b16 v[158:159], v9 offset:57600
  v_mfma_f32_16x16x32_bf16 v[52:55], v[108:111], a[104:107], v[52:55]
  ds_read_b64_tr_b16 v[160:161], v8 offset:59648
  ds_read_b64_tr_b16 v[162:163], v9 offset:59648
  v_mfma_f32_16x16x32_bf16 v[56:59], v[112:115], a[104:107], v[56:59]
  ds_read_b64_tr_b16 v[164:165], v8 offset:61696
  ds_read_b64_tr_b16 v[166:167], v9 offset:61696
  v_mfma_f32_16x16x32_bf16 v[40:43], v[112:115], a[96:99], v[40:43]
  ds_read_b64_tr_b16 v[168:169], v8 offset:63744
  ds_read_b64_tr_b16 v[170:171], v9 offset:63744
  v_mfma_f32_16x16x32_bf16 v[12:15], v[116:119], a[100:103], v[12:15]
  s_add_u32 m0, s6, 81920
  s_nop 0
  buffer_load_dwordx4 v65, s[12:15], s29 offen offset:0 sc1 lds
  v_mfma_f32_16x16x32_bf16 v[44:47], v[116:119], a[108:111], v[44:47]
  v_mfma_f32_16x16x32_bf16 v[48:51], v[120:123], a[108:111], v[48:51]
  buffer_load_dwordx4 v65, s[12:15], s29 offen offset:1024 sc1 lds
  v_mfma_f32_16x16x32_bf16 v[16:19], v[120:123], a[100:103], v[16:19]
  v_mfma_f32_16x16x32_bf16 v[20:23], v[132:135], a[100:103], v[20:23]
  buffer_load_dwordx4 v65, s[12:15], s29 offen offset:2048 sc1 lds
  v_mfma_f32_16x16x32_bf16 v[52:55], v[132:135], a[108:111], v[52:55]
  v_mfma_f32_16x16x32_bf16 v[56:59], v[136:139], a[108:111], v[56:59]
  buffer_load_dwordx4 v65, s[12:15], s29 offen offset:3072 sc1 lds
  s_add_u32 s29, s29, 32768
  s_and_b32 s29, s29, 0x3ffff
  v_mfma_f32_16x16x32_bf16 v[40:43], v[136:139], a[100:103], v[40:43]
  v_xor_b32 v130, 0x30000, v130
  v_xor_b32 v131, 0x30000, v131
  s_waitcnt vmcnt(12)
  ds_read_b128 a[176:179], v130 offset:16384
  ds_read_b128 a[180:183], v131 offset:16384
  ds_read_b128 a[184:187], v130 offset:18432
  ds_read_b128 a[188:191], v131 offset:18432
  s_waitcnt vmcnt(8) lgkmcnt(4)
  s_barrier
  v_mfma_f32_16x16x32_bf16 v[12:15], v[140:143], a[112:115], v[12:15]
  ds_read_b64_tr_b16 v[100:101], v10 offset:0
  ds_read_b64_tr_b16 v[102:103], v11 offset:0
  v_mfma_f32_16x16x32_bf16 v[44:47], v[140:143], a[120:123], v[44:47]
  ds_read_b64_tr_b16 v[104:105], v10 offset:2048
  ds_read_b64_tr_b16 v[106:107], v11 offset:2048
  v_mfma_f32_16x16x32_bf16 v[48:51], v[144:147], a[120:123], v[48:51]
  ds_read_b64_tr_b16 v[108:109], v10 offset:4096
  ds_read_b64_tr_b16 v[110:111], v11 offset:4096
  v_mfma_f32_16x16x32_bf16 v[16:19], v[144:147], a[112:115], v[16:19]
  ds_read_b64_tr_b16 v[112:113], v10 offset:6144
  ds_read_b64_tr_b16 v[114:115], v11 offset:6144
  v_mfma_f32_16x16x32_bf16 v[20:23], v[148:151], a[112:115], v[20:23]
  ds_read_b64_tr_b16 v[116:117], v10 offset:256
  ds_read_b64_tr_b16 v[118:119], v11 offset:256
  v_mfma_f32_16x16x32_bf16 v[52:55], v[148:151], a[120:123], v[52:55]
  ds_read_b64_tr_b16 v[120:121], v10 offset:2304
  ds_read_b64_tr_b16 v[122:123], v11 offset:2304
  v_mfma_f32_16x16x32_bf16 v[56:59], v[152:155], a[120:123], v[56:59]
  ds_read_b64_tr_b16 v[132:133], v10 offset:4352
  ds_read_b64_tr_b16 v[134:135], v11 offset:4352
  v_mfma_f32_16x16x32_bf16 v[40:43], v[152:155], a[112:115], v[40:43]
  ds_read_b64_tr_b16 v[136:137], v10 offset:6400
  ds_read_b64_tr_b16 v[138:139], v11 offset:6400
  v_mfma_f32_16x16x32_bf16 v[12:15], v[156:159], a[116:119], v[12:15]
  s_add_u32 m0, s43, 114688
  s_nop 0
  buffer_load_dwordx4 v124, s[72:75], s28 offen offset:0 lds
  v_mfma_f32_16x16x32_bf16 v[44:47], v[156:159], a[124:127], v[44:47]
  v_mfma_f32_16x16x32_bf16 v[48:51], v[160:163], a[124:127], v[48:51]
  buffer_load_dwordx4 v125, s[72:75], s28 offen offset:1024 lds
  v_mfma_f32_16x16x32_bf16 v[16:19], v[160:163], a[116:119], v[16:19]
  v_mfma_f32_16x16x32_bf16 v[20:23], v[164:167], a[116:119], v[20:23]
  s_add_u32 m0, s43, 116736
  s_nop 0
  buffer_load_dwordx4 v126, s[72:75], s28 offen offset:0 lds
  v_mfma_f32_16x16x32_bf16 v[52:55], v[164:167], a[124:127], v[52:55]
  v_mfma_f32_16x16x32_bf16 v[56:59], v[168:171], a[124:127], v[56:59]
  buffer_load_dwordx4 v127, s[72:75], s28 offen offset:1024 lds
  s_add_u32 s28, s28, 128
  s_and_b32 s28, s28, 0x3ff
  v_mfma_f32_16x16x32_bf16 v[40:43], v[168:171], a[116:119], v[40:43]
  buffer_load_dword v188, v7, s[16:19], s56 offen sc1
  s_waitcnt lgkmcnt(0)
  v_mfma_f32_16x16x32_bf16 v[12:15], v[100:103], a[128:131], v[12:15]
  ds_read_b64_tr_b16 v[140:141], v10 offset:8192
  ds_read_b64_tr_b16 v[142:143], v11 offset:8192
  v_mfma_f32_16x16x32_bf16 v[44:47], v[100:103], a[136:139], v[44:47]
  ds_read_b64_tr_b16 v[144:145], v10 offset:10240
  ds_read_b64_tr_b16 v[146:147], v11 offset:10240
  v_mfma_f32_16x16x32_bf16 v[48:51], v[104:107], a[136:139], v[48:51]
  ds_read_b64_tr_b16 v[148:149], v10 offset:12288
  ds_read_b64_tr_b16 v[150:151], v11 offset:12288
  v_mfma_f32_16x16x32_bf16 v[16:19], v[104:107], a[128:131], v[16:19]
  ds_read_b64_tr_b16 v[152:153], v10 offset:14336
  ds_read_b64_tr_b16 v[154:155], v11 offset:14336
  v_mfma_f32_16x16x32_bf16 v[20:23], v[108:111], a[128:131], v[20:23]
  ds_read_b64_tr_b16 v[156:157], v10 offset:8448
  ds_read_b64_tr_b16 v[158:159], v11 offset:8448
  v_mfma_f32_16x16x32_bf16 v[52:55], v[108:111], a[136:139], v[52:55]
  ds_read_b64_tr_b16 v[160:161], v10 offset:10496
  ds_read_b64_tr_b16 v[162:163], v11 offset:10496
  v_mfma_f32_16x16x32_bf16 v[56:59], v[112:115], a[136:139], v[56:59]
  ds_read_b64_tr_b16 v[164:165], v10 offset:12544
  ds_read_b64_tr_b16 v[166:167], v11 offset:12544
  v_mfma_f32_16x16x32_bf16 v[40:43], v[112:115], a[128:131], v[40:43]
  ds_read_b64_tr_b16 v[168:169], v10 offset:14592
  ds_read_b64_tr_b16 v[170:171], v11 offset:14592
  v_mfma_f32_16x16x32_bf16 v[12:15], v[116:119], a[132:135], v[12:15]
  s_add_u32 m0, s6, 0
  s_nop 0
  buffer_load_dwordx4 v65, s[12:15], s29 offen offset:0 sc1 lds
  v_mfma_f32_16x16x32_bf16 v[44:47], v[116:119], a[140:143], v[44:47]
  v_mfma_f32_16x16x32_bf16 v[48:51], v[120:123], a[140:143], v[48:51]
  buffer_load_dwordx4 v65, s[12:15], s29 offen offset:1024 sc1 lds
  v_mfma_f32_16x16x32_bf16 v[16:19], v[120:123], a[132:135], v[16:19]
  v_mfma_f32_16x16x32_bf16 v[20:23], v[132:135], a[132:135], v[20:23]
  buffer_load_dwordx4 v65, s[12:15], s29 offen offset:2048 sc1 lds
  v_mfma_f32_16x16x32_bf16 v[52:55], v[132:135], a[140:143], v[52:55]
  v_mfma_f32_16x16x32_bf16 v[56:59], v[136:139], a[140:143], v[56:59]
  buffer_load_dwordx4 v65, s[12:15], s29 offen offset:3072 sc1 lds
  s_add_u32 s29, s29, 32768
  s_and_b32 s29, s29, 0x3ffff
  v_mfma_f32_16x16x32_bf16 v[40:43], v[136:139], a[132:135], v[40:43]
  v_xor_b32 v130, 0x30000, v130
  v_xor_b32 v131, 0x30000, v131
  s_waitcnt vmcnt(13)
  ds_read_b128 a[192:195], v130 offset:32768
  ds_read_b128 a[196:199], v131 offset:32768
  ds_read_b128 a[200:203], v130 offset:34816
  ds_read_b128 a[204:207], v131 offset:34816
  s_waitcnt vmcnt(9) lgkmcnt(4)
  s_barrier
  v_mfma_f32_16x16x32_bf16 v[12:15], v[140:143], a[144:147], v[12:15]
  ds_read_b64_tr_b16 v[100:101], v10 offset:16384
  ds_read_b64_tr_b16 v[102:103], v11 offset:16384
  v_mfma_f32_16x16x32_bf16 v[44:47], v[140:143], a[152:155], v[44:47]
  ds_read_b64_tr_b16 v[104:105], v10 offset:18432
  ds_read_b64_tr_b16 v[106:107], v11 offset:18432
  v_mfma_f32_16x16x32_bf16 v[48:51], v[144:147], a[152:155], v[48:51]
  ds_read_b64_tr_b16 v[108:109], v10 offset:20480
  ds_read_b64_tr_b16 v[110:111], v11 offset:20480
  v_mfma_f32_16x16x32_bf16 v[16:19], v[144:147], a[144:147], v[16:19]
  ds_read_b64_tr_b16 v[112:113], v10 offset:22528
  ds_read_b64_tr_b16 v[114:115], v11 offset:22528
  v_mfma_f32_16x16x32_bf16 v[20:23], v[148:151], a[144:147], v[20:23]
  ds_read_b64_tr_b16 v[116:117], v10 offset:16640
  ds_read_b64_tr_b16 v[118:119], v11 offset:16640
  v_mfma_f32_16x16x32_bf16 v[52:55], v[148:151], a[152:155], v[52:55]
  ds_read_b64_tr_b16 v[120:121], v10 offset:18688
  ds_read_b64_tr_b16 v[122:123], v11 offset:18688
  v_mfma_f32_16x16x32_bf16 v[56:59], v[152:155], a[152:155], v[56:59]
  ds_read_b64_tr_b16 v[132:133], v10 offset:20736
  ds_read_b64_tr_b16 v[134:135], v11 offset:20736
  v_mfma_f32_16x16x32_bf16 v[40:43], v[152:155], a[144:147], v[40:43]
  ds_read_b64_tr_b16 v[136:137], v10 offset:22784
  ds_read_b64_tr_b16 v[138:139], v11 offset:22784
  v_mfma_f32_16x16x32_bf16 v[12:15], v[156:159], a[148:151], v[12:15]
  s_add_u32 m0, s43, 147456
  s_nop 0
  buffer_load_dwordx4 v124, s[68:71], s28 offen offset:0 lds
  v_mfma_f32_16x16x32_bf16 v[44:47], v[156:159], a[156:159], v[44:47]
  v_mfma_f32_16x16x32_bf16 v[48:51], v[160:163], a[156:159], v[48:51]
  buffer_load_dwordx4 v125, s[68:71], s28 offen offset:1024 lds
  v_mfma_f32_16x16x32_bf16 v[16:19], v[160:163], a[148:151], v[16:19]
  v_mfma_f32_16x16x32_bf16 v[20:23], v[164:167], a[148:151], v[20:23]
  s_add_u32 m0, s43, 149504
  s_nop 0
  buffer_load_dwordx4 v126, s[68:71], s28 offen offset:0 lds
  v_mfma_f32_16x16x32_bf16 v[52:55], v[164:167], a[156:159], v[52:55]
  v_mfma_f32_16x16x32_bf16 v[56:59], v[168:171], a[156:159], v[56:59]
  buffer_load_dwordx4 v127, s[68:71], s28 offen offset:1024 lds
  v_mfma_f32_16x16x32_bf16 v[40:43], v[168:171], a[148:151], v[40:43]
  s_cmp_lg_u32 s3, 1
  s_cbranch_scc1 gated_mix__spectral_gfnet__ssm_conv_s5__prompt_kernel_skip45
  s_getpc_b64 s[48:49]
gated_mix__spectral_gfnet__ssm_conv_s5__prompt_kernel_pc44:
  s_lshr_b32 s59, s2, 3
  s_mul_i32 s59, s59, 512
  v_min_u32 v190, 3, v1
  v_lshl_add_u32 v190, v190, 7, s59
  v_min_u32 v190, gated_mix__spectral_gfnet__ssm_conv_s5__prompt_kernel_end-gated_mix__spectral_gfnet__ssm_conv_s5__prompt_kernel_pc44, v190
  v_mov_b32 v191, 0
  v_lshl_add_u64 v[190:191], v[190:191], 0, s[48:49]
  global_load_dword v4, v[190:191], off
gated_mix__spectral_gfnet__ssm_conv_s5__prompt_kernel_skip45:
  s_waitcnt lgkmcnt(0)
  v_mfma_f32_16x16x32_bf16 v[12:15], v[100:103], a[160:163], v[12:15]
  ds_read_b64_tr_b16 v[140:141], v10 offset:24576
  ds_read_b64_tr_b16 v[142:143], v11 offset:24576
  v_mfma_f32_16x16x32_bf16 v[44:47], v[100:103], a[168:171], v[44:47]
  ds_read_b64_tr_b16 v[144:145], v10 offset:26624
  ds_read_b64_tr_b16 v[146:147], v11 offset:26624
  v_mfma_f32_16x16x32_bf16 v[48:51], v[104:107], a[168:171], v[48:51]
  ds_read_b64_tr_b16 v[148:149], v10 offset:28672
  ds_read_b64_tr_b16 v[150:151], v11 offset:28672
  v_mfma_f32_16x16x32_bf16 v[16:19], v[104:107], a[160:163], v[16:19]
  ds_read_b64_tr_b16 v[152:153], v10 offset:30720
  ds_read_b64_tr_b16 v[154:155], v11 offset:30720
  v_mfma_f32_16x16x32_bf16 v[20:23], v[108:111], a[160:163], v[20:23]
  ds_read_b64_tr_b16 v[156:157], v10 offset:24832
  ds_read_b64_tr_b16 v[158:159], v11 offset:24832
  v_mfma_f32_16x16x32_bf16 v[52:55], v[108:111], a[168:171], v[52:55]
  ds_read_b64_tr_b16 v[160:161], v10 offset:26880
  ds_read_b64_tr_b16 v[162:163], v11 offset:26880
  v_mfma_f32_16x16x32_bf16 v[56:59], v[112:115], a[168:171], v[56:59]
  ds_read_b64_tr_b16 v[164:165], v10 offset:28928
  ds_read_b64_tr_b16 v[166:167], v11 offset:28928
  v_mfma_f32_16x16x32_bf16 v[40:43], v[112:115], a[160:163], v[40:43]
  ds_read_b64_tr_b16 v[168:169], v10 offset:30976
  ds_read_b64_tr_b16 v[170:171], v11 offset:30976
  v_mfma_f32_16x16x32_bf16 v[12:15], v[116:119], a[164:167], v[12:15]
  s_add_u32 m0, s6, 16384
  s_nop 0
  buffer_load_dwordx4 v65, s[12:15], s29 offen offset:0 sc1 lds
  v_mfma_f32_16x16x32_bf16 v[44:47], v[116:119], a[172:175], v[44:47]
  v_mfma_f32_16x16x32_bf16 v[48:51], v[120:123], a[172:175], v[48:51]
  buffer_load_dwordx4 v65, s[12:15], s29 offen offset:1024 sc1 lds
  v_mfma_f32_16x16x32_bf16 v[16:19], v[120:123], a[164:167], v[16:19]
  v_mfma_f32_16x16x32_bf16 v[20:23], v[132:135], a[164:167], v[20:23]
  buffer_load_dwordx4 v65, s[12:15], s29 offen offset:2048 sc1 lds
  v_mfma_f32_16x16x32_bf16 v[52:55], v[132:135], a[172:175], v[52:55]
  v_mfma_f32_16x16x32_bf16 v[56:59], v[136:139], a[172:175], v[56:59]
  buffer_load_dwordx4 v65, s[12:15], s29 offen offset:3072 sc1 lds
  s_add_u32 s29, s29, 32768
  s_and_b32 s29, s29, 0x3ffff
  v_xor_b32 v65, 8192, v65
  v_mfma_f32_16x16x32_bf16 v[40:43], v[136:139], a[164:167], v[40:43]
  s_waitcnt vmcnt(13)
  ds_read_b128 a[208:211], v130 offset:49152
  ds_read_b128 a[212:215], v131 offset:49152
  ds_read_b128 a[216:219], v130 offset:51200
  ds_read_b128 a[220:223], v131 offset:51200
  s_waitcnt vmcnt(12)
  v_cmp_ne_u32 vcc, 1, v188
  s_nop 0
  s_cbranch_vccz gated_mix__spectral_gfnet__ssm_conv_s5__prompt_kernel_skip46
  s_mov_b32 s59, 0
gated_mix__spectral_gfnet__ssm_conv_s5__prompt_kernel_poll47:
  s_sleep 16
  buffer_load_dword v188, v7, s[16:19], s56 offen sc1
  s_waitcnt vmcnt(0)
  v_cmp_ne_u32 vcc, 1, v188
  s_nop 0
  s_cbranch_vccz gated_mix__spectral_gfnet__ssm_conv_s5__prompt_kernel_pollout48
  s_add_u32 s59, s59, 1
  s_cmp_lt_u32 s59, 1048576
  s_cbranch_scc1 gated_mix__spectral_gfnet__ssm_conv_s5__prompt_kernel_poll47
gated_mix__spectral_gfnet__ssm_conv_s5__prompt_kernel_pollout48:
gated_mix__spectral_gfnet__ssm_conv_s5__prompt_kernel_skip46:
  s_waitcnt vmcnt(8) lgkmcnt(4)
  s_barrier
  v_mfma_f32_16x16x32_bf16 v[12:15], v[140:143], a[176:179], v[12:15]
  ds_read_b64_tr_b16 v[100:101], v8 offset:0
  ds_read_b64_tr_b16 v[102:103], v9 offset:0
  v_mfma_f32_16x16x32_bf16 v[44:47], v[140:143], a[184:187], v[44:47]
  ds_read_b64_tr_b16 v[104:105], v8 offset:2048
  ds_read_b64_tr_b16 v[106:107], v9 offset:2048
  v_mfma_f32_16x16x32_bf16 v[48:51], v[144:147], a[184:187], v[48:51]
  ds_read_b64_tr_b16 v[108:109], v8 offset:4096
  ds_read_b64_tr_b16 v[110:111], v9 offset:4096
  v_mfma_f32_16x16x32_bf16 v[16:19], v[144:147], a[176:179], v[16:19]
  ds_read_b64_tr_b16 v[112:113], v8 offset:6144
  ds_read_b64_tr_b16 v[114:115], v9 offset:6144
  v_mfma_f32_16x16x32_bf16 v[20:23], v[148:151], a[176:179], v[20:23]
  ds_read_b64_tr_b16 v[116:117], v8 offset:256
  ds_read_b64_tr_b16 v[118:119], v9 offset:256
  v_mfma_f32_16x16x32_bf16 v[52:55], v[148:151], a[184:187], v[52:55]
  ds_read_b64_tr_b16 v[120:121], v8 offset:2304
  ds_read_b64_tr_b16 v[122:123], v9 offset:2304
  v_mfma_f32_16x16x32_bf16 v[56:59], v[152:155], a[184:187], v[56:59]
  ds_read_b64_tr_b16 v[132:133], v8 offset:4352
  ds_read_b64_tr_b16 v[134:135], v9 offset:4352
  v_mfma_f32_16x16x32_bf16 v[40:43], v[152:155], a[176:179], v[40:43]
  ds_read_b64_tr_b16 v[136:137], v8 offset:6400
  ds_read_b64_tr_b16 v[138:139], v9 offset:6400
  v_mfma_f32_16x16x32_bf16 v[12:15], v[156:159], a[180:183], v[12:15]
  s_add_u32 m0, s43, 98304
  s_nop 0
  buffer_load_dwordx4 v124, s[72:75], s28 offen offset:0 lds
  v_mfma_f32_16x16x32_bf16 v[44:47], v[156:159], a[188:191], v[44:47]
  v_mfma_f32_16x16x32_bf16 v[48:51], v[160:163], a[188:191], v[48:51]
  buffer_load_dwordx4 v125, s[72:75], s28 offen offset:1024 lds
  v_mfma_f32_16x16x32_bf16 v[16:19], v[160:163], a[180:183], v[16:19]
  v_mfma_f32_16x16x32_bf16 v[20:23], v[164:167], a[180:183], v[20:23]
  s_add_u32 m0, s43, 100352
  s_nop 0
  buffer_load_dwordx4 v126, s[72:75], s28 offen offset:0 lds
  v_mfma_f32_16x16x32_bf16 v[52:55], v[164:167], a[188:191], v[52:55]
  v_mfma_f32_16x16x32_bf16 v[56:59], v[168:171], a[188:191], v[56:59]
  buffer_load_dwordx4 v127, s[72:75], s28 offen offset:1024 lds
  s_add_u32 s28, s28, 128
  s_and_b32 s28, s28, 0x3ff
  v_mfma_f32_16x16x32_bf16 v[40:43], v[168:171], a[180:183], v[40:43]
  buffer_load_dwordx4 v[124:127], v64, s[20:23], s32 offen offset:0 sc1
  buffer_load_dwordx4 v[188:191], v64, s[20:23], s32 offen offset:1024 sc1
  buffer_load_dwordx4 v[192:195], v64, s[20:23], s32 offen offset:2048 sc1
  buffer_load_dwordx4 v[196:199], v64, s[20:23], s32 offen offset:3072 sc1
  s_waitcnt lgkmcnt(0)
  v_mfma_f32_16x16x32_bf16 v[12:15], v[100:103], a[192:195], v[12:15]
  ds_read_b64_tr_b16 v[140:141], v8 offset:8192
  ds_read_b64_tr_b16 v[142:143], v9 offset:8192
  v_mfma_f32_16x16x32_bf16 v[44:47], v[100:103], a[200:203], v[44:47]
  ds_read_b64_tr_b16 v[144:145], v8 offset:10240
  ds_read_b64_tr_b16 v[146:147], v9 offset:10240
  v_mfma_f32_16x16x32_bf16 v[48:51], v[104:107], a[200:203], v[48:51]
  ds_read_b64_tr_b16 v[148:149], v8 offset:12288
  ds_read_b64_tr_b16 v[150:151], v9 offset:12288
  v_mfma_f32_16x16x32_bf16 v[16:19], v[104:107], a[192:195], v[16:19]
  ds_read_b64_tr_b16 v[152:153], v8 offset:14336
  ds_read_b64_tr_b16 v[154:155], v9 offset:14336
  v_mfma_f32_16x16x32_bf16 v[20:23], v[108:111], a[192:195], v[20:23]
  ds_read_b64_tr_b16 v[156:157], v8 offset:8448
  ds_read_b64_tr_b16 v[158:159], v9 offset:8448
  v_mfma_f32_16x16x32_bf16 v[52:55], v[108:111], a[200:203], v[52:55]
  ds_read_b64_tr_b16 v[160:161], v8 offset:10496
  ds_read_b64_tr_b16 v[162:163], v9 offset:10496
  v_mfma_f32_16x16x32_bf16 v[56:59], v[112:115], a[200:203], v[56:59]
  ds_read_b64_tr_b16 v[164:165], v8 offset:12544
  ds_read_b64_tr_b16 v[166:167], v9 offset:12544
  v_mfma_f32_16x16x32_bf16 v[40:43], v[112:115], a[192:195], v[40:43]
  ds_read_b64_tr_b16 v[168:169], v8 offset:14592
  ds_read_b64_tr_b16 v[170:171], v9 offset:14592
  v_mfma_f32_16x16x32_bf16 v[12:15], v[116:119], a[196:199], v[12:15]
  s_lshr_b32 m0, s3, 1
  s_lshl_b32 m0, m0, 15
  s_add_u32 s29, s29, m0
  s_and_b32 s29, s29, 0x3ffff
  s_and_b32 m0, s3, 1
  s_lshl_b32 m0, m0, 14
  v_and_b32 v65, 0xffffafff, v65
  v_or_b32 v65, m0, v65
  s_add_u32 m0, s6, 32768
  s_nop 0
  buffer_load_dwordx4 v65, s[12:15], s29 offen offset:0 sc1 lds
  v_mfma_f32_16x16x32_bf16 v[44:47], v[116:119], a[204:207], v[44:47]
  v_mfma_f32_16x16x32_bf16 v[48:51], v[120:123], a[204:207], v[48:51]
  buffer_load_dwordx4 v65, s[12:15], s29 offen offset:1024 sc1 lds
  v_mfma_f32_16x16x32_bf16 v[16:19], v[120:123], a[196:199], v[16:19]
  v_mfma_f32_16x16x32_bf16 v[20:23], v[132:135], a[196:199], v[20:23]
  buffer_load_dwordx4 v65, s[12:15], s29 offen offset:2048 sc1 lds
  v_mfma_f32_16x16x32_bf16 v[52:55], v[132:135], a[204:207], v[52:55]
  v_mfma_f32_16x16x32_bf16 v[56:59], v[136:139], a[204:207], v[56:59]
  buffer_load_dwordx4 v65, s[12:15], s29 offen offset:3072 sc1 lds
  s_add_u32 s29, s29, 65536
  s_and_b32 s29, s29, 0x3ffff
  v_mfma_f32_16x16x32_bf16 v[40:43], v[136:139], a[196:199], v[40:43]
  v_xor_b32 v130, 0x30000, v130
  v_xor_b32 v131, 0x30000, v131
  s_waitcnt vmcnt(16)
  ds_read_b128 a[224:227], v130 offset:16384
  ds_read_b128 a[228:231], v131 offset:16384
  ds_read_b128 a[232:235], v130 offset:18432
  ds_read_b128 a[236:239], v131 offset:18432
  s_waitcnt vmcnt(12) lgkmcnt(4)
  s_barrier
  v_mfma_f32_16x16x32_bf16 v[12:15], v[140:143], a[208:211], v[12:15]
  ds_read_b64_tr_b16 v[100:101], v8 offset:16384
  ds_read_b64_tr_b16 v[102:103], v9 offset:16384
  v_mfma_f32_16x16x32_bf16 v[44:47], v[140:143], a[216:219], v[44:47]
  ds_read_b64_tr_b16 v[104:105], v8 offset:18432
  ds_read_b64_tr_b16 v[106:107], v9 offset:18432
  v_mfma_f32_16x16x32_bf16 v[48:51], v[144:147], a[216:219], v[48:51]
  ds_read_b64_tr_b16 v[108:109], v8 offset:20480
  ds_read_b64_tr_b16 v[110:111], v9 offset:20480
  v_mfma_f32_16x16x32_bf16 v[16:19], v[144:147], a[208:211], v[16:19]
  ds_read_b64_tr_b16 v[112:113], v8 offset:22528
  ds_read_b64_tr_b16 v[114:115], v9 offset:22528
  v_mfma_f32_16x16x32_bf16 v[20:23], v[148:151], a[208:211], v[20:23]
  ds_read_b64_tr_b16 v[116:117], v8 offset:16640
  ds_read_b64_tr_b16 v[118:119], v9 offset:16640
  v_mfma_f32_16x16x32_bf16 v[52:55], v[148:151], a[216:219], v[52:55]
  ds_read_b64_tr_b16 v[120:121], v8 offset:18688
  ds_read_b64_tr_b16 v[122:123], v9 offset:18688
  v_mfma_f32_16x16x32_bf16 v[56:59], v[152:155], a[216:219], v[56:59]
  ds_read_b64_tr_b16 v[132:133], v8 offset:20736
  ds_read_b64_tr_b16 v[134:135], v9 offset:20736
  v_mfma_f32_16x16x32_bf16 v[40:43], v[152:155], a[208:211], v[40:43]
  ds_read_b64_tr_b16 v[136:137], v8 offset:22784
  ds_read_b64_tr_b16 v[138:139], v9 offset:22784
  v_mfma_f32_16x16x32_bf16 v[12:15], v[156:159], a[212:215], v[12:15]
  s_add_u32 m0, s6, 49152
  s_nop 0
  buffer_load_dwordx4 v65, s[12:15], s29 offen offset:0 sc1 lds
  s_lshl_b32 s28, s3, 10
  s_add_u32 s28, s28, 131072
  v_lshl_add_u32 v67, v1, 4, s28
  s_waitcnt vmcnt(8)
  v_lshlrev_b32 v200, 16, v124
  v_and_b32 v202, 0xffff0000, v124
  v_lshlrev_b32 v201, 16, v125
  v_and_b32 v203, 0xffff0000, v125
  s_waitcnt vmcnt(7)
  v_lshlrev_b32 v204, 16, v188
  v_and_b32 v206, 0xffff0000, v188
  v_lshlrev_b32 v205, 16, v189
  v_and_b32 v207, 0xffff0000, v189
  s_waitcnt vmcnt(6)
  v_lshlrev_b32 v208, 16, v192
  v_and_b32 v210, 0xffff0000, v192
  v_lshlrev_b32 v209, 16, v193
  v_and_b32 v211, 0xffff0000, v193
  s_waitcnt vmcnt(5)
  v_lshlrev_b32 v212, 16, v196
  v_and_b32 v214, 0xffff0000, v196
  v_lshlrev_b32 v213, 16, v197
  v_and_b32 v215, 0xffff0000, v197
  v_pk_add_f32 v[216:217], v[200:201], v[208:209]
  v_pk_add_f32 v[220:221], v[200:201], v[208:209] neg_lo:[0,1] neg_hi:[0,1]
  v_pk_add_f32 v[224:225], v[204:205], v[212:213]
  v_pk_add_f32 v[218:219], v[202:203], v[210:211]
  v_pk_add_f32 v[222:223], v[202:203], v[210:211] neg_lo:[0,1] neg_hi:[0,1]
  v_pk_add_f32 v[226:227], v[206:207], v[214:215]
  v_pk_add_f32 v[228:229], v[214:215], v[206:207] neg_lo:[0,1] neg_hi:[0,1]
  v_pk_add_f32 v[230:231], v[204:205], v[212:213] neg_lo:[0,1] neg_hi:[0,1]
  s_cmp_lg_u32 s33, 0
  s_cbranch_scc1 gated_mix__spectral_gfnet__ssm_conv_s5__prompt_kernel_skip49
  s_mov_b64 exec, 15
  v_pk_add_f32 v[224:225], v[204:205], v[204:205]
  v_pk_add_f32 v[226:227], v[212:213], v[212:213]
  v_pk_add_f32 v[228:229], v[206:207], v[206:207] neg_lo:[1,1] neg_hi:[1,1]
  v_pk_add_f32 v[230:231], v[214:215], v[214:215] neg_lo:[1,1] neg_hi:[1,1]
  s_mov_b64 exec, -1
gated_mix__spectral_gfnet__ssm_conv_s5__prompt_kernel_skip49:
  v_pk_add_f32 v[200:201], v[216:217], v[224:225]
  v_cvt_pk_bf16_f32 v232, v200, v201
  v_pk_add_f32 v[202:203], v[218:219], v[226:227]
  v_cvt_pk_bf16_f32 v233, v202, v203
  v_pk_add_f32 v[204:205], v[220:221], v[228:229]
  v_cvt_pk_bf16_f32 v234, v204, v205
  v_pk_add_f32 v[206:207], v[222:223], v[230:231]
  v_cvt_pk_bf16_f32 v235, v206, v207
  v_pk_add_f32 v[208:209], v[216:217], v[224:225] neg_lo:[0,1] neg_hi:[0,1]
  v_cvt_pk_bf16_f32 v236, v208, v209
  v_pk_add_f32 v[210:211], v[218:219], v[226:227] neg_lo:[0,1] neg_hi:[0,1]
  v_cvt_pk_bf16_f32 v237, v210, v211
  v_pk_add_f32 v[212:213], v[220:221], v[228:229] neg_lo:[0,1] neg_hi:[0,1]
  v_cvt_pk_bf16_f32 v238, v212, v213
  v_pk_add_f32 v[214:215], v[222:223], v[230:231] neg_lo:[0,1] neg_hi:[0,1]
  v_cvt_pk_bf16_f32 v239, v214, v215
  v_lshlrev_b32 v200, 16, v126
  v_and_b32 v202, 0xffff0000, v126
  v_lshlrev_b32 v201, 16, v127
  v_and_b32 v203, 0xffff0000, v127
  v_lshlrev_b32 v204, 16, v190
  v_and_b32 v206, 0xffff0000, v190
  v_lshlrev_b32 v205, 16, v191
  v_and_b32 v207, 0xffff0000, v191
  v_lshlrev_b32 v208, 16, v194
  v_and_b32 v210, 0xffff0000, v194
  v_lshlrev_b32 v209, 16, v195
  v_and_b32 v211, 0xffff0000, v195
  v_lshlrev_b32 v212, 16, v198
  v_and_b32 v214, 0xffff0000, v198
  v_lshlrev_b32 v213, 16, v199
  v_and_b32 v215, 0xffff0000, v199
  v_pk_add_f32 v[216:217], v[200:201], v[208:209]
  v_pk_add_f32 v[220:221], v[200:201], v[208:209] neg_lo:[0,1] neg_hi:[0,1]
  v_pk_add_f32 v[224:225], v[204:205], v[212:213]
  v_pk_add_f32 v[218:219], v[202:203], v[210:211]
  v_pk_add_f32 v[222:223], v[202:203], v[210:211] neg_lo:[0,1] neg_hi:[0,1]
  v_pk_add_f32 v[226:227], v[206:207], v[214:215]
  v_pk_add_f32 v[228:229], v[214:215], v[206:207] neg_lo:[0,1] neg_hi:[0,1]
  v_pk_add_f32 v[230:231], v[204:205], v[212:213] neg_lo:[0,1] neg_hi:[0,1]
  s_cmp_lg_u32 s33, 0
  s_cbranch_scc1 gated_mix__spectral_gfnet__ssm_conv_s5__prompt_kernel_skip50
  s_mov_b64 exec, 15
  v_pk_add_f32 v[224:225], v[204:205], v[204:205]
  v_pk_add_f32 v[226:227], v[212:213], v[212:213]
  v_pk_add_f32 v[228:229], v[206:207], v[206:207] neg_lo:[1,1] neg_hi:[1,1]
  v_pk_add_f32 v[230:231], v[214:215], v[214:215] neg_lo:[1,1] neg_hi:[1,1]
  s_mov_b64 exec, -1
gated_mix__spectral_gfnet__ssm_conv_s5__prompt_kernel_skip50:
  v_pk_add_f32 v[200:201], v[216:217], v[224:225]
  v_cvt_pk_bf16_f32 v125, v200, v201
  v_pk_add_f32 v[202:203], v[218:219], v[226:227]
  v_cvt_pk_bf16_f32 v127, v202, v203
  v_pk_add_f32 v[204:205], v[220:221], v[228:229]
  v_cvt_pk_bf16_f32 v189, v204, v205
  v_pk_add_f32 v[206:207], v[222:223], v[230:231]
  v_cvt_pk_bf16_f32 v191, v206, v207
  v_pk_add_f32 v[208:209], v[216:217], v[224:225] neg_lo:[0,1] neg_hi:[0,1]
  v_cvt_pk_bf16_f32 v193, v208, v209
  v_pk_add_f32 v[210:211], v[218:219], v[226:227] neg_lo:[0,1] neg_hi:[0,1]
  v_cvt_pk_bf16_f32 v195, v210, v211
  v_pk_add_f32 v[212:213], v[220:221], v[228:229] neg_lo:[0,1] neg_hi:[0,1]
  v_cvt_pk_bf16_f32 v197, v212, v213
  v_pk_add_f32 v[214:215], v[222:223], v[230:231] neg_lo:[0,1] neg_hi:[0,1]
  v_cvt_pk_bf16_f32 v199, v214, v215
  v_mov_b32 v124, v232
  v_mov_b32 v126, v233
  ds_write_b128 v67, v[124:127] offset:0
  v_mov_b32 v188, v234
  v_mov_b32 v190, v235
  ds_write_b128 v67, v[188:191] offset:4096
  v_mov_b32 v192, v236
  v_mov_b32 v194, v237
  ds_write_b128 v67, v[192:195] offset:8192
  v_mov_b32 v196, v238
  v_mov_b32 v198, v239
  ds_write_b128 v67, v[196:199] offset:12288
  v_mfma_f32_16x16x32_bf16 v[44:47], v[156:159], a[220:223], v[44:47]
  v_mfma_f32_16x16x32_bf16 v[48:51], v[160:163], a[220:223], v[48:51]
  buffer_load_dwordx4 v65, s[12:15], s29 offen offset:1024 sc1 lds
  v_mfma_f32_16x16x32_bf16 v[16:19], v[160:163], a[212:215], v[16:19]
  v_mfma_f32_16x16x32_bf16 v[20:23], v[164:167], a[212:215], v[20:23]
  buffer_load_dwordx4 v65, s[12:15], s29 offen offset:2048 sc1 lds
  v_mfma_f32_16x16x32_bf16 v[52:55], v[164:167], a[220:223], v[52:55]
  v_mfma_f32_16x16x32_bf16 v[56:59], v[168:171], a[220:223], v[56:59]
  buffer_load_dwordx4 v65, s[12:15], s29 offen offset:3072 sc1 lds
  s_add_u32 s29, s29, 65536
  s_and_b32 s29, s29, 0x3ffff
  v_mfma_f32_16x16x32_bf16 v[40:43], v[168:171], a[212:215], v[40:43]
  s_waitcnt lgkmcnt(4)
  v_mfma_f32_16x16x32_bf16 v[12:15], v[100:103], a[224:227], v[12:15]
  ds_read_b64_tr_b16 v[140:141], v8 offset:24576
  ds_read_b64_tr_b16 v[142:143], v9 offset:24576
  v_mfma_f32_16x16x32_bf16 v[44:47], v[100:103], a[232:235], v[44:47]
  ds_read_b64_tr_b16 v[144:145], v8 offset:26624
  ds_read_b64_tr_b16 v[146:147], v9 offset:26624
  v_mfma_f32_16x16x32_bf16 v[48:51], v[104:107], a[232:235], v[48:51]
  ds_read_b64_tr_b16 v[148:149], v8 offset:28672
  ds_read_b64_tr_b16 v[150:151], v9 offset:28672
  v_mfma_f32_16x16x32_bf16 v[16:19], v[104:107], a[224:227], v[16:19]
  ds_read_b64_tr_b16 v[152:153], v8 offset:30720
  ds_read_b64_tr_b16 v[154:155], v9 offset:30720
  v_mfma_f32_16x16x32_bf16 v[20:23], v[108:111], a[224:227], v[20:23]
  ds_read_b64_tr_b16 v[156:157], v8 offset:24832
  ds_read_b64_tr_b16 v[158:159], v9 offset:24832
  v_mfma_f32_16x16x32_bf16 v[52:55], v[108:111], a[232:235], v[52:55]
  ds_read_b64_tr_b16 v[160:161], v8 offset:26880
  ds_read_b64_tr_b16 v[162:163], v9 offset:26880
  v_mfma_f32_16x16x32_bf16 v[56:59], v[112:115], a[232:235], v[56:59]
  ds_read_b64_tr_b16 v[164:165], v8 offset:28928
  ds_read_b64_tr_b16 v[166:167], v9 offset:28928
  v_mfma_f32_16x16x32_bf16 v[40:43], v[112:115], a[224:227], v[40:43]
  ds_read_b64_tr_b16 v[168:169], v8 offset:30976
  ds_read_b64_tr_b16 v[170:171], v9 offset:30976
  v_mfma_f32_16x16x32_bf16 v[12:15], v[116:119], a[228:231], v[12:15]
  s_add_u32 m0, s6, 65536
  s_nop 0
  buffer_load_dwordx4 v65, s[12:15], s29 offen offset:0 sc1 lds
  v_mfma_f32_16x16x32_bf16 v[44:47], v[116:119], a[236:239], v[44:47]
  v_mfma_f32_16x16x32_bf16 v[48:51], v[120:123], a[236:239], v[48:51]
  buffer_load_dwordx4 v65, s[12:15], s29 offen offset:1024 sc1 lds
  v_mfma_f32_16x16x32_bf16 v[16:19], v[120:123], a[228:231], v[16:19]
  v_mfma_f32_16x16x32_bf16 v[20:23], v[132:135], a[228:231], v[20:23]
  buffer_load_dwordx4 v65, s[12:15], s29 offen offset:2048 sc1 lds
  v_mfma_f32_16x16x32_bf16 v[52:55], v[132:135], a[236:239], v[52:55]
  v_mfma_f32_16x16x32_bf16 v[56:59], v[136:139], a[236:239], v[56:59]
  buffer_load_dwordx4 v65, s[12:15], s29 offen offset:3072 sc1 lds
  s_add_u32 s29, s29, 65536
  s_and_b32 s29, s29, 0x3ffff
  v_mfma_f32_16x16x32_bf16 v[40:43], v[136:139], a[228:231], v[40:43]
  v_xor_b32 v130, 0x30000, v130
  v_xor_b32 v131, 0x30000, v131
  ds_read_b128 a[240:243], v130 offset:32768
  ds_read_b128 a[244:247], v131 offset:32768
  ds_read_b128 a[248:251], v130 offset:34816
  ds_read_b128 a[252:255], v131 offset:34816
  s_waitcnt lgkmcnt(15)
  s_waitcnt vmcnt(8) lgkmcnt(4)
  s_barrier
  s_waitcnt lgkmcnt(3)
  v_mfma_f32_16x16x32_bf16 v[12:15], v[140:143], a[240:243], v[12:15]
  ds_read_b64_tr_b16 v[100:101], v8 offset:32768
  ds_read_b64_tr_b16 v[102:103], v9 offset:32768
  s_waitcnt lgkmcnt(3)
  v_mfma_f32_16x16x32_bf16 v[44:47], v[140:143], a[248:251], v[44:47]
  ds_read_b64_tr_b16 v[104:105], v8 offset:34816
  ds_read_b64_tr_b16 v[106:107], v9 offset:34816
  v_mfma_f32_16x16x32_bf16 v[48:51], v[144:147], a[248:251], v[48:51]
  ds_read_b64_tr_b16 v[108:109], v8 offset:36864
  ds_read_b64_tr_b16 v[110:111], v9 offset:36864
  v_mfma_f32_16x16x32_bf16 v[16:19], v[144:147], a[240:243], v[16:19]
  ds_read_b64_tr_b16 v[112:113], v8 offset:38912
  ds_read_b64_tr_b16 v[114:115], v9 offset:38912
  v_mfma_f32_16x16x32_bf16 v[20:23], v[148:151], a[240:243], v[20:23]
  ds_read_b64_tr_b16 v[116:117], v8 offset:33024
  ds_read_b64_tr_b16 v[118:119], v9 offset:33024
  v_mfma_f32_16x16x32_bf16 v[52:55], v[148:151], a[248:251], v[52:55]
  ds_read_b64_tr_b16 v[120:121], v8 offset:35072
  ds_read_b64_tr_b16 v[122:123], v9 offset:35072
  v_mfma_f32_16x16x32_bf16 v[56:59], v[152:155], a[248:251], v[56:59]
  ds_read_b64_tr_b16 v[132:133], v8 offset:37120
  ds_read_b64_tr_b16 v[134:135], v9 offset:37120
  v_mfma_f32_16x16x32_bf16 v[40:43], v[152:155], a[240:243], v[40:43]
  ds_read_b64_tr_b16 v[136:137], v8 offset:39168
  ds_read_b64_tr_b16 v[138:139], v9 offset:39168
  v_mfma_f32_16x16x32_bf16 v[12:15], v[156:159], a[244:247], v[12:15]
  s_add_u32 m0, s6, 81920
  s_nop 0
  buffer_load_dwordx4 v65, s[12:15], s29 offen offset:0 sc1 lds
  s_waitcnt lgkmcnt(15)
  v_mfma_f32_16x16x32_bf16 v[44:47], v[156:159], a[252:255], v[44:47]
  v_mfma_f32_16x16x32_bf16 v[48:51], v[160:163], a[252:255], v[48:51]
  buffer_load_dwordx4 v65, s[12:15], s29 offen offset:1024 sc1 lds
  v_mfma_f32_16x16x32_bf16 v[16:19], v[160:163], a[244:247], v[16:19]
  v_mfma_f32_16x16x32_bf16 v[20:23], v[164:167], a[244:247], v[20:23]
  buffer_load_dwordx4 v65, s[12:15], s29 offen offset:2048 sc1 lds
  v_mfma_f32_16x16x32_bf16 v[52:55], v[164:167], a[252:255], v[52:55]
  v_mfma_f32_16x16x32_bf16 v[56:59], v[168:171], a[252:255], v[56:59]
  buffer_load_dwordx4 v65, s[12:15], s29 offen offset:3072 sc1 lds
  s_add_u32 s29, s29, 65536
  s_and_b32 s29, s29, 0x3ffff
  v_xor_b32 v65, 4096, v65
  v_mfma_f32_16x16x32_bf16 v[40:43], v[168:171], a[244:247], v[40:43]
  buffer_load_dwordx4 v[228:231], v66, s[80:83], s8 offen offset:0 sc1
  buffer_load_dwordx4 v[232:235], v66, s[80:83], s8 offen offset:256 sc1
  buffer_load_dwordx4 v[236:239], v66, s[80:83], s8 offen offset:512 sc1
  buffer_load_dwordx4 v[240:243], v66, s[80:83], s8 offen offset:768 sc1
  ds_read_b64_tr_b16 v[124:125], v6 offset:0
  ds_read_b64_tr_b16 v[126:127], v6 offset:256
  ds_read_b64_tr_b16 v[128:129], v6 offset:1024
  ds_read_b64_tr_b16 v[130:131], v6 offset:1280
  ds_read_b64_tr_b16 v[188:189], v6 offset:2048
  ds_read_b64_tr_b16 v[190:191], v6 offset:2304
  ds_read_b64_tr_b16 v[192:193], v6 offset:3072
  ds_read_b64_tr_b16 v[194:195], v6 offset:3328
  s_waitcnt lgkmcnt(8)
  v_mfma_f32_16x16x32_bf16 v[68:71], v[100:103], a[0:3], v[68:71]
  ds_read_b64_tr_b16 v[140:141], v8 offset:40960
  ds_read_b64_tr_b16 v[142:143], v9 offset:40960
  v_mfma_f32_16x16x32_bf16 v[84:87], v[100:103], a[8:11], 0
  ds_read_b64_tr_b16 v[144:145], v8 offset:43008
  ds_read_b64_tr_b16 v[146:147], v9 offset:43008
  v_mfma_f32_16x16x32_bf16 v[88:91], v[104:107], a[8:11], 0
  ds_read_b64_tr_b16 v[148:149], v8 offset:45056
  ds_read_b64_tr_b16 v[150:151], v9 offset:45056
  v_mfma_f32_16x16x32_bf16 v[72:75], v[104:107], a[0:3], v[72:75]
  ds_read_b64_tr_b16 v[152:153], v8 offset:47104
  ds_read_b64_tr_b16 v[154:155], v9 offset:47104
  v_mfma_f32_16x16x32_bf16 v[68:71], v[108:111], a[16:19], v[68:71]
  ds_read_b64_tr_b16 v[156:157], v8 offset:41216
  ds_read_b64_tr_b16 v[158:159], v9 offset:41216
  v_mfma_f32_16x16x32_bf16 v[84:87], v[108:111], a[24:27], v[84:87]
  ds_read_b64_tr_b16 v[160:161], v8 offset:43264
  ds_read_b64_tr_b16 v[162:163], v9 offset:43264
  v_mfma_f32_16x16x32_bf16 v[88:91], v[112:115], a[24:27], v[88:91]
  ds_read_b64_tr_b16 v[164:165], v8 offset:45312
  ds_read_b64_tr_b16 v[166:167], v9 offset:45312
  v_mfma_f32_16x16x32_bf16 v[72:75], v[112:115], a[16:19], v[72:75]
  ds_read_b64_tr_b16 v[168:169], v8 offset:47360
  ds_read_b64_tr_b16 v[170:171], v9 offset:47360
  v_mfma_f32_16x16x32_bf16 v[68:71], v[116:119], a[4:7], v[68:71]
  s_add_u32 m0, s6, 0
  s_nop 0
  buffer_load_dwordx4 v65, s[12:15], s29 offen offset:0 sc1 lds
  s_waitcnt lgkmcnt(15)
  v_mfma_f32_16x16x32_bf16 v[196:199], v[24:27], v[124:127], 0
  s_waitcnt lgkmcnt(15)
  v_mfma_f32_16x16x32_bf16 v[212:215], v[24:27], v[188:191], 0
  v_mfma_f32_16x16x32_bf16 v[84:87], v[116:119], a[12:15], v[84:87]
  v_mfma_f32_16x16x32_bf16 v[200:203], v[32:35], v[124:127], 0
  v_mfma_f32_16x16x32_bf16 v[216:219], v[32:35], v[188:191], 0
  v_mfma_f32_16x16x32_bf16 v[88:91], v[120:123], a[12:15], v[88:91]
  buffer_load_dwordx4 v65, s[12:15], s29 offen offset:1024 sc1 lds
  v_mfma_f32_16x16x32_bf16 v[204:207], v[172:175], v[124:127], 0
  v_mfma_f32_16x16x32_bf16 v[220:223], v[172:175], v[188:191], 0
  v_mfma_f32_16x16x32_bf16 v[72:75], v[120:123], a[4:7], v[72:75]
  v_mfma_f32_16x16x32_bf16 v[208:211], v[180:183], v[124:127], 0
  v_mfma_f32_16x16x32_bf16 v[224:227], v[180:183], v[188:191], 0
  v_mfma_f32_16x16x32_bf16 v[68:71], v[132:135], a[20:23], v[68:71]
  buffer_load_dwordx4 v65, s[12:15], s29 offen offset:2048 sc1 lds
  v_mfma_f32_16x16x32_bf16 v[196:199], v[28:31], v[128:131], v[196:199]
  s_waitcnt lgkmcnt(15)
  v_mfma_f32_16x16x32_bf16 v[212:215], v[28:31], v[192:195], v[212:215]
  v_mfma_f32_16x16x32_bf16 v[84:87], v[132:135], a[28:31], v[84:87]
  v_mfma_f32_16x16x32_bf16 v[200:203], v[60:63], v[128:131], v[200:203]
  v_mfma_f32_16x16x32_bf16 v[216:219], v[60:63], v[192:195], v[216:219]
  v_mfma_f32_16x16x32_bf16 v[88:91], v[136:139], a[28:31], v[88:91]
  buffer_load_dwordx4 v65, s[12:15], s29 offen offset:3072 sc1 lds
  s_add_u32 s29, s29, 65536
  s_and_b32 s29, s29, 0x3ffff
  v_mfma_f32_16x16x32_bf16 v[204:207], v[176:179], v[128:131], v[204:207]
  v_mfma_f32_16x16x32_bf16 v[220:223], v[176:179], v[192:195], v[220:223]
  v_mfma_f32_16x16x32_bf16 v[72:75], v[136:139], a[20:23], v[72:75]
  v_mfma_f32_16x16x32_bf16 v[208:211], v[184:187], v[128:131], v[208:211]
  v_mfma_f32_16x16x32_bf16 v[224:227], v[184:187], v[192:195], v[224:227]
  s_waitcnt vmcnt(12) lgkmcnt(0)
  s_barrier
  v_mfma_f32_16x16x32_bf16 v[68:71], v[140:143], a[32:35], v[68:71]
  ds_read_b64_tr_b16 v[100:101], v8 offset:49152
  ds_read_b64_tr_b16 v[102:103], v9 offset:49152
  v_mfma_f32_16x16x32_bf16 v[84:87], v[140:143], a[40:43], v[84:87]
  ds_read_b64_tr_b16 v[104:105], v8 offset:51200
  ds_read_b64_tr_b16 v[106:107], v9 offset:51200
  v_mfma_f32_16x16x32_bf16 v[88:91], v[144:147], a[40:43], v[88:91]
  ds_read_b64_tr_b16 v[108:109], v8 offset:53248
  ds_read_b64_tr_b16 v[110:111], v9 offset:53248
  v_mfma_f32_16x16x32_bf16 v[72:75], v[144:147], a[32:35], v[72:75]
  ds_read_b64_tr_b16 v[112:113], v8 offset:55296
  ds_read_b64_tr_b16 v[114:115], v9 offset:55296
  v_mfma_f32_16x16x32_bf16 v[68:71], v[148:151], a[48:51], v[68:71]
  ds_read_b64_tr_b16 v[116:117], v8 offset:49408
  ds_read_b64_tr_b16 v[118:119], v9 offset:49408
  v_mfma_f32_16x16x32_bf16 v[84:87], v[148:151], a[56:59], v[84:87]
  ds_read_b64_tr_b16 v[120:121], v8 offset:51456
  ds_read_b64_tr_b16 v[122:123], v9 offset:51456
  v_mfma_f32_16x16x32_bf16 v[88:91], v[152:155], a[56:59], v[88:91]
  ds_read_b64_tr_b16 v[132:133], v8 offset:53504
  ds_read_b64_tr_b16 v[134:135], v9 offset:53504
  v_mfma_f32_16x16x32_bf16 v[72:75], v[152:155], a[48:51], v[72:75]
  ds_read_b64_tr_b16 v[136:137], v8 offset:55552
  ds_read_b64_tr_b16 v[138:139], v9 offset:55552
  v_mfma_f32_16x16x32_bf16 v[68:71], v[156:159], a[36:39], v[68:71]
  s_add_u32 m0, s6, 16384
  s_nop 0
  buffer_load_dwordx4 v65, s[12:15], s29 offen offset:0 sc1 lds
  v_xor_b32 v25, 0x80008000, v25
  v_xor_b32 v27, 0x80008000, v27
  v_xor_b32 v29, 0x80008000, v29
  v_xor_b32 v31, 0x80008000, v31
  v_xor_b32 v33, 0x80008000, v33
  v_xor_b32 v35, 0x80008000, v35
  v_mfma_f32_16x16x32_bf16 v[84:87], v[156:159], a[44:47], v[84:87]
  v_xor_b32 v61, 0x80008000, v61
  v_xor_b32 v63, 0x80008000, v63
  v_xor_b32 v173, 0x80008000, v173
  v_xor_b32 v175, 0x80008000, v175
  v_xor_b32 v177, 0x80008000, v177
  v_xor_b32 v179, 0x80008000, v179
  v_mfma_f32_16x16x32_bf16 v[88:91], v[160:163], a[44:47], v[88:91]
  buffer_load_dwordx4 v65, s[12:15], s29 offen offset:1024 sc1 lds
  v_xor_b32 v181, 0x80008000, v181
  v_xor_b32 v183, 0x80008000, v183
  v_xor_b32 v185, 0x80008000, v185
  v_xor_b32 v187, 0x80008000, v187
  v_pk_add_f32 v[196:197], v[196:197], v[12:13] neg_lo:[0,1] neg_hi:[0,1]
  v_pk_add_f32 v[198:199], v[198:199], v[14:15] neg_lo:[0,1] neg_hi:[0,1]
  v_mfma_f32_16x16x32_bf16 v[72:75], v[160:163], a[36:39], v[72:75]
  s_waitcnt vmcnt(9)
  v_pk_fma_f32 v[12:13], v[228:229], v[196:197], v[12:13]
  v_pk_fma_f32 v[14:15], v[230:231], v[198:199], v[14:15]
  v_perm_b32 v12, v13, v12, s58
  v_perm_b32 v13, v15, v14, s58
  v_or_b32 v12, 0x10001, v12
  v_or_b32 v13, 0x10001, v13
  v_mfma_f32_16x16x32_bf16 v[68:71], v[164:167], a[52:55], v[68:71]
  buffer_load_dwordx4 v65, s[12:15], s29 offen offset:2048 sc1 lds
  v_pk_add_f32 v[200:201], v[200:201], v[16:17] neg_lo:[0,1] neg_hi:[0,1]
  v_pk_add_f32 v[202:203], v[202:203], v[18:19] neg_lo:[0,1] neg_hi:[0,1]
  s_waitcnt vmcnt(9)
  v_pk_fma_f32 v[16:17], v[232:233], v[200:201], v[16:17]
  v_pk_fma_f32 v[18:19], v[234:235], v[202:203], v[18:19]
  v_perm_b32 v14, v17, v16, s58
  v_perm_b32 v15, v19, v18, s58
  v_mfma_f32_16x16x32_bf16 v[84:87], v[164:167], a[60:63], v[84:87]
  v_or_b32 v14, 0x10001, v14
  v_or_b32 v15, 0x10001, v15
  buffer_store_dwordx4 v[12:15], v64, s[44:47], s9 offen offset:0 sc1
  v_pk_add_f32 v[204:205], v[204:205], v[20:21] neg_lo:[0,1] neg_hi:[0,1]
  v_pk_add_f32 v[206:207], v[206:207], v[22:23] neg_lo:[0,1] neg_hi:[0,1]
  s_waitcnt vmcnt(9)
  v_pk_fma_f32 v[20:21], v[236:237], v[204:205], v[20:21]
  v_mfma_f32_16x16x32_bf16 v[88:91], v[168:171], a[60:63], v[88:91]
  buffer_load_dwordx4 v65, s[12:15], s29 offen offset:3072 sc1 lds
  s_add_u32 s29, s29, 65536
  s_and_b32 s29, s29, 0x3ffff
  v_pk_fma_f32 v[22:23], v[238:239], v[206:207], v[22:23]
  v_perm_b32 v16, v21, v20, s58
  v_perm_b32 v17, v23, v22, s58
  v_or_b32 v16, 0x10001, v16
  v_or_b32 v17, 0x10001, v17
  v_pk_add_f32 v[208:209], v[208:209], v[40:41] neg_lo:[0,1] neg_hi:[0,1]
  v_mfma_f32_16x16x32_bf16 v[72:75], v[168:171], a[52:55], v[72:75]
  v_pk_add_f32 v[210:211], v[210:211], v[42:43] neg_lo:[0,1] neg_hi:[0,1]
  s_waitcnt vmcnt(9)
  v_pk_fma_f32 v[40:41], v[240:241], v[208:209], v[40:41]
  v_pk_fma_f32 v[42:43], v[242:243], v[210:211], v[42:43]
  v_perm_b32 v18, v41, v40, s58
  v_perm_b32 v19, v43, v42, s58
  v_or_b32 v18, 0x10001, v18
  s_waitcnt lgkmcnt(0)
  v_mfma_f32_16x16x32_bf16 v[68:71], v[100:103], a[64:67], v[68:71]
  ds_read_b64_tr_b16 v[140:141], v8 offset:57344
  ds_read_b64_tr_b16 v[142:143], v9 offset:57344
  v_mfma_f32_16x16x32_bf16 v[84:87], v[100:103], a[72:75], v[84:87]
  ds_read_b64_tr_b16 v[144:145], v8 offset:59392
  ds_read_b64_tr_b16 v[146:147], v9 offset:59392
  v_mfma_f32_16x16x32_bf16 v[88:91], v[104:107], a[72:75], v[88:91]
  ds_read_b64_tr_b16 v[148:149], v8 offset:61440
  ds_read_b64_tr_b16 v[150:151], v9 offset:61440
  v_mfma_f32_16x16x32_bf16 v[72:75], v[104:107], a[64:67], v[72:75]
  ds_read_b64_tr_b16 v[152:153], v8 offset:63488
  ds_read_b64_tr_b16 v[154:155], v9 offset:63488
  v_mfma_f32_16x16x32_bf16 v[68:71], v[108:111], a[80:83], v[68:71]
  ds_read_b64_tr_b16 v[156:157], v8 offset:57600
  ds_read_b64_tr_b16 v[158:159], v9 offset:57600
  v_mfma_f32_16x16x32_bf16 v[84:87], v[108:111], a[88:91], v[84:87]
  ds_read_b64_tr_b16 v[160:161], v8 offset:59648
  ds_read_b64_tr_b16 v[162:163], v9 offset:59648
  v_mfma_f32_16x16x32_bf16 v[88:91], v[112:115], a[88:91], v[88:91]
  ds_read_b64_tr_b16 v[164:165], v8 offset:61696
  ds_read_b64_tr_b16 v[166:167], v9 offset:61696
  v_mfma_f32_16x16x32_bf16 v[72:75], v[112:115], a[80:83], v[72:75]
  ds_read_b64_tr_b16 v[168:169], v8 offset:63744
  ds_read_b64_tr_b16 v[170:171], v9 offset:63744
  v_mfma_f32_16x16x32_bf16 v[68:71], v[116:119], a[68:71], v[68:71]
  s_add_u32 m0, s6, 32768
  s_nop 0
  buffer_load_dwordx4 v65, s[12:15], s29 offen offset:0 sc1 lds
  v_or_b32 v19, 0x10001, v19
  buffer_store_dwordx4 v[16:19], v64, s[44:47], s9 offen offset:1024 sc1
  v_pk_add_f32 v[212:213], v[212:213], v[44:45] neg_lo:[0,1] neg_hi:[0,1]
  v_pk_add_f32 v[214:215], v[214:215], v[46:47] neg_lo:[0,1] neg_hi:[0,1]
  v_pk_fma_f32 v[44:45], v[228:229], v[212:213], v[44:45]
  v_pk_fma_f32 v[46:47], v[230:231], v[214:215], v[46:47]
  v_mfma_f32_16x16x32_bf16 v[84:87], v[116:119], a[76:79], v[84:87]
  v_perm_b32 v20, v45, v44, s58
  v_perm_b32 v21, v47, v46, s58
  v_or_b32 v20, 0x10001, v20
  v_or_b32 v21, 0x10001, v21
  v_pk_add_f32 v[216:217], v[216:217], v[48:49] neg_lo:[0,1] neg_hi:[0,1]
  v_pk_add_f32 v[218:219], v[218:219], v[50:51] neg_lo:[0,1] neg_hi:[0,1]
  v_mfma_f32_16x16x32_bf16 v[88:91], v[120:123], a[76:79], v[88:91]
  buffer_load_dwordx4 v65, s[12:15], s29 offen offset:1024 sc1 lds
  v_pk_fma_f32 v[48:49], v[232:233], v[216:217], v[48:49]
  v_pk_fma_f32 v[50:51], v[234:235], v[218:219], v[50:51]
  v_perm_b32 v22, v49, v48, s58
  v_perm_b32 v23, v51, v50, s58
  v_or_b32 v22, 0x10001, v22
  v_or_b32 v23, 0x10001, v23
  v_mfma_f32_16x16x32_bf16 v[72:75], v[120:123], a[68:71], v[72:75]
  buffer_store_dwordx4 v[20:23], v64, s[44:47], s9 offen offset:2048 sc1
  v_pk_add_f32 v[220:221], v[220:221], v[52:53] neg_lo:[0,1] neg_hi:[0,1]
  v_pk_add_f32 v[222:223], v[222:223], v[54:55] neg_lo:[0,1] neg_hi:[0,1]
  v_pk_fma_f32 v[52:53], v[236:237], v[220:221], v[52:53]
  v_pk_fma_f32 v[54:55], v[238:239], v[222:223], v[54:55]
  v_perm_b32 v40, v53, v52, s58
  v_mfma_f32_16x16x32_bf16 v[68:71], v[132:135], a[84:87], v[68:71]
  buffer_load_dwordx4 v65, s[12:15], s29 offen offset:2048 sc1 lds
  v_perm_b32 v41, v55, v54, s58
  v_or_b32 v40, 0x10001, v40
  v_or_b32 v41, 0x10001, v41
  v_pk_add_f32 v[224:225], v[224:225], v[56:57] neg_lo:[0,1] neg_hi:[0,1]
  v_pk_add_f32 v[226:227], v[226:227], v[58:59] neg_lo:[0,1] neg_hi:[0,1]
  v_pk_fma_f32 v[56:57], v[240:241], v[224:225], v[56:57]
  v_mfma_f32_16x16x32_bf16 v[84:87], v[132:135], a[92:95], v[84:87]
  v_pk_fma_f32 v[58:59], v[242:243], v[226:227], v[58:59]
  v_perm_b32 v42, v57, v56, s58
  v_perm_b32 v43, v59, v58, s58
  v_or_b32 v42, 0x10001, v42
  v_or_b32 v43, 0x10001, v43
  buffer_store_dwordx4 v[40:43], v64, s[44:47], s9 offen offset:3072 sc1
  v_mfma_f32_16x16x32_bf16 v[88:91], v[136:139], a[92:95], v[88:91]
  buffer_load_dwordx4 v65, s[12:15], s29 offen offset:3072 sc1 lds
  s_add_u32 s29, s29, 65536
  s_and_b32 s29, s29, 0x3ffff
  s_xor_b32 s8, s8, 1024
  s_xor_b32 s9, s9, 131072
  v_mfma_f32_16x16x32_bf16 v[72:75], v[136:139], a[84:87], v[72:75]
  s_waitcnt lgkmcnt(0)
  v_mfma_f32_16x16x32_bf16 v[68:71], v[140:143], a[96:99], v[68:71]
  ds_read_b64_tr_b16 v[100:101], v10 offset:0
  ds_read_b64_tr_b16 v[102:103], v11 offset:0
  v_mfma_f32_16x16x32_bf16 v[84:87], v[140:143], a[104:107], v[84:87]
  ds_read_b64_tr_b16 v[104:105], v10 offset:2048
  ds_read_b64_tr_b16 v[106:107], v11 offset:2048
  v_mfma_f32_16x16x32_bf16 v[88:91], v[144:147], a[104:107], v[88:91]
  ds_read_b64_tr_b16 v[108:109], v10 offset:4096
  ds_read_b64_tr_b16 v[110:111], v11 offset:4096
  v_mfma_f32_16x16x32_bf16 v[72:75], v[144:147], a[96:99], v[72:75]
  ds_read_b64_tr_b16 v[112:113], v10 offset:6144
  ds_read_b64_tr_b16 v[114:115], v11 offset:6144
  v_mfma_f32_16x16x32_bf16 v[68:71], v[148:151], a[112:115], v[68:71]
  ds_read_b64_tr_b16 v[116:117], v10 offset:256
  ds_read_b64_tr_b16 v[118:119], v11 offset:256
  v_mfma_f32_16x16x32_bf16 v[84:87], v[148:151], a[120:123], v[84:87]
  ds_read_b64_tr_b16 v[120:121], v10 offset:2304
  ds_read_b64_tr_b16 v[122:123], v11 offset:2304
  v_mfma_f32_16x16x32_bf16 v[88:91], v[152:155], a[120:123], v[88:91]
  ds_read_b64_tr_b16 v[132:133], v10 offset:4352
  ds_read_b64_tr_b16 v[134:135], v11 offset:4352
  v_mfma_f32_16x16x32_bf16 v[72:75], v[152:155], a[112:115], v[72:75]
  ds_read_b64_tr_b16 v[136:137], v10 offset:6400
  ds_read_b64_tr_b16 v[138:139], v11 offset:6400
  v_mfma_f32_16x16x32_bf16 v[68:71], v[156:159], a[100:103], v[68:71]
  v_mfma_f32_16x16x32_bf16 v[84:87], v[156:159], a[108:111], v[84:87]
  v_mfma_f32_16x16x32_bf16 v[88:91], v[160:163], a[108:111], v[88:91]
  v_mfma_f32_16x16x32_bf16 v[72:75], v[160:163], a[100:103], v[72:75]
  v_mfma_f32_16x16x32_bf16 v[68:71], v[164:167], a[116:119], v[68:71]
  v_mfma_f32_16x16x32_bf16 v[84:87], v[164:167], a[124:127], v[84:87]
  v_mfma_f32_16x16x32_bf16 v[88:91], v[168:171], a[124:127], v[88:91]
  v_mfma_f32_16x16x32_bf16 v[72:75], v[168:171], a[116:119], v[72:75]
  s_waitcnt lgkmcnt(0)
  v_mfma_f32_16x16x32_bf16 v[68:71], v[100:103], a[128:131], v[68:71]
  ds_read_b64_tr_b16 v[140:141], v10 offset:8192
  ds_read_b64_tr_b16 v[142:143], v11 offset:8192
  v_mfma_f32_16x16x32_bf16 v[84:87], v[100:103], a[136:139], v[84:87]
  ds_read_b64_tr_b16 v[144:145], v10 offset:10240
  ds_read_b64_tr_b16 v[146:147], v11 offset:10240
  v_mfma_f32_16x16x32_bf16 v[88:91], v[104:107], a[136:139], v[88:91]
  ds_read_b64_tr_b16 v[148:149], v10 offset:12288
  ds_read_b64_tr_b16 v[150:151], v11 offset:12288
  v_mfma_f32_16x16x32_bf16 v[72:75], v[104:107], a[128:131], v[72:75]
  ds_read_b64_tr_b16 v[152:153], v10 offset:14336
  ds_read_b64_tr_b16 v[154:155], v11 offset:14336
  v_mfma_f32_16x16x32_bf16 v[68:71], v[108:111], a[144:147], v[68:71]
  ds_read_b64_tr_b16 v[156:157], v10 offset:8448
  ds_read_b64_tr_b16 v[158:159], v11 offset:8448
  v_mfma_f32_16x16x32_bf16 v[84:87], v[108:111], a[152:155], v[84:87]
  ds_read_b64_tr_b16 v[160:161], v10 offset:10496
  ds_read_b64_tr_b16 v[162:163], v11 offset:10496
  v_mfma_f32_16x16x32_bf16 v[88:91], v[112:115], a[152:155], v[88:91]
  ds_read_b64_tr_b16 v[164:165], v10 offset:12544
  ds_read_b64_tr_b16 v[166:167], v11 offset:12544
  v_mfma_f32_16x16x32_bf16 v[72:75], v[112:115], a[144:147], v[72:75]
  ds_read_b64_tr_b16 v[168:169], v10 offset:14592
  ds_read_b64_tr_b16 v[170:171], v11 offset:14592
  v_mfma_f32_16x16x32_bf16 v[68:71], v[116:119], a[132:135], v[68:71]
  v_mfma_f32_16x16x32_bf16 v[84:87], v[116:119], a[140:143], v[84:87]
  v_mfma_f32_16x16x32_bf16 v[88:91], v[120:123], a[140:143], v[88:91]
  v_mfma_f32_16x16x32_bf16 v[72:75], v[120:123], a[132:135], v[72:75]
  v_mfma_f32_16x16x32_bf16 v[68:71], v[132:135], a[148:151], v[68:71]
  v_mfma_f32_16x16x32_bf16 v[84:87], v[132:135], a[156:159], v[84:87]
  v_mfma_f32_16x16x32_bf16 v[88:91], v[136:139], a[156:159], v[88:91]
  v_mfma_f32_16x16x32_bf16 v[72:75], v[136:139], a[148:151], v[72:75]
  s_waitcnt vmcnt(12) lgkmcnt(0)
  s_barrier
  v_mfma_f32_16x16x32_bf16 v[68:71], v[140:143], a[160:163], v[68:71]
  ds_read_b64_tr_b16 v[100:101], v10 offset:16384
  ds_read_b64_tr_b16 v[102:103], v11 offset:16384
  v_mfma_f32_16x16x32_bf16 v[84:87], v[140:143], a[168:171], v[84:87]
  ds_read_b64_tr_b16 v[104:105], v10 offset:18432
  ds_read_b64_tr_b16 v[106:107], v11 offset:18432
  v_mfma_f32_16x16x32_bf16 v[88:91], v[144:147], a[168:171], v[88:91]
  ds_read_b64_tr_b16 v[108:109], v10 offset:20480
  ds_read_b64_tr_b16 v[110:111], v11 offset:20480
  v_mfma_f32_16x16x32_bf16 v[72:75], v[144:147], a[160:163], v[72:75]
  ds_read_b64_tr_b16 v[112:113], v10 offset:22528
  ds_read_b64_tr_b16 v[114:115], v11 offset:22528
  v_mfma_f32_16x16x32_bf16 v[68:71], v[148:151], a[176:179], v[68:71]
  ds_read_b64_tr_b16 v[116:117], v10 offset:16640
  ds_read_b64_tr_b16 v[118:119], v11 offset:16640
  v_mfma_f32_16x16x32_bf16 v[84:87], v[148:151], a[184:187], v[84:87]
  ds_read_b64_tr_b16 v[120:121], v10 offset:18688
  ds_read_b64_tr_b16 v[122:123], v11 offset:18688
  v_mfma_f32_16x16x32_bf16 v[88:91], v[152:155], a[184:187], v[88:91]
  ds_read_b64_tr_b16 v[132:133], v10 offset:20736
  ds_read_b64_tr_b16 v[134:135], v11 offset:20736
  v_mfma_f32_16x16x32_bf16 v[72:75], v[152:155], a[176:179], v[72:75]
  ds_read_b64_tr_b16 v[136:137], v10 offset:22784
  ds_read_b64_tr_b16 v[138:139], v11 offset:22784
  v_mfma_f32_16x16x32_bf16 v[68:71], v[156:159], a[164:167], v[68:71]
  s_add_u32 m0, s6, 49152
  s_nop 0
  buffer_load_dwordx4 v65, s[12:15], s29 offen offset:0 sc1 lds
  v_mfma_f32_16x16x32_bf16 v[84:87], v[156:159], a[172:175], v[84:87]
  v_mfma_f32_16x16x32_bf16 v[88:91], v[160:163], a[172:175], v[88:91]
  buffer_load_dwordx4 v65, s[12:15], s29 offen offset:1024 sc1 lds
  v_mfma_f32_16x16x32_bf16 v[72:75], v[160:163], a[164:167], v[72:75]
  v_mfma_f32_16x16x32_bf16 v[68:71], v[164:167], a[180:183], v[68:71]
  buffer_load_dwordx4 v65, s[12:15], s29 offen offset:2048 sc1 lds
  v_mfma_f32_16x16x32_bf16 v[84:87], v[164:167], a[188:191], v[84:87]
  v_mfma_f32_16x16x32_bf16 v[88:91], v[168:171], a[188:191], v[88:91]
  buffer_load_dwordx4 v65, s[12:15], s29 offen offset:3072 sc1 lds
  s_add_u32 s29, s29, 65536
  s_and_b32 s29, s29, 0x3ffff
  v_mfma_f32_16x16x32_bf16 v[72:75], v[168:171], a[180:183], v[72:75]
  s_waitcnt lgkmcnt(0)
  v_mfma_f32_16x16x32_bf16 v[68:71], v[100:103], a[192:195], v[68:71]
  ds_read_b64_tr_b16 v[140:141], v10 offset:24576
  ds_read_b64_tr_b16 v[142:143], v11 offset:24576
  v_mfma_f32_16x16x32_bf16 v[84:87], v[100:103], a[200:203], v[84:87]
  ds_read_b64_tr_b16 v[144:145], v10 offset:26624
  ds_read_b64_tr_b16 v[146:147], v11 offset:26624
  v_mfma_f32_16x16x32_bf16 v[88:91], v[104:107], a[200:203], v[88:91]
  ds_read_b64_tr_b16 v[148:149], v10 offset:28672
  ds_read_b64_tr_b16 v[150:151], v11 offset:28672
  v_mfma_f32_16x16x32_bf16 v[72:75], v[104:107], a[192:195], v[72:75]
  ds_read_b64_tr_b16 v[152:153], v10 offset:30720
  ds_read_b64_tr_b16 v[154:155], v11 offset:30720
  v_mfma_f32_16x16x32_bf16 v[68:71], v[108:111], a[208:211], v[68:71]
  ds_read_b64_tr_b16 v[156:157], v10 offset:24832
  ds_read_b64_tr_b16 v[158:159], v11 offset:24832
  v_mfma_f32_16x16x32_bf16 v[84:87], v[108:111], a[216:219], v[84:87]
  ds_read_b64_tr_b16 v[160:161], v10 offset:26880
  ds_read_b64_tr_b16 v[162:163], v11 offset:26880
  v_mfma_f32_16x16x32_bf16 v[88:91], v[112:115], a[216:219], v[88:91]
  ds_read_b64_tr_b16 v[164:165], v10 offset:28928
  ds_read_b64_tr_b16 v[166:167], v11 offset:28928
  v_mfma_f32_16x16x32_bf16 v[72:75], v[112:115], a[208:211], v[72:75]
  ds_read_b64_tr_b16 v[168:169], v10 offset:30976
  ds_read_b64_tr_b16 v[170:171], v11 offset:30976
  v_mfma_f32_16x16x32_bf16 v[68:71], v[116:119], a[196:199], v[68:71]
  v_mfma_f32_16x16x32_bf16 v[84:87], v[116:119], a[204:207], v[84:87]
  v_mfma_f32_16x16x32_bf16 v[88:91], v[120:123], a[204:207], v[88:91]
  v_mfma_f32_16x16x32_bf16 v[72:75], v[120:123], a[196:199], v[72:75]
  v_mfma_f32_16x16x32_bf16 v[68:71], v[132:135], a[212:215], v[68:71]
  v_mfma_f32_16x16x32_bf16 v[84:87], v[132:135], a[220:223], v[84:87]
  v_mfma_f32_16x16x32_bf16 v[88:91], v[136:139], a[220:223], v[88:91]
  v_mfma_f32_16x16x32_bf16 v[72:75], v[136:139], a[212:215], v[72:75]
  buffer_load_dwordx4 v[228:231], v66, s[80:83], s8 offen offset:0 sc1
  buffer_load_dwordx4 v[232:235], v66, s[80:83], s8 offen offset:256 sc1
  buffer_load_dwordx4 v[236:239], v66, s[80:83], s8 offen offset:512 sc1
  buffer_load_dwordx4 v[240:243], v66, s[80:83], s8 offen offset:768 sc1
  s_waitcnt lgkmcnt(0)
  v_mfma_f32_16x16x32_bf16 v[68:71], v[140:143], a[224:227], v[68:71]
  ds_read_b64_tr_b16 v[100:101], v8 offset:0
  ds_read_b64_tr_b16 v[102:103], v9 offset:0
  v_mfma_f32_16x16x32_bf16 v[84:87], v[140:143], a[232:235], v[84:87]
  ds_read_b64_tr_b16 v[104:105], v8 offset:2048
  ds_read_b64_tr_b16 v[106:107], v9 offset:2048
  v_mfma_f32_16x16x32_bf16 v[88:91], v[144:147], a[232:235], v[88:91]
  ds_read_b64_tr_b16 v[108:109], v8 offset:4096
  ds_read_b64_tr_b16 v[110:111], v9 offset:4096
  v_mfma_f32_16x16x32_bf16 v[72:75], v[144:147], a[224:227], v[72:75]
  ds_read_b64_tr_b16 v[112:113], v8 offset:6144
  ds_read_b64_tr_b16 v[114:115], v9 offset:6144
  v_mfma_f32_16x16x32_bf16 v[68:71], v[148:151], a[240:243], v[68:71]
  ds_read_b64_tr_b16 v[116:117], v8 offset:256
  ds_read_b64_tr_b16 v[118:119], v9 offset:256
  v_mfma_f32_16x16x32_bf16 v[84:87], v[148:151], a[248:251], v[84:87]
  ds_read_b64_tr_b16 v[120:121], v8 offset:2304
  ds_read_b64_tr_b16 v[122:123], v9 offset:2304
  v_mfma_f32_16x16x32_bf16 v[88:91], v[152:155], a[248:251], v[88:91]
  ds_read_b64_tr_b16 v[132:133], v8 offset:4352
  ds_read_b64_tr_b16 v[134:135], v9 offset:4352
  v_mfma_f32_16x16x32_bf16 v[72:75], v[152:155], a[240:243], v[72:75]
  ds_read_b64_tr_b16 v[136:137], v8 offset:6400
  ds_read_b64_tr_b16 v[138:139], v9 offset:6400
  v_mfma_f32_16x16x32_bf16 v[68:71], v[156:159], a[228:231], v[68:71]
  v_mfma_f32_16x16x32_bf16 v[84:87], v[156:159], a[236:239], v[84:87]
  buffer_load_dwordx4 v[20:23], v64, s[44:47], s9 offen offset:0 sc1
  v_mfma_f32_16x16x32_bf16 v[88:91], v[160:163], a[236:239], v[88:91]
  v_mfma_f32_16x16x32_bf16 v[72:75], v[160:163], a[228:231], v[72:75]
  buffer_load_dwordx4 v[40:43], v64, s[44:47], s9 offen offset:1024 sc1
  v_mfma_f32_16x16x32_bf16 v[68:71], v[164:167], a[244:247], v[68:71]
  v_mfma_f32_16x16x32_bf16 v[84:87], v[164:167], a[252:255], v[84:87]
  buffer_load_dwordx4 v[12:15], v64, s[44:47], s9 offen offset:2048 sc1
  v_mfma_f32_16x16x32_bf16 v[88:91], v[168:171], a[252:255], v[88:91]
  v_mfma_f32_16x16x32_bf16 v[72:75], v[168:171], a[244:247], v[72:75]
  buffer_load_dwordx4 v[16:19], v64, s[44:47], s9 offen offset:3072 sc1
  s_waitcnt lgkmcnt(0)
  v_mfma_f32_16x16x32_bf16 v[76:79], v[100:103], a[0:3], v[76:79]
  ds_read_b64_tr_b16 v[140:141], v8 offset:8192
  ds_read_b64_tr_b16 v[142:143], v9 offset:8192
  v_mfma_f32_16x16x32_bf16 v[92:95], v[100:103], a[8:11], 0
  ds_read_b64_tr_b16 v[144:145], v8 offset:10240
  ds_read_b64_tr_b16 v[146:147], v9 offset:10240
  v_mfma_f32_16x16x32_bf16 v[96:99], v[104:107], a[8:11], 0
  ds_read_b64_tr_b16 v[148:149], v8 offset:12288
  ds_read_b64_tr_b16 v[150:151], v9 offset:12288
  v_mfma_f32_16x16x32_bf16 v[80:83], v[104:107], a[0:3], v[80:83]
  ds_read_b64_tr_b16 v[152:153], v8 offset:14336
  ds_read_b64_tr_b16 v[154:155], v9 offset:14336
  v_mfma_f32_16x16x32_bf16 v[76:79], v[108:111], a[16:19], v[76:79]
  ds_read_b64_tr_b16 v[156:157], v8 offset:8448
  ds_read_b64_tr_b16 v[158:159], v9 offset:8448
  v_mfma_f32_16x16x32_bf16 v[92:95], v[108:111], a[24:27], v[92:95]
  ds_read_b64_tr_b16 v[160:161], v8 offset:10496
  ds_read_b64_tr_b16 v[162:163], v9 offset:10496
  v_mfma_f32_16x16x32_bf16 v[96:99], v[112:115], a[24:27], v[96:99]
  ds_read_b64_tr_b16 v[164:165], v8 offset:12544
  ds_read_b64_tr_b16 v[166:167], v9 offset:12544
  v_mfma_f32_16x16x32_bf16 v[80:83], v[112:115], a[16:19], v[80:83]
  ds_read_b64_tr_b16 v[168:169], v8 offset:14592
  ds_read_b64_tr_b16 v[170:171], v9 offset:14592
  v_mfma_f32_16x16x32_bf16 v[76:79], v[116:119], a[4:7], v[76:79]
  v_mfma_f32_16x16x32_bf16 v[196:199], v[24:27], v[124:127], 0
  v_mfma_f32_16x16x32_bf16 v[212:215], v[24:27], v[188:191], 0
  v_mfma_f32_16x16x32_bf16 v[92:95], v[116:119], a[12:15], v[92:95]
  v_mfma_f32_16x16x32_bf16 v[200:203], v[32:35], v[124:127], 0
  v_mfma_f32_16x16x32_bf16 v[216:219], v[32:35], v[188:191], 0
  v_mfma_f32_16x16x32_bf16 v[96:99], v[120:123], a[12:15], v[96:99]
  v_mfma_f32_16x16x32_bf16 v[204:207], v[172:175], v[124:127], 0
  v_mfma_f32_16x16x32_bf16 v[220:223], v[172:175], v[188:191], 0
  v_mfma_f32_16x16x32_bf16 v[80:83], v[120:123], a[4:7], v[80:83]
  v_mfma_f32_16x16x32_bf16 v[208:211], v[180:183], v[124:127], 0
  v_mfma_f32_16x16x32_bf16 v[224:227], v[180:183], v[188:191], 0
  v_mfma_f32_16x16x32_bf16 v[76:79], v[132:135], a[20:23], v[76:79]
  v_mfma_f32_16x16x32_bf16 v[196:199], v[28:31], v[128:131], v[196:199]
  v_mfma_f32_16x16x32_bf16 v[212:215], v[28:31], v[192:195], v[212:215]
  v_mfma_f32_16x16x32_bf16 v[92:95], v[132:135], a[28:31], v[92:95]
  v_mfma_f32_16x16x32_bf16 v[200:203], v[60:63], v[128:131], v[200:203]
  v_mfma_f32_16x16x32_bf16 v[216:219], v[60:63], v[192:195], v[216:219]
  v_mfma_f32_16x16x32_bf16 v[96:99], v[136:139], a[28:31], v[96:99]
  v_mfma_f32_16x16x32_bf16 v[204:207], v[176:179], v[128:131], v[204:207]
  v_mfma_f32_16x16x32_bf16 v[220:223], v[176:179], v[192:195], v[220:223]
  v_mfma_f32_16x16x32_bf16 v[80:83], v[136:139], a[20:23], v[80:83]
  v_mfma_f32_16x16x32_bf16 v[208:211], v[184:187], v[128:131], v[208:211]
  v_mfma_f32_16x16x32_bf16 v[224:227], v[184:187], v[192:195], v[224:227]
  s_waitcnt vmcnt(8) lgkmcnt(0)
  s_barrier
  v_mfma_f32_16x16x32_bf16 v[76:79], v[140:143], a[32:35], v[76:79]
  ds_read_b64_tr_b16 v[100:101], v8 offset:16384
  ds_read_b64_tr_b16 v[102:103], v9 offset:16384
  v_mfma_f32_16x16x32_bf16 v[92:95], v[140:143], a[40:43], v[92:95]
  ds_read_b64_tr_b16 v[104:105], v8 offset:18432
  ds_read_b64_tr_b16 v[106:107], v9 offset:18432
  v_mfma_f32_16x16x32_bf16 v[96:99], v[144:147], a[40:43], v[96:99]
  ds_read_b64_tr_b16 v[108:109], v8 offset:20480
  ds_read_b64_tr_b16 v[110:111], v9 offset:20480
  v_mfma_f32_16x16x32_bf16 v[80:83], v[144:147], a[32:35], v[80:83]
  ds_read_b64_tr_b16 v[112:113], v8 offset:22528
  ds_read_b64_tr_b16 v[114:115], v9 offset:22528
  v_mfma_f32_16x16x32_bf16 v[76:79], v[148:151], a[48:51], v[76:79]
  ds_read_b64_tr_b16 v[116:117], v8 offset:16640
  ds_read_b64_tr_b16 v[118:119], v9 offset:16640
  v_mfma_f32_16x16x32_bf16 v[92:95], v[148:151], a[56:59], v[92:95]
  ds_read_b64_tr_b16 v[120:121], v8 offset:18688
  ds_read_b64_tr_b16 v[122:123], v9 offset:18688
  v_mfma_f32_16x16x32_bf16 v[96:99], v[152:155], a[56:59], v[96:99]
  ds_read_b64_tr_b16 v[132:133], v8 offset:20736
  ds_read_b64_tr_b16 v[134:135], v9 offset:20736
  v_mfma_f32_16x16x32_bf16 v[80:83], v[152:155], a[48:51], v[80:83]
  ds_read_b64_tr_b16 v[136:137], v8 offset:22784
  ds_read_b64_tr_b16 v[138:139], v9 offset:22784
  v_mfma_f32_16x16x32_bf16 v[76:79], v[156:159], a[36:39], v[76:79]
  s_waitcnt vmcnt(0)
  v_and_b32 v44, 1, v12
  v_bitop3_b32 v44, v44, v13, v14 bitop3:0x80
  v_bitop3_b32 v44, v44, v15, v16 bitop3:0x80
  v_bitop3_b32 v44, v44, v17, v18 bitop3:0x80
  v_bitop3_b32 v44, v44, v19, v20 bitop3:0x80
  v_bitop3_b32 v44, v44, v21, v22 bitop3:0x80
  v_bitop3_b32 v44, v44, v23, v40 bitop3:0x80
  v_bitop3_b32 v44, v44, v41, v42 bitop3:0x80
  v_and_b32 v44, v44, v43
  v_cmp_eq_u32 vcc, 0, v44
  s_nop 0
  s_cbranch_vccz gated_mix__spectral_gfnet__ssm_conv_s5__prompt_kernel_skip51
  s_mov_b32 s28, 0
gated_mix__spectral_gfnet__ssm_conv_s5__prompt_kernel_px52:
  s_sleep 2
  buffer_load_dwordx4 v[20:23], v64, s[44:47], s9 offen offset:0 sc1
  buffer_load_dwordx4 v[40:43], v64, s[44:47], s9 offen offset:1024 sc1
  buffer_load_dwordx4 v[12:15], v64, s[44:47], s9 offen offset:2048 sc1
  buffer_load_dwordx4 v[16:19], v64, s[44:47], s9 offen offset:3072 sc1
  s_waitcnt vmcnt(0)
  v_and_b32 v44, 1, v12
  v_bitop3_b32 v44, v44, v13, v14 bitop3:0x80
  v_bitop3_b32 v44, v44, v15, v16 bitop3:0x80
  v_bitop3_b32 v44, v44, v17, v18 bitop3:0x80
  v_bitop3_b32 v44, v44, v19, v20 bitop3:0x80
  v_bitop3_b32 v44, v44, v21, v22 bitop3:0x80
  v_bitop3_b32 v44, v44, v23, v40 bitop3:0x80
  v_bitop3_b32 v44, v44, v41, v42 bitop3:0x80
  v_and_b32 v44, v44, v43
  v_cmp_eq_u32 vcc, 0, v44
  s_nop 0
  s_cbranch_vccz gated_mix__spectral_gfnet__ssm_conv_s5__prompt_kernel_pxout53
  s_add_u32 s28, s28, 1
  s_cmp_lt_u32 s28, 1048576
  s_cbranch_scc1 gated_mix__spectral_gfnet__ssm_conv_s5__prompt_kernel_px52
gated_mix__spectral_gfnet__ssm_conv_s5__prompt_kernel_pxout53:
gated_mix__spectral_gfnet__ssm_conv_s5__prompt_kernel_skip51:
  v_mfma_f32_16x16x32_bf16 v[92:95], v[156:159], a[44:47], v[92:95]
  v_mfma_f32_16x16x32_bf16 v[96:99], v[160:163], a[44:47], v[96:99]
  v_mfma_f32_16x16x32_bf16 v[80:83], v[160:163], a[36:39], v[80:83]
  v_mfma_f32_16x16x32_bf16 v[76:79], v[164:167], a[52:55], v[76:79]
  v_mfma_f32_16x16x32_bf16 v[92:95], v[164:167], a[60:63], v[92:95]
  v_mfma_f32_16x16x32_bf16 v[96:99], v[168:171], a[60:63], v[96:99]
  v_mfma_f32_16x16x32_bf16 v[80:83], v[168:171], a[52:55], v[80:83]
  s_waitcnt lgkmcnt(0)
  v_mfma_f32_16x16x32_bf16 v[76:79], v[100:103], a[64:67], v[76:79]
  ds_read_b64_tr_b16 v[140:141], v8 offset:24576
  ds_read_b64_tr_b16 v[142:143], v9 offset:24576
  v_mfma_f32_16x16x32_bf16 v[92:95], v[100:103], a[72:75], v[92:95]
  ds_read_b64_tr_b16 v[144:145], v8 offset:26624
  ds_read_b64_tr_b16 v[146:147], v9 offset:26624
  v_mfma_f32_16x16x32_bf16 v[96:99], v[104:107], a[72:75], v[96:99]
  ds_read_b64_tr_b16 v[148:149], v8 offset:28672
  ds_read_b64_tr_b16 v[150:151], v9 offset:28672
  v_mfma_f32_16x16x32_bf16 v[80:83], v[104:107], a[64:67], v[80:83]
  ds_read_b64_tr_b16 v[152:153], v8 offset:30720
  ds_read_b64_tr_b16 v[154:155], v9 offset:30720
  v_mfma_f32_16x16x32_bf16 v[76:79], v[108:111], a[80:83], v[76:79]
  ds_read_b64_tr_b16 v[156:157], v8 offset:24832
  ds_read_b64_tr_b16 v[158:159], v9 offset:24832
  v_mfma_f32_16x16x32_bf16 v[92:95], v[108:111], a[88:91], v[92:95]
  ds_read_b64_tr_b16 v[160:161], v8 offset:26880
  ds_read_b64_tr_b16 v[162:163], v9 offset:26880
  v_mfma_f32_16x16x32_bf16 v[96:99], v[112:115], a[88:91], v[96:99]
  ds_read_b64_tr_b16 v[164:165], v8 offset:28928
  ds_read_b64_tr_b16 v[166:167], v9 offset:28928
  v_mfma_f32_16x16x32_bf16 v[80:83], v[112:115], a[80:83], v[80:83]
  ds_read_b64_tr_b16 v[168:169], v8 offset:30976
  ds_read_b64_tr_b16 v[170:171], v9 offset:30976
  v_mfma_f32_16x16x32_bf16 v[76:79], v[116:119], a[68:71], v[76:79]
  v_pk_add_f32 v[196:197], v[196:197], v[68:69] neg_lo:[0,1] neg_hi:[0,1]
  v_pk_add_f32 v[198:199], v[198:199], v[70:71] neg_lo:[0,1] neg_hi:[0,1]
  v_pk_fma_f32 v[68:69], v[228:229], v[196:197], v[68:69]
  v_pk_fma_f32 v[70:71], v[230:231], v[198:199], v[70:71]
  v_lshlrev_b32 v44, 16, v12
  v_and_b32 v45, 0xffff0000, v12
  v_pk_add_f32 v[68:69], v[68:69], v[44:45]
  v_lshlrev_b32 v46, 16, v13
  v_and_b32 v47, 0xffff0000, v13
  v_pk_add_f32 v[70:71], v[70:71], v[46:47]
  v_pk_add_f32 v[212:213], v[212:213], v[84:85] neg_lo:[0,1] neg_hi:[0,1]
  v_pk_add_f32 v[214:215], v[214:215], v[86:87] neg_lo:[0,1] neg_hi:[0,1]
  v_pk_fma_f32 v[84:85], v[228:229], v[212:213], v[84:85]
  v_pk_fma_f32 v[86:87], v[230:231], v[214:215], v[86:87]
  v_lshlrev_b32 v48, 16, v20
  v_and_b32 v49, 0xffff0000, v20
  v_pk_add_f32 v[84:85], v[84:85], v[48:49]
  v_lshlrev_b32 v50, 16, v21
  v_and_b32 v51, 0xffff0000, v21
  v_pk_add_f32 v[86:87], v[86:87], v[50:51]
  v_mfma_f32_16x16x32_bf16 v[92:95], v[116:119], a[76:79], v[92:95]
  v_mfma_f32_16x16x32_bf16 v[96:99], v[120:123], a[76:79], v[96:99]
  v_mfma_f32_16x16x32_bf16 v[80:83], v[120:123], a[68:71], v[80:83]
  v_mfma_f32_16x16x32_bf16 v[76:79], v[132:135], a[84:87], v[76:79]
  buffer_store_dword v68, v36, s[24:27], s7 offen sc1
  v_mfma_f32_16x16x32_bf16 v[92:95], v[132:135], a[92:95], v[92:95]
  v_mfma_f32_16x16x32_bf16 v[96:99], v[136:139], a[92:95], v[96:99]
  v_mfma_f32_16x16x32_bf16 v[80:83], v[136:139], a[84:87], v[80:83]
  s_waitcnt lgkmcnt(0)
  v_mfma_f32_16x16x32_bf16 v[76:79], v[140:143], a[96:99], v[76:79]
  ds_read_b64_tr_b16 v[100:101], v8 offset:32768
  ds_read_b64_tr_b16 v[102:103], v9 offset:32768
  buffer_store_dword v84, v37, s[24:27], s7 offen sc1
  v_mfma_f32_16x16x32_bf16 v[92:95], v[140:143], a[104:107], v[92:95]
  ds_read_b64_tr_b16 v[104:105], v8 offset:34816
  ds_read_b64_tr_b16 v[106:107], v9 offset:34816
  s_add_u32 s7, s7, 65536
  v_mfma_f32_16x16x32_bf16 v[96:99], v[144:147], a[104:107], v[96:99]
  ds_read_b64_tr_b16 v[108:109], v8 offset:36864
  ds_read_b64_tr_b16 v[110:111], v9 offset:36864
  v_mfma_f32_16x16x32_bf16 v[80:83], v[144:147], a[96:99], v[80:83]
  ds_read_b64_tr_b16 v[112:113], v8 offset:38912
  ds_read_b64_tr_b16 v[114:115], v9 offset:38912
  v_mfma_f32_16x16x32_bf16 v[76:79], v[148:151], a[112:115], v[76:79]
  ds_read_b64_tr_b16 v[116:117], v8 offset:33024
  ds_read_b64_tr_b16 v[118:119], v9 offset:33024
  buffer_store_dword v69, v36, s[24:27], s7 offen sc1
  v_mfma_f32_16x16x32_bf16 v[92:95], v[148:151], a[120:123], v[92:95]
  ds_read_b64_tr_b16 v[120:121], v8 offset:35072
  ds_read_b64_tr_b16 v[122:123], v9 offset:35072
  v_mfma_f32_16x16x32_bf16 v[96:99], v[152:155], a[120:123], v[96:99]
  ds_read_b64_tr_b16 v[132:133], v8 offset:37120
  ds_read_b64_tr_b16 v[134:135], v9 offset:37120
  v_mfma_f32_16x16x32_bf16 v[80:83], v[152:155], a[112:115], v[80:83]
  ds_read_b64_tr_b16 v[136:137], v8 offset:39168
  ds_read_b64_tr_b16 v[138:139], v9 offset:39168
  v_mfma_f32_16x16x32_bf16 v[76:79], v[156:159], a[100:103], v[76:79]
  buffer_store_dword v85, v37, s[24:27], s7 offen sc1
  v_mfma_f32_16x16x32_bf16 v[92:95], v[156:159], a[108:111], v[92:95]
  s_add_u32 s7, s7, 65536
  v_mfma_f32_16x16x32_bf16 v[96:99], v[160:163], a[108:111], v[96:99]
  v_mfma_f32_16x16x32_bf16 v[80:83], v[160:163], a[100:103], v[80:83]
  v_mfma_f32_16x16x32_bf16 v[76:79], v[164:167], a[116:119], v[76:79]
  buffer_store_dword v70, v36, s[24:27], s7 offen sc1
  v_mfma_f32_16x16x32_bf16 v[92:95], v[164:167], a[124:127], v[92:95]
  v_mfma_f32_16x16x32_bf16 v[96:99], v[168:171], a[124:127], v[96:99]
  v_mfma_f32_16x16x32_bf16 v[80:83], v[168:171], a[116:119], v[80:83]
  s_waitcnt lgkmcnt(0)
  v_mfma_f32_16x16x32_bf16 v[76:79], v[100:103], a[128:131], v[76:79]
  ds_read_b64_tr_b16 v[140:141], v8 offset:40960
  ds_read_b64_tr_b16 v[142:143], v9 offset:40960
  buffer_store_dword v86, v37, s[24:27], s7 offen sc1
  v_mfma_f32_16x16x32_bf16 v[92:95], v[100:103], a[136:139], v[92:95]
  ds_read_b64_tr_b16 v[144:145], v8 offset:43008
  ds_read_b64_tr_b16 v[146:147], v9 offset:43008
  s_add_u32 s7, s7, 65536
  v_mfma_f32_16x16x32_bf16 v[96:99], v[104:107], a[136:139], v[96:99]
  ds_read_b64_tr_b16 v[148:149], v8 offset:45056
  ds_read_b64_tr_b16 v[150:151], v9 offset:45056
  v_mfma_f32_16x16x32_bf16 v[80:83], v[104:107], a[128:131], v[80:83]
  ds_read_b64_tr_b16 v[152:153], v8 offset:47104
  ds_read_b64_tr_b16 v[154:155], v9 offset:47104
  v_mfma_f32_16x16x32_bf16 v[76:79], v[108:111], a[144:147], v[76:79]
  ds_read_b64_tr_b16 v[156:157], v8 offset:41216
  ds_read_b64_tr_b16 v[158:159], v9 offset:41216
  buffer_store_dword v71, v36, s[24:27], s7 offen sc1
  v_mfma_f32_16x16x32_bf16 v[92:95], v[108:111], a[152:155], v[92:95]
  ds_read_b64_tr_b16 v[160:161], v8 offset:43264
  ds_read_b64_tr_b16 v[162:163], v9 offset:43264
  v_mfma_f32_16x16x32_bf16 v[96:99], v[112:115], a[152:155], v[96:99]
  ds_read_b64_tr_b16 v[164:165], v8 offset:45312
  ds_read_b64_tr_b16 v[166:167], v9 offset:45312
  v_mfma_f32_16x16x32_bf16 v[80:83], v[112:115], a[144:147], v[80:83]
  ds_read_b64_tr_b16 v[168:169], v8 offset:47360
  ds_read_b64_tr_b16 v[170:171], v9 offset:47360
  v_mfma_f32_16x16x32_bf16 v[76:79], v[116:119], a[132:135], v[76:79]
  buffer_store_dword v87, v37, s[24:27], s7 offen sc1
  v_mfma_f32_16x16x32_bf16 v[92:95], v[116:119], a[140:143], v[92:95]
  s_add_u32 s7, s7, 851968
  v_pk_add_f32 v[200:201], v[200:201], v[72:73] neg_lo:[0,1] neg_hi:[0,1]
  v_pk_add_f32 v[202:203], v[202:203], v[74:75] neg_lo:[0,1] neg_hi:[0,1]
  v_pk_fma_f32 v[72:73], v[232:233], v[200:201], v[72:73]
  v_pk_fma_f32 v[74:75], v[234:235], v[202:203], v[74:75]
  v_lshlrev_b32 v52, 16, v14
  v_and_b32 v53, 0xffff0000, v14
  v_pk_add_f32 v[72:73], v[72:73], v[52:53]
  v_lshlrev_b32 v54, 16, v15
  v_and_b32 v55, 0xffff0000, v15
  v_pk_add_f32 v[74:75], v[74:75], v[54:55]
  v_pk_add_f32 v[216:217], v[216:217], v[88:89] neg_lo:[0,1] neg_hi:[0,1]
  v_pk_add_f32 v[218:219], v[218:219], v[90:91] neg_lo:[0,1] neg_hi:[0,1]
  v_pk_fma_f32 v[88:89], v[232:233], v[216:217], v[88:89]
  v_pk_fma_f32 v[90:91], v[234:235], v[218:219], v[90:91]
  v_lshlrev_b32 v56, 16, v22
  v_and_b32 v57, 0xffff0000, v22
  v_pk_add_f32 v[88:89], v[88:89], v[56:57]
  v_lshlrev_b32 v58, 16, v23
  v_and_b32 v59, 0xffff0000, v23
  v_pk_add_f32 v[90:91], v[90:91], v[58:59]
  v_mfma_f32_16x16x32_bf16 v[96:99], v[120:123], a[140:143], v[96:99]
  v_mfma_f32_16x16x32_bf16 v[80:83], v[120:123], a[132:135], v[80:83]
  v_mfma_f32_16x16x32_bf16 v[76:79], v[132:135], a[148:151], v[76:79]
  buffer_store_dword v72, v36, s[24:27], s7 offen sc1
  v_mfma_f32_16x16x32_bf16 v[92:95], v[132:135], a[156:159], v[92:95]
  v_mfma_f32_16x16x32_bf16 v[96:99], v[136:139], a[156:159], v[96:99]
  v_mfma_f32_16x16x32_bf16 v[80:83], v[136:139], a[148:151], v[80:83]
  s_waitcnt lgkmcnt(0)
  v_mfma_f32_16x16x32_bf16 v[76:79], v[140:143], a[160:163], v[76:79]
  ds_read_b64_tr_b16 v[100:101], v8 offset:49152
  ds_read_b64_tr_b16 v[102:103], v9 offset:49152
  buffer_store_dword v88, v37, s[24:27], s7 offen sc1
  v_mfma_f32_16x16x32_bf16 v[92:95], v[140:143], a[168:171], v[92:95]
  ds_read_b64_tr_b16 v[104:105], v8 offset:51200
  ds_read_b64_tr_b16 v[106:107], v9 offset:51200
  s_add_u32 s7, s7, 65536
  v_mfma_f32_16x16x32_bf16 v[96:99], v[144:147], a[168:171], v[96:99]
  ds_read_b64_tr_b16 v[108:109], v8 offset:53248
  ds_read_b64_tr_b16 v[110:111], v9 offset:53248
  v_mfma_f32_16x16x32_bf16 v[80:83], v[144:147], a[160:163], v[80:83]
  ds_read_b64_tr_b16 v[112:113], v8 offset:55296
  ds_read_b64_tr_b16 v[114:115], v9 offset:55296
  v_mfma_f32_16x16x32_bf16 v[76:79], v[148:151], a[176:179], v[76:79]
  ds_read_b64_tr_b16 v[116:117], v8 offset:49408
  ds_read_b64_tr_b16 v[118:119], v9 offset:49408
  buffer_store_dword v73, v36, s[24:27], s7 offen sc1
  v_mfma_f32_16x16x32_bf16 v[92:95], v[148:151], a[184:187], v[92:95]
  ds_read_b64_tr_b16 v[120:121], v8 offset:51456
  ds_read_b64_tr_b16 v[122:123], v9 offset:51456
  v_mfma_f32_16x16x32_bf16 v[96:99], v[152:155], a[184:187], v[96:99]
  ds_read_b64_tr_b16 v[132:133], v8 offset:53504
  ds_read_b64_tr_b16 v[134:135], v9 offset:53504
  v_mfma_f32_16x16x32_bf16 v[80:83], v[152:155], a[176:179], v[80:83]
  ds_read_b64_tr_b16 v[136:137], v8 offset:55552
  ds_read_b64_tr_b16 v[138:139], v9 offset:55552
  v_mfma_f32_16x16x32_bf16 v[76:79], v[156:159], a[164:167], v[76:79]
  buffer_store_dword v89, v37, s[24:27], s7 offen sc1
  v_mfma_f32_16x16x32_bf16 v[92:95], v[156:159], a[172:175], v[92:95]
  s_add_u32 s7, s7, 65536
  v_mfma_f32_16x16x32_bf16 v[96:99], v[160:163], a[172:175], v[96:99]
  v_mfma_f32_16x16x32_bf16 v[80:83], v[160:163], a[164:167], v[80:83]
  v_mfma_f32_16x16x32_bf16 v[76:79], v[164:167], a[180:183], v[76:79]
  buffer_store_dword v74, v36, s[24:27], s7 offen sc1
  v_mfma_f32_16x16x32_bf16 v[92:95], v[164:167], a[188:191], v[92:95]
  v_mfma_f32_16x16x32_bf16 v[96:99], v[168:171], a[188:191], v[96:99]
  v_mfma_f32_16x16x32_bf16 v[80:83], v[168:171], a[180:183], v[80:83]
  s_waitcnt lgkmcnt(0)
  v_mfma_f32_16x16x32_bf16 v[76:79], v[100:103], a[192:195], v[76:79]
  ds_read_b64_tr_b16 v[140:141], v8 offset:57344
  ds_read_b64_tr_b16 v[142:143], v9 offset:57344
  buffer_store_dword v90, v37, s[24:27], s7 offen sc1
  v_mfma_f32_16x16x32_bf16 v[92:95], v[100:103], a[200:203], v[92:95]
  ds_read_b64_tr_b16 v[144:145], v8 offset:59392
  ds_read_b64_tr_b16 v[146:147], v9 offset:59392
  s_add_u32 s7, s7, 65536
  v_mfma_f32_16x16x32_bf16 v[96:99], v[104:107], a[200:203], v[96:99]
  ds_read_b64_tr_b16 v[148:149], v8 offset:61440
  ds_read_b64_tr_b16 v[150:151], v9 offset:61440
  v_mfma_f32_16x16x32_bf16 v[80:83], v[104:107], a[192:195], v[80:83]
  ds_read_b64_tr_b16 v[152:153], v8 offset:63488
  ds_read_b64_tr_b16 v[154:155], v9 offset:63488
  v_mfma_f32_16x16x32_bf16 v[76:79], v[108:111], a[208:211], v[76:79]
  ds_read_b64_tr_b16 v[156:157], v8 offset:57600
  ds_read_b64_tr_b16 v[158:159], v9 offset:57600
  buffer_store_dword v75, v36, s[24:27], s7 offen sc1
  v_mfma_f32_16x16x32_bf16 v[92:95], v[108:111], a[216:219], v[92:95]
  ds_read_b64_tr_b16 v[160:161], v8 offset:59648
  ds_read_b64_tr_b16 v[162:163], v9 offset:59648
  v_mfma_f32_16x16x32_bf16 v[96:99], v[112:115], a[216:219], v[96:99]
  ds_read_b64_tr_b16 v[164:165], v8 offset:61696
  ds_read_b64_tr_b16 v[166:167], v9 offset:61696
  v_mfma_f32_16x16x32_bf16 v[80:83], v[112:115], a[208:211], v[80:83]
  ds_read_b64_tr_b16 v[168:169], v8 offset:63744
  ds_read_b64_tr_b16 v[170:171], v9 offset:63744
  v_mfma_f32_16x16x32_bf16 v[76:79], v[116:119], a[196:199], v[76:79]
  buffer_store_dword v91, v37, s[24:27], s7 offen sc1
  v_mfma_f32_16x16x32_bf16 v[92:95], v[116:119], a[204:207], v[92:95]
  s_add_u32 s7, s7, 851968
  v_mfma_f32_16x16x32_bf16 v[96:99], v[120:123], a[204:207], v[96:99]
  v_mfma_f32_16x16x32_bf16 v[80:83], v[120:123], a[196:199], v[80:83]
  v_mfma_f32_16x16x32_bf16 v[76:79], v[132:135], a[212:215], v[76:79]
  v_mfma_f32_16x16x32_bf16 v[92:95], v[132:135], a[220:223], v[92:95]
  v_mfma_f32_16x16x32_bf16 v[96:99], v[136:139], a[220:223], v[96:99]
  v_mfma_f32_16x16x32_bf16 v[80:83], v[136:139], a[212:215], v[80:83]
  s_waitcnt lgkmcnt(0)
  v_mfma_f32_16x16x32_bf16 v[76:79], v[140:143], a[224:227], v[76:79]
  v_mfma_f32_16x16x32_bf16 v[92:95], v[140:143], a[232:235], v[92:95]
  v_mfma_f32_16x16x32_bf16 v[96:99], v[144:147], a[232:235], v[96:99]
  v_mfma_f32_16x16x32_bf16 v[80:83], v[144:147], a[224:227], v[80:83]
  v_mfma_f32_16x16x32_bf16 v[76:79], v[148:151], a[240:243], v[76:79]
  v_mfma_f32_16x16x32_bf16 v[92:95], v[148:151], a[248:251], v[92:95]
  v_mfma_f32_16x16x32_bf16 v[96:99], v[152:155], a[248:251], v[96:99]
  v_mfma_f32_16x16x32_bf16 v[80:83], v[152:155], a[240:243], v[80:83]
  v_mfma_f32_16x16x32_bf16 v[76:79], v[156:159], a[228:231], v[76:79]
  v_mfma_f32_16x16x32_bf16 v[92:95], v[156:159], a[236:239], v[92:95]
  v_mfma_f32_16x16x32_bf16 v[96:99], v[160:163], a[236:239], v[96:99]
  v_mfma_f32_16x16x32_bf16 v[80:83], v[160:163], a[228:231], v[80:83]
  v_mfma_f32_16x16x32_bf16 v[76:79], v[164:167], a[244:247], v[76:79]
  v_mfma_f32_16x16x32_bf16 v[92:95], v[164:167], a[252:255], v[92:95]
  v_mfma_f32_16x16x32_bf16 v[96:99], v[168:171], a[252:255], v[96:99]
  v_mfma_f32_16x16x32_bf16 v[80:83], v[168:171], a[244:247], v[80:83]
  s_nop 4
  v_pk_add_f32 v[204:205], v[204:205], v[76:77] neg_lo:[0,1] neg_hi:[0,1]
  v_pk_add_f32 v[206:207], v[206:207], v[78:79] neg_lo:[0,1] neg_hi:[0,1]
  v_pk_fma_f32 v[76:77], v[236:237], v[204:205], v[76:77]
  v_pk_fma_f32 v[78:79], v[238:239], v[206:207], v[78:79]
  v_lshlrev_b32 v44, 16, v16
  v_and_b32 v45, 0xffff0000, v16
  v_pk_add_f32 v[76:77], v[76:77], v[44:45]
  v_lshlrev_b32 v46, 16, v17
  v_and_b32 v47, 0xffff0000, v17
  v_pk_add_f32 v[78:79], v[78:79], v[46:47]
  v_pk_add_f32 v[220:221], v[220:221], v[92:93] neg_lo:[0,1] neg_hi:[0,1]
  v_pk_add_f32 v[222:223], v[222:223], v[94:95] neg_lo:[0,1] neg_hi:[0,1]
  v_pk_fma_f32 v[92:93], v[236:237], v[220:221], v[92:93]
  v_pk_fma_f32 v[94:95], v[238:239], v[222:223], v[94:95]
  v_lshlrev_b32 v48, 16, v40
  v_and_b32 v49, 0xffff0000, v40
  v_pk_add_f32 v[92:93], v[92:93], v[48:49]
  v_lshlrev_b32 v50, 16, v41
  v_and_b32 v51, 0xffff0000, v41
  v_pk_add_f32 v[94:95], v[94:95], v[50:51]
  buffer_store_dword v76, v36, s[24:27], s7 offen sc1
  buffer_store_dword v92, v37, s[24:27], s7 offen sc1
  s_add_u32 s7, s7, 65536
  buffer_store_dword v77, v36, s[24:27], s7 offen sc1
  buffer_store_dword v93, v37, s[24:27], s7 offen sc1
  s_add_u32 s7, s7, 65536
  buffer_store_dword v78, v36, s[24:27], s7 offen sc1
  buffer_store_dword v94, v37, s[24:27], s7 offen sc1
  s_add_u32 s7, s7, 65536
  buffer_store_dword v79, v36, s[24:27], s7 offen sc1
  buffer_store_dword v95, v37, s[24:27], s7 offen sc1
  s_add_u32 s7, s7, 851968
  v_pk_add_f32 v[208:209], v[208:209], v[80:81] neg_lo:[0,1] neg_hi:[0,1]
  v_pk_add_f32 v[210:211], v[210:211], v[82:83] neg_lo:[0,1] neg_hi:[0,1]
  v_pk_fma_f32 v[80:81], v[240:241], v[208:209], v[80:81]
  v_pk_fma_f32 v[82:83], v[242:243], v[210:211], v[82:83]
  v_lshlrev_b32 v52, 16, v18
  v_and_b32 v53, 0xffff0000, v18
  v_pk_add_f32 v[80:81], v[80:81], v[52:53]
  v_lshlrev_b32 v54, 16, v19
  v_and_b32 v55, 0xffff0000, v19
  v_pk_add_f32 v[82:83], v[82:83], v[54:55]
  v_pk_add_f32 v[224:225], v[224:225], v[96:97] neg_lo:[0,1] neg_hi:[0,1]
  v_pk_add_f32 v[226:227], v[226:227], v[98:99] neg_lo:[0,1] neg_hi:[0,1]
  v_pk_fma_f32 v[96:97], v[240:241], v[224:225], v[96:97]
  v_pk_fma_f32 v[98:99], v[242:243], v[226:227], v[98:99]
  v_lshlrev_b32 v56, 16, v42
  v_and_b32 v57, 0xffff0000, v42
  v_pk_add_f32 v[96:97], v[96:97], v[56:57]
  v_lshlrev_b32 v58, 16, v43
  v_and_b32 v59, 0xffff0000, v43
  v_pk_add_f32 v[98:99], v[98:99], v[58:59]
  buffer_store_dword v80, v36, s[24:27], s7 offen sc1
  buffer_store_dword v96, v37, s[24:27], s7 offen sc1
  s_add_u32 s7, s7, 65536
  buffer_store_dword v81, v36, s[24:27], s7 offen sc1
  buffer_store_dword v97, v37, s[24:27], s7 offen sc1
  s_add_u32 s7, s7, 65536
  buffer_store_dword v82, v36, s[24:27], s7 offen sc1
  buffer_store_dword v98, v37, s[24:27], s7 offen sc1
  s_add_u32 s7, s7, 65536
  buffer_store_dword v83, v36, s[24:27], s7 offen sc1
  buffer_store_dword v99, v37, s[24:27], s7 offen sc1
gated_mix__spectral_gfnet__ssm_conv_s5__prompt_kernel_end:
  s_endpgm
.section .rodata,"a"
.p2align 6
.amdhsa_kernel gated_mix__spectral_gfnet__ssm_conv_s5__prompt_kernel
  .amdhsa_next_free_vgpr 500
  .amdhsa_next_free_sgpr 102
  .amdhsa_accum_offset 244
  .amdhsa_group_segment_fixed_size 0
  .amdhsa_kernarg_size 128
  .amdhsa_user_sgpr_count 2
  .amdhsa_user_sgpr_kernarg_segment_ptr 1
  .amdhsa_system_sgpr_workgroup_id_x 1
  .amdhsa_float_denorm_mode_32 3
.end_amdhsa_kernel
```

```asm
; @launch grid=(256,1,1) block=(256,1,1) lds=163840
.amdgcn_target "amdgcn-amd-amdhsa--gfx950"
.text
.p2align 8
.globl gated_mix__spectral_gfnet__ssm_conv_s5__prompt_kernel
.type gated_mix__spectral_gfnet__ssm_conv_s5__prompt_kernel,@function
gated_mix__spectral_gfnet__ssm_conv_s5__prompt_kernel:
  s_cmp_ge_u32 s2, 256
  s_cbranch_scc1 gated_mix__spectral_gfnet__ssm_conv_s5__prompt_kernel_end
  s_load_dwordx16 s[4:19], s[0:1], 0
  s_load_dwordx16 s[20:35], s[0:1], 64
  v_readfirstlane_b32 s3, v0
  v_and_b32 v1, 63, v0
  v_and_b32 v2, 15, v0
  v_bfe_u32 v3, v0, 4, 2
  s_bfe_u32 s36, s2, 0x20003
  s_lshr_b32 s43, s2, 5
  s_lshr_b32 s3, s3, 6
  s_and_b32 s38, s2, 3
  s_lshl2_add_u32 s38, s38, s36
  s_bfe_u32 s39, s2, 0x10002
  s_lshl3_add_u32 s39, s39, s43
  s_and_b32 s42, s2, 1
  s_lshl3_add_u32 s40, s42, s43
  s_lshl1_add_u32 s42, s43, s42
  s_bfe_u32 s41, s2, 0x20001
  s_lshl2_add_u32 s41, s41, s36
  s_and_b32 s37, s2, 7
  s_lshl3_add_u32 s37, s37, s43
  s_cmp_lg_u32 s3, 0
  s_cbranch_scc1 gated_mix__spectral_gfnet__ssm_conv_s5__prompt_kernel_skip2
  s_getpc_b64 s[44:45]
gated_mix__spectral_gfnet__ssm_conv_s5__prompt_kernel_pc1:
  s_lshr_b32 s43, s2, 3
  s_mul_i32 s43, s43, 1280
  v_min_u32 v6, 9, v1
  v_lshl_add_u32 v6, v6, 7, s43
  v_min_u32 v6, gated_mix__spectral_gfnet__ssm_conv_s5__prompt_kernel_end-gated_mix__spectral_gfnet__ssm_conv_s5__prompt_kernel_pc1, v6
  v_mov_b32 v7, 0
  v_lshl_add_u64 v[6:7], v[6:7], 0, s[44:45]
  global_load_dword v4, v[6:7], off
gated_mix__spectral_gfnet__ssm_conv_s5__prompt_kernel_skip2:
  s_mov_b32 s46, 4194304
  s_mov_b32 s47, 0x20000
  s_mov_b32 s50, 2097152
  s_mov_b32 s51, 0x20000
  v_bfe_u32 v6, v1, 1, 2
  v_xor_b32 v6, v6, v3
  v_lshlrev_b32 v5, 9, v6
  v_and_b32 v6, 1, v1
  v_lshl_or_b32 v5, v6, 4, v5
  v_lshrrev_b32 v6, 3, v1
  v_lshl_or_b32 v5, v6, 15, v5
  s_lshl_b32 s43, s3, 9
  s_add_u32 s43, s43, s40
  s_lshl_b32 s43, s43, 6
  s_add_u32 s43, s43, s41
  s_lshl_b32 s43, s43, 5
  s_lshl_b32 m0, s3, 12
  s_add_u32 m0, m0, 131072
  s_waitcnt lgkmcnt(0)
  s_mov_b64 s[44:45], s[4:5]
  buffer_load_dwordx4 v5, s[44:47], s43 offen offset:0 lds
  s_add_u32 s43, s43, 261120
  buffer_load_dwordx4 v5, s[44:47], s43 offen offset:1024 lds
  s_add_u32 s43, s43, 261120
  buffer_load_dwordx4 v5, s[44:47], s43 offen offset:2048 lds
  s_add_u32 s43, s43, 261120
  buffer_load_dwordx4 v5, s[44:47], s43 offen offset:3072 lds
  v_and_b32 v6, 7, v1
  v_xor_b32 v6, v6, v3
  v_lshlrev_b32 v6, 4, v6
  v_lshrrev_b32 v7, 3, v1
  v_lshl_or_b32 v12, v7, 11, v6
  v_and_b32 v7, 32, v1
  v_lshl_or_b32 v8, v7, 11, v6
  v_and_b32 v7, 8, v1
  v_lshl_or_b32 v8, v7, 12, v8
  v_and_b32 v7, 16, v1
  v_lshl_or_b32 v8, v7, 7, v8
  s_lshr_b32 s53, s3, 1
  s_lshl1_add_u32 s54, s39, s53
  s_lshl_b32 s54, s54, 16
  v_add_u32 v12, s54, v12
  s_lshl1_add_u32 s54, s38, s53
  s_and_b32 s53, s3, 1
  s_lshl3_add_u32 s54, s54, s53
  s_lshl_b32 s54, s54, 14
  v_add_u32 v8, s54, v8
  v_xor_b32 v9, 64, v8
  v_xor_b32 v13, 64, v12
  v_add_u32 v9, 3072, v9
  v_add_u32 v13, 15360, v13
  v_add_u32 v10, 6144, v8
  v_add_u32 v14, 30720, v12
  v_add_u32 v11, 6144, v9
  v_add_u32 v15, 30720, v13
  s_lshl_b32 s54, s3, 12
  s_add_u32 s55, s54, 65536
  s_lshl_b32 s52, s38, 7
  s_bitcmp1_b32 s3, 0
  s_cselect_b64 s[48:49], s[18:19], s[16:17]
  s_lshl_b32 s11, s37, 2
  s_add_u32 s11, s11, s36
  s_cmp_eq_u32 s11, 3
  s_cselect_b32 s4, 1, s36
  s_cselect_b32 s5, 64, s37
  s_and_b32 s10, s11, 0xfd
  s_cmp_eq_u32 s10, 0
  s_cselect_b32 s10, 1, 0
  v_cvt_f32_u32 v6, v2
  v_cvt_f32_u32 v7, v3
  v_mul_f32 v7, 4.0, v7
  s_cmp_lg_u32 s3, 0
  s_cbranch_scc1 gated_mix__spectral_gfnet__ssm_conv_s5__prompt_kernel_skip3
  v_cvt_f32_u32 v43, s10
  v_mul_f32 v43, 0xc4700000, v43
  v_cmp_lt_u32 vcc, 7, v2
  v_cvt_f32_u32 v42, s5
  s_nop 0
  v_cndmask_b32 v43, 0, v43, vcc
  v_add_f32 v42, v42, v43
  v_fmamk_f32 v40, v6, 0x43000000, v42
  v_mul_f32 v40, 0x3a000000, v40
  v_mul_f32 v41, v40, v7
  v_fmamk_f32 v32, v40, 0x0, v41
  v_fmamk_f32 v33, v40, 0x3f800000, v41
  v_fmamk_f32 v34, v40, 0x40000000, v41
  v_fmamk_f32 v35, v40, 0x40400000, v41
  v_cos_f32 v36, v32
  v_cos_f32 v37, v33
  v_cos_f32 v38, v34
  v_cos_f32 v39, v35
  v_sin_f32 v32, v32
  v_sin_f32 v33, v33
  v_sin_f32 v34, v34
  v_sin_f32 v35, v35
  v_cvt_pk_bf16_f32 v16, v36, v32
  v_cvt_pk_bf16_f32 v20, -v32, v36
  v_cvt_pk_bf16_f32 v17, v37, v33
  v_cvt_pk_bf16_f32 v21, -v33, v37
  v_cvt_pk_bf16_f32 v18, v38, v34
  v_cvt_pk_bf16_f32 v22, -v34, v38
  v_cvt_pk_bf16_f32 v19, v39, v35
  v_cvt_pk_bf16_f32 v23, -v35, v39
  v_xor_b32 v42, 3, v2
  v_cndmask_b32 v42, v2, v42, vcc
  v_cvt_f32_u32 v40, v42
  v_mul_f32 v40, 0x3d800000, v40
  v_mul_f32 v41, v40, v7
  v_fmamk_f32 v32, v40, 0x0, v41
  v_fmamk_f32 v33, v40, 0x3f800000, v41
  v_fmamk_f32 v34, v40, 0x40000000, v41
  v_fmamk_f32 v35, v40, 0x40400000, v41
  v_cos_f32 v36, v32
  v_cos_f32 v37, v33
  v_cos_f32 v38, v34
  v_cos_f32 v39, v35
  v_sin_f32 v32, v32
  v_sin_f32 v33, v33
  v_sin_f32 v34, v34
  v_sin_f32 v35, v35
  v_cvt_pk_bf16_f32 v24, v36, v32
  v_cvt_pk_bf16_f32 v28, -v32, v36
  v_cvt_pk_bf16_f32 v25, v37, v33
  v_cvt_pk_bf16_f32 v29, -v33, v37
  v_cvt_pk_bf16_f32 v26, v38, v34
  v_cvt_pk_bf16_f32 v30, -v34, v38
  v_cvt_pk_bf16_f32 v27, v39, v35
  v_cvt_pk_bf16_f32 v31, -v35, v39
  s_cmp_eq_u32 s10, 0
  s_cbranch_scc1 gated_mix__spectral_gfnet__ssm_conv_s5__prompt_kernel_skip4
  v_cndmask_b32 v42, 0, 16, vcc
  v_and_b32 v16, 0xffff, v16
  v_lshlrev_b32 v16, v42, v16
  v_and_b32 v17, 0xffff, v17
  v_lshlrev_b32 v17, v42, v17
  v_and_b32 v18, 0xffff, v18
  v_lshlrev_b32 v18, v42, v18
  v_and_b32 v19, 0xffff, v19
  v_lshlrev_b32 v19, v42, v19
  v_and_b32 v20, 0xffff, v20
  v_lshlrev_b32 v20, v42, v20
  v_and_b32 v21, 0xffff, v21
  v_lshlrev_b32 v21, v42, v21
  v_and_b32 v22, 0xffff, v22
  v_lshlrev_b32 v22, v42, v22
  v_and_b32 v23, 0xffff, v23
  v_lshlrev_b32 v23, v42, v23
  v_cmp_eq_u32 vcc, 0, v2
  v_mov_b32 v42, 0x3f80
  s_nop 0
  v_cndmask_b32 v20, v20, v42, vcc
  v_mov_b32 v42, 0xbf80
  v_cndmask_b32 v21, v21, v42, vcc
  v_mov_b32 v42, 0x3f80
  v_cndmask_b32 v22, v22, v42, vcc
  v_mov_b32 v42, 0xbf80
  v_cndmask_b32 v23, v23, v42, vcc
gated_mix__spectral_gfnet__ssm_conv_s5__prompt_kernel_skip4:
gated_mix__spectral_gfnet__ssm_conv_s5__prompt_kernel_skip3:
  s_cmp_lg_u32 s3, 1
  s_cbranch_scc1 gated_mix__spectral_gfnet__ssm_conv_s5__prompt_kernel_skip5
  v_cvt_f32_u32 v43, s10
  v_mul_f32 v43, 0xc4700000, v43
  v_cmp_lt_u32 vcc, 1, v3
  v_cvt_f32_u32 v42, s5
  s_nop 0
  v_cndmask_b32 v43, 0, v43, vcc
  v_add_f32 v42, v42, v43
  v_fmamk_f32 v42, v7, 0x43000000, v42
  v_mul_f32 v41, v42, v6
  v_mul_f32 v41, 0x3a000000, v41
  v_mul_f32 v40, 0x3d800000, v6
  v_fmamk_f32 v32, v40, 0x0, v41
  v_fmamk_f32 v33, v40, 0x3f800000, v41
  v_fmamk_f32 v34, v40, 0x40000000, v41
  v_fmamk_f32 v35, v40, 0x40400000, v41
  v_cos_f32 v36, v32
  v_cos_f32 v37, v33
  v_cos_f32 v38, v34
  v_cos_f32 v39, v35
  v_sin_f32 v32, v32
  v_sin_f32 v33, v33
  v_sin_f32 v34, v34
  v_sin_f32 v35, v35
  v_cvt_pk_bf16_f32 v16, v36, -v32
  v_cvt_pk_bf16_f32 v20, v32, v36
  v_cvt_pk_bf16_f32 v17, v37, -v33
  v_cvt_pk_bf16_f32 v21, v33, v37
  v_cvt_pk_bf16_f32 v18, v38, -v34
  v_cvt_pk_bf16_f32 v22, v34, v38
  v_cvt_pk_bf16_f32 v19, v39, -v35
  v_cvt_pk_bf16_f32 v23, v35, v39
  v_add_f32 v42, 0x40400000, v7
  v_cndmask_b32 v42, v7, v42, vcc
  v_mul_f32 v41, v40, v42
  v_cndmask_b32 v40, v40, -v40, vcc
  v_fmamk_f32 v32, v40, 0x0, v41
  v_fmamk_f32 v33, v40, 0x3f800000, v41
  v_fmamk_f32 v34, v40, 0x40000000, v41
  v_fmamk_f32 v35, v40, 0x40400000, v41
  v_cos_f32 v36, v32
  v_cos_f32 v37, v33
  v_cos_f32 v38, v34
  v_cos_f32 v39, v35
  v_sin_f32 v32, v32
  v_sin_f32 v33, v33
  v_sin_f32 v34, v34
  v_sin_f32 v35, v35
  v_cvt_pk_bf16_f32 v24, v36, -v32
  v_cvt_pk_bf16_f32 v28, v32, v36
  v_cvt_pk_bf16_f32 v25, v37, -v33
  v_cvt_pk_bf16_f32 v29, v33, v37
  v_cvt_pk_bf16_f32 v26, v38, -v34
  v_cvt_pk_bf16_f32 v30, v34, v38
  v_cvt_pk_bf16_f32 v27, v39, -v35
  v_cvt_pk_bf16_f32 v31, v35, v39
  s_cmp_eq_u32 s10, 0
  s_cbranch_scc1 gated_mix__spectral_gfnet__ssm_conv_s5__prompt_kernel_skip6
  v_lshlrev_b32 v42, 16, v16
  v_and_b32 v43, 0xffff0000, v16
  v_add_f32 v42, v42, v42
  v_add_f32 v43, v43, v43
  v_cvt_pk_bf16_f32 v42, v42, v43
  v_cndmask_b32 v16, v42, 0, vcc
  v_cndmask_b32 v20, 0, v42, vcc
  v_lshlrev_b32 v42, 16, v17
  v_and_b32 v43, 0xffff0000, v17
  v_add_f32 v42, v42, v42
  v_add_f32 v43, v43, v43
  v_cvt_pk_bf16_f32 v42, v42, v43
  v_cndmask_b32 v17, v42, 0, vcc
  v_cndmask_b32 v21, 0, v42, vcc
  v_lshlrev_b32 v42, 16, v18
  v_and_b32 v43, 0xffff0000, v18
  v_add_f32 v42, v42, v42
  v_add_f32 v43, v43, v43
  v_cvt_pk_bf16_f32 v42, v42, v43
  v_cndmask_b32 v18, v42, 0, vcc
  v_cndmask_b32 v22, 0, v42, vcc
  v_lshlrev_b32 v42, 16, v19
  v_and_b32 v43, 0xffff0000, v19
  v_add_f32 v42, v42, v42
  v_add_f32 v43, v43, v43
  v_cvt_pk_bf16_f32 v42, v42, v43
  v_cndmask_b32 v19, v42, 0, vcc
  v_cndmask_b32 v23, 0, v42, vcc
  v_lshlrev_b32 v42, 31, v2
  v_or_b32 v42, 0x3f803f80, v42
  v_cmp_eq_u32 vcc, 0, v3
  s_nop 1
  v_cndmask_b32 v16, v16, v42, vcc
gated_mix__spectral_gfnet__ssm_conv_s5__prompt_kernel_skip6:
gated_mix__spectral_gfnet__ssm_conv_s5__prompt_kernel_skip5:
  s_cmp_lg_u32 s3, 2
  s_cbranch_scc1 gated_mix__spectral_gfnet__ssm_conv_s5__prompt_kernel_skip7
  v_cvt_f32_u32 v43, s4
  v_fma_f32 v42, v6, 4.0, v43
  v_mul_f32 v40, 0x3c800000, v42
  v_mul_f32 v41, v40, v7
  v_fmamk_f32 v32, v40, 0x0, v41
  v_fmamk_f32 v33, v40, 0x3f800000, v41
  v_fmamk_f32 v34, v40, 0x40000000, v41
  v_fmamk_f32 v35, v40, 0x40400000, v41
  v_cos_f32 v36, v32
  v_cos_f32 v37, v33
  v_cos_f32 v38, v34
  v_cos_f32 v39, v35
  v_sin_f32 v32, v32
  v_sin_f32 v33, v33
  v_sin_f32 v34, v34
  v_sin_f32 v35, v35
  v_cvt_pk_bf16_f32 v16, v36, v32
  v_cvt_pk_bf16_f32 v20, -v32, v36
  v_cvt_pk_bf16_f32 v17, v37, v33
  v_cvt_pk_bf16_f32 v21, -v33, v37
  v_cvt_pk_bf16_f32 v18, v38, v34
  v_cvt_pk_bf16_f32 v22, -v34, v38
  v_cvt_pk_bf16_f32 v19, v39, v35
  v_cvt_pk_bf16_f32 v23, -v35, v39
  v_mul_f32 v40, 0x3d800000, v40
  v_mul_f32 v41, 0x3d800000, v41
  v_fmamk_f32 v32, v40, 0x0, v41
  v_fmamk_f32 v33, v40, 0x3f800000, v41
  v_fmamk_f32 v34, v40, 0x40000000, v41
  v_fmamk_f32 v35, v40, 0x40400000, v41
  v_cos_f32 v24, v32
  v_cos_f32 v25, v33
  v_cos_f32 v26, v34
  v_cos_f32 v27, v35
  v_sin_f32 v28, v32
  v_sin_f32 v29, v33
  v_sin_f32 v30, v34
  v_sin_f32 v31, v35
gated_mix__spectral_gfnet__ssm_conv_s5__prompt_kernel_skip7:
  s_cmp_lg_u32 s3, 3
  s_cbranch_scc1 gated_mix__spectral_gfnet__ssm_conv_s5__prompt_kernel_skip8
  v_cvt_f32_u32 v43, s4
  v_fma_f32 v42, v7, 4.0, v43
  v_mul_f32 v41, v42, v6
  v_mul_f32 v41, 0x3c800000, v41
  v_mul_f32 v40, 0x3d800000, v6
  v_fmamk_f32 v32, v40, 0x0, v41
  v_fmamk_f32 v33, v40, 0x3f800000, v41
  v_fmamk_f32 v34, v40, 0x40000000, v41
  v_fmamk_f32 v35, v40, 0x40400000, v41
  v_cos_f32 v36, v32
  v_cos_f32 v37, v33
  v_cos_f32 v38, v34
  v_cos_f32 v39, v35
  v_sin_f32 v32, v32
  v_sin_f32 v33, v33
  v_sin_f32 v34, v34
  v_sin_f32 v35, v35
  v_cvt_pk_bf16_f32 v16, v36, -v32
  v_cvt_pk_bf16_f32 v20, v32, v36
  v_cvt_pk_bf16_f32 v17, v37, -v33
  v_cvt_pk_bf16_f32 v21, v33, v37
  v_cvt_pk_bf16_f32 v18, v38, -v34
  v_cvt_pk_bf16_f32 v22, v34, v38
  v_cvt_pk_bf16_f32 v19, v39, -v35
  v_cvt_pk_bf16_f32 v23, v35, v39
  v_mul_f32 v40, 0x3d800000, v40
  v_mul_f32 v41, 0x3d800000, v41
  v_fmamk_f32 v32, v40, 0x0, v41
  v_fmamk_f32 v33, v40, 0x3f800000, v41
  v_fmamk_f32 v34, v40, 0x40000000, v41
  v_fmamk_f32 v35, v40, 0x40400000, v41
  v_cos_f32 v24, v32
  v_cos_f32 v25, v33
  v_cos_f32 v26, v34
  v_cos_f32 v27, v35
  v_sin_f32 v28, v32
  v_sin_f32 v29, v33
  v_sin_f32 v30, v34
  v_sin_f32 v31, v35
  v_mul_f32 v24, 0x35800000, v24
  v_mul_f32 v25, 0x35800000, v25
  v_mul_f32 v26, 0x35800000, v26
  v_mul_f32 v27, 0x35800000, v27
  v_mul_f32 v28, 0x35800000, v28
  v_mul_f32 v29, 0x35800000, v29
  v_mul_f32 v30, 0x35800000, v30
  v_mul_f32 v31, 0x35800000, v31
gated_mix__spectral_gfnet__ssm_conv_s5__prompt_kernel_skip8:
  s_lshl_b32 s16, s3, 12
  s_add_u32 s16, s16, 147456
  v_lshl_add_u32 v42, v1, 4, s16
  ds_write_b128 v42, v[16:19] offset:0
  ds_write_b128 v42, v[20:23] offset:1024
  ds_write_b128 v42, v[24:27] offset:2048
  ds_write_b128 v42, v[28:31] offset:3072
  v_bfe_u32 v6, v1, 1, 3
  v_lshrrev_b32 v7, 5, v1
  v_xor_b32 v6, v6, v7
  v_lshlrev_b32 v6, 4, v6
  v_and_b32 v7, 31, v1
  v_lshl_or_b32 v6, v7, 7, v6
  s_lshr_b32 s53, s3, 1
  v_lshl_add_u32 v16, s53, 13, v6
  s_and_b32 s53, s3, 1
  s_or_b32 s53, s53, 8
  v_lshl_add_u32 v20, s53, 13, v6
  v_xor_b32 v17, 32, v16
  v_xor_b32 v21, 32, v20
  v_xor_b32 v18, 64, v16
  v_xor_b32 v22, 64, v20
  v_xor_b32 v19, 96, v16
  v_xor_b32 v23, 96, v20
  s_add_u32 s16, s34, 20316160
  s_addc_u32 s17, s35, 0
  s_mov_b32 s18, 262144
  s_mov_b32 s19, 0x20000
  v_mov_b32 v6, 0
  v_lshlrev_b32 v7, 4, v0
  s_mov_b32 s56, 4096
  s_cmp_lg_u32 s2, 0
  s_cbranch_scc1 gated_mix__spectral_gfnet__ssm_conv_s5__prompt_kernel_skip9
  v_mov_b32 v24, 0
  v_mov_b32 v25, 0
  v_mov_b32 v26, 0
  v_mov_b32 v27, 0
  buffer_store_dwordx4 v[24:27], v7, s[16:19], 0 offen sc1
  buffer_store_dwordx4 v[24:27], v7, s[16:19], s56 offen sc1
gated_mix__spectral_gfnet__ssm_conv_s5__prompt_kernel_skip9:
  s_mov_b32 s60, s28
  s_mov_b32 s61, s29
  s_mov_b32 s62, 2048
  s_mov_b32 s63, 0x20000
  s_mov_b32 s64, s12
  s_mov_b32 s65, s13
  s_mov_b32 s66, 2048
  s_mov_b32 s67, 0x20000
  s_mov_b32 s68, s14
  s_mov_b32 s69, s15
  s_mov_b32 s70, 2048
  s_mov_b32 s71, 0x20000
  s_add_u32 m0, s55, 0
  s_nop 0
  buffer_load_dwordx4 v12, s[48:51], s52 offen offset:0 lds
  s_mov_b32 s72, s24
  s_mov_b32 s73, s25
  s_mov_b32 s74, 2048
  s_mov_b32 s75, 0x20000
  s_mov_b32 s76, s26
  buffer_load_dwordx4 v13, s[48:51], s52 offen offset:1024 lds
  s_mov_b32 s77, s27
  s_mov_b32 s78, 2048
  s_mov_b32 s79, 0x20000
  s_mov_b32 s12, s34
  s_mov_b32 s13, s35
  buffer_load_dwordx4 v14, s[48:51], s52 offen offset:2048 lds
  s_mov_b32 s14, 4194304
  s_mov_b32 s15, 0x20000
  s_lshl_b32 s28, s3, 4
  v_add_u32 v76, s28, v2
  v_cvt_f32_u32 v72, v76
  buffer_load_dwordx4 v15, s[48:51], s52 offen offset:3072 lds
  v_mul_f32 v72, 0x3c000000, v72
  v_lshrrev_b32 v74, 1, v3
  v_lshlrev_b32 v74, 4, v74
  v_and_b32 v75, 1, v3
  v_lshl_add_u32 v74, v75, 2, v74
  s_add_u32 m0, s54, 0
  s_nop 0
  buffer_load_dwordx4 v8, s[44:47], s52 offen offset:0 lds
  v_cvt_f32_u32 v73, v74
  v_mul_f32 v73, v73, v72
  v_cmp_eq_u32 vcc, 0, v76
  v_fmamk_f32 v56, v72, 0x0, v73
  v_fmamk_f32 v57, v72, 0x3f800000, v73
  buffer_load_dwordx4 v9, s[44:47], s52 offen offset:1024 lds
  v_fmamk_f32 v58, v72, 0x40000000, v73
  v_fmamk_f32 v59, v72, 0x40400000, v73
  v_fmamk_f32 v60, v72, 0x41000000, v73
  v_fmamk_f32 v61, v72, 0x41100000, v73
  v_fmamk_f32 v62, v72, 0x41200000, v73
  buffer_load_dwordx4 v10, s[44:47], s52 offen offset:2048 lds
  v_fmamk_f32 v63, v72, 0x41300000, v73
  v_cos_f32 v64, v56
  v_cos_f32 v65, v57
  buffer_load_dwordx4 v11, s[44:47], s52 offen offset:3072 lds
  s_add_u32 s52, s52, 128
  s_and_b32 s52, s52, 0x7ff
  v_cos_f32 v66, v58
  v_cos_f32 v67, v59
  v_cos_f32 v68, v60
  v_cos_f32 v69, v61
  v_cos_f32 v70, v62
  v_cos_f32 v71, v63
  v_sin_f32 v56, v56
  v_sin_f32 v57, v57
  v_sin_f32 v58, v58
  v_sin_f32 v59, v59
  v_sin_f32 v60, v60
  v_sin_f32 v61, v61
  v_sin_f32 v62, v62
  v_sin_f32 v63, v63
  v_mov_b32 v73, 0x80008000
  v_bfe_i32 v75, v2, 0, 1
  v_bfe_i32 v74, v2, 1, 1
  v_cmp_ne_u32 s[58:59], 0, v75
  v_and_b32 v75, v73, v75
  v_and_b32 v74, v73, v74
  v_xor_b32 v76, v74, v75
  v_mov_b32 v72, 0xbf803f80
  v_cvt_pk_bf16_f32 v24, v64, v65
  v_cvt_pk_bf16_f32 v40, -v56, -v57
  v_cndmask_b32 v40, v40, v72, vcc
  v_cvt_pk_bf16_f32 v25, v66, v67
  v_cvt_pk_bf16_f32 v41, -v58, -v59
  v_cndmask_b32 v41, v41, v72, vcc
  v_cvt_pk_bf16_f32 v26, v68, v69
  v_cvt_pk_bf16_f32 v42, -v60, -v61
  v_cndmask_b32 v42, v42, v72, vcc
  v_cvt_pk_bf16_f32 v27, v70, v71
  v_cvt_pk_bf16_f32 v43, -v62, -v63
  v_cndmask_b32 v43, v43, v72, vcc
  v_cndmask_b32 v28, v24, v40, s[58:59]
  v_cndmask_b32 v44, v40, v24, s[58:59]
  v_xor_b32 v32, v75, v24
  v_xor_b32 v48, v75, v40
  v_xor_b32 v36, v76, v28
  v_xor_b32 v52, v74, v44
  v_xor_b32 v28, v74, v28
  v_xor_b32 v44, v76, v44
  v_cndmask_b32 v29, v25, v41, s[58:59]
  v_cndmask_b32 v45, v41, v25, s[58:59]
  v_xor_b32 v33, v75, v25
  v_xor_b32 v49, v75, v41
  v_xor_b32 v37, v76, v29
  v_xor_b32 v53, v74, v45
  v_xor_b32 v29, v74, v29
  v_xor_b32 v45, v76, v45
  v_cndmask_b32 v30, v26, v42, s[58:59]
  v_cndmask_b32 v46, v42, v26, s[58:59]
  v_xor_b32 v34, v75, v26
  v_xor_b32 v50, v75, v42
  v_xor_b32 v38, v76, v30
  v_xor_b32 v54, v74, v46
  v_xor_b32 v30, v74, v30
  v_xor_b32 v46, v76, v46
  v_cndmask_b32 v31, v27, v43, s[58:59]
  v_cndmask_b32 v47, v43, v27, s[58:59]
  v_xor_b32 v35, v75, v27
  v_xor_b32 v51, v75, v43
  v_xor_b32 v39, v76, v31
  v_xor_b32 v55, v74, v47
  v_xor_b32 v31, v74, v31
  v_xor_b32 v47, v76, v47
  v_and_b32 v5, 31, v1
  v_lshlrev_b32 v5, 1, v5
  s_lshl_b32 s43, s39, 7
  s_and_b32 s28, s3, 1
  s_lshl_b32 s28, s28, 6
  s_add_u32 s43, s43, s28
  buffer_load_ushort v56, v5, s[64:67], s43 offen
  buffer_load_ushort v57, v5, s[68:71], s43 offen
  buffer_load_ushort v58, v5, s[72:75], s43 offen
  v_lshlrev_b32 v5, 1, v2
  s_lshl4_add_u32 s43, s3, s41
  s_lshl_b32 s43, s43, 5
  buffer_load_short_d16_hi v60, v5, s[76:79], s43 offen
  v_lshlrev_b32 v59, 4, v1
  s_lshl_b32 s29, s38, 18
  s_lshl_b32 s58, s39, 11
  s_add_u32 s29, s29, s58
  s_lshl_b32 s58, s3, 16
  s_add_u32 s29, s29, s58
  s_add_u32 s58, s29, 32768
  buffer_load_dwordx4 v[64:67], v59, s[44:47], s29 offen offset:0
  buffer_load_dwordx4 v[68:71], v59, s[44:47], s29 offen offset:1024
  buffer_load_dwordx4 v[72:75], v59, s[44:47], s58 offen offset:0
  buffer_load_dwordx4 v[76:79], v59, s[44:47], s58 offen offset:1024
  buffer_load_dwordx4 v[80:83], v59, s[60:63], 0 offen offset:0
  buffer_load_dwordx4 v[84:87], v59, s[60:63], 0 offen offset:1024
  s_add_u32 m0, s55, 16384
  s_nop 0
  buffer_load_dwordx4 v12, s[48:51], s52 offen offset:0 lds
  buffer_load_dwordx4 v13, s[48:51], s52 offen offset:1024 lds
  buffer_load_dwordx4 v14, s[48:51], s52 offen offset:2048 lds
  buffer_load_dwordx4 v15, s[48:51], s52 offen offset:3072 lds
  s_waitcnt vmcnt(22) lgkmcnt(0)
  s_barrier
  s_add_u32 m0, s54, 16384
  s_nop 0
  buffer_load_dwordx4 v8, s[44:47], s52 offen offset:0 lds
  v_bfe_u32 v5, v1, 2, 3
  v_lshrrev_b32 v62, 5, v1
  v_lshl_or_b32 v5, v62, 4, v5
  v_lshlrev_b32 v5, 7, v5
  v_and_b32 v62, 3, v1
  v_lshl_or_b32 v5, v62, 3, v5
  v_add_u32 v5, 131072, v5
  v_bfe_u32 v62, v1, 3, 2
  v_xor_b32 v88, 0, v62
  v_lshl_add_u32 v88, v88, 5, v5
  v_xor_b32 v89, 1, v62
  v_lshl_add_u32 v89, v89, 5, v5
  v_xor_b32 v90, 2, v62
  v_lshl_add_u32 v90, v90, 5, v5
  v_xor_b32 v91, 3, v62
  v_lshl_add_u32 v91, v91, 5, v5
  ds_read_b64_tr_b16 v[124:125], v88 offset:0
  ds_read_b64_tr_b16 v[126:127], v88 offset:1024
  buffer_load_dwordx4 v9, s[44:47], s52 offen offset:1024 lds
  ds_read_b64_tr_b16 v[128:129], v88 offset:4096
  ds_read_b64_tr_b16 v[130:131], v88 offset:5120
  ds_read_b64_tr_b16 v[132:133], v88 offset:8192
  ds_read_b64_tr_b16 v[134:135], v88 offset:9216
  ds_read_b64_tr_b16 v[136:137], v88 offset:12288
  ds_read_b64_tr_b16 v[138:139], v88 offset:13312
  ds_read_b64_tr_b16 v[140:141], v90 offset:0
  ds_read_b64_tr_b16 v[142:143], v90 offset:1024
  ds_read_b64_tr_b16 v[144:145], v90 offset:4096
  ds_read_b64_tr_b16 v[146:147], v90 offset:5120
  ds_read_b64_tr_b16 v[148:149], v90 offset:8192
  ds_read_b64_tr_b16 v[150:151], v90 offset:9216
  ds_read_b64_tr_b16 v[152:153], v90 offset:12288
  ds_read_b64_tr_b16 v[154:155], v90 offset:13312
  ds_read_b64_tr_b16 v[156:157], v89 offset:0
  ds_read_b64_tr_b16 v[158:159], v89 offset:1024
  ds_read_b64_tr_b16 v[160:161], v89 offset:4096
  ds_read_b64_tr_b16 v[162:163], v89 offset:5120
  buffer_load_dwordx4 v10, s[44:47], s52 offen offset:2048 lds
  ds_read_b64_tr_b16 v[164:165], v89 offset:8192
  ds_read_b64_tr_b16 v[166:167], v89 offset:9216
  ds_read_b64_tr_b16 v[168:169], v89 offset:12288
  ds_read_b64_tr_b16 v[170:171], v89 offset:13312
  s_waitcnt lgkmcnt(15)
  v_mfma_f32_16x16x32_bf16 v[92:95], v[24:27], v[124:127], 0
  v_mfma_f32_16x16x32_bf16 v[96:99], v[40:43], v[124:127], 0
  s_waitcnt lgkmcnt(15)
  v_mfma_f32_16x16x32_bf16 v[92:95], v[28:31], v[128:131], v[92:95]
  v_mfma_f32_16x16x32_bf16 v[96:99], v[44:47], v[128:131], v[96:99]
  buffer_load_dwordx4 v11, s[44:47], s52 offen offset:3072 lds
  s_add_u32 s52, s52, 128
  s_and_b32 s52, s52, 0x7ff
  s_waitcnt lgkmcnt(15)
  v_mfma_f32_16x16x32_bf16 v[92:95], v[32:35], v[132:135], v[92:95]
  v_mfma_f32_16x16x32_bf16 v[96:99], v[48:51], v[132:135], v[96:99]
  s_waitcnt lgkmcnt(15)
  v_mfma_f32_16x16x32_bf16 v[92:95], v[36:39], v[136:139], v[92:95]
  v_mfma_f32_16x16x32_bf16 v[96:99], v[52:55], v[136:139], v[96:99]
  ds_read_b64_tr_b16 v[124:125], v91 offset:0
  ds_read_b64_tr_b16 v[126:127], v91 offset:1024
  s_add_u32 m0, s55, 32768
  s_nop 0
  buffer_load_dwordx4 v12, s[48:51], s52 offen offset:0 lds
  ds_read_b64_tr_b16 v[128:129], v91 offset:4096
  ds_read_b64_tr_b16 v[130:131], v91 offset:5120
  ds_read_b64_tr_b16 v[132:133], v91 offset:8192
  ds_read_b64_tr_b16 v[134:135], v91 offset:9216
  ds_read_b64_tr_b16 v[136:137], v91 offset:12288
  ds_read_b64_tr_b16 v[138:139], v91 offset:13312
  s_waitcnt lgkmcnt(15)
  v_mfma_f32_16x16x32_bf16 v[108:111], v[24:27], v[140:143], 0
  v_mfma_f32_16x16x32_bf16 v[112:115], v[40:43], v[140:143], 0
  s_waitcnt lgkmcnt(15)
  v_mfma_f32_16x16x32_bf16 v[108:111], v[28:31], v[144:147], v[108:111]
  buffer_load_dwordx4 v13, s[48:51], s52 offen offset:1024 lds
  v_mfma_f32_16x16x32_bf16 v[112:115], v[44:47], v[144:147], v[112:115]
  s_waitcnt lgkmcnt(15)
  v_mfma_f32_16x16x32_bf16 v[108:111], v[32:35], v[148:151], v[108:111]
  v_mfma_f32_16x16x32_bf16 v[112:115], v[48:51], v[148:151], v[112:115]
  s_waitcnt lgkmcnt(15)
  v_mfma_f32_16x16x32_bf16 v[108:111], v[36:39], v[152:155], v[108:111]
  v_mfma_f32_16x16x32_bf16 v[112:115], v[52:55], v[152:155], v[112:115]
  buffer_load_dwordx4 v14, s[48:51], s52 offen offset:2048 lds
  s_waitcnt lgkmcnt(14)
  v_mfma_f32_16x16x32_bf16 v[100:103], v[24:27], v[156:159], 0
  v_mfma_f32_16x16x32_bf16 v[104:107], v[40:43], v[156:159], 0
  s_waitcnt lgkmcnt(12)
  v_mfma_f32_16x16x32_bf16 v[100:103], v[28:31], v[160:163], v[100:103]
  v_mfma_f32_16x16x32_bf16 v[104:107], v[44:47], v[160:163], v[104:107]
  s_waitcnt lgkmcnt(10)
  v_mfma_f32_16x16x32_bf16 v[100:103], v[32:35], v[164:167], v[100:103]
  buffer_load_dwordx4 v15, s[48:51], s52 offen offset:3072 lds
  v_mfma_f32_16x16x32_bf16 v[104:107], v[48:51], v[164:167], v[104:107]
  s_waitcnt lgkmcnt(8)
  v_mfma_f32_16x16x32_bf16 v[100:103], v[36:39], v[168:171], v[100:103]
  v_mfma_f32_16x16x32_bf16 v[104:107], v[52:55], v[168:171], v[104:107]
  s_waitcnt lgkmcnt(6)
  v_mfma_f32_16x16x32_bf16 v[116:119], v[24:27], v[124:127], 0
  v_mfma_f32_16x16x32_bf16 v[120:123], v[40:43], v[124:127], 0
  s_add_u32 m0, s54, 32768
  s_nop 0
  buffer_load_dwordx4 v8, s[44:47], s52 offen offset:0 lds
  s_waitcnt lgkmcnt(4)
  v_mfma_f32_16x16x32_bf16 v[116:119], v[28:31], v[128:131], v[116:119]
  v_mfma_f32_16x16x32_bf16 v[120:123], v[44:47], v[128:131], v[120:123]
  s_waitcnt lgkmcnt(2)
  v_mfma_f32_16x16x32_bf16 v[116:119], v[32:35], v[132:135], v[116:119]
  v_mfma_f32_16x16x32_bf16 v[120:123], v[48:51], v[132:135], v[120:123]
  s_waitcnt lgkmcnt(0)
  v_mfma_f32_16x16x32_bf16 v[116:119], v[36:39], v[136:139], v[116:119]
  buffer_load_dwordx4 v9, s[44:47], s52 offen offset:1024 lds
  v_mfma_f32_16x16x32_bf16 v[120:123], v[52:55], v[136:139], v[120:123]
  v_pk_add_f32 v[140:141], v[92:93], v[108:109]
  v_pk_add_f32 v[148:149], v[92:93], v[108:109] neg_lo:[0,1] neg_hi:[0,1]
  v_pk_add_f32 v[142:143], v[94:95], v[110:111]
  v_pk_add_f32 v[150:151], v[94:95], v[110:111] neg_lo:[0,1] neg_hi:[0,1]
  v_pk_add_f32 v[144:145], v[96:97], v[112:113]
  v_pk_add_f32 v[152:153], v[96:97], v[112:113] neg_lo:[0,1] neg_hi:[0,1]
  v_pk_add_f32 v[146:147], v[98:99], v[114:115]
  v_pk_add_f32 v[154:155], v[98:99], v[114:115] neg_lo:[0,1] neg_hi:[0,1]
  v_pk_add_f32 v[156:157], v[100:101], v[116:117]
  v_pk_add_f32 v[164:165], v[100:101], v[116:117] neg_lo:[0,1] neg_hi:[0,1]
  v_pk_add_f32 v[158:159], v[102:103], v[118:119]
  v_pk_add_f32 v[166:167], v[102:103], v[118:119] neg_lo:[0,1] neg_hi:[0,1]
  v_pk_add_f32 v[160:161], v[104:105], v[120:121]
  v_pk_add_f32 v[168:169], v[104:105], v[120:121] neg_lo:[0,1] neg_hi:[0,1]
  buffer_load_dwordx4 v10, s[44:47], s52 offen offset:2048 lds
  v_pk_add_f32 v[162:163], v[106:107], v[122:123]
  v_pk_add_f32 v[170:171], v[106:107], v[122:123] neg_lo:[0,1] neg_hi:[0,1]
  v_pk_add_f32 v[92:93], v[140:141], v[156:157]
  v_pk_add_f32 v[108:109], v[140:141], v[156:157] neg_lo:[0,1] neg_hi:[0,1]
  v_pk_add_f32 v[96:97], v[144:145], v[160:161]
  v_pk_add_f32 v[112:113], v[144:145], v[160:161] neg_lo:[0,1] neg_hi:[0,1]
  v_pk_add_f32 v[100:101], v[148:149], v[168:169]
  v_pk_add_f32 v[104:105], v[152:153], v[164:165] neg_lo:[0,1] neg_hi:[0,1]
  v_pk_add_f32 v[116:117], v[148:149], v[168:169] neg_lo:[0,1] neg_hi:[0,1]
  v_pk_add_f32 v[120:121], v[152:153], v[164:165]
  v_pk_add_f32 v[94:95], v[142:143], v[158:159]
  v_pk_add_f32 v[110:111], v[142:143], v[158:159] neg_lo:[0,1] neg_hi:[0,1]
  v_pk_add_f32 v[98:99], v[146:147], v[162:163]
  v_pk_add_f32 v[114:115], v[146:147], v[162:163] neg_lo:[0,1] neg_hi:[0,1]
  v_pk_add_f32 v[102:103], v[150:151], v[170:171]
  v_pk_add_f32 v[106:107], v[154:155], v[166:167] neg_lo:[0,1] neg_hi:[0,1]
  v_pk_add_f32 v[118:119], v[150:151], v[170:171] neg_lo:[0,1] neg_hi:[0,1]
  v_pk_add_f32 v[122:123], v[154:155], v[166:167]
  buffer_load_dwordx4 v11, s[44:47], s52 offen offset:3072 lds
  s_add_u32 s52, s52, 128
  s_and_b32 s52, s52, 0x7ff
  v_cmp_gt_u32 vcc, 16, v0
  s_nop 1
  v_cndmask_b32 v100, v100, v148, vcc
  v_cndmask_b32 v104, v104, -v164, vcc
  v_cndmask_b32 v116, v116, v152, vcc
  v_cndmask_b32 v120, v120, -v168, vcc
  v_cvt_pk_bf16_f32 v124, v92, v96
  v_cvt_pk_bf16_f32 v125, v100, v104
  v_cvt_pk_bf16_f32 v126, v108, v112
  v_cvt_pk_bf16_f32 v127, v116, v120
  v_cvt_pk_bf16_f32 v128, v93, v97
  v_cvt_pk_bf16_f32 v129, v101, v105
  v_cvt_pk_bf16_f32 v130, v109, v113
  v_cvt_pk_bf16_f32 v131, v117, v121
  v_cvt_pk_bf16_f32 v132, v94, v98
  v_cvt_pk_bf16_f32 v133, v102, v106
  v_cvt_pk_bf16_f32 v134, v110, v114
  v_cvt_pk_bf16_f32 v135, v118, v122
  v_cvt_pk_bf16_f32 v136, v95, v99
  s_add_u32 m0, s55, 49152
  s_nop 0
  buffer_load_dwordx4 v12, s[48:51], s52 offen offset:0 lds
  v_cvt_pk_bf16_f32 v137, v103, v107
  v_cvt_pk_bf16_f32 v138, v111, v115
  v_cvt_pk_bf16_f32 v139, v119, v123
  v_and_b32 v124, -2, v124
  v_and_b32 v125, -2, v125
  v_and_b32 v126, -2, v126
  v_and_b32 v127, -2, v127
  v_and_b32 v128, -2, v128
  v_and_b32 v129, -2, v129
  v_and_b32 v130, -2, v130
  v_and_b32 v131, -2, v131
  v_and_b32 v132, -2, v132
  v_and_b32 v133, -2, v133
  v_and_b32 v134, -2, v134
  v_and_b32 v135, -2, v135
  v_and_b32 v136, -2, v136
  v_and_b32 v137, -2, v137
  v_and_b32 v138, -2, v138
  buffer_load_dwordx4 v13, s[48:51], s52 offen offset:1024 lds
  v_and_b32 v139, -2, v139
  s_mov_b32 s28, 262144
  v_mul_lo_u32 v5, v3, s28
  v_lshl_add_u32 v5, v2, 2, v5
  s_mul_i32 s28, s3, 1048576
  s_lshl_b32 s43, s40, 10
  s_add_u32 s28, s28, s43
  s_lshl_b32 s43, s41, 6
  s_add_u32 s28, s28, s43
  s_lshr_b32 s43, s41, 3
  s_lshl_b32 s43, s43, 13
  s_add_u32 s43, s43, 131072
  v_lshrrev_b32 v40, 2, v1
  v_lshl_add_u32 v40, v40, 7, s43
  v_and_b32 v41, 3, v1
  v_lshl_add_u32 v40, v41, 3, v40
  v_bfe_u32 v41, v1, 3, 2
  v_xor_b32 v41, s3, v41
  buffer_load_dwordx4 v14, s[48:51], s52 offen offset:2048 lds
  v_lshl_add_u32 v39, v41, 5, v40
  v_xor_b32 v38, 8192, v39
  ds_read_b64_tr_b16 v[62:63], v38 offset:0
  ds_read_b64_tr_b16 v[24:25], v38 offset:2048
  ds_read_b64_tr_b16 v[26:27], v38 offset:4096
  ds_read_b64_tr_b16 v[28:29], v38 offset:6144
  ds_read_b64_tr_b16 v[30:31], v39 offset:0
  ds_read_b64_tr_b16 v[32:33], v39 offset:2048
  ds_read_b64_tr_b16 v[34:35], v39 offset:4096
  ds_read_b64_tr_b16 v[36:37], v39 offset:6144
  buffer_load_dwordx4 v15, s[48:51], s52 offen offset:3072 lds
  s_add_u32 m0, s54, 49152
  s_nop 0
  buffer_load_dwordx4 v8, s[44:47], s52 offen offset:0 lds
  buffer_load_dwordx4 v9, s[44:47], s52 offen offset:1024 lds
  buffer_load_dwordx4 v10, s[44:47], s52 offen offset:2048 lds
  buffer_load_dwordx4 v11, s[44:47], s52 offen offset:3072 lds
  s_add_u32 s52, s52, 128
  s_and_b32 s52, s52, 0x7ff
  s_waitcnt vmcnt(34)
  s_barrier
  ds_read_b128 v[120:123], v16 offset:0
  ds_read_b128 v[160:163], v20 offset:0
  ds_read_b128 v[156:159], v16 offset:4096
  ds_read_b128 v[164:167], v20 offset:4096
  s_waitcnt lgkmcnt(2)
  v_mfma_f32_32x32x16_bf16 v[40:55], v[120:123], v[160:163], 0
  ds_read_b128 v[168:171], v17 offset:0
  ds_read_b128 v[176:179], v21 offset:0
  buffer_store_dword v124, v5, s[12:15], s28 offen sc1
  s_add_u32 s28, s28, 16384
  buffer_store_dword v125, v5, s[12:15], s28 offen sc1
  s_waitcnt lgkmcnt(2)
  v_mfma_f32_32x32x16_bf16 v[88:103], v[120:123], v[164:167], 0
  ds_read_b128 v[172:175], v17 offset:4096
  ds_read_b128 v[180:183], v21 offset:4096
  s_add_u32 s28, s28, 16384
  buffer_store_dword v126, v5, s[12:15], s28 offen sc1
  v_mfma_f32_32x32x16_bf16 v[140:155], v[156:159], v[164:167], 0
  s_add_u32 s28, s28, 16384
  buffer_store_dword v127, v5, s[12:15], s28 offen sc1
  v_mfma_f32_32x32x16_bf16 v[104:119], v[156:159], v[160:163], 0
  s_add_u32 s28, s28, 16384
  buffer_store_dword v128, v5, s[12:15], s28 offen sc1
  s_waitcnt lgkmcnt(2)
  v_mfma_f32_32x32x16_bf16 v[40:55], v[168:171], v[176:179], v[40:55]
  ds_read_b128 v[120:123], v18 offset:0
  ds_read_b128 v[160:163], v22 offset:0
  s_add_u32 s28, s28, 16384
  buffer_store_dword v129, v5, s[12:15], s28 offen sc1
  s_waitcnt lgkmcnt(2)
  v_mfma_f32_32x32x16_bf16 v[88:103], v[168:171], v[180:183], v[88:103]
  ds_read_b128 v[156:159], v18 offset:4096
  ds_read_b128 v[164:167], v22 offset:4096
  s_add_u32 s28, s28, 16384
  buffer_store_dword v130, v5, s[12:15], s28 offen sc1
  v_mfma_f32_32x32x16_bf16 v[140:155], v[172:175], v[180:183], v[140:155]
  s_add_u32 s28, s28, 16384
  buffer_store_dword v131, v5, s[12:15], s28 offen sc1
  v_mfma_f32_32x32x16_bf16 v[104:119], v[172:175], v[176:179], v[104:119]
  s_add_u32 s28, s28, 16384
  buffer_store_dword v132, v5, s[12:15], s28 offen sc1
  s_waitcnt lgkmcnt(2)
  v_mfma_f32_32x32x16_bf16 v[40:55], v[120:123], v[160:163], v[40:55]
  ds_read_b128 v[168:171], v19 offset:0
  ds_read_b128 v[176:179], v23 offset:0
  s_add_u32 s28, s28, 16384
  buffer_store_dword v133, v5, s[12:15], s28 offen sc1
  s_add_u32 s28, s28, 16384
  s_waitcnt lgkmcnt(2)
  v_mfma_f32_32x32x16_bf16 v[88:103], v[120:123], v[164:167], v[88:103]
  ds_read_b128 v[172:175], v19 offset:4096
  ds_read_b128 v[180:183], v23 offset:4096
  buffer_store_dword v134, v5, s[12:15], s28 offen sc1
  s_add_u32 s28, s28, 16384
  v_mfma_f32_32x32x16_bf16 v[140:155], v[156:159], v[164:167], v[140:155]
  buffer_store_dword v135, v5, s[12:15], s28 offen sc1
  s_add_u32 s28, s28, 16384
  v_mfma_f32_32x32x16_bf16 v[104:119], v[156:159], v[160:163], v[104:119]
  buffer_store_dword v136, v5, s[12:15], s28 offen sc1
  s_add_u32 s28, s28, 16384
  s_waitcnt vmcnt(29) lgkmcnt(0)
  s_barrier
  v_mfma_f32_32x32x16_bf16 v[40:55], v[168:171], v[176:179], v[40:55]
  ds_read_b128 v[120:123], v16 offset:16384
  ds_read_b128 v[160:163], v20 offset:16384
  buffer_store_dword v137, v5, s[12:15], s28 offen sc1
  s_add_u32 s28, s28, 16384
  v_mfma_f32_32x32x16_bf16 v[88:103], v[168:171], v[180:183], v[88:103]
  ds_read_b128 v[156:159], v16 offset:20480
  ds_read_b128 v[164:167], v20 offset:20480
  buffer_store_dword v138, v5, s[12:15], s28 offen sc1
  s_add_u32 s28, s28, 16384
  v_mfma_f32_32x32x16_bf16 v[140:155], v[172:175], v[180:183], v[140:155]
  s_add_u32 m0, s55, 0
  s_nop 0
  buffer_load_dwordx4 v12, s[48:51], s52 offen offset:0 lds
  buffer_store_dword v139, v5, s[12:15], s28 offen sc1
  s_mov_b32 s24, s32
  v_mfma_f32_32x32x16_bf16 v[104:119], v[172:175], v[176:179], v[104:119]
  buffer_load_dwordx4 v13, s[48:51], s52 offen offset:1024 lds
  s_mov_b32 s25, s33
  s_mov_b32 s26, 256
  s_waitcnt lgkmcnt(2)
  v_mfma_f32_32x32x16_bf16 v[40:55], v[120:123], v[160:163], v[40:55]
  ds_read_b128 v[168:171], v17 offset:16384
  ds_read_b128 v[176:179], v21 offset:16384
  s_mov_b32 s27, 0x20000
  s_and_b32 s57, s2, 7
  s_lshl_b32 s57, s57, 8
  s_add_u32 s57, s57, s2
  s_and_b32 s57, s57, -8
  s_lshl_b32 s57, s57, 1
  s_waitcnt lgkmcnt(2)
  v_mfma_f32_32x32x16_bf16 v[88:103], v[120:123], v[164:167], v[88:103]
  ds_read_b128 v[172:175], v17 offset:20480
  ds_read_b128 v[180:183], v21 offset:20480
  v_mov_b32 v38, s57
  s_lshl4_add_u32 s57, s39, s38
  s_lshl_b32 s57, s57, 7
  v_lshl_add_u32 v39, v2, 2, s57
  s_mov_b32 s57, 8192
  v_mfma_f32_32x32x16_bf16 v[140:155], v[156:159], v[164:167], v[140:155]
  buffer_load_dwordx4 v14, s[48:51], s52 offen offset:2048 lds
  v_mov_b32 v5, 1
  s_lshl_b32 s28, s39, 14
  s_add_u32 s66, s28, 19988480
  s_add_u32 s64, s34, s66
  s_addc_u32 s65, s35, 0
  s_mov_b32 s66, 8192
  v_mfma_f32_32x32x16_bf16 v[104:119], v[156:159], v[160:163], v[104:119]
  buffer_load_dwordx4 v15, s[48:51], s52 offen offset:3072 lds
  s_mov_b32 s67, 0x20000
  s_sub_u32 s28, 15, s38
  s_lshl_b32 s28, s28, 9
  v_lshl_add_u32 v124, v0, 2, s28
  v_mov_b32 v125, -1
  s_waitcnt lgkmcnt(2)
  v_mfma_f32_32x32x16_bf16 v[40:55], v[168:171], v[176:179], v[40:55]
  ds_read_b128 v[120:123], v18 offset:16384
  ds_read_b128 v[160:163], v22 offset:16384
  s_cmp_ge_u32 s3, 2
  s_cbranch_scc1 gated_mix__spectral_gfnet__ssm_conv_s5__prompt_kernel_skip10
  buffer_store_dword v125, v124, s[64:67], 0 offen sc1
gated_mix__spectral_gfnet__ssm_conv_s5__prompt_kernel_skip10:
  s_cmp_lg_u32 s3, 0
  s_cbranch_scc1 gated_mix__spectral_gfnet__ssm_conv_s5__prompt_kernel_skip11
  s_mov_b64 exec, 65535
  buffer_store_dword v6, v39, s[16:19], s57 offen sc1
  s_mov_b64 exec, -1
gated_mix__spectral_gfnet__ssm_conv_s5__prompt_kernel_skip11:
  s_waitcnt lgkmcnt(2)
  v_mfma_f32_32x32x16_bf16 v[88:103], v[168:171], v[180:183], v[88:103]
  ds_read_b128 v[156:159], v18 offset:20480
  ds_read_b128 v[164:167], v22 offset:20480
  s_or_b32 s28, s3, s2
  v_mfma_f32_32x32x16_bf16 v[140:155], v[172:175], v[180:183], v[140:155]
  s_add_u32 m0, s54, 0
  s_nop 0
  buffer_load_dwordx4 v8, s[44:47], s52 offen offset:0 lds
  s_cmp_lg_u32 s28, 0
  s_cbranch_scc1 gated_mix__spectral_gfnet__ssm_conv_s5__prompt_kernel_skip12
  s_mov_b64 exec, 1
  buffer_store_dword v5, v6, s[24:27], 0 offen sc1
  s_mov_b64 exec, -1
gated_mix__spectral_gfnet__ssm_conv_s5__prompt_kernel_skip12:
  v_mfma_f32_32x32x16_bf16 v[104:119], v[172:175], v[176:179], v[104:119]
  buffer_load_dwordx4 v9, s[44:47], s52 offen offset:1024 lds
  s_mov_b32 s68, s20
  s_mov_b32 s69, s21
  s_mov_b32 s70, 2097152
  s_mov_b32 s71, 0x20000
  s_mov_b32 s72, s22
  s_waitcnt lgkmcnt(2)
  v_mfma_f32_32x32x16_bf16 v[40:55], v[120:123], v[160:163], v[40:55]
  ds_read_b128 v[168:171], v19 offset:16384
  ds_read_b128 v[176:179], v23 offset:16384
  s_mov_b32 s73, s23
  s_mov_b32 s74, 2097152
  s_mov_b32 s75, 0x20000
  v_and_b32 v132, 7, v1
  v_xor_b32 v132, v132, v3
  s_waitcnt lgkmcnt(2)
  v_mfma_f32_32x32x16_bf16 v[88:103], v[120:123], v[164:167], v[88:103]
  ds_read_b128 v[172:175], v19 offset:20480
  ds_read_b128 v[180:183], v23 offset:20480
  v_and_b32 v133, 4, v132
  v_lshlrev_b32 v124, 4, v133
  v_and_b32 v133, 1, v132
  v_lshl_or_b32 v124, v133, 5, v124
  v_and_b32 v133, 2, v132
  v_lshl_or_b32 v124, v133, 3, v124
  v_mfma_f32_32x32x16_bf16 v[140:155], v[156:159], v[164:167], v[140:155]
  buffer_load_dwordx4 v10, s[44:47], s52 offen offset:2048 lds
  v_lshrrev_b32 v133, 3, v1
  v_lshl_or_b32 v124, v133, 11, v124
  s_lshl4_add_u32 s59, s3, s41
  s_lshl_b32 s59, s59, 15
  s_lshr_b32 s28, s41, 3
  v_mfma_f32_32x32x16_bf16 v[104:119], v[156:159], v[160:163], v[104:119]
  buffer_load_dwordx4 v11, s[44:47], s52 offen offset:3072 lds
  s_add_u32 s52, s52, 128
  s_and_b32 s52, s52, 0x7ff
  s_lshl_b32 s28, s28, 10
  s_add_u32 s59, s59, s28
  v_add_u32 v124, s59, v124
  v_xor_b32 v126, 262144, v124
  v_xor_b32 v125, 64, v124
  v_xor_b32 v127, 64, v126
  s_waitcnt vmcnt(32) lgkmcnt(0)
  s_barrier
  v_mfma_f32_32x32x16_bf16 v[40:55], v[168:171], v[176:179], v[40:55]
  ds_read_b128 v[120:123], v16 offset:32768
  ds_read_b128 v[160:163], v20 offset:32768
  v_add_u32 v125, 15360, v125
  v_add_u32 v127, 15360, v127
  s_and_b32 s28, s40, 7
  s_lshl_b32 s28, s28, 7
  s_lshl_b32 s43, s3, 12
  v_mfma_f32_32x32x16_bf16 v[88:103], v[168:171], v[180:183], v[88:103]
  ds_read_b128 v[156:159], v16 offset:36864
  ds_read_b128 v[164:167], v20 offset:36864
  v_lshrrev_b32 v132, 1, v2
  v_xor_b32 v132, v132, v3
  v_lshlrev_b32 v132, 4, v132
  v_lshl_or_b32 v132, v2, 7, v132
  v_add_u32 v128, s43, v132
  v_xor_b32 v129, 64, v128
  v_mfma_f32_32x32x16_bf16 v[140:155], v[172:175], v[180:183], v[140:155]
  s_add_u32 m0, s55, 16384
  s_nop 0
  buffer_load_dwordx4 v12, s[48:51], s52 offen offset:0 lds
  v_add_u32 v130, 0x10000, v128
  v_add_u32 v131, 0x10000, v129
  s_mov_b32 s20, s6
  s_mov_b32 s21, s7
  s_mov_b32 s22, 2101248
  v_mfma_f32_32x32x16_bf16 v[104:119], v[172:175], v[176:179], v[104:119]
  buffer_load_dwordx4 v13, s[48:51], s52 offen offset:1024 lds
  s_mov_b32 s23, 0x20000
  s_sub_u32 s76, s8, 1024
  s_subb_u32 s77, s9, 0
  s_mov_b32 s78, 2102272
  s_mov_b32 s79, 0x20000
  s_waitcnt lgkmcnt(2)
  v_mfma_f32_32x32x16_bf16 v[40:55], v[120:123], v[160:163], v[40:55]
  ds_read_b128 v[168:171], v17 offset:32768
  ds_read_b128 v[176:179], v21 offset:32768
  s_waitcnt lgkmcnt(2)
  v_mfma_f32_32x32x16_bf16 v[88:103], v[120:123], v[164:167], v[88:103]
  ds_read_b128 v[172:175], v17 offset:36864
  ds_read_b128 v[180:183], v21 offset:36864
  v_mfma_f32_32x32x16_bf16 v[140:155], v[156:159], v[164:167], v[140:155]
  buffer_load_dwordx4 v14, s[48:51], s52 offen offset:2048 lds
  v_mfma_f32_32x32x16_bf16 v[104:119], v[156:159], v[160:163], v[104:119]
  buffer_load_dwordx4 v15, s[48:51], s52 offen offset:3072 lds
  s_waitcnt lgkmcnt(2)
  v_mfma_f32_32x32x16_bf16 v[40:55], v[168:171], v[176:179], v[40:55]
  ds_read_b128 v[120:123], v18 offset:32768
  ds_read_b128 v[160:163], v22 offset:32768
  s_waitcnt lgkmcnt(2)
  v_mfma_f32_32x32x16_bf16 v[88:103], v[168:171], v[180:183], v[88:103]
  ds_read_b128 v[156:159], v18 offset:36864
  ds_read_b128 v[164:167], v22 offset:36864
  v_mfma_f32_32x32x16_bf16 v[140:155], v[172:175], v[180:183], v[140:155]
  s_add_u32 m0, s54, 16384
  s_nop 0
  buffer_load_dwordx4 v8, s[44:47], s52 offen offset:0 lds
  v_mfma_f32_32x32x16_bf16 v[104:119], v[172:175], v[176:179], v[104:119]
  buffer_load_dwordx4 v9, s[44:47], s52 offen offset:1024 lds
  s_waitcnt lgkmcnt(2)
  v_mfma_f32_32x32x16_bf16 v[40:55], v[120:123], v[160:163], v[40:55]
  ds_read_b128 v[168:171], v19 offset:32768
  ds_read_b128 v[176:179], v23 offset:32768
  s_waitcnt lgkmcnt(2)
  v_mfma_f32_32x32x16_bf16 v[88:103], v[120:123], v[164:167], v[88:103]
  ds_read_b128 v[172:175], v19 offset:36864
  ds_read_b128 v[180:183], v23 offset:36864
  v_mfma_f32_32x32x16_bf16 v[140:155], v[156:159], v[164:167], v[140:155]
  buffer_load_dwordx4 v10, s[44:47], s52 offen offset:2048 lds
  v_mfma_f32_32x32x16_bf16 v[104:119], v[156:159], v[160:163], v[104:119]
  buffer_load_dwordx4 v11, s[44:47], s52 offen offset:3072 lds
  s_add_u32 s52, s52, 128
  s_and_b32 s52, s52, 0x7ff
  s_waitcnt vmcnt(32) lgkmcnt(0)
  s_barrier
  v_mfma_f32_32x32x16_bf16 v[40:55], v[168:171], v[176:179], v[40:55]
  ds_read_b128 v[120:123], v16 offset:49152
  ds_read_b128 v[160:163], v20 offset:49152
  v_mfma_f32_32x32x16_bf16 v[88:103], v[168:171], v[180:183], v[88:103]
  ds_read_b128 v[156:159], v16 offset:53248
  ds_read_b128 v[164:167], v20 offset:53248
  v_mfma_f32_32x32x16_bf16 v[140:155], v[172:175], v[180:183], v[140:155]
  s_add_u32 m0, s55, 32768
  s_nop 0
  buffer_load_dwordx4 v12, s[48:51], s52 offen offset:0 lds
  v_mfma_f32_32x32x16_bf16 v[104:119], v[172:175], v[176:179], v[104:119]
  buffer_load_dwordx4 v13, s[48:51], s52 offen offset:1024 lds
  s_waitcnt lgkmcnt(2)
  v_mfma_f32_32x32x16_bf16 v[40:55], v[120:123], v[160:163], v[40:55]
  ds_read_b128 v[168:171], v17 offset:49152
  ds_read_b128 v[176:179], v21 offset:49152
  s_add_u32 s80, s34, 19922944
  s_addc_u32 s81, s35, 0
  s_waitcnt lgkmcnt(2)
  v_mfma_f32_32x32x16_bf16 v[88:103], v[120:123], v[164:167], v[88:103]
  ds_read_b128 v[172:175], v17 offset:53248
  ds_read_b128 v[180:183], v21 offset:53248
  s_mov_b32 s82, 32768
  s_mov_b32 s83, 0x20000
  v_mfma_f32_32x32x16_bf16 v[140:155], v[156:159], v[164:167], v[140:155]
  buffer_load_dwordx4 v14, s[48:51], s52 offen offset:2048 lds
  v_mov_b32 v132, 0
  v_mfma_f32_32x32x16_bf16 v[104:119], v[156:159], v[160:163], v[104:119]
  buffer_load_dwordx4 v15, s[48:51], s52 offen offset:3072 lds
  v_mov_b32 v133, 0
  v_dot2c_f32_bf16 v132, v64, v80
  s_waitcnt lgkmcnt(2)
  v_mfma_f32_32x32x16_bf16 v[40:55], v[168:171], v[176:179], v[40:55]
  ds_read_b128 v[120:123], v18 offset:49152
  ds_read_b128 v[160:163], v22 offset:49152
  v_dot2c_f32_bf16 v133, v72, v80
  s_waitcnt lgkmcnt(2)
  v_mfma_f32_32x32x16_bf16 v[88:103], v[168:171], v[180:183], v[88:103]
  ds_read_b128 v[156:159], v18 offset:53248
  ds_read_b128 v[164:167], v22 offset:53248
  v_dot2c_f32_bf16 v132, v65, v81
  v_dot2c_f32_bf16 v133, v73, v81
  v_mfma_f32_32x32x16_bf16 v[140:155], v[172:175], v[180:183], v[140:155]
  s_add_u32 m0, s54, 32768
  s_nop 0
  buffer_load_dwordx4 v8, s[44:47], s52 offen offset:0 lds
  v_dot2c_f32_bf16 v132, v66, v82
  v_dot2c_f32_bf16 v133, v74, v82
  v_mfma_f32_32x32x16_bf16 v[104:119], v[172:175], v[176:179], v[104:119]
  buffer_load_dwordx4 v9, s[44:47], s52 offen offset:1024 lds
  v_dot2c_f32_bf16 v132, v67, v83
  s_waitcnt lgkmcnt(2)
  v_mfma_f32_32x32x16_bf16 v[40:55], v[120:123], v[160:163], v[40:55]
  ds_read_b128 v[168:171], v19 offset:49152
  ds_read_b128 v[176:179], v23 offset:49152
  v_dot2c_f32_bf16 v133, v75, v83
  v_dot2c_f32_bf16 v132, v68, v84
  s_waitcnt lgkmcnt(2)
  v_mfma_f32_32x32x16_bf16 v[88:103], v[120:123], v[164:167], v[88:103]
  ds_read_b128 v[172:175], v19 offset:53248
  ds_read_b128 v[180:183], v23 offset:53248
  v_dot2c_f32_bf16 v133, v76, v84
  v_mfma_f32_32x32x16_bf16 v[140:155], v[156:159], v[164:167], v[140:155]
  buffer_load_dwordx4 v10, s[44:47], s52 offen offset:2048 lds
  v_dot2c_f32_bf16 v132, v69, v85
  v_dot2c_f32_bf16 v133, v77, v85
  v_mfma_f32_32x32x16_bf16 v[104:119], v[156:159], v[160:163], v[104:119]
  buffer_load_dwordx4 v11, s[44:47], s52 offen offset:3072 lds
  s_add_u32 s52, s52, 128
  s_and_b32 s52, s52, 0x7ff
  v_dot2c_f32_bf16 v132, v70, v86
  v_dot2c_f32_bf16 v133, v78, v86
  s_waitcnt vmcnt(16) lgkmcnt(0)
  s_barrier
  v_mfma_f32_32x32x16_bf16 v[40:55], v[168:171], v[176:179], v[40:55]
  ds_read_b128 v[120:123], v16 offset:0
  ds_read_b128 v[160:163], v20 offset:0
  v_dot2c_f32_bf16 v132, v71, v87
  v_mfma_f32_32x32x16_bf16 v[88:103], v[168:171], v[180:183], v[88:103]
  ds_read_b128 v[156:159], v16 offset:4096
  ds_read_b128 v[164:167], v20 offset:4096
  v_dot2c_f32_bf16 v133, v79, v87
  s_lshl_b32 s59, s39, 11
  v_mfma_f32_32x32x16_bf16 v[140:155], v[172:175], v[180:183], v[140:155]
  s_add_u32 m0, s55, 49152
  s_nop 0
  buffer_load_dwordx4 v12, s[48:51], s52 offen offset:0 lds
  s_lshl_b32 s6, s38, 7
  v_mfma_f32_32x32x16_bf16 v[104:119], v[172:175], v[176:179], v[104:119]
  buffer_load_dwordx4 v13, s[48:51], s52 offen offset:1024 lds
  s_add_u32 s59, s59, s6
  v_permlane32_swap_b32 v132, v133
  s_waitcnt lgkmcnt(2)
  v_mfma_f32_32x32x16_bf16 v[40:55], v[120:123], v[160:163], v[40:55]
  ds_read_b128 v[168:171], v17 offset:0
  ds_read_b128 v[176:179], v21 offset:0
  v_add_f32 v132, v132, v133
  v_mov_b32 v133, v132
  s_waitcnt lgkmcnt(2)
  v_mfma_f32_32x32x16_bf16 v[88:103], v[120:123], v[164:167], v[88:103]
  ds_read_b128 v[172:175], v17 offset:4096
  ds_read_b128 v[180:183], v21 offset:4096
  s_lshl_b32 s6, s3, 3
  v_mfma_f32_32x32x16_bf16 v[140:155], v[156:159], v[164:167], v[140:155]
  buffer_load_dwordx4 v14, s[48:51], s52 offen offset:2048 lds
  s_add_u32 s59, s59, s6
  v_permlane16_swap_b32 v132, v133
  v_mfma_f32_32x32x16_bf16 v[104:119], v[156:159], v[160:163], v[104:119]
  buffer_load_dwordx4 v15, s[48:51], s52 offen offset:3072 lds
  v_add_f32 v132, v132, v133
  s_waitcnt lgkmcnt(2)
  v_mfma_f32_32x32x16_bf16 v[40:55], v[168:171], v[176:179], v[40:55]
  ds_read_b128 v[120:123], v18 offset:0
  ds_read_b128 v[160:163], v22 offset:0
  v_add_f32 v132, v132, v132 row_ror:8 row_mask:0xf bank_mask:0xf
  s_nop 1
  v_add_f32 v132, v132, v132 row_ror:4 row_mask:0xf bank_mask:0xf
  s_waitcnt lgkmcnt(2)
  v_mfma_f32_32x32x16_bf16 v[88:103], v[168:171], v[180:183], v[88:103]
  ds_read_b128 v[156:159], v18 offset:4096
  ds_read_b128 v[164:167], v22 offset:4096
  v_add_f32 v132, v132, v132 row_ror:2 row_mask:0xf bank_mask:0xf
  s_nop 1
  v_add_f32 v132, v132, v132 row_ror:1 row_mask:0xf bank_mask:0xf
  v_mfma_f32_32x32x16_bf16 v[140:155], v[172:175], v[180:183], v[140:155]
  s_add_u32 m0, s54, 49152
  s_nop 0
  buffer_load_dwordx4 v8, s[44:47], s52 offen offset:0 lds
  v_cvt_pk_bf16_f32 v132, v132, v132
  v_mfma_f32_32x32x16_bf16 v[104:119], v[172:175], v[176:179], v[104:119]
  buffer_load_dwordx4 v9, s[44:47], s52 offen offset:1024 lds
  v_and_b32 v132, 0xffff0000, v132
  v_mul_f32 v132, 0xbfb8aa3b, v132
  s_waitcnt lgkmcnt(2)
  v_mfma_f32_32x32x16_bf16 v[40:55], v[120:123], v[160:163], v[40:55]
  ds_read_b128 v[168:171], v19 offset:0
  ds_read_b128 v[176:179], v23 offset:0
  v_exp_f32 v132, v132
  s_waitcnt lgkmcnt(2)
  v_mfma_f32_32x32x16_bf16 v[88:103], v[120:123], v[164:167], v[88:103]
  ds_read_b128 v[172:175], v19 offset:4096
  ds_read_b128 v[180:183], v23 offset:4096
  v_lshrrev_b32 v134, 3, v1
  v_add_f32 v132, 1.0, v132
  v_mfma_f32_32x32x16_bf16 v[140:155], v[156:159], v[164:167], v[140:155]
  buffer_load_dwordx4 v10, s[44:47], s52 offen offset:2048 lds
  v_rcp_f32 v132, v132
  s_mov_b32 exec_lo, 1
  s_mov_b32 exec_hi, 1
  v_cvt_pk_bf16_f32 v132, v132, v132
  v_and_b32 v132, 0xffff0000, v132
  s_add_u32 s6, s6, 131072
  v_add_u32 v134, s6, v134
  ds_write_b32 v134, v132
  s_mov_b64 exec, -1
  v_mfma_f32_32x32x16_bf16 v[104:119], v[156:159], v[160:163], v[104:119]
  buffer_load_dwordx4 v11, s[44:47], s52 offen offset:3072 lds
  s_add_u32 s52, s52, 128
  s_and_b32 s52, s52, 0x7ff
  s_waitcnt vmcnt(16) lgkmcnt(1)
  s_barrier
  v_mfma_f32_32x32x16_bf16 v[40:55], v[168:171], v[176:179], v[40:55]
  ds_read_b128 v[120:123], v16 offset:16384
  ds_read_b128 v[160:163], v20 offset:16384
  v_mfma_f32_32x32x16_bf16 v[88:103], v[168:171], v[180:183], v[88:103]
  ds_read_b128 v[156:159], v16 offset:20480
  ds_read_b128 v[164:167], v20 offset:20480
  s_cmp_lg_u32 s3, 1
  s_cbranch_scc1 gated_mix__spectral_gfnet__ssm_conv_s5__prompt_kernel_skip15
  s_getpc_b64 s[90:91]
gated_mix__spectral_gfnet__ssm_conv_s5__prompt_kernel_pc14:
  s_lshr_b32 s29, s2, 3
  s_mul_i32 s29, s29, 512
  v_min_u32 v210, 3, v1
  v_lshl_add_u32 v210, v210, 7, s29
  v_min_u32 v210, gated_mix__spectral_gfnet__ssm_conv_s5__prompt_kernel_end-gated_mix__spectral_gfnet__ssm_conv_s5__prompt_kernel_pc14, v210
  v_mov_b32 v211, 0
  v_lshl_add_u64 v[210:211], v[210:211], 0, s[90:91]
  global_load_dword v4, v[210:211], off
gated_mix__spectral_gfnet__ssm_conv_s5__prompt_kernel_skip15:
  v_mfma_f32_32x32x16_bf16 v[140:155], v[172:175], v[180:183], v[140:155]
  s_add_u32 m0, s55, 0
  s_nop 0
  buffer_load_dwordx4 v12, s[48:51], s52 offen offset:0 lds
  v_mfma_f32_32x32x16_bf16 v[104:119], v[172:175], v[176:179], v[104:119]
  buffer_load_dwordx4 v13, s[48:51], s52 offen offset:1024 lds
  s_waitcnt lgkmcnt(2)
  v_mfma_f32_32x32x16_bf16 v[40:55], v[120:123], v[160:163], v[40:55]
  ds_read_b128 v[168:171], v17 offset:16384
  ds_read_b128 v[176:179], v21 offset:16384
  v_lshlrev_b32 v64, 4, v1
  v_add_u32 v64, 147456, v64
  s_waitcnt lgkmcnt(2)
  v_mfma_f32_32x32x16_bf16 v[88:103], v[120:123], v[164:167], v[88:103]
  ds_read_b128 v[172:175], v17 offset:20480
  ds_read_b128 v[180:183], v21 offset:20480
  ds_read_b128 v[68:71], v64 offset:0
  v_mfma_f32_32x32x16_bf16 v[140:155], v[156:159], v[164:167], v[140:155]
  buffer_load_dwordx4 v14, s[48:51], s52 offen offset:2048 lds
  ds_read_b128 v[72:75], v64 offset:1024
  v_mfma_f32_32x32x16_bf16 v[104:119], v[156:159], v[160:163], v[104:119]
  buffer_load_dwordx4 v15, s[48:51], s52 offen offset:3072 lds
  ds_read_b128 a[224:227], v64 offset:2048
  s_waitcnt lgkmcnt(5)
  v_mfma_f32_32x32x16_bf16 v[40:55], v[168:171], v[176:179], v[40:55]
  ds_read_b128 v[120:123], v18 offset:16384
  ds_read_b128 v[160:163], v22 offset:16384
  ds_read_b128 a[228:231], v64 offset:3072
  s_waitcnt lgkmcnt(6)
  v_mfma_f32_32x32x16_bf16 v[88:103], v[168:171], v[180:183], v[88:103]
  ds_read_b128 v[156:159], v18 offset:20480
  ds_read_b128 v[164:167], v22 offset:20480
  ds_read_b128 a[248:251], v64 offset:4096
  v_mfma_f32_32x32x16_bf16 v[140:155], v[172:175], v[180:183], v[140:155]
  s_add_u32 m0, s54, 0
  s_nop 0
  buffer_load_dwordx4 v8, s[44:47], s52 offen offset:0 lds
  ds_read_b128 a[252:255], v64 offset:5120
  v_mfma_f32_32x32x16_bf16 v[104:119], v[172:175], v[176:179], v[104:119]
  buffer_load_dwordx4 v9, s[44:47], s52 offen offset:1024 lds
  ds_read_b128 a[232:235], v64 offset:6144
  s_waitcnt lgkmcnt(6)
  v_mfma_f32_32x32x16_bf16 v[40:55], v[120:123], v[160:163], v[40:55]
  ds_read_b128 v[168:171], v19 offset:16384
  ds_read_b128 v[176:179], v23 offset:16384
  ds_read_b128 a[236:239], v64 offset:7168
  s_waitcnt lgkmcnt(6)
  v_mfma_f32_32x32x16_bf16 v[88:103], v[120:123], v[164:167], v[88:103]
  ds_read_b128 v[172:175], v19 offset:20480
  ds_read_b128 v[180:183], v23 offset:20480
  ds_read_b128 v[76:79], v64 offset:8192
  v_mfma_f32_32x32x16_bf16 v[140:155], v[156:159], v[164:167], v[140:155]
  buffer_load_dwordx4 v10, s[44:47], s52 offen offset:2048 lds
  ds_read_b128 v[80:83], v64 offset:9216
  v_mfma_f32_32x32x16_bf16 v[104:119], v[156:159], v[160:163], v[104:119]
  buffer_load_dwordx4 v11, s[44:47], s52 offen offset:3072 lds
  s_add_u32 s52, s52, 128
  s_and_b32 s52, s52, 0x7ff
  ds_read_b128 v[84:87], v64 offset:10240
  s_waitcnt vmcnt(16) lgkmcnt(3)
  s_barrier
  v_mfma_f32_32x32x16_bf16 v[40:55], v[168:171], v[176:179], v[40:55]
  ds_read_b128 v[120:123], v16 offset:32768
  ds_read_b128 v[160:163], v20 offset:32768
  ds_read_b128 v[132:135], v64 offset:11264
  v_mfma_f32_32x32x16_bf16 v[88:103], v[168:171], v[180:183], v[88:103]
  ds_read_b128 v[156:159], v16 offset:36864
  ds_read_b128 v[164:167], v20 offset:36864
  s_cmp_lg_u32 s3, 0
  s_cbranch_scc1 gated_mix__spectral_gfnet__ssm_conv_s5__prompt_kernel_skip16
  v_lshlrev_b32 v210, 2, v2
  v_add_u32 v211, 131072, v210
  ds_read_b32 v211, v211
  s_lshl_b32 s29, s39, 11
  s_lshl_b32 s58, s38, 7
  s_add_u32 s29, s29, s58
  s_mov_b64 exec, 0xffff
  s_waitcnt lgkmcnt(0)
  buffer_store_dword v211, v210, s[80:83], s29 offen sc1
  s_mov_b64 exec, -1
gated_mix__spectral_gfnet__ssm_conv_s5__prompt_kernel_skip16:
  buffer_load_dword v208, v6, s[24:27], 0 offen sc1
  ds_read_b128 a[240:243], v64 offset:12288
  v_mfma_f32_32x32x16_bf16 v[140:155], v[172:175], v[180:183], v[140:155]
  s_add_u32 m0, s55, 16384
  s_nop 0
  buffer_load_dwordx4 v12, s[48:51], s52 offen offset:0 lds
  ds_read_b128 a[244:247], v64 offset:13312
  v_mfma_f32_32x32x16_bf16 v[104:119], v[172:175], v[176:179], v[104:119]
  buffer_load_dwordx4 v13, s[48:51], s52 offen offset:1024 lds
  ds_read_b128 v[136:139], v64 offset:14336
  s_waitcnt lgkmcnt(6)
  v_mfma_f32_32x32x16_bf16 v[40:55], v[120:123], v[160:163], v[40:55]
  ds_read_b128 v[168:171], v17 offset:32768
  ds_read_b128 v[176:179], v21 offset:32768
  ds_read_b128 v[184:187], v64 offset:15360
  s_lshl_b32 s59, s3, 9
  s_waitcnt lgkmcnt(6)
  v_mfma_f32_32x32x16_bf16 v[88:103], v[120:123], v[164:167], v[88:103]
  ds_read_b128 v[172:175], v17 offset:36864
  ds_read_b128 v[180:183], v21 offset:36864
  s_add_u32 s59, s59, s5
  v_mfma_f32_32x32x16_bf16 v[140:155], v[156:159], v[164:167], v[140:155]
  buffer_load_dwordx4 v14, s[48:51], s52 offen offset:2048 lds
  s_lshr_b32 s87, s3, 1
  v_mfma_f32_32x32x16_bf16 v[104:119], v[156:159], v[160:163], v[104:119]
  buffer_load_dwordx4 v15, s[48:51], s52 offen offset:3072 lds
  s_and_b32 s87, s87, s10
  s_waitcnt lgkmcnt(3)
  v_mfma_f32_32x32x16_bf16 v[40:55], v[168:171], v[176:179], v[40:55]
  ds_read_b128 v[120:123], v18 offset:32768
  ds_read_b128 v[160:163], v22 offset:32768
  s_mul_i32 s87, s87, 960
  s_waitcnt lgkmcnt(2)
  v_mfma_f32_32x32x16_bf16 v[88:103], v[168:171], v[180:183], v[88:103]
  ds_read_b128 v[156:159], v18 offset:36864
  ds_read_b128 v[164:167], v22 offset:36864
  s_sub_u32 s87, s59, s87
  v_mfma_f32_32x32x16_bf16 v[140:155], v[172:175], v[180:183], v[140:155]
  s_add_u32 m0, s54, 16384
  s_nop 0
  buffer_load_dwordx4 v8, s[44:47], s52 offen offset:0 lds
  s_mul_i32 s59, s87, 1026
  v_mfma_f32_32x32x16_bf16 v[104:119], v[172:175], v[176:179], v[104:119]
  buffer_load_dwordx4 v9, s[44:47], s52 offen offset:1024 lds
  s_lshl1_add_u32 s59, s4, s59
  s_waitcnt lgkmcnt(2)
  v_mfma_f32_32x32x16_bf16 v[40:55], v[120:123], v[160:163], v[40:55]
  ds_read_b128 v[168:171], v19 offset:32768
  ds_read_b128 v[176:179], v23 offset:32768
  s_sub_u32 s6, 2101256, s59
  s_waitcnt lgkmcnt(2)
  v_mfma_f32_32x32x16_bf16 v[88:103], v[120:123], v[164:167], v[88:103]
  ds_read_b128 v[172:175], v19 offset:36864
  ds_read_b128 v[180:183], v23 offset:36864
  s_and_b32 s88, s59, 2
  v_mfma_f32_32x32x16_bf16 v[140:155], v[156:159], v[164:167], v[140:155]
  buffer_load_dwordx4 v10, s[44:47], s52 offen offset:2048 lds
  s_and_b32 s59, s59, -4
  v_mfma_f32_32x32x16_bf16 v[104:119], v[156:159], v[160:163], v[104:119]
  buffer_load_dwordx4 v11, s[44:47], s52 offen offset:3072 lds
  s_add_u32 s52, s52, 128
  s_and_b32 s52, s52, 0x7ff
  s_and_b32 s6, s6, -4
  s_waitcnt vmcnt(17) lgkmcnt(0)
  s_barrier
  v_mfma_f32_32x32x16_bf16 v[40:55], v[168:171], v[176:179], v[40:55]
  ds_read_b128 v[120:123], v16 offset:49152
  ds_read_b128 v[160:163], v20 offset:49152
  s_add_u32 s7, s59, 131328
  v_mfma_f32_32x32x16_bf16 v[88:103], v[168:171], v[180:183], v[88:103]
  ds_read_b128 v[156:159], v16 offset:53248
  ds_read_b128 v[164:167], v20 offset:53248
  s_sub_u32 s8, s6, 131328
  v_mfma_f32_32x32x16_bf16 v[140:155], v[172:175], v[180:183], v[140:155]
  s_add_u32 m0, s55, 32768
  s_nop 0
  buffer_load_dwordx4 v12, s[48:51], s52 offen offset:0 lds
  s_add_u32 s9, s59, 262656
  v_mfma_f32_32x32x16_bf16 v[104:119], v[172:175], v[176:179], v[104:119]
  buffer_load_dwordx4 v13, s[48:51], s52 offen offset:1024 lds
  s_sub_u32 s32, s6, 262656
  s_waitcnt lgkmcnt(2)
  v_mfma_f32_32x32x16_bf16 v[40:55], v[120:123], v[160:163], v[40:55]
  ds_read_b128 v[168:171], v17 offset:49152
  ds_read_b128 v[176:179], v21 offset:49152
  s_add_u32 s33, s59, 393984
  s_sub_u32 s84, s6, 393984
  s_waitcnt lgkmcnt(2)
  v_mfma_f32_32x32x16_bf16 v[88:103], v[120:123], v[164:167], v[88:103]
  ds_read_b128 v[172:175], v17 offset:53248
  ds_read_b128 v[180:183], v21 offset:53248
  s_cmp_eq_u32 s87, 0
  s_cselect_b32 s87, 2101248, 0
  s_cselect_b32 s86, s10, 0
  v_mfma_f32_32x32x16_bf16 v[140:155], v[156:159], v[164:167], v[140:155]
  buffer_load_dwordx4 v14, s[48:51], s52 offen offset:2048 lds
  v_mfma_f32_32x32x16_bf16 v[104:119], v[156:159], v[160:163], v[104:119]
  buffer_load_dwordx4 v15, s[48:51], s52 offen offset:3072 lds
  s_waitcnt lgkmcnt(2)
  v_mfma_f32_32x32x16_bf16 v[40:55], v[168:171], v[176:179], v[40:55]
  ds_read_b128 v[120:123], v18 offset:49152
  ds_read_b128 v[160:163], v22 offset:49152
  s_sub_u32 s6, s6, s87
  s_waitcnt lgkmcnt(2)
  v_mfma_f32_32x32x16_bf16 v[88:103], v[168:171], v[180:183], v[88:103]
  ds_read_b128 v[156:159], v18 offset:53248
  ds_read_b128 v[164:167], v22 offset:53248
  s_lshl_b32 s85, s3, 12
  v_mfma_f32_32x32x16_bf16 v[140:155], v[172:175], v[180:183], v[140:155]
  s_add_u32 m0, s54, 32768
  s_nop 0
  buffer_load_dwordx4 v8, s[44:47], s52 offen offset:0 lds
  s_add_u32 s88, s88, s85
  v_mfma_f32_32x32x16_bf16 v[104:119], v[172:175], v[176:179], v[104:119]
  buffer_load_dwordx4 v9, s[44:47], s52 offen offset:1024 lds
  v_lshlrev_b32 v64, 4, v1
  s_waitcnt lgkmcnt(2)
  v_mfma_f32_32x32x16_bf16 v[40:55], v[120:123], v[160:163], v[40:55]
  ds_read_b128 v[168:171], v19 offset:49152
  ds_read_b128 v[176:179], v23 offset:49152
  v_lshlrev_b32 v65, 9, v3
  s_waitcnt lgkmcnt(2)
  v_mfma_f32_32x32x16_bf16 v[88:103], v[120:123], v[164:167], v[88:103]
  ds_read_b128 v[172:175], v19 offset:53248
  ds_read_b128 v[180:183], v23 offset:53248
  v_lshl_add_u32 v65, v2, 3, v65
  v_mfma_f32_32x32x16_bf16 v[140:155], v[156:159], v[164:167], v[140:155]
  buffer_load_dwordx4 v10, s[44:47], s52 offen offset:2048 lds
  v_sub_u32 v67, 3704, v65
  v_mfma_f32_32x32x16_bf16 v[104:119], v[156:159], v[160:163], v[104:119]
  buffer_load_dwordx4 v11, s[44:47], s52 offen offset:3072 lds
  s_add_u32 s52, s52, 128
  s_and_b32 s52, s52, 0x7ff
  v_cmp_lt_u32 vcc, 1, v3
  s_waitcnt vmcnt(17) lgkmcnt(0)
  s_barrier
  v_mfma_f32_32x32x16_bf16 v[40:55], v[168:171], v[176:179], v[40:55]
  ds_read_b128 v[120:123], v16 offset:0
  ds_read_b128 v[160:163], v20 offset:0
  v_cndmask_b32 v65, v65, v67, vcc
  v_mfma_f32_32x32x16_bf16 v[88:103], v[168:171], v[180:183], v[88:103]
  ds_read_b128 v[156:159], v16 offset:4096
  ds_read_b128 v[164:167], v20 offset:4096
  v_cndmask_b32 v66, 1.0, -1.0, vcc
  v_mfma_f32_32x32x16_bf16 v[140:155], v[172:175], v[180:183], v[140:155]
  s_add_u32 m0, s55, 49152
  s_nop 0
  buffer_load_dwordx4 v12, s[48:51], s52 offen offset:0 lds
  v_add_u32 v65, s88, v65
  v_mfma_f32_32x32x16_bf16 v[104:119], v[172:175], v[176:179], v[104:119]
  buffer_load_dwordx4 v13, s[48:51], s52 offen offset:1024 lds
  v_mov_b32 v188, 1050624
  s_waitcnt lgkmcnt(2)
  v_mfma_f32_32x32x16_bf16 v[40:55], v[120:123], v[160:163], v[40:55]
  ds_read_b128 v[168:171], v17 offset:0
  ds_read_b128 v[176:179], v21 offset:0
  v_mov_b32 v189, 147456
  s_cmp_lg_u32 s4, 0
  s_cbranch_scc1 gated_mix__spectral_gfnet__ssm_conv_s5__prompt_kernel_skip13
  s_sub_u32 s87, s6, 8
  v_writelane_b32 v188, s87, 0
  v_writelane_b32 v188, s59, 1
  s_mov_b32 s87, 0
  v_writelane_b32 v189, s87, 0
  v_writelane_b32 v189, s87, 1
  s_sub_u32 s87, s8, 8
  v_writelane_b32 v188, s87, 2
  v_writelane_b32 v188, s7, 3
  s_mov_b32 s87, 16384
  v_writelane_b32 v189, s87, 2
  v_writelane_b32 v189, s87, 3
  s_sub_u32 s87, s32, 8
  v_writelane_b32 v188, s87, 4
  v_writelane_b32 v188, s9, 5
  s_mov_b32 s87, 81920
  v_writelane_b32 v189, s87, 4
  v_writelane_b32 v189, s87, 5
  s_sub_u32 s87, s84, 8
  v_writelane_b32 v188, s87, 6
  v_writelane_b32 v188, s33, 7
  s_mov_b32 s87, 32768
  v_writelane_b32 v189, s87, 6
  v_writelane_b32 v189, s87, 7
  v_and_b32 v67, 1, v1
  v_lshl_add_u32 v188, v67, 10, v188
  s_and_b32 s87, s88, 2
  v_add_u32 v188, s87, v188
  v_mul_u32_u24 v67, 3064, v67
  v_add3_u32 v189, v189, v67, s88
gated_mix__spectral_gfnet__ssm_conv_s5__prompt_kernel_skip13:
  s_waitcnt lgkmcnt(2)
  v_mfma_f32_32x32x16_bf16 v[88:103], v[120:123], v[164:167], v[88:103]
  ds_read_b128 v[172:175], v17 offset:4096
  ds_read_b128 v[180:183], v21 offset:4096
  v_mfma_f32_32x32x16_bf16 v[140:155], v[156:159], v[164:167], v[140:155]
  buffer_load_dwordx4 v14, s[48:51], s52 offen offset:2048 lds
  v_mfma_f32_32x32x16_bf16 v[104:119], v[156:159], v[160:163], v[104:119]
  buffer_load_dwordx4 v15, s[48:51], s52 offen offset:3072 lds
  s_waitcnt lgkmcnt(2)
  v_mfma_f32_32x32x16_bf16 v[40:55], v[168:171], v[176:179], v[40:55]
  ds_read_b128 v[120:123], v18 offset:0
  ds_read_b128 v[160:163], v22 offset:0
  s_waitcnt lgkmcnt(2)
  v_mfma_f32_32x32x16_bf16 v[88:103], v[168:171], v[180:183], v[88:103]
  ds_read_b128 v[156:159], v18 offset:4096
  ds_read_b128 v[164:167], v22 offset:4096
  v_mfma_f32_32x32x16_bf16 v[140:155], v[172:175], v[180:183], v[140:155]
  s_add_u32 m0, s54, 49152
  s_nop 0
  buffer_load_dwordx4 v8, s[44:47], s52 offen offset:0 lds
  v_mfma_f32_32x32x16_bf16 v[104:119], v[172:175], v[176:179], v[104:119]
  buffer_load_dwordx4 v9, s[44:47], s52 offen offset:1024 lds
  s_waitcnt lgkmcnt(2)
  v_mfma_f32_32x32x16_bf16 v[40:55], v[120:123], v[160:163], v[40:55]
  ds_read_b128 v[168:171], v19 offset:0
  ds_read_b128 v[176:179], v23 offset:0
  s_waitcnt lgkmcnt(2)
  v_mfma_f32_32x32x16_bf16 v[88:103], v[120:123], v[164:167], v[88:103]
  ds_read_b128 v[172:175], v19 offset:4096
  ds_read_b128 v[180:183], v23 offset:4096
  v_mfma_f32_32x32x16_bf16 v[140:155], v[156:159], v[164:167], v[140:155]
  buffer_load_dwordx4 v10, s[44:47], s52 offen offset:2048 lds
  v_mfma_f32_32x32x16_bf16 v[104:119], v[156:159], v[160:163], v[104:119]
  buffer_load_dwordx4 v11, s[44:47], s52 offen offset:3072 lds
  s_add_u32 s52, s52, 128
  s_and_b32 s52, s52, 0x7ff
  s_waitcnt vmcnt(25)
  s_waitcnt vmcnt(16) lgkmcnt(0)
  s_barrier
  v_mfma_f32_32x32x16_bf16 v[40:55], v[168:171], v[176:179], v[40:55]
  ds_read_b128 v[120:123], v16 offset:16384
  ds_read_b128 v[160:163], v20 offset:16384
  v_mfma_f32_32x32x16_bf16 v[88:103], v[168:171], v[180:183], v[88:103]
  ds_read_b128 v[156:159], v16 offset:20480
  ds_read_b128 v[164:167], v20 offset:20480
  v_cmp_ne_u32 vcc, 1, v208
  s_nop 0
  s_cbranch_vccz gated_mix__spectral_gfnet__ssm_conv_s5__prompt_kernel_skip17
  s_mov_b32 s29, 0
gated_mix__spectral_gfnet__ssm_conv_s5__prompt_kernel_poll18:
  s_sleep 16
  buffer_load_dword v208, v6, s[24:27], 0 offen sc1
  s_waitcnt vmcnt(0)
  v_cmp_ne_u32 vcc, 1, v208
  s_nop 0
  s_cbranch_vccz gated_mix__spectral_gfnet__ssm_conv_s5__prompt_kernel_pollout19
  s_add_u32 s29, s29, 1
  s_cmp_lt_u32 s29, 1048576
  s_cbranch_scc1 gated_mix__spectral_gfnet__ssm_conv_s5__prompt_kernel_poll18
gated_mix__spectral_gfnet__ssm_conv_s5__prompt_kernel_pollout19:
gated_mix__spectral_gfnet__ssm_conv_s5__prompt_kernel_skip17:
  s_cmp_lg_u32 s3, 0
  s_cbranch_scc1 gated_mix__spectral_gfnet__ssm_conv_s5__prompt_kernel_skip20
  s_mov_b64 exec, 1
  buffer_store_dword v5, v38, s[16:19], 0 offen sc1
  s_mov_b64 exec, -1
gated_mix__spectral_gfnet__ssm_conv_s5__prompt_kernel_skip20:
  v_mfma_f32_32x32x16_bf16 v[140:155], v[172:175], v[180:183], v[140:155]
  s_add_u32 m0, s55, 0
  s_nop 0
  buffer_load_dwordx4 v12, s[48:51], s52 offen offset:0 lds
  v_mfma_f32_32x32x16_bf16 v[104:119], v[172:175], v[176:179], v[104:119]
  buffer_load_dwordx4 v13, s[48:51], s52 offen offset:1024 lds
  s_waitcnt lgkmcnt(2)
  v_mfma_f32_32x32x16_bf16 v[40:55], v[120:123], v[160:163], v[40:55]
  ds_read_b128 v[168:171], v17 offset:16384
  ds_read_b128 v[176:179], v21 offset:16384
  s_waitcnt lgkmcnt(2)
  v_mfma_f32_32x32x16_bf16 v[88:103], v[120:123], v[164:167], v[88:103]
  ds_read_b128 v[172:175], v17 offset:20480
  ds_read_b128 v[180:183], v21 offset:20480
  v_mfma_f32_32x32x16_bf16 v[140:155], v[156:159], v[164:167], v[140:155]
  buffer_load_dwordx4 v14, s[48:51], s52 offen offset:2048 lds
  v_mfma_f32_32x32x16_bf16 v[104:119], v[156:159], v[160:163], v[104:119]
  buffer_load_dwordx4 v15, s[48:51], s52 offen offset:3072 lds
  s_waitcnt lgkmcnt(2)
  v_mfma_f32_32x32x16_bf16 v[40:55], v[168:171], v[176:179], v[40:55]
  ds_read_b128 v[120:123], v18 offset:16384
  ds_read_b128 v[160:163], v22 offset:16384
  s_waitcnt lgkmcnt(2)
  v_mfma_f32_32x32x16_bf16 v[88:103], v[168:171], v[180:183], v[88:103]
  ds_read_b128 v[156:159], v18 offset:20480
  ds_read_b128 v[164:167], v22 offset:20480
  v_mfma_f32_32x32x16_bf16 v[140:155], v[172:175], v[180:183], v[140:155]
  s_add_u32 m0, s54, 0
  s_nop 0
  buffer_load_dwordx4 v8, s[44:47], s52 offen offset:0 lds
  v_mfma_f32_32x32x16_bf16 v[104:119], v[172:175], v[176:179], v[104:119]
  buffer_load_dwordx4 v9, s[44:47], s52 offen offset:1024 lds
  s_waitcnt lgkmcnt(2)
  v_mfma_f32_32x32x16_bf16 v[40:55], v[120:123], v[160:163], v[40:55]
  ds_read_b128 v[168:171], v19 offset:16384
  ds_read_b128 v[176:179], v23 offset:16384
  s_waitcnt lgkmcnt(2)
  v_mfma_f32_32x32x16_bf16 v[88:103], v[120:123], v[164:167], v[88:103]
  ds_read_b128 v[172:175], v19 offset:20480
  ds_read_b128 v[180:183], v23 offset:20480
  v_mfma_f32_32x32x16_bf16 v[140:155], v[156:159], v[164:167], v[140:155]
  buffer_load_dwordx4 v10, s[44:47], s52 offen offset:2048 lds
  v_mfma_f32_32x32x16_bf16 v[104:119], v[156:159], v[160:163], v[104:119]
  buffer_load_dwordx4 v11, s[44:47], s52 offen offset:3072 lds
  s_add_u32 s52, s52, 128
  s_and_b32 s52, s52, 0x7ff
  s_waitcnt vmcnt(16) lgkmcnt(0)
  s_barrier
  v_mfma_f32_32x32x16_bf16 v[40:55], v[168:171], v[176:179], v[40:55]
  ds_read_b128 v[120:123], v16 offset:32768
  ds_read_b128 v[160:163], v20 offset:32768
  v_mfma_f32_32x32x16_bf16 v[88:103], v[168:171], v[180:183], v[88:103]
  ds_read_b128 v[156:159], v16 offset:36864
  ds_read_b128 v[164:167], v20 offset:36864
  v_mfma_f32_32x32x16_bf16 v[140:155], v[172:175], v[180:183], v[140:155]
  s_add_u32 m0, s55, 16384
  s_nop 0
  buffer_load_dwordx4 v12, s[48:51], s52 offen offset:0 lds
  v_mfma_f32_32x32x16_bf16 v[104:119], v[172:175], v[176:179], v[104:119]
  buffer_load_dwordx4 v13, s[48:51], s52 offen offset:1024 lds
  s_waitcnt lgkmcnt(2)
  v_mfma_f32_32x32x16_bf16 v[40:55], v[120:123], v[160:163], v[40:55]
  ds_read_b128 v[168:171], v17 offset:32768
  ds_read_b128 v[176:179], v21 offset:32768
  v_lshlrev_b32 v56, 16, v56
  v_lshlrev_b32 v57, 16, v57
  s_waitcnt lgkmcnt(2)
  v_mfma_f32_32x32x16_bf16 v[88:103], v[120:123], v[164:167], v[88:103]
  ds_read_b128 v[172:175], v17 offset:36864
  ds_read_b128 v[180:183], v21 offset:36864
  v_lshlrev_b32 v58, 16, v58
  v_mfma_f32_32x32x16_bf16 v[140:155], v[156:159], v[164:167], v[140:155]
  buffer_load_dwordx4 v14, s[48:51], s52 offen offset:2048 lds
  v_mul_f32 v58, 0x3fb8aa3b, v58
  v_mfma_f32_32x32x16_bf16 v[104:119], v[156:159], v[160:163], v[104:119]
  buffer_load_dwordx4 v15, s[48:51], s52 offen offset:3072 lds
  v_exp_f32 v58, v58
  s_waitcnt lgkmcnt(2)
  v_mfma_f32_32x32x16_bf16 v[40:55], v[168:171], v[176:179], v[40:55]
  ds_read_b128 v[120:123], v18 offset:32768
  ds_read_b128 v[160:163], v22 offset:32768
  v_cvt_pk_bf16_f32 v58, v58, v58
  s_waitcnt lgkmcnt(2)
  v_mfma_f32_32x32x16_bf16 v[88:103], v[168:171], v[180:183], v[88:103]
  ds_read_b128 v[156:159], v18 offset:36864
  ds_read_b128 v[164:167], v22 offset:36864
  v_and_b32 v58, 0xffff0000, v58
  v_mul_f32 v204, v58, v56
  v_mfma_f32_32x32x16_bf16 v[140:155], v[172:175], v[180:183], v[140:155]
  s_add_u32 m0, s54, 16384
  s_nop 0
  buffer_load_dwordx4 v8, s[44:47], s52 offen offset:0 lds
  v_mul_f32 v205, v58, v57
  v_mfma_f32_32x32x16_bf16 v[104:119], v[172:175], v[176:179], v[104:119]
  buffer_load_dwordx4 v9, s[44:47], s52 offen offset:1024 lds
  v_mul_f32 v204, 0x3fb8aa3b, v204
  s_waitcnt lgkmcnt(2)
  v_mfma_f32_32x32x16_bf16 v[40:55], v[120:123], v[160:163], v[40:55]
  ds_read_b128 v[168:171], v19 offset:32768
  ds_read_b128 v[176:179], v23 offset:32768
  v_mul_f32 v205, 0.15915494, v205
  s_waitcnt lgkmcnt(2)
  v_mfma_f32_32x32x16_bf16 v[88:103], v[120:123], v[164:167], v[88:103]
  ds_read_b128 v[172:175], v19 offset:36864
  ds_read_b128 v[180:183], v23 offset:36864
  v_exp_f32 v204, v204
  v_mfma_f32_32x32x16_bf16 v[140:155], v[156:159], v[164:167], v[140:155]
  buffer_load_dwordx4 v10, s[44:47], s52 offen offset:2048 lds
  v_rndne_f32 v206, v205
  v_sub_f32 v205, v205, v206
  v_mfma_f32_32x32x16_bf16 v[104:119], v[156:159], v[160:163], v[104:119]
  buffer_load_dwordx4 v11, s[44:47], s52 offen offset:3072 lds
  s_add_u32 s52, s52, 128
  s_and_b32 s52, s52, 0x7ff
  v_cos_f32 v206, v205
  s_waitcnt vmcnt(16) lgkmcnt(0)
  s_barrier
  v_mfma_f32_32x32x16_bf16 v[40:55], v[168:171], v[176:179], v[40:55]
  ds_read_b128 v[120:123], v16 offset:49152
  ds_read_b128 v[160:163], v20 offset:49152
  v_sin_f32 v207, v205
  v_mfma_f32_32x32x16_bf16 v[88:103], v[168:171], v[180:183], v[88:103]
  ds_read_b128 v[156:159], v16 offset:53248
  ds_read_b128 v[164:167], v20 offset:53248
  s_lshl_b32 s29, s36, 2
  s_add_u32 s29, s29, s3
  s_lshl_b32 s29, s29, 7
  s_add_u32 s29, s29, s37
  s_sub_u32 s58, 2048, s29
  s_and_b32 s58, s58, 2047
  s_mul_i32 s29, s29, 1026
  s_mul_i32 s58, s58, 1026
  s_sub_u32 s58, s58, s29
  v_and_b32 v208, 1, v3
  v_mul_lo_u32 v208, v208, s58
  v_lshl_add_u32 v59, v2, 7, s29
  v_add_u32 v59, v59, v208
  v_and_b32 v59, -4, v59
  s_mov_b64 exec, 0x01ff01ff
  buffer_load_dword v4, v59, s[20:23], 0 offen
  buffer_load_dword v4, v59, s[76:79], 0 offen offset:1024
  s_mov_b64 exec, -1
  v_mul_f32 v190, v204, v206
  v_mfma_f32_32x32x16_bf16 v[140:155], v[172:175], v[180:183], v[140:155]
  s_add_u32 m0, s55, 32768
  s_nop 0
  buffer_load_dwordx4 v12, s[48:51], s52 offen offset:0 lds
  v_mul_f32 v191, v204, v207
  v_mfma_f32_32x32x16_bf16 v[104:119], v[172:175], v[176:179], v[104:119]
  buffer_load_dwordx4 v13, s[48:51], s52 offen offset:1024 lds
  v_mul_f32 v204, v56, v56
  s_waitcnt lgkmcnt(2)
  v_mfma_f32_32x32x16_bf16 v[40:55], v[120:123], v[160:163], v[40:55]
  ds_read_b128 v[168:171], v17 offset:49152
  ds_read_b128 v[176:179], v21 offset:49152
  v_fma_f32 v204, v57, v57, v204
  v_rcp_f32 v204, v204
  s_waitcnt lgkmcnt(2)
  v_mfma_f32_32x32x16_bf16 v[88:103], v[120:123], v[164:167], v[88:103]
  ds_read_b128 v[172:175], v17 offset:53248
  ds_read_b128 v[180:183], v21 offset:53248
  v_add_f32 v205, -1.0, v190
  v_mfma_f32_32x32x16_bf16 v[140:155], v[156:159], v[164:167], v[140:155]
  buffer_load_dwordx4 v14, s[48:51], s52 offen offset:2048 lds
  v_add_f32 v204, v204, v204
  v_mfma_f32_32x32x16_bf16 v[104:119], v[156:159], v[160:163], v[104:119]
  buffer_load_dwordx4 v15, s[48:51], s52 offen offset:3072 lds
  v_mul_f32 v206, v205, v56
  s_waitcnt lgkmcnt(2)
  v_mfma_f32_32x32x16_bf16 v[40:55], v[168:171], v[176:179], v[40:55]
  ds_read_b128 v[120:123], v18 offset:49152
  ds_read_b128 v[160:163], v22 offset:49152
  v_fma_f32 v206, v191, v57, v206
  s_waitcnt lgkmcnt(2)
  v_mfma_f32_32x32x16_bf16 v[88:103], v[168:171], v[180:183], v[88:103]
  ds_read_b128 v[156:159], v18 offset:53248
  ds_read_b128 v[164:167], v22 offset:53248
  v_mul_f32 v207, v191, v56
  v_fma_f32 v207, -v205, v57, v207
  v_mfma_f32_32x32x16_bf16 v[140:155], v[172:175], v[180:183], v[140:155]
  s_add_u32 m0, s54, 32768
  s_nop 0
  buffer_load_dwordx4 v8, s[44:47], s52 offen offset:0 lds
  v_mul_f32 v200, v206, v204
  v_mfma_f32_32x32x16_bf16 v[104:119], v[172:175], v[176:179], v[104:119]
  buffer_load_dwordx4 v9, s[44:47], s52 offen offset:1024 lds
  v_mul_f32 v201, v207, v204
  s_waitcnt lgkmcnt(2)
  v_mfma_f32_32x32x16_bf16 v[40:55], v[120:123], v[160:163], v[40:55]
  ds_read_b128 v[168:171], v19 offset:49152
  ds_read_b128 v[176:179], v23 offset:49152
  v_mul_f32 v204, v191, v191
  s_waitcnt lgkmcnt(2)
  v_mfma_f32_32x32x16_bf16 v[88:103], v[120:123], v[164:167], v[88:103]
  ds_read_b128 v[172:175], v19 offset:53248
  ds_read_b128 v[180:183], v23 offset:53248
  v_mul_f32 v193, v190, v191
  v_mfma_f32_32x32x16_bf16 v[140:155], v[156:159], v[164:167], v[140:155]
  buffer_load_dwordx4 v10, s[44:47], s52 offen offset:2048 lds
  v_fma_f32 v192, v190, v190, -v204
  v_add_f32 v193, v193, v193
  v_mfma_f32_32x32x16_bf16 v[104:119], v[156:159], v[160:163], v[104:119]
  buffer_load_dwordx4 v11, s[44:47], s52 offen offset:3072 lds
  s_add_u32 s52, s52, 128
  s_and_b32 s52, s52, 0x7ff
  v_mul_f32 v204, v193, v193
  s_waitcnt vmcnt(18) lgkmcnt(0)
  s_barrier
  v_mfma_f32_32x32x16_bf16 v[40:55], v[168:171], v[176:179], v[40:55]
  ds_read_b128 v[120:123], v16 offset:0
  ds_read_b128 v[160:163], v20 offset:0
  v_mul_f32 v193, v192, v193
  v_mfma_f32_32x32x16_bf16 v[88:103], v[168:171], v[180:183], v[88:103]
  ds_read_b128 v[156:159], v16 offset:4096
  ds_read_b128 v[164:167], v20 offset:4096
  s_cmp_lg_u32 s3, 2
  s_cbranch_scc1 gated_mix__spectral_gfnet__ssm_conv_s5__prompt_kernel_skip22
  s_getpc_b64 s[90:91]
gated_mix__spectral_gfnet__ssm_conv_s5__prompt_kernel_pc21:
  s_lshr_b32 s29, s2, 3
  s_mul_i32 s29, s29, 512
  v_min_u32 v210, 3, v1
  v_lshl_add_u32 v210, v210, 7, s29
  v_min_u32 v210, gated_mix__spectral_gfnet__ssm_conv_s5__prompt_kernel_end-gated_mix__spectral_gfnet__ssm_conv_s5__prompt_kernel_pc21, v210
  v_mov_b32 v211, 0
  v_lshl_add_u64 v[210:211], v[210:211], 0, s[90:91]
  global_load_dword v4, v[210:211], off
gated_mix__spectral_gfnet__ssm_conv_s5__prompt_kernel_skip22:
  v_fma_f32 v192, v192, v192, -v204
  v_mfma_f32_32x32x16_bf16 v[140:155], v[172:175], v[180:183], v[140:155]
  s_add_u32 m0, s55, 49152
  s_nop 0
  buffer_load_dwordx4 v12, s[48:51], s52 offen offset:0 lds
  v_add_f32 v193, v193, v193
  v_mfma_f32_32x32x16_bf16 v[104:119], v[172:175], v[176:179], v[104:119]
  buffer_load_dwordx4 v13, s[48:51], s52 offen offset:1024 lds
  v_mul_f32 v204, v193, v193
  s_waitcnt lgkmcnt(2)
  v_mfma_f32_32x32x16_bf16 v[40:55], v[120:123], v[160:163], v[40:55]
  ds_read_b128 v[168:171], v17 offset:0
  ds_read_b128 v[176:179], v21 offset:0
  v_mul_f32 v193, v192, v193
  v_fma_f32 v192, v192, v192, -v204
  s_waitcnt lgkmcnt(2)
  v_mfma_f32_32x32x16_bf16 v[88:103], v[120:123], v[164:167], v[88:103]
  ds_read_b128 v[172:175], v17 offset:4096
  ds_read_b128 v[180:183], v21 offset:4096
  v_add_f32 v193, v193, v193
  v_mfma_f32_32x32x16_bf16 v[140:155], v[156:159], v[164:167], v[140:155]
  buffer_load_dwordx4 v14, s[48:51], s52 offen offset:2048 lds
  v_mul_f32 v204, v193, v193
  v_mfma_f32_32x32x16_bf16 v[104:119], v[156:159], v[160:163], v[104:119]
  buffer_load_dwordx4 v15, s[48:51], s52 offen offset:3072 lds
  v_mul_f32 v193, v192, v193
  s_waitcnt lgkmcnt(2)
  v_mfma_f32_32x32x16_bf16 v[40:55], v[168:171], v[176:179], v[40:55]
  ds_read_b128 v[120:123], v18 offset:0
  ds_read_b128 v[160:163], v22 offset:0
  v_fma_f32 v192, v192, v192, -v204
  s_waitcnt lgkmcnt(2)
  v_mfma_f32_32x32x16_bf16 v[88:103], v[168:171], v[180:183], v[88:103]
  ds_read_b128 v[156:159], v18 offset:4096
  ds_read_b128 v[164:167], v22 offset:4096
  v_add_f32 v193, v193, v193
  v_mul_f32 v204, v193, v193
  v_mfma_f32_32x32x16_bf16 v[140:155], v[172:175], v[180:183], v[140:155]
  s_add_u32 m0, s54, 49152
  s_nop 0
  buffer_load_dwordx4 v8, s[44:47], s52 offen offset:0 lds
  v_mul_f32 v195, v192, v193
  v_mfma_f32_32x32x16_bf16 v[104:119], v[172:175], v[176:179], v[104:119]
  buffer_load_dwordx4 v9, s[44:47], s52 offen offset:1024 lds
  v_fma_f32 v194, v192, v192, -v204
  s_waitcnt lgkmcnt(2)
  v_mfma_f32_32x32x16_bf16 v[40:55], v[120:123], v[160:163], v[40:55]
  ds_read_b128 v[168:171], v19 offset:0
  ds_read_b128 v[176:179], v23 offset:0
  v_add_f32 v195, v195, v195
  s_waitcnt lgkmcnt(2)
  v_mfma_f32_32x32x16_bf16 v[88:103], v[120:123], v[164:167], v[88:103]
  ds_read_b128 v[172:175], v19 offset:4096
  ds_read_b128 v[180:183], v23 offset:4096
  v_mul_f32 v204, v195, v195
  v_mfma_f32_32x32x16_bf16 v[140:155], v[156:159], v[164:167], v[140:155]
  buffer_load_dwordx4 v10, s[44:47], s52 offen offset:2048 lds
  v_mul_f32 v197, v194, v195
  v_fma_f32 v196, v194, v194, -v204
  v_mfma_f32_32x32x16_bf16 v[104:119], v[156:159], v[160:163], v[104:119]
  buffer_load_dwordx4 v11, s[44:47], s52 offen offset:3072 lds
  s_add_u32 s52, s52, 128
  s_and_b32 s52, s52, 0x7ff
  v_add_f32 v197, v197, v197
  s_waitcnt vmcnt(18) lgkmcnt(0)
  s_barrier
  v_mfma_f32_32x32x16_bf16 v[40:55], v[168:171], v[176:179], v[40:55]
  ds_read_b128 v[120:123], v16 offset:16384
  ds_read_b128 v[160:163], v20 offset:16384
  v_mul_f32 v204, v197, v197
  v_mfma_f32_32x32x16_bf16 v[88:103], v[168:171], v[180:183], v[88:103]
  ds_read_b128 v[156:159], v16 offset:20480
  ds_read_b128 v[164:167], v20 offset:20480
  v_mul_f32 v203, v196, v197
  v_mfma_f32_32x32x16_bf16 v[140:155], v[172:175], v[180:183], v[140:155]
  buffer_load_dword v209, v7, s[16:19], 0 offen sc1
  s_cmp_eq_u32 s86, 0
  s_cbranch_scc1 gated_mix__spectral_gfnet__ssm_conv_s5__prompt_kernel_skip23
  s_add_u32 s29, s59, 1050624
  s_mov_b32 m0, 147456
  s_nop 0
  buffer_load_dwordx4 v64, s[20:23], s29 offen lds
  buffer_load_dwordx4 v64, s[76:79], s29 offen offset:1024 lds
  s_add_u32 s29, s6, 1050624
  s_mov_b32 m0, 149504
  s_nop 0
  buffer_load_dwordx4 v64, s[20:23], s29 offen lds
  buffer_load_dwordx4 v64, s[76:79], s29 offen offset:1024 lds
gated_mix__spectral_gfnet__ssm_conv_s5__prompt_kernel_skip23:
  s_cmp_lg_u32 s4, 0
  s_cbranch_scc1 gated_mix__spectral_gfnet__ssm_conv_s5__prompt_kernel_skip24
  s_mov_b64 exec, 0x3ff
  buffer_load_short_d16_hi v210, v188, s[20:23], 0 offen
  buffer_load_short_d16_hi v211, v188, s[76:79], 0 offen offset:1024
  s_mov_b64 exec, -1
gated_mix__spectral_gfnet__ssm_conv_s5__prompt_kernel_skip24:
  v_fma_f32 v202, v196, v196, -v204
  v_mfma_f32_32x32x16_bf16 v[104:119], v[172:175], v[176:179], v[104:119]
  s_add_u32 m0, s43, 131072
  s_nop 0
  buffer_load_dwordx4 v124, s[68:71], s28 offen offset:0 lds
  v_add_f32 v203, v203, v203
  s_waitcnt lgkmcnt(2)
  v_mfma_f32_32x32x16_bf16 v[40:55], v[120:123], v[160:163], v[40:55]
  ds_read_b128 v[168:171], v17 offset:16384
  ds_read_b128 v[176:179], v21 offset:16384
  v_mul_f32 v204, v203, v203
  v_mul_f32 v199, v202, v203
  s_waitcnt lgkmcnt(2)
  v_mfma_f32_32x32x16_bf16 v[88:103], v[120:123], v[164:167], v[88:103]
  ds_read_b128 v[172:175], v17 offset:20480
  ds_read_b128 v[180:183], v21 offset:20480
  v_fma_f32 v198, v202, v202, -v204
  v_mfma_f32_32x32x16_bf16 v[140:155], v[156:159], v[164:167], v[140:155]
  buffer_load_dwordx4 v125, s[68:71], s28 offen offset:1024 lds
  v_add_f32 v199, v199, v199
  v_mfma_f32_32x32x16_bf16 v[104:119], v[156:159], v[160:163], v[104:119]
  s_add_u32 m0, s43, 133120
  s_nop 0
  buffer_load_dwordx4 v126, s[68:71], s28 offen offset:0 lds
  v_mul_f32 v204, v199, v199
  s_waitcnt lgkmcnt(2)
  v_mfma_f32_32x32x16_bf16 v[40:55], v[168:171], v[176:179], v[40:55]
  ds_read_b128 v[120:123], v18 offset:16384
  ds_read_b128 v[160:163], v22 offset:16384
  v_mul_f32 v199, v198, v199
  s_waitcnt lgkmcnt(2)
  v_mfma_f32_32x32x16_bf16 v[88:103], v[168:171], v[180:183], v[88:103]
  ds_read_b128 v[156:159], v18 offset:20480
  ds_read_b128 v[164:167], v22 offset:20480
  v_fma_f32 v198, v198, v198, -v204
  v_add_f32 v199, v199, v199
  v_mfma_f32_32x32x16_bf16 v[140:155], v[172:175], v[180:183], v[140:155]
  buffer_load_dwordx4 v127, s[68:71], s28 offen offset:1024 lds
  v_mul_f32 v204, v199, v199
  v_mfma_f32_32x32x16_bf16 v[104:119], v[172:175], v[176:179], v[104:119]
  s_add_u32 m0, s43, 65536
  s_nop 0
  buffer_load_dwordx4 v124, s[72:75], s28 offen offset:0 lds
  v_mul_f32 v199, v198, v199
  s_waitcnt lgkmcnt(2)
  v_mfma_f32_32x32x16_bf16 v[40:55], v[120:123], v[160:163], v[40:55]
  ds_read_b128 v[168:171], v19 offset:16384
  ds_read_b128 v[176:179], v23 offset:16384
  v_fma_f32 v198, v198, v198, -v204
  s_waitcnt lgkmcnt(2)
  v_mfma_f32_32x32x16_bf16 v[88:103], v[120:123], v[164:167], v[88:103]
  ds_read_b128 v[172:175], v19 offset:20480
  ds_read_b128 v[180:183], v23 offset:20480
  v_add_f32 v199, v199, v199
  v_mfma_f32_32x32x16_bf16 v[140:155], v[156:159], v[164:167], v[140:155]
  buffer_load_dwordx4 v125, s[72:75], s28 offen offset:1024 lds
  v_lshlrev_b32 v56, 3, v0
  v_add_u32 v56, 151552, v56
  v_mfma_f32_32x32x16_bf16 v[104:119], v[156:159], v[160:163], v[104:119]
  s_add_u32 m0, s43, 67584
  s_nop 0
  buffer_load_dwordx4 v126, s[72:75], s28 offen offset:0 lds
  s_sub_u32 s87, 15, s38
  s_waitcnt vmcnt(16) lgkmcnt(0)
  s_barrier
  v_mfma_f32_32x32x16_bf16 v[40:55], v[168:171], v[176:179], v[40:55]
  ds_read_b128 v[120:123], v16 offset:32768
  ds_read_b128 v[160:163], v20 offset:32768
  s_lshl_b32 s87, s87, 9
  v_mfma_f32_32x32x16_bf16 v[88:103], v[168:171], v[180:183], v[88:103]
  ds_read_b128 v[156:159], v16 offset:36864
  ds_read_b128 v[164:167], v20 offset:36864
  s_and_b32 s88, s3, 1
  v_mfma_f32_32x32x16_bf16 v[140:155], v[172:175], v[180:183], v[140:155]
  buffer_load_dwordx4 v127, s[72:75], s28 offen offset:1024 lds
  s_add_u32 s28, s28, 128
  s_and_b32 s28, s28, 0x3ff
  s_lshl_b32 s88, s88, 8
  v_mfma_f32_32x32x16_bf16 v[104:119], v[172:175], v[176:179], v[104:119]
  s_add_u32 s87, s87, s88
  s_waitcnt lgkmcnt(2)
  v_mfma_f32_32x32x16_bf16 v[40:55], v[120:123], v[160:163], v[40:55]
  ds_read_b128 v[168:171], v17 offset:32768
  ds_read_b128 v[176:179], v21 offset:32768
  v_and_b32 v57, 31, v1
  v_lshl_add_u32 v57, v57, 3, s87
  s_waitcnt lgkmcnt(2)
  v_mfma_f32_32x32x16_bf16 v[88:103], v[120:123], v[164:167], v[88:103]
  ds_read_b128 v[172:175], v17 offset:36864
  ds_read_b128 v[180:183], v21 offset:36864
  s_lshl_b32 s88, s38, 1
  v_mfma_f32_32x32x16_bf16 v[140:155], v[156:159], v[164:167], v[140:155]
  s_lshr_b32 s89, s3, 1
  v_mfma_f32_32x32x16_bf16 v[104:119], v[156:159], v[160:163], v[104:119]
  s_add_u32 s88, s88, s89
  s_waitcnt lgkmcnt(2)
  v_mfma_f32_32x32x16_bf16 v[40:55], v[168:171], v[176:179], v[40:55]
  ds_read_b128 v[120:123], v18 offset:32768
  ds_read_b128 v[160:163], v22 offset:32768
  s_lshl_b32 s87, s88, 9
  s_waitcnt lgkmcnt(2)
  v_mfma_f32_32x32x16_bf16 v[88:103], v[168:171], v[180:183], v[88:103]
  ds_read_b128 v[156:159], v18 offset:36864
  ds_read_b128 v[164:167], v22 offset:36864
  s_and_b32 s88, s88, 3
  s_lshl_b32 s88, s88, 2
  v_mfma_f32_32x32x16_bf16 v[140:155], v[172:175], v[180:183], v[140:155]
  v_xor_b32 v58, s88, v2
  v_mfma_f32_32x32x16_bf16 v[104:119], v[172:175], v[176:179], v[104:119]
  v_lshlrev_b32 v58, 4, v58
  s_waitcnt lgkmcnt(2)
  v_mfma_f32_32x32x16_bf16 v[40:55], v[120:123], v[160:163], v[40:55]
  ds_read_b128 v[168:171], v19 offset:32768
  ds_read_b128 v[176:179], v23 offset:32768
  v_lshrrev_b32 v204, 1, v3
  s_waitcnt lgkmcnt(2)
  v_mfma_f32_32x32x16_bf16 v[88:103], v[120:123], v[164:167], v[88:103]
  ds_read_b128 v[172:175], v19 offset:36864
  ds_read_b128 v[180:183], v23 offset:36864
  v_lshl_or_b32 v58, v204, 14, v58
  v_mfma_f32_32x32x16_bf16 v[140:155], v[156:159], v[164:167], v[140:155]
  v_and_b32 v204, 1, v3
  v_lshl_or_b32 v58, v204, 19, v58
  v_mfma_f32_32x32x16_bf16 v[104:119], v[156:159], v[160:163], v[104:119]
  s_and_b32 s89, s3, 1
  s_waitcnt vmcnt(9) lgkmcnt(0)
  s_barrier
  v_mfma_f32_32x32x16_bf16 v[40:55], v[168:171], v[176:179], v[40:55]
  ds_read_b128 v[120:123], v16 offset:49152
  ds_read_b128 v[160:163], v20 offset:49152
  s_lshl_b32 s89, s89, 8
  v_mfma_f32_32x32x16_bf16 v[88:103], v[168:171], v[180:183], v[88:103]
  ds_read_b128 v[156:159], v16 offset:53248
  ds_read_b128 v[164:167], v20 offset:53248
  s_add_u32 s87, s87, s89
  v_mfma_f32_32x32x16_bf16 v[140:155], v[172:175], v[180:183], v[140:155]
  s_add_u32 m0, s85, 0
  s_nop 0
  buffer_load_dwordx4 v64, s[20:23], s59 offen offset:0 lds
  s_lshl_b32 s89, s39, 15
  v_mfma_f32_32x32x16_bf16 v[104:119], v[172:175], v[176:179], v[104:119]
  buffer_load_dwordx4 v64, s[76:79], s59 offen offset:1024 lds
  s_add_u32 s87, s87, s89
  s_waitcnt lgkmcnt(2)
  v_mfma_f32_32x32x16_bf16 v[40:55], v[120:123], v[160:163], v[40:55]
  ds_read_b128 v[168:171], v17 offset:49152
  ds_read_b128 v[176:179], v21 offset:49152
  s_waitcnt lgkmcnt(2)
  v_mfma_f32_32x32x16_bf16 v[88:103], v[120:123], v[164:167], v[88:103]
  ds_read_b128 v[172:175], v17 offset:53248
  ds_read_b128 v[180:183], v21 offset:53248
  s_add_u32 m0, s85, 2048
  s_nop 0
  buffer_load_dwordx4 v64, s[20:23], s6 offen offset:0 lds
  v_mfma_f32_32x32x16_bf16 v[140:155], v[156:159], v[164:167], v[140:155]
  buffer_load_dwordx4 v64, s[76:79], s6 offen offset:1024 lds
  v_mfma_f32_32x32x16_bf16 v[104:119], v[156:159], v[160:163], v[104:119]
  s_add_u32 m0, s85, 16384
  s_nop 0
  buffer_load_dwordx4 v64, s[20:23], s7 offen offset:0 lds
  s_waitcnt lgkmcnt(2)
  v_mfma_f32_32x32x16_bf16 v[40:55], v[168:171], v[176:179], v[40:55]
  ds_read_b128 v[120:123], v18 offset:49152
  ds_read_b128 v[160:163], v22 offset:49152
  s_waitcnt lgkmcnt(2)
  v_mfma_f32_32x32x16_bf16 v[88:103], v[168:171], v[180:183], v[88:103]
  ds_read_b128 v[156:159], v18 offset:53248
  ds_read_b128 v[164:167], v22 offset:53248
  buffer_load_dwordx4 v64, s[76:79], s7 offen offset:1024 lds
  v_mfma_f32_32x32x16_bf16 v[140:155], v[172:175], v[180:183], v[140:155]
  s_add_u32 m0, s85, 18432
  s_nop 0
  buffer_load_dwordx4 v64, s[20:23], s8 offen offset:0 lds
  v_mfma_f32_32x32x16_bf16 v[104:119], v[172:175], v[176:179], v[104:119]
  buffer_load_dwordx4 v64, s[76:79], s8 offen offset:1024 lds
  s_waitcnt lgkmcnt(2)
  v_mfma_f32_32x32x16_bf16 v[40:55], v[120:123], v[160:163], v[40:55]
  ds_read_b128 v[168:171], v19 offset:49152
  ds_read_b128 v[176:179], v23 offset:49152
  s_waitcnt lgkmcnt(2)
  v_mfma_f32_32x32x16_bf16 v[88:103], v[120:123], v[164:167], v[88:103]
  ds_read_b128 v[172:175], v19 offset:53248
  ds_read_b128 v[180:183], v23 offset:53248
  v_mfma_f32_32x32x16_bf16 v[140:155], v[156:159], v[164:167], v[140:155]
  v_mfma_f32_32x32x16_bf16 v[104:119], v[156:159], v[160:163], v[104:119]
  s_waitcnt lgkmcnt(2)
  v_mfma_f32_32x32x16_bf16 v[40:55], v[168:171], v[176:179], v[40:55]
  s_waitcnt lgkmcnt(0)
  v_mfma_f32_32x32x16_bf16 v[88:103], v[168:171], v[180:183], v[88:103]
  v_mfma_f32_32x32x16_bf16 v[140:155], v[172:175], v[180:183], v[140:155]
  v_mfma_f32_32x32x16_bf16 v[104:119], v[172:175], v[176:179], v[104:119]
  s_nop 7
  v_pk_fma_f32 v[8:9], v[190:191], v[40:41], v[42:43] op_sel:[0,0,0] op_sel_hi:[0,1,1]
  s_nop 0
  v_pk_fma_f32 v[10:11], v[190:191], v[88:89], v[90:91] op_sel:[0,0,0] op_sel_hi:[0,1,1]
  v_pk_fma_f32 v[8:9], v[190:191], v[88:89], v[8:9] op_sel:[1,0,0] op_sel_hi:[1,1,1] neg_lo:[1,0,0] neg_hi:[1,0,0]
  v_pk_fma_f32 v[10:11], v[190:191], v[40:41], v[10:11] op_sel:[1,0,0] op_sel_hi:[1,1,1]
  v_pk_fma_f32 v[12:13], v[190:191], v[8:9], v[44:45] op_sel:[0,0,0] op_sel_hi:[0,1,1]
  v_pk_fma_f32 v[14:15], v[190:191], v[10:11], v[92:93] op_sel:[0,0,0] op_sel_hi:[0,1,1]
  v_pk_fma_f32 v[12:13], v[190:191], v[10:11], v[12:13] op_sel:[1,0,0] op_sel_hi:[1,1,1] neg_lo:[1,0,0] neg_hi:[1,0,0]
  v_pk_fma_f32 v[14:15], v[190:191], v[8:9], v[14:15] op_sel:[1,0,0] op_sel_hi:[1,1,1]
  v_pk_fma_f32 v[8:9], v[190:191], v[12:13], v[46:47] op_sel:[0,0,0] op_sel_hi:[0,1,1]
  v_pk_fma_f32 v[10:11], v[190:191], v[14:15], v[94:95] op_sel:[0,0,0] op_sel_hi:[0,1,1]
  v_pk_fma_f32 v[8:9], v[190:191], v[14:15], v[8:9] op_sel:[1,0,0] op_sel_hi:[1,1,1] neg_lo:[1,0,0] neg_hi:[1,0,0]
  v_pk_fma_f32 v[10:11], v[190:191], v[12:13], v[10:11] op_sel:[1,0,0] op_sel_hi:[1,1,1]
  v_pk_fma_f32 v[12:13], v[190:191], v[8:9], v[48:49] op_sel:[0,0,0] op_sel_hi:[0,1,1]
  v_pk_fma_f32 v[14:15], v[190:191], v[10:11], v[96:97] op_sel:[0,0,0] op_sel_hi:[0,1,1]
  v_pk_fma_f32 v[12:13], v[190:191], v[10:11], v[12:13] op_sel:[1,0,0] op_sel_hi:[1,1,1] neg_lo:[1,0,0] neg_hi:[1,0,0]
  v_pk_fma_f32 v[14:15], v[190:191], v[8:9], v[14:15] op_sel:[1,0,0] op_sel_hi:[1,1,1]
  v_pk_fma_f32 v[8:9], v[190:191], v[12:13], v[50:51] op_sel:[0,0,0] op_sel_hi:[0,1,1]
  v_pk_fma_f32 v[10:11], v[190:191], v[14:15], v[98:99] op_sel:[0,0,0] op_sel_hi:[0,1,1]
  v_pk_fma_f32 v[8:9], v[190:191], v[14:15], v[8:9] op_sel:[1,0,0] op_sel_hi:[1,1,1] neg_lo:[1,0,0] neg_hi:[1,0,0]
  v_pk_fma_f32 v[10:11], v[190:191], v[12:13], v[10:11] op_sel:[1,0,0] op_sel_hi:[1,1,1]
  v_pk_fma_f32 v[12:13], v[190:191], v[8:9], v[52:53] op_sel:[0,0,0] op_sel_hi:[0,1,1]
  v_pk_fma_f32 v[14:15], v[190:191], v[10:11], v[100:101] op_sel:[0,0,0] op_sel_hi:[0,1,1]
  v_pk_fma_f32 v[12:13], v[190:191], v[10:11], v[12:13] op_sel:[1,0,0] op_sel_hi:[1,1,1] neg_lo:[1,0,0] neg_hi:[1,0,0]
  v_pk_fma_f32 v[14:15], v[190:191], v[8:9], v[14:15] op_sel:[1,0,0] op_sel_hi:[1,1,1]
  v_pk_fma_f32 v[8:9], v[190:191], v[12:13], v[54:55] op_sel:[0,0,0] op_sel_hi:[0,1,1]
  v_pk_fma_f32 v[10:11], v[190:191], v[14:15], v[102:103] op_sel:[0,0,0] op_sel_hi:[0,1,1]
  v_pk_fma_f32 v[8:9], v[190:191], v[14:15], v[8:9] op_sel:[1,0,0] op_sel_hi:[1,1,1] neg_lo:[1,0,0] neg_hi:[1,0,0]
  v_pk_fma_f32 v[10:11], v[190:191], v[12:13], v[10:11] op_sel:[1,0,0] op_sel_hi:[1,1,1]
  v_pk_fma_f32 v[12:13], v[190:191], v[8:9], v[104:105] op_sel:[0,0,0] op_sel_hi:[0,1,1]
  v_pk_fma_f32 v[14:15], v[190:191], v[10:11], v[140:141] op_sel:[0,0,0] op_sel_hi:[0,1,1]
  v_pk_fma_f32 v[12:13], v[190:191], v[10:11], v[12:13] op_sel:[1,0,0] op_sel_hi:[1,1,1] neg_lo:[1,0,0] neg_hi:[1,0,0]
  v_pk_fma_f32 v[14:15], v[190:191], v[8:9], v[14:15] op_sel:[1,0,0] op_sel_hi:[1,1,1]
  v_pk_fma_f32 v[8:9], v[190:191], v[12:13], v[106:107] op_sel:[0,0,0] op_sel_hi:[0,1,1]
  v_pk_fma_f32 v[10:11], v[190:191], v[14:15], v[142:143] op_sel:[0,0,0] op_sel_hi:[0,1,1]
  v_pk_fma_f32 v[8:9], v[190:191], v[14:15], v[8:9] op_sel:[1,0,0] op_sel_hi:[1,1,1] neg_lo:[1,0,0] neg_hi:[1,0,0]
  v_pk_fma_f32 v[10:11], v[190:191], v[12:13], v[10:11] op_sel:[1,0,0] op_sel_hi:[1,1,1]
  v_pk_fma_f32 v[12:13], v[190:191], v[8:9], v[108:109] op_sel:[0,0,0] op_sel_hi:[0,1,1]
  v_pk_fma_f32 v[14:15], v[190:191], v[10:11], v[144:145] op_sel:[0,0,0] op_sel_hi:[0,1,1]
  v_pk_fma_f32 v[12:13], v[190:191], v[10:11], v[12:13] op_sel:[1,0,0] op_sel_hi:[1,1,1] neg_lo:[1,0,0] neg_hi:[1,0,0]
  v_pk_fma_f32 v[14:15], v[190:191], v[8:9], v[14:15] op_sel:[1,0,0] op_sel_hi:[1,1,1]
  v_pk_fma_f32 v[8:9], v[190:191], v[12:13], v[110:111] op_sel:[0,0,0] op_sel_hi:[0,1,1]
  v_pk_fma_f32 v[10:11], v[190:191], v[14:15], v[146:147] op_sel:[0,0,0] op_sel_hi:[0,1,1]
  v_pk_fma_f32 v[8:9], v[190:191], v[14:15], v[8:9] op_sel:[1,0,0] op_sel_hi:[1,1,1] neg_lo:[1,0,0] neg_hi:[1,0,0]
  v_pk_fma_f32 v[10:11], v[190:191], v[12:13], v[10:11] op_sel:[1,0,0] op_sel_hi:[1,1,1]
  v_pk_fma_f32 v[12:13], v[190:191], v[8:9], v[112:113] op_sel:[0,0,0] op_sel_hi:[0,1,1]
  v_pk_fma_f32 v[14:15], v[190:191], v[10:11], v[148:149] op_sel:[0,0,0] op_sel_hi:[0,1,1]
  v_pk_fma_f32 v[12:13], v[190:191], v[10:11], v[12:13] op_sel:[1,0,0] op_sel_hi:[1,1,1] neg_lo:[1,0,0] neg_hi:[1,0,0]
  v_pk_fma_f32 v[14:15], v[190:191], v[8:9], v[14:15] op_sel:[1,0,0] op_sel_hi:[1,1,1]
  v_pk_fma_f32 v[8:9], v[190:191], v[12:13], v[114:115] op_sel:[0,0,0] op_sel_hi:[0,1,1]
  v_pk_fma_f32 v[10:11], v[190:191], v[14:15], v[150:151] op_sel:[0,0,0] op_sel_hi:[0,1,1]
  v_pk_fma_f32 v[8:9], v[190:191], v[14:15], v[8:9] op_sel:[1,0,0] op_sel_hi:[1,1,1] neg_lo:[1,0,0] neg_hi:[1,0,0]
  v_pk_fma_f32 v[10:11], v[190:191], v[12:13], v[10:11] op_sel:[1,0,0] op_sel_hi:[1,1,1]
  v_pk_fma_f32 v[12:13], v[190:191], v[8:9], v[116:117] op_sel:[0,0,0] op_sel_hi:[0,1,1]
  v_pk_fma_f32 v[14:15], v[190:191], v[10:11], v[152:153] op_sel:[0,0,0] op_sel_hi:[0,1,1]
  v_pk_fma_f32 v[12:13], v[190:191], v[10:11], v[12:13] op_sel:[1,0,0] op_sel_hi:[1,1,1] neg_lo:[1,0,0] neg_hi:[1,0,0]
  v_pk_fma_f32 v[14:15], v[190:191], v[8:9], v[14:15] op_sel:[1,0,0] op_sel_hi:[1,1,1]
  v_pk_fma_f32 v[8:9], v[190:191], v[12:13], v[118:119] op_sel:[0,0,0] op_sel_hi:[0,1,1]
  v_pk_fma_f32 v[10:11], v[190:191], v[14:15], v[154:155] op_sel:[0,0,0] op_sel_hi:[0,1,1]
  v_pk_fma_f32 v[8:9], v[190:191], v[14:15], v[8:9] op_sel:[1,0,0] op_sel_hi:[1,1,1] neg_lo:[1,0,0] neg_hi:[1,0,0]
  v_pk_fma_f32 v[10:11], v[190:191], v[12:13], v[10:11] op_sel:[1,0,0] op_sel_hi:[1,1,1]
  v_fma_f32 v12, v192, v8, v9
  v_fma_f32 v13, v192, v10, v11
  v_fma_f32 v12, -v193, v10, v12
  v_fma_f32 v13, v193, v8, v13
  v_mov_b32 v14, v12
  v_mov_b32 v15, v13
  s_nop 0
  v_permlane32_swap_b32 v12, v14
  v_permlane32_swap_b32 v13, v15
  v_fma_f32 v14, v194, v12, v14
  v_fma_f32 v15, v194, v13, v15
  v_fma_f32 v14, -v195, v13, v14
  v_fma_f32 v15, v195, v12, v15
  ds_write_b64 v56, v[14:15]
  s_waitcnt vmcnt(16)
  v_cmp_ne_u32 vcc, 1, v209
  s_nop 0
  s_cbranch_vccz gated_mix__spectral_gfnet__ssm_conv_s5__prompt_kernel_skip25
  s_mov_b32 s29, 0
gated_mix__spectral_gfnet__ssm_conv_s5__prompt_kernel_poll26:
  s_sleep 16
  buffer_load_dword v209, v7, s[16:19], 0 offen sc1
  s_waitcnt vmcnt(0)
  v_cmp_ne_u32 vcc, 1, v209
  s_nop 0
  s_cbranch_vccz gated_mix__spectral_gfnet__ssm_conv_s5__prompt_kernel_pollout27
  s_add_u32 s29, s29, 1
  s_cmp_lt_u32 s29, 1048576
  s_cbranch_scc1 gated_mix__spectral_gfnet__ssm_conv_s5__prompt_kernel_poll26
gated_mix__spectral_gfnet__ssm_conv_s5__prompt_kernel_pollout27:
gated_mix__spectral_gfnet__ssm_conv_s5__prompt_kernel_skip25:
  s_waitcnt lgkmcnt(0)
  s_barrier
  v_and_b32 v56, 0xfffffbff, v56
  ds_read_b64 v[208:209], v56
  s_cmp_lt_u32 s3, 2
  s_cbranch_scc1 gated_mix__spectral_gfnet__ssm_conv_s5__prompt_kernel_skip28
  s_waitcnt lgkmcnt(0)
  v_fma_f32 v14, v196, v208, v14
  s_waitcnt lgkmcnt(0)
  v_fma_f32 v15, v196, v209, v15
  s_waitcnt lgkmcnt(0)
  v_fma_f32 v14, -v197, v209, v14
  s_waitcnt lgkmcnt(0)
  v_fma_f32 v15, v197, v208, v15
  v_min_u32 v14, -2, v14
  v_min_u32 v15, -2, v15
  s_mov_b32 exec_hi, 0
  buffer_store_dwordx2 v[14:15], v57, s[64:67], 0 offen sc1
  s_mov_b64 exec, -1
gated_mix__spectral_gfnet__ssm_conv_s5__prompt_kernel_skip28:
  v_lshrrev_b32 v6, 5, v1
  v_lshl_add_u32 v57, v6, 12, v57
  v_add_u32 v57, 512, v57
  v_and_b32 v14, 3, v2
  v_lshlrev_b32 v6, 6, v14
  v_lshrrev_b32 v14, 2, v2
  v_lshl_or_b32 v6, v14, 4, v6
  v_lshl_or_b32 v6, v3, 12, v6
  s_mul_i32 s29, s11, 16384
  s_lshl_b32 s58, s3, 8
  s_add_u32 s29, s29, s58
  buffer_load_dwordx4 v[16:19], v6, s[12:15], s29 offen offset:0 sc1
  buffer_load_dwordx4 v[20:23], v6, s[12:15], s29 offen offset:1024 sc1
  buffer_load_dwordx4 v[120:123], v6, s[12:15], s29 offen offset:2048 sc1
  buffer_load_dwordx4 v[156:159], v6, s[12:15], s29 offen offset:3072 sc1
  v_pk_mul_f32 v[162:163], v[200:201], v[40:41] op_sel:[1,0] op_sel_hi:[1,1]
  v_pk_mul_f32 v[40:41], v[200:201], v[40:41] op_sel:[0,0] op_sel_hi:[0,1]
  v_pk_fma_f32 v[40:41], v[200:201], v[88:89], v[40:41] op_sel:[1,0,0] op_sel_hi:[1,1,1] neg_lo:[1,0,0] neg_hi:[1,0,0]
  v_pk_fma_f32 v[88:89], v[200:201], v[88:89], v[162:163] op_sel:[0,0,0] op_sel_hi:[0,1,1]
  v_pk_mul_f32 v[160:161], v[200:201], v[42:43] op_sel:[1,0] op_sel_hi:[1,1]
  v_pk_mul_f32 v[42:43], v[200:201], v[42:43] op_sel:[0,0] op_sel_hi:[0,1]
  v_pk_fma_f32 v[42:43], v[200:201], v[90:91], v[42:43] op_sel:[1,0,0] op_sel_hi:[1,1,1] neg_lo:[1,0,0] neg_hi:[1,0,0]
  v_pk_fma_f32 v[90:91], v[200:201], v[90:91], v[160:161] op_sel:[0,0,0] op_sel_hi:[0,1,1]
  v_pk_mul_f32 v[162:163], v[200:201], v[44:45] op_sel:[1,0] op_sel_hi:[1,1]
  v_pk_mul_f32 v[44:45], v[200:201], v[44:45] op_sel:[0,0] op_sel_hi:[0,1]
  v_pk_fma_f32 v[44:45], v[200:201], v[92:93], v[44:45] op_sel:[1,0,0] op_sel_hi:[1,1,1] neg_lo:[1,0,0] neg_hi:[1,0,0]
  v_pk_fma_f32 v[92:93], v[200:201], v[92:93], v[162:163] op_sel:[0,0,0] op_sel_hi:[0,1,1]
  v_pk_mul_f32 v[160:161], v[200:201], v[46:47] op_sel:[1,0] op_sel_hi:[1,1]
  v_pk_mul_f32 v[46:47], v[200:201], v[46:47] op_sel:[0,0] op_sel_hi:[0,1]
  v_pk_fma_f32 v[46:47], v[200:201], v[94:95], v[46:47] op_sel:[1,0,0] op_sel_hi:[1,1,1] neg_lo:[1,0,0] neg_hi:[1,0,0]
  v_pk_fma_f32 v[94:95], v[200:201], v[94:95], v[160:161] op_sel:[0,0,0] op_sel_hi:[0,1,1]
  v_pk_mul_f32 v[162:163], v[200:201], v[48:49] op_sel:[1,0] op_sel_hi:[1,1]
  v_pk_mul_f32 v[48:49], v[200:201], v[48:49] op_sel:[0,0] op_sel_hi:[0,1]
  v_pk_fma_f32 v[48:49], v[200:201], v[96:97], v[48:49] op_sel:[1,0,0] op_sel_hi:[1,1,1] neg_lo:[1,0,0] neg_hi:[1,0,0]
  v_pk_fma_f32 v[96:97], v[200:201], v[96:97], v[162:163] op_sel:[0,0,0] op_sel_hi:[0,1,1]
  v_pk_mul_f32 v[160:161], v[200:201], v[50:51] op_sel:[1,0] op_sel_hi:[1,1]
  v_pk_mul_f32 v[50:51], v[200:201], v[50:51] op_sel:[0,0] op_sel_hi:[0,1]
  v_pk_fma_f32 v[50:51], v[200:201], v[98:99], v[50:51] op_sel:[1,0,0] op_sel_hi:[1,1,1] neg_lo:[1,0,0] neg_hi:[1,0,0]
  v_pk_fma_f32 v[98:99], v[200:201], v[98:99], v[160:161] op_sel:[0,0,0] op_sel_hi:[0,1,1]
  v_pk_mul_f32 v[162:163], v[200:201], v[52:53] op_sel:[1,0] op_sel_hi:[1,1]
  s_add_u32 m0, s85, 81920
  s_nop 0
  buffer_load_dwordx4 v64, s[20:23], s9 offen offset:0 lds
  v_pk_mul_f32 v[52:53], v[200:201], v[52:53] op_sel:[0,0] op_sel_hi:[0,1]
  v_pk_fma_f32 v[52:53], v[200:201], v[100:101], v[52:53] op_sel:[1,0,0] op_sel_hi:[1,1,1] neg_lo:[1,0,0] neg_hi:[1,0,0]
  v_pk_fma_f32 v[100:101], v[200:201], v[100:101], v[162:163] op_sel:[0,0,0] op_sel_hi:[0,1,1]
  v_pk_mul_f32 v[160:161], v[200:201], v[54:55] op_sel:[1,0] op_sel_hi:[1,1]
  v_pk_mul_f32 v[54:55], v[200:201], v[54:55] op_sel:[0,0] op_sel_hi:[0,1]
  v_pk_fma_f32 v[54:55], v[200:201], v[102:103], v[54:55] op_sel:[1,0,0] op_sel_hi:[1,1,1] neg_lo:[1,0,0] neg_hi:[1,0,0]
  v_pk_fma_f32 v[102:103], v[200:201], v[102:103], v[160:161] op_sel:[0,0,0] op_sel_hi:[0,1,1]
  v_pk_mul_f32 v[162:163], v[200:201], v[104:105] op_sel:[1,0] op_sel_hi:[1,1]
  v_pk_mul_f32 v[104:105], v[200:201], v[104:105] op_sel:[0,0] op_sel_hi:[0,1]
  v_pk_fma_f32 v[104:105], v[200:201], v[140:141], v[104:105] op_sel:[1,0,0] op_sel_hi:[1,1,1] neg_lo:[1,0,0] neg_hi:[1,0,0]
  v_pk_fma_f32 v[140:141], v[200:201], v[140:141], v[162:163] op_sel:[0,0,0] op_sel_hi:[0,1,1]
  v_pk_mul_f32 v[160:161], v[200:201], v[106:107] op_sel:[1,0] op_sel_hi:[1,1]
  v_pk_mul_f32 v[106:107], v[200:201], v[106:107] op_sel:[0,0] op_sel_hi:[0,1]
  v_pk_fma_f32 v[106:107], v[200:201], v[142:143], v[106:107] op_sel:[1,0,0] op_sel_hi:[1,1,1] neg_lo:[1,0,0] neg_hi:[1,0,0]
  v_pk_fma_f32 v[142:143], v[200:201], v[142:143], v[160:161] op_sel:[0,0,0] op_sel_hi:[0,1,1]
  v_pk_mul_f32 v[162:163], v[200:201], v[108:109] op_sel:[1,0] op_sel_hi:[1,1]
  v_pk_mul_f32 v[108:109], v[200:201], v[108:109] op_sel:[0,0] op_sel_hi:[0,1]
  v_pk_fma_f32 v[108:109], v[200:201], v[144:145], v[108:109] op_sel:[1,0,0] op_sel_hi:[1,1,1] neg_lo:[1,0,0] neg_hi:[1,0,0]
  buffer_load_dwordx4 v64, s[76:79], s9 offen offset:1024 lds
  v_pk_fma_f32 v[144:145], v[200:201], v[144:145], v[162:163] op_sel:[0,0,0] op_sel_hi:[0,1,1]
  v_pk_mul_f32 v[160:161], v[200:201], v[110:111] op_sel:[1,0] op_sel_hi:[1,1]
  v_pk_mul_f32 v[110:111], v[200:201], v[110:111] op_sel:[0,0] op_sel_hi:[0,1]
  v_pk_fma_f32 v[110:111], v[200:201], v[146:147], v[110:111] op_sel:[1,0,0] op_sel_hi:[1,1,1] neg_lo:[1,0,0] neg_hi:[1,0,0]
  v_pk_fma_f32 v[146:147], v[200:201], v[146:147], v[160:161] op_sel:[0,0,0] op_sel_hi:[0,1,1]
  v_pk_mul_f32 v[162:163], v[200:201], v[112:113] op_sel:[1,0] op_sel_hi:[1,1]
  v_pk_mul_f32 v[112:113], v[200:201], v[112:113] op_sel:[0,0] op_sel_hi:[0,1]
  v_pk_fma_f32 v[112:113], v[200:201], v[148:149], v[112:113] op_sel:[1,0,0] op_sel_hi:[1,1,1] neg_lo:[1,0,0] neg_hi:[1,0,0]
  v_pk_fma_f32 v[148:149], v[200:201], v[148:149], v[162:163] op_sel:[0,0,0] op_sel_hi:[0,1,1]
  v_pk_mul_f32 v[160:161], v[200:201], v[114:115] op_sel:[1,0] op_sel_hi:[1,1]
  v_pk_mul_f32 v[114:115], v[200:201], v[114:115] op_sel:[0,0] op_sel_hi:[0,1]
  v_pk_fma_f32 v[114:115], v[200:201], v[150:151], v[114:115] op_sel:[1,0,0] op_sel_hi:[1,1,1] neg_lo:[1,0,0] neg_hi:[1,0,0]
  v_pk_fma_f32 v[150:151], v[200:201], v[150:151], v[160:161] op_sel:[0,0,0] op_sel_hi:[0,1,1]
  v_pk_mul_f32 v[162:163], v[200:201], v[116:117] op_sel:[1,0] op_sel_hi:[1,1]
  v_pk_mul_f32 v[116:117], v[200:201], v[116:117] op_sel:[0,0] op_sel_hi:[0,1]
  v_pk_fma_f32 v[116:117], v[200:201], v[152:153], v[116:117] op_sel:[1,0,0] op_sel_hi:[1,1,1] neg_lo:[1,0,0] neg_hi:[1,0,0]
  v_pk_fma_f32 v[152:153], v[200:201], v[152:153], v[162:163] op_sel:[0,0,0] op_sel_hi:[0,1,1]
  v_pk_mul_f32 v[160:161], v[200:201], v[118:119] op_sel:[1,0] op_sel_hi:[1,1]
  s_add_u32 m0, s85, 83968
  s_nop 0
  buffer_load_dwordx4 v64, s[20:23], s32 offen offset:0 lds
  v_pk_mul_f32 v[118:119], v[200:201], v[118:119] op_sel:[0,0] op_sel_hi:[0,1]
  v_pk_fma_f32 v[118:119], v[200:201], v[154:155], v[118:119] op_sel:[1,0,0] op_sel_hi:[1,1,1] neg_lo:[1,0,0] neg_hi:[1,0,0]
  v_pk_fma_f32 v[154:155], v[200:201], v[154:155], v[160:161] op_sel:[0,0,0] op_sel_hi:[0,1,1]
  v_pk_mul_f32 v[14:15], v[200:201], v[196:197] op_sel:[0,0] op_sel_hi:[0,1]
  v_pk_fma_f32 v[14:15], v[200:201], v[196:197], v[14:15] op_sel:[1,1,0] op_sel_hi:[1,0,1] neg_lo:[1,0,0]
  s_cmp_ge_u32 s3, 2
  s_cbranch_scc1 gated_mix__spectral_gfnet__ssm_conv_s5__prompt_kernel_skip29
  v_mov_b32 v14, v200
  v_mov_b32 v15, v201
  s_waitcnt lgkmcnt(0)
  v_mov_b32 v208, 0
  s_waitcnt lgkmcnt(0)
  v_mov_b32 v209, 0
gated_mix__spectral_gfnet__ssm_conv_s5__prompt_kernel_skip29:
  v_pk_mul_f32 v[164:165], v[194:195], v[14:15] op_sel:[0,0] op_sel_hi:[0,1]
  v_pk_fma_f32 v[164:165], v[194:195], v[14:15], v[164:165] op_sel:[1,1,0] op_sel_hi:[1,0,1] neg_lo:[1,0,0]
  s_waitcnt lgkmcnt(0)
  v_pk_fma_f32 v[12:13], v[194:195], v[208:209], v[12:13] op_sel:[0,0,0] op_sel_hi:[0,1,1]
  v_pk_fma_f32 v[12:13], v[194:195], v[208:209], v[12:13] op_sel:[1,1,0] op_sel_hi:[1,0,1] neg_lo:[1,0,0]
  s_mov_b32 exec_lo, 0
  v_mov_b32 v14, v164
  v_mov_b32 v15, v165
  v_mov_b32 v208, v12
  v_mov_b32 v209, v13
  s_mov_b64 exec, -1
  v_mov_b32 v9, v10
  buffer_load_dwordx4 v64, s[76:79], s32 offen offset:1024 lds
  v_pk_mul_f32 v[160:161], v[192:193], v[14:15] op_sel:[0,0] op_sel_hi:[0,1]
  v_pk_fma_f32 v[160:161], v[192:193], v[14:15], v[160:161] op_sel:[1,1,0] op_sel_hi:[1,0,1] neg_lo:[1,0,0]
  v_pk_fma_f32 v[8:9], v[192:193], v[208:209], v[8:9] op_sel:[0,0,0] op_sel_hi:[0,1,1]
  v_pk_fma_f32 v[8:9], v[192:193], v[208:209], v[8:9] op_sel:[1,1,0] op_sel_hi:[1,0,1] neg_lo:[1,0,0]
  v_pk_mul_f32 v[162:163], v[200:201], v[8:9] op_sel:[0,0] op_sel_hi:[0,1]
  v_pk_fma_f32 v[162:163], v[200:201], v[8:9], v[162:163] op_sel:[1,1,0] op_sel_hi:[1,0,1] neg_lo:[1,0,0]
  v_pk_mul_f32 v[164:165], v[200:201], v[208:209] op_sel:[0,0] op_sel_hi:[0,1]
  v_pk_fma_f32 v[164:165], v[200:201], v[208:209], v[164:165] op_sel:[1,1,0] op_sel_hi:[1,0,1] neg_lo:[1,0,0]
  s_add_u32 m0, s85, 32768
  s_nop 0
  buffer_load_dwordx4 v64, s[20:23], s33 offen offset:0 lds
  buffer_load_dwordx4 v64, s[76:79], s33 offen offset:1024 lds
  s_add_u32 m0, s85, 34816
  s_nop 0
  buffer_load_dwordx4 v64, s[20:23], s84 offen offset:0 lds
  buffer_load_dwordx4 v64, s[76:79], s84 offen offset:1024 lds
  buffer_load_dwordx2 v[12:13], v57, s[64:67], 0 offen offset:0 sc1
  buffer_load_dwordx2 v[166:167], v57, s[64:67], 0 offen offset:512 sc1
  buffer_load_dwordx2 v[196:197], v57, s[64:67], 0 offen offset:1024 sc1
  buffer_load_dwordx2 v[208:209], v57, s[64:67], 0 offen offset:1536 sc1
  buffer_load_dwordx2 v[8:9], v57, s[64:67], 0 offen offset:2048 sc1
  buffer_load_dwordx2 v[10:11], v57, s[64:67], 0 offen offset:2560 sc1
  buffer_load_dwordx2 v[168:169], v57, s[64:67], 0 offen offset:3072 sc1
  buffer_load_dwordx2 v[170:171], v57, s[64:67], 0 offen offset:3584 sc1
  s_add_u32 m0, s43, 114688
  s_nop 0
  buffer_load_dwordx4 v124, s[68:71], s28 offen offset:0 lds
  v_and_b32 v6, 7, v2
  v_lshlrev_b32 v56, 2, v3
  v_xor_b32 v6, v6, v56
  v_lshlrev_b32 v6, 4, v6
  v_lshl_or_b32 v6, v2, 10, v6
  s_lshl_b32 s29, s3, 8
  s_add_u32 s29, s29, 49152
  v_add_u32 v6, s29, v6
  s_waitcnt vmcnt(20)
  v_mov_b32 v172, v16
  s_waitcnt vmcnt(19)
  v_mov_b32 v173, v20
  s_waitcnt vmcnt(18)
  v_mov_b32 v174, v120
  s_waitcnt vmcnt(17)
  v_mov_b32 v175, v156
  v_mov_b32 v176, v17
  v_mov_b32 v177, v21
  v_mov_b32 v178, v121
  v_mov_b32 v179, v157
  v_mfma_f32_16x16x32_bf16 v[180:183], v[172:175], v[68:71], 0
  buffer_load_dwordx4 v125, s[68:71], s28 offen offset:1024 lds
  v_mfma_f32_16x16x32_bf16 v[192:195], v[172:175], v[72:75], 0
  v_mfma_f32_16x16x32_bf16 v[204:207], v[176:179], v[68:71], 0
  v_mfma_f32_16x16x32_bf16 v[212:215], v[176:179], v[72:75], 0
  v_mov_b32 v172, v18
  v_mov_b32 v173, v22
  v_mov_b32 v174, v122
  v_mov_b32 v175, v158
  v_mov_b32 v176, v19
  v_mov_b32 v177, v23
  s_add_u32 m0, s43, 116736
  s_nop 0
  buffer_load_dwordx4 v126, s[68:71], s28 offen offset:0 lds
  v_mov_b32 v178, v123
  v_mov_b32 v179, v159
  v_xor_b32 v56, 0, v6
  v_cvt_pk_bf16_f32 v156, v180, v192
  v_cvt_pk_bf16_f32 v157, v181, v193
  v_cvt_pk_bf16_f32 v158, v182, v194
  v_cvt_pk_bf16_f32 v159, v183, v195
  ds_write_b128 v56, v[156:159]
  v_mfma_f32_16x16x32_bf16 v[180:183], v[172:175], v[68:71], 0
  v_mfma_f32_16x16x32_bf16 v[192:195], v[172:175], v[72:75], 0
  v_xor_b32 v56, 16, v6
  v_cvt_pk_bf16_f32 v16, v204, v212
  buffer_load_dwordx4 v127, s[68:71], s28 offen offset:1024 lds
  v_cvt_pk_bf16_f32 v17, v205, v213
  v_cvt_pk_bf16_f32 v18, v206, v214
  v_cvt_pk_bf16_f32 v19, v207, v215
  ds_write_b128 v56, v[16:19]
  v_mfma_f32_16x16x32_bf16 v[204:207], v[176:179], v[68:71], 0
  v_mfma_f32_16x16x32_bf16 v[212:215], v[176:179], v[72:75], 0
  v_xor_b32 v56, 32, v6
  v_cvt_pk_bf16_f32 v20, v180, v192
  v_cvt_pk_bf16_f32 v21, v181, v193
  v_cvt_pk_bf16_f32 v22, v182, v194
  v_cvt_pk_bf16_f32 v23, v183, v195
  ds_write_b128 v56, v[20:23]
  v_xor_b32 v56, 48, v6
  s_nop 0
  v_cvt_pk_bf16_f32 v120, v204, v212
  v_cvt_pk_bf16_f32 v121, v205, v213
  v_cvt_pk_bf16_f32 v122, v206, v214
  v_cvt_pk_bf16_f32 v123, v207, v215
  ds_write_b128 v56, v[120:123]
  s_waitcnt vmcnt(4)
  v_max_u32 v6, v12, v13
  v_max3_u32 v6, v6, v166, v167
  v_max3_u32 v6, v6, v196, v197
  v_max3_u32 v6, v6, v208, v209
  v_max3_u32 v6, v6, v8, v9
  v_max3_u32 v6, v6, v10, v11
  v_max3_u32 v6, v6, v168, v169
  v_max3_u32 v6, v6, v170, v171
  v_cmp_eq_u32 vcc, -1, v6
  s_nop 0
  s_cbranch_vccz gated_mix__spectral_gfnet__ssm_conv_s5__prompt_kernel_skip30
  s_mov_b32 s29, 0
gated_mix__spectral_gfnet__ssm_conv_s5__prompt_kernel_lb31:
  buffer_load_dwordx2 v[12:13], v57, s[64:67], 0 offen offset:0 sc1
  buffer_load_dwordx2 v[166:167], v57, s[64:67], 0 offen offset:512 sc1
  buffer_load_dwordx2 v[196:197], v57, s[64:67], 0 offen offset:1024 sc1
  buffer_load_dwordx2 v[208:209], v57, s[64:67], 0 offen offset:1536 sc1
  buffer_load_dwordx2 v[8:9], v57, s[64:67], 0 offen offset:2048 sc1
  buffer_load_dwordx2 v[10:11], v57, s[64:67], 0 offen offset:2560 sc1
  buffer_load_dwordx2 v[168:169], v57, s[64:67], 0 offen offset:3072 sc1
  buffer_load_dwordx2 v[170:171], v57, s[64:67], 0 offen offset:3584 sc1
  s_waitcnt vmcnt(0)
  v_max_u32 v6, v12, v13
  v_max3_u32 v6, v6, v166, v167
  v_max3_u32 v6, v6, v196, v197
  v_max3_u32 v6, v6, v208, v209
  v_max3_u32 v6, v6, v8, v9
  v_max3_u32 v6, v6, v10, v11
  v_max3_u32 v6, v6, v168, v169
  v_max3_u32 v6, v6, v170, v171
  v_cmp_eq_u32 vcc, -1, v6
  s_nop 0
  s_cbranch_vccz gated_mix__spectral_gfnet__ssm_conv_s5__prompt_kernel_lbout32
  s_add_u32 s29, s29, 1
  s_cmp_lt_u32 s29, 1048576
  s_cbranch_scc1 gated_mix__spectral_gfnet__ssm_conv_s5__prompt_kernel_lb31
gated_mix__spectral_gfnet__ssm_conv_s5__prompt_kernel_lbout32:
gated_mix__spectral_gfnet__ssm_conv_s5__prompt_kernel_skip30:
  s_add_u32 s12, s34, 10485760
  s_addc_u32 s13, s35, 0
  s_mov_b32 s14, 8388608
  s_mov_b32 s15, 0x20000
  v_pk_fma_f32 v[168:169], v[202:203], v[170:171], v[168:169] op_sel:[0,0,0] op_sel_hi:[0,1,1]
  v_pk_fma_f32 v[168:169], v[202:203], v[170:171], v[168:169] op_sel:[1,1,0] op_sel_hi:[1,0,1] neg_lo:[1,0,0]
  v_pk_fma_f32 v[10:11], v[202:203], v[168:169], v[10:11] op_sel:[0,0,0] op_sel_hi:[0,1,1]
  v_pk_fma_f32 v[10:11], v[202:203], v[168:169], v[10:11] op_sel:[1,1,0] op_sel_hi:[1,0,1] neg_lo:[1,0,0]
  v_pk_fma_f32 v[8:9], v[202:203], v[10:11], v[8:9] op_sel:[0,0,0] op_sel_hi:[0,1,1]
  v_pk_fma_f32 v[8:9], v[202:203], v[10:11], v[8:9] op_sel:[1,1,0] op_sel_hi:[1,0,1] neg_lo:[1,0,0]
  v_pk_fma_f32 v[208:209], v[202:203], v[8:9], v[208:209] op_sel:[0,0,0] op_sel_hi:[0,1,1]
  v_pk_fma_f32 v[208:209], v[202:203], v[8:9], v[208:209] op_sel:[1,1,0] op_sel_hi:[1,0,1] neg_lo:[1,0,0]
  v_pk_fma_f32 v[196:197], v[202:203], v[208:209], v[196:197] op_sel:[0,0,0] op_sel_hi:[0,1,1]
  v_pk_fma_f32 v[196:197], v[202:203], v[208:209], v[196:197] op_sel:[1,1,0] op_sel_hi:[1,0,1] neg_lo:[1,0,0]
  v_pk_fma_f32 v[166:167], v[202:203], v[196:197], v[166:167] op_sel:[0,0,0] op_sel_hi:[0,1,1]
  v_pk_fma_f32 v[166:167], v[202:203], v[196:197], v[166:167] op_sel:[1,1,0] op_sel_hi:[1,0,1] neg_lo:[1,0,0]
  v_pk_fma_f32 v[12:13], v[202:203], v[166:167], v[12:13] op_sel:[0,0,0] op_sel_hi:[0,1,1]
  v_pk_fma_f32 v[12:13], v[202:203], v[166:167], v[12:13] op_sel:[1,1,0] op_sel_hi:[1,0,1] neg_lo:[1,0,0]
  v_mov_b32 v166, v12
  v_mov_b32 v167, v13
  s_nop 0
  v_permlane32_swap_b32 v12, v166
  v_permlane32_swap_b32 v13, v167
  v_pk_fma_f32 v[12:13], v[198:199], v[166:167], v[12:13] op_sel:[0,0,0] op_sel_hi:[0,1,1]
  v_pk_fma_f32 v[12:13], v[198:199], v[166:167], v[12:13] op_sel:[1,1,0] op_sel_hi:[1,0,1] neg_lo:[1,0,0]
  v_pk_fma_f32 v[164:165], v[14:15], v[12:13], v[164:165] op_sel:[0,0,0] op_sel_hi:[0,1,1]
  v_pk_fma_f32 v[164:165], v[14:15], v[12:13], v[164:165] op_sel:[1,1,0] op_sel_hi:[1,0,1] neg_lo:[1,0,0]
  v_pk_fma_f32 v[162:163], v[160:161], v[12:13], v[162:163] op_sel:[0,0,0] op_sel_hi:[0,1,1]
  v_pk_fma_f32 v[162:163], v[160:161], v[12:13], v[162:163] op_sel:[1,1,0] op_sel_hi:[1,0,1] neg_lo:[1,0,0]
  v_swap_b32 v165, v162
  v_pk_fma_f32 v[40:41], v[190:191], v[164:165], v[40:41] op_sel:[0,0,0] op_sel_hi:[0,1,1]
  v_pk_fma_f32 v[88:89], v[190:191], v[162:163], v[88:89] op_sel:[0,0,0] op_sel_hi:[0,1,1]
  v_pk_fma_f32 v[40:41], v[190:191], v[162:163], v[40:41] op_sel:[1,0,0] op_sel_hi:[1,1,1] neg_lo:[1,0,0] neg_hi:[1,0,0]
  v_pk_fma_f32 v[88:89], v[190:191], v[164:165], v[88:89] op_sel:[1,0,0] op_sel_hi:[1,1,1]
  v_cvt_pk_bf16_f32 v16, v40, v41
  v_cvt_pk_bf16_f32 v17, -v88, -v89
  v_pk_fma_f32 v[42:43], v[190:191], v[40:41], v[42:43] op_sel:[0,0,0] op_sel_hi:[0,1,1]
  v_pk_fma_f32 v[90:91], v[190:191], v[88:89], v[90:91] op_sel:[0,0,0] op_sel_hi:[0,1,1]
  v_pk_fma_f32 v[42:43], v[190:191], v[88:89], v[42:43] op_sel:[1,0,0] op_sel_hi:[1,1,1] neg_lo:[1,0,0] neg_hi:[1,0,0]
  v_pk_fma_f32 v[90:91], v[190:191], v[40:41], v[90:91] op_sel:[1,0,0] op_sel_hi:[1,1,1]
  v_cvt_pk_bf16_f32 v18, v42, v43
  v_cvt_pk_bf16_f32 v19, -v90, -v91
  v_pk_fma_f32 v[44:45], v[190:191], v[42:43], v[44:45] op_sel:[0,0,0] op_sel_hi:[0,1,1]
  v_pk_fma_f32 v[92:93], v[190:191], v[90:91], v[92:93] op_sel:[0,0,0] op_sel_hi:[0,1,1]
  v_permlane32_swap_b32 v16, v17
  v_permlane32_swap_b32 v18, v19
  v_pk_fma_f32 v[44:45], v[190:191], v[90:91], v[44:45] op_sel:[1,0,0] op_sel_hi:[1,1,1] neg_lo:[1,0,0] neg_hi:[1,0,0]
  v_pk_fma_f32 v[92:93], v[190:191], v[42:43], v[92:93] op_sel:[1,0,0] op_sel_hi:[1,1,1]
  v_permlane16_swap_b32 v16, v18
  v_permlane16_swap_b32 v17, v19
  buffer_store_dwordx4 v[16:19], v58, s[12:15], s87 offen sc1
  s_add_u32 s87, s87, 1048576
  v_cvt_pk_bf16_f32 v20, v44, v45
  v_cvt_pk_bf16_f32 v21, -v92, -v93
  v_pk_fma_f32 v[46:47], v[190:191], v[44:45], v[46:47] op_sel:[0,0,0] op_sel_hi:[0,1,1]
  v_pk_fma_f32 v[94:95], v[190:191], v[92:93], v[94:95] op_sel:[0,0,0] op_sel_hi:[0,1,1]
  v_pk_fma_f32 v[46:47], v[190:191], v[92:93], v[46:47] op_sel:[1,0,0] op_sel_hi:[1,1,1] neg_lo:[1,0,0] neg_hi:[1,0,0]
  v_pk_fma_f32 v[94:95], v[190:191], v[44:45], v[94:95] op_sel:[1,0,0] op_sel_hi:[1,1,1]
  v_cvt_pk_bf16_f32 v22, v46, v47
  v_cvt_pk_bf16_f32 v23, -v94, -v95
  v_pk_fma_f32 v[48:49], v[190:191], v[46:47], v[48:49] op_sel:[0,0,0] op_sel_hi:[0,1,1]
  v_pk_fma_f32 v[96:97], v[190:191], v[94:95], v[96:97] op_sel:[0,0,0] op_sel_hi:[0,1,1]
  v_permlane32_swap_b32 v20, v21
  v_permlane32_swap_b32 v22, v23
  v_pk_fma_f32 v[48:49], v[190:191], v[94:95], v[48:49] op_sel:[1,0,0] op_sel_hi:[1,1,1] neg_lo:[1,0,0] neg_hi:[1,0,0]
  v_pk_fma_f32 v[96:97], v[190:191], v[46:47], v[96:97] op_sel:[1,0,0] op_sel_hi:[1,1,1]
  v_permlane16_swap_b32 v20, v22
  v_permlane16_swap_b32 v21, v23
  buffer_store_dwordx4 v[20:23], v58, s[12:15], s87 offen sc1
  s_add_u32 s87, s87, 1048576
  v_cvt_pk_bf16_f32 v68, v48, v49
  v_cvt_pk_bf16_f32 v69, -v96, -v97
  v_pk_fma_f32 v[50:51], v[190:191], v[48:49], v[50:51] op_sel:[0,0,0] op_sel_hi:[0,1,1]
  v_pk_fma_f32 v[98:99], v[190:191], v[96:97], v[98:99] op_sel:[0,0,0] op_sel_hi:[0,1,1]
  v_pk_fma_f32 v[50:51], v[190:191], v[96:97], v[50:51] op_sel:[1,0,0] op_sel_hi:[1,1,1] neg_lo:[1,0,0] neg_hi:[1,0,0]
  v_pk_fma_f32 v[98:99], v[190:191], v[48:49], v[98:99] op_sel:[1,0,0] op_sel_hi:[1,1,1]
  v_cvt_pk_bf16_f32 v70, v50, v51
  v_cvt_pk_bf16_f32 v71, -v98, -v99
  v_pk_fma_f32 v[52:53], v[190:191], v[50:51], v[52:53] op_sel:[0,0,0] op_sel_hi:[0,1,1]
  v_pk_fma_f32 v[100:101], v[190:191], v[98:99], v[100:101] op_sel:[0,0,0] op_sel_hi:[0,1,1]
  v_permlane32_swap_b32 v68, v69
  v_permlane32_swap_b32 v70, v71
  v_pk_fma_f32 v[52:53], v[190:191], v[98:99], v[52:53] op_sel:[1,0,0] op_sel_hi:[1,1,1] neg_lo:[1,0,0] neg_hi:[1,0,0]
  v_pk_fma_f32 v[100:101], v[190:191], v[50:51], v[100:101] op_sel:[1,0,0] op_sel_hi:[1,1,1]
  v_permlane16_swap_b32 v68, v70
  v_permlane16_swap_b32 v69, v71
  buffer_store_dwordx4 v[68:71], v58, s[12:15], s87 offen sc1
  s_add_u32 s87, s87, 1048576
  v_cvt_pk_bf16_f32 v16, v52, v53
  v_cvt_pk_bf16_f32 v17, -v100, -v101
  v_pk_fma_f32 v[54:55], v[190:191], v[52:53], v[54:55] op_sel:[0,0,0] op_sel_hi:[0,1,1]
  v_pk_fma_f32 v[102:103], v[190:191], v[100:101], v[102:103] op_sel:[0,0,0] op_sel_hi:[0,1,1]
  v_pk_fma_f32 v[54:55], v[190:191], v[100:101], v[54:55] op_sel:[1,0,0] op_sel_hi:[1,1,1] neg_lo:[1,0,0] neg_hi:[1,0,0]
  v_pk_fma_f32 v[102:103], v[190:191], v[52:53], v[102:103] op_sel:[1,0,0] op_sel_hi:[1,1,1]
  v_cvt_pk_bf16_f32 v18, v54, v55
  v_cvt_pk_bf16_f32 v19, -v102, -v103
  v_pk_fma_f32 v[104:105], v[190:191], v[54:55], v[104:105] op_sel:[0,0,0] op_sel_hi:[0,1,1]
  v_pk_fma_f32 v[140:141], v[190:191], v[102:103], v[140:141] op_sel:[0,0,0] op_sel_hi:[0,1,1]
  v_permlane32_swap_b32 v16, v17
  v_permlane32_swap_b32 v18, v19
  v_pk_fma_f32 v[104:105], v[190:191], v[102:103], v[104:105] op_sel:[1,0,0] op_sel_hi:[1,1,1] neg_lo:[1,0,0] neg_hi:[1,0,0]
  v_pk_fma_f32 v[140:141], v[190:191], v[54:55], v[140:141] op_sel:[1,0,0] op_sel_hi:[1,1,1]
  v_permlane16_swap_b32 v16, v18
  v_permlane16_swap_b32 v17, v19
  buffer_store_dwordx4 v[16:19], v58, s[12:15], s87 offen sc1
  s_add_u32 s87, s87, 1048576
  v_cvt_pk_bf16_f32 v20, v104, v105
  v_cvt_pk_bf16_f32 v21, -v140, -v141
  v_pk_fma_f32 v[106:107], v[190:191], v[104:105], v[106:107] op_sel:[0,0,0] op_sel_hi:[0,1,1]
  v_pk_fma_f32 v[142:143], v[190:191], v[140:141], v[142:143] op_sel:[0,0,0] op_sel_hi:[0,1,1]
  v_pk_fma_f32 v[106:107], v[190:191], v[140:141], v[106:107] op_sel:[1,0,0] op_sel_hi:[1,1,1] neg_lo:[1,0,0] neg_hi:[1,0,0]
  v_pk_fma_f32 v[142:143], v[190:191], v[104:105], v[142:143] op_sel:[1,0,0] op_sel_hi:[1,1,1]
  v_cvt_pk_bf16_f32 v22, v106, v107
  v_cvt_pk_bf16_f32 v23, -v142, -v143
  v_pk_fma_f32 v[108:109], v[190:191], v[106:107], v[108:109] op_sel:[0,0,0] op_sel_hi:[0,1,1]
  v_pk_fma_f32 v[144:145], v[190:191], v[142:143], v[144:145] op_sel:[0,0,0] op_sel_hi:[0,1,1]
  v_permlane32_swap_b32 v20, v21
  v_permlane32_swap_b32 v22, v23
  v_pk_fma_f32 v[108:109], v[190:191], v[142:143], v[108:109] op_sel:[1,0,0] op_sel_hi:[1,1,1] neg_lo:[1,0,0] neg_hi:[1,0,0]
  v_pk_fma_f32 v[144:145], v[190:191], v[106:107], v[144:145] op_sel:[1,0,0] op_sel_hi:[1,1,1]
  v_permlane16_swap_b32 v20, v22
  v_permlane16_swap_b32 v21, v23
  buffer_store_dwordx4 v[20:23], v58, s[12:15], s87 offen sc1
  s_add_u32 s87, s87, 1048576
  v_cvt_pk_bf16_f32 v68, v108, v109
  v_cvt_pk_bf16_f32 v69, -v144, -v145
  v_pk_fma_f32 v[110:111], v[190:191], v[108:109], v[110:111] op_sel:[0,0,0] op_sel_hi:[0,1,1]
  v_pk_fma_f32 v[146:147], v[190:191], v[144:145], v[146:147] op_sel:[0,0,0] op_sel_hi:[0,1,1]
  v_pk_fma_f32 v[110:111], v[190:191], v[144:145], v[110:111] op_sel:[1,0,0] op_sel_hi:[1,1,1] neg_lo:[1,0,0] neg_hi:[1,0,0]
  v_pk_fma_f32 v[146:147], v[190:191], v[108:109], v[146:147] op_sel:[1,0,0] op_sel_hi:[1,1,1]
  v_cvt_pk_bf16_f32 v70, v110, v111
  v_cvt_pk_bf16_f32 v71, -v146, -v147
  v_pk_fma_f32 v[112:113], v[190:191], v[110:111], v[112:113] op_sel:[0,0,0] op_sel_hi:[0,1,1]
  v_pk_fma_f32 v[148:149], v[190:191], v[146:147], v[148:149] op_sel:[0,0,0] op_sel_hi:[0,1,1]
  v_permlane32_swap_b32 v68, v69
  v_permlane32_swap_b32 v70, v71
  v_pk_fma_f32 v[112:113], v[190:191], v[146:147], v[112:113] op_sel:[1,0,0] op_sel_hi:[1,1,1] neg_lo:[1,0,0] neg_hi:[1,0,0]
  v_pk_fma_f32 v[148:149], v[190:191], v[110:111], v[148:149] op_sel:[1,0,0] op_sel_hi:[1,1,1]
  v_permlane16_swap_b32 v68, v70
  v_permlane16_swap_b32 v69, v71
  buffer_store_dwordx4 v[68:71], v58, s[12:15], s87 offen sc1
  s_add_u32 s87, s87, 1048576
  v_cvt_pk_bf16_f32 v16, v112, v113
  v_cvt_pk_bf16_f32 v17, -v148, -v149
  v_pk_fma_f32 v[114:115], v[190:191], v[112:113], v[114:115] op_sel:[0,0,0] op_sel_hi:[0,1,1]
  v_pk_fma_f32 v[150:151], v[190:191], v[148:149], v[150:151] op_sel:[0,0,0] op_sel_hi:[0,1,1]
  v_pk_fma_f32 v[114:115], v[190:191], v[148:149], v[114:115] op_sel:[1,0,0] op_sel_hi:[1,1,1] neg_lo:[1,0,0] neg_hi:[1,0,0]
  v_pk_fma_f32 v[150:151], v[190:191], v[112:113], v[150:151] op_sel:[1,0,0] op_sel_hi:[1,1,1]
  v_cvt_pk_bf16_f32 v18, v114, v115
  v_cvt_pk_bf16_f32 v19, -v150, -v151
  v_pk_fma_f32 v[116:117], v[190:191], v[114:115], v[116:117] op_sel:[0,0,0] op_sel_hi:[0,1,1]
  v_pk_fma_f32 v[152:153], v[190:191], v[150:151], v[152:153] op_sel:[0,0,0] op_sel_hi:[0,1,1]
  v_permlane32_swap_b32 v16, v17
  v_permlane32_swap_b32 v18, v19
  v_pk_fma_f32 v[116:117], v[190:191], v[150:151], v[116:117] op_sel:[1,0,0] op_sel_hi:[1,1,1] neg_lo:[1,0,0] neg_hi:[1,0,0]
  v_pk_fma_f32 v[152:153], v[190:191], v[114:115], v[152:153] op_sel:[1,0,0] op_sel_hi:[1,1,1]
  v_permlane16_swap_b32 v16, v18
  v_permlane16_swap_b32 v17, v19
  buffer_store_dwordx4 v[16:19], v58, s[12:15], s87 offen sc1
  s_add_u32 s87, s87, 1048576
  v_cvt_pk_bf16_f32 v20, v116, v117
  v_cvt_pk_bf16_f32 v21, -v152, -v153
  v_pk_fma_f32 v[118:119], v[190:191], v[116:117], v[118:119] op_sel:[0,0,0] op_sel_hi:[0,1,1]
  v_pk_fma_f32 v[154:155], v[190:191], v[152:153], v[154:155] op_sel:[0,0,0] op_sel_hi:[0,1,1]
  v_pk_fma_f32 v[118:119], v[190:191], v[152:153], v[118:119] op_sel:[1,0,0] op_sel_hi:[1,1,1] neg_lo:[1,0,0] neg_hi:[1,0,0]
  v_pk_fma_f32 v[154:155], v[190:191], v[116:117], v[154:155] op_sel:[1,0,0] op_sel_hi:[1,1,1]
  v_cvt_pk_bf16_f32 v22, v118, v119
  v_cvt_pk_bf16_f32 v23, -v154, -v155
  v_permlane32_swap_b32 v20, v21
  s_nop 0
  v_permlane32_swap_b32 v22, v23
  s_nop 1
  v_permlane16_swap_b32 v20, v22
  v_permlane16_swap_b32 v21, v23
  buffer_store_dwordx4 v[20:23], v58, s[12:15], s87 offen sc1
  s_cmp_lg_u32 s4, 0
  s_cbranch_scc1 gated_mix__spectral_gfnet__ssm_conv_s5__prompt_kernel_skip33
  s_mul_i32 exec_lo, s86, 0x300
  s_or_b32 exec_lo, exec_lo, 0xff
  s_mov_b32 exec_hi, 0
  ds_read_u16_d16_hi v56, v189
  ds_read_u16_d16_hi v57, v189 offset:1024
  s_waitcnt lgkmcnt(1)
  v_add_f32 v56, v56, v210
  s_waitcnt lgkmcnt(0)
  v_sub_f32 v57, v57, v211
  v_mul_f32 v56, 0.5, v56
  v_mul_f32 v57, 0.5, v57
  v_cvt_pk_bf16_f32 v56, v56, v57
  ds_write_b16 v189, v56
  ds_write_b16_d16_hi v189, v56 offset:1024
  s_mov_b64 exec, -1
gated_mix__spectral_gfnet__ssm_conv_s5__prompt_kernel_skip33:
  s_cmp_eq_u32 s86, 0
  s_cbranch_scc1 gated_mix__spectral_gfnet__ssm_conv_s5__prompt_kernel_skip34
  v_add_u32 v64, 147456, v65
  ds_read_u16_d16_hi v56, v64 offset:0
  ds_read_u16_d16_hi v68, v64 offset:1024
  ds_read_u16_d16_hi v57, v64 offset:128
  ds_read_u16_d16_hi v69, v64 offset:1152
  ds_read_u16_d16_hi v58, v64 offset:256
  ds_read_u16_d16_hi v70, v64 offset:1280
  ds_read_u16_d16_hi v59, v64 offset:384
  ds_read_u16_d16_hi v71, v64 offset:1408
gated_mix__spectral_gfnet__ssm_conv_s5__prompt_kernel_skip34:
  ds_read_u16_d16_hi v8, v65 offset:0
  ds_read_u16_d16_hi v12, v65 offset:1024
  ds_read_u16_d16_hi v9, v65 offset:128
  ds_read_u16_d16_hi v13, v65 offset:1152
  ds_read_u16_d16_hi v10, v65 offset:256
  ds_read_u16_d16_hi v14, v65 offset:1280
  ds_read_u16_d16_hi v11, v65 offset:384
  ds_read_u16_d16_hi v15, v65 offset:1408
  ds_read_u16_d16_hi v16, v65 offset:16384
  ds_read_u16_d16_hi v20, v65 offset:17408
  ds_read_u16_d16_hi v17, v65 offset:16512
  ds_read_u16_d16_hi v21, v65 offset:17536
  ds_read_u16_d16_hi v18, v65 offset:16640
  ds_read_u16_d16_hi v22, v65 offset:17664
  ds_read_u16_d16_hi v19, v65 offset:16768
  ds_read_u16_d16_hi v23, v65 offset:17792
  v_add_u32 v64, 81920, v65
  ds_read_u16_d16_hi v40, v64 offset:0
  ds_read_u16_d16_hi v44, v64 offset:1024
  ds_read_u16_d16_hi v41, v64 offset:128
  ds_read_u16_d16_hi v45, v64 offset:1152
  ds_read_u16_d16_hi v42, v64 offset:256
  ds_read_u16_d16_hi v46, v64 offset:1280
  ds_read_u16_d16_hi v43, v64 offset:384
  ds_read_u16_d16_hi v47, v64 offset:1408
  ds_read_u16_d16_hi v48, v65 offset:32768
  ds_read_u16_d16_hi v52, v65 offset:33792
  ds_read_u16_d16_hi v49, v65 offset:32896
  ds_read_u16_d16_hi v53, v65 offset:33920
  ds_read_u16_d16_hi v50, v65 offset:33024
  ds_read_u16_d16_hi v54, v65 offset:34048
  ds_read_u16_d16_hi v51, v65 offset:33152
  ds_read_u16_d16_hi v55, v65 offset:34176
  v_xor_b32 v130, 0x30000, v130
  v_xor_b32 v131, 0x30000, v131
  ds_read_b128 a[0:3], v130 offset:0
  ds_read_b128 a[4:7], v131 offset:0
  ds_read_b128 a[8:11], v130 offset:2048
  ds_read_b128 a[12:15], v131 offset:2048
  v_xor_b32 v130, 0x30000, v130
  v_xor_b32 v131, 0x30000, v131
  ds_read_b128 a[16:19], v130 offset:0
  ds_read_b128 a[20:23], v131 offset:0
  ds_read_b128 a[24:27], v130 offset:2048
  ds_read_b128 a[28:31], v131 offset:2048
  s_waitcnt vmcnt(8)
  ds_read_b128 a[32:35], v130 offset:49152
  ds_read_b128 a[36:39], v131 offset:49152
  ds_read_b128 a[40:43], v130 offset:51200
  ds_read_b128 a[44:47], v131 offset:51200
  s_waitcnt lgkmcnt(12)
  v_pk_mul_f32 v[12:13], v[66:67], v[12:13] op_sel_hi:[0,1]
  v_pk_mul_f32 v[14:15], v[66:67], v[14:15] op_sel_hi:[0,1]
  v_pk_mul_f32 v[20:21], v[66:67], v[20:21] op_sel_hi:[0,1]
  v_pk_mul_f32 v[22:23], v[66:67], v[22:23] op_sel_hi:[0,1]
  v_pk_mul_f32 v[44:45], v[66:67], v[44:45] op_sel_hi:[0,1]
  v_pk_mul_f32 v[46:47], v[66:67], v[46:47] op_sel_hi:[0,1]
  v_pk_mul_f32 v[52:53], v[66:67], v[52:53] op_sel_hi:[0,1]
  v_pk_mul_f32 v[54:55], v[66:67], v[54:55] op_sel_hi:[0,1]
  v_pk_mul_f32 v[68:69], v[66:67], v[68:69] op_sel_hi:[0,1]
  v_pk_mul_f32 v[70:71], v[66:67], v[70:71] op_sel_hi:[0,1]
  s_cmp_lg_u32 s3, 3
  s_cbranch_scc1 gated_mix__spectral_gfnet__ssm_conv_s5__prompt_kernel_skip36
  s_getpc_b64 s[6:7]
gated_mix__spectral_gfnet__ssm_conv_s5__prompt_kernel_pc35:
  s_lshr_b32 s29, s2, 3
  s_mul_i32 s29, s29, 512
  v_min_u32 v64, 3, v1
  v_lshl_add_u32 v64, v64, 7, s29
  v_min_u32 v64, gated_mix__spectral_gfnet__ssm_conv_s5__prompt_kernel_end-gated_mix__spectral_gfnet__ssm_conv_s5__prompt_kernel_pc35, v64
  v_mov_b32 v65, 0
  v_lshl_add_u64 v[64:65], v[64:65], 0, s[6:7]
  global_load_dword v4, v[64:65], off
gated_mix__spectral_gfnet__ssm_conv_s5__prompt_kernel_skip36:
  s_barrier
  s_lshr_b32 s29, s41, 3
  s_lshl2_add_u32 s29, s29, s3
  s_lshl_b32 s29, s29, 12
  v_lshl_add_u32 v6, v1, 7, s29
  s_add_u32 m0, s43, 98304
  s_nop 0
  buffer_load_dwordx4 v124, s[72:75], s28 offen offset:0 lds
  s_and_b32 s29, s3, 1
  s_lshl_b32 s29, s29, 2
  v_xor_b32 v65, s29, v1
  s_lshl_b32 s29, s3, 12
  s_add_u32 s29, s29, 49152
  v_lshl_add_u32 v66, v65, 4, s29
  v_xor_b32 v65, 0, v66
  ds_read_b128 v[72:75], v65 offset:0
  v_xor_b32 v65, 16, v66
  ds_read_b128 v[88:91], v65 offset:1024
  v_xor_b32 v65, 32, v66
  ds_read_b128 v[92:95], v65 offset:2048
  v_xor_b32 v65, 48, v66
  ds_read_b128 v[96:99], v65 offset:3072
  s_waitcnt lgkmcnt(3)
  v_mfma_f32_16x16x32_bf16 v[100:103], v[72:75], v[76:79], 0
  v_mfma_f32_16x16x32_bf16 v[104:107], v[72:75], v[80:83], 0
  buffer_load_dwordx4 v125, s[72:75], s28 offen offset:1024 lds
  s_waitcnt lgkmcnt(2)
  v_mfma_f32_16x16x32_bf16 v[108:111], v[88:91], v[76:79], 0
  v_mfma_f32_16x16x32_bf16 v[112:115], v[88:91], v[80:83], 0
  s_waitcnt lgkmcnt(1)
  v_mfma_f32_16x16x32_bf16 v[116:119], v[92:95], v[76:79], 0
  v_mfma_f32_16x16x32_bf16 v[120:123], v[92:95], v[80:83], 0
  s_waitcnt lgkmcnt(0)
  v_mfma_f32_16x16x32_bf16 v[140:143], v[96:99], v[76:79], 0
  s_add_u32 m0, s43, 100352
  s_nop 0
  buffer_load_dwordx4 v126, s[72:75], s28 offen offset:0 lds
  v_mfma_f32_16x16x32_bf16 v[144:147], v[96:99], v[80:83], 0
  v_pk_mul_f32 v[148:149], v[100:101], v[84:85]
  v_pk_mul_f32 v[150:151], v[104:105], v[84:85]
  v_pk_fma_f32 v[148:149], v[104:105], v[132:133], v[148:149]
  v_pk_fma_f32 v[150:151], v[100:101], v[132:133], v[150:151] neg_lo:[0,1,0] neg_hi:[0,1,0]
  v_cvt_pk_bf16_f32 v72, v148, v150
  v_cvt_pk_bf16_f32 v73, v149, v151
  v_pk_mul_f32 v[148:149], v[102:103], v[86:87]
  v_pk_mul_f32 v[150:151], v[106:107], v[86:87]
  v_pk_fma_f32 v[148:149], v[106:107], v[134:135], v[148:149]
  v_pk_fma_f32 v[150:151], v[102:103], v[134:135], v[150:151] neg_lo:[0,1,0] neg_hi:[0,1,0]
  v_cvt_pk_bf16_f32 v74, v148, v150
  v_cvt_pk_bf16_f32 v75, v149, v151
  v_pk_mul_f32 v[148:149], v[108:109], v[84:85]
  v_pk_mul_f32 v[150:151], v[112:113], v[84:85]
  v_pk_fma_f32 v[148:149], v[112:113], v[132:133], v[148:149]
  v_pk_fma_f32 v[150:151], v[108:109], v[132:133], v[150:151] neg_lo:[0,1,0] neg_hi:[0,1,0]
  buffer_load_dwordx4 v127, s[72:75], s28 offen offset:1024 lds
  s_add_u32 s28, s28, 128
  s_and_b32 s28, s28, 0x3ff
  v_cvt_pk_bf16_f32 v88, v148, v150
  v_cvt_pk_bf16_f32 v89, v149, v151
  v_pk_mul_f32 v[148:149], v[110:111], v[86:87]
  v_pk_mul_f32 v[150:151], v[114:115], v[86:87]
  v_pk_fma_f32 v[148:149], v[114:115], v[134:135], v[148:149]
  v_pk_fma_f32 v[150:151], v[110:111], v[134:135], v[150:151] neg_lo:[0,1,0] neg_hi:[0,1,0]
  v_cvt_pk_bf16_f32 v90, v148, v150
  v_cvt_pk_bf16_f32 v91, v149, v151
  v_mfma_f32_16x16x32_bf16 v[100:103], a[224:227], v[72:75], 0
  v_mfma_f32_16x16x32_bf16 v[104:107], a[228:231], v[72:75], 0
  v_pk_mul_f32 v[148:149], v[116:117], v[84:85]
  v_pk_mul_f32 v[150:151], v[120:121], v[84:85]
  v_pk_fma_f32 v[148:149], v[120:121], v[132:133], v[148:149]
  v_pk_fma_f32 v[150:151], v[116:117], v[132:133], v[150:151] neg_lo:[0,1,0] neg_hi:[0,1,0]
  s_add_u32 m0, s43, 131072
  s_nop 0
  buffer_load_dwordx4 v124, s[68:71], s28 offen offset:0 lds
  v_cvt_pk_bf16_f32 v92, v148, v150
  v_cvt_pk_bf16_f32 v93, v149, v151
  v_pk_mul_f32 v[148:149], v[118:119], v[86:87]
  v_pk_mul_f32 v[150:151], v[122:123], v[86:87]
  v_pk_fma_f32 v[148:149], v[122:123], v[134:135], v[148:149]
  v_pk_fma_f32 v[150:151], v[118:119], v[134:135], v[150:151] neg_lo:[0,1,0] neg_hi:[0,1,0]
  v_cvt_pk_bf16_f32 v94, v148, v150
  v_cvt_pk_bf16_f32 v95, v149, v151
  v_mfma_f32_16x16x32_bf16 v[108:111], a[224:227], v[88:91], 0
  v_mfma_f32_16x16x32_bf16 v[112:115], a[228:231], v[88:91], 0
  v_pk_mul_f32 v[148:149], v[140:141], v[84:85]
  v_pk_mul_f32 v[150:151], v[144:145], v[84:85]
  v_pk_fma_f32 v[148:149], v[144:145], v[132:133], v[148:149]
  v_pk_fma_f32 v[150:151], v[140:141], v[132:133], v[150:151] neg_lo:[0,1,0] neg_hi:[0,1,0]
  buffer_load_dwordx4 v125, s[68:71], s28 offen offset:1024 lds
  v_cvt_pk_bf16_f32 v96, v148, v150
  v_cvt_pk_bf16_f32 v97, v149, v151
  v_pk_mul_f32 v[148:149], v[142:143], v[86:87]
  v_pk_mul_f32 v[150:151], v[146:147], v[86:87]
  v_pk_fma_f32 v[148:149], v[146:147], v[134:135], v[148:149]
  v_pk_fma_f32 v[150:151], v[142:143], v[134:135], v[150:151] neg_lo:[0,1,0] neg_hi:[0,1,0]
  v_cvt_pk_bf16_f32 v98, v148, v150
  v_cvt_pk_bf16_f32 v99, v149, v151
  v_mfma_f32_16x16x32_bf16 v[116:119], a[224:227], v[92:95], 0
  v_mfma_f32_16x16x32_bf16 v[120:123], a[228:231], v[92:95], 0
  v_mfma_f32_16x16x32_bf16 v[140:143], a[224:227], v[96:99], 0
  s_add_u32 m0, s43, 133120
  s_nop 0
  buffer_load_dwordx4 v126, s[68:71], s28 offen offset:0 lds
  v_mfma_f32_16x16x32_bf16 v[144:147], a[228:231], v[96:99], 0
  s_waitcnt vmcnt(7)
  s_barrier
  s_cmp_lg_u32 s3, 0
  s_cbranch_scc1 gated_mix__spectral_gfnet__ssm_conv_s5__prompt_kernel_skip37
  s_mov_b64 exec, 65535
  buffer_store_dword v5, v39, s[16:19], s57 offen sc1
  s_mov_b64 exec, -1
gated_mix__spectral_gfnet__ssm_conv_s5__prompt_kernel_skip37:
  s_cmp_eq_u32 s10, 0
  s_cbranch_scc1 gated_mix__spectral_gfnet__ssm_conv_s5__prompt_kernel_skip38
  v_pk_mul_f32 v[148:149], v[100:101], v[56:57]
  v_pk_mul_f32 v[150:151], v[104:105], v[56:57]
  v_pk_fma_f32 v[148:149], v[104:105], v[68:69], v[148:149] neg_lo:[0,1,0] neg_hi:[0,1,0]
  v_pk_fma_f32 v[150:151], v[100:101], v[68:69], v[150:151]
  v_cvt_pk_bf16_f32 v152, v148, v150
  v_cvt_pk_bf16_f32 v153, v149, v151
  v_pk_mul_f32 v[148:149], v[102:103], v[58:59]
  v_pk_mul_f32 v[150:151], v[106:107], v[58:59]
  v_pk_fma_f32 v[148:149], v[106:107], v[70:71], v[148:149] neg_lo:[0,1,0] neg_hi:[0,1,0]
  v_pk_fma_f32 v[150:151], v[102:103], v[70:71], v[150:151]
  v_cvt_pk_bf16_f32 v154, v148, v150
  v_cvt_pk_bf16_f32 v155, v149, v151
  s_nop 1
  v_mfma_f32_16x16x32_bf16 v[56:59], v[152:155], a[232:235], 0
  v_mfma_f32_16x16x32_bf16 v[68:71], v[152:155], a[236:239], 0
  s_nop 6
  v_pk_mul_f32 v[148:149], v[56:57], v[136:137]
  v_pk_mul_f32 v[150:151], v[68:69], v[136:137]
  v_pk_fma_f32 v[148:149], v[68:69], v[184:185], v[148:149] neg_lo:[0,1,0] neg_hi:[0,1,0]
  v_pk_fma_f32 v[150:151], v[56:57], v[184:185], v[150:151]
  v_cvt_pk_bf16_f32 v152, v148, v150
  v_cvt_pk_bf16_f32 v153, v149, v151
  v_pk_mul_f32 v[148:149], v[58:59], v[138:139]
  v_pk_mul_f32 v[150:151], v[70:71], v[138:139]
  v_pk_fma_f32 v[148:149], v[70:71], v[186:187], v[148:149] neg_lo:[0,1,0] neg_hi:[0,1,0]
  v_pk_fma_f32 v[150:151], v[58:59], v[186:187], v[150:151]
  v_cvt_pk_bf16_f32 v154, v148, v150
  v_cvt_pk_bf16_f32 v155, v149, v151
  s_nop 1
  v_mfma_f32_16x16x32_bf16 v[56:59], a[240:243], v[152:155], 0
  v_mfma_f32_16x16x32_bf16 v[68:71], a[244:247], v[152:155], 0
gated_mix__spectral_gfnet__ssm_conv_s5__prompt_kernel_skip38:
  v_pk_mul_f32 v[148:149], v[100:101], v[8:9]
  v_pk_mul_f32 v[150:151], v[104:105], v[8:9]
  v_pk_fma_f32 v[148:149], v[104:105], v[12:13], v[148:149] neg_lo:[0,1,0] neg_hi:[0,1,0]
  v_pk_fma_f32 v[150:151], v[100:101], v[12:13], v[150:151]
  v_cvt_pk_bf16_f32 v72, v148, v150
  v_cvt_pk_bf16_f32 v73, v149, v151
  v_pk_mul_f32 v[148:149], v[102:103], v[10:11]
  v_pk_mul_f32 v[150:151], v[106:107], v[10:11]
  v_pk_fma_f32 v[148:149], v[106:107], v[14:15], v[148:149] neg_lo:[0,1,0] neg_hi:[0,1,0]
  v_pk_fma_f32 v[150:151], v[102:103], v[14:15], v[150:151]
  v_cvt_pk_bf16_f32 v74, v148, v150
  buffer_load_dwordx4 v127, s[68:71], s28 offen offset:1024 lds
  v_cvt_pk_bf16_f32 v75, v149, v151
  v_pk_mul_f32 v[148:149], v[108:109], v[16:17]
  v_pk_mul_f32 v[150:151], v[112:113], v[16:17]
  v_pk_fma_f32 v[148:149], v[112:113], v[20:21], v[148:149] neg_lo:[0,1,0] neg_hi:[0,1,0]
  v_pk_fma_f32 v[150:151], v[108:109], v[20:21], v[150:151]
  v_cvt_pk_bf16_f32 v88, v148, v150
  v_cvt_pk_bf16_f32 v89, v149, v151
  v_pk_mul_f32 v[148:149], v[110:111], v[18:19]
  v_pk_mul_f32 v[150:151], v[114:115], v[18:19]
  v_pk_fma_f32 v[148:149], v[114:115], v[22:23], v[148:149] neg_lo:[0,1,0] neg_hi:[0,1,0]
  v_pk_fma_f32 v[150:151], v[110:111], v[22:23], v[150:151]
  v_cvt_pk_bf16_f32 v90, v148, v150
  v_cvt_pk_bf16_f32 v91, v149, v151
  v_mfma_f32_16x16x32_bf16 v[100:103], v[72:75], a[232:235], 0
  v_mfma_f32_16x16x32_bf16 v[104:107], v[72:75], a[236:239], 0
  s_add_u32 m0, s43, 65536
  s_nop 0
  buffer_load_dwordx4 v124, s[72:75], s28 offen offset:0 lds
  v_pk_mul_f32 v[148:149], v[116:117], v[40:41]
  v_pk_mul_f32 v[150:151], v[120:121], v[40:41]
  v_pk_fma_f32 v[148:149], v[120:121], v[44:45], v[148:149] neg_lo:[0,1,0] neg_hi:[0,1,0]
  v_pk_fma_f32 v[150:151], v[116:117], v[44:45], v[150:151]
  v_cvt_pk_bf16_f32 v92, v148, v150
  v_cvt_pk_bf16_f32 v93, v149, v151
  v_pk_mul_f32 v[148:149], v[118:119], v[42:43]
  v_pk_mul_f32 v[150:151], v[122:123], v[42:43]
  v_pk_fma_f32 v[148:149], v[122:123], v[46:47], v[148:149] neg_lo:[0,1,0] neg_hi:[0,1,0]
  v_pk_fma_f32 v[150:151], v[118:119], v[46:47], v[150:151]
  v_cvt_pk_bf16_f32 v94, v148, v150
  v_cvt_pk_bf16_f32 v95, v149, v151
  v_mfma_f32_16x16x32_bf16 v[108:111], v[88:91], a[232:235], 0
  v_mfma_f32_16x16x32_bf16 v[112:115], v[88:91], a[236:239], 0
  buffer_load_dwordx4 v125, s[72:75], s28 offen offset:1024 lds
  v_pk_mul_f32 v[148:149], v[140:141], v[48:49]
  v_pk_mul_f32 v[150:151], v[144:145], v[48:49]
  v_pk_fma_f32 v[148:149], v[144:145], v[52:53], v[148:149] neg_lo:[0,1,0] neg_hi:[0,1,0]
  v_pk_fma_f32 v[150:151], v[140:141], v[52:53], v[150:151]
  v_cvt_pk_bf16_f32 v96, v148, v150
  v_cvt_pk_bf16_f32 v97, v149, v151
  v_pk_mul_f32 v[148:149], v[142:143], v[50:51]
  v_pk_mul_f32 v[150:151], v[146:147], v[50:51]
  v_pk_fma_f32 v[148:149], v[146:147], v[54:55], v[148:149] neg_lo:[0,1,0] neg_hi:[0,1,0]
  v_pk_fma_f32 v[150:151], v[142:143], v[54:55], v[150:151]
  v_cvt_pk_bf16_f32 v98, v148, v150
  v_cvt_pk_bf16_f32 v99, v149, v151
  v_mfma_f32_16x16x32_bf16 v[116:119], v[92:95], a[232:235], 0
  v_mfma_f32_16x16x32_bf16 v[120:123], v[92:95], a[236:239], 0
  s_add_u32 m0, s43, 67584
  s_nop 0
  buffer_load_dwordx4 v126, s[72:75], s28 offen offset:0 lds
  v_mfma_f32_16x16x32_bf16 v[140:143], v[96:99], a[232:235], 0
  v_mfma_f32_16x16x32_bf16 v[144:147], v[96:99], a[236:239], 0
  v_pk_mul_f32 v[148:149], v[100:101], v[136:137]
  v_pk_mul_f32 v[150:151], v[104:105], v[136:137]
  v_pk_fma_f32 v[148:149], v[104:105], v[184:185], v[148:149] neg_lo:[0,1,0] neg_hi:[0,1,0]
  v_pk_fma_f32 v[150:151], v[100:101], v[184:185], v[150:151]
  v_cvt_pk_bf16_f32 v72, v148, v150
  v_cvt_pk_bf16_f32 v73, v149, v151
  v_pk_mul_f32 v[148:149], v[102:103], v[138:139]
  v_pk_mul_f32 v[150:151], v[106:107], v[138:139]
  v_pk_fma_f32 v[148:149], v[106:107], v[186:187], v[148:149] neg_lo:[0,1,0] neg_hi:[0,1,0]
  v_pk_fma_f32 v[150:151], v[102:103], v[186:187], v[150:151]
  v_cvt_pk_bf16_f32 v74, v148, v150
  v_cvt_pk_bf16_f32 v75, v149, v151
  buffer_load_dwordx4 v127, s[72:75], s28 offen offset:1024 lds
  s_add_u32 s28, s28, 128
  s_and_b32 s28, s28, 0x3ff
  v_pk_mul_f32 v[148:149], v[108:109], v[136:137]
  v_pk_mul_f32 v[150:151], v[112:113], v[136:137]
  v_pk_fma_f32 v[148:149], v[112:113], v[184:185], v[148:149] neg_lo:[0,1,0] neg_hi:[0,1,0]
  v_pk_fma_f32 v[150:151], v[108:109], v[184:185], v[150:151]
  v_cvt_pk_bf16_f32 v88, v148, v150
  v_cvt_pk_bf16_f32 v89, v149, v151
  v_pk_mul_f32 v[148:149], v[110:111], v[138:139]
  v_pk_mul_f32 v[150:151], v[114:115], v[138:139]
  v_pk_fma_f32 v[148:149], v[114:115], v[186:187], v[148:149] neg_lo:[0,1,0] neg_hi:[0,1,0]
  v_pk_fma_f32 v[150:151], v[110:111], v[186:187], v[150:151]
  v_cvt_pk_bf16_f32 v90, v148, v150
  v_cvt_pk_bf16_f32 v91, v149, v151
  v_mfma_f32_16x16x32_bf16 v[100:103], a[240:243], v[72:75], 0
  v_mfma_f32_16x16x32_bf16 v[104:107], a[244:247], v[72:75], 0
  s_add_u32 m0, s43, 114688
  s_nop 0
  buffer_load_dwordx4 v124, s[68:71], s28 offen offset:0 lds
  v_pk_mul_f32 v[148:149], v[116:117], v[136:137]
  v_pk_mul_f32 v[150:151], v[120:121], v[136:137]
  v_pk_fma_f32 v[148:149], v[120:121], v[184:185], v[148:149] neg_lo:[0,1,0] neg_hi:[0,1,0]
  v_pk_fma_f32 v[150:151], v[116:117], v[184:185], v[150:151]
  v_cvt_pk_bf16_f32 v92, v148, v150
  v_cvt_pk_bf16_f32 v93, v149, v151
  v_pk_mul_f32 v[148:149], v[118:119], v[138:139]
  v_pk_mul_f32 v[150:151], v[122:123], v[138:139]
  v_pk_fma_f32 v[148:149], v[122:123], v[186:187], v[148:149] neg_lo:[0,1,0] neg_hi:[0,1,0]
  v_pk_fma_f32 v[150:151], v[118:119], v[186:187], v[150:151]
  v_cvt_pk_bf16_f32 v94, v148, v150
  v_cvt_pk_bf16_f32 v95, v149, v151
  v_mfma_f32_16x16x32_bf16 v[108:111], a[240:243], v[88:91], 0
  v_mfma_f32_16x16x32_bf16 v[112:115], a[244:247], v[88:91], 0
  buffer_load_dwordx4 v125, s[68:71], s28 offen offset:1024 lds
  v_pk_mul_f32 v[148:149], v[140:141], v[136:137]
  v_pk_mul_f32 v[150:151], v[144:145], v[136:137]
  v_pk_fma_f32 v[148:149], v[144:145], v[184:185], v[148:149] neg_lo:[0,1,0] neg_hi:[0,1,0]
  v_pk_fma_f32 v[150:151], v[140:141], v[184:185], v[150:151]
  v_cvt_pk_bf16_f32 v96, v148, v150
  v_cvt_pk_bf16_f32 v97, v149, v151
  v_pk_mul_f32 v[148:149], v[142:143], v[138:139]
  v_pk_mul_f32 v[150:151], v[146:147], v[138:139]
  v_pk_fma_f32 v[148:149], v[146:147], v[186:187], v[148:149] neg_lo:[0,1,0] neg_hi:[0,1,0]
  v_pk_fma_f32 v[150:151], v[142:143], v[186:187], v[150:151]
  v_cvt_pk_bf16_f32 v98, v148, v150
  v_cvt_pk_bf16_f32 v99, v149, v151
  v_mfma_f32_16x16x32_bf16 v[116:119], a[240:243], v[92:95], 0
  v_mfma_f32_16x16x32_bf16 v[120:123], a[244:247], v[92:95], 0
  s_add_u32 m0, s43, 116736
  s_nop 0
  buffer_load_dwordx4 v126, s[68:71], s28 offen offset:0 lds
  v_mfma_f32_16x16x32_bf16 v[140:143], a[240:243], v[96:99], 0
  v_mfma_f32_16x16x32_bf16 v[144:147], a[244:247], v[96:99], 0
  v_lshlrev_b32 v65, 12, v3
  v_lshl_add_u32 v65, v2, 4, v65
  s_lshl_b32 s29, s3, 8
  s_add_u32 s29, s29, 147456
  v_add_u32 v65, s29, v65
  s_sub_u32 s29, s10, 1
  s_or_b32 s29, s29, s3
  s_cmp_lg_u32 s29, 0
  s_cbranch_scc1 gated_mix__spectral_gfnet__ssm_conv_s5__prompt_kernel_skip39
  v_mov_b32 v104, v68
  v_mov_b32 v105, v69
  v_mov_b32 v106, v70
  v_mov_b32 v107, v71
gated_mix__spectral_gfnet__ssm_conv_s5__prompt_kernel_skip39:
  v_cvt_pk_bf16_f32 v72, v100, v104
  v_cvt_pk_bf16_f32 v73, v108, v112
  v_cvt_pk_bf16_f32 v74, v116, v120
  buffer_load_dwordx4 v127, s[68:71], s28 offen offset:1024 lds
  v_cvt_pk_bf16_f32 v75, v140, v144
  ds_write_b128 v65, v[72:75] offset:0
  v_cvt_pk_bf16_f32 v88, v101, v105
  v_cvt_pk_bf16_f32 v89, v109, v113
  v_cvt_pk_bf16_f32 v90, v117, v121
  v_cvt_pk_bf16_f32 v91, v141, v145
  ds_write_b128 v65, v[88:91] offset:1024
  v_cvt_pk_bf16_f32 v92, v102, v106
  v_cvt_pk_bf16_f32 v93, v110, v114
  v_cvt_pk_bf16_f32 v94, v118, v122
  v_cvt_pk_bf16_f32 v95, v142, v146
  ds_write_b128 v65, v[92:95] offset:2048
  v_cvt_pk_bf16_f32 v96, v103, v107
  v_cvt_pk_bf16_f32 v97, v111, v115
  v_cvt_pk_bf16_f32 v98, v119, v123
  v_cvt_pk_bf16_f32 v99, v143, v147
  ds_write_b128 v65, v[96:99] offset:3072
  s_add_u32 m0, s43, 0
  s_nop 0
  buffer_load_dwordx4 v124, s[72:75], s28 offen offset:0 lds
  buffer_load_dwordx4 v125, s[72:75], s28 offen offset:1024 lds
  s_add_u32 m0, s43, 2048
  s_nop 0
  buffer_load_dwordx4 v126, s[72:75], s28 offen offset:0 lds
  buffer_load_dwordx4 v127, s[72:75], s28 offen offset:1024 lds
  s_add_u32 s28, s28, 128
  s_and_b32 s28, s28, 0x3ff
  s_add_u32 m0, s43, 16384
  s_nop 0
  buffer_load_dwordx4 v124, s[68:71], s28 offen offset:0 lds
  buffer_load_dwordx4 v125, s[68:71], s28 offen offset:1024 lds
  s_add_u32 m0, s43, 18432
  s_nop 0
  buffer_load_dwordx4 v126, s[68:71], s28 offen offset:0 lds
  buffer_load_dwordx4 v127, s[68:71], s28 offen offset:1024 lds
  s_mov_b64 exec, 0xffffffff
  buffer_load_dword v64, v6, s[16:19], s57 offen sc1
  s_mov_b64 exec, -1
  s_waitcnt lgkmcnt(0)
  s_barrier
  s_lshl_b32 s29, s3, 12
  s_add_u32 s29, s29, 147456
  v_lshl_add_u32 v65, v1, 4, s29
  ds_read_b128 v[8:11], v65 offset:0
  ds_read_b128 v[12:15], v65 offset:1024
  ds_read_b128 v[16:19], v65 offset:2048
  ds_read_b128 v[20:23], v65 offset:3072
  s_mov_b32 s29, 1048576
  v_mul_lo_u32 v65, v3, s29
  v_lshl_add_u32 v65, v2, 2, v65
  s_mul_i32 s6, s3, 65536
  s_lshr_b32 s29, s37, 4
  s_lshl_b32 s29, s29, 12
  s_add_u32 s6, s6, s29
  s_lshl_b32 s29, s36, 10
  s_add_u32 s6, s6, s29
  s_and_b32 s29, s37, 15
  s_lshl_b32 s29, s29, 6
  s_add_u32 s6, s6, s29
  s_waitcnt lgkmcnt(3)
  v_mfma_f32_16x16x32_bf16 v[40:43], a[248:251], v[8:11], 0
  v_mfma_f32_16x16x32_bf16 v[44:47], a[252:255], v[8:11], 0
  s_waitcnt lgkmcnt(2)
  v_mfma_f32_16x16x32_bf16 v[48:51], a[248:251], v[12:15], 0
  v_mfma_f32_16x16x32_bf16 v[52:55], a[252:255], v[12:15], 0
  s_waitcnt lgkmcnt(1)
  v_mfma_f32_16x16x32_bf16 v[56:59], a[248:251], v[16:19], 0
  v_mfma_f32_16x16x32_bf16 v[68:71], a[252:255], v[16:19], 0
  s_waitcnt lgkmcnt(0)
  v_mfma_f32_16x16x32_bf16 v[72:75], a[248:251], v[20:23], 0
  v_mfma_f32_16x16x32_bf16 v[76:79], a[252:255], v[20:23], 0
  v_cvt_pk_bf16_f32 v8, v40, v44
  v_cvt_pk_bf16_f32 v9, v41, v45
  v_cvt_pk_bf16_f32 v10, v42, v46
  v_cvt_pk_bf16_f32 v11, v43, v47
  v_cvt_pk_bf16_f32 v12, v48, v52
  v_cvt_pk_bf16_f32 v13, v49, v53
  v_cvt_pk_bf16_f32 v14, v50, v54
  v_cvt_pk_bf16_f32 v15, v51, v55
  v_cvt_pk_bf16_f32 v16, v56, v68
  v_cvt_pk_bf16_f32 v17, v57, v69
  v_cvt_pk_bf16_f32 v18, v58, v70
  v_cvt_pk_bf16_f32 v19, v59, v71
  v_cvt_pk_bf16_f32 v20, v72, v76
  v_cvt_pk_bf16_f32 v21, v73, v77
  v_cvt_pk_bf16_f32 v22, v74, v78
  v_cvt_pk_bf16_f32 v23, v75, v79
  s_add_u32 s20, s34, 5242880
  s_addc_u32 s21, s35, 0
  s_mov_b32 s22, 4194304
  s_mov_b32 s23, 0x20000
  s_waitcnt vmcnt(21)
  ds_read_b128 a[48:51], v130 offset:32768
  ds_read_b128 a[52:55], v131 offset:32768
  ds_read_b128 a[56:59], v130 offset:34816
  ds_read_b128 a[60:63], v131 offset:34816
  v_xor_b32 v130, 0x30000, v130
  v_xor_b32 v131, 0x30000, v131
  s_waitcnt vmcnt(17)
  ds_read_b128 a[64:67], v130 offset:0
  ds_read_b128 a[68:71], v131 offset:0
  ds_read_b128 a[72:75], v130 offset:2048
  ds_read_b128 a[76:79], v131 offset:2048
  v_xor_b32 v130, 0x30000, v130
  v_xor_b32 v131, 0x30000, v131
  s_waitcnt vmcnt(13)
  ds_read_b128 a[80:83], v130 offset:0
  ds_read_b128 a[84:87], v131 offset:0
  ds_read_b128 a[88:91], v130 offset:2048
  ds_read_b128 a[92:95], v131 offset:2048
  s_waitcnt vmcnt(9)
  ds_read_b128 a[96:99], v130 offset:49152
  ds_read_b128 a[100:103], v131 offset:49152
  ds_read_b128 a[104:107], v130 offset:51200
  ds_read_b128 a[108:111], v131 offset:51200
  s_waitcnt vmcnt(5)
  ds_read_b128 a[112:115], v128 offset:0
  ds_read_b128 a[116:119], v129 offset:0
  ds_read_b128 a[120:123], v128 offset:2048
  ds_read_b128 a[124:127], v129 offset:2048
  s_waitcnt vmcnt(1)
  ds_read_b128 a[128:131], v128 offset:16384
  ds_read_b128 a[132:135], v129 offset:16384
  ds_read_b128 a[136:139], v128 offset:18432
  ds_read_b128 a[140:143], v129 offset:18432
  buffer_store_dword v8, v65, s[20:23], s6 offen sc1
  s_add_u32 s6, s6, 262144
  buffer_store_dword v9, v65, s[20:23], s6 offen sc1
  s_add_u32 s6, s6, 262144
  buffer_store_dword v10, v65, s[20:23], s6 offen sc1
  s_add_u32 s6, s6, 262144
  buffer_store_dword v11, v65, s[20:23], s6 offen sc1
  s_sub_u32 s6, s6, 770048
  buffer_store_dword v12, v65, s[20:23], s6 offen sc1
  s_add_u32 s6, s6, 262144
  buffer_store_dword v13, v65, s[20:23], s6 offen sc1
  s_add_u32 s6, s6, 262144
  buffer_store_dword v14, v65, s[20:23], s6 offen sc1
  s_add_u32 s6, s6, 262144
  buffer_store_dword v15, v65, s[20:23], s6 offen sc1
  s_sub_u32 s6, s6, 770048
  buffer_store_dword v16, v65, s[20:23], s6 offen sc1
  s_add_u32 s6, s6, 262144
  buffer_store_dword v17, v65, s[20:23], s6 offen sc1
  s_add_u32 s6, s6, 262144
  buffer_store_dword v18, v65, s[20:23], s6 offen sc1
  s_add_u32 s6, s6, 262144
  buffer_store_dword v19, v65, s[20:23], s6 offen sc1
  s_sub_u32 s6, s6, 770048
  buffer_store_dword v20, v65, s[20:23], s6 offen sc1
  s_add_u32 s6, s6, 262144
  buffer_store_dword v21, v65, s[20:23], s6 offen sc1
  s_add_u32 s6, s6, 262144
  buffer_store_dword v22, v65, s[20:23], s6 offen sc1
  s_add_u32 s6, s6, 262144
  buffer_store_dword v23, v65, s[20:23], s6 offen sc1
  s_lshr_b32 s7, s41, 3
  s_mul_i32 s6, s7, 253952
  s_lshl_b32 s29, s40, 19
  s_add_u32 s6, s6, s29
  s_lshr_b32 s7, s3, 1
  s_lshl1_add_u32 s7, s7, s3
  s_add_u32 s7, s7, 2
  s_lshl_b32 s7, s7, 12
  s_add_u32 s6, s6, s7
  v_lshl_add_u32 v65, v1, 4, s6
  s_and_b32 s29, s40, 7
  s_lshl_b32 s29, s29, 15
  s_lshl_b32 s6, s3, 12
  v_and_b32 v66, 3, v1
  v_and_b32 v67, 2, v3
  v_xor_b32 v67, v67, v66
  v_lshlrev_b32 v66, 9, v66
  v_lshl_or_b32 v66, v67, 6, v66
  v_bfe_u32 v67, v1, 2, 2
  v_lshl_or_b32 v66, v67, 4, v66
  v_and_b32 v67, 1, v3
  v_lshl_or_b32 v8, v67, 3, v66
  v_xor_b32 v9, 64, v8
  v_add_u32 v10, 0x10000, v8
  v_add_u32 v11, 0x10000, v9
  v_lshlrev_b32 v12, 16, v62
  v_and_b32 v13, 0xffff0000, v62
  v_lshlrev_b32 v14, 16, v63
  v_and_b32 v15, 0xffff0000, v63
  v_pk_mul_f32 v[12:13], v[60:61], v[12:13] op_sel_hi:[0,1]
  v_pk_mul_f32 v[14:15], v[60:61], v[14:15] op_sel_hi:[0,1]
  v_lshlrev_b32 v16, 16, v24
  v_and_b32 v17, 0xffff0000, v24
  v_lshlrev_b32 v18, 16, v25
  v_and_b32 v19, 0xffff0000, v25
  v_pk_mul_f32 v[16:17], v[60:61], v[16:17] op_sel_hi:[0,1]
  v_pk_mul_f32 v[18:19], v[60:61], v[18:19] op_sel_hi:[0,1]
  v_lshlrev_b32 v20, 16, v26
  v_and_b32 v21, 0xffff0000, v26
  v_lshlrev_b32 v22, 16, v27
  v_and_b32 v23, 0xffff0000, v27
  v_pk_mul_f32 v[20:21], v[60:61], v[20:21] op_sel_hi:[0,1]
  v_pk_mul_f32 v[22:23], v[60:61], v[22:23] op_sel_hi:[0,1]
  v_lshlrev_b32 v40, 16, v28
  v_and_b32 v41, 0xffff0000, v28
  v_lshlrev_b32 v42, 16, v29
  v_and_b32 v43, 0xffff0000, v29
  v_pk_mul_f32 v[40:41], v[60:61], v[40:41] op_sel_hi:[0,1]
  v_pk_mul_f32 v[42:43], v[60:61], v[42:43] op_sel_hi:[0,1]
  v_lshlrev_b32 v68, 16, v30
  v_and_b32 v69, 0xffff0000, v30
  v_lshlrev_b32 v70, 16, v31
  v_and_b32 v71, 0xffff0000, v31
  v_pk_mul_f32 v[68:69], v[60:61], v[68:69] op_sel_hi:[0,1]
  v_pk_mul_f32 v[70:71], v[60:61], v[70:71] op_sel_hi:[0,1]
  v_lshlrev_b32 v72, 16, v32
  v_and_b32 v73, 0xffff0000, v32
  v_lshlrev_b32 v74, 16, v33
  v_and_b32 v75, 0xffff0000, v33
  v_pk_mul_f32 v[72:73], v[60:61], v[72:73] op_sel_hi:[0,1]
  v_pk_mul_f32 v[74:75], v[60:61], v[74:75] op_sel_hi:[0,1]
  v_lshlrev_b32 v76, 16, v34
  v_and_b32 v77, 0xffff0000, v34
  v_lshlrev_b32 v78, 16, v35
  v_and_b32 v79, 0xffff0000, v35
  v_pk_mul_f32 v[76:77], v[60:61], v[76:77] op_sel_hi:[0,1]
  v_pk_mul_f32 v[78:79], v[60:61], v[78:79] op_sel_hi:[0,1]
  v_lshlrev_b32 v80, 16, v36
  v_and_b32 v81, 0xffff0000, v36
  v_lshlrev_b32 v82, 16, v37
  v_and_b32 v83, 0xffff0000, v37
  v_pk_mul_f32 v[80:81], v[60:61], v[80:81] op_sel_hi:[0,1]
  v_pk_mul_f32 v[82:83], v[60:61], v[82:83] op_sel_hi:[0,1]
  s_waitcnt vmcnt(16)
  v_cmp_ne_u32 vcc, 1, v64
  s_nop 0
  s_and_b64 vcc, vcc, 0xffffffff
  s_cbranch_vccz gated_mix__spectral_gfnet__ssm_conv_s5__prompt_kernel_skip40
  s_mov_b32 s7, 0
gated_mix__spectral_gfnet__ssm_conv_s5__prompt_kernel_poll41:
  s_sleep 5
  s_mov_b64 exec, 0xffffffff
  buffer_load_dword v64, v6, s[16:19], s57 offen sc1
  s_mov_b64 exec, -1
  s_waitcnt vmcnt(0)
  v_cmp_ne_u32 vcc, 1, v64
  s_nop 0
  s_and_b64 vcc, vcc, 0xffffffff
  s_cbranch_vccz gated_mix__spectral_gfnet__ssm_conv_s5__prompt_kernel_pollout42
  s_add_u32 s7, s7, 1
  s_cmp_lt_u32 s7, 1048576
  s_cbranch_scc1 gated_mix__spectral_gfnet__ssm_conv_s5__prompt_kernel_poll41
gated_mix__spectral_gfnet__ssm_conv_s5__prompt_kernel_pollout42:
gated_mix__spectral_gfnet__ssm_conv_s5__prompt_kernel_skip40:
  s_waitcnt lgkmcnt(0)
  s_barrier
  s_add_u32 m0, s6, 0
  s_nop 0
  buffer_load_dwordx4 v65, s[12:15], s29 offen offset:0 sc1 lds
  buffer_load_dwordx4 v65, s[12:15], s29 offen offset:1024 sc1 lds
  buffer_load_dwordx4 v65, s[12:15], s29 offen offset:2048 sc1 lds
  s_and_b32 s7, s41, 8
  s_lshl_b32 s7, s7, 2
  v_lshrrev_b32 v6, 1, v3
  v_lshl_add_u32 v6, v6, 3, s7
  v_and_b32 v36, 1, v3
  v_lshl_add_u32 v6, v36, 1, v6
  v_cmp_eq_u32 vcc, 0, v6
  v_cvt_f32_u32 v37, v6
  v_bfe_i32 v66, v3, 0, 1
  v_and_b32 v66, 0x80008000, v66
  v_xor_b32 v67, 0x80000000, v66
  s_lshl_b32 s7, s7, 1
  buffer_load_dwordx4 v65, s[12:15], s29 offen offset:3072 sc1 lds
  s_add_u32 s29, s29, 32768
  s_and_b32 s29, s29, 0x3ffff
  s_xor_b32 s7, s7, 64
  v_add_u32 v6, s7, v2
  v_cvt_f32_u32 v6, v6
  v_mul_f32 v6, 0x3c000000, v6
  v_mul_f32 v36, v6, v37
  v_fmamk_f32 v188, v6, 0x0, v36
  v_fmamk_f32 v189, v6, 0x3f800000, v36
  v_fmamk_f32 v190, v6, 0x40800000, v36
  v_fmamk_f32 v191, v6, 0x40a00000, v36
  v_fmamk_f32 v192, v6, 0x41800000, v36
  v_fmamk_f32 v193, v6, 0x41880000, v36
  v_fmamk_f32 v194, v6, 0x41a00000, v36
  s_add_u32 m0, s6, 16384
  s_nop 0
  buffer_load_dwordx4 v65, s[12:15], s29 offen offset:0 sc1 lds
  v_fmamk_f32 v195, v6, 0x41a80000, v36
  v_cos_f32 v196, v188
  v_cos_f32 v197, v189
  v_cos_f32 v198, v190
  v_cos_f32 v199, v191
  v_cos_f32 v200, v192
  v_cos_f32 v201, v193
  buffer_load_dwordx4 v65, s[12:15], s29 offen offset:1024 sc1 lds
  v_cos_f32 v202, v194
  v_cos_f32 v203, v195
  v_sin_f32 v188, v188
  v_sin_f32 v189, v189
  v_sin_f32 v190, v190
  v_sin_f32 v191, v191
  buffer_load_dwordx4 v65, s[12:15], s29 offen offset:2048 sc1 lds
  v_sin_f32 v192, v192
  v_sin_f32 v193, v193
  v_sin_f32 v194, v194
  v_sin_f32 v195, v195
  v_lshlrev_b32 v36, 31, v2
  v_or_b32 v36, 0x3f003f00, v36
  v_cvt_pk_bf16_f32 v24, v196, -v188
  v_cvt_pk_bf16_f32 v25, v197, -v189
  buffer_load_dwordx4 v65, s[12:15], s29 offen offset:3072 sc1 lds
  s_add_u32 s29, s29, 32768
  s_and_b32 s29, s29, 0x3ffff
  v_cvt_pk_bf16_f32 v26, v198, -v190
  v_cvt_pk_bf16_f32 v27, v199, -v191
  v_cvt_pk_bf16_f32 v28, v200, -v192
  v_cvt_pk_bf16_f32 v29, v201, -v193
  v_cvt_pk_bf16_f32 v30, v202, -v194
  v_cvt_pk_bf16_f32 v31, v203, -v195
  v_cndmask_b32 v24, v24, v36, vcc
  v_xor_b32 v172, v66, v24
  v_alignbit_b32 v173, v25, v25, 16
  v_xor_b32 v173, v67, v173
  v_xor_b32 v174, v66, v26
  v_alignbit_b32 v175, v27, v27, 16
  s_add_u32 m0, s43, 98304
  s_nop 0
  buffer_load_dwordx4 v124, s[72:75], s28 offen offset:0 lds
  v_xor_b32 v175, v67, v175
  v_xor_b32 v176, v66, v28
  v_alignbit_b32 v177, v29, v29, 16
  v_xor_b32 v177, v67, v177
  v_xor_b32 v178, v66, v30
  v_alignbit_b32 v179, v31, v31, 16
  v_xor_b32 v179, v67, v179
  v_add_f32 v6, 0x3e000000, v6
  v_mul_f32 v36, v6, v37
  v_fmamk_f32 v188, v6, 0x0, v36
  v_fmamk_f32 v189, v6, 0x3f800000, v36
  v_fmamk_f32 v190, v6, 0x40800000, v36
  buffer_load_dwordx4 v125, s[72:75], s28 offen offset:1024 lds
  v_fmamk_f32 v191, v6, 0x40a00000, v36
  v_fmamk_f32 v192, v6, 0x41800000, v36
  v_fmamk_f32 v193, v6, 0x41880000, v36
  v_fmamk_f32 v194, v6, 0x41a00000, v36
  v_fmamk_f32 v195, v6, 0x41a80000, v36
  v_cos_f32 v196, v188
  v_cos_f32 v197, v189
  v_cos_f32 v198, v190
  v_cos_f32 v199, v191
  s_add_u32 m0, s43, 100352
  s_nop 0
  buffer_load_dwordx4 v126, s[72:75], s28 offen offset:0 lds
  v_cos_f32 v200, v192
  v_cos_f32 v201, v193
  v_cos_f32 v202, v194
  v_cos_f32 v203, v195
  v_sin_f32 v188, v188
  v_sin_f32 v189, v189
  buffer_load_dwordx4 v127, s[72:75], s28 offen offset:1024 lds
  s_add_u32 s28, s28, 128
  s_and_b32 s28, s28, 0x3ff
  v_sin_f32 v190, v190
  v_sin_f32 v191, v191
  v_sin_f32 v192, v192
  v_sin_f32 v193, v193
  v_sin_f32 v194, v194
  v_sin_f32 v195, v195
  v_lshlrev_b32 v36, 31, v2
  v_or_b32 v36, 0x3f003f00, v36
  v_cvt_pk_bf16_f32 v32, v196, -v188
  v_cvt_pk_bf16_f32 v33, v197, -v189
  v_cvt_pk_bf16_f32 v34, v198, -v190
  v_cvt_pk_bf16_f32 v35, v199, -v191
  v_cvt_pk_bf16_f32 v60, v200, -v192
  v_cvt_pk_bf16_f32 v61, v201, -v193
  v_cvt_pk_bf16_f32 v62, v202, -v194
  v_cvt_pk_bf16_f32 v63, v203, -v195
  v_cndmask_b32 v32, v32, v36, vcc
  v_xor_b32 v180, v66, v32
  v_alignbit_b32 v181, v33, v33, 16
  v_xor_b32 v181, v67, v181
  v_xor_b32 v182, v66, v34
  v_alignbit_b32 v183, v35, v35, 16
  v_xor_b32 v183, v67, v183
  v_xor_b32 v184, v66, v60
  v_alignbit_b32 v185, v61, v61, 16
  v_xor_b32 v185, v67, v185
  v_xor_b32 v186, v66, v62
  v_alignbit_b32 v187, v63, v63, 16
  v_xor_b32 v187, v67, v187
  s_waitcnt vmcnt(12)
  s_waitcnt vmcnt(8)
  s_barrier
  ds_read_b64_tr_b16 v[100:101], v8 offset:0
  ds_read_b64_tr_b16 v[102:103], v9 offset:0
  ds_read_b64_tr_b16 v[104:105], v8 offset:2048
  ds_read_b64_tr_b16 v[106:107], v9 offset:2048
  ds_read_b64_tr_b16 v[108:109], v8 offset:4096
  ds_read_b64_tr_b16 v[110:111], v9 offset:4096
  ds_read_b64_tr_b16 v[112:113], v8 offset:6144
  ds_read_b64_tr_b16 v[114:115], v9 offset:6144
  ds_read_b64_tr_b16 v[116:117], v8 offset:256
  ds_read_b64_tr_b16 v[118:119], v9 offset:256
  ds_read_b64_tr_b16 v[120:121], v8 offset:2304
  ds_read_b64_tr_b16 v[122:123], v9 offset:2304
  ds_read_b64_tr_b16 v[132:133], v8 offset:4352
  ds_read_b64_tr_b16 v[134:135], v9 offset:4352
  ds_read_b64_tr_b16 v[136:137], v8 offset:6400
  ds_read_b64_tr_b16 v[138:139], v9 offset:6400
  s_cmp_lg_u32 s3, 0
  s_cbranch_scc1 gated_mix__spectral_gfnet__ssm_conv_s5__prompt_kernel_skip43
  s_mov_b64 exec, 1
  buffer_store_dword v5, v38, s[16:19], s56 offen sc1
  s_mov_b64 exec, -1
gated_mix__spectral_gfnet__ssm_conv_s5__prompt_kernel_skip43:
  s_waitcnt lgkmcnt(0)
  v_mfma_f32_16x16x32_bf16 v[12:15], v[100:103], a[0:3], v[12:15]
  ds_read_b64_tr_b16 v[140:141], v8 offset:8192
  ds_read_b64_tr_b16 v[142:143], v9 offset:8192
  v_mfma_f32_16x16x32_bf16 v[44:47], v[100:103], a[8:11], 0
  ds_read_b64_tr_b16 v[144:145], v8 offset:10240
  ds_read_b64_tr_b16 v[146:147], v9 offset:10240
  v_mfma_f32_16x16x32_bf16 v[48:51], v[104:107], a[8:11], 0
  ds_read_b64_tr_b16 v[148:149], v8 offset:12288
  ds_read_b64_tr_b16 v[150:151], v9 offset:12288
  v_mfma_f32_16x16x32_bf16 v[16:19], v[104:107], a[0:3], v[16:19]
  ds_read_b64_tr_b16 v[152:153], v8 offset:14336
  ds_read_b64_tr_b16 v[154:155], v9 offset:14336
  v_mfma_f32_16x16x32_bf16 v[20:23], v[108:111], a[0:3], v[20:23]
  ds_read_b64_tr_b16 v[156:157], v8 offset:8448
  ds_read_b64_tr_b16 v[158:159], v9 offset:8448
  v_mfma_f32_16x16x32_bf16 v[52:55], v[108:111], a[8:11], 0
  ds_read_b64_tr_b16 v[160:161], v8 offset:10496
  ds_read_b64_tr_b16 v[162:163], v9 offset:10496
  v_mfma_f32_16x16x32_bf16 v[56:59], v[112:115], a[8:11], 0
  ds_read_b64_tr_b16 v[164:165], v8 offset:12544
  ds_read_b64_tr_b16 v[166:167], v9 offset:12544
  v_mfma_f32_16x16x32_bf16 v[40:43], v[112:115], a[0:3], v[40:43]
  ds_read_b64_tr_b16 v[168:169], v8 offset:14592
  ds_read_b64_tr_b16 v[170:171], v9 offset:14592
  v_mfma_f32_16x16x32_bf16 v[12:15], v[116:119], a[4:7], v[12:15]
  s_add_u32 m0, s6, 32768
  s_nop 0
  buffer_load_dwordx4 v65, s[12:15], s29 offen offset:0 sc1 lds
  s_mov_b32 s24, s30
  s_mov_b32 s25, s31
  v_mfma_f32_16x16x32_bf16 v[44:47], v[116:119], a[12:15], v[44:47]
  s_mov_b32 s26, 8388608
  s_mov_b32 s27, 0x20000
  v_mfma_f32_16x16x32_bf16 v[48:51], v[120:123], a[12:15], v[48:51]
  buffer_load_dwordx4 v65, s[12:15], s29 offen offset:1024 sc1 lds
  s_mov_b32 s44, s34
  s_mov_b32 s45, s35
  v_mfma_f32_16x16x32_bf16 v[16:19], v[120:123], a[4:7], v[16:19]
  s_mov_b32 s46, 4194304
  s_mov_b32 s47, 0x20000
  v_mfma_f32_16x16x32_bf16 v[20:23], v[132:135], a[4:7], v[20:23]
  buffer_load_dwordx4 v65, s[12:15], s29 offen offset:2048 sc1 lds
  v_lshlrev_b32 v64, 4, v1
  v_lshrrev_b32 v67, 5, v1
  v_mfma_f32_16x16x32_bf16 v[52:55], v[132:135], a[12:15], v[52:55]
  v_lshlrev_b32 v6, 9, v67
  v_lshlrev_b32 v66, 7, v67
  v_mfma_f32_16x16x32_bf16 v[56:59], v[136:139], a[12:15], v[56:59]
  buffer_load_dwordx4 v65, s[12:15], s29 offen offset:3072 sc1 lds
  s_add_u32 s29, s29, 32768
  s_and_b32 s29, s29, 0x3ffff
  v_bfe_u32 v67, v1, 3, 2
  v_lshl_or_b32 v6, v67, 6, v6
  v_mfma_f32_16x16x32_bf16 v[40:43], v[136:139], a[4:7], v[40:43]
  v_and_b32 v67, 3, v1
  v_lshl_or_b32 v6, v67, 4, v6
  s_waitcnt vmcnt(8) lgkmcnt(0)
  s_barrier
  v_mfma_f32_16x16x32_bf16 v[12:15], v[140:143], a[16:19], v[12:15]
  ds_read_b64_tr_b16 v[100:101], v8 offset:16384
  ds_read_b64_tr_b16 v[102:103], v9 offset:16384
  v_mfma_f32_16x16x32_bf16 v[44:47], v[140:143], a[24:27], v[44:47]
  ds_read_b64_tr_b16 v[104:105], v8 offset:18432
  ds_read_b64_tr_b16 v[106:107], v9 offset:18432
  v_mfma_f32_16x16x32_bf16 v[48:51], v[144:147], a[24:27], v[48:51]
  ds_read_b64_tr_b16 v[108:109], v8 offset:20480
  ds_read_b64_tr_b16 v[110:111], v9 offset:20480
  v_mfma_f32_16x16x32_bf16 v[16:19], v[144:147], a[16:19], v[16:19]
  ds_read_b64_tr_b16 v[112:113], v8 offset:22528
  ds_read_b64_tr_b16 v[114:115], v9 offset:22528
  v_mfma_f32_16x16x32_bf16 v[20:23], v[148:151], a[16:19], v[20:23]
  ds_read_b64_tr_b16 v[116:117], v8 offset:16640
  ds_read_b64_tr_b16 v[118:119], v9 offset:16640
  v_mfma_f32_16x16x32_bf16 v[52:55], v[148:151], a[24:27], v[52:55]
  ds_read_b64_tr_b16 v[120:121], v8 offset:18688
  ds_read_b64_tr_b16 v[122:123], v9 offset:18688
  v_mfma_f32_16x16x32_bf16 v[56:59], v[152:155], a[24:27], v[56:59]
  ds_read_b64_tr_b16 v[132:133], v8 offset:20736
  ds_read_b64_tr_b16 v[134:135], v9 offset:20736
  v_mfma_f32_16x16x32_bf16 v[40:43], v[152:155], a[16:19], v[40:43]
  ds_read_b64_tr_b16 v[136:137], v8 offset:22784
  ds_read_b64_tr_b16 v[138:139], v9 offset:22784
  v_mfma_f32_16x16x32_bf16 v[12:15], v[156:159], a[20:23], v[12:15]
  s_add_u32 m0, s43, 114688
  s_nop 0
  buffer_load_dwordx4 v124, s[68:71], s28 offen offset:0 lds
  v_and_b32 v67, 4, v1
  v_lshl_or_b32 v6, v67, 1, v6
  v_mfma_f32_16x16x32_bf16 v[44:47], v[156:159], a[28:31], v[44:47]
  s_lshl_b32 s33, s3, 12
  s_add_u32 s33, s33, 131072
  v_mfma_f32_16x16x32_bf16 v[48:51], v[160:163], a[28:31], v[48:51]
  buffer_load_dwordx4 v125, s[68:71], s28 offen offset:1024 lds
  v_add_u32 v6, s33, v6
  v_and_or_b32 v66, v1, 16, v66
  v_mfma_f32_16x16x32_bf16 v[16:19], v[160:163], a[20:23], v[16:19]
  s_lshl_b32 s33, s41, 6
  v_lshl_add_u32 v36, v2, 2, s33
  v_mfma_f32_16x16x32_bf16 v[20:23], v[164:167], a[20:23], v[20:23]
  s_add_u32 m0, s43, 116736
  s_nop 0
  buffer_load_dwordx4 v126, s[68:71], s28 offen offset:0 lds
  v_lshl_or_b32 v36, v3, 18, v36
  v_xor_b32 v37, 512, v36
  v_mfma_f32_16x16x32_bf16 v[52:55], v[164:167], a[28:31], v[52:55]
  s_lshr_b32 s33, s41, 3
  s_lshl_b32 s7, s33, 10
  v_mfma_f32_16x16x32_bf16 v[56:59], v[168:171], a[28:31], v[56:59]
  buffer_load_dwordx4 v127, s[68:71], s28 offen offset:1024 lds
  s_add_u32 s7, s7, s40
  s_lshl2_add_u32 s7, s7, s3
  v_mfma_f32_16x16x32_bf16 v[40:43], v[168:171], a[20:23], v[40:43]
  s_lshl_b32 s7, s7, 10
  s_xor_b32 s8, s33, 1
  s_waitcnt lgkmcnt(0)
  v_mfma_f32_16x16x32_bf16 v[12:15], v[100:103], a[32:35], v[12:15]
  ds_read_b64_tr_b16 v[140:141], v8 offset:24576
  ds_read_b64_tr_b16 v[142:143], v9 offset:24576
  v_mfma_f32_16x16x32_bf16 v[44:47], v[100:103], a[40:43], v[44:47]
  ds_read_b64_tr_b16 v[144:145], v8 offset:26624
  ds_read_b64_tr_b16 v[146:147], v9 offset:26624
  v_mfma_f32_16x16x32_bf16 v[48:51], v[104:107], a[40:43], v[48:51]
  ds_read_b64_tr_b16 v[148:149], v8 offset:28672
  ds_read_b64_tr_b16 v[150:151], v9 offset:28672
  v_mfma_f32_16x16x32_bf16 v[16:19], v[104:107], a[32:35], v[16:19]
  ds_read_b64_tr_b16 v[152:153], v8 offset:30720
  ds_read_b64_tr_b16 v[154:155], v9 offset:30720
  v_mfma_f32_16x16x32_bf16 v[20:23], v[108:111], a[32:35], v[20:23]
  ds_read_b64_tr_b16 v[156:157], v8 offset:24832
  ds_read_b64_tr_b16 v[158:159], v9 offset:24832
  v_mfma_f32_16x16x32_bf16 v[52:55], v[108:111], a[40:43], v[52:55]
  ds_read_b64_tr_b16 v[160:161], v8 offset:26880
  ds_read_b64_tr_b16 v[162:163], v9 offset:26880
  v_mfma_f32_16x16x32_bf16 v[56:59], v[112:115], a[40:43], v[56:59]
  ds_read_b64_tr_b16 v[164:165], v8 offset:28928
  ds_read_b64_tr_b16 v[166:167], v9 offset:28928
  v_mfma_f32_16x16x32_bf16 v[40:43], v[112:115], a[32:35], v[40:43]
  ds_read_b64_tr_b16 v[168:169], v8 offset:30976
  ds_read_b64_tr_b16 v[170:171], v9 offset:30976
  v_mfma_f32_16x16x32_bf16 v[12:15], v[116:119], a[36:39], v[12:15]
  s_add_u32 m0, s6, 49152
  s_nop 0
  buffer_load_dwordx4 v65, s[12:15], s29 offen offset:0 sc1 lds
  s_lshl1_add_u32 s8, s40, s8
  s_lshl_b32 s8, s8, 10
  v_mfma_f32_16x16x32_bf16 v[44:47], v[116:119], a[44:47], v[44:47]
  s_lshl4_add_u32 s9, s40, s41
  s_and_b32 s32, s3, 2
  v_mfma_f32_16x16x32_bf16 v[48:51], v[120:123], a[44:47], v[48:51]
  buffer_load_dwordx4 v65, s[12:15], s29 offen offset:1024 sc1 lds
  s_lshl_b32 s32, s32, 2
  s_xor_b32 s32, s32, s9
  v_mfma_f32_16x16x32_bf16 v[16:19], v[120:123], a[36:39], v[16:19]
  s_lshl1_add_u32 s32, s32, s33
  s_and_b32 s33, s3, 1
  v_mfma_f32_16x16x32_bf16 v[20:23], v[132:135], a[36:39], v[20:23]
  buffer_load_dwordx4 v65, s[12:15], s29 offen offset:2048 sc1 lds
  s_lshl1_add_u32 s32, s32, s33
  s_lshl_b32 s32, s32, 12
  v_mfma_f32_16x16x32_bf16 v[52:55], v[132:135], a[44:47], v[52:55]
  s_lshl2_add_u32 s9, s9, s3
  s_lshl_b32 s9, s9, 13
  v_mfma_f32_16x16x32_bf16 v[56:59], v[136:139], a[44:47], v[56:59]
  buffer_load_dwordx4 v65, s[12:15], s29 offen offset:3072 sc1 lds
  s_add_u32 s29, s29, 32768
  s_and_b32 s29, s29, 0x3ffff
  s_lshr_b32 s33, s41, 3
  s_or_b32 s33, s33, s3
  v_mfma_f32_16x16x32_bf16 v[40:43], v[136:139], a[36:39], v[40:43]
  s_and_b32 s33, s33, 1
  s_lshr_b32 s9, s9, 1
  s_waitcnt vmcnt(12)
  ds_read_b128 a[144:147], v130 offset:32768
  ds_read_b128 a[148:151], v131 offset:32768
  ds_read_b128 a[152:155], v130 offset:34816
  ds_read_b128 a[156:159], v131 offset:34816
  s_waitcnt vmcnt(8) lgkmcnt(4)
  s_barrier
  v_mfma_f32_16x16x32_bf16 v[12:15], v[140:143], a[48:51], v[12:15]
  ds_read_b64_tr_b16 v[100:101], v8 offset:32768
  ds_read_b64_tr_b16 v[102:103], v9 offset:32768
  v_mfma_f32_16x16x32_bf16 v[44:47], v[140:143], a[56:59], v[44:47]
  ds_read_b64_tr_b16 v[104:105], v8 offset:34816
  ds_read_b64_tr_b16 v[106:107], v9 offset:34816
  v_mfma_f32_16x16x32_bf16 v[48:51], v[144:147], a[56:59], v[48:51]
  ds_read_b64_tr_b16 v[108:109], v8 offset:36864
  ds_read_b64_tr_b16 v[110:111], v9 offset:36864
  v_mfma_f32_16x16x32_bf16 v[16:19], v[144:147], a[48:51], v[16:19]
  ds_read_b64_tr_b16 v[112:113], v8 offset:38912
  ds_read_b64_tr_b16 v[114:115], v9 offset:38912
  v_mfma_f32_16x16x32_bf16 v[20:23], v[148:151], a[48:51], v[20:23]
  ds_read_b64_tr_b16 v[116:117], v8 offset:33024
  ds_read_b64_tr_b16 v[118:119], v9 offset:33024
  v_mfma_f32_16x16x32_bf16 v[52:55], v[148:151], a[56:59], v[52:55]
  ds_read_b64_tr_b16 v[120:121], v8 offset:35072
  ds_read_b64_tr_b16 v[122:123], v9 offset:35072
  v_mfma_f32_16x16x32_bf16 v[56:59], v[152:155], a[56:59], v[56:59]
  ds_read_b64_tr_b16 v[132:133], v8 offset:37120
  ds_read_b64_tr_b16 v[134:135], v9 offset:37120
  v_mfma_f32_16x16x32_bf16 v[40:43], v[152:155], a[48:51], v[40:43]
  ds_read_b64_tr_b16 v[136:137], v8 offset:39168
  ds_read_b64_tr_b16 v[138:139], v9 offset:39168
  v_mfma_f32_16x16x32_bf16 v[12:15], v[156:159], a[52:55], v[12:15]
  s_add_u32 m0, s43, 147456
  s_nop 0
  buffer_load_dwordx4 v124, s[72:75], s28 offen offset:0 lds
  s_mov_b32 s58, 0x07060302
  v_mfma_f32_16x16x32_bf16 v[44:47], v[156:159], a[60:63], v[44:47]
  v_mfma_f32_16x16x32_bf16 v[48:51], v[160:163], a[60:63], v[48:51]
  buffer_load_dwordx4 v125, s[72:75], s28 offen offset:1024 lds
  v_mfma_f32_16x16x32_bf16 v[16:19], v[160:163], a[52:55], v[16:19]
  v_mfma_f32_16x16x32_bf16 v[20:23], v[164:167], a[52:55], v[20:23]
  s_add_u32 m0, s43, 149504
  s_nop 0
  buffer_load_dwordx4 v126, s[72:75], s28 offen offset:0 lds
  v_mfma_f32_16x16x32_bf16 v[52:55], v[164:167], a[60:63], v[52:55]
  v_mfma_f32_16x16x32_bf16 v[56:59], v[168:171], a[60:63], v[56:59]
  buffer_load_dwordx4 v127, s[72:75], s28 offen offset:1024 lds
  s_add_u32 s28, s28, 128
  s_and_b32 s28, s28, 0x3ff
  v_mfma_f32_16x16x32_bf16 v[40:43], v[168:171], a[52:55], v[40:43]
  s_waitcnt lgkmcnt(0)
  v_mfma_f32_16x16x32_bf16 v[12:15], v[100:103], a[64:67], v[12:15]
  ds_read_b64_tr_b16 v[140:141], v8 offset:40960
  ds_read_b64_tr_b16 v[142:143], v9 offset:40960
  v_mfma_f32_16x16x32_bf16 v[44:47], v[100:103], a[72:75], v[44:47]
  ds_read_b64_tr_b16 v[144:145], v8 offset:43008
  ds_read_b64_tr_b16 v[146:147], v9 offset:43008
  v_mfma_f32_16x16x32_bf16 v[48:51], v[104:107], a[72:75], v[48:51]
  ds_read_b64_tr_b16 v[148:149], v8 offset:45056
  ds_read_b64_tr_b16 v[150:151], v9 offset:45056
  v_mfma_f32_16x16x32_bf16 v[16:19], v[104:107], a[64:67], v[16:19]
  ds_read_b64_tr_b16 v[152:153], v8 offset:47104
  ds_read_b64_tr_b16 v[154:155], v9 offset:47104
  v_mfma_f32_16x16x32_bf16 v[20:23], v[108:111], a[64:67], v[20:23]
  ds_read_b64_tr_b16 v[156:157], v8 offset:41216
  ds_read_b64_tr_b16 v[158:159], v9 offset:41216
  v_mfma_f32_16x16x32_bf16 v[52:55], v[108:111], a[72:75], v[52:55]
  ds_read_b64_tr_b16 v[160:161], v8 offset:43264
  ds_read_b64_tr_b16 v[162:163], v9 offset:43264
  v_mfma_f32_16x16x32_bf16 v[56:59], v[112:115], a[72:75], v[56:59]
  ds_read_b64_tr_b16 v[164:165], v8 offset:45312
  ds_read_b64_tr_b16 v[166:167], v9 offset:45312
  v_mfma_f32_16x16x32_bf16 v[40:43], v[112:115], a[64:67], v[40:43]
  ds_read_b64_tr_b16 v[168:169], v8 offset:47360
  ds_read_b64_tr_b16 v[170:171], v9 offset:47360
  v_mfma_f32_16x16x32_bf16 v[12:15], v[116:119], a[68:71], v[12:15]
  s_add_u32 m0, s6, 65536
  s_nop 0
  buffer_load_dwordx4 v65, s[12:15], s29 offen offset:0 sc1 lds
  v_mfma_f32_16x16x32_bf16 v[44:47], v[116:119], a[76:79], v[44:47]
  v_mfma_f32_16x16x32_bf16 v[48:51], v[120:123], a[76:79], v[48:51]
  buffer_load_dwordx4 v65, s[12:15], s29 offen offset:1024 sc1 lds
  v_mfma_f32_16x16x32_bf16 v[16:19], v[120:123], a[68:71], v[16:19]
  v_mfma_f32_16x16x32_bf16 v[20:23], v[132:135], a[68:71], v[20:23]
  buffer_load_dwordx4 v65, s[12:15], s29 offen offset:2048 sc1 lds
  v_mfma_f32_16x16x32_bf16 v[52:55], v[132:135], a[76:79], v[52:55]
  v_mfma_f32_16x16x32_bf16 v[56:59], v[136:139], a[76:79], v[56:59]
  buffer_load_dwordx4 v65, s[12:15], s29 offen offset:3072 sc1 lds
  s_add_u32 s29, s29, 32768
  s_and_b32 s29, s29, 0x3ffff
  v_mfma_f32_16x16x32_bf16 v[40:43], v[136:139], a[68:71], v[40:43]
  s_waitcnt vmcnt(12)
  ds_read_b128 a[160:163], v130 offset:49152
  ds_read_b128 a[164:167], v131 offset:49152
  ds_read_b128 a[168:171], v130 offset:51200
  ds_read_b128 a[172:175], v131 offset:51200
  s_waitcnt vmcnt(8) lgkmcnt(4)
  s_barrier
  v_mfma_f32_16x16x32_bf16 v[12:15], v[140:143], a[80:83], v[12:15]
  ds_read_b64_tr_b16 v[100:101], v8 offset:49152
  ds_read_b64_tr_b16 v[102:103], v9 offset:49152
  v_mfma_f32_16x16x32_bf16 v[44:47], v[140:143], a[88:91], v[44:47]
  ds_read_b64_tr_b16 v[104:105], v8 offset:51200
  ds_read_b64_tr_b16 v[106:107], v9 offset:51200
  v_mfma_f32_16x16x32_bf16 v[48:51], v[144:147], a[88:91], v[48:51]
  ds_read_b64_tr_b16 v[108:109], v8 offset:53248
  ds_read_b64_tr_b16 v[110:111], v9 offset:53248
  v_mfma_f32_16x16x32_bf16 v[16:19], v[144:147], a[80:83], v[16:19]
  ds_read_b64_tr_b16 v[112:113], v8 offset:55296
  ds_read_b64_tr_b16 v[114:115], v9 offset:55296
  v_mfma_f32_16x16x32_bf16 v[20:23], v[148:151], a[80:83], v[20:23]
  ds_read_b64_tr_b16 v[116:117], v8 offset:49408
  ds_read_b64_tr_b16 v[118:119], v9 offset:49408
  v_mfma_f32_16x16x32_bf16 v[52:55], v[148:151], a[88:91], v[52:55]
  ds_read_b64_tr_b16 v[120:121], v8 offset:51456
  ds_read_b64_tr_b16 v[122:123], v9 offset:51456
  v_mfma_f32_16x16x32_bf16 v[56:59], v[152:155], a[88:91], v[56:59]
  ds_read_b64_tr_b16 v[132:133], v8 offset:53504
  ds_read_b64_tr_b16 v[134:135], v9 offset:53504
  v_mfma_f32_16x16x32_bf16 v[40:43], v[152:155], a[80:83], v[40:43]
  ds_read_b64_tr_b16 v[136:137], v8 offset:55552
  ds_read_b64_tr_b16 v[138:139], v9 offset:55552
  v_mfma_f32_16x16x32_bf16 v[12:15], v[156:159], a[84:87], v[12:15]
  s_add_u32 m0, s43, 98304
  s_nop 0
  buffer_load_dwordx4 v124, s[68:71], s28 offen offset:0 lds
  v_mfma_f32_16x16x32_bf16 v[44:47], v[156:159], a[92:95], v[44:47]
  v_mfma_f32_16x16x32_bf16 v[48:51], v[160:163], a[92:95], v[48:51]
  buffer_load_dwordx4 v125, s[68:71], s28 offen offset:1024 lds
  v_mfma_f32_16x16x32_bf16 v[16:19], v[160:163], a[84:87], v[16:19]
  v_mfma_f32_16x16x32_bf16 v[20:23], v[164:167], a[84:87], v[20:23]
  s_add_u32 m0, s43, 100352
  s_nop 0
  buffer_load_dwordx4 v126, s[68:71], s28 offen offset:0 lds
  v_mfma_f32_16x16x32_bf16 v[52:55], v[164:167], a[92:95], v[52:55]
  v_mfma_f32_16x16x32_bf16 v[56:59], v[168:171], a[92:95], v[56:59]
  buffer_load_dwordx4 v127, s[68:71], s28 offen offset:1024 lds
  v_mfma_f32_16x16x32_bf16 v[40:43], v[168:171], a[84:87], v[40:43]
  s_waitcnt lgkmcnt(0)
  v_mfma_f32_16x16x32_bf16 v[12:15], v[100:103], a[96:99], v[12:15]
  ds_read_b64_tr_b16 v[140:141], v8 offset:57344
  ds_read_b64_tr_b16 v[142:143], v9 offset:57344
  v_mfma_f32_16x16x32_bf16 v[44:47], v[100:103], a[104:107], v[44:47]
  ds_read_b64_tr_b16 v[144:145], v8 offset:59392
  ds_read_b64_tr_b16 v[146:147], v9 offset:59392
  v_mfma_f32_16x16x32_bf16 v[48:51], v[104:107], a[104:107], v[48:51]
  ds_read_b64_tr_b16 v[148:149], v8 offset:61440
  ds_read_b64_tr_b16 v[150:151], v9 offset:61440
  v_mfma_f32_16x16x32_bf16 v[16:19], v[104:107], a[96:99], v[16:19]
  ds_read_b64_tr_b16 v[152:153], v8 offset:63488
  ds_read_b64_tr_b16 v[154:155], v9 offset:63488
  v_mfma_f32_16x16x32_bf16 v[20:23], v[108:111], a[96:99], v[20:23]
  ds_read_b64_tr_b16 v[156:157], v8 offset:57600
  ds_read_b64_tr_b16 v[158:159], v9 offset:57600
  v_mfma_f32_16x16x32_bf16 v[52:55], v[108:111], a[104:107], v[52:55]
  ds_read_b64_tr_b16 v[160:161], v8 offset:59648
  ds_read_b64_tr_b16 v[162:163], v9 offset:59648
  v_mfma_f32_16x16x32_bf16 v[56:59], v[112:115], a[104:107], v[56:59]
  ds_read_b64_tr_b16 v[164:165], v8 offset:61696
  ds_read_b64_tr_b16 v[166:167], v9 offset:61696
  v_mfma_f32_16x16x32_bf16 v[40:43], v[112:115], a[96:99], v[40:43]
  ds_read_b64_tr_b16 v[168:169], v8 offset:63744
  ds_read_b64_tr_b16 v[170:171], v9 offset:63744
  v_mfma_f32_16x16x32_bf16 v[12:15], v[116:119], a[100:103], v[12:15]
  s_add_u32 m0, s6, 81920
  s_nop 0
  buffer_load_dwordx4 v65, s[12:15], s29 offen offset:0 sc1 lds
  v_mfma_f32_16x16x32_bf16 v[44:47], v[116:119], a[108:111], v[44:47]
  v_mfma_f32_16x16x32_bf16 v[48:51], v[120:123], a[108:111], v[48:51]
  buffer_load_dwordx4 v65, s[12:15], s29 offen offset:1024 sc1 lds
  v_mfma_f32_16x16x32_bf16 v[16:19], v[120:123], a[100:103], v[16:19]
  v_mfma_f32_16x16x32_bf16 v[20:23], v[132:135], a[100:103], v[20:23]
  buffer_load_dwordx4 v65, s[12:15], s29 offen offset:2048 sc1 lds
  v_mfma_f32_16x16x32_bf16 v[52:55], v[132:135], a[108:111], v[52:55]
  v_mfma_f32_16x16x32_bf16 v[56:59], v[136:139], a[108:111], v[56:59]
  buffer_load_dwordx4 v65, s[12:15], s29 offen offset:3072 sc1 lds
  s_add_u32 s29, s29, 32768
  s_and_b32 s29, s29, 0x3ffff
  v_mfma_f32_16x16x32_bf16 v[40:43], v[136:139], a[100:103], v[40:43]
  v_xor_b32 v130, 0x30000, v130
  v_xor_b32 v131, 0x30000, v131
  s_waitcnt vmcnt(12)
  ds_read_b128 a[176:179], v130 offset:16384
  ds_read_b128 a[180:183], v131 offset:16384
  ds_read_b128 a[184:187], v130 offset:18432
  ds_read_b128 a[188:191], v131 offset:18432
  s_waitcnt vmcnt(8) lgkmcnt(4)
  s_barrier
  v_mfma_f32_16x16x32_bf16 v[12:15], v[140:143], a[112:115], v[12:15]
  ds_read_b64_tr_b16 v[100:101], v10 offset:0
  ds_read_b64_tr_b16 v[102:103], v11 offset:0
  v_mfma_f32_16x16x32_bf16 v[44:47], v[140:143], a[120:123], v[44:47]
  ds_read_b64_tr_b16 v[104:105], v10 offset:2048
  ds_read_b64_tr_b16 v[106:107], v11 offset:2048
  v_mfma_f32_16x16x32_bf16 v[48:51], v[144:147], a[120:123], v[48:51]
  ds_read_b64_tr_b16 v[108:109], v10 offset:4096
  ds_read_b64_tr_b16 v[110:111], v11 offset:4096
  v_mfma_f32_16x16x32_bf16 v[16:19], v[144:147], a[112:115], v[16:19]
  ds_read_b64_tr_b16 v[112:113], v10 offset:6144
  ds_read_b64_tr_b16 v[114:115], v11 offset:6144
  v_mfma_f32_16x16x32_bf16 v[20:23], v[148:151], a[112:115], v[20:23]
  ds_read_b64_tr_b16 v[116:117], v10 offset:256
  ds_read_b64_tr_b16 v[118:119], v11 offset:256
  v_mfma_f32_16x16x32_bf16 v[52:55], v[148:151], a[120:123], v[52:55]
  ds_read_b64_tr_b16 v[120:121], v10 offset:2304
  ds_read_b64_tr_b16 v[122:123], v11 offset:2304
  v_mfma_f32_16x16x32_bf16 v[56:59], v[152:155], a[120:123], v[56:59]
  ds_read_b64_tr_b16 v[132:133], v10 offset:4352
  ds_read_b64_tr_b16 v[134:135], v11 offset:4352
  v_mfma_f32_16x16x32_bf16 v[40:43], v[152:155], a[112:115], v[40:43]
  ds_read_b64_tr_b16 v[136:137], v10 offset:6400
  ds_read_b64_tr_b16 v[138:139], v11 offset:6400
  v_mfma_f32_16x16x32_bf16 v[12:15], v[156:159], a[116:119], v[12:15]
  s_add_u32 m0, s43, 114688
  s_nop 0
  buffer_load_dwordx4 v124, s[72:75], s28 offen offset:0 lds
  v_mfma_f32_16x16x32_bf16 v[44:47], v[156:159], a[124:127], v[44:47]
  v_mfma_f32_16x16x32_bf16 v[48:51], v[160:163], a[124:127], v[48:51]
  buffer_load_dwordx4 v125, s[72:75], s28 offen offset:1024 lds
  v_mfma_f32_16x16x32_bf16 v[16:19], v[160:163], a[116:119], v[16:19]
  v_mfma_f32_16x16x32_bf16 v[20:23], v[164:167], a[116:119], v[20:23]
  s_add_u32 m0, s43, 116736
  s_nop 0
  buffer_load_dwordx4 v126, s[72:75], s28 offen offset:0 lds
  v_mfma_f32_16x16x32_bf16 v[52:55], v[164:167], a[124:127], v[52:55]
  v_mfma_f32_16x16x32_bf16 v[56:59], v[168:171], a[124:127], v[56:59]
  buffer_load_dwordx4 v127, s[72:75], s28 offen offset:1024 lds
  s_add_u32 s28, s28, 128
  s_and_b32 s28, s28, 0x3ff
  v_mfma_f32_16x16x32_bf16 v[40:43], v[168:171], a[116:119], v[40:43]
  buffer_load_dword v188, v7, s[16:19], s56 offen sc1
  s_waitcnt lgkmcnt(0)
  v_mfma_f32_16x16x32_bf16 v[12:15], v[100:103], a[128:131], v[12:15]
  ds_read_b64_tr_b16 v[140:141], v10 offset:8192
  ds_read_b64_tr_b16 v[142:143], v11 offset:8192
  v_mfma_f32_16x16x32_bf16 v[44:47], v[100:103], a[136:139], v[44:47]
  ds_read_b64_tr_b16 v[144:145], v10 offset:10240
  ds_read_b64_tr_b16 v[146:147], v11 offset:10240
  v_mfma_f32_16x16x32_bf16 v[48:51], v[104:107], a[136:139], v[48:51]
  ds_read_b64_tr_b16 v[148:149], v10 offset:12288
  ds_read_b64_tr_b16 v[150:151], v11 offset:12288
  v_mfma_f32_16x16x32_bf16 v[16:19], v[104:107], a[128:131], v[16:19]
  ds_read_b64_tr_b16 v[152:153], v10 offset:14336
  ds_read_b64_tr_b16 v[154:155], v11 offset:14336
  v_mfma_f32_16x16x32_bf16 v[20:23], v[108:111], a[128:131], v[20:23]
  ds_read_b64_tr_b16 v[156:157], v10 offset:8448
  ds_read_b64_tr_b16 v[158:159], v11 offset:8448
  v_mfma_f32_16x16x32_bf16 v[52:55], v[108:111], a[136:139], v[52:55]
  ds_read_b64_tr_b16 v[160:161], v10 offset:10496
  ds_read_b64_tr_b16 v[162:163], v11 offset:10496
  v_mfma_f32_16x16x32_bf16 v[56:59], v[112:115], a[136:139], v[56:59]
  ds_read_b64_tr_b16 v[164:165], v10 offset:12544
  ds_read_b64_tr_b16 v[166:167], v11 offset:12544
  v_mfma_f32_16x16x32_bf16 v[40:43], v[112:115], a[128:131], v[40:43]
  ds_read_b64_tr_b16 v[168:169], v10 offset:14592
  ds_read_b64_tr_b16 v[170:171], v11 offset:14592
  v_mfma_f32_16x16x32_bf16 v[12:15], v[116:119], a[132:135], v[12:15]
  s_add_u32 m0, s6, 0
  s_nop 0
  buffer_load_dwordx4 v65, s[12:15], s29 offen offset:0 sc1 lds
  v_mfma_f32_16x16x32_bf16 v[44:47], v[116:119], a[140:143], v[44:47]
  v_mfma_f32_16x16x32_bf16 v[48:51], v[120:123], a[140:143], v[48:51]
  buffer_load_dwordx4 v65, s[12:15], s29 offen offset:1024 sc1 lds
  v_mfma_f32_16x16x32_bf16 v[16:19], v[120:123], a[132:135], v[16:19]
  v_mfma_f32_16x16x32_bf16 v[20:23], v[132:135], a[132:135], v[20:23]
  buffer_load_dwordx4 v65, s[12:15], s29 offen offset:2048 sc1 lds
  v_mfma_f32_16x16x32_bf16 v[52:55], v[132:135], a[140:143], v[52:55]
  v_mfma_f32_16x16x32_bf16 v[56:59], v[136:139], a[140:143], v[56:59]
  buffer_load_dwordx4 v65, s[12:15], s29 offen offset:3072 sc1 lds
  s_add_u32 s29, s29, 32768
  s_and_b32 s29, s29, 0x3ffff
  v_mfma_f32_16x16x32_bf16 v[40:43], v[136:139], a[132:135], v[40:43]
  v_xor_b32 v130, 0x30000, v130
  v_xor_b32 v131, 0x30000, v131
  s_waitcnt vmcnt(13)
  ds_read_b128 a[192:195], v130 offset:32768
  ds_read_b128 a[196:199], v131 offset:32768
  ds_read_b128 a[200:203], v130 offset:34816
  ds_read_b128 a[204:207], v131 offset:34816
  s_waitcnt vmcnt(9) lgkmcnt(4)
  s_barrier
  v_mfma_f32_16x16x32_bf16 v[12:15], v[140:143], a[144:147], v[12:15]
  ds_read_b64_tr_b16 v[100:101], v10 offset:16384
  ds_read_b64_tr_b16 v[102:103], v11 offset:16384
  v_mfma_f32_16x16x32_bf16 v[44:47], v[140:143], a[152:155], v[44:47]
  ds_read_b64_tr_b16 v[104:105], v10 offset:18432
  ds_read_b64_tr_b16 v[106:107], v11 offset:18432
  v_mfma_f32_16x16x32_bf16 v[48:51], v[144:147], a[152:155], v[48:51]
  ds_read_b64_tr_b16 v[108:109], v10 offset:20480
  ds_read_b64_tr_b16 v[110:111], v11 offset:20480
  v_mfma_f32_16x16x32_bf16 v[16:19], v[144:147], a[144:147], v[16:19]
  ds_read_b64_tr_b16 v[112:113], v10 offset:22528
  ds_read_b64_tr_b16 v[114:115], v11 offset:22528
  v_mfma_f32_16x16x32_bf16 v[20:23], v[148:151], a[144:147], v[20:23]
  ds_read_b64_tr_b16 v[116:117], v10 offset:16640
  ds_read_b64_tr_b16 v[118:119], v11 offset:16640
  v_mfma_f32_16x16x32_bf16 v[52:55], v[148:151], a[152:155], v[52:55]
  ds_read_b64_tr_b16 v[120:121], v10 offset:18688
  ds_read_b64_tr_b16 v[122:123], v11 offset:18688
  v_mfma_f32_16x16x32_bf16 v[56:59], v[152:155], a[152:155], v[56:59]
  ds_read_b64_tr_b16 v[132:133], v10 offset:20736
  ds_read_b64_tr_b16 v[134:135], v11 offset:20736
  v_mfma_f32_16x16x32_bf16 v[40:43], v[152:155], a[144:147], v[40:43]
  ds_read_b64_tr_b16 v[136:137], v10 offset:22784
  ds_read_b64_tr_b16 v[138:139], v11 offset:22784
  v_mfma_f32_16x16x32_bf16 v[12:15], v[156:159], a[148:151], v[12:15]
  s_add_u32 m0, s43, 147456
  s_nop 0
  buffer_load_dwordx4 v124, s[68:71], s28 offen offset:0 lds
  v_mfma_f32_16x16x32_bf16 v[44:47], v[156:159], a[156:159], v[44:47]
  v_mfma_f32_16x16x32_bf16 v[48:51], v[160:163], a[156:159], v[48:51]
  buffer_load_dwordx4 v125, s[68:71], s28 offen offset:1024 lds
  v_mfma_f32_16x16x32_bf16 v[16:19], v[160:163], a[148:151], v[16:19]
  v_mfma_f32_16x16x32_bf16 v[20:23], v[164:167], a[148:151], v[20:23]
  s_add_u32 m0, s43, 149504
  s_nop 0
  buffer_load_dwordx4 v126, s[68:71], s28 offen offset:0 lds
  v_mfma_f32_16x16x32_bf16 v[52:55], v[164:167], a[156:159], v[52:55]
  v_mfma_f32_16x16x32_bf16 v[56:59], v[168:171], a[156:159], v[56:59]
  buffer_load_dwordx4 v127, s[68:71], s28 offen offset:1024 lds
  v_mfma_f32_16x16x32_bf16 v[40:43], v[168:171], a[148:151], v[40:43]
  s_cmp_lg_u32 s3, 1
  s_cbranch_scc1 gated_mix__spectral_gfnet__ssm_conv_s5__prompt_kernel_skip45
  s_getpc_b64 s[48:49]
gated_mix__spectral_gfnet__ssm_conv_s5__prompt_kernel_pc44:
  s_lshr_b32 s59, s2, 3
  s_mul_i32 s59, s59, 512
  v_min_u32 v190, 3, v1
  v_lshl_add_u32 v190, v190, 7, s59
  v_min_u32 v190, gated_mix__spectral_gfnet__ssm_conv_s5__prompt_kernel_end-gated_mix__spectral_gfnet__ssm_conv_s5__prompt_kernel_pc44, v190
  v_mov_b32 v191, 0
  v_lshl_add_u64 v[190:191], v[190:191], 0, s[48:49]
  global_load_dword v4, v[190:191], off
gated_mix__spectral_gfnet__ssm_conv_s5__prompt_kernel_skip45:
  s_waitcnt lgkmcnt(0)
  v_mfma_f32_16x16x32_bf16 v[12:15], v[100:103], a[160:163], v[12:15]
  ds_read_b64_tr_b16 v[140:141], v10 offset:24576
  ds_read_b64_tr_b16 v[142:143], v11 offset:24576
  v_mfma_f32_16x16x32_bf16 v[44:47], v[100:103], a[168:171], v[44:47]
  ds_read_b64_tr_b16 v[144:145], v10 offset:26624
  ds_read_b64_tr_b16 v[146:147], v11 offset:26624
  v_mfma_f32_16x16x32_bf16 v[48:51], v[104:107], a[168:171], v[48:51]
  ds_read_b64_tr_b16 v[148:149], v10 offset:28672
  ds_read_b64_tr_b16 v[150:151], v11 offset:28672
  v_mfma_f32_16x16x32_bf16 v[16:19], v[104:107], a[160:163], v[16:19]
  ds_read_b64_tr_b16 v[152:153], v10 offset:30720
  ds_read_b64_tr_b16 v[154:155], v11 offset:30720
  v_mfma_f32_16x16x32_bf16 v[20:23], v[108:111], a[160:163], v[20:23]
  ds_read_b64_tr_b16 v[156:157], v10 offset:24832
  ds_read_b64_tr_b16 v[158:159], v11 offset:24832
  v_mfma_f32_16x16x32_bf16 v[52:55], v[108:111], a[168:171], v[52:55]
  ds_read_b64_tr_b16 v[160:161], v10 offset:26880
  ds_read_b64_tr_b16 v[162:163], v11 offset:26880
  v_mfma_f32_16x16x32_bf16 v[56:59], v[112:115], a[168:171], v[56:59]
  ds_read_b64_tr_b16 v[164:165], v10 offset:28928
  ds_read_b64_tr_b16 v[166:167], v11 offset:28928
  v_mfma_f32_16x16x32_bf16 v[40:43], v[112:115], a[160:163], v[40:43]
  ds_read_b64_tr_b16 v[168:169], v10 offset:30976
  ds_read_b64_tr_b16 v[170:171], v11 offset:30976
  v_mfma_f32_16x16x32_bf16 v[12:15], v[116:119], a[164:167], v[12:15]
  s_add_u32 m0, s6, 16384
  s_nop 0
  buffer_load_dwordx4 v65, s[12:15], s29 offen offset:0 sc1 lds
  v_mfma_f32_16x16x32_bf16 v[44:47], v[116:119], a[172:175], v[44:47]
  v_mfma_f32_16x16x32_bf16 v[48:51], v[120:123], a[172:175], v[48:51]
  buffer_load_dwordx4 v65, s[12:15], s29 offen offset:1024 sc1 lds
  v_mfma_f32_16x16x32_bf16 v[16:19], v[120:123], a[164:167], v[16:19]
  v_mfma_f32_16x16x32_bf16 v[20:23], v[132:135], a[164:167], v[20:23]
  buffer_load_dwordx4 v65, s[12:15], s29 offen offset:2048 sc1 lds
  v_mfma_f32_16x16x32_bf16 v[52:55], v[132:135], a[172:175], v[52:55]
  v_mfma_f32_16x16x32_bf16 v[56:59], v[136:139], a[172:175], v[56:59]
  buffer_load_dwordx4 v65, s[12:15], s29 offen offset:3072 sc1 lds
  s_add_u32 s29, s29, 32768
  s_and_b32 s29, s29, 0x3ffff
  v_xor_b32 v65, 8192, v65
  v_mfma_f32_16x16x32_bf16 v[40:43], v[136:139], a[164:167], v[40:43]
  s_waitcnt vmcnt(13)
  ds_read_b128 a[208:211], v130 offset:49152
  ds_read_b128 a[212:215], v131 offset:49152
  ds_read_b128 a[216:219], v130 offset:51200
  ds_read_b128 a[220:223], v131 offset:51200
  s_waitcnt vmcnt(12)
  v_cmp_ne_u32 vcc, 1, v188
  s_nop 0
  s_cbranch_vccz gated_mix__spectral_gfnet__ssm_conv_s5__prompt_kernel_skip46
  s_mov_b32 s59, 0
gated_mix__spectral_gfnet__ssm_conv_s5__prompt_kernel_poll47:
  s_sleep 16
  buffer_load_dword v188, v7, s[16:19], s56 offen sc1
  s_waitcnt vmcnt(0)
  v_cmp_ne_u32 vcc, 1, v188
  s_nop 0
  s_cbranch_vccz gated_mix__spectral_gfnet__ssm_conv_s5__prompt_kernel_pollout48
  s_add_u32 s59, s59, 1
  s_cmp_lt_u32 s59, 1048576
  s_cbranch_scc1 gated_mix__spectral_gfnet__ssm_conv_s5__prompt_kernel_poll47
gated_mix__spectral_gfnet__ssm_conv_s5__prompt_kernel_pollout48:
gated_mix__spectral_gfnet__ssm_conv_s5__prompt_kernel_skip46:
  s_waitcnt vmcnt(8) lgkmcnt(4)
  s_barrier
  v_mfma_f32_16x16x32_bf16 v[12:15], v[140:143], a[176:179], v[12:15]
  ds_read_b64_tr_b16 v[100:101], v8 offset:0
  ds_read_b64_tr_b16 v[102:103], v9 offset:0
  v_mfma_f32_16x16x32_bf16 v[44:47], v[140:143], a[184:187], v[44:47]
  ds_read_b64_tr_b16 v[104:105], v8 offset:2048
  ds_read_b64_tr_b16 v[106:107], v9 offset:2048
  v_mfma_f32_16x16x32_bf16 v[48:51], v[144:147], a[184:187], v[48:51]
  ds_read_b64_tr_b16 v[108:109], v8 offset:4096
  ds_read_b64_tr_b16 v[110:111], v9 offset:4096
  v_mfma_f32_16x16x32_bf16 v[16:19], v[144:147], a[176:179], v[16:19]
  ds_read_b64_tr_b16 v[112:113], v8 offset:6144
  ds_read_b64_tr_b16 v[114:115], v9 offset:6144
  v_mfma_f32_16x16x32_bf16 v[20:23], v[148:151], a[176:179], v[20:23]
  ds_read_b64_tr_b16 v[116:117], v8 offset:256
  ds_read_b64_tr_b16 v[118:119], v9 offset:256
  v_mfma_f32_16x16x32_bf16 v[52:55], v[148:151], a[184:187], v[52:55]
  ds_read_b64_tr_b16 v[120:121], v8 offset:2304
  ds_read_b64_tr_b16 v[122:123], v9 offset:2304
  v_mfma_f32_16x16x32_bf16 v[56:59], v[152:155], a[184:187], v[56:59]
  ds_read_b64_tr_b16 v[132:133], v8 offset:4352
  ds_read_b64_tr_b16 v[134:135], v9 offset:4352
  v_mfma_f32_16x16x32_bf16 v[40:43], v[152:155], a[176:179], v[40:43]
  ds_read_b64_tr_b16 v[136:137], v8 offset:6400
  ds_read_b64_tr_b16 v[138:139], v9 offset:6400
  v_mfma_f32_16x16x32_bf16 v[12:15], v[156:159], a[180:183], v[12:15]
  s_add_u32 m0, s43, 98304
  s_nop 0
  buffer_load_dwordx4 v124, s[72:75], s28 offen offset:0 lds
  v_mfma_f32_16x16x32_bf16 v[44:47], v[156:159], a[188:191], v[44:47]
  v_mfma_f32_16x16x32_bf16 v[48:51], v[160:163], a[188:191], v[48:51]
  buffer_load_dwordx4 v125, s[72:75], s28 offen offset:1024 lds
  v_mfma_f32_16x16x32_bf16 v[16:19], v[160:163], a[180:183], v[16:19]
  v_mfma_f32_16x16x32_bf16 v[20:23], v[164:167], a[180:183], v[20:23]
  s_add_u32 m0, s43, 100352
  s_nop 0
  buffer_load_dwordx4 v126, s[72:75], s28 offen offset:0 lds
  v_mfma_f32_16x16x32_bf16 v[52:55], v[164:167], a[188:191], v[52:55]
  v_mfma_f32_16x16x32_bf16 v[56:59], v[168:171], a[188:191], v[56:59]
  buffer_load_dwordx4 v127, s[72:75], s28 offen offset:1024 lds
  s_add_u32 s28, s28, 128
  s_and_b32 s28, s28, 0x3ff
  v_mfma_f32_16x16x32_bf16 v[40:43], v[168:171], a[180:183], v[40:43]
  buffer_load_dwordx4 v[124:127], v64, s[20:23], s32 offen offset:0 sc1
  buffer_load_dwordx4 v[188:191], v64, s[20:23], s32 offen offset:1024 sc1
  buffer_load_dwordx4 v[192:195], v64, s[20:23], s32 offen offset:2048 sc1
  buffer_load_dwordx4 v[196:199], v64, s[20:23], s32 offen offset:3072 sc1
  s_waitcnt lgkmcnt(0)
  v_mfma_f32_16x16x32_bf16 v[12:15], v[100:103], a[192:195], v[12:15]
  ds_read_b64_tr_b16 v[140:141], v8 offset:8192
  ds_read_b64_tr_b16 v[142:143], v9 offset:8192
  v_mfma_f32_16x16x32_bf16 v[44:47], v[100:103], a[200:203], v[44:47]
  ds_read_b64_tr_b16 v[144:145], v8 offset:10240
  ds_read_b64_tr_b16 v[146:147], v9 offset:10240
  v_mfma_f32_16x16x32_bf16 v[48:51], v[104:107], a[200:203], v[48:51]
  ds_read_b64_tr_b16 v[148:149], v8 offset:12288
  ds_read_b64_tr_b16 v[150:151], v9 offset:12288
  v_mfma_f32_16x16x32_bf16 v[16:19], v[104:107], a[192:195], v[16:19]
  ds_read_b64_tr_b16 v[152:153], v8 offset:14336
  ds_read_b64_tr_b16 v[154:155], v9 offset:14336
  v_mfma_f32_16x16x32_bf16 v[20:23], v[108:111], a[192:195], v[20:23]
  ds_read_b64_tr_b16 v[156:157], v8 offset:8448
  ds_read_b64_tr_b16 v[158:159], v9 offset:8448
  v_mfma_f32_16x16x32_bf16 v[52:55], v[108:111], a[200:203], v[52:55]
  ds_read_b64_tr_b16 v[160:161], v8 offset:10496
  ds_read_b64_tr_b16 v[162:163], v9 offset:10496
  v_mfma_f32_16x16x32_bf16 v[56:59], v[112:115], a[200:203], v[56:59]
  ds_read_b64_tr_b16 v[164:165], v8 offset:12544
  ds_read_b64_tr_b16 v[166:167], v9 offset:12544
  v_mfma_f32_16x16x32_bf16 v[40:43], v[112:115], a[192:195], v[40:43]
  ds_read_b64_tr_b16 v[168:169], v8 offset:14592
  ds_read_b64_tr_b16 v[170:171], v9 offset:14592
  v_mfma_f32_16x16x32_bf16 v[12:15], v[116:119], a[196:199], v[12:15]
  s_lshr_b32 m0, s3, 1
  s_lshl_b32 m0, m0, 15
  s_add_u32 s29, s29, m0
  s_and_b32 s29, s29, 0x3ffff
  s_and_b32 m0, s3, 1
  s_lshl_b32 m0, m0, 14
  v_and_b32 v65, 0xffffafff, v65
  v_or_b32 v65, m0, v65
  s_add_u32 m0, s6, 32768
  s_nop 0
  buffer_load_dwordx4 v65, s[12:15], s29 offen offset:0 sc1 lds
  v_mfma_f32_16x16x32_bf16 v[44:47], v[116:119], a[204:207], v[44:47]
  v_mfma_f32_16x16x32_bf16 v[48:51], v[120:123], a[204:207], v[48:51]
  buffer_load_dwordx4 v65, s[12:15], s29 offen offset:1024 sc1 lds
  v_mfma_f32_16x16x32_bf16 v[16:19], v[120:123], a[196:199], v[16:19]
  v_mfma_f32_16x16x32_bf16 v[20:23], v[132:135], a[196:199], v[20:23]
  buffer_load_dwordx4 v65, s[12:15], s29 offen offset:2048 sc1 lds
  v_mfma_f32_16x16x32_bf16 v[52:55], v[132:135], a[204:207], v[52:55]
  v_mfma_f32_16x16x32_bf16 v[56:59], v[136:139], a[204:207], v[56:59]
  buffer_load_dwordx4 v65, s[12:15], s29 offen offset:3072 sc1 lds
  s_add_u32 s29, s29, 65536
  s_and_b32 s29, s29, 0x3ffff
  v_mfma_f32_16x16x32_bf16 v[40:43], v[136:139], a[196:199], v[40:43]
  v_xor_b32 v130, 0x30000, v130
  v_xor_b32 v131, 0x30000, v131
  s_waitcnt vmcnt(16)
  ds_read_b128 a[224:227], v130 offset:16384
  ds_read_b128 a[228:231], v131 offset:16384
  ds_read_b128 a[232:235], v130 offset:18432
  ds_read_b128 a[236:239], v131 offset:18432
  s_waitcnt vmcnt(12) lgkmcnt(4)
  s_barrier
  v_mfma_f32_16x16x32_bf16 v[12:15], v[140:143], a[208:211], v[12:15]
  ds_read_b64_tr_b16 v[100:101], v8 offset:16384
  ds_read_b64_tr_b16 v[102:103], v9 offset:16384
  v_mfma_f32_16x16x32_bf16 v[44:47], v[140:143], a[216:219], v[44:47]
  ds_read_b64_tr_b16 v[104:105], v8 offset:18432
  ds_read_b64_tr_b16 v[106:107], v9 offset:18432
  v_mfma_f32_16x16x32_bf16 v[48:51], v[144:147], a[216:219], v[48:51]
  ds_read_b64_tr_b16 v[108:109], v8 offset:20480
  ds_read_b64_tr_b16 v[110:111], v9 offset:20480
  v_mfma_f32_16x16x32_bf16 v[16:19], v[144:147], a[208:211], v[16:19]
  ds_read_b64_tr_b16 v[112:113], v8 offset:22528
  ds_read_b64_tr_b16 v[114:115], v9 offset:22528
  v_mfma_f32_16x16x32_bf16 v[20:23], v[148:151], a[208:211], v[20:23]
  ds_read_b64_tr_b16 v[116:117], v8 offset:16640
  ds_read_b64_tr_b16 v[118:119], v9 offset:16640
  v_mfma_f32_16x16x32_bf16 v[52:55], v[148:151], a[216:219], v[52:55]
  ds_read_b64_tr_b16 v[120:121], v8 offset:18688
  ds_read_b64_tr_b16 v[122:123], v9 offset:18688
  v_mfma_f32_16x16x32_bf16 v[56:59], v[152:155], a[216:219], v[56:59]
  ds_read_b64_tr_b16 v[132:133], v8 offset:20736
  ds_read_b64_tr_b16 v[134:135], v9 offset:20736
  v_mfma_f32_16x16x32_bf16 v[40:43], v[152:155], a[208:211], v[40:43]
  ds_read_b64_tr_b16 v[136:137], v8 offset:22784
  ds_read_b64_tr_b16 v[138:139], v9 offset:22784
  v_mfma_f32_16x16x32_bf16 v[12:15], v[156:159], a[212:215], v[12:15]
  s_add_u32 m0, s6, 49152
  s_nop 0
  buffer_load_dwordx4 v65, s[12:15], s29 offen offset:0 sc1 lds
  s_lshl_b32 s28, s3, 10
  s_add_u32 s28, s28, 131072
  v_lshl_add_u32 v67, v1, 4, s28
  s_waitcnt vmcnt(8)
  v_lshlrev_b32 v200, 16, v124
  v_and_b32 v202, 0xffff0000, v124
  v_lshlrev_b32 v201, 16, v125
  v_and_b32 v203, 0xffff0000, v125
  s_waitcnt vmcnt(7)
  v_lshlrev_b32 v204, 16, v188
  v_and_b32 v206, 0xffff0000, v188
  v_lshlrev_b32 v205, 16, v189
  v_and_b32 v207, 0xffff0000, v189
  s_waitcnt vmcnt(6)
  v_lshlrev_b32 v208, 16, v192
  v_and_b32 v210, 0xffff0000, v192
  v_lshlrev_b32 v209, 16, v193
  v_and_b32 v211, 0xffff0000, v193
  s_waitcnt vmcnt(5)
  v_lshlrev_b32 v212, 16, v196
  v_and_b32 v214, 0xffff0000, v196
  v_lshlrev_b32 v213, 16, v197
  v_and_b32 v215, 0xffff0000, v197
  v_pk_add_f32 v[216:217], v[200:201], v[208:209]
  v_pk_add_f32 v[220:221], v[200:201], v[208:209] neg_lo:[0,1] neg_hi:[0,1]
  v_pk_add_f32 v[224:225], v[204:205], v[212:213]
  v_pk_add_f32 v[218:219], v[202:203], v[210:211]
  v_pk_add_f32 v[222:223], v[202:203], v[210:211] neg_lo:[0,1] neg_hi:[0,1]
  v_pk_add_f32 v[226:227], v[206:207], v[214:215]
  v_pk_add_f32 v[228:229], v[214:215], v[206:207] neg_lo:[0,1] neg_hi:[0,1]
  v_pk_add_f32 v[230:231], v[204:205], v[212:213] neg_lo:[0,1] neg_hi:[0,1]
  s_cmp_lg_u32 s33, 0
  s_cbranch_scc1 gated_mix__spectral_gfnet__ssm_conv_s5__prompt_kernel_skip49
  s_mov_b64 exec, 15
  v_pk_add_f32 v[224:225], v[204:205], v[204:205]
  v_pk_add_f32 v[226:227], v[212:213], v[212:213]
  v_pk_add_f32 v[228:229], v[206:207], v[206:207] neg_lo:[1,1] neg_hi:[1,1]
  v_pk_add_f32 v[230:231], v[214:215], v[214:215] neg_lo:[1,1] neg_hi:[1,1]
  s_mov_b64 exec, -1
gated_mix__spectral_gfnet__ssm_conv_s5__prompt_kernel_skip49:
  v_pk_add_f32 v[200:201], v[216:217], v[224:225]
  v_cvt_pk_bf16_f32 v232, v200, v201
  v_pk_add_f32 v[202:203], v[218:219], v[226:227]
  v_cvt_pk_bf16_f32 v233, v202, v203
  v_pk_add_f32 v[204:205], v[220:221], v[228:229]
  v_cvt_pk_bf16_f32 v234, v204, v205
  v_pk_add_f32 v[206:207], v[222:223], v[230:231]
  v_cvt_pk_bf16_f32 v235, v206, v207
  v_pk_add_f32 v[208:209], v[216:217], v[224:225] neg_lo:[0,1] neg_hi:[0,1]
  v_cvt_pk_bf16_f32 v236, v208, v209
  v_pk_add_f32 v[210:211], v[218:219], v[226:227] neg_lo:[0,1] neg_hi:[0,1]
  v_cvt_pk_bf16_f32 v237, v210, v211
  v_pk_add_f32 v[212:213], v[220:221], v[228:229] neg_lo:[0,1] neg_hi:[0,1]
  v_cvt_pk_bf16_f32 v238, v212, v213
  v_pk_add_f32 v[214:215], v[222:223], v[230:231] neg_lo:[0,1] neg_hi:[0,1]
  v_cvt_pk_bf16_f32 v239, v214, v215
  v_lshlrev_b32 v200, 16, v126
  v_and_b32 v202, 0xffff0000, v126
  v_lshlrev_b32 v201, 16, v127
  v_and_b32 v203, 0xffff0000, v127
  v_lshlrev_b32 v204, 16, v190
  v_and_b32 v206, 0xffff0000, v190
  v_lshlrev_b32 v205, 16, v191
  v_and_b32 v207, 0xffff0000, v191
  v_lshlrev_b32 v208, 16, v194
  v_and_b32 v210, 0xffff0000, v194
  v_lshlrev_b32 v209, 16, v195
  v_and_b32 v211, 0xffff0000, v195
  v_lshlrev_b32 v212, 16, v198
  v_and_b32 v214, 0xffff0000, v198
  v_lshlrev_b32 v213, 16, v199
  v_and_b32 v215, 0xffff0000, v199
  v_pk_add_f32 v[216:217], v[200:201], v[208:209]
  v_pk_add_f32 v[220:221], v[200:201], v[208:209] neg_lo:[0,1] neg_hi:[0,1]
  v_pk_add_f32 v[224:225], v[204:205], v[212:213]
  v_pk_add_f32 v[218:219], v[202:203], v[210:211]
  v_pk_add_f32 v[222:223], v[202:203], v[210:211] neg_lo:[0,1] neg_hi:[0,1]
  v_pk_add_f32 v[226:227], v[206:207], v[214:215]
  v_pk_add_f32 v[228:229], v[214:215], v[206:207] neg_lo:[0,1] neg_hi:[0,1]
  v_pk_add_f32 v[230:231], v[204:205], v[212:213] neg_lo:[0,1] neg_hi:[0,1]
  s_cmp_lg_u32 s33, 0
  s_cbranch_scc1 gated_mix__spectral_gfnet__ssm_conv_s5__prompt_kernel_skip50
  s_mov_b64 exec, 15
  v_pk_add_f32 v[224:225], v[204:205], v[204:205]
  v_pk_add_f32 v[226:227], v[212:213], v[212:213]
  v_pk_add_f32 v[228:229], v[206:207], v[206:207] neg_lo:[1,1] neg_hi:[1,1]
  v_pk_add_f32 v[230:231], v[214:215], v[214:215] neg_lo:[1,1] neg_hi:[1,1]
  s_mov_b64 exec, -1
gated_mix__spectral_gfnet__ssm_conv_s5__prompt_kernel_skip50:
  v_pk_add_f32 v[200:201], v[216:217], v[224:225]
  v_cvt_pk_bf16_f32 v125, v200, v201
  v_pk_add_f32 v[202:203], v[218:219], v[226:227]
  v_cvt_pk_bf16_f32 v127, v202, v203
  v_pk_add_f32 v[204:205], v[220:221], v[228:229]
  v_cvt_pk_bf16_f32 v189, v204, v205
  v_pk_add_f32 v[206:207], v[222:223], v[230:231]
  v_cvt_pk_bf16_f32 v191, v206, v207
  v_pk_add_f32 v[208:209], v[216:217], v[224:225] neg_lo:[0,1] neg_hi:[0,1]
  v_cvt_pk_bf16_f32 v193, v208, v209
  v_pk_add_f32 v[210:211], v[218:219], v[226:227] neg_lo:[0,1] neg_hi:[0,1]
  v_cvt_pk_bf16_f32 v195, v210, v211
  v_pk_add_f32 v[212:213], v[220:221], v[228:229] neg_lo:[0,1] neg_hi:[0,1]
  v_cvt_pk_bf16_f32 v197, v212, v213
  v_pk_add_f32 v[214:215], v[222:223], v[230:231] neg_lo:[0,1] neg_hi:[0,1]
  v_cvt_pk_bf16_f32 v199, v214, v215
  v_mov_b32 v124, v232
  v_mov_b32 v126, v233
  ds_write_b128 v67, v[124:127] offset:0
  v_mov_b32 v188, v234
  v_mov_b32 v190, v235
  ds_write_b128 v67, v[188:191] offset:4096
  v_mov_b32 v192, v236
  v_mov_b32 v194, v237
  ds_write_b128 v67, v[192:195] offset:8192
  v_mov_b32 v196, v238
  v_mov_b32 v198, v239
  ds_write_b128 v67, v[196:199] offset:12288
  v_mfma_f32_16x16x32_bf16 v[44:47], v[156:159], a[220:223], v[44:47]
  v_mfma_f32_16x16x32_bf16 v[48:51], v[160:163], a[220:223], v[48:51]
  buffer_load_dwordx4 v65, s[12:15], s29 offen offset:1024 sc1 lds
  v_mfma_f32_16x16x32_bf16 v[16:19], v[160:163], a[212:215], v[16:19]
  v_mfma_f32_16x16x32_bf16 v[20:23], v[164:167], a[212:215], v[20:23]
  buffer_load_dwordx4 v65, s[12:15], s29 offen offset:2048 sc1 lds
  v_mfma_f32_16x16x32_bf16 v[52:55], v[164:167], a[220:223], v[52:55]
  v_mfma_f32_16x16x32_bf16 v[56:59], v[168:171], a[220:223], v[56:59]
  buffer_load_dwordx4 v65, s[12:15], s29 offen offset:3072 sc1 lds
  s_add_u32 s29, s29, 65536
  s_and_b32 s29, s29, 0x3ffff
  v_mfma_f32_16x16x32_bf16 v[40:43], v[168:171], a[212:215], v[40:43]
  s_waitcnt lgkmcnt(4)
  v_mfma_f32_16x16x32_bf16 v[12:15], v[100:103], a[224:227], v[12:15]
  ds_read_b64_tr_b16 v[140:141], v8 offset:24576
  ds_read_b64_tr_b16 v[142:143], v9 offset:24576
  v_mfma_f32_16x16x32_bf16 v[44:47], v[100:103], a[232:235], v[44:47]
  ds_read_b64_tr_b16 v[144:145], v8 offset:26624
  ds_read_b64_tr_b16 v[146:147], v9 offset:26624
  v_mfma_f32_16x16x32_bf16 v[48:51], v[104:107], a[232:235], v[48:51]
  ds_read_b64_tr_b16 v[148:149], v8 offset:28672
  ds_read_b64_tr_b16 v[150:151], v9 offset:28672
  v_mfma_f32_16x16x32_bf16 v[16:19], v[104:107], a[224:227], v[16:19]
  ds_read_b64_tr_b16 v[152:153], v8 offset:30720
  ds_read_b64_tr_b16 v[154:155], v9 offset:30720
  v_mfma_f32_16x16x32_bf16 v[20:23], v[108:111], a[224:227], v[20:23]
  ds_read_b64_tr_b16 v[156:157], v8 offset:24832
  ds_read_b64_tr_b16 v[158:159], v9 offset:24832
  v_mfma_f32_16x16x32_bf16 v[52:55], v[108:111], a[232:235], v[52:55]
  ds_read_b64_tr_b16 v[160:161], v8 offset:26880
  ds_read_b64_tr_b16 v[162:163], v9 offset:26880
  v_mfma_f32_16x16x32_bf16 v[56:59], v[112:115], a[232:235], v[56:59]
  ds_read_b64_tr_b16 v[164:165], v8 offset:28928
  ds_read_b64_tr_b16 v[166:167], v9 offset:28928
  v_mfma_f32_16x16x32_bf16 v[40:43], v[112:115], a[224:227], v[40:43]
  ds_read_b64_tr_b16 v[168:169], v8 offset:30976
  ds_read_b64_tr_b16 v[170:171], v9 offset:30976
  v_mfma_f32_16x16x32_bf16 v[12:15], v[116:119], a[228:231], v[12:15]
  s_add_u32 m0, s6, 65536
  s_nop 0
  buffer_load_dwordx4 v65, s[12:15], s29 offen offset:0 sc1 lds
  v_mfma_f32_16x16x32_bf16 v[44:47], v[116:119], a[236:239], v[44:47]
  v_mfma_f32_16x16x32_bf16 v[48:51], v[120:123], a[236:239], v[48:51]
  buffer_load_dwordx4 v65, s[12:15], s29 offen offset:1024 sc1 lds
  v_mfma_f32_16x16x32_bf16 v[16:19], v[120:123], a[228:231], v[16:19]
  v_mfma_f32_16x16x32_bf16 v[20:23], v[132:135], a[228:231], v[20:23]
  buffer_load_dwordx4 v65, s[12:15], s29 offen offset:2048 sc1 lds
  v_mfma_f32_16x16x32_bf16 v[52:55], v[132:135], a[236:239], v[52:55]
  v_mfma_f32_16x16x32_bf16 v[56:59], v[136:139], a[236:239], v[56:59]
  buffer_load_dwordx4 v65, s[12:15], s29 offen offset:3072 sc1 lds
  s_add_u32 s29, s29, 65536
  s_and_b32 s29, s29, 0x3ffff
  v_mfma_f32_16x16x32_bf16 v[40:43], v[136:139], a[228:231], v[40:43]
  v_xor_b32 v130, 0x30000, v130
  v_xor_b32 v131, 0x30000, v131
  ds_read_b128 a[240:243], v130 offset:32768
  ds_read_b128 a[244:247], v131 offset:32768
  ds_read_b128 a[248:251], v130 offset:34816
  ds_read_b128 a[252:255], v131 offset:34816
  s_waitcnt lgkmcnt(15)
  s_waitcnt vmcnt(8) lgkmcnt(4)
  s_barrier
  s_waitcnt lgkmcnt(3)
  v_mfma_f32_16x16x32_bf16 v[12:15], v[140:143], a[240:243], v[12:15]
  ds_read_b64_tr_b16 v[100:101], v8 offset:32768
  ds_read_b64_tr_b16 v[102:103], v9 offset:32768
  s_waitcnt lgkmcnt(3)
  v_mfma_f32_16x16x32_bf16 v[44:47], v[140:143], a[248:251], v[44:47]
  ds_read_b64_tr_b16 v[104:105], v8 offset:34816
  ds_read_b64_tr_b16 v[106:107], v9 offset:34816
  v_mfma_f32_16x16x32_bf16 v[48:51], v[144:147], a[248:251], v[48:51]
  ds_read_b64_tr_b16 v[108:109], v8 offset:36864
  ds_read_b64_tr_b16 v[110:111], v9 offset:36864
  v_mfma_f32_16x16x32_bf16 v[16:19], v[144:147], a[240:243], v[16:19]
  ds_read_b64_tr_b16 v[112:113], v8 offset:38912
  ds_read_b64_tr_b16 v[114:115], v9 offset:38912
  v_mfma_f32_16x16x32_bf16 v[20:23], v[148:151], a[240:243], v[20:23]
  ds_read_b64_tr_b16 v[116:117], v8 offset:33024
  ds_read_b64_tr_b16 v[118:119], v9 offset:33024
  v_mfma_f32_16x16x32_bf16 v[52:55], v[148:151], a[248:251], v[52:55]
  ds_read_b64_tr_b16 v[120:121], v8 offset:35072
  ds_read_b64_tr_b16 v[122:123], v9 offset:35072
  v_mfma_f32_16x16x32_bf16 v[56:59], v[152:155], a[248:251], v[56:59]
  ds_read_b64_tr_b16 v[132:133], v8 offset:37120
  ds_read_b64_tr_b16 v[134:135], v9 offset:37120
  v_mfma_f32_16x16x32_bf16 v[40:43], v[152:155], a[240:243], v[40:43]
  ds_read_b64_tr_b16 v[136:137], v8 offset:39168
  ds_read_b64_tr_b16 v[138:139], v9 offset:39168
  v_mfma_f32_16x16x32_bf16 v[12:15], v[156:159], a[244:247], v[12:15]
  s_add_u32 m0, s6, 81920
  s_nop 0
  buffer_load_dwordx4 v65, s[12:15], s29 offen offset:0 sc1 lds
  s_waitcnt lgkmcnt(15)
  v_mfma_f32_16x16x32_bf16 v[44:47], v[156:159], a[252:255], v[44:47]
  v_mfma_f32_16x16x32_bf16 v[48:51], v[160:163], a[252:255], v[48:51]
  buffer_load_dwordx4 v65, s[12:15], s29 offen offset:1024 sc1 lds
  v_mfma_f32_16x16x32_bf16 v[16:19], v[160:163], a[244:247], v[16:19]
  v_mfma_f32_16x16x32_bf16 v[20:23], v[164:167], a[244:247], v[20:23]
  buffer_load_dwordx4 v65, s[12:15], s29 offen offset:2048 sc1 lds
  v_mfma_f32_16x16x32_bf16 v[52:55], v[164:167], a[252:255], v[52:55]
  v_mfma_f32_16x16x32_bf16 v[56:59], v[168:171], a[252:255], v[56:59]
  buffer_load_dwordx4 v65, s[12:15], s29 offen offset:3072 sc1 lds
  s_add_u32 s29, s29, 65536
  s_and_b32 s29, s29, 0x3ffff
  v_xor_b32 v65, 4096, v65
  v_mfma_f32_16x16x32_bf16 v[40:43], v[168:171], a[244:247], v[40:43]
  buffer_load_dwordx4 v[228:231], v66, s[80:83], s8 offen offset:0 sc1
  buffer_load_dwordx4 v[232:235], v66, s[80:83], s8 offen offset:256 sc1
  buffer_load_dwordx4 v[236:239], v66, s[80:83], s8 offen offset:512 sc1
  buffer_load_dwordx4 v[240:243], v66, s[80:83], s8 offen offset:768 sc1
  ds_read_b64_tr_b16 v[124:125], v6 offset:0
  ds_read_b64_tr_b16 v[126:127], v6 offset:256
  ds_read_b64_tr_b16 v[128:129], v6 offset:1024
  ds_read_b64_tr_b16 v[130:131], v6 offset:1280
  ds_read_b64_tr_b16 v[188:189], v6 offset:2048
  ds_read_b64_tr_b16 v[190:191], v6 offset:2304
  ds_read_b64_tr_b16 v[192:193], v6 offset:3072
  ds_read_b64_tr_b16 v[194:195], v6 offset:3328
  s_waitcnt lgkmcnt(8)
  v_mfma_f32_16x16x32_bf16 v[68:71], v[100:103], a[0:3], v[68:71]
  ds_read_b64_tr_b16 v[140:141], v8 offset:40960
  ds_read_b64_tr_b16 v[142:143], v9 offset:40960
  v_mfma_f32_16x16x32_bf16 v[84:87], v[100:103], a[8:11], 0
  ds_read_b64_tr_b16 v[144:145], v8 offset:43008
  ds_read_b64_tr_b16 v[146:147], v9 offset:43008
  v_mfma_f32_16x16x32_bf16 v[88:91], v[104:107], a[8:11], 0
  ds_read_b64_tr_b16 v[148:149], v8 offset:45056
  ds_read_b64_tr_b16 v[150:151], v9 offset:45056
  v_mfma_f32_16x16x32_bf16 v[72:75], v[104:107], a[0:3], v[72:75]
  ds_read_b64_tr_b16 v[152:153], v8 offset:47104
  ds_read_b64_tr_b16 v[154:155], v9 offset:47104
  v_mfma_f32_16x16x32_bf16 v[68:71], v[108:111], a[16:19], v[68:71]
  ds_read_b64_tr_b16 v[156:157], v8 offset:41216
  ds_read_b64_tr_b16 v[158:159], v9 offset:41216
  v_mfma_f32_16x16x32_bf16 v[84:87], v[108:111], a[24:27], v[84:87]
  ds_read_b64_tr_b16 v[160:161], v8 offset:43264
  ds_read_b64_tr_b16 v[162:163], v9 offset:43264
  v_mfma_f32_16x16x32_bf16 v[88:91], v[112:115], a[24:27], v[88:91]
  ds_read_b64_tr_b16 v[164:165], v8 offset:45312
  ds_read_b64_tr_b16 v[166:167], v9 offset:45312
  v_mfma_f32_16x16x32_bf16 v[72:75], v[112:115], a[16:19], v[72:75]
  ds_read_b64_tr_b16 v[168:169], v8 offset:47360
  ds_read_b64_tr_b16 v[170:171], v9 offset:47360
  v_mfma_f32_16x16x32_bf16 v[68:71], v[116:119], a[4:7], v[68:71]
  s_add_u32 m0, s6, 0
  s_nop 0
  buffer_load_dwordx4 v65, s[12:15], s29 offen offset:0 sc1 lds
  s_waitcnt lgkmcnt(15)
  v_mfma_f32_16x16x32_bf16 v[196:199], v[24:27], v[124:127], 0
  s_waitcnt lgkmcnt(15)
  v_mfma_f32_16x16x32_bf16 v[212:215], v[24:27], v[188:191], 0
  v_mfma_f32_16x16x32_bf16 v[84:87], v[116:119], a[12:15], v[84:87]
  v_mfma_f32_16x16x32_bf16 v[200:203], v[32:35], v[124:127], 0
  v_mfma_f32_16x16x32_bf16 v[216:219], v[32:35], v[188:191], 0
  v_mfma_f32_16x16x32_bf16 v[88:91], v[120:123], a[12:15], v[88:91]
  buffer_load_dwordx4 v65, s[12:15], s29 offen offset:1024 sc1 lds
  v_mfma_f32_16x16x32_bf16 v[204:207], v[172:175], v[124:127], 0
  v_mfma_f32_16x16x32_bf16 v[220:223], v[172:175], v[188:191], 0
  v_mfma_f32_16x16x32_bf16 v[72:75], v[120:123], a[4:7], v[72:75]
  v_mfma_f32_16x16x32_bf16 v[208:211], v[180:183], v[124:127], 0
  v_mfma_f32_16x16x32_bf16 v[224:227], v[180:183], v[188:191], 0
  v_mfma_f32_16x16x32_bf16 v[68:71], v[132:135], a[20:23], v[68:71]
  buffer_load_dwordx4 v65, s[12:15], s29 offen offset:2048 sc1 lds
  v_mfma_f32_16x16x32_bf16 v[196:199], v[28:31], v[128:131], v[196:199]
  s_waitcnt lgkmcnt(15)
  v_mfma_f32_16x16x32_bf16 v[212:215], v[28:31], v[192:195], v[212:215]
  v_mfma_f32_16x16x32_bf16 v[84:87], v[132:135], a[28:31], v[84:87]
  v_mfma_f32_16x16x32_bf16 v[200:203], v[60:63], v[128:131], v[200:203]
  v_mfma_f32_16x16x32_bf16 v[216:219], v[60:63], v[192:195], v[216:219]
  v_mfma_f32_16x16x32_bf16 v[88:91], v[136:139], a[28:31], v[88:91]
  buffer_load_dwordx4 v65, s[12:15], s29 offen offset:3072 sc1 lds
  s_add_u32 s29, s29, 65536
  s_and_b32 s29, s29, 0x3ffff
  v_mfma_f32_16x16x32_bf16 v[204:207], v[176:179], v[128:131], v[204:207]
  v_mfma_f32_16x16x32_bf16 v[220:223], v[176:179], v[192:195], v[220:223]
  v_mfma_f32_16x16x32_bf16 v[72:75], v[136:139], a[20:23], v[72:75]
  v_mfma_f32_16x16x32_bf16 v[208:211], v[184:187], v[128:131], v[208:211]
  v_mfma_f32_16x16x32_bf16 v[224:227], v[184:187], v[192:195], v[224:227]
  s_waitcnt vmcnt(12) lgkmcnt(0)
  s_barrier
  v_mfma_f32_16x16x32_bf16 v[68:71], v[140:143], a[32:35], v[68:71]
  ds_read_b64_tr_b16 v[100:101], v8 offset:49152
  ds_read_b64_tr_b16 v[102:103], v9 offset:49152
  v_mfma_f32_16x16x32_bf16 v[84:87], v[140:143], a[40:43], v[84:87]
  ds_read_b64_tr_b16 v[104:105], v8 offset:51200
  ds_read_b64_tr_b16 v[106:107], v9 offset:51200
  v_mfma_f32_16x16x32_bf16 v[88:91], v[144:147], a[40:43], v[88:91]
  ds_read_b64_tr_b16 v[108:109], v8 offset:53248
  ds_read_b64_tr_b16 v[110:111], v9 offset:53248
  v_mfma_f32_16x16x32_bf16 v[72:75], v[144:147], a[32:35], v[72:75]
  ds_read_b64_tr_b16 v[112:113], v8 offset:55296
  ds_read_b64_tr_b16 v[114:115], v9 offset:55296
  v_mfma_f32_16x16x32_bf16 v[68:71], v[148:151], a[48:51], v[68:71]
  ds_read_b64_tr_b16 v[116:117], v8 offset:49408
  ds_read_b64_tr_b16 v[118:119], v9 offset:49408
  v_mfma_f32_16x16x32_bf16 v[84:87], v[148:151], a[56:59], v[84:87]
  ds_read_b64_tr_b16 v[120:121], v8 offset:51456
  ds_read_b64_tr_b16 v[122:123], v9 offset:51456
  v_mfma_f32_16x16x32_bf16 v[88:91], v[152:155], a[56:59], v[88:91]
  ds_read_b64_tr_b16 v[132:133], v8 offset:53504
  ds_read_b64_tr_b16 v[134:135], v9 offset:53504
  v_mfma_f32_16x16x32_bf16 v[72:75], v[152:155], a[48:51], v[72:75]
  ds_read_b64_tr_b16 v[136:137], v8 offset:55552
  ds_read_b64_tr_b16 v[138:139], v9 offset:55552
  v_mfma_f32_16x16x32_bf16 v[68:71], v[156:159], a[36:39], v[68:71]
  s_add_u32 m0, s6, 16384
  s_nop 0
  buffer_load_dwordx4 v65, s[12:15], s29 offen offset:0 sc1 lds
  v_xor_b32 v25, 0x80008000, v25
  v_xor_b32 v27, 0x80008000, v27
  v_xor_b32 v29, 0x80008000, v29
  v_xor_b32 v31, 0x80008000, v31
  v_xor_b32 v33, 0x80008000, v33
  v_xor_b32 v35, 0x80008000, v35
  v_mfma_f32_16x16x32_bf16 v[84:87], v[156:159], a[44:47], v[84:87]
  v_xor_b32 v61, 0x80008000, v61
  v_xor_b32 v63, 0x80008000, v63
  v_xor_b32 v173, 0x80008000, v173
  v_xor_b32 v175, 0x80008000, v175
  v_xor_b32 v177, 0x80008000, v177
  v_xor_b32 v179, 0x80008000, v179
  v_mfma_f32_16x16x32_bf16 v[88:91], v[160:163], a[44:47], v[88:91]
  buffer_load_dwordx4 v65, s[12:15], s29 offen offset:1024 sc1 lds
  v_xor_b32 v181, 0x80008000, v181
  v_xor_b32 v183, 0x80008000, v183
  v_xor_b32 v185, 0x80008000, v185
  v_xor_b32 v187, 0x80008000, v187
  v_pk_add_f32 v[196:197], v[196:197], v[12:13] neg_lo:[0,1] neg_hi:[0,1]
  v_pk_add_f32 v[198:199], v[198:199], v[14:15] neg_lo:[0,1] neg_hi:[0,1]
  v_mfma_f32_16x16x32_bf16 v[72:75], v[160:163], a[36:39], v[72:75]
  s_waitcnt vmcnt(9)
  v_pk_fma_f32 v[12:13], v[228:229], v[196:197], v[12:13]
  v_pk_fma_f32 v[14:15], v[230:231], v[198:199], v[14:15]
  v_perm_b32 v12, v13, v12, s58
  v_perm_b32 v13, v15, v14, s58
  v_or_b32 v12, 0x10001, v12
  v_or_b32 v13, 0x10001, v13
  v_mfma_f32_16x16x32_bf16 v[68:71], v[164:167], a[52:55], v[68:71]
  buffer_load_dwordx4 v65, s[12:15], s29 offen offset:2048 sc1 lds
  v_pk_add_f32 v[200:201], v[200:201], v[16:17] neg_lo:[0,1] neg_hi:[0,1]
  v_pk_add_f32 v[202:203], v[202:203], v[18:19] neg_lo:[0,1] neg_hi:[0,1]
  s_waitcnt vmcnt(9)
  v_pk_fma_f32 v[16:17], v[232:233], v[200:201], v[16:17]
  v_pk_fma_f32 v[18:19], v[234:235], v[202:203], v[18:19]
  v_perm_b32 v14, v17, v16, s58
  v_perm_b32 v15, v19, v18, s58
  v_mfma_f32_16x16x32_bf16 v[84:87], v[164:167], a[60:63], v[84:87]
  v_or_b32 v14, 0x10001, v14
  v_or_b32 v15, 0x10001, v15
  buffer_store_dwordx4 v[12:15], v64, s[44:47], s9 offen offset:0 sc1
  v_pk_add_f32 v[204:205], v[204:205], v[20:21] neg_lo:[0,1] neg_hi:[0,1]
  v_pk_add_f32 v[206:207], v[206:207], v[22:23] neg_lo:[0,1] neg_hi:[0,1]
  s_waitcnt vmcnt(9)
  v_pk_fma_f32 v[20:21], v[236:237], v[204:205], v[20:21]
  v_mfma_f32_16x16x32_bf16 v[88:91], v[168:171], a[60:63], v[88:91]
  buffer_load_dwordx4 v65, s[12:15], s29 offen offset:3072 sc1 lds
  s_add_u32 s29, s29, 65536
  s_and_b32 s29, s29, 0x3ffff
  v_pk_fma_f32 v[22:23], v[238:239], v[206:207], v[22:23]
  v_perm_b32 v16, v21, v20, s58
  v_perm_b32 v17, v23, v22, s58
  v_or_b32 v16, 0x10001, v16
  v_or_b32 v17, 0x10001, v17
  v_pk_add_f32 v[208:209], v[208:209], v[40:41] neg_lo:[0,1] neg_hi:[0,1]
  v_mfma_f32_16x16x32_bf16 v[72:75], v[168:171], a[52:55], v[72:75]
  v_pk_add_f32 v[210:211], v[210:211], v[42:43] neg_lo:[0,1] neg_hi:[0,1]
  s_waitcnt vmcnt(9)
  v_pk_fma_f32 v[40:41], v[240:241], v[208:209], v[40:41]
  v_pk_fma_f32 v[42:43], v[242:243], v[210:211], v[42:43]
  v_perm_b32 v18, v41, v40, s58
  v_perm_b32 v19, v43, v42, s58
  v_or_b32 v18, 0x10001, v18
  s_waitcnt lgkmcnt(0)
  v_mfma_f32_16x16x32_bf16 v[68:71], v[100:103], a[64:67], v[68:71]
  ds_read_b64_tr_b16 v[140:141], v8 offset:57344
  ds_read_b64_tr_b16 v[142:143], v9 offset:57344
  v_mfma_f32_16x16x32_bf16 v[84:87], v[100:103], a[72:75], v[84:87]
  ds_read_b64_tr_b16 v[144:145], v8 offset:59392
  ds_read_b64_tr_b16 v[146:147], v9 offset:59392
  v_mfma_f32_16x16x32_bf16 v[88:91], v[104:107], a[72:75], v[88:91]
  ds_read_b64_tr_b16 v[148:149], v8 offset:61440
  ds_read_b64_tr_b16 v[150:151], v9 offset:61440
  v_mfma_f32_16x16x32_bf16 v[72:75], v[104:107], a[64:67], v[72:75]
  ds_read_b64_tr_b16 v[152:153], v8 offset:63488
  ds_read_b64_tr_b16 v[154:155], v9 offset:63488
  v_mfma_f32_16x16x32_bf16 v[68:71], v[108:111], a[80:83], v[68:71]
  ds_read_b64_tr_b16 v[156:157], v8 offset:57600
  ds_read_b64_tr_b16 v[158:159], v9 offset:57600
  v_mfma_f32_16x16x32_bf16 v[84:87], v[108:111], a[88:91], v[84:87]
  ds_read_b64_tr_b16 v[160:161], v8 offset:59648
  ds_read_b64_tr_b16 v[162:163], v9 offset:59648
  v_mfma_f32_16x16x32_bf16 v[88:91], v[112:115], a[88:91], v[88:91]
  ds_read_b64_tr_b16 v[164:165], v8 offset:61696
  ds_read_b64_tr_b16 v[166:167], v9 offset:61696
  v_mfma_f32_16x16x32_bf16 v[72:75], v[112:115], a[80:83], v[72:75]
  ds_read_b64_tr_b16 v[168:169], v8 offset:63744
  ds_read_b64_tr_b16 v[170:171], v9 offset:63744
  v_mfma_f32_16x16x32_bf16 v[68:71], v[116:119], a[68:71], v[68:71]
  s_add_u32 m0, s6, 32768
  s_nop 0
  buffer_load_dwordx4 v65, s[12:15], s29 offen offset:0 sc1 lds
  v_or_b32 v19, 0x10001, v19
  buffer_store_dwordx4 v[16:19], v64, s[44:47], s9 offen offset:1024 sc1
  v_pk_add_f32 v[212:213], v[212:213], v[44:45] neg_lo:[0,1] neg_hi:[0,1]
  v_pk_add_f32 v[214:215], v[214:215], v[46:47] neg_lo:[0,1] neg_hi:[0,1]
  v_pk_fma_f32 v[44:45], v[228:229], v[212:213], v[44:45]
  v_pk_fma_f32 v[46:47], v[230:231], v[214:215], v[46:47]
  v_mfma_f32_16x16x32_bf16 v[84:87], v[116:119], a[76:79], v[84:87]
  v_perm_b32 v20, v45, v44, s58
  v_perm_b32 v21, v47, v46, s58
  v_or_b32 v20, 0x10001, v20
  v_or_b32 v21, 0x10001, v21
  v_pk_add_f32 v[216:217], v[216:217], v[48:49] neg_lo:[0,1] neg_hi:[0,1]
  v_pk_add_f32 v[218:219], v[218:219], v[50:51] neg_lo:[0,1] neg_hi:[0,1]
  v_mfma_f32_16x16x32_bf16 v[88:91], v[120:123], a[76:79], v[88:91]
  buffer_load_dwordx4 v65, s[12:15], s29 offen offset:1024 sc1 lds
  v_pk_fma_f32 v[48:49], v[232:233], v[216:217], v[48:49]
  v_pk_fma_f32 v[50:51], v[234:235], v[218:219], v[50:51]
  v_perm_b32 v22, v49, v48, s58
  v_perm_b32 v23, v51, v50, s58
  v_or_b32 v22, 0x10001, v22
  v_or_b32 v23, 0x10001, v23
  v_mfma_f32_16x16x32_bf16 v[72:75], v[120:123], a[68:71], v[72:75]
  buffer_store_dwordx4 v[20:23], v64, s[44:47], s9 offen offset:2048 sc1
  v_pk_add_f32 v[220:221], v[220:221], v[52:53] neg_lo:[0,1] neg_hi:[0,1]
  v_pk_add_f32 v[222:223], v[222:223], v[54:55] neg_lo:[0,1] neg_hi:[0,1]
  v_pk_fma_f32 v[52:53], v[236:237], v[220:221], v[52:53]
  v_pk_fma_f32 v[54:55], v[238:239], v[222:223], v[54:55]
  v_perm_b32 v40, v53, v52, s58
  v_mfma_f32_16x16x32_bf16 v[68:71], v[132:135], a[84:87], v[68:71]
  buffer_load_dwordx4 v65, s[12:15], s29 offen offset:2048 sc1 lds
  v_perm_b32 v41, v55, v54, s58
  v_or_b32 v40, 0x10001, v40
  v_or_b32 v41, 0x10001, v41
  v_pk_add_f32 v[224:225], v[224:225], v[56:57] neg_lo:[0,1] neg_hi:[0,1]
  v_pk_add_f32 v[226:227], v[226:227], v[58:59] neg_lo:[0,1] neg_hi:[0,1]
  v_pk_fma_f32 v[56:57], v[240:241], v[224:225], v[56:57]
  v_mfma_f32_16x16x32_bf16 v[84:87], v[132:135], a[92:95], v[84:87]
  v_pk_fma_f32 v[58:59], v[242:243], v[226:227], v[58:59]
  v_perm_b32 v42, v57, v56, s58
  v_perm_b32 v43, v59, v58, s58
  v_or_b32 v42, 0x10001, v42
  v_or_b32 v43, 0x10001, v43
  buffer_store_dwordx4 v[40:43], v64, s[44:47], s9 offen offset:3072 sc1
  v_mfma_f32_16x16x32_bf16 v[88:91], v[136:139], a[92:95], v[88:91]
  buffer_load_dwordx4 v65, s[12:15], s29 offen offset:3072 sc1 lds
  s_add_u32 s29, s29, 65536
  s_and_b32 s29, s29, 0x3ffff
  s_xor_b32 s8, s8, 1024
  s_xor_b32 s9, s9, 131072
  v_mfma_f32_16x16x32_bf16 v[72:75], v[136:139], a[84:87], v[72:75]
  s_waitcnt lgkmcnt(0)
  v_mfma_f32_16x16x32_bf16 v[68:71], v[140:143], a[96:99], v[68:71]
  ds_read_b64_tr_b16 v[100:101], v10 offset:0
  ds_read_b64_tr_b16 v[102:103], v11 offset:0
  v_mfma_f32_16x16x32_bf16 v[84:87], v[140:143], a[104:107], v[84:87]
  ds_read_b64_tr_b16 v[104:105], v10 offset:2048
  ds_read_b64_tr_b16 v[106:107], v11 offset:2048
  v_mfma_f32_16x16x32_bf16 v[88:91], v[144:147], a[104:107], v[88:91]
  ds_read_b64_tr_b16 v[108:109], v10 offset:4096
  ds_read_b64_tr_b16 v[110:111], v11 offset:4096
  v_mfma_f32_16x16x32_bf16 v[72:75], v[144:147], a[96:99], v[72:75]
  ds_read_b64_tr_b16 v[112:113], v10 offset:6144
  ds_read_b64_tr_b16 v[114:115], v11 offset:6144
  v_mfma_f32_16x16x32_bf16 v[68:71], v[148:151], a[112:115], v[68:71]
  ds_read_b64_tr_b16 v[116:117], v10 offset:256
  ds_read_b64_tr_b16 v[118:119], v11 offset:256
  v_mfma_f32_16x16x32_bf16 v[84:87], v[148:151], a[120:123], v[84:87]
  ds_read_b64_tr_b16 v[120:121], v10 offset:2304
  ds_read_b64_tr_b16 v[122:123], v11 offset:2304
  v_mfma_f32_16x16x32_bf16 v[88:91], v[152:155], a[120:123], v[88:91]
  ds_read_b64_tr_b16 v[132:133], v10 offset:4352
  ds_read_b64_tr_b16 v[134:135], v11 offset:4352
  v_mfma_f32_16x16x32_bf16 v[72:75], v[152:155], a[112:115], v[72:75]
  ds_read_b64_tr_b16 v[136:137], v10 offset:6400
  ds_read_b64_tr_b16 v[138:139], v11 offset:6400
  v_mfma_f32_16x16x32_bf16 v[68:71], v[156:159], a[100:103], v[68:71]
  v_mfma_f32_16x16x32_bf16 v[84:87], v[156:159], a[108:111], v[84:87]
  v_mfma_f32_16x16x32_bf16 v[88:91], v[160:163], a[108:111], v[88:91]
  v_mfma_f32_16x16x32_bf16 v[72:75], v[160:163], a[100:103], v[72:75]
  v_mfma_f32_16x16x32_bf16 v[68:71], v[164:167], a[116:119], v[68:71]
  v_mfma_f32_16x16x32_bf16 v[84:87], v[164:167], a[124:127], v[84:87]
  v_mfma_f32_16x16x32_bf16 v[88:91], v[168:171], a[124:127], v[88:91]
  v_mfma_f32_16x16x32_bf16 v[72:75], v[168:171], a[116:119], v[72:75]
  s_waitcnt lgkmcnt(0)
  v_mfma_f32_16x16x32_bf16 v[68:71], v[100:103], a[128:131], v[68:71]
  ds_read_b64_tr_b16 v[140:141], v10 offset:8192
  ds_read_b64_tr_b16 v[142:143], v11 offset:8192
  v_mfma_f32_16x16x32_bf16 v[84:87], v[100:103], a[136:139], v[84:87]
  ds_read_b64_tr_b16 v[144:145], v10 offset:10240
  ds_read_b64_tr_b16 v[146:147], v11 offset:10240
  v_mfma_f32_16x16x32_bf16 v[88:91], v[104:107], a[136:139], v[88:91]
  ds_read_b64_tr_b16 v[148:149], v10 offset:12288
  ds_read_b64_tr_b16 v[150:151], v11 offset:12288
  v_mfma_f32_16x16x32_bf16 v[72:75], v[104:107], a[128:131], v[72:75]
  ds_read_b64_tr_b16 v[152:153], v10 offset:14336
  ds_read_b64_tr_b16 v[154:155], v11 offset:14336
  v_mfma_f32_16x16x32_bf16 v[68:71], v[108:111], a[144:147], v[68:71]
  ds_read_b64_tr_b16 v[156:157], v10 offset:8448
  ds_read_b64_tr_b16 v[158:159], v11 offset:8448
  v_mfma_f32_16x16x32_bf16 v[84:87], v[108:111], a[152:155], v[84:87]
  ds_read_b64_tr_b16 v[160:161], v10 offset:10496
  ds_read_b64_tr_b16 v[162:163], v11 offset:10496
  v_mfma_f32_16x16x32_bf16 v[88:91], v[112:115], a[152:155], v[88:91]
  ds_read_b64_tr_b16 v[164:165], v10 offset:12544
  ds_read_b64_tr_b16 v[166:167], v11 offset:12544
  v_mfma_f32_16x16x32_bf16 v[72:75], v[112:115], a[144:147], v[72:75]
  ds_read_b64_tr_b16 v[168:169], v10 offset:14592
  ds_read_b64_tr_b16 v[170:171], v11 offset:14592
  v_mfma_f32_16x16x32_bf16 v[68:71], v[116:119], a[132:135], v[68:71]
  v_mfma_f32_16x16x32_bf16 v[196:199], v[24:27], v[124:127], 0
  v_mfma_f32_16x16x32_bf16 v[212:215], v[24:27], v[188:191], 0
  v_mfma_f32_16x16x32_bf16 v[84:87], v[116:119], a[140:143], v[84:87]
  v_mfma_f32_16x16x32_bf16 v[200:203], v[32:35], v[124:127], 0
  v_mfma_f32_16x16x32_bf16 v[216:219], v[32:35], v[188:191], 0
  v_mfma_f32_16x16x32_bf16 v[88:91], v[120:123], a[140:143], v[88:91]
  v_mfma_f32_16x16x32_bf16 v[204:207], v[172:175], v[124:127], 0
  v_mfma_f32_16x16x32_bf16 v[220:223], v[172:175], v[188:191], 0
  v_mfma_f32_16x16x32_bf16 v[72:75], v[120:123], a[132:135], v[72:75]
  v_mfma_f32_16x16x32_bf16 v[208:211], v[180:183], v[124:127], 0
  v_mfma_f32_16x16x32_bf16 v[224:227], v[180:183], v[188:191], 0
  v_mfma_f32_16x16x32_bf16 v[68:71], v[132:135], a[148:151], v[68:71]
  v_mfma_f32_16x16x32_bf16 v[196:199], v[28:31], v[128:131], v[196:199]
  v_mfma_f32_16x16x32_bf16 v[212:215], v[28:31], v[192:195], v[212:215]
  v_mfma_f32_16x16x32_bf16 v[84:87], v[132:135], a[156:159], v[84:87]
  v_mfma_f32_16x16x32_bf16 v[200:203], v[60:63], v[128:131], v[200:203]
  v_mfma_f32_16x16x32_bf16 v[216:219], v[60:63], v[192:195], v[216:219]
  v_mfma_f32_16x16x32_bf16 v[88:91], v[136:139], a[156:159], v[88:91]
  v_mfma_f32_16x16x32_bf16 v[204:207], v[176:179], v[128:131], v[204:207]
  v_mfma_f32_16x16x32_bf16 v[220:223], v[176:179], v[192:195], v[220:223]
  v_mfma_f32_16x16x32_bf16 v[72:75], v[136:139], a[148:151], v[72:75]
  v_mfma_f32_16x16x32_bf16 v[208:211], v[184:187], v[128:131], v[208:211]
  v_mfma_f32_16x16x32_bf16 v[224:227], v[184:187], v[192:195], v[224:227]
  s_waitcnt vmcnt(12) lgkmcnt(0)
  s_barrier
  v_mfma_f32_16x16x32_bf16 v[68:71], v[140:143], a[160:163], v[68:71]
  ds_read_b64_tr_b16 v[100:101], v10 offset:16384
  ds_read_b64_tr_b16 v[102:103], v11 offset:16384
  v_mfma_f32_16x16x32_bf16 v[84:87], v[140:143], a[168:171], v[84:87]
  ds_read_b64_tr_b16 v[104:105], v10 offset:18432
  ds_read_b64_tr_b16 v[106:107], v11 offset:18432
  v_mfma_f32_16x16x32_bf16 v[88:91], v[144:147], a[168:171], v[88:91]
  ds_read_b64_tr_b16 v[108:109], v10 offset:20480
  ds_read_b64_tr_b16 v[110:111], v11 offset:20480
  v_mfma_f32_16x16x32_bf16 v[72:75], v[144:147], a[160:163], v[72:75]
  ds_read_b64_tr_b16 v[112:113], v10 offset:22528
  ds_read_b64_tr_b16 v[114:115], v11 offset:22528
  v_mfma_f32_16x16x32_bf16 v[68:71], v[148:151], a[176:179], v[68:71]
  ds_read_b64_tr_b16 v[116:117], v10 offset:16640
  ds_read_b64_tr_b16 v[118:119], v11 offset:16640
  v_mfma_f32_16x16x32_bf16 v[84:87], v[148:151], a[184:187], v[84:87]
  ds_read_b64_tr_b16 v[120:121], v10 offset:18688
  ds_read_b64_tr_b16 v[122:123], v11 offset:18688
  v_mfma_f32_16x16x32_bf16 v[88:91], v[152:155], a[184:187], v[88:91]
  ds_read_b64_tr_b16 v[132:133], v10 offset:20736
  ds_read_b64_tr_b16 v[134:135], v11 offset:20736
  v_mfma_f32_16x16x32_bf16 v[72:75], v[152:155], a[176:179], v[72:75]
  ds_read_b64_tr_b16 v[136:137], v10 offset:22784
  ds_read_b64_tr_b16 v[138:139], v11 offset:22784
  v_mfma_f32_16x16x32_bf16 v[68:71], v[156:159], a[164:167], v[68:71]
  s_add_u32 m0, s6, 49152
  s_nop 0
  buffer_load_dwordx4 v65, s[12:15], s29 offen offset:0 sc1 lds
  v_mfma_f32_16x16x32_bf16 v[84:87], v[156:159], a[172:175], v[84:87]
  v_mfma_f32_16x16x32_bf16 v[88:91], v[160:163], a[172:175], v[88:91]
  buffer_load_dwordx4 v65, s[12:15], s29 offen offset:1024 sc1 lds
  v_mfma_f32_16x16x32_bf16 v[72:75], v[160:163], a[164:167], v[72:75]
  v_mfma_f32_16x16x32_bf16 v[68:71], v[164:167], a[180:183], v[68:71]
  buffer_load_dwordx4 v65, s[12:15], s29 offen offset:2048 sc1 lds
  v_mfma_f32_16x16x32_bf16 v[84:87], v[164:167], a[188:191], v[84:87]
  v_mfma_f32_16x16x32_bf16 v[88:91], v[168:171], a[188:191], v[88:91]
  buffer_load_dwordx4 v65, s[12:15], s29 offen offset:3072 sc1 lds
  s_add_u32 s29, s29, 65536
  s_and_b32 s29, s29, 0x3ffff
  v_mfma_f32_16x16x32_bf16 v[72:75], v[168:171], a[180:183], v[72:75]
  s_waitcnt lgkmcnt(0)
  v_mfma_f32_16x16x32_bf16 v[68:71], v[100:103], a[192:195], v[68:71]
  ds_read_b64_tr_b16 v[140:141], v10 offset:24576
  ds_read_b64_tr_b16 v[142:143], v11 offset:24576
  v_mfma_f32_16x16x32_bf16 v[84:87], v[100:103], a[200:203], v[84:87]
  ds_read_b64_tr_b16 v[144:145], v10 offset:26624
  ds_read_b64_tr_b16 v[146:147], v11 offset:26624
  v_mfma_f32_16x16x32_bf16 v[88:91], v[104:107], a[200:203], v[88:91]
  ds_read_b64_tr_b16 v[148:149], v10 offset:28672
  ds_read_b64_tr_b16 v[150:151], v11 offset:28672
  v_mfma_f32_16x16x32_bf16 v[72:75], v[104:107], a[192:195], v[72:75]
  ds_read_b64_tr_b16 v[152:153], v10 offset:30720
  ds_read_b64_tr_b16 v[154:155], v11 offset:30720
  v_mfma_f32_16x16x32_bf16 v[68:71], v[108:111], a[208:211], v[68:71]
  ds_read_b64_tr_b16 v[156:157], v10 offset:24832
  ds_read_b64_tr_b16 v[158:159], v11 offset:24832
  v_mfma_f32_16x16x32_bf16 v[84:87], v[108:111], a[216:219], v[84:87]
  ds_read_b64_tr_b16 v[160:161], v10 offset:26880
  ds_read_b64_tr_b16 v[162:163], v11 offset:26880
  v_mfma_f32_16x16x32_bf16 v[88:91], v[112:115], a[216:219], v[88:91]
  ds_read_b64_tr_b16 v[164:165], v10 offset:28928
  ds_read_b64_tr_b16 v[166:167], v11 offset:28928
  v_mfma_f32_16x16x32_bf16 v[72:75], v[112:115], a[208:211], v[72:75]
  ds_read_b64_tr_b16 v[168:169], v10 offset:30976
  ds_read_b64_tr_b16 v[170:171], v11 offset:30976
  v_mfma_f32_16x16x32_bf16 v[68:71], v[116:119], a[196:199], v[68:71]
  v_mfma_f32_16x16x32_bf16 v[84:87], v[116:119], a[204:207], v[84:87]
  v_mfma_f32_16x16x32_bf16 v[88:91], v[120:123], a[204:207], v[88:91]
  v_mfma_f32_16x16x32_bf16 v[72:75], v[120:123], a[196:199], v[72:75]
  v_mfma_f32_16x16x32_bf16 v[68:71], v[132:135], a[212:215], v[68:71]
  v_mfma_f32_16x16x32_bf16 v[84:87], v[132:135], a[220:223], v[84:87]
  v_mfma_f32_16x16x32_bf16 v[88:91], v[136:139], a[220:223], v[88:91]
  v_mfma_f32_16x16x32_bf16 v[72:75], v[136:139], a[212:215], v[72:75]
  buffer_load_dwordx4 v[228:231], v66, s[80:83], s8 offen offset:0 sc1
  buffer_load_dwordx4 v[232:235], v66, s[80:83], s8 offen offset:256 sc1
  buffer_load_dwordx4 v[236:239], v66, s[80:83], s8 offen offset:512 sc1
  buffer_load_dwordx4 v[240:243], v66, s[80:83], s8 offen offset:768 sc1
  s_waitcnt lgkmcnt(0)
  v_mfma_f32_16x16x32_bf16 v[68:71], v[140:143], a[224:227], v[68:71]
  ds_read_b64_tr_b16 v[100:101], v8 offset:0
  ds_read_b64_tr_b16 v[102:103], v9 offset:0
  v_mfma_f32_16x16x32_bf16 v[84:87], v[140:143], a[232:235], v[84:87]
  ds_read_b64_tr_b16 v[104:105], v8 offset:2048
  ds_read_b64_tr_b16 v[106:107], v9 offset:2048
  v_mfma_f32_16x16x32_bf16 v[88:91], v[144:147], a[232:235], v[88:91]
  ds_read_b64_tr_b16 v[108:109], v8 offset:4096
  ds_read_b64_tr_b16 v[110:111], v9 offset:4096
  v_mfma_f32_16x16x32_bf16 v[72:75], v[144:147], a[224:227], v[72:75]
  ds_read_b64_tr_b16 v[112:113], v8 offset:6144
  ds_read_b64_tr_b16 v[114:115], v9 offset:6144
  v_mfma_f32_16x16x32_bf16 v[68:71], v[148:151], a[240:243], v[68:71]
  ds_read_b64_tr_b16 v[116:117], v8 offset:256
  ds_read_b64_tr_b16 v[118:119], v9 offset:256
  v_mfma_f32_16x16x32_bf16 v[84:87], v[148:151], a[248:251], v[84:87]
  ds_read_b64_tr_b16 v[120:121], v8 offset:2304
  ds_read_b64_tr_b16 v[122:123], v9 offset:2304
  v_mfma_f32_16x16x32_bf16 v[88:91], v[152:155], a[248:251], v[88:91]
  ds_read_b64_tr_b16 v[132:133], v8 offset:4352
  ds_read_b64_tr_b16 v[134:135], v9 offset:4352
  v_mfma_f32_16x16x32_bf16 v[72:75], v[152:155], a[240:243], v[72:75]
  ds_read_b64_tr_b16 v[136:137], v8 offset:6400
  ds_read_b64_tr_b16 v[138:139], v9 offset:6400
  v_mfma_f32_16x16x32_bf16 v[68:71], v[156:159], a[228:231], v[68:71]
  v_mfma_f32_16x16x32_bf16 v[84:87], v[156:159], a[236:239], v[84:87]
  buffer_load_dwordx4 v[20:23], v64, s[44:47], s9 offen offset:0 sc1
  v_mfma_f32_16x16x32_bf16 v[88:91], v[160:163], a[236:239], v[88:91]
  v_mfma_f32_16x16x32_bf16 v[72:75], v[160:163], a[228:231], v[72:75]
  buffer_load_dwordx4 v[40:43], v64, s[44:47], s9 offen offset:1024 sc1
  v_mfma_f32_16x16x32_bf16 v[68:71], v[164:167], a[244:247], v[68:71]
  v_mfma_f32_16x16x32_bf16 v[84:87], v[164:167], a[252:255], v[84:87]
  buffer_load_dwordx4 v[12:15], v64, s[44:47], s9 offen offset:2048 sc1
  v_mfma_f32_16x16x32_bf16 v[88:91], v[168:171], a[252:255], v[88:91]
  v_mfma_f32_16x16x32_bf16 v[72:75], v[168:171], a[244:247], v[72:75]
  buffer_load_dwordx4 v[16:19], v64, s[44:47], s9 offen offset:3072 sc1
  s_waitcnt lgkmcnt(0)
  v_mfma_f32_16x16x32_bf16 v[76:79], v[100:103], a[0:3], v[76:79]
  ds_read_b64_tr_b16 v[140:141], v8 offset:8192
  ds_read_b64_tr_b16 v[142:143], v9 offset:8192
  v_mfma_f32_16x16x32_bf16 v[92:95], v[100:103], a[8:11], 0
  ds_read_b64_tr_b16 v[144:145], v8 offset:10240
  ds_read_b64_tr_b16 v[146:147], v9 offset:10240
  v_mfma_f32_16x16x32_bf16 v[96:99], v[104:107], a[8:11], 0
  ds_read_b64_tr_b16 v[148:149], v8 offset:12288
  ds_read_b64_tr_b16 v[150:151], v9 offset:12288
  v_mfma_f32_16x16x32_bf16 v[80:83], v[104:107], a[0:3], v[80:83]
  ds_read_b64_tr_b16 v[152:153], v8 offset:14336
  ds_read_b64_tr_b16 v[154:155], v9 offset:14336
  v_mfma_f32_16x16x32_bf16 v[76:79], v[108:111], a[16:19], v[76:79]
  ds_read_b64_tr_b16 v[156:157], v8 offset:8448
  ds_read_b64_tr_b16 v[158:159], v9 offset:8448
  v_mfma_f32_16x16x32_bf16 v[92:95], v[108:111], a[24:27], v[92:95]
  ds_read_b64_tr_b16 v[160:161], v8 offset:10496
  ds_read_b64_tr_b16 v[162:163], v9 offset:10496
  v_mfma_f32_16x16x32_bf16 v[96:99], v[112:115], a[24:27], v[96:99]
  ds_read_b64_tr_b16 v[164:165], v8 offset:12544
  ds_read_b64_tr_b16 v[166:167], v9 offset:12544
  v_mfma_f32_16x16x32_bf16 v[80:83], v[112:115], a[16:19], v[80:83]
  ds_read_b64_tr_b16 v[168:169], v8 offset:14592
  ds_read_b64_tr_b16 v[170:171], v9 offset:14592
  v_mfma_f32_16x16x32_bf16 v[76:79], v[116:119], a[4:7], v[76:79]
  v_mfma_f32_16x16x32_bf16 v[92:95], v[116:119], a[12:15], v[92:95]
  v_mfma_f32_16x16x32_bf16 v[96:99], v[120:123], a[12:15], v[96:99]
  v_mfma_f32_16x16x32_bf16 v[80:83], v[120:123], a[4:7], v[80:83]
  v_mfma_f32_16x16x32_bf16 v[76:79], v[132:135], a[20:23], v[76:79]
  v_mfma_f32_16x16x32_bf16 v[92:95], v[132:135], a[28:31], v[92:95]
  v_mfma_f32_16x16x32_bf16 v[96:99], v[136:139], a[28:31], v[96:99]
  v_mfma_f32_16x16x32_bf16 v[80:83], v[136:139], a[20:23], v[80:83]
  s_waitcnt vmcnt(8) lgkmcnt(0)
  s_barrier
  v_mfma_f32_16x16x32_bf16 v[76:79], v[140:143], a[32:35], v[76:79]
  ds_read_b64_tr_b16 v[100:101], v8 offset:16384
  ds_read_b64_tr_b16 v[102:103], v9 offset:16384
  v_mfma_f32_16x16x32_bf16 v[92:95], v[140:143], a[40:43], v[92:95]
  ds_read_b64_tr_b16 v[104:105], v8 offset:18432
  ds_read_b64_tr_b16 v[106:107], v9 offset:18432
  v_mfma_f32_16x16x32_bf16 v[96:99], v[144:147], a[40:43], v[96:99]
  ds_read_b64_tr_b16 v[108:109], v8 offset:20480
  ds_read_b64_tr_b16 v[110:111], v9 offset:20480
  v_mfma_f32_16x16x32_bf16 v[80:83], v[144:147], a[32:35], v[80:83]
  ds_read_b64_tr_b16 v[112:113], v8 offset:22528
  ds_read_b64_tr_b16 v[114:115], v9 offset:22528
  v_mfma_f32_16x16x32_bf16 v[76:79], v[148:151], a[48:51], v[76:79]
  ds_read_b64_tr_b16 v[116:117], v8 offset:16640
  ds_read_b64_tr_b16 v[118:119], v9 offset:16640
  v_mfma_f32_16x16x32_bf16 v[92:95], v[148:151], a[56:59], v[92:95]
  ds_read_b64_tr_b16 v[120:121], v8 offset:18688
  ds_read_b64_tr_b16 v[122:123], v9 offset:18688
  v_mfma_f32_16x16x32_bf16 v[96:99], v[152:155], a[56:59], v[96:99]
  ds_read_b64_tr_b16 v[132:133], v8 offset:20736
  ds_read_b64_tr_b16 v[134:135], v9 offset:20736
  v_mfma_f32_16x16x32_bf16 v[80:83], v[152:155], a[48:51], v[80:83]
  ds_read_b64_tr_b16 v[136:137], v8 offset:22784
  ds_read_b64_tr_b16 v[138:139], v9 offset:22784
  v_mfma_f32_16x16x32_bf16 v[76:79], v[156:159], a[36:39], v[76:79]
  s_waitcnt vmcnt(0)
  v_and_b32 v44, 1, v12
  v_bitop3_b32 v44, v44, v13, v14 bitop3:0x80
  v_bitop3_b32 v44, v44, v15, v16 bitop3:0x80
  v_bitop3_b32 v44, v44, v17, v18 bitop3:0x80
  v_bitop3_b32 v44, v44, v19, v20 bitop3:0x80
  v_bitop3_b32 v44, v44, v21, v22 bitop3:0x80
  v_bitop3_b32 v44, v44, v23, v40 bitop3:0x80
  v_bitop3_b32 v44, v44, v41, v42 bitop3:0x80
  v_and_b32 v44, v44, v43
  v_cmp_eq_u32 vcc, 0, v44
  s_nop 0
  s_cbranch_vccz gated_mix__spectral_gfnet__ssm_conv_s5__prompt_kernel_skip51
  s_mov_b32 s28, 0
gated_mix__spectral_gfnet__ssm_conv_s5__prompt_kernel_px52:
  s_sleep 2
  buffer_load_dwordx4 v[20:23], v64, s[44:47], s9 offen offset:0 sc1
  buffer_load_dwordx4 v[40:43], v64, s[44:47], s9 offen offset:1024 sc1
  buffer_load_dwordx4 v[12:15], v64, s[44:47], s9 offen offset:2048 sc1
  buffer_load_dwordx4 v[16:19], v64, s[44:47], s9 offen offset:3072 sc1
  s_waitcnt vmcnt(0)
  v_and_b32 v44, 1, v12
  v_bitop3_b32 v44, v44, v13, v14 bitop3:0x80
  v_bitop3_b32 v44, v44, v15, v16 bitop3:0x80
  v_bitop3_b32 v44, v44, v17, v18 bitop3:0x80
  v_bitop3_b32 v44, v44, v19, v20 bitop3:0x80
  v_bitop3_b32 v44, v44, v21, v22 bitop3:0x80
  v_bitop3_b32 v44, v44, v23, v40 bitop3:0x80
  v_bitop3_b32 v44, v44, v41, v42 bitop3:0x80
  v_and_b32 v44, v44, v43
  v_cmp_eq_u32 vcc, 0, v44
  s_nop 0
  s_cbranch_vccz gated_mix__spectral_gfnet__ssm_conv_s5__prompt_kernel_pxout53
  s_add_u32 s28, s28, 1
  s_cmp_lt_u32 s28, 1048576
  s_cbranch_scc1 gated_mix__spectral_gfnet__ssm_conv_s5__prompt_kernel_px52
gated_mix__spectral_gfnet__ssm_conv_s5__prompt_kernel_pxout53:
gated_mix__spectral_gfnet__ssm_conv_s5__prompt_kernel_skip51:
  v_mfma_f32_16x16x32_bf16 v[92:95], v[156:159], a[44:47], v[92:95]
  v_mfma_f32_16x16x32_bf16 v[96:99], v[160:163], a[44:47], v[96:99]
  v_mfma_f32_16x16x32_bf16 v[80:83], v[160:163], a[36:39], v[80:83]
  v_mfma_f32_16x16x32_bf16 v[76:79], v[164:167], a[52:55], v[76:79]
  v_mfma_f32_16x16x32_bf16 v[92:95], v[164:167], a[60:63], v[92:95]
  v_mfma_f32_16x16x32_bf16 v[96:99], v[168:171], a[60:63], v[96:99]
  v_mfma_f32_16x16x32_bf16 v[80:83], v[168:171], a[52:55], v[80:83]
  s_waitcnt lgkmcnt(0)
  v_mfma_f32_16x16x32_bf16 v[76:79], v[100:103], a[64:67], v[76:79]
  ds_read_b64_tr_b16 v[140:141], v8 offset:24576
  ds_read_b64_tr_b16 v[142:143], v9 offset:24576
  v_mfma_f32_16x16x32_bf16 v[92:95], v[100:103], a[72:75], v[92:95]
  ds_read_b64_tr_b16 v[144:145], v8 offset:26624
  ds_read_b64_tr_b16 v[146:147], v9 offset:26624
  v_mfma_f32_16x16x32_bf16 v[96:99], v[104:107], a[72:75], v[96:99]
  ds_read_b64_tr_b16 v[148:149], v8 offset:28672
  ds_read_b64_tr_b16 v[150:151], v9 offset:28672
  v_mfma_f32_16x16x32_bf16 v[80:83], v[104:107], a[64:67], v[80:83]
  ds_read_b64_tr_b16 v[152:153], v8 offset:30720
  ds_read_b64_tr_b16 v[154:155], v9 offset:30720
  v_mfma_f32_16x16x32_bf16 v[76:79], v[108:111], a[80:83], v[76:79]
  ds_read_b64_tr_b16 v[156:157], v8 offset:24832
  ds_read_b64_tr_b16 v[158:159], v9 offset:24832
  v_mfma_f32_16x16x32_bf16 v[92:95], v[108:111], a[88:91], v[92:95]
  ds_read_b64_tr_b16 v[160:161], v8 offset:26880
  ds_read_b64_tr_b16 v[162:163], v9 offset:26880
  v_mfma_f32_16x16x32_bf16 v[96:99], v[112:115], a[88:91], v[96:99]
  ds_read_b64_tr_b16 v[164:165], v8 offset:28928
  ds_read_b64_tr_b16 v[166:167], v9 offset:28928
  v_mfma_f32_16x16x32_bf16 v[80:83], v[112:115], a[80:83], v[80:83]
  ds_read_b64_tr_b16 v[168:169], v8 offset:30976
  ds_read_b64_tr_b16 v[170:171], v9 offset:30976
  v_mfma_f32_16x16x32_bf16 v[76:79], v[116:119], a[68:71], v[76:79]
  v_pk_add_f32 v[196:197], v[196:197], v[68:69] neg_lo:[0,1] neg_hi:[0,1]
  v_pk_add_f32 v[198:199], v[198:199], v[70:71] neg_lo:[0,1] neg_hi:[0,1]
  v_pk_fma_f32 v[68:69], v[228:229], v[196:197], v[68:69]
  v_pk_fma_f32 v[70:71], v[230:231], v[198:199], v[70:71]
  v_lshlrev_b32 v44, 16, v12
  v_and_b32 v45, 0xffff0000, v12
  v_pk_add_f32 v[68:69], v[68:69], v[44:45]
  v_lshlrev_b32 v46, 16, v13
  v_and_b32 v47, 0xffff0000, v13
  v_pk_add_f32 v[70:71], v[70:71], v[46:47]
  v_pk_add_f32 v[212:213], v[212:213], v[84:85] neg_lo:[0,1] neg_hi:[0,1]
  v_pk_add_f32 v[214:215], v[214:215], v[86:87] neg_lo:[0,1] neg_hi:[0,1]
  v_pk_fma_f32 v[84:85], v[228:229], v[212:213], v[84:85]
  v_pk_fma_f32 v[86:87], v[230:231], v[214:215], v[86:87]
  v_lshlrev_b32 v48, 16, v20
  v_and_b32 v49, 0xffff0000, v20
  v_pk_add_f32 v[84:85], v[84:85], v[48:49]
  v_lshlrev_b32 v50, 16, v21
  v_and_b32 v51, 0xffff0000, v21
  v_pk_add_f32 v[86:87], v[86:87], v[50:51]
  v_mfma_f32_16x16x32_bf16 v[92:95], v[116:119], a[76:79], v[92:95]
  v_mfma_f32_16x16x32_bf16 v[96:99], v[120:123], a[76:79], v[96:99]
  v_mfma_f32_16x16x32_bf16 v[80:83], v[120:123], a[68:71], v[80:83]
  v_mfma_f32_16x16x32_bf16 v[76:79], v[132:135], a[84:87], v[76:79]
  buffer_store_dword v68, v36, s[24:27], s7 offen sc1
  v_mfma_f32_16x16x32_bf16 v[92:95], v[132:135], a[92:95], v[92:95]
  v_mfma_f32_16x16x32_bf16 v[96:99], v[136:139], a[92:95], v[96:99]
  v_mfma_f32_16x16x32_bf16 v[80:83], v[136:139], a[84:87], v[80:83]
  s_waitcnt lgkmcnt(0)
  v_mfma_f32_16x16x32_bf16 v[76:79], v[140:143], a[96:99], v[76:79]
  ds_read_b64_tr_b16 v[100:101], v8 offset:32768
  ds_read_b64_tr_b16 v[102:103], v9 offset:32768
  buffer_store_dword v84, v37, s[24:27], s7 offen sc1
  v_mfma_f32_16x16x32_bf16 v[92:95], v[140:143], a[104:107], v[92:95]
  ds_read_b64_tr_b16 v[104:105], v8 offset:34816
  ds_read_b64_tr_b16 v[106:107], v9 offset:34816
  s_add_u32 s7, s7, 65536
  v_mfma_f32_16x16x32_bf16 v[96:99], v[144:147], a[104:107], v[96:99]
  ds_read_b64_tr_b16 v[108:109], v8 offset:36864
  ds_read_b64_tr_b16 v[110:111], v9 offset:36864
  v_mfma_f32_16x16x32_bf16 v[80:83], v[144:147], a[96:99], v[80:83]
  ds_read_b64_tr_b16 v[112:113], v8 offset:38912
  ds_read_b64_tr_b16 v[114:115], v9 offset:38912
  v_mfma_f32_16x16x32_bf16 v[76:79], v[148:151], a[112:115], v[76:79]
  ds_read_b64_tr_b16 v[116:117], v8 offset:33024
  ds_read_b64_tr_b16 v[118:119], v9 offset:33024
  buffer_store_dword v69, v36, s[24:27], s7 offen sc1
  v_mfma_f32_16x16x32_bf16 v[92:95], v[148:151], a[120:123], v[92:95]
  ds_read_b64_tr_b16 v[120:121], v8 offset:35072
  ds_read_b64_tr_b16 v[122:123], v9 offset:35072
  v_mfma_f32_16x16x32_bf16 v[96:99], v[152:155], a[120:123], v[96:99]
  ds_read_b64_tr_b16 v[132:133], v8 offset:37120
  ds_read_b64_tr_b16 v[134:135], v9 offset:37120
  v_mfma_f32_16x16x32_bf16 v[80:83], v[152:155], a[112:115], v[80:83]
  ds_read_b64_tr_b16 v[136:137], v8 offset:39168
  ds_read_b64_tr_b16 v[138:139], v9 offset:39168
  v_mfma_f32_16x16x32_bf16 v[76:79], v[156:159], a[100:103], v[76:79]
  buffer_store_dword v85, v37, s[24:27], s7 offen sc1
  v_mfma_f32_16x16x32_bf16 v[92:95], v[156:159], a[108:111], v[92:95]
  s_add_u32 s7, s7, 65536
  v_mfma_f32_16x16x32_bf16 v[96:99], v[160:163], a[108:111], v[96:99]
  v_mfma_f32_16x16x32_bf16 v[80:83], v[160:163], a[100:103], v[80:83]
  v_mfma_f32_16x16x32_bf16 v[76:79], v[164:167], a[116:119], v[76:79]
  buffer_store_dword v70, v36, s[24:27], s7 offen sc1
  v_mfma_f32_16x16x32_bf16 v[92:95], v[164:167], a[124:127], v[92:95]
  v_mfma_f32_16x16x32_bf16 v[96:99], v[168:171], a[124:127], v[96:99]
  v_mfma_f32_16x16x32_bf16 v[80:83], v[168:171], a[116:119], v[80:83]
  s_waitcnt lgkmcnt(0)
  v_mfma_f32_16x16x32_bf16 v[76:79], v[100:103], a[128:131], v[76:79]
  ds_read_b64_tr_b16 v[140:141], v8 offset:40960
  ds_read_b64_tr_b16 v[142:143], v9 offset:40960
  buffer_store_dword v86, v37, s[24:27], s7 offen sc1
  v_mfma_f32_16x16x32_bf16 v[92:95], v[100:103], a[136:139], v[92:95]
  ds_read_b64_tr_b16 v[144:145], v8 offset:43008
  ds_read_b64_tr_b16 v[146:147], v9 offset:43008
  s_add_u32 s7, s7, 65536
  v_mfma_f32_16x16x32_bf16 v[96:99], v[104:107], a[136:139], v[96:99]
  ds_read_b64_tr_b16 v[148:149], v8 offset:45056
  ds_read_b64_tr_b16 v[150:151], v9 offset:45056
  v_mfma_f32_16x16x32_bf16 v[80:83], v[104:107], a[128:131], v[80:83]
  ds_read_b64_tr_b16 v[152:153], v8 offset:47104
  ds_read_b64_tr_b16 v[154:155], v9 offset:47104
  v_mfma_f32_16x16x32_bf16 v[76:79], v[108:111], a[144:147], v[76:79]
  ds_read_b64_tr_b16 v[156:157], v8 offset:41216
  ds_read_b64_tr_b16 v[158:159], v9 offset:41216
  buffer_store_dword v71, v36, s[24:27], s7 offen sc1
  v_mfma_f32_16x16x32_bf16 v[92:95], v[108:111], a[152:155], v[92:95]
  ds_read_b64_tr_b16 v[160:161], v8 offset:43264
  ds_read_b64_tr_b16 v[162:163], v9 offset:43264
  v_mfma_f32_16x16x32_bf16 v[96:99], v[112:115], a[152:155], v[96:99]
  ds_read_b64_tr_b16 v[164:165], v8 offset:45312
  ds_read_b64_tr_b16 v[166:167], v9 offset:45312
  v_mfma_f32_16x16x32_bf16 v[80:83], v[112:115], a[144:147], v[80:83]
  ds_read_b64_tr_b16 v[168:169], v8 offset:47360
  ds_read_b64_tr_b16 v[170:171], v9 offset:47360
  v_mfma_f32_16x16x32_bf16 v[76:79], v[116:119], a[132:135], v[76:79]
  buffer_store_dword v87, v37, s[24:27], s7 offen sc1
  v_mfma_f32_16x16x32_bf16 v[92:95], v[116:119], a[140:143], v[92:95]
  s_add_u32 s7, s7, 851968
  v_pk_add_f32 v[200:201], v[200:201], v[72:73] neg_lo:[0,1] neg_hi:[0,1]
  v_pk_add_f32 v[202:203], v[202:203], v[74:75] neg_lo:[0,1] neg_hi:[0,1]
  v_pk_fma_f32 v[72:73], v[232:233], v[200:201], v[72:73]
  v_pk_fma_f32 v[74:75], v[234:235], v[202:203], v[74:75]
  v_lshlrev_b32 v52, 16, v14
  v_and_b32 v53, 0xffff0000, v14
  v_pk_add_f32 v[72:73], v[72:73], v[52:53]
  v_lshlrev_b32 v54, 16, v15
  v_and_b32 v55, 0xffff0000, v15
  v_pk_add_f32 v[74:75], v[74:75], v[54:55]
  v_pk_add_f32 v[216:217], v[216:217], v[88:89] neg_lo:[0,1] neg_hi:[0,1]
  v_pk_add_f32 v[218:219], v[218:219], v[90:91] neg_lo:[0,1] neg_hi:[0,1]
  v_pk_fma_f32 v[88:89], v[232:233], v[216:217], v[88:89]
  v_pk_fma_f32 v[90:91], v[234:235], v[218:219], v[90:91]
  v_lshlrev_b32 v56, 16, v22
  v_and_b32 v57, 0xffff0000, v22
  v_pk_add_f32 v[88:89], v[88:89], v[56:57]
  v_lshlrev_b32 v58, 16, v23
  v_and_b32 v59, 0xffff0000, v23
  v_pk_add_f32 v[90:91], v[90:91], v[58:59]
  v_mfma_f32_16x16x32_bf16 v[96:99], v[120:123], a[140:143], v[96:99]
  v_mfma_f32_16x16x32_bf16 v[80:83], v[120:123], a[132:135], v[80:83]
  v_mfma_f32_16x16x32_bf16 v[76:79], v[132:135], a[148:151], v[76:79]
  buffer_store_dword v72, v36, s[24:27], s7 offen sc1
  v_mfma_f32_16x16x32_bf16 v[92:95], v[132:135], a[156:159], v[92:95]
  v_mfma_f32_16x16x32_bf16 v[96:99], v[136:139], a[156:159], v[96:99]
  v_mfma_f32_16x16x32_bf16 v[80:83], v[136:139], a[148:151], v[80:83]
  s_waitcnt lgkmcnt(0)
  v_mfma_f32_16x16x32_bf16 v[76:79], v[140:143], a[160:163], v[76:79]
  ds_read_b64_tr_b16 v[100:101], v8 offset:49152
  ds_read_b64_tr_b16 v[102:103], v9 offset:49152
  buffer_store_dword v88, v37, s[24:27], s7 offen sc1
  v_mfma_f32_16x16x32_bf16 v[92:95], v[140:143], a[168:171], v[92:95]
  ds_read_b64_tr_b16 v[104:105], v8 offset:51200
  ds_read_b64_tr_b16 v[106:107], v9 offset:51200
  s_add_u32 s7, s7, 65536
  v_mfma_f32_16x16x32_bf16 v[96:99], v[144:147], a[168:171], v[96:99]
  ds_read_b64_tr_b16 v[108:109], v8 offset:53248
  ds_read_b64_tr_b16 v[110:111], v9 offset:53248
  v_mfma_f32_16x16x32_bf16 v[80:83], v[144:147], a[160:163], v[80:83]
  ds_read_b64_tr_b16 v[112:113], v8 offset:55296
  ds_read_b64_tr_b16 v[114:115], v9 offset:55296
  v_mfma_f32_16x16x32_bf16 v[76:79], v[148:151], a[176:179], v[76:79]
  ds_read_b64_tr_b16 v[116:117], v8 offset:49408
  ds_read_b64_tr_b16 v[118:119], v9 offset:49408
  buffer_store_dword v73, v36, s[24:27], s7 offen sc1
  v_mfma_f32_16x16x32_bf16 v[92:95], v[148:151], a[184:187], v[92:95]
  ds_read_b64_tr_b16 v[120:121], v8 offset:51456
  ds_read_b64_tr_b16 v[122:123], v9 offset:51456
  v_mfma_f32_16x16x32_bf16 v[96:99], v[152:155], a[184:187], v[96:99]
  ds_read_b64_tr_b16 v[132:133], v8 offset:53504
  ds_read_b64_tr_b16 v[134:135], v9 offset:53504
  v_mfma_f32_16x16x32_bf16 v[80:83], v[152:155], a[176:179], v[80:83]
  ds_read_b64_tr_b16 v[136:137], v8 offset:55552
  ds_read_b64_tr_b16 v[138:139], v9 offset:55552
  v_mfma_f32_16x16x32_bf16 v[76:79], v[156:159], a[164:167], v[76:79]
  buffer_store_dword v89, v37, s[24:27], s7 offen sc1
  v_mfma_f32_16x16x32_bf16 v[92:95], v[156:159], a[172:175], v[92:95]
  s_add_u32 s7, s7, 65536
  v_mfma_f32_16x16x32_bf16 v[96:99], v[160:163], a[172:175], v[96:99]
  v_mfma_f32_16x16x32_bf16 v[80:83], v[160:163], a[164:167], v[80:83]
  v_mfma_f32_16x16x32_bf16 v[76:79], v[164:167], a[180:183], v[76:79]
  buffer_store_dword v74, v36, s[24:27], s7 offen sc1
  v_mfma_f32_16x16x32_bf16 v[92:95], v[164:167], a[188:191], v[92:95]
  v_mfma_f32_16x16x32_bf16 v[96:99], v[168:171], a[188:191], v[96:99]
  v_mfma_f32_16x16x32_bf16 v[80:83], v[168:171], a[180:183], v[80:83]
  s_waitcnt lgkmcnt(0)
  v_mfma_f32_16x16x32_bf16 v[76:79], v[100:103], a[192:195], v[76:79]
  ds_read_b64_tr_b16 v[140:141], v8 offset:57344
  ds_read_b64_tr_b16 v[142:143], v9 offset:57344
  buffer_store_dword v90, v37, s[24:27], s7 offen sc1
  v_mfma_f32_16x16x32_bf16 v[92:95], v[100:103], a[200:203], v[92:95]
  ds_read_b64_tr_b16 v[144:145], v8 offset:59392
  ds_read_b64_tr_b16 v[146:147], v9 offset:59392
  s_add_u32 s7, s7, 65536
  v_mfma_f32_16x16x32_bf16 v[96:99], v[104:107], a[200:203], v[96:99]
  ds_read_b64_tr_b16 v[148:149], v8 offset:61440
  ds_read_b64_tr_b16 v[150:151], v9 offset:61440
  v_mfma_f32_16x16x32_bf16 v[80:83], v[104:107], a[192:195], v[80:83]
  ds_read_b64_tr_b16 v[152:153], v8 offset:63488
  ds_read_b64_tr_b16 v[154:155], v9 offset:63488
  v_mfma_f32_16x16x32_bf16 v[76:79], v[108:111], a[208:211], v[76:79]
  ds_read_b64_tr_b16 v[156:157], v8 offset:57600
  ds_read_b64_tr_b16 v[158:159], v9 offset:57600
  buffer_store_dword v75, v36, s[24:27], s7 offen sc1
  v_mfma_f32_16x16x32_bf16 v[92:95], v[108:111], a[216:219], v[92:95]
  ds_read_b64_tr_b16 v[160:161], v8 offset:59648
  ds_read_b64_tr_b16 v[162:163], v9 offset:59648
  v_mfma_f32_16x16x32_bf16 v[96:99], v[112:115], a[216:219], v[96:99]
  ds_read_b64_tr_b16 v[164:165], v8 offset:61696
  ds_read_b64_tr_b16 v[166:167], v9 offset:61696
  v_mfma_f32_16x16x32_bf16 v[80:83], v[112:115], a[208:211], v[80:83]
  ds_read_b64_tr_b16 v[168:169], v8 offset:63744
  ds_read_b64_tr_b16 v[170:171], v9 offset:63744
  v_mfma_f32_16x16x32_bf16 v[76:79], v[116:119], a[196:199], v[76:79]
  buffer_store_dword v91, v37, s[24:27], s7 offen sc1
  v_mfma_f32_16x16x32_bf16 v[92:95], v[116:119], a[204:207], v[92:95]
  s_add_u32 s7, s7, 851968
  v_mfma_f32_16x16x32_bf16 v[96:99], v[120:123], a[204:207], v[96:99]
  v_mfma_f32_16x16x32_bf16 v[80:83], v[120:123], a[196:199], v[80:83]
  v_mfma_f32_16x16x32_bf16 v[76:79], v[132:135], a[212:215], v[76:79]
  v_mfma_f32_16x16x32_bf16 v[92:95], v[132:135], a[220:223], v[92:95]
  v_mfma_f32_16x16x32_bf16 v[96:99], v[136:139], a[220:223], v[96:99]
  v_mfma_f32_16x16x32_bf16 v[80:83], v[136:139], a[212:215], v[80:83]
  s_waitcnt lgkmcnt(0)
  v_mfma_f32_16x16x32_bf16 v[76:79], v[140:143], a[224:227], v[76:79]
  v_mfma_f32_16x16x32_bf16 v[92:95], v[140:143], a[232:235], v[92:95]
  v_mfma_f32_16x16x32_bf16 v[96:99], v[144:147], a[232:235], v[96:99]
  v_mfma_f32_16x16x32_bf16 v[80:83], v[144:147], a[224:227], v[80:83]
  v_mfma_f32_16x16x32_bf16 v[76:79], v[148:151], a[240:243], v[76:79]
  v_mfma_f32_16x16x32_bf16 v[92:95], v[148:151], a[248:251], v[92:95]
  v_mfma_f32_16x16x32_bf16 v[96:99], v[152:155], a[248:251], v[96:99]
  v_mfma_f32_16x16x32_bf16 v[80:83], v[152:155], a[240:243], v[80:83]
  v_mfma_f32_16x16x32_bf16 v[76:79], v[156:159], a[228:231], v[76:79]
  v_mfma_f32_16x16x32_bf16 v[92:95], v[156:159], a[236:239], v[92:95]
  v_mfma_f32_16x16x32_bf16 v[96:99], v[160:163], a[236:239], v[96:99]
  v_mfma_f32_16x16x32_bf16 v[80:83], v[160:163], a[228:231], v[80:83]
  v_mfma_f32_16x16x32_bf16 v[76:79], v[164:167], a[244:247], v[76:79]
  v_mfma_f32_16x16x32_bf16 v[92:95], v[164:167], a[252:255], v[92:95]
  v_mfma_f32_16x16x32_bf16 v[96:99], v[168:171], a[252:255], v[96:99]
  v_mfma_f32_16x16x32_bf16 v[80:83], v[168:171], a[244:247], v[80:83]
  s_nop 4
  v_pk_add_f32 v[204:205], v[204:205], v[76:77] neg_lo:[0,1] neg_hi:[0,1]
  v_pk_add_f32 v[206:207], v[206:207], v[78:79] neg_lo:[0,1] neg_hi:[0,1]
  v_pk_fma_f32 v[76:77], v[236:237], v[204:205], v[76:77]
  v_pk_fma_f32 v[78:79], v[238:239], v[206:207], v[78:79]
  v_lshlrev_b32 v44, 16, v16
  v_and_b32 v45, 0xffff0000, v16
  v_pk_add_f32 v[76:77], v[76:77], v[44:45]
  v_lshlrev_b32 v46, 16, v17
  v_and_b32 v47, 0xffff0000, v17
  v_pk_add_f32 v[78:79], v[78:79], v[46:47]
  v_pk_add_f32 v[220:221], v[220:221], v[92:93] neg_lo:[0,1] neg_hi:[0,1]
  v_pk_add_f32 v[222:223], v[222:223], v[94:95] neg_lo:[0,1] neg_hi:[0,1]
  v_pk_fma_f32 v[92:93], v[236:237], v[220:221], v[92:93]
  v_pk_fma_f32 v[94:95], v[238:239], v[222:223], v[94:95]
  v_lshlrev_b32 v48, 16, v40
  v_and_b32 v49, 0xffff0000, v40
  v_pk_add_f32 v[92:93], v[92:93], v[48:49]
  v_lshlrev_b32 v50, 16, v41
  v_and_b32 v51, 0xffff0000, v41
  v_pk_add_f32 v[94:95], v[94:95], v[50:51]
  buffer_store_dword v76, v36, s[24:27], s7 offen sc1
  buffer_store_dword v92, v37, s[24:27], s7 offen sc1
  s_add_u32 s7, s7, 65536
  buffer_store_dword v77, v36, s[24:27], s7 offen sc1
  buffer_store_dword v93, v37, s[24:27], s7 offen sc1
  s_add_u32 s7, s7, 65536
  buffer_store_dword v78, v36, s[24:27], s7 offen sc1
  buffer_store_dword v94, v37, s[24:27], s7 offen sc1
  s_add_u32 s7, s7, 65536
  buffer_store_dword v79, v36, s[24:27], s7 offen sc1
  buffer_store_dword v95, v37, s[24:27], s7 offen sc1
  s_add_u32 s7, s7, 851968
  v_pk_add_f32 v[208:209], v[208:209], v[80:81] neg_lo:[0,1] neg_hi:[0,1]
  v_pk_add_f32 v[210:211], v[210:211], v[82:83] neg_lo:[0,1] neg_hi:[0,1]
  v_pk_fma_f32 v[80:81], v[240:241], v[208:209], v[80:81]
  v_pk_fma_f32 v[82:83], v[242:243], v[210:211], v[82:83]
  v_lshlrev_b32 v52, 16, v18
  v_and_b32 v53, 0xffff0000, v18
  v_pk_add_f32 v[80:81], v[80:81], v[52:53]
  v_lshlrev_b32 v54, 16, v19
  v_and_b32 v55, 0xffff0000, v19
  v_pk_add_f32 v[82:83], v[82:83], v[54:55]
  v_pk_add_f32 v[224:225], v[224:225], v[96:97] neg_lo:[0,1] neg_hi:[0,1]
  v_pk_add_f32 v[226:227], v[226:227], v[98:99] neg_lo:[0,1] neg_hi:[0,1]
  v_pk_fma_f32 v[96:97], v[240:241], v[224:225], v[96:97]
  v_pk_fma_f32 v[98:99], v[242:243], v[226:227], v[98:99]
  v_lshlrev_b32 v56, 16, v42
  v_and_b32 v57, 0xffff0000, v42
  v_pk_add_f32 v[96:97], v[96:97], v[56:57]
  v_lshlrev_b32 v58, 16, v43
  v_and_b32 v59, 0xffff0000, v43
  v_pk_add_f32 v[98:99], v[98:99], v[58:59]
  buffer_store_dword v80, v36, s[24:27], s7 offen sc1
  buffer_store_dword v96, v37, s[24:27], s7 offen sc1
  s_add_u32 s7, s7, 65536
  buffer_store_dword v81, v36, s[24:27], s7 offen sc1
  buffer_store_dword v97, v37, s[24:27], s7 offen sc1
  s_add_u32 s7, s7, 65536
  buffer_store_dword v82, v36, s[24:27], s7 offen sc1
  buffer_store_dword v98, v37, s[24:27], s7 offen sc1
  s_add_u32 s7, s7, 65536
  buffer_store_dword v83, v36, s[24:27], s7 offen sc1
  buffer_store_dword v99, v37, s[24:27], s7 offen sc1
gated_mix__spectral_gfnet__ssm_conv_s5__prompt_kernel_end:
  s_endpgm
.section .rodata,"a"
.p2align 6
.amdhsa_kernel gated_mix__spectral_gfnet__ssm_conv_s5__prompt_kernel
  .amdhsa_next_free_vgpr 500
  .amdhsa_next_free_sgpr 102
  .amdhsa_accum_offset 244
  .amdhsa_group_segment_fixed_size 0
  .amdhsa_kernarg_size 128
  .amdhsa_user_sgpr_count 2
  .amdhsa_user_sgpr_kernarg_segment_ptr 1
  .amdhsa_system_sgpr_workgroup_id_x 1
  .amdhsa_float_denorm_mode_32 3
.end_amdhsa_kernel
```

```asm
; @launch grid=(256,1,1) block=(256,1,1) lds=163840
.amdgcn_target "amdgcn-amd-amdhsa--gfx950"
.text
.p2align 8
.globl gated_mix__spectral_gfnet__ssm_conv_s5__prompt_kernel
.type gated_mix__spectral_gfnet__ssm_conv_s5__prompt_kernel,@function
gated_mix__spectral_gfnet__ssm_conv_s5__prompt_kernel:
  s_cmp_ge_u32 s2, 256
  s_cbranch_scc1 gated_mix__spectral_gfnet__ssm_conv_s5__prompt_kernel_end
  s_load_dwordx16 s[4:19], s[0:1], 0
  s_load_dwordx16 s[20:35], s[0:1], 64
  v_readfirstlane_b32 s3, v0
  v_and_b32 v1, 63, v0
  v_and_b32 v2, 15, v0
  v_bfe_u32 v3, v0, 4, 2
  s_bfe_u32 s36, s2, 0x20003
  s_lshr_b32 s43, s2, 5
  s_lshr_b32 s3, s3, 6
  s_and_b32 s38, s2, 3
  s_lshl2_add_u32 s38, s38, s36
  s_bfe_u32 s39, s2, 0x10002
  s_lshl3_add_u32 s39, s39, s43
  s_and_b32 s42, s2, 1
  s_lshl3_add_u32 s40, s42, s43
  s_lshl1_add_u32 s42, s43, s42
  s_bfe_u32 s41, s2, 0x20001
  s_lshl2_add_u32 s41, s41, s36
  s_and_b32 s37, s2, 7
  s_lshl3_add_u32 s37, s37, s43
  s_cmp_lg_u32 s3, 0
  s_cbranch_scc1 gated_mix__spectral_gfnet__ssm_conv_s5__prompt_kernel_skip2
  s_getpc_b64 s[44:45]
gated_mix__spectral_gfnet__ssm_conv_s5__prompt_kernel_pc1:
  s_lshr_b32 s43, s2, 3
  s_mul_i32 s43, s43, 1280
  v_min_u32 v6, 9, v1
  v_lshl_add_u32 v6, v6, 7, s43
  v_min_u32 v6, gated_mix__spectral_gfnet__ssm_conv_s5__prompt_kernel_end-gated_mix__spectral_gfnet__ssm_conv_s5__prompt_kernel_pc1, v6
  v_mov_b32 v7, 0
  v_lshl_add_u64 v[6:7], v[6:7], 0, s[44:45]
  global_load_dword v4, v[6:7], off
gated_mix__spectral_gfnet__ssm_conv_s5__prompt_kernel_skip2:
  s_mov_b32 s46, 4194304
  s_mov_b32 s47, 0x20000
  s_mov_b32 s50, 2097152
  s_mov_b32 s51, 0x20000
  v_bfe_u32 v6, v1, 1, 2
  v_xor_b32 v6, v6, v3
  v_lshlrev_b32 v5, 9, v6
  v_and_b32 v6, 1, v1
  v_lshl_or_b32 v5, v6, 4, v5
  v_lshrrev_b32 v6, 3, v1
  v_lshl_or_b32 v5, v6, 15, v5
  s_lshl_b32 s43, s3, 9
  s_add_u32 s43, s43, s40
  s_lshl_b32 s43, s43, 6
  s_add_u32 s43, s43, s41
  s_lshl_b32 s43, s43, 5
  s_lshl_b32 m0, s3, 12
  s_add_u32 m0, m0, 131072
  s_waitcnt lgkmcnt(0)
  s_mov_b64 s[44:45], s[4:5]
  buffer_load_dwordx4 v5, s[44:47], s43 offen offset:0 lds
  s_add_u32 s43, s43, 261120
  buffer_load_dwordx4 v5, s[44:47], s43 offen offset:1024 lds
  s_add_u32 s43, s43, 261120
  buffer_load_dwordx4 v5, s[44:47], s43 offen offset:2048 lds
  s_add_u32 s43, s43, 261120
  buffer_load_dwordx4 v5, s[44:47], s43 offen offset:3072 lds
  v_and_b32 v6, 7, v1
  v_xor_b32 v6, v6, v3
  v_lshlrev_b32 v6, 4, v6
  v_lshrrev_b32 v7, 3, v1
  v_lshl_or_b32 v12, v7, 11, v6
  v_and_b32 v7, 32, v1
  v_lshl_or_b32 v8, v7, 11, v6
  v_and_b32 v7, 8, v1
  v_lshl_or_b32 v8, v7, 12, v8
  v_and_b32 v7, 16, v1
  v_lshl_or_b32 v8, v7, 7, v8
  s_lshr_b32 s53, s3, 1
  s_lshl1_add_u32 s54, s39, s53
  s_lshl_b32 s54, s54, 16
  v_add_u32 v12, s54, v12
  s_lshl1_add_u32 s54, s38, s53
  s_and_b32 s53, s3, 1
  s_lshl3_add_u32 s54, s54, s53
  s_lshl_b32 s54, s54, 14
  v_add_u32 v8, s54, v8
  v_xor_b32 v9, 64, v8
  v_xor_b32 v13, 64, v12
  v_add_u32 v9, 3072, v9
  v_add_u32 v13, 15360, v13
  v_add_u32 v10, 6144, v8
  v_add_u32 v14, 30720, v12
  v_add_u32 v11, 6144, v9
  v_add_u32 v15, 30720, v13
  s_lshl_b32 s54, s3, 12
  s_add_u32 s55, s54, 65536
  s_lshl_b32 s52, s38, 7
  s_bitcmp1_b32 s3, 0
  s_cselect_b64 s[48:49], s[18:19], s[16:17]
  s_lshl_b32 s11, s37, 2
  s_add_u32 s11, s11, s36
  s_cmp_eq_u32 s11, 3
  s_cselect_b32 s4, 1, s36
  s_cselect_b32 s5, 64, s37
  s_and_b32 s10, s11, 0xfd
  s_cmp_eq_u32 s10, 0
  s_cselect_b32 s10, 1, 0
  v_cvt_f32_u32 v6, v2
  v_cvt_f32_u32 v7, v3
  v_mul_f32 v7, 4.0, v7
  s_cmp_lg_u32 s3, 0
  s_cbranch_scc1 gated_mix__spectral_gfnet__ssm_conv_s5__prompt_kernel_skip3
  v_cvt_f32_u32 v43, s10
  v_mul_f32 v43, 0xc4700000, v43
  v_cmp_lt_u32 vcc, 7, v2
  v_cvt_f32_u32 v42, s5
  s_nop 0
  v_cndmask_b32 v43, 0, v43, vcc
  v_add_f32 v42, v42, v43
  v_fmamk_f32 v40, v6, 0x43000000, v42
  v_mul_f32 v40, 0x3a000000, v40
  v_mul_f32 v41, v40, v7
  v_fmamk_f32 v32, v40, 0x0, v41
  v_fmamk_f32 v33, v40, 0x3f800000, v41
  v_fmamk_f32 v34, v40, 0x40000000, v41
  v_fmamk_f32 v35, v40, 0x40400000, v41
  v_cos_f32 v36, v32
  v_cos_f32 v37, v33
  v_cos_f32 v38, v34
  v_cos_f32 v39, v35
  v_sin_f32 v32, v32
  v_sin_f32 v33, v33
  v_sin_f32 v34, v34
  v_sin_f32 v35, v35
  v_cvt_pk_bf16_f32 v16, v36, v32
  v_cvt_pk_bf16_f32 v20, -v32, v36
  v_cvt_pk_bf16_f32 v17, v37, v33
  v_cvt_pk_bf16_f32 v21, -v33, v37
  v_cvt_pk_bf16_f32 v18, v38, v34
  v_cvt_pk_bf16_f32 v22, -v34, v38
  v_cvt_pk_bf16_f32 v19, v39, v35
  v_cvt_pk_bf16_f32 v23, -v35, v39
  v_xor_b32 v42, 3, v2
  v_cndmask_b32 v42, v2, v42, vcc
  v_cvt_f32_u32 v40, v42
  v_mul_f32 v40, 0x3d800000, v40
  v_mul_f32 v41, v40, v7
  v_fmamk_f32 v32, v40, 0x0, v41
  v_fmamk_f32 v33, v40, 0x3f800000, v41
  v_fmamk_f32 v34, v40, 0x40000000, v41
  v_fmamk_f32 v35, v40, 0x40400000, v41
  v_cos_f32 v36, v32
  v_cos_f32 v37, v33
  v_cos_f32 v38, v34
  v_cos_f32 v39, v35
  v_sin_f32 v32, v32
  v_sin_f32 v33, v33
  v_sin_f32 v34, v34
  v_sin_f32 v35, v35
  v_cvt_pk_bf16_f32 v24, v36, v32
  v_cvt_pk_bf16_f32 v28, -v32, v36
  v_cvt_pk_bf16_f32 v25, v37, v33
  v_cvt_pk_bf16_f32 v29, -v33, v37
  v_cvt_pk_bf16_f32 v26, v38, v34
  v_cvt_pk_bf16_f32 v30, -v34, v38
  v_cvt_pk_bf16_f32 v27, v39, v35
  v_cvt_pk_bf16_f32 v31, -v35, v39
  s_cmp_eq_u32 s10, 0
  s_cbranch_scc1 gated_mix__spectral_gfnet__ssm_conv_s5__prompt_kernel_skip4
  v_cndmask_b32 v42, 0, 16, vcc
  v_and_b32 v16, 0xffff, v16
  v_lshlrev_b32 v16, v42, v16
  v_and_b32 v17, 0xffff, v17
  v_lshlrev_b32 v17, v42, v17
  v_and_b32 v18, 0xffff, v18
  v_lshlrev_b32 v18, v42, v18
  v_and_b32 v19, 0xffff, v19
  v_lshlrev_b32 v19, v42, v19
  v_and_b32 v20, 0xffff, v20
  v_lshlrev_b32 v20, v42, v20
  v_and_b32 v21, 0xffff, v21
  v_lshlrev_b32 v21, v42, v21
  v_and_b32 v22, 0xffff, v22
  v_lshlrev_b32 v22, v42, v22
  v_and_b32 v23, 0xffff, v23
  v_lshlrev_b32 v23, v42, v23
  v_cmp_eq_u32 vcc, 0, v2
  v_mov_b32 v42, 0x3f80
  s_nop 0
  v_cndmask_b32 v20, v20, v42, vcc
  v_mov_b32 v42, 0xbf80
  v_cndmask_b32 v21, v21, v42, vcc
  v_mov_b32 v42, 0x3f80
  v_cndmask_b32 v22, v22, v42, vcc
  v_mov_b32 v42, 0xbf80
  v_cndmask_b32 v23, v23, v42, vcc
gated_mix__spectral_gfnet__ssm_conv_s5__prompt_kernel_skip4:
gated_mix__spectral_gfnet__ssm_conv_s5__prompt_kernel_skip3:
  s_cmp_lg_u32 s3, 1
  s_cbranch_scc1 gated_mix__spectral_gfnet__ssm_conv_s5__prompt_kernel_skip5
  v_cvt_f32_u32 v43, s10
  v_mul_f32 v43, 0xc4700000, v43
  v_cmp_lt_u32 vcc, 1, v3
  v_cvt_f32_u32 v42, s5
  s_nop 0
  v_cndmask_b32 v43, 0, v43, vcc
  v_add_f32 v42, v42, v43
  v_fmamk_f32 v42, v7, 0x43000000, v42
  v_mul_f32 v41, v42, v6
  v_mul_f32 v41, 0x3a000000, v41
  v_mul_f32 v40, 0x3d800000, v6
  v_fmamk_f32 v32, v40, 0x0, v41
  v_fmamk_f32 v33, v40, 0x3f800000, v41
  v_fmamk_f32 v34, v40, 0x40000000, v41
  v_fmamk_f32 v35, v40, 0x40400000, v41
  v_cos_f32 v36, v32
  v_cos_f32 v37, v33
  v_cos_f32 v38, v34
  v_cos_f32 v39, v35
  v_sin_f32 v32, v32
  v_sin_f32 v33, v33
  v_sin_f32 v34, v34
  v_sin_f32 v35, v35
  v_cvt_pk_bf16_f32 v16, v36, -v32
  v_cvt_pk_bf16_f32 v20, v32, v36
  v_cvt_pk_bf16_f32 v17, v37, -v33
  v_cvt_pk_bf16_f32 v21, v33, v37
  v_cvt_pk_bf16_f32 v18, v38, -v34
  v_cvt_pk_bf16_f32 v22, v34, v38
  v_cvt_pk_bf16_f32 v19, v39, -v35
  v_cvt_pk_bf16_f32 v23, v35, v39
  v_add_f32 v42, 0x40400000, v7
  v_cndmask_b32 v42, v7, v42, vcc
  v_mul_f32 v41, v40, v42
  v_cndmask_b32 v40, v40, -v40, vcc
  v_fmamk_f32 v32, v40, 0x0, v41
  v_fmamk_f32 v33, v40, 0x3f800000, v41
  v_fmamk_f32 v34, v40, 0x40000000, v41
  v_fmamk_f32 v35, v40, 0x40400000, v41
  v_cos_f32 v36, v32
  v_cos_f32 v37, v33
  v_cos_f32 v38, v34
  v_cos_f32 v39, v35
  v_sin_f32 v32, v32
  v_sin_f32 v33, v33
  v_sin_f32 v34, v34
  v_sin_f32 v35, v35
  v_cvt_pk_bf16_f32 v24, v36, -v32
  v_cvt_pk_bf16_f32 v28, v32, v36
  v_cvt_pk_bf16_f32 v25, v37, -v33
  v_cvt_pk_bf16_f32 v29, v33, v37
  v_cvt_pk_bf16_f32 v26, v38, -v34
  v_cvt_pk_bf16_f32 v30, v34, v38
  v_cvt_pk_bf16_f32 v27, v39, -v35
  v_cvt_pk_bf16_f32 v31, v35, v39
  s_cmp_eq_u32 s10, 0
  s_cbranch_scc1 gated_mix__spectral_gfnet__ssm_conv_s5__prompt_kernel_skip6
  v_lshlrev_b32 v42, 16, v16
  v_and_b32 v43, 0xffff0000, v16
  v_add_f32 v42, v42, v42
  v_add_f32 v43, v43, v43
  v_cvt_pk_bf16_f32 v42, v42, v43
  v_cndmask_b32 v16, v42, 0, vcc
  v_cndmask_b32 v20, 0, v42, vcc
  v_lshlrev_b32 v42, 16, v17
  v_and_b32 v43, 0xffff0000, v17
  v_add_f32 v42, v42, v42
  v_add_f32 v43, v43, v43
  v_cvt_pk_bf16_f32 v42, v42, v43
  v_cndmask_b32 v17, v42, 0, vcc
  v_cndmask_b32 v21, 0, v42, vcc
  v_lshlrev_b32 v42, 16, v18
  v_and_b32 v43, 0xffff0000, v18
  v_add_f32 v42, v42, v42
  v_add_f32 v43, v43, v43
  v_cvt_pk_bf16_f32 v42, v42, v43
  v_cndmask_b32 v18, v42, 0, vcc
  v_cndmask_b32 v22, 0, v42, vcc
  v_lshlrev_b32 v42, 16, v19
  v_and_b32 v43, 0xffff0000, v19
  v_add_f32 v42, v42, v42
  v_add_f32 v43, v43, v43
  v_cvt_pk_bf16_f32 v42, v42, v43
  v_cndmask_b32 v19, v42, 0, vcc
  v_cndmask_b32 v23, 0, v42, vcc
  v_lshlrev_b32 v42, 31, v2
  v_or_b32 v42, 0x3f803f80, v42
  v_cmp_eq_u32 vcc, 0, v3
  s_nop 1
  v_cndmask_b32 v16, v16, v42, vcc
gated_mix__spectral_gfnet__ssm_conv_s5__prompt_kernel_skip6:
gated_mix__spectral_gfnet__ssm_conv_s5__prompt_kernel_skip5:
  s_cmp_lg_u32 s3, 2
  s_cbranch_scc1 gated_mix__spectral_gfnet__ssm_conv_s5__prompt_kernel_skip7
  v_cvt_f32_u32 v43, s4
  v_fma_f32 v42, v6, 4.0, v43
  v_mul_f32 v40, 0x3c800000, v42
  v_mul_f32 v41, v40, v7
  v_fmamk_f32 v32, v40, 0x0, v41
  v_fmamk_f32 v33, v40, 0x3f800000, v41
  v_fmamk_f32 v34, v40, 0x40000000, v41
  v_fmamk_f32 v35, v40, 0x40400000, v41
  v_cos_f32 v36, v32
  v_cos_f32 v37, v33
  v_cos_f32 v38, v34
  v_cos_f32 v39, v35
  v_sin_f32 v32, v32
  v_sin_f32 v33, v33
  v_sin_f32 v34, v34
  v_sin_f32 v35, v35
  v_cvt_pk_bf16_f32 v16, v36, v32
  v_cvt_pk_bf16_f32 v20, -v32, v36
  v_cvt_pk_bf16_f32 v17, v37, v33
  v_cvt_pk_bf16_f32 v21, -v33, v37
  v_cvt_pk_bf16_f32 v18, v38, v34
  v_cvt_pk_bf16_f32 v22, -v34, v38
  v_cvt_pk_bf16_f32 v19, v39, v35
  v_cvt_pk_bf16_f32 v23, -v35, v39
  v_mul_f32 v40, 0x3d800000, v40
  v_mul_f32 v41, 0x3d800000, v41
  v_fmamk_f32 v32, v40, 0x0, v41
  v_fmamk_f32 v33, v40, 0x3f800000, v41
  v_fmamk_f32 v34, v40, 0x40000000, v41
  v_fmamk_f32 v35, v40, 0x40400000, v41
  v_cos_f32 v24, v32
  v_cos_f32 v25, v33
  v_cos_f32 v26, v34
  v_cos_f32 v27, v35
  v_sin_f32 v28, v32
  v_sin_f32 v29, v33
  v_sin_f32 v30, v34
  v_sin_f32 v31, v35
gated_mix__spectral_gfnet__ssm_conv_s5__prompt_kernel_skip7:
  s_cmp_lg_u32 s3, 3
  s_cbranch_scc1 gated_mix__spectral_gfnet__ssm_conv_s5__prompt_kernel_skip8
  v_cvt_f32_u32 v43, s4
  v_fma_f32 v42, v7, 4.0, v43
  v_mul_f32 v41, v42, v6
  v_mul_f32 v41, 0x3c800000, v41
  v_mul_f32 v40, 0x3d800000, v6
  v_fmamk_f32 v32, v40, 0x0, v41
  v_fmamk_f32 v33, v40, 0x3f800000, v41
  v_fmamk_f32 v34, v40, 0x40000000, v41
  v_fmamk_f32 v35, v40, 0x40400000, v41
  v_cos_f32 v36, v32
  v_cos_f32 v37, v33
  v_cos_f32 v38, v34
  v_cos_f32 v39, v35
  v_sin_f32 v32, v32
  v_sin_f32 v33, v33
  v_sin_f32 v34, v34
  v_sin_f32 v35, v35
  v_cvt_pk_bf16_f32 v16, v36, -v32
  v_cvt_pk_bf16_f32 v20, v32, v36
  v_cvt_pk_bf16_f32 v17, v37, -v33
  v_cvt_pk_bf16_f32 v21, v33, v37
  v_cvt_pk_bf16_f32 v18, v38, -v34
  v_cvt_pk_bf16_f32 v22, v34, v38
  v_cvt_pk_bf16_f32 v19, v39, -v35
  v_cvt_pk_bf16_f32 v23, v35, v39
  v_mul_f32 v40, 0x3d800000, v40
  v_mul_f32 v41, 0x3d800000, v41
  v_fmamk_f32 v32, v40, 0x0, v41
  v_fmamk_f32 v33, v40, 0x3f800000, v41
  v_fmamk_f32 v34, v40, 0x40000000, v41
  v_fmamk_f32 v35, v40, 0x40400000, v41
  v_cos_f32 v24, v32
  v_cos_f32 v25, v33
  v_cos_f32 v26, v34
  v_cos_f32 v27, v35
  v_sin_f32 v28, v32
  v_sin_f32 v29, v33
  v_sin_f32 v30, v34
  v_sin_f32 v31, v35
  v_mul_f32 v24, 0x35800000, v24
  v_mul_f32 v25, 0x35800000, v25
  v_mul_f32 v26, 0x35800000, v26
  v_mul_f32 v27, 0x35800000, v27
  v_mul_f32 v28, 0x35800000, v28
  v_mul_f32 v29, 0x35800000, v29
  v_mul_f32 v30, 0x35800000, v30
  v_mul_f32 v31, 0x35800000, v31
gated_mix__spectral_gfnet__ssm_conv_s5__prompt_kernel_skip8:
  s_lshl_b32 s16, s3, 12
  s_add_u32 s16, s16, 147456
  v_lshl_add_u32 v42, v1, 4, s16
  ds_write_b128 v42, v[16:19] offset:0
  ds_write_b128 v42, v[20:23] offset:1024
  ds_write_b128 v42, v[24:27] offset:2048
  ds_write_b128 v42, v[28:31] offset:3072
  v_bfe_u32 v6, v1, 1, 3
  v_lshrrev_b32 v7, 5, v1
  v_xor_b32 v6, v6, v7
  v_lshlrev_b32 v6, 4, v6
  v_and_b32 v7, 31, v1
  v_lshl_or_b32 v6, v7, 7, v6
  s_lshr_b32 s53, s3, 1
  v_lshl_add_u32 v16, s53, 13, v6
  s_and_b32 s53, s3, 1
  s_or_b32 s53, s53, 8
  v_lshl_add_u32 v20, s53, 13, v6
  v_xor_b32 v17, 32, v16
  v_xor_b32 v21, 32, v20
  v_xor_b32 v18, 64, v16
  v_xor_b32 v22, 64, v20
  v_xor_b32 v19, 96, v16
  v_xor_b32 v23, 96, v20
  s_add_u32 s16, s34, 20316160
  s_addc_u32 s17, s35, 0
  s_mov_b32 s18, 262144
  s_mov_b32 s19, 0x20000
  v_mov_b32 v6, 0
  v_lshlrev_b32 v7, 4, v0
  s_mov_b32 s56, 4096
  s_cmp_lg_u32 s2, 0
  s_cbranch_scc1 gated_mix__spectral_gfnet__ssm_conv_s5__prompt_kernel_skip9
  v_mov_b32 v24, 0
  v_mov_b32 v25, 0
  v_mov_b32 v26, 0
  v_mov_b32 v27, 0
  buffer_store_dwordx4 v[24:27], v7, s[16:19], 0 offen sc1
  buffer_store_dwordx4 v[24:27], v7, s[16:19], s56 offen sc1
gated_mix__spectral_gfnet__ssm_conv_s5__prompt_kernel_skip9:
  s_mov_b32 s60, s28
  s_mov_b32 s61, s29
  s_mov_b32 s62, 2048
  s_mov_b32 s63, 0x20000
  s_mov_b32 s64, s12
  s_mov_b32 s65, s13
  s_mov_b32 s66, 2048
  s_mov_b32 s67, 0x20000
  s_mov_b32 s68, s14
  s_mov_b32 s69, s15
  s_mov_b32 s70, 2048
  s_mov_b32 s71, 0x20000
  s_add_u32 m0, s55, 0
  s_nop 0
  buffer_load_dwordx4 v12, s[48:51], s52 offen offset:0   lds
  s_mov_b32 s72, s24
  s_mov_b32 s73, s25
  s_mov_b32 s74, 2048
  s_mov_b32 s75, 0x20000
  s_mov_b32 s76, s26
  buffer_load_dwordx4 v13, s[48:51], s52 offen offset:1024   lds
  s_mov_b32 s77, s27
  s_mov_b32 s78, 2048
  s_mov_b32 s79, 0x20000
  s_mov_b32 s12, s34
  s_mov_b32 s13, s35
  buffer_load_dwordx4 v14, s[48:51], s52 offen offset:2048   lds
  s_mov_b32 s14, 4194304
  s_mov_b32 s15, 0x20000
  s_lshl_b32 s28, s3, 4
  v_add_u32 v76, s28, v2
  v_cvt_f32_u32 v72, v76
  buffer_load_dwordx4 v15, s[48:51], s52 offen offset:3072   lds
  v_mul_f32 v72, 0x3c000000, v72
  v_lshrrev_b32 v74, 1, v3
  v_lshlrev_b32 v74, 4, v74
  v_and_b32 v75, 1, v3
  v_lshl_add_u32 v74, v75, 2, v74
  s_add_u32 m0, s54, 0
  s_nop 0
  buffer_load_dwordx4 v8, s[44:47], s52 offen offset:0   lds
  v_cvt_f32_u32 v73, v74
  v_mul_f32 v73, v73, v72
  v_cmp_eq_u32 vcc, 0, v76
  v_fmamk_f32 v56, v72, 0x0, v73
  v_fmamk_f32 v57, v72, 0x3f800000, v73
  buffer_load_dwordx4 v9, s[44:47], s52 offen offset:1024   lds
  v_fmamk_f32 v58, v72, 0x40000000, v73
  v_fmamk_f32 v59, v72, 0x40400000, v73
  v_fmamk_f32 v60, v72, 0x41000000, v73
  v_fmamk_f32 v61, v72, 0x41100000, v73
  v_fmamk_f32 v62, v72, 0x41200000, v73
  buffer_load_dwordx4 v10, s[44:47], s52 offen offset:2048   lds
  v_fmamk_f32 v63, v72, 0x41300000, v73
  v_cos_f32 v64, v56
  v_cos_f32 v65, v57
  buffer_load_dwordx4 v11, s[44:47], s52 offen offset:3072   lds
  s_add_u32 s52, s52, 128
  s_and_b32 s52, s52, 0x7ff
  v_cos_f32 v66, v58
  v_cos_f32 v67, v59
  v_cos_f32 v68, v60
  v_cos_f32 v69, v61
  v_cos_f32 v70, v62
  v_cos_f32 v71, v63
  v_sin_f32 v56, v56
  v_sin_f32 v57, v57
  v_sin_f32 v58, v58
  v_sin_f32 v59, v59
  v_sin_f32 v60, v60
  v_sin_f32 v61, v61
  v_sin_f32 v62, v62
  v_sin_f32 v63, v63
  v_mov_b32 v73, 0x80008000
  v_bfe_i32 v75, v2, 0, 1
  v_bfe_i32 v74, v2, 1, 1
  v_cmp_ne_u32 s[58:59], 0, v75
  v_and_b32 v75, v73, v75
  v_and_b32 v74, v73, v74
  v_xor_b32 v76, v74, v75
  v_mov_b32 v72, 0xbf803f80
  v_cvt_pk_bf16_f32 v24, v64, v65
  v_cvt_pk_bf16_f32 v40, -v56, -v57
  v_cndmask_b32 v40, v40, v72, vcc
  v_cvt_pk_bf16_f32 v25, v66, v67
  v_cvt_pk_bf16_f32 v41, -v58, -v59
  v_cndmask_b32 v41, v41, v72, vcc
  v_cvt_pk_bf16_f32 v26, v68, v69
  v_cvt_pk_bf16_f32 v42, -v60, -v61
  v_cndmask_b32 v42, v42, v72, vcc
  v_cvt_pk_bf16_f32 v27, v70, v71
  v_cvt_pk_bf16_f32 v43, -v62, -v63
  v_cndmask_b32 v43, v43, v72, vcc
  v_cndmask_b32 v28, v24, v40, s[58:59]
  v_cndmask_b32 v44, v40, v24, s[58:59]
  v_xor_b32 v32, v75, v24
  v_xor_b32 v48, v75, v40
  v_xor_b32 v36, v76, v28
  v_xor_b32 v52, v74, v44
  v_xor_b32 v28, v74, v28
  v_xor_b32 v44, v76, v44
  v_cndmask_b32 v29, v25, v41, s[58:59]
  v_cndmask_b32 v45, v41, v25, s[58:59]
  v_xor_b32 v33, v75, v25
  v_xor_b32 v49, v75, v41
  v_xor_b32 v37, v76, v29
  v_xor_b32 v53, v74, v45
  v_xor_b32 v29, v74, v29
  v_xor_b32 v45, v76, v45
  v_cndmask_b32 v30, v26, v42, s[58:59]
  v_cndmask_b32 v46, v42, v26, s[58:59]
  v_xor_b32 v34, v75, v26
  v_xor_b32 v50, v75, v42
  v_xor_b32 v38, v76, v30
  v_xor_b32 v54, v74, v46
  v_xor_b32 v30, v74, v30
  v_xor_b32 v46, v76, v46
  v_cndmask_b32 v31, v27, v43, s[58:59]
  v_cndmask_b32 v47, v43, v27, s[58:59]
  v_xor_b32 v35, v75, v27
  v_xor_b32 v51, v75, v43
  v_xor_b32 v39, v76, v31
  v_xor_b32 v55, v74, v47
  v_xor_b32 v31, v74, v31
  v_xor_b32 v47, v76, v47
  s_lshl_b32 s29, s38, 7
  v_lshl_add_u32 v59, v1, 4, s29
  v_and_b32 v59, 0x7ff, v59
  s_add_u32 m0, s54, 49152
  s_nop 0
  buffer_load_dwordx4 v59, s[60:63], 0 offen lds
  v_xor_b32 v59, 1024, v59
  s_add_u32 m0, s54, 50176
  s_nop 0
  buffer_load_dwordx4 v59, s[60:63], 0 offen lds
  v_and_b32 v5, 31, v1
  v_lshlrev_b32 v5, 1, v5
  s_lshl_b32 s43, s39, 7
  s_and_b32 s28, s3, 1
  s_lshl_b32 s28, s28, 6
  s_add_u32 s43, s43, s28
  buffer_load_ushort v56, v5, s[64:67], s43 offen
  buffer_load_ushort v57, v5, s[68:71], s43 offen
  buffer_load_ushort v58, v5, s[72:75], s43 offen
  v_lshlrev_b32 v5, 1, v2
  s_lshl4_add_u32 s43, s3, s41
  s_lshl_b32 s43, s43, 5
  buffer_load_short_d16_hi v60, v5, s[76:79], s43 offen
  s_waitcnt vmcnt(14) lgkmcnt(0)
  s_barrier
  s_add_u32 m0, s55, 16384
  s_nop 0
  buffer_load_dwordx4 v12, s[48:51], s52 offen offset:0   lds
  v_bfe_u32 v5, v1, 2, 3
  v_lshrrev_b32 v59, 5, v1
  v_lshl_or_b32 v5, v59, 4, v5
  v_lshlrev_b32 v5, 7, v5
  v_and_b32 v59, 3, v1
  v_lshl_or_b32 v5, v59, 3, v5
  v_add_u32 v5, 131072, v5
  v_bfe_u32 v59, v1, 3, 2
  v_xor_b32 v64, 0, v59
  v_lshl_add_u32 v64, v64, 5, v5
  v_xor_b32 v65, 1, v59
  v_lshl_add_u32 v65, v65, 5, v5
  v_xor_b32 v66, 2, v59
  buffer_load_dwordx4 v13, s[48:51], s52 offen offset:1024   lds
  v_lshl_add_u32 v66, v66, 5, v5
  v_xor_b32 v67, 3, v59
  v_lshl_add_u32 v67, v67, 5, v5
  ds_read_b64_tr_b16 v[100:101], v64 offset:0
  ds_read_b64_tr_b16 v[102:103], v64 offset:1024
  ds_read_b64_tr_b16 v[104:105], v64 offset:4096
  ds_read_b64_tr_b16 v[106:107], v64 offset:5120
  ds_read_b64_tr_b16 v[108:109], v64 offset:8192
  ds_read_b64_tr_b16 v[110:111], v64 offset:9216
  ds_read_b64_tr_b16 v[112:113], v64 offset:12288
  ds_read_b64_tr_b16 v[114:115], v64 offset:13312
  ds_read_b64_tr_b16 v[116:117], v66 offset:0
  ds_read_b64_tr_b16 v[118:119], v66 offset:1024
  buffer_load_dwordx4 v14, s[48:51], s52 offen offset:2048   lds
  ds_read_b64_tr_b16 v[120:121], v66 offset:4096
  ds_read_b64_tr_b16 v[122:123], v66 offset:5120
  ds_read_b64_tr_b16 v[124:125], v66 offset:8192
  ds_read_b64_tr_b16 v[126:127], v66 offset:9216
  ds_read_b64_tr_b16 v[128:129], v66 offset:12288
  ds_read_b64_tr_b16 v[130:131], v66 offset:13312
  ds_read_b64_tr_b16 v[132:133], v65 offset:0
  ds_read_b64_tr_b16 v[134:135], v65 offset:1024
  ds_read_b64_tr_b16 v[136:137], v65 offset:4096
  ds_read_b64_tr_b16 v[138:139], v65 offset:5120
  ds_read_b64_tr_b16 v[140:141], v65 offset:8192
  ds_read_b64_tr_b16 v[142:143], v65 offset:9216
  ds_read_b64_tr_b16 v[144:145], v65 offset:12288
  buffer_load_dwordx4 v15, s[48:51], s52 offen offset:3072   lds
  ds_read_b64_tr_b16 v[146:147], v65 offset:13312
  s_waitcnt lgkmcnt(15)
  v_mfma_f32_16x16x32_bf16 v[68:71], v[24:27], v[100:103], 0
  v_mfma_f32_16x16x32_bf16 v[72:75], v[40:43], v[100:103], 0
  s_waitcnt lgkmcnt(15)
  v_mfma_f32_16x16x32_bf16 v[68:71], v[28:31], v[104:107], v[68:71]
  s_add_u32 m0, s54, 16384
  s_nop 0
  buffer_load_dwordx4 v8, s[44:47], s52 offen offset:0   lds
  v_mfma_f32_16x16x32_bf16 v[72:75], v[44:47], v[104:107], v[72:75]
  s_waitcnt lgkmcnt(15)
  v_mfma_f32_16x16x32_bf16 v[68:71], v[32:35], v[108:111], v[68:71]
  v_mfma_f32_16x16x32_bf16 v[72:75], v[48:51], v[108:111], v[72:75]
  s_waitcnt lgkmcnt(15)
  v_mfma_f32_16x16x32_bf16 v[68:71], v[36:39], v[112:115], v[68:71]
  buffer_load_dwordx4 v9, s[44:47], s52 offen offset:1024   lds
  v_mfma_f32_16x16x32_bf16 v[72:75], v[52:55], v[112:115], v[72:75]
  ds_read_b64_tr_b16 v[100:101], v67 offset:0
  ds_read_b64_tr_b16 v[102:103], v67 offset:1024
  ds_read_b64_tr_b16 v[104:105], v67 offset:4096
  ds_read_b64_tr_b16 v[106:107], v67 offset:5120
  ds_read_b64_tr_b16 v[108:109], v67 offset:8192
  ds_read_b64_tr_b16 v[110:111], v67 offset:9216
  ds_read_b64_tr_b16 v[112:113], v67 offset:12288
  ds_read_b64_tr_b16 v[114:115], v67 offset:13312
  s_waitcnt lgkmcnt(15)
  v_mfma_f32_16x16x32_bf16 v[84:87], v[24:27], v[116:119], 0
  buffer_load_dwordx4 v10, s[44:47], s52 offen offset:2048   lds
  v_mfma_f32_16x16x32_bf16 v[88:91], v[40:43], v[116:119], 0
  s_waitcnt lgkmcnt(15)
  v_mfma_f32_16x16x32_bf16 v[84:87], v[28:31], v[120:123], v[84:87]
  v_mfma_f32_16x16x32_bf16 v[88:91], v[44:47], v[120:123], v[88:91]
  s_waitcnt lgkmcnt(15)
  v_mfma_f32_16x16x32_bf16 v[84:87], v[32:35], v[124:127], v[84:87]
  buffer_load_dwordx4 v11, s[44:47], s52 offen offset:3072   lds
  s_add_u32 s52, s52, 128
  s_and_b32 s52, s52, 0x7ff
  v_mfma_f32_16x16x32_bf16 v[88:91], v[48:51], v[124:127], v[88:91]
  s_waitcnt lgkmcnt(15)
  v_mfma_f32_16x16x32_bf16 v[84:87], v[36:39], v[128:131], v[84:87]
  v_mfma_f32_16x16x32_bf16 v[88:91], v[52:55], v[128:131], v[88:91]
  s_lshr_b32 s43, s3, 1
  s_add_u32 m0, s55, 32768
  s_nop 0
  buffer_load_dwordx4 v12, s[48:51], s52 offen offset:0   lds
  s_lshr_b32 s28, s39, 1
  s_lshl3_add_u32 s43, s43, s28
  s_and_b32 s28, s3, 1
  s_lshl1_add_u32 s43, s43, s28
  s_and_b32 s28, s39, 1
  s_lshl1_add_u32 s43, s43, s28
  s_lshl_b32 s28, s43, 8
  v_lshl_add_u32 v62, v1, 2, s28
  s_and_b32 s43, s43, 7
  s_lshl_b32 s43, s43, 2
  v_and_b32 v63, 31, v1
  v_xor_b32 v63, s43, v63
  v_lshl_add_u32 v63, v63, 2, s54
  buffer_load_dwordx4 v13, s[48:51], s52 offen offset:1024   lds
  v_mov_b32 v164, 0
  s_waitcnt vmcnt(14)
  ds_read_b32 v148, v63 offset:49152
  ds_read_b32 v149, v63 offset:49280
  ds_read_b32 v150, v63 offset:49408
  ds_read_b32 v151, v63 offset:49536
  ds_read_b32 v152, v63 offset:49664
  ds_read_b32 v153, v63 offset:49792
  ds_read_b32 v154, v63 offset:49920
  ds_read_b32 v155, v63 offset:50048
  ds_read_b32 v156, v63 offset:50176
  ds_read_b32 v157, v63 offset:50304
  ds_read_b32 v158, v63 offset:50432
  ds_read_b32 v159, v63 offset:50560
  buffer_load_dwordx4 v14, s[48:51], s52 offen offset:2048   lds
  ds_read_b32 v160, v63 offset:50688
  ds_read_b32 v161, v63 offset:50816
  ds_read_b32 v162, v63 offset:50944
  ds_read_b32 v163, v63 offset:51072
  s_waitcnt lgkmcnt(15)
  v_mfma_f32_16x16x32_bf16 v[76:79], v[24:27], v[132:135], 0
  v_mfma_f32_16x16x32_bf16 v[80:83], v[40:43], v[132:135], 0
  s_waitcnt lgkmcnt(15)
  v_mfma_f32_16x16x32_bf16 v[76:79], v[28:31], v[136:139], v[76:79]
  buffer_load_dwordx4 v15, s[48:51], s52 offen offset:3072   lds
  v_mfma_f32_16x16x32_bf16 v[80:83], v[44:47], v[136:139], v[80:83]
  s_waitcnt lgkmcnt(15)
  v_mfma_f32_16x16x32_bf16 v[76:79], v[32:35], v[140:143], v[76:79]
  v_mfma_f32_16x16x32_bf16 v[80:83], v[48:51], v[140:143], v[80:83]
  s_waitcnt lgkmcnt(15)
  v_mfma_f32_16x16x32_bf16 v[76:79], v[36:39], v[144:147], v[76:79]
  s_add_u32 m0, s54, 32768
  s_nop 0
  buffer_load_dwordx4 v8, s[44:47], s52 offen offset:0   lds
  v_mfma_f32_16x16x32_bf16 v[80:83], v[52:55], v[144:147], v[80:83]
  s_waitcnt lgkmcnt(15)
  v_mfma_f32_16x16x32_bf16 v[92:95], v[24:27], v[100:103], 0
  v_mfma_f32_16x16x32_bf16 v[96:99], v[40:43], v[100:103], 0
  s_waitcnt lgkmcnt(15)
  v_mfma_f32_16x16x32_bf16 v[92:95], v[28:31], v[104:107], v[92:95]
  buffer_load_dwordx4 v9, s[44:47], s52 offen offset:1024   lds
  v_mfma_f32_16x16x32_bf16 v[96:99], v[44:47], v[104:107], v[96:99]
  s_waitcnt lgkmcnt(15)
  v_mfma_f32_16x16x32_bf16 v[92:95], v[32:35], v[108:111], v[92:95]
  v_mfma_f32_16x16x32_bf16 v[96:99], v[48:51], v[108:111], v[96:99]
  s_waitcnt lgkmcnt(15)
  v_mfma_f32_16x16x32_bf16 v[92:95], v[36:39], v[112:115], v[92:95]
  buffer_load_dwordx4 v10, s[44:47], s52 offen offset:2048   lds
  v_mfma_f32_16x16x32_bf16 v[96:99], v[52:55], v[112:115], v[96:99]
  v_pk_add_f32 v[116:117], v[68:69], v[84:85]
  v_pk_add_f32 v[124:125], v[68:69], v[84:85] neg_lo:[0,1] neg_hi:[0,1]
  v_pk_add_f32 v[118:119], v[70:71], v[86:87]
  v_pk_add_f32 v[126:127], v[70:71], v[86:87] neg_lo:[0,1] neg_hi:[0,1]
  v_pk_add_f32 v[120:121], v[72:73], v[88:89]
  v_pk_add_f32 v[128:129], v[72:73], v[88:89] neg_lo:[0,1] neg_hi:[0,1]
  v_pk_add_f32 v[122:123], v[74:75], v[90:91]
  v_pk_add_f32 v[130:131], v[74:75], v[90:91] neg_lo:[0,1] neg_hi:[0,1]
  v_pk_add_f32 v[132:133], v[76:77], v[92:93]
  buffer_load_dwordx4 v11, s[44:47], s52 offen offset:3072   lds
  s_add_u32 s52, s52, 128
  s_and_b32 s52, s52, 0x7ff
  v_pk_add_f32 v[140:141], v[76:77], v[92:93] neg_lo:[0,1] neg_hi:[0,1]
  v_pk_add_f32 v[134:135], v[78:79], v[94:95]
  v_pk_add_f32 v[142:143], v[78:79], v[94:95] neg_lo:[0,1] neg_hi:[0,1]
  v_pk_add_f32 v[136:137], v[80:81], v[96:97]
  v_pk_add_f32 v[144:145], v[80:81], v[96:97] neg_lo:[0,1] neg_hi:[0,1]
  v_pk_add_f32 v[138:139], v[82:83], v[98:99]
  v_pk_add_f32 v[146:147], v[82:83], v[98:99] neg_lo:[0,1] neg_hi:[0,1]
  v_pk_add_f32 v[68:69], v[116:117], v[132:133]
  v_pk_add_f32 v[84:85], v[116:117], v[132:133] neg_lo:[0,1] neg_hi:[0,1]
  v_pk_add_f32 v[72:73], v[120:121], v[136:137]
  v_pk_add_f32 v[88:89], v[120:121], v[136:137] neg_lo:[0,1] neg_hi:[0,1]
  v_pk_add_f32 v[76:77], v[124:125], v[144:145]
  v_pk_add_f32 v[80:81], v[128:129], v[140:141] neg_lo:[0,1] neg_hi:[0,1]
  s_add_u32 m0, s55, 49152
  s_nop 0
  buffer_load_dwordx4 v12, s[48:51], s52 offen offset:0   lds
  v_pk_add_f32 v[92:93], v[124:125], v[144:145] neg_lo:[0,1] neg_hi:[0,1]
  v_pk_add_f32 v[96:97], v[128:129], v[140:141]
  v_pk_add_f32 v[70:71], v[118:119], v[134:135]
  v_pk_add_f32 v[86:87], v[118:119], v[134:135] neg_lo:[0,1] neg_hi:[0,1]
  v_pk_add_f32 v[74:75], v[122:123], v[138:139]
  v_pk_add_f32 v[90:91], v[122:123], v[138:139] neg_lo:[0,1] neg_hi:[0,1]
  v_pk_add_f32 v[78:79], v[126:127], v[146:147]
  v_pk_add_f32 v[82:83], v[130:131], v[142:143] neg_lo:[0,1] neg_hi:[0,1]
  v_pk_add_f32 v[94:95], v[126:127], v[146:147] neg_lo:[0,1] neg_hi:[0,1]
  v_pk_add_f32 v[98:99], v[130:131], v[142:143]
  v_cmp_gt_u32 vcc, 16, v0
  s_nop 1
  v_cndmask_b32 v76, v76, v124, vcc
  v_cndmask_b32 v80, v80, -v140, vcc
  buffer_load_dwordx4 v13, s[48:51], s52 offen offset:1024   lds
  v_cndmask_b32 v92, v92, v128, vcc
  v_cndmask_b32 v96, v96, -v144, vcc
  v_cvt_pk_bf16_f32 v100, v68, v72
  v_cvt_pk_bf16_f32 v101, v76, v80
  v_cvt_pk_bf16_f32 v102, v84, v88
  v_cvt_pk_bf16_f32 v103, v92, v96
  v_cvt_pk_bf16_f32 v104, v69, v73
  v_cvt_pk_bf16_f32 v105, v77, v81
  v_cvt_pk_bf16_f32 v106, v85, v89
  v_cvt_pk_bf16_f32 v107, v93, v97
  v_cvt_pk_bf16_f32 v108, v70, v74
  v_cvt_pk_bf16_f32 v109, v78, v82
  v_cvt_pk_bf16_f32 v110, v86, v90
  buffer_load_dwordx4 v14, s[48:51], s52 offen offset:2048   lds
  v_cvt_pk_bf16_f32 v111, v94, v98
  v_cvt_pk_bf16_f32 v112, v71, v75
  v_cvt_pk_bf16_f32 v113, v79, v83
  v_cvt_pk_bf16_f32 v114, v87, v91
  v_cvt_pk_bf16_f32 v115, v95, v99
  v_and_b32 v100, -2, v100
  v_and_b32 v101, -2, v101
  v_and_b32 v102, -2, v102
  v_and_b32 v103, -2, v103
  v_and_b32 v104, -2, v104
  v_and_b32 v105, -2, v105
  v_and_b32 v106, -2, v106
  v_and_b32 v107, -2, v107
  buffer_load_dwordx4 v15, s[48:51], s52 offen offset:3072   lds
  v_and_b32 v108, -2, v108
  v_and_b32 v109, -2, v109
  v_and_b32 v110, -2, v110
  v_and_b32 v111, -2, v111
  v_and_b32 v112, -2, v112
  v_and_b32 v113, -2, v113
  v_and_b32 v114, -2, v114
  v_and_b32 v115, -2, v115
  s_mov_b32 s43, 262144
  v_mul_lo_u32 v5, v3, s43
  v_lshl_add_u32 v5, v2, 2, v5
  s_mul_i32 s43, s3, 1048576
  s_lshl_b32 s28, s40, 10
  s_waitcnt lgkmcnt(0)
  s_add_u32 m0, s54, 49152
  s_nop 0
  buffer_load_dwordx4 v8, s[44:47], s52 offen offset:0   lds
  s_add_u32 s43, s43, s28
  s_lshl_b32 s28, s41, 6
  s_add_u32 s43, s43, s28
  s_lshr_b32 s28, s41, 3
  s_lshl_b32 s28, s28, 13
  s_add_u32 s28, s28, 131072
  v_lshl_add_u32 v39, v2, 7, s28
  v_lshl_add_u32 v39, v3, 3, v39
  v_bfe_u32 v59, v2, 1, 2
  v_xor_b32 v59, s3, v59
  v_lshl_add_u32 v39, v59, 5, v39
  v_xor_b32 v38, 8192, v39
  ds_read_b64 v[166:167], v38 offset:0
  buffer_load_dwordx4 v9, s[44:47], s52 offen offset:1024   lds
  ds_read_b64 v[24:25], v38 offset:2048
  ds_read_b64 v[26:27], v38 offset:4096
  ds_read_b64 v[28:29], v38 offset:6144
  ds_read_b64 v[30:31], v39 offset:0
  ds_read_b64 v[32:33], v39 offset:2048
  ds_read_b64 v[34:35], v39 offset:4096
  ds_read_b64 v[36:37], v39 offset:6144
  buffer_load_dwordx4 v10, s[44:47], s52 offen offset:2048   lds
  buffer_load_dwordx4 v11, s[44:47], s52 offen offset:3072   lds
  s_add_u32 s52, s52, 128
  s_and_b32 s52, s52, 0x7ff
  s_barrier
  ds_read_b128 v[96:99], v16 offset:0
  ds_read_b128 v[136:139], v20 offset:0
  ds_read_b128 v[132:135], v16 offset:4096
  ds_read_b128 v[140:143], v20 offset:4096
  s_waitcnt lgkmcnt(2)
  v_mfma_f32_32x32x16_bf16 v[40:55], v[96:99], v[136:139], 0
  ds_read_b128 v[144:147], v17 offset:0
  ds_read_b128 v[172:175], v21 offset:0
  buffer_store_dword v100, v5, s[12:15], s43 offen sc1
  s_add_u32 s43, s43, 16384
  buffer_store_dword v101, v5, s[12:15], s43 offen sc1
  s_waitcnt lgkmcnt(2)
  v_mfma_f32_32x32x16_bf16 v[64:79], v[96:99], v[140:143], 0
  ds_read_b128 v[168:171], v17 offset:4096
  ds_read_b128 v[176:179], v21 offset:4096
  s_add_u32 s43, s43, 16384
  buffer_store_dword v102, v5, s[12:15], s43 offen sc1
  ds_read_b32 v63, v62 offset:0
  v_mfma_f32_32x32x16_bf16 v[116:131], v[132:135], v[140:143], 0
  s_add_u32 s43, s43, 16384
  buffer_store_dword v103, v5, s[12:15], s43 offen sc1
  v_mfma_f32_32x32x16_bf16 v[80:95], v[132:135], v[136:139], 0
  s_add_u32 s43, s43, 16384
  buffer_store_dword v104, v5, s[12:15], s43 offen sc1
  s_waitcnt lgkmcnt(3)
  v_mfma_f32_32x32x16_bf16 v[40:55], v[144:147], v[172:175], v[40:55]
  ds_read_b128 v[96:99], v18 offset:0
  ds_read_b128 v[136:139], v22 offset:0
  s_add_u32 s43, s43, 16384
  buffer_store_dword v105, v5, s[12:15], s43 offen sc1
  s_waitcnt lgkmcnt(3)
  v_mfma_f32_32x32x16_bf16 v[64:79], v[144:147], v[176:179], v[64:79]
  ds_read_b128 v[132:135], v18 offset:4096
  ds_read_b128 v[140:143], v22 offset:4096
  s_add_u32 s43, s43, 16384
  buffer_store_dword v106, v5, s[12:15], s43 offen sc1
  v_mfma_f32_32x32x16_bf16 v[116:131], v[168:171], v[176:179], v[116:131]
  s_add_u32 s43, s43, 16384
  buffer_store_dword v107, v5, s[12:15], s43 offen sc1
  v_mfma_f32_32x32x16_bf16 v[80:95], v[168:171], v[172:175], v[80:95]
  s_add_u32 s43, s43, 16384
  buffer_store_dword v108, v5, s[12:15], s43 offen sc1
  s_waitcnt lgkmcnt(2)
  v_mfma_f32_32x32x16_bf16 v[40:55], v[96:99], v[136:139], v[40:55]
  ds_read_b128 v[144:147], v19 offset:0
  ds_read_b128 v[172:175], v23 offset:0
  s_add_u32 s43, s43, 16384
  buffer_store_dword v109, v5, s[12:15], s43 offen sc1
  s_add_u32 s43, s43, 16384
  s_waitcnt lgkmcnt(2)
  v_mfma_f32_32x32x16_bf16 v[64:79], v[96:99], v[140:143], v[64:79]
  ds_read_b128 v[168:171], v19 offset:4096
  ds_read_b128 v[176:179], v23 offset:4096
  buffer_store_dword v110, v5, s[12:15], s43 offen sc1
  s_add_u32 s43, s43, 16384
  v_mfma_f32_32x32x16_bf16 v[116:131], v[132:135], v[140:143], v[116:131]
  buffer_store_dword v111, v5, s[12:15], s43 offen sc1
  s_add_u32 s43, s43, 16384
  v_dot2c_f32_bf16 v164, v63, v148
  v_mfma_f32_32x32x16_bf16 v[80:95], v[132:135], v[136:139], v[80:95]
  buffer_store_dword v112, v5, s[12:15], s43 offen sc1
  s_add_u32 s43, s43, 16384
  s_waitcnt vmcnt(29) lgkmcnt(0)
  s_barrier
  v_mfma_f32_32x32x16_bf16 v[40:55], v[144:147], v[172:175], v[40:55]
  ds_read_b128 v[96:99], v16 offset:16384
  ds_read_b128 v[136:139], v20 offset:16384
  buffer_store_dword v113, v5, s[12:15], s43 offen sc1
  s_add_u32 s43, s43, 16384
  v_mfma_f32_32x32x16_bf16 v[64:79], v[144:147], v[176:179], v[64:79]
  ds_read_b128 v[132:135], v16 offset:20480
  ds_read_b128 v[140:143], v20 offset:20480
  buffer_store_dword v114, v5, s[12:15], s43 offen sc1
  s_add_u32 s43, s43, 16384
  v_mfma_f32_32x32x16_bf16 v[116:131], v[168:171], v[176:179], v[116:131]
  s_add_u32 m0, s55, 0
  s_nop 0
  buffer_load_dwordx4 v12, s[48:51], s52 offen offset:0   lds
  buffer_store_dword v115, v5, s[12:15], s43 offen sc1
  s_mov_b32 s24, s32
  v_mfma_f32_32x32x16_bf16 v[80:95], v[168:171], v[172:175], v[80:95]
  buffer_load_dwordx4 v13, s[48:51], s52 offen offset:1024   lds
  s_mov_b32 s25, s33
  s_mov_b32 s26, 256
  s_waitcnt lgkmcnt(2)
  v_mfma_f32_32x32x16_bf16 v[40:55], v[96:99], v[136:139], v[40:55]
  ds_read_b128 v[144:147], v17 offset:16384
  ds_read_b128 v[172:175], v21 offset:16384
  s_mov_b32 s27, 0x20000
  s_and_b32 s57, s2, 7
  s_lshl_b32 s57, s57, 8
  s_add_u32 s57, s57, s2
  s_and_b32 s57, s57, -8
  s_lshl_b32 s57, s57, 1
  s_waitcnt lgkmcnt(2)
  v_mfma_f32_32x32x16_bf16 v[64:79], v[96:99], v[140:143], v[64:79]
  ds_read_b128 v[168:171], v17 offset:20480
  ds_read_b128 v[176:179], v21 offset:20480
  v_mov_b32 v59, s57
  s_lshl4_add_u32 s57, s39, s38
  s_lshl_b32 s57, s57, 7
  v_lshl_add_u32 v38, v2, 2, s57
  s_mov_b32 s57, 8192
  ds_read_b32 v63, v62 offset:16384
  v_mfma_f32_32x32x16_bf16 v[116:131], v[132:135], v[140:143], v[116:131]
  buffer_load_dwordx4 v14, s[48:51], s52 offen offset:2048   lds
  v_mov_b32 v5, 1
  s_lshl_b32 s43, s39, 14
  s_add_u32 s62, s43, 19988480
  s_add_u32 s60, s34, s62
  s_addc_u32 s61, s35, 0
  s_mov_b32 s62, 8192
  v_mfma_f32_32x32x16_bf16 v[80:95], v[132:135], v[136:139], v[80:95]
  buffer_load_dwordx4 v15, s[48:51], s52 offen offset:3072   lds
  s_mov_b32 s63, 0x20000
  s_sub_u32 s43, 15, s38
  s_lshl_b32 s43, s43, 9
  v_lshl_add_u32 v100, v0, 2, s43
  v_mov_b32 v101, -1
  s_waitcnt lgkmcnt(3)
  v_mfma_f32_32x32x16_bf16 v[40:55], v[144:147], v[172:175], v[40:55]
  ds_read_b128 v[96:99], v18 offset:16384
  ds_read_b128 v[136:139], v22 offset:16384
  s_cmp_ge_u32 s3, 2
  s_cbranch_scc1 gated_mix__spectral_gfnet__ssm_conv_s5__prompt_kernel_skip10
  buffer_store_dword v101, v100, s[60:63], 0 offen sc1
gated_mix__spectral_gfnet__ssm_conv_s5__prompt_kernel_skip10:
  s_cmp_lg_u32 s3, 0
  s_cbranch_scc1 gated_mix__spectral_gfnet__ssm_conv_s5__prompt_kernel_skip11
  s_mov_b64 exec, 65535
  buffer_store_dword v6, v38, s[16:19], s57 offen sc1
  s_mov_b64 exec, -1
gated_mix__spectral_gfnet__ssm_conv_s5__prompt_kernel_skip11:
  s_waitcnt lgkmcnt(3)
  v_mfma_f32_32x32x16_bf16 v[64:79], v[144:147], v[176:179], v[64:79]
  ds_read_b128 v[132:135], v18 offset:20480
  ds_read_b128 v[140:143], v22 offset:20480
  s_or_b32 s43, s3, s2
  v_mfma_f32_32x32x16_bf16 v[116:131], v[168:171], v[176:179], v[116:131]
  s_add_u32 m0, s54, 0
  s_nop 0
  buffer_load_dwordx4 v8, s[44:47], s52 offen offset:0   lds
  s_cmp_lg_u32 s43, 0
  s_cbranch_scc1 gated_mix__spectral_gfnet__ssm_conv_s5__prompt_kernel_skip12
  s_mov_b64 exec, 1
  buffer_store_dword v5, v6, s[24:27], 0 offen sc1
  s_mov_b64 exec, -1
gated_mix__spectral_gfnet__ssm_conv_s5__prompt_kernel_skip12:
  v_mfma_f32_32x32x16_bf16 v[80:95], v[168:171], v[172:175], v[80:95]
  buffer_load_dwordx4 v9, s[44:47], s52 offen offset:1024   lds
  s_mov_b32 s64, s20
  s_mov_b32 s65, s21
  s_mov_b32 s66, 2097152
  s_mov_b32 s67, 0x20000
  s_mov_b32 s68, s22
  s_waitcnt lgkmcnt(2)
  v_mfma_f32_32x32x16_bf16 v[40:55], v[96:99], v[136:139], v[40:55]
  ds_read_b128 v[144:147], v19 offset:16384
  ds_read_b128 v[172:175], v23 offset:16384
  s_mov_b32 s69, s23
  s_mov_b32 s70, 2097152
  s_mov_b32 s71, 0x20000
  v_and_b32 v108, 7, v1
  v_xor_b32 v108, v108, v3
  s_waitcnt lgkmcnt(2)
  v_mfma_f32_32x32x16_bf16 v[64:79], v[96:99], v[140:143], v[64:79]
  ds_read_b128 v[168:171], v19 offset:20480
  ds_read_b128 v[176:179], v23 offset:20480
  v_and_b32 v109, 4, v108
  v_lshlrev_b32 v100, 4, v109
  v_and_b32 v109, 1, v108
  v_lshl_or_b32 v100, v109, 5, v100
  v_and_b32 v109, 2, v108
  v_lshl_or_b32 v100, v109, 3, v100
  v_mfma_f32_32x32x16_bf16 v[116:131], v[132:135], v[140:143], v[116:131]
  buffer_load_dwordx4 v10, s[44:47], s52 offen offset:2048   lds
  v_lshrrev_b32 v109, 3, v1
  v_lshl_or_b32 v100, v109, 11, v100
  s_lshl4_add_u32 s29, s3, s41
  s_lshl_b32 s29, s29, 15
  s_lshr_b32 s43, s41, 3
  v_dot2c_f32_bf16 v164, v63, v149
  v_mfma_f32_32x32x16_bf16 v[80:95], v[132:135], v[136:139], v[80:95]
  buffer_load_dwordx4 v11, s[44:47], s52 offen offset:3072   lds
  s_add_u32 s52, s52, 128
  s_and_b32 s52, s52, 0x7ff
  s_lshl_b32 s43, s43, 10
  s_add_u32 s29, s29, s43
  v_add_u32 v100, s29, v100
  v_xor_b32 v102, 262144, v100
  v_xor_b32 v101, 64, v100
  v_xor_b32 v103, 64, v102
  s_waitcnt vmcnt(32) lgkmcnt(0)
  s_barrier
  v_mfma_f32_32x32x16_bf16 v[40:55], v[144:147], v[172:175], v[40:55]
  ds_read_b128 v[96:99], v16 offset:32768
  ds_read_b128 v[136:139], v20 offset:32768
  v_add_u32 v101, 15360, v101
  v_add_u32 v103, 15360, v103
  s_and_b32 s43, s40, 7
  s_lshl_b32 s43, s43, 7
  s_lshl_b32 s28, s3, 12
  v_mfma_f32_32x32x16_bf16 v[64:79], v[144:147], v[176:179], v[64:79]
  ds_read_b128 v[132:135], v16 offset:36864
  ds_read_b128 v[140:143], v20 offset:36864
  v_lshrrev_b32 v108, 1, v2
  v_xor_b32 v108, v108, v3
  v_lshlrev_b32 v108, 4, v108
  v_lshl_or_b32 v108, v2, 7, v108
  v_add_u32 v104, s28, v108
  v_xor_b32 v105, 64, v104
  v_mfma_f32_32x32x16_bf16 v[116:131], v[168:171], v[176:179], v[116:131]
  s_add_u32 m0, s55, 16384
  s_nop 0
  buffer_load_dwordx4 v12, s[48:51], s52 offen offset:0   lds
  v_add_u32 v106, 0x10000, v104
  v_add_u32 v107, 0x10000, v105
  s_mov_b32 s20, s6
  s_mov_b32 s21, s7
  s_mov_b32 s22, 2101248
  v_mfma_f32_32x32x16_bf16 v[80:95], v[168:171], v[172:175], v[80:95]
  buffer_load_dwordx4 v13, s[48:51], s52 offen offset:1024   lds
  s_mov_b32 s23, 0x20000
  s_sub_u32 s72, s8, 1024
  s_subb_u32 s73, s9, 0
  s_mov_b32 s74, 2102272
  s_mov_b32 s75, 0x20000
  s_waitcnt lgkmcnt(2)
  v_mfma_f32_32x32x16_bf16 v[40:55], v[96:99], v[136:139], v[40:55]
  ds_read_b128 v[144:147], v17 offset:32768
  ds_read_b128 v[172:175], v21 offset:32768
  s_waitcnt lgkmcnt(2)
  v_mfma_f32_32x32x16_bf16 v[64:79], v[96:99], v[140:143], v[64:79]
  ds_read_b128 v[168:171], v17 offset:36864
  ds_read_b128 v[176:179], v21 offset:36864
  ds_read_b32 v63, v62 offset:32768
  v_mfma_f32_32x32x16_bf16 v[116:131], v[132:135], v[140:143], v[116:131]
  buffer_load_dwordx4 v14, s[48:51], s52 offen offset:2048   lds
  v_mfma_f32_32x32x16_bf16 v[80:95], v[132:135], v[136:139], v[80:95]
  buffer_load_dwordx4 v15, s[48:51], s52 offen offset:3072   lds
  s_waitcnt lgkmcnt(3)
  v_mfma_f32_32x32x16_bf16 v[40:55], v[144:147], v[172:175], v[40:55]
  ds_read_b128 v[96:99], v18 offset:32768
  ds_read_b128 v[136:139], v22 offset:32768
  s_waitcnt lgkmcnt(3)
  v_mfma_f32_32x32x16_bf16 v[64:79], v[144:147], v[176:179], v[64:79]
  ds_read_b128 v[132:135], v18 offset:36864
  ds_read_b128 v[140:143], v22 offset:36864
  v_mfma_f32_32x32x16_bf16 v[116:131], v[168:171], v[176:179], v[116:131]
  s_add_u32 m0, s54, 16384
  s_nop 0
  buffer_load_dwordx4 v8, s[44:47], s52 offen offset:0   lds
  v_mfma_f32_32x32x16_bf16 v[80:95], v[168:171], v[172:175], v[80:95]
  buffer_load_dwordx4 v9, s[44:47], s52 offen offset:1024   lds
  s_waitcnt lgkmcnt(2)
  v_mfma_f32_32x32x16_bf16 v[40:55], v[96:99], v[136:139], v[40:55]
  ds_read_b128 v[144:147], v19 offset:32768
  ds_read_b128 v[172:175], v23 offset:32768
  s_waitcnt lgkmcnt(2)
  v_mfma_f32_32x32x16_bf16 v[64:79], v[96:99], v[140:143], v[64:79]
  ds_read_b128 v[168:171], v19 offset:36864
  ds_read_b128 v[176:179], v23 offset:36864
  v_mfma_f32_32x32x16_bf16 v[116:131], v[132:135], v[140:143], v[116:131]
  buffer_load_dwordx4 v10, s[44:47], s52 offen offset:2048   lds
  v_dot2c_f32_bf16 v164, v63, v150
  v_mfma_f32_32x32x16_bf16 v[80:95], v[132:135], v[136:139], v[80:95]
  buffer_load_dwordx4 v11, s[44:47], s52 offen offset:3072   lds
  s_add_u32 s52, s52, 128
  s_and_b32 s52, s52, 0x7ff
  s_waitcnt vmcnt(32) lgkmcnt(0)
  s_barrier
  v_mfma_f32_32x32x16_bf16 v[40:55], v[144:147], v[172:175], v[40:55]
  ds_read_b128 v[96:99], v16 offset:49152
  ds_read_b128 v[136:139], v20 offset:49152
  v_mfma_f32_32x32x16_bf16 v[64:79], v[144:147], v[176:179], v[64:79]
  ds_read_b128 v[132:135], v16 offset:53248
  ds_read_b128 v[140:143], v20 offset:53248
  v_mfma_f32_32x32x16_bf16 v[116:131], v[168:171], v[176:179], v[116:131]
  s_add_u32 m0, s55, 32768
  s_nop 0
  buffer_load_dwordx4 v12, s[48:51], s52 offen offset:0   lds
  v_mfma_f32_32x32x16_bf16 v[80:95], v[168:171], v[172:175], v[80:95]
  buffer_load_dwordx4 v13, s[48:51], s52 offen offset:1024   lds
  s_waitcnt lgkmcnt(2)
  v_mfma_f32_32x32x16_bf16 v[40:55], v[96:99], v[136:139], v[40:55]
  ds_read_b128 v[144:147], v17 offset:49152
  ds_read_b128 v[172:175], v21 offset:49152
  s_add_u32 s76, s34, 19922944
  s_addc_u32 s77, s35, 0
  s_waitcnt lgkmcnt(2)
  v_mfma_f32_32x32x16_bf16 v[64:79], v[96:99], v[140:143], v[64:79]
  ds_read_b128 v[168:171], v17 offset:53248
  ds_read_b128 v[176:179], v21 offset:53248
  ds_read_b32 v63, v62 offset:49152
  v_mfma_f32_32x32x16_bf16 v[116:131], v[132:135], v[140:143], v[116:131]
  buffer_load_dwordx4 v14, s[48:51], s52 offen offset:2048   lds
  v_mfma_f32_32x32x16_bf16 v[80:95], v[132:135], v[136:139], v[80:95]
  buffer_load_dwordx4 v15, s[48:51], s52 offen offset:3072   lds
  s_waitcnt lgkmcnt(3)
  v_mfma_f32_32x32x16_bf16 v[40:55], v[144:147], v[172:175], v[40:55]
  ds_read_b128 v[96:99], v18 offset:49152
  ds_read_b128 v[136:139], v22 offset:49152
  s_waitcnt lgkmcnt(3)
  v_mfma_f32_32x32x16_bf16 v[64:79], v[144:147], v[176:179], v[64:79]
  ds_read_b128 v[132:135], v18 offset:53248
  ds_read_b128 v[140:143], v22 offset:53248
  v_mfma_f32_32x32x16_bf16 v[116:131], v[168:171], v[176:179], v[116:131]
  s_add_u32 m0, s54, 32768
  s_nop 0
  buffer_load_dwordx4 v8, s[44:47], s52 offen offset:0   lds
  v_mfma_f32_32x32x16_bf16 v[80:95], v[168:171], v[172:175], v[80:95]
  buffer_load_dwordx4 v9, s[44:47], s52 offen offset:1024   lds
  s_waitcnt lgkmcnt(2)
  v_mfma_f32_32x32x16_bf16 v[40:55], v[96:99], v[136:139], v[40:55]
  ds_read_b128 v[144:147], v19 offset:49152
  ds_read_b128 v[172:175], v23 offset:49152
  s_waitcnt lgkmcnt(2)
  v_mfma_f32_32x32x16_bf16 v[64:79], v[96:99], v[140:143], v[64:79]
  ds_read_b128 v[168:171], v19 offset:53248
  ds_read_b128 v[176:179], v23 offset:53248
  v_mfma_f32_32x32x16_bf16 v[116:131], v[132:135], v[140:143], v[116:131]
  buffer_load_dwordx4 v10, s[44:47], s52 offen offset:2048   lds
  v_dot2c_f32_bf16 v164, v63, v151
  v_mfma_f32_32x32x16_bf16 v[80:95], v[132:135], v[136:139], v[80:95]
  buffer_load_dwordx4 v11, s[44:47], s52 offen offset:3072   lds
  s_add_u32 s52, s52, 128
  s_and_b32 s52, s52, 0x7ff
  s_waitcnt vmcnt(16) lgkmcnt(0)
  s_barrier
  v_mfma_f32_32x32x16_bf16 v[40:55], v[144:147], v[172:175], v[40:55]
  ds_read_b128 v[96:99], v16 offset:0
  ds_read_b128 v[136:139], v20 offset:0
  v_mfma_f32_32x32x16_bf16 v[64:79], v[144:147], v[176:179], v[64:79]
  ds_read_b128 v[132:135], v16 offset:4096
  ds_read_b128 v[140:143], v20 offset:4096
  v_mfma_f32_32x32x16_bf16 v[116:131], v[168:171], v[176:179], v[116:131]
  s_add_u32 m0, s55, 49152
  s_nop 0
  buffer_load_dwordx4 v12, s[48:51], s52 offen offset:0   lds
  v_mfma_f32_32x32x16_bf16 v[80:95], v[168:171], v[172:175], v[80:95]
  buffer_load_dwordx4 v13, s[48:51], s52 offen offset:1024   lds
  s_waitcnt lgkmcnt(2)
  v_mfma_f32_32x32x16_bf16 v[40:55], v[96:99], v[136:139], v[40:55]
  ds_read_b128 v[144:147], v17 offset:0
  ds_read_b128 v[172:175], v21 offset:0
  s_mov_b32 s78, 32768
  s_waitcnt lgkmcnt(2)
  v_mfma_f32_32x32x16_bf16 v[64:79], v[96:99], v[140:143], v[64:79]
  ds_read_b128 v[168:171], v17 offset:4096
  ds_read_b128 v[176:179], v21 offset:4096
  ds_read_b32 v63, v62 offset:0
  v_mfma_f32_32x32x16_bf16 v[116:131], v[132:135], v[140:143], v[116:131]
  buffer_load_dwordx4 v14, s[48:51], s52 offen offset:2048   lds
  v_mfma_f32_32x32x16_bf16 v[80:95], v[132:135], v[136:139], v[80:95]
  buffer_load_dwordx4 v15, s[48:51], s52 offen offset:3072   lds
  s_waitcnt lgkmcnt(3)
  v_mfma_f32_32x32x16_bf16 v[40:55], v[144:147], v[172:175], v[40:55]
  ds_read_b128 v[96:99], v18 offset:0
  ds_read_b128 v[136:139], v22 offset:0
  s_waitcnt lgkmcnt(3)
  v_mfma_f32_32x32x16_bf16 v[64:79], v[144:147], v[176:179], v[64:79]
  ds_read_b128 v[132:135], v18 offset:4096
  ds_read_b128 v[140:143], v22 offset:4096
  v_mfma_f32_32x32x16_bf16 v[116:131], v[168:171], v[176:179], v[116:131]
  s_add_u32 m0, s54, 49152
  s_nop 0
  buffer_load_dwordx4 v8, s[44:47], s52 offen offset:0   lds
  v_mfma_f32_32x32x16_bf16 v[80:95], v[168:171], v[172:175], v[80:95]
  buffer_load_dwordx4 v9, s[44:47], s52 offen offset:1024   lds
  s_waitcnt lgkmcnt(2)
  v_mfma_f32_32x32x16_bf16 v[40:55], v[96:99], v[136:139], v[40:55]
  ds_read_b128 v[144:147], v19 offset:0
  ds_read_b128 v[172:175], v23 offset:0
  s_mov_b32 s79, 0x20000
  s_waitcnt lgkmcnt(2)
  v_mfma_f32_32x32x16_bf16 v[64:79], v[96:99], v[140:143], v[64:79]
  ds_read_b128 v[168:171], v19 offset:4096
  ds_read_b128 v[176:179], v23 offset:4096
  v_mfma_f32_32x32x16_bf16 v[116:131], v[132:135], v[140:143], v[116:131]
  buffer_load_dwordx4 v10, s[44:47], s52 offen offset:2048   lds
  v_dot2c_f32_bf16 v164, v63, v152
  v_mfma_f32_32x32x16_bf16 v[80:95], v[132:135], v[136:139], v[80:95]
  buffer_load_dwordx4 v11, s[44:47], s52 offen offset:3072   lds
  s_add_u32 s52, s52, 128
  s_and_b32 s52, s52, 0x7ff
  s_waitcnt vmcnt(16) lgkmcnt(0)
  s_barrier
  v_mfma_f32_32x32x16_bf16 v[40:55], v[144:147], v[172:175], v[40:55]
  ds_read_b128 v[96:99], v16 offset:16384
  ds_read_b128 v[136:139], v20 offset:16384
  v_mfma_f32_32x32x16_bf16 v[64:79], v[144:147], v[176:179], v[64:79]
  ds_read_b128 v[132:135], v16 offset:20480
  ds_read_b128 v[140:143], v20 offset:20480
  s_cmp_lg_u32 s3, 1
  s_cbranch_scc1 gated_mix__spectral_gfnet__ssm_conv_s5__prompt_kernel_skip15
  s_getpc_b64 s[94:95]
gated_mix__spectral_gfnet__ssm_conv_s5__prompt_kernel_pc14:
  s_lshr_b32 s93, s2, 3
  s_mul_i32 s93, s93, 512
  v_min_u32 v232, 3, v1
  v_lshl_add_u32 v232, v232, 7, s93
  v_min_u32 v232, gated_mix__spectral_gfnet__ssm_conv_s5__prompt_kernel_end-gated_mix__spectral_gfnet__ssm_conv_s5__prompt_kernel_pc14, v232
  v_mov_b32 v233, 0
  v_lshl_add_u64 v[232:233], v[232:233], 0, s[94:95]
  global_load_dword v4, v[232:233], off
gated_mix__spectral_gfnet__ssm_conv_s5__prompt_kernel_skip15:
  v_mfma_f32_32x32x16_bf16 v[116:131], v[168:171], v[176:179], v[116:131]
  s_add_u32 m0, s55, 0
  s_nop 0
  buffer_load_dwordx4 v12, s[48:51], s52 offen offset:0   lds
  v_mfma_f32_32x32x16_bf16 v[80:95], v[168:171], v[172:175], v[80:95]
  buffer_load_dwordx4 v13, s[48:51], s52 offen offset:1024   lds
  s_waitcnt lgkmcnt(2)
  v_mfma_f32_32x32x16_bf16 v[40:55], v[96:99], v[136:139], v[40:55]
  ds_read_b128 v[144:147], v17 offset:16384
  ds_read_b128 v[172:175], v21 offset:16384
  v_lshlrev_b32 v39, 4, v1
  v_add_u32 v39, 147456, v39
  s_waitcnt lgkmcnt(2)
  v_mfma_f32_32x32x16_bf16 v[64:79], v[96:99], v[140:143], v[64:79]
  ds_read_b128 v[168:171], v17 offset:20480
  ds_read_b128 v[176:179], v21 offset:20480
  ds_read_b128 v[108:111], v39 offset:0
  ds_read_b32 v63, v62 offset:16384
  v_mfma_f32_32x32x16_bf16 v[116:131], v[132:135], v[140:143], v[116:131]
  buffer_load_dwordx4 v14, s[48:51], s52 offen offset:2048   lds
  ds_read_b128 v[112:115], v39 offset:1024
  v_mfma_f32_32x32x16_bf16 v[80:95], v[132:135], v[136:139], v[80:95]
  buffer_load_dwordx4 v15, s[48:51], s52 offen offset:3072   lds
  ds_read_b128 a[224:227], v39 offset:2048
  s_waitcnt lgkmcnt(6)
  v_mfma_f32_32x32x16_bf16 v[40:55], v[144:147], v[172:175], v[40:55]
  ds_read_b128 v[96:99], v18 offset:16384
  ds_read_b128 v[136:139], v22 offset:16384
  ds_read_b128 a[228:231], v39 offset:3072
  s_waitcnt lgkmcnt(7)
  v_mfma_f32_32x32x16_bf16 v[64:79], v[144:147], v[176:179], v[64:79]
  ds_read_b128 v[132:135], v18 offset:20480
  ds_read_b128 v[140:143], v22 offset:20480
  ds_read_b128 a[248:251], v39 offset:4096
  v_mfma_f32_32x32x16_bf16 v[116:131], v[168:171], v[176:179], v[116:131]
  s_add_u32 m0, s54, 0
  s_nop 0
  buffer_load_dwordx4 v8, s[44:47], s52 offen offset:0   lds
  ds_read_b128 a[252:255], v39 offset:5120
  v_mfma_f32_32x32x16_bf16 v[80:95], v[168:171], v[172:175], v[80:95]
  buffer_load_dwordx4 v9, s[44:47], s52 offen offset:1024   lds
  ds_read_b128 a[232:235], v39 offset:6144
  s_waitcnt lgkmcnt(6)
  v_mfma_f32_32x32x16_bf16 v[40:55], v[96:99], v[136:139], v[40:55]
  ds_read_b128 v[144:147], v19 offset:16384
  ds_read_b128 v[172:175], v23 offset:16384
  ds_read_b128 a[236:239], v39 offset:7168
  s_waitcnt lgkmcnt(6)
  v_mfma_f32_32x32x16_bf16 v[64:79], v[96:99], v[140:143], v[64:79]
  ds_read_b128 v[168:171], v19 offset:20480
  ds_read_b128 v[176:179], v23 offset:20480
  ds_read_b128 v[180:183], v39 offset:8192
  v_mfma_f32_32x32x16_bf16 v[116:131], v[132:135], v[140:143], v[116:131]
  buffer_load_dwordx4 v10, s[44:47], s52 offen offset:2048   lds
  ds_read_b128 v[184:187], v39 offset:9216
  v_dot2c_f32_bf16 v164, v63, v153
  v_mfma_f32_32x32x16_bf16 v[80:95], v[132:135], v[136:139], v[80:95]
  buffer_load_dwordx4 v11, s[44:47], s52 offen offset:3072   lds
  s_add_u32 s52, s52, 128
  s_and_b32 s52, s52, 0x7ff
  ds_read_b128 v[188:191], v39 offset:10240
  s_waitcnt vmcnt(16) lgkmcnt(3)
  s_barrier
  v_mfma_f32_32x32x16_bf16 v[40:55], v[144:147], v[172:175], v[40:55]
  ds_read_b128 v[96:99], v16 offset:32768
  ds_read_b128 v[136:139], v20 offset:32768
  ds_read_b128 v[192:195], v39 offset:11264
  v_mfma_f32_32x32x16_bf16 v[64:79], v[144:147], v[176:179], v[64:79]
  ds_read_b128 v[132:135], v16 offset:36864
  ds_read_b128 v[140:143], v20 offset:36864
  buffer_load_dword v230, v6, s[24:27], 0 offen sc1
  ds_read_b128 a[240:243], v39 offset:12288
  v_mfma_f32_32x32x16_bf16 v[116:131], v[168:171], v[176:179], v[116:131]
  s_add_u32 m0, s55, 16384
  s_nop 0
  buffer_load_dwordx4 v12, s[48:51], s52 offen offset:0   lds
  ds_read_b128 a[244:247], v39 offset:13312
  v_mfma_f32_32x32x16_bf16 v[80:95], v[168:171], v[172:175], v[80:95]
  buffer_load_dwordx4 v13, s[48:51], s52 offen offset:1024   lds
  ds_read_b128 v[196:199], v39 offset:14336
  s_waitcnt lgkmcnt(6)
  v_mfma_f32_32x32x16_bf16 v[40:55], v[96:99], v[136:139], v[40:55]
  ds_read_b128 v[144:147], v17 offset:32768
  ds_read_b128 v[172:175], v21 offset:32768
  ds_read_b128 v[200:203], v39 offset:15360
  s_lshl_b32 s29, s3, 9
  s_waitcnt lgkmcnt(6)
  v_mfma_f32_32x32x16_bf16 v[64:79], v[96:99], v[140:143], v[64:79]
  ds_read_b128 v[168:171], v17 offset:36864
  ds_read_b128 v[176:179], v21 offset:36864
  s_add_u32 s29, s29, s5
  ds_read_b32 v63, v62 offset:32768
  v_mfma_f32_32x32x16_bf16 v[116:131], v[132:135], v[140:143], v[116:131]
  buffer_load_dwordx4 v14, s[48:51], s52 offen offset:2048   lds
  s_lshr_b32 s81, s3, 1
  v_mfma_f32_32x32x16_bf16 v[80:95], v[132:135], v[136:139], v[80:95]
  buffer_load_dwordx4 v15, s[48:51], s52 offen offset:3072   lds
  s_and_b32 s81, s81, s10
  s_waitcnt lgkmcnt(4)
  v_mfma_f32_32x32x16_bf16 v[40:55], v[144:147], v[172:175], v[40:55]
  ds_read_b128 v[96:99], v18 offset:32768
  ds_read_b128 v[136:139], v22 offset:32768
  s_mul_i32 s81, s81, 960
  s_waitcnt lgkmcnt(3)
  v_mfma_f32_32x32x16_bf16 v[64:79], v[144:147], v[176:179], v[64:79]
  ds_read_b128 v[132:135], v18 offset:36864
  ds_read_b128 v[140:143], v22 offset:36864
  s_sub_u32 s81, s29, s81
  v_mfma_f32_32x32x16_bf16 v[116:131], v[168:171], v[176:179], v[116:131]
  s_add_u32 m0, s54, 16384
  s_nop 0
  buffer_load_dwordx4 v8, s[44:47], s52 offen offset:0   lds
  s_mul_i32 s29, s81, 1026
  v_mfma_f32_32x32x16_bf16 v[80:95], v[168:171], v[172:175], v[80:95]
  buffer_load_dwordx4 v9, s[44:47], s52 offen offset:1024   lds
  s_lshl1_add_u32 s29, s4, s29
  s_waitcnt lgkmcnt(2)
  v_mfma_f32_32x32x16_bf16 v[40:55], v[96:99], v[136:139], v[40:55]
  ds_read_b128 v[144:147], v19 offset:32768
  ds_read_b128 v[172:175], v23 offset:32768
  s_sub_u32 s6, 2101256, s29
  s_waitcnt lgkmcnt(2)
  v_mfma_f32_32x32x16_bf16 v[64:79], v[96:99], v[140:143], v[64:79]
  ds_read_b128 v[168:171], v19 offset:36864
  ds_read_b128 v[176:179], v23 offset:36864
  s_and_b32 s82, s29, 2
  v_mfma_f32_32x32x16_bf16 v[116:131], v[132:135], v[140:143], v[116:131]
  buffer_load_dwordx4 v10, s[44:47], s52 offen offset:2048   lds
  s_and_b32 s29, s29, -4
  v_dot2c_f32_bf16 v164, v63, v154
  v_mfma_f32_32x32x16_bf16 v[80:95], v[132:135], v[136:139], v[80:95]
  buffer_load_dwordx4 v11, s[44:47], s52 offen offset:3072   lds
  s_add_u32 s52, s52, 128
  s_and_b32 s52, s52, 0x7ff
  s_and_b32 s6, s6, -4
  s_waitcnt vmcnt(17) lgkmcnt(0)
  s_barrier
  v_mfma_f32_32x32x16_bf16 v[40:55], v[144:147], v[172:175], v[40:55]
  ds_read_b128 v[96:99], v16 offset:49152
  ds_read_b128 v[136:139], v20 offset:49152
  s_add_u32 s7, s29, 131328
  v_mfma_f32_32x32x16_bf16 v[64:79], v[144:147], v[176:179], v[64:79]
  ds_read_b128 v[132:135], v16 offset:53248
  ds_read_b128 v[140:143], v20 offset:53248
  s_sub_u32 s8, s6, 131328
  v_mfma_f32_32x32x16_bf16 v[116:131], v[168:171], v[176:179], v[116:131]
  s_add_u32 m0, s55, 32768
  s_nop 0
  buffer_load_dwordx4 v12, s[48:51], s52 offen offset:0   lds
  s_add_u32 s9, s29, 262656
  v_mfma_f32_32x32x16_bf16 v[80:95], v[168:171], v[172:175], v[80:95]
  buffer_load_dwordx4 v13, s[48:51], s52 offen offset:1024   lds
  s_sub_u32 s32, s6, 262656
  s_waitcnt lgkmcnt(2)
  v_mfma_f32_32x32x16_bf16 v[40:55], v[96:99], v[136:139], v[40:55]
  ds_read_b128 v[144:147], v17 offset:49152
  ds_read_b128 v[172:175], v21 offset:49152
  s_add_u32 s33, s29, 393984
  s_sub_u32 s58, s6, 393984
  s_waitcnt lgkmcnt(2)
  v_mfma_f32_32x32x16_bf16 v[64:79], v[96:99], v[140:143], v[64:79]
  ds_read_b128 v[168:171], v17 offset:53248
  ds_read_b128 v[176:179], v21 offset:53248
  s_cmp_eq_u32 s81, 0
  s_cselect_b32 s81, 2101248, 0
  s_cselect_b32 s80, s10, 0
  ds_read_b32 v63, v62 offset:49152
  v_mfma_f32_32x32x16_bf16 v[116:131], v[132:135], v[140:143], v[116:131]
  buffer_load_dwordx4 v14, s[48:51], s52 offen offset:2048   lds
  v_mfma_f32_32x32x16_bf16 v[80:95], v[132:135], v[136:139], v[80:95]
  buffer_load_dwordx4 v15, s[48:51], s52 offen offset:3072   lds
  s_waitcnt lgkmcnt(3)
  v_mfma_f32_32x32x16_bf16 v[40:55], v[144:147], v[172:175], v[40:55]
  ds_read_b128 v[96:99], v18 offset:49152
  ds_read_b128 v[136:139], v22 offset:49152
  s_sub_u32 s6, s6, s81
  s_waitcnt lgkmcnt(3)
  v_mfma_f32_32x32x16_bf16 v[64:79], v[144:147], v[176:179], v[64:79]
  ds_read_b128 v[132:135], v18 offset:53248
  ds_read_b128 v[140:143], v22 offset:53248
  s_lshl_b32 s59, s3, 12
  v_mfma_f32_32x32x16_bf16 v[116:131], v[168:171], v[176:179], v[116:131]
  s_add_u32 m0, s54, 32768
  s_nop 0
  buffer_load_dwordx4 v8, s[44:47], s52 offen offset:0   lds
  s_add_u32 s82, s82, s59
  v_mfma_f32_32x32x16_bf16 v[80:95], v[168:171], v[172:175], v[80:95]
  buffer_load_dwordx4 v9, s[44:47], s52 offen offset:1024   lds
  v_lshlrev_b32 v39, 4, v1
  s_waitcnt lgkmcnt(2)
  v_mfma_f32_32x32x16_bf16 v[40:55], v[96:99], v[136:139], v[40:55]
  ds_read_b128 v[144:147], v19 offset:49152
  ds_read_b128 v[172:175], v23 offset:49152
  v_lshlrev_b32 v204, 9, v3
  s_waitcnt lgkmcnt(2)
  v_mfma_f32_32x32x16_bf16 v[64:79], v[96:99], v[140:143], v[64:79]
  ds_read_b128 v[168:171], v19 offset:53248
  ds_read_b128 v[176:179], v23 offset:53248
  v_lshl_add_u32 v204, v2, 3, v204
  v_mfma_f32_32x32x16_bf16 v[116:131], v[132:135], v[140:143], v[116:131]
  buffer_load_dwordx4 v10, s[44:47], s52 offen offset:2048   lds
  v_sub_u32 v207, 3704, v204
  v_dot2c_f32_bf16 v164, v63, v155
  v_mfma_f32_32x32x16_bf16 v[80:95], v[132:135], v[136:139], v[80:95]
  buffer_load_dwordx4 v11, s[44:47], s52 offen offset:3072   lds
  s_add_u32 s52, s52, 128
  s_and_b32 s52, s52, 0x7ff
  v_cmp_lt_u32 vcc, 1, v3
  s_waitcnt vmcnt(17) lgkmcnt(0)
  s_barrier
  v_mfma_f32_32x32x16_bf16 v[40:55], v[144:147], v[172:175], v[40:55]
  ds_read_b128 v[96:99], v16 offset:0
  ds_read_b128 v[136:139], v20 offset:0
  v_cndmask_b32 v204, v204, v207, vcc
  v_mfma_f32_32x32x16_bf16 v[64:79], v[144:147], v[176:179], v[64:79]
  ds_read_b128 v[132:135], v16 offset:4096
  ds_read_b128 v[140:143], v20 offset:4096
  v_cndmask_b32 v206, 1.0, -1.0, vcc
  v_mfma_f32_32x32x16_bf16 v[116:131], v[168:171], v[176:179], v[116:131]
  s_add_u32 m0, s55, 49152
  s_nop 0
  buffer_load_dwordx4 v12, s[48:51], s52 offen offset:0   lds
  v_add_u32 v204, s82, v204
  v_mfma_f32_32x32x16_bf16 v[80:95], v[168:171], v[172:175], v[80:95]
  buffer_load_dwordx4 v13, s[48:51], s52 offen offset:1024   lds
  v_mov_b32 v205, 1050624
  s_waitcnt lgkmcnt(2)
  v_mfma_f32_32x32x16_bf16 v[40:55], v[96:99], v[136:139], v[40:55]
  ds_read_b128 v[144:147], v17 offset:0
  ds_read_b128 v[172:175], v21 offset:0
  v_mov_b32 v208, 147456
  s_cmp_lg_u32 s4, 0
  s_cbranch_scc1 gated_mix__spectral_gfnet__ssm_conv_s5__prompt_kernel_skip13
  s_sub_u32 s81, s6, 8
  v_writelane_b32 v205, s81, 0
  v_writelane_b32 v205, s29, 1
  s_mov_b32 s81, 0
  v_writelane_b32 v208, s81, 0
  v_writelane_b32 v208, s81, 1
  s_sub_u32 s81, s8, 8
  v_writelane_b32 v205, s81, 2
  v_writelane_b32 v205, s7, 3
  s_mov_b32 s81, 16384
  v_writelane_b32 v208, s81, 2
  v_writelane_b32 v208, s81, 3
  s_sub_u32 s81, s32, 8
  v_writelane_b32 v205, s81, 4
  v_writelane_b32 v205, s9, 5
  s_mov_b32 s81, 81920
  v_writelane_b32 v208, s81, 4
  v_writelane_b32 v208, s81, 5
  s_sub_u32 s81, s58, 8
  v_writelane_b32 v205, s81, 6
  v_writelane_b32 v205, s33, 7
  s_mov_b32 s81, 32768
  v_writelane_b32 v208, s81, 6
  v_writelane_b32 v208, s81, 7
  v_and_b32 v207, 1, v1
  v_lshl_add_u32 v205, v207, 10, v205
  s_and_b32 s81, s82, 2
  v_add_u32 v205, s81, v205
  v_mul_u32_u24 v207, 3064, v207
  v_add3_u32 v208, v208, v207, s82
gated_mix__spectral_gfnet__ssm_conv_s5__prompt_kernel_skip13:
  s_waitcnt lgkmcnt(2)
  v_mfma_f32_32x32x16_bf16 v[64:79], v[96:99], v[140:143], v[64:79]
  ds_read_b128 v[168:171], v17 offset:4096
  ds_read_b128 v[176:179], v21 offset:4096
  ds_read_b32 v63, v62 offset:0
  v_mfma_f32_32x32x16_bf16 v[116:131], v[132:135], v[140:143], v[116:131]
  buffer_load_dwordx4 v14, s[48:51], s52 offen offset:2048   lds
  v_mfma_f32_32x32x16_bf16 v[80:95], v[132:135], v[136:139], v[80:95]
  buffer_load_dwordx4 v15, s[48:51], s52 offen offset:3072   lds
  s_waitcnt lgkmcnt(3)
  v_mfma_f32_32x32x16_bf16 v[40:55], v[144:147], v[172:175], v[40:55]
  ds_read_b128 v[96:99], v18 offset:0
  ds_read_b128 v[136:139], v22 offset:0
  s_waitcnt lgkmcnt(3)
  v_mfma_f32_32x32x16_bf16 v[64:79], v[144:147], v[176:179], v[64:79]
  ds_read_b128 v[132:135], v18 offset:4096
  ds_read_b128 v[140:143], v22 offset:4096
  v_mfma_f32_32x32x16_bf16 v[116:131], v[168:171], v[176:179], v[116:131]
  s_add_u32 m0, s54, 49152
  s_nop 0
  buffer_load_dwordx4 v8, s[44:47], s52 offen offset:0   lds
  v_mfma_f32_32x32x16_bf16 v[80:95], v[168:171], v[172:175], v[80:95]
  buffer_load_dwordx4 v9, s[44:47], s52 offen offset:1024   lds
  s_waitcnt lgkmcnt(2)
  v_mfma_f32_32x32x16_bf16 v[40:55], v[96:99], v[136:139], v[40:55]
  ds_read_b128 v[144:147], v19 offset:0
  ds_read_b128 v[172:175], v23 offset:0
  s_waitcnt lgkmcnt(2)
  v_mfma_f32_32x32x16_bf16 v[64:79], v[96:99], v[140:143], v[64:79]
  ds_read_b128 v[168:171], v19 offset:4096
  ds_read_b128 v[176:179], v23 offset:4096
  v_mfma_f32_32x32x16_bf16 v[116:131], v[132:135], v[140:143], v[116:131]
  buffer_load_dwordx4 v10, s[44:47], s52 offen offset:2048   lds
  v_dot2c_f32_bf16 v164, v63, v156
  v_mfma_f32_32x32x16_bf16 v[80:95], v[132:135], v[136:139], v[80:95]
  buffer_load_dwordx4 v11, s[44:47], s52 offen offset:3072   lds
  s_add_u32 s52, s52, 128
  s_and_b32 s52, s52, 0x7ff
  s_waitcnt vmcnt(16) lgkmcnt(0)
  s_barrier
  v_mfma_f32_32x32x16_bf16 v[40:55], v[144:147], v[172:175], v[40:55]
  ds_read_b128 v[96:99], v16 offset:16384
  ds_read_b128 v[136:139], v20 offset:16384
  v_mfma_f32_32x32x16_bf16 v[64:79], v[144:147], v[176:179], v[64:79]
  ds_read_b128 v[132:135], v16 offset:20480
  ds_read_b128 v[140:143], v20 offset:20480
  v_cmp_ne_u32 vcc, 1, v230
  s_nop 0
  s_cbranch_vccz gated_mix__spectral_gfnet__ssm_conv_s5__prompt_kernel_skip16
  s_mov_b32 s93, 0
gated_mix__spectral_gfnet__ssm_conv_s5__prompt_kernel_poll17:
  s_sleep 16
  buffer_load_dword v230, v6, s[24:27], 0 offen sc1
  s_waitcnt vmcnt(0)
  v_cmp_ne_u32 vcc, 1, v230
  s_nop 0
  s_cbranch_vccz gated_mix__spectral_gfnet__ssm_conv_s5__prompt_kernel_pollout18
  s_add_u32 s93, s93, 1
  s_cmp_lt_u32 s93, 1048576
  s_cbranch_scc1 gated_mix__spectral_gfnet__ssm_conv_s5__prompt_kernel_poll17
gated_mix__spectral_gfnet__ssm_conv_s5__prompt_kernel_pollout18:
gated_mix__spectral_gfnet__ssm_conv_s5__prompt_kernel_skip16:
  s_cmp_lg_u32 s3, 0
  s_cbranch_scc1 gated_mix__spectral_gfnet__ssm_conv_s5__prompt_kernel_skip19
  s_mov_b64 exec, 1
  buffer_store_dword v5, v59, s[16:19], 0 offen sc1
  s_mov_b64 exec, -1
gated_mix__spectral_gfnet__ssm_conv_s5__prompt_kernel_skip19:
  v_mfma_f32_32x32x16_bf16 v[116:131], v[168:171], v[176:179], v[116:131]
  s_add_u32 m0, s55, 0
  s_nop 0
  buffer_load_dwordx4 v12, s[48:51], s52 offen offset:0   lds
  v_mfma_f32_32x32x16_bf16 v[80:95], v[168:171], v[172:175], v[80:95]
  buffer_load_dwordx4 v13, s[48:51], s52 offen offset:1024   lds
  s_waitcnt lgkmcnt(2)
  v_mfma_f32_32x32x16_bf16 v[40:55], v[96:99], v[136:139], v[40:55]
  ds_read_b128 v[144:147], v17 offset:16384
  ds_read_b128 v[172:175], v21 offset:16384
  s_waitcnt lgkmcnt(2)
  v_mfma_f32_32x32x16_bf16 v[64:79], v[96:99], v[140:143], v[64:79]
  ds_read_b128 v[168:171], v17 offset:20480
  ds_read_b128 v[176:179], v21 offset:20480
  ds_read_b32 v63, v62 offset:16384
  v_mfma_f32_32x32x16_bf16 v[116:131], v[132:135], v[140:143], v[116:131]
  buffer_load_dwordx4 v14, s[48:51], s52 offen offset:2048   lds
  v_mfma_f32_32x32x16_bf16 v[80:95], v[132:135], v[136:139], v[80:95]
  buffer_load_dwordx4 v15, s[48:51], s52 offen offset:3072   lds
  s_waitcnt lgkmcnt(3)
  v_mfma_f32_32x32x16_bf16 v[40:55], v[144:147], v[172:175], v[40:55]
  ds_read_b128 v[96:99], v18 offset:16384
  ds_read_b128 v[136:139], v22 offset:16384
  s_waitcnt lgkmcnt(3)
  v_mfma_f32_32x32x16_bf16 v[64:79], v[144:147], v[176:179], v[64:79]
  ds_read_b128 v[132:135], v18 offset:20480
  ds_read_b128 v[140:143], v22 offset:20480
  v_mfma_f32_32x32x16_bf16 v[116:131], v[168:171], v[176:179], v[116:131]
  s_add_u32 m0, s54, 0
  s_nop 0
  buffer_load_dwordx4 v8, s[44:47], s52 offen offset:0   lds
  v_mfma_f32_32x32x16_bf16 v[80:95], v[168:171], v[172:175], v[80:95]
  buffer_load_dwordx4 v9, s[44:47], s52 offen offset:1024   lds
  s_waitcnt lgkmcnt(2)
  v_mfma_f32_32x32x16_bf16 v[40:55], v[96:99], v[136:139], v[40:55]
  ds_read_b128 v[144:147], v19 offset:16384
  ds_read_b128 v[172:175], v23 offset:16384
  s_waitcnt lgkmcnt(2)
  v_mfma_f32_32x32x16_bf16 v[64:79], v[96:99], v[140:143], v[64:79]
  ds_read_b128 v[168:171], v19 offset:20480
  ds_read_b128 v[176:179], v23 offset:20480
  v_mfma_f32_32x32x16_bf16 v[116:131], v[132:135], v[140:143], v[116:131]
  buffer_load_dwordx4 v10, s[44:47], s52 offen offset:2048   lds
  v_dot2c_f32_bf16 v164, v63, v157
  v_mfma_f32_32x32x16_bf16 v[80:95], v[132:135], v[136:139], v[80:95]
  buffer_load_dwordx4 v11, s[44:47], s52 offen offset:3072   lds
  s_add_u32 s52, s52, 128
  s_and_b32 s52, s52, 0x7ff
  s_waitcnt vmcnt(16) lgkmcnt(0)
  s_barrier
  v_mfma_f32_32x32x16_bf16 v[40:55], v[144:147], v[172:175], v[40:55]
  ds_read_b128 v[96:99], v16 offset:32768
  ds_read_b128 v[136:139], v20 offset:32768
  v_mfma_f32_32x32x16_bf16 v[64:79], v[144:147], v[176:179], v[64:79]
  ds_read_b128 v[132:135], v16 offset:36864
  ds_read_b128 v[140:143], v20 offset:36864
  v_mfma_f32_32x32x16_bf16 v[116:131], v[168:171], v[176:179], v[116:131]
  s_add_u32 m0, s55, 16384
  s_nop 0
  buffer_load_dwordx4 v12, s[48:51], s52 offen offset:0   lds
  v_mfma_f32_32x32x16_bf16 v[80:95], v[168:171], v[172:175], v[80:95]
  buffer_load_dwordx4 v13, s[48:51], s52 offen offset:1024   lds
  s_waitcnt lgkmcnt(2)
  v_mfma_f32_32x32x16_bf16 v[40:55], v[96:99], v[136:139], v[40:55]
  ds_read_b128 v[144:147], v17 offset:32768
  ds_read_b128 v[172:175], v21 offset:32768
  v_lshlrev_b32 v56, 16, v56
  v_lshlrev_b32 v57, 16, v57
  s_waitcnt lgkmcnt(2)
  v_mfma_f32_32x32x16_bf16 v[64:79], v[96:99], v[140:143], v[64:79]
  ds_read_b128 v[168:171], v17 offset:36864
  ds_read_b128 v[176:179], v21 offset:36864
  v_lshlrev_b32 v58, 16, v58
  v_mul_f32 v58, 0x3fb8aa3b, v58
  ds_read_b32 v63, v62 offset:32768
  v_mfma_f32_32x32x16_bf16 v[116:131], v[132:135], v[140:143], v[116:131]
  buffer_load_dwordx4 v14, s[48:51], s52 offen offset:2048   lds
  v_exp_f32 v58, v58
  s_nop 0
  v_cvt_pk_bf16_f32 v58, v58, v58
  v_mfma_f32_32x32x16_bf16 v[80:95], v[132:135], v[136:139], v[80:95]
  buffer_load_dwordx4 v15, s[48:51], s52 offen offset:3072   lds
  v_and_b32 v58, 0xffff0000, v58
  s_waitcnt lgkmcnt(3)
  v_mfma_f32_32x32x16_bf16 v[40:55], v[144:147], v[172:175], v[40:55]
  ds_read_b128 v[96:99], v18 offset:32768
  ds_read_b128 v[136:139], v22 offset:32768
  v_mul_f32 v224, v58, v56
  v_mul_f32 v225, v58, v57
  s_waitcnt lgkmcnt(3)
  v_mfma_f32_32x32x16_bf16 v[64:79], v[144:147], v[176:179], v[64:79]
  ds_read_b128 v[132:135], v18 offset:36864
  ds_read_b128 v[140:143], v22 offset:36864
  v_mul_f32 v224, 0x3fb8aa3b, v224
  v_mul_f32 v225, 0.15915494, v225
  v_mfma_f32_32x32x16_bf16 v[116:131], v[168:171], v[176:179], v[116:131]
  s_add_u32 m0, s54, 16384
  s_nop 0
  buffer_load_dwordx4 v8, s[44:47], s52 offen offset:0   lds
  v_exp_f32 v224, v224
  v_rndne_f32 v226, v225
  v_mfma_f32_32x32x16_bf16 v[80:95], v[168:171], v[172:175], v[80:95]
  buffer_load_dwordx4 v9, s[44:47], s52 offen offset:1024   lds
  v_sub_f32 v225, v225, v226
  s_waitcnt lgkmcnt(2)
  v_mfma_f32_32x32x16_bf16 v[40:55], v[96:99], v[136:139], v[40:55]
  ds_read_b128 v[144:147], v19 offset:32768
  ds_read_b128 v[172:175], v23 offset:32768
  v_cos_f32 v226, v225
  v_sin_f32 v227, v225
  s_waitcnt lgkmcnt(2)
  v_mfma_f32_32x32x16_bf16 v[64:79], v[96:99], v[140:143], v[64:79]
  ds_read_b128 v[168:171], v19 offset:36864
  ds_read_b128 v[176:179], v23 offset:36864
  v_mul_f32 v210, v224, v226
  v_mul_f32 v211, v224, v227
  v_mfma_f32_32x32x16_bf16 v[116:131], v[132:135], v[140:143], v[116:131]
  buffer_load_dwordx4 v10, s[44:47], s52 offen offset:2048   lds
  v_mul_f32 v224, v56, v56
  v_fma_f32 v224, v57, v57, v224
  v_dot2c_f32_bf16 v164, v63, v158
  v_mfma_f32_32x32x16_bf16 v[80:95], v[132:135], v[136:139], v[80:95]
  buffer_load_dwordx4 v11, s[44:47], s52 offen offset:3072   lds
  s_add_u32 s52, s52, 128
  s_and_b32 s52, s52, 0x7ff
  v_rcp_f32 v224, v224
  s_waitcnt vmcnt(16) lgkmcnt(0)
  s_barrier
  v_mfma_f32_32x32x16_bf16 v[40:55], v[144:147], v[172:175], v[40:55]
  ds_read_b128 v[96:99], v16 offset:49152
  ds_read_b128 v[136:139], v20 offset:49152
  v_add_f32 v225, -1.0, v210
  v_add_f32 v224, v224, v224
  v_mfma_f32_32x32x16_bf16 v[64:79], v[144:147], v[176:179], v[64:79]
  ds_read_b128 v[132:135], v16 offset:53248
  ds_read_b128 v[140:143], v20 offset:53248
  s_lshl_b32 s93, s36, 2
  s_add_u32 s93, s93, s3
  s_lshl_b32 s93, s93, 7
  s_add_u32 s93, s93, s37
  s_sub_u32 s94, 2048, s93
  s_and_b32 s94, s94, 2047
  s_mul_i32 s93, s93, 1026
  s_mul_i32 s94, s94, 1026
  s_sub_u32 s94, s94, s93
  v_and_b32 v232, 1, v3
  v_mul_lo_u32 v232, v232, s94
  v_lshl_add_u32 v230, v2, 7, s93
  v_add_u32 v230, v230, v232
  v_and_b32 v230, -4, v230
  s_mov_b64 exec, 0x01ff01ff
  buffer_load_dword v4, v230, s[20:23], 0 offen
  buffer_load_dword v4, v230, s[72:75], 0 offen offset:1024
  s_mov_b64 exec, -1
  v_mul_f32 v226, v225, v56
  v_fma_f32 v226, v211, v57, v226
  v_mfma_f32_32x32x16_bf16 v[116:131], v[168:171], v[176:179], v[116:131]
  s_add_u32 m0, s55, 32768
  s_nop 0
  buffer_load_dwordx4 v12, s[48:51], s52 offen offset:0   lds
  v_mul_f32 v227, v211, v56
  v_fma_f32 v227, -v225, v57, v227
  v_mfma_f32_32x32x16_bf16 v[80:95], v[168:171], v[172:175], v[80:95]
  buffer_load_dwordx4 v13, s[48:51], s52 offen offset:1024   lds
  v_mul_f32 v220, v226, v224
  s_waitcnt lgkmcnt(2)
  v_mfma_f32_32x32x16_bf16 v[40:55], v[96:99], v[136:139], v[40:55]
  ds_read_b128 v[144:147], v17 offset:49152
  ds_read_b128 v[172:175], v21 offset:49152
  v_mul_f32 v221, v227, v224
  v_mul_f32 v224, v211, v211
  s_waitcnt lgkmcnt(2)
  v_mfma_f32_32x32x16_bf16 v[64:79], v[96:99], v[140:143], v[64:79]
  ds_read_b128 v[168:171], v17 offset:53248
  ds_read_b128 v[176:179], v21 offset:53248
  v_mul_f32 v213, v210, v211
  v_fma_f32 v212, v210, v210, -v224
  ds_read_b32 v63, v62 offset:49152
  v_mfma_f32_32x32x16_bf16 v[116:131], v[132:135], v[140:143], v[116:131]
  buffer_load_dwordx4 v14, s[48:51], s52 offen offset:2048   lds
  v_add_f32 v213, v213, v213
  v_mul_f32 v224, v213, v213
  v_mfma_f32_32x32x16_bf16 v[80:95], v[132:135], v[136:139], v[80:95]
  buffer_load_dwordx4 v15, s[48:51], s52 offen offset:3072   lds
  v_mul_f32 v213, v212, v213
  s_waitcnt lgkmcnt(3)
  v_mfma_f32_32x32x16_bf16 v[40:55], v[144:147], v[172:175], v[40:55]
  ds_read_b128 v[96:99], v18 offset:49152
  ds_read_b128 v[136:139], v22 offset:49152
  v_fma_f32 v212, v212, v212, -v224
  v_add_f32 v213, v213, v213
  s_waitcnt lgkmcnt(3)
  v_mfma_f32_32x32x16_bf16 v[64:79], v[144:147], v[176:179], v[64:79]
  ds_read_b128 v[132:135], v18 offset:53248
  ds_read_b128 v[140:143], v22 offset:53248
  v_mul_f32 v224, v213, v213
  v_mul_f32 v213, v212, v213
  v_mfma_f32_32x32x16_bf16 v[116:131], v[168:171], v[176:179], v[116:131]
  s_add_u32 m0, s54, 32768
  s_nop 0
  buffer_load_dwordx4 v8, s[44:47], s52 offen offset:0   lds
  v_fma_f32 v212, v212, v212, -v224
  v_mfma_f32_32x32x16_bf16 v[80:95], v[168:171], v[172:175], v[80:95]
  buffer_load_dwordx4 v9, s[44:47], s52 offen offset:1024   lds
  v_add_f32 v213, v213, v213
  v_mul_f32 v224, v213, v213
  s_waitcnt lgkmcnt(2)
  v_mfma_f32_32x32x16_bf16 v[40:55], v[96:99], v[136:139], v[40:55]
  ds_read_b128 v[144:147], v19 offset:49152
  ds_read_b128 v[172:175], v23 offset:49152
  v_mul_f32 v213, v212, v213
  v_fma_f32 v212, v212, v212, -v224
  s_waitcnt lgkmcnt(2)
  v_mfma_f32_32x32x16_bf16 v[64:79], v[96:99], v[140:143], v[64:79]
  ds_read_b128 v[168:171], v19 offset:53248
  ds_read_b128 v[176:179], v23 offset:53248
  v_add_f32 v213, v213, v213
  v_mul_f32 v224, v213, v213
  v_mfma_f32_32x32x16_bf16 v[116:131], v[132:135], v[140:143], v[116:131]
  buffer_load_dwordx4 v10, s[44:47], s52 offen offset:2048   lds
  v_mul_f32 v215, v212, v213
  v_dot2c_f32_bf16 v164, v63, v159
  v_mfma_f32_32x32x16_bf16 v[80:95], v[132:135], v[136:139], v[80:95]
  buffer_load_dwordx4 v11, s[44:47], s52 offen offset:3072   lds
  s_add_u32 s52, s52, 128
  s_and_b32 s52, s52, 0x7ff
  v_fma_f32 v214, v212, v212, -v224
  v_add_f32 v215, v215, v215
  s_waitcnt vmcnt(18) lgkmcnt(0)
  s_barrier
  v_mfma_f32_32x32x16_bf16 v[40:55], v[144:147], v[172:175], v[40:55]
  ds_read_b128 v[96:99], v16 offset:0
  ds_read_b128 v[136:139], v20 offset:0
  v_mul_f32 v224, v215, v215
  v_mul_f32 v217, v214, v215
  v_mfma_f32_32x32x16_bf16 v[64:79], v[144:147], v[176:179], v[64:79]
  ds_read_b128 v[132:135], v16 offset:4096
  ds_read_b128 v[140:143], v20 offset:4096
  s_cmp_lg_u32 s3, 2
  s_cbranch_scc1 gated_mix__spectral_gfnet__ssm_conv_s5__prompt_kernel_skip21
  s_getpc_b64 s[94:95]
gated_mix__spectral_gfnet__ssm_conv_s5__prompt_kernel_pc20:
  s_lshr_b32 s93, s2, 3
  s_mul_i32 s93, s93, 512
  v_min_u32 v232, 3, v1
  v_lshl_add_u32 v232, v232, 7, s93
  v_min_u32 v232, gated_mix__spectral_gfnet__ssm_conv_s5__prompt_kernel_end-gated_mix__spectral_gfnet__ssm_conv_s5__prompt_kernel_pc20, v232
  v_mov_b32 v233, 0
  v_lshl_add_u64 v[232:233], v[232:233], 0, s[94:95]
  global_load_dword v4, v[232:233], off
gated_mix__spectral_gfnet__ssm_conv_s5__prompt_kernel_skip21:
  v_fma_f32 v216, v214, v214, -v224
  v_add_f32 v217, v217, v217
  v_mfma_f32_32x32x16_bf16 v[116:131], v[168:171], v[176:179], v[116:131]
  s_add_u32 m0, s55, 49152
  s_nop 0
  buffer_load_dwordx4 v12, s[48:51], s52 offen offset:0   lds
  v_mul_f32 v224, v217, v217
  v_mfma_f32_32x32x16_bf16 v[80:95], v[168:171], v[172:175], v[80:95]
  buffer_load_dwordx4 v13, s[48:51], s52 offen offset:1024   lds
  v_mul_f32 v223, v216, v217
  v_fma_f32 v222, v216, v216, -v224
  s_waitcnt lgkmcnt(2)
  v_mfma_f32_32x32x16_bf16 v[40:55], v[96:99], v[136:139], v[40:55]
  ds_read_b128 v[144:147], v17 offset:0
  ds_read_b128 v[172:175], v21 offset:0
  v_add_f32 v223, v223, v223
  v_mul_f32 v224, v223, v223
  s_waitcnt lgkmcnt(2)
  v_mfma_f32_32x32x16_bf16 v[64:79], v[96:99], v[140:143], v[64:79]
  ds_read_b128 v[168:171], v17 offset:4096
  ds_read_b128 v[176:179], v21 offset:4096
  v_mul_f32 v219, v222, v223
  v_fma_f32 v218, v222, v222, -v224
  ds_read_b32 v63, v62 offset:0
  v_mfma_f32_32x32x16_bf16 v[116:131], v[132:135], v[140:143], v[116:131]
  buffer_load_dwordx4 v14, s[48:51], s52 offen offset:2048   lds
  v_add_f32 v219, v219, v219
  v_mfma_f32_32x32x16_bf16 v[80:95], v[132:135], v[136:139], v[80:95]
  buffer_load_dwordx4 v15, s[48:51], s52 offen offset:3072   lds
  v_mul_f32 v224, v219, v219
  v_mul_f32 v219, v218, v219
  s_waitcnt lgkmcnt(3)
  v_mfma_f32_32x32x16_bf16 v[40:55], v[144:147], v[172:175], v[40:55]
  ds_read_b128 v[96:99], v18 offset:0
  ds_read_b128 v[136:139], v22 offset:0
  v_fma_f32 v218, v218, v218, -v224
  v_add_f32 v219, v219, v219
  s_waitcnt lgkmcnt(3)
  v_mfma_f32_32x32x16_bf16 v[64:79], v[144:147], v[176:179], v[64:79]
  ds_read_b128 v[132:135], v18 offset:4096
  ds_read_b128 v[140:143], v22 offset:4096
  v_mul_f32 v224, v219, v219
  v_mul_f32 v219, v218, v219
  v_mfma_f32_32x32x16_bf16 v[116:131], v[168:171], v[176:179], v[116:131]
  s_add_u32 m0, s54, 49152
  s_nop 0
  buffer_load_dwordx4 v8, s[44:47], s52 offen offset:0   lds
  v_fma_f32 v218, v218, v218, -v224
  v_mfma_f32_32x32x16_bf16 v[80:95], v[168:171], v[172:175], v[80:95]
  buffer_load_dwordx4 v9, s[44:47], s52 offen offset:1024   lds
  v_add_f32 v219, v219, v219
  v_lshlrev_b32 v209, 3, v0
  s_waitcnt lgkmcnt(2)
  v_mfma_f32_32x32x16_bf16 v[40:55], v[96:99], v[136:139], v[40:55]
  ds_read_b128 v[144:147], v19 offset:0
  ds_read_b128 v[172:175], v23 offset:0
  v_add_u32 v209, 151552, v209
  s_sub_u32 s81, 15, s38
  s_waitcnt lgkmcnt(2)
  v_mfma_f32_32x32x16_bf16 v[64:79], v[96:99], v[140:143], v[64:79]
  ds_read_b128 v[168:171], v19 offset:4096
  ds_read_b128 v[176:179], v23 offset:4096
  s_lshl_b32 s81, s81, 9
  v_mfma_f32_32x32x16_bf16 v[116:131], v[132:135], v[140:143], v[116:131]
  buffer_load_dwordx4 v10, s[44:47], s52 offen offset:2048   lds
  s_and_b32 s82, s3, 1
  s_lshl_b32 s82, s82, 8
  v_dot2c_f32_bf16 v164, v63, v160
  v_mfma_f32_32x32x16_bf16 v[80:95], v[132:135], v[136:139], v[80:95]
  buffer_load_dwordx4 v11, s[44:47], s52 offen offset:3072   lds
  s_add_u32 s52, s52, 128
  s_and_b32 s52, s52, 0x7ff
  s_add_u32 s81, s81, s82
  v_and_b32 v56, 31, v1
  s_waitcnt vmcnt(18) lgkmcnt(0)
  s_barrier
  v_mfma_f32_32x32x16_bf16 v[40:55], v[144:147], v[172:175], v[40:55]
  ds_read_b128 v[96:99], v16 offset:16384
  ds_read_b128 v[136:139], v20 offset:16384
  v_lshl_add_u32 v56, v56, 3, s81
  s_lshl_b32 s82, s38, 1
  v_mfma_f32_32x32x16_bf16 v[64:79], v[144:147], v[176:179], v[64:79]
  ds_read_b128 v[132:135], v16 offset:20480
  ds_read_b128 v[140:143], v20 offset:20480
  s_lshr_b32 s83, s3, 1
  v_mfma_f32_32x32x16_bf16 v[116:131], v[168:171], v[176:179], v[116:131]
  buffer_load_dword v231, v7, s[16:19], 0 offen sc1
  s_cmp_eq_u32 s80, 0
  s_cbranch_scc1 gated_mix__spectral_gfnet__ssm_conv_s5__prompt_kernel_skip22
  s_add_u32 s93, s29, 1050624
  s_mov_b32 m0, 147456
  s_nop 0
  buffer_load_dwordx4 v39, s[20:23], s93 offen lds
  buffer_load_dwordx4 v39, s[72:75], s93 offen offset:1024 lds
  s_add_u32 s93, s6, 1050624
  s_mov_b32 m0, 149504
  s_nop 0
  buffer_load_dwordx4 v39, s[20:23], s93 offen lds
  buffer_load_dwordx4 v39, s[72:75], s93 offen offset:1024 lds
gated_mix__spectral_gfnet__ssm_conv_s5__prompt_kernel_skip22:
  s_cmp_lg_u32 s4, 0
  s_cbranch_scc1 gated_mix__spectral_gfnet__ssm_conv_s5__prompt_kernel_skip23
  s_mov_b64 exec, 0x3ff
  buffer_load_short_d16_hi v232, v205, s[20:23], 0 offen
  buffer_load_short_d16_hi v233, v205, s[72:75], 0 offen offset:1024
  s_mov_b64 exec, -1
gated_mix__spectral_gfnet__ssm_conv_s5__prompt_kernel_skip23:
  s_add_u32 s82, s82, s83
  s_lshl_b32 s81, s82, 9
  v_mfma_f32_32x32x16_bf16 v[80:95], v[168:171], v[172:175], v[80:95]
  s_add_u32 m0, s28, 131072
  s_nop 0
  buffer_load_dwordx4 v100, s[64:67], s43 offen offset:0 lds
  s_and_b32 s82, s82, 3
  s_lshl_b32 s82, s82, 2
  s_waitcnt lgkmcnt(2)
  v_mfma_f32_32x32x16_bf16 v[40:55], v[96:99], v[136:139], v[40:55]
  ds_read_b128 v[144:147], v17 offset:16384
  ds_read_b128 v[172:175], v21 offset:16384
  v_xor_b32 v57, s82, v2
  v_lshlrev_b32 v57, 4, v57
  s_waitcnt lgkmcnt(2)
  v_mfma_f32_32x32x16_bf16 v[64:79], v[96:99], v[140:143], v[64:79]
  ds_read_b128 v[168:171], v17 offset:20480
  ds_read_b128 v[176:179], v21 offset:20480
  v_lshrrev_b32 v58, 1, v3
  ds_read_b32 v63, v62 offset:16384
  v_mfma_f32_32x32x16_bf16 v[116:131], v[132:135], v[140:143], v[116:131]
  buffer_load_dwordx4 v101, s[64:67], s43 offen offset:1024 lds
  v_lshl_or_b32 v57, v58, 14, v57
  v_and_b32 v58, 1, v3
  v_mfma_f32_32x32x16_bf16 v[80:95], v[132:135], v[136:139], v[80:95]
  s_add_u32 m0, s28, 133120
  s_nop 0
  buffer_load_dwordx4 v102, s[64:67], s43 offen offset:0 lds
  v_lshl_or_b32 v57, v58, 19, v57
  s_and_b32 s83, s3, 1
  s_waitcnt lgkmcnt(3)
  v_mfma_f32_32x32x16_bf16 v[40:55], v[144:147], v[172:175], v[40:55]
  ds_read_b128 v[96:99], v18 offset:16384
  ds_read_b128 v[136:139], v22 offset:16384
  s_lshl_b32 s83, s83, 8
  s_add_u32 s81, s81, s83
  s_waitcnt lgkmcnt(3)
  v_mfma_f32_32x32x16_bf16 v[64:79], v[144:147], v[176:179], v[64:79]
  ds_read_b128 v[132:135], v18 offset:20480
  ds_read_b128 v[140:143], v22 offset:20480
  s_lshl_b32 s83, s39, 15
  v_mfma_f32_32x32x16_bf16 v[116:131], v[168:171], v[176:179], v[116:131]
  buffer_load_dwordx4 v103, s[64:67], s43 offen offset:1024 lds
  s_add_u32 s81, s81, s83
  v_and_b32 v224, 1, v2
  v_mfma_f32_32x32x16_bf16 v[80:95], v[168:171], v[172:175], v[80:95]
  s_add_u32 m0, s28, 65536
  s_nop 0
  buffer_load_dwordx4 v100, s[68:71], s43 offen offset:0 lds
  v_lshlrev_b32 v224, 4, v224
  v_xor_b32 v224, 16, v224
  s_waitcnt lgkmcnt(2)
  v_mfma_f32_32x32x16_bf16 v[40:55], v[96:99], v[136:139], v[40:55]
  ds_read_b128 v[144:147], v19 offset:16384
  ds_read_b128 v[172:175], v23 offset:16384
  v_lshrrev_b32 v224, v224, v60
  v_lshrrev_b32 v225, 1, v2
  s_waitcnt lgkmcnt(2)
  v_mfma_f32_32x32x16_bf16 v[64:79], v[96:99], v[140:143], v[64:79]
  ds_read_b128 v[168:171], v19 offset:20480
  ds_read_b128 v[176:179], v23 offset:20480
  v_lshlrev_b32 v61, 1, v3
  v_mfma_f32_32x32x16_bf16 v[116:131], v[132:135], v[140:143], v[116:131]
  buffer_load_dwordx4 v101, s[68:71], s43 offen offset:1024 lds
  v_sub_u32 v225, v225, v61
  v_cmp_eq_u32 vcc, 0, v225
  v_dot2c_f32_bf16 v164, v63, v161
  v_mfma_f32_32x32x16_bf16 v[80:95], v[132:135], v[136:139], v[80:95]
  s_add_u32 m0, s28, 67584
  s_nop 0
  buffer_load_dwordx4 v102, s[68:71], s43 offen offset:0 lds
  v_cndmask_b32 v60, 0, v224, vcc
  v_cmp_eq_u32 vcc, 1, v225
  s_waitcnt vmcnt(16) lgkmcnt(0)
  s_barrier
  v_mfma_f32_32x32x16_bf16 v[40:55], v[144:147], v[172:175], v[40:55]
  ds_read_b128 v[96:99], v16 offset:32768
  ds_read_b128 v[136:139], v20 offset:32768
  v_cndmask_b32 v61, 0, v224, vcc
  v_mfma_f32_32x32x16_bf16 v[64:79], v[144:147], v[176:179], v[64:79]
  ds_read_b128 v[132:135], v16 offset:36864
  ds_read_b128 v[140:143], v20 offset:36864
  s_add_u32 s84, s34, 10485760
  s_addc_u32 s85, s35, 0
  v_mfma_f32_32x32x16_bf16 v[116:131], v[168:171], v[176:179], v[116:131]
  buffer_load_dwordx4 v103, s[68:71], s43 offen offset:1024 lds
  s_add_u32 s43, s43, 128
  s_and_b32 s43, s43, 0x3ff
  s_mov_b32 s86, 8388608
  s_mov_b32 s87, 0x20000
  v_mfma_f32_32x32x16_bf16 v[80:95], v[168:171], v[172:175], v[80:95]
  s_add_u32 s88, s34, 5242880
  s_addc_u32 s89, s35, 0
  s_waitcnt lgkmcnt(2)
  v_mfma_f32_32x32x16_bf16 v[40:55], v[96:99], v[136:139], v[40:55]
  ds_read_b128 v[144:147], v17 offset:32768
  ds_read_b128 v[172:175], v21 offset:32768
  s_mov_b32 s90, 4194304
  s_waitcnt lgkmcnt(2)
  v_mfma_f32_32x32x16_bf16 v[64:79], v[96:99], v[140:143], v[64:79]
  ds_read_b128 v[168:171], v17 offset:36864
  ds_read_b128 v[176:179], v21 offset:36864
  s_mov_b32 s91, 0x20000
  s_lshr_b32 s92, s41, 3
  ds_read_b32 v63, v62 offset:32768
  v_mfma_f32_32x32x16_bf16 v[116:131], v[132:135], v[140:143], v[116:131]
  s_mul_i32 s83, s92, 253952
  s_lshl_b32 s82, s40, 19
  v_mfma_f32_32x32x16_bf16 v[80:95], v[132:135], v[136:139], v[80:95]
  s_add_u32 s83, s83, s82
  s_lshr_b32 s92, s3, 1
  s_waitcnt lgkmcnt(3)
  v_mfma_f32_32x32x16_bf16 v[40:55], v[144:147], v[172:175], v[40:55]
  ds_read_b128 v[96:99], v18 offset:32768
  ds_read_b128 v[136:139], v22 offset:32768
  s_lshl1_add_u32 s92, s92, s3
  s_waitcnt lgkmcnt(3)
  v_mfma_f32_32x32x16_bf16 v[64:79], v[144:147], v[176:179], v[64:79]
  ds_read_b128 v[132:135], v18 offset:36864
  ds_read_b128 v[140:143], v22 offset:36864
  s_add_u32 s92, s92, 2
  s_lshl_b32 s92, s92, 12
  v_mfma_f32_32x32x16_bf16 v[116:131], v[168:171], v[176:179], v[116:131]
  s_add_u32 s83, s83, s92
  v_lshl_add_u32 v58, v1, 4, s83
  v_mfma_f32_32x32x16_bf16 v[80:95], v[168:171], v[172:175], v[80:95]
  s_and_b32 s82, s40, 7
  s_lshl_b32 s82, s82, 15
  s_waitcnt lgkmcnt(2)
  v_mfma_f32_32x32x16_bf16 v[40:55], v[96:99], v[136:139], v[40:55]
  ds_read_b128 v[144:147], v19 offset:32768
  ds_read_b128 v[172:175], v23 offset:32768
  s_lshl_b32 s83, s3, 12
  s_waitcnt lgkmcnt(2)
  v_mfma_f32_32x32x16_bf16 v[64:79], v[96:99], v[140:143], v[64:79]
  ds_read_b128 v[168:171], v19 offset:36864
  ds_read_b128 v[176:179], v23 offset:36864
  v_and_b32 v228, 3, v1
  v_and_b32 v229, 2, v3
  v_mfma_f32_32x32x16_bf16 v[116:131], v[132:135], v[140:143], v[116:131]
  v_xor_b32 v229, v229, v228
  v_lshlrev_b32 v228, 9, v228
  v_dot2c_f32_bf16 v164, v63, v162
  v_mfma_f32_32x32x16_bf16 v[80:95], v[132:135], v[136:139], v[80:95]
  v_lshl_or_b32 v228, v229, 6, v228
  v_bfe_u32 v229, v1, 2, 2
  s_waitcnt vmcnt(9) lgkmcnt(0)
  s_barrier
  v_mfma_f32_32x32x16_bf16 v[40:55], v[144:147], v[172:175], v[40:55]
  ds_read_b128 v[96:99], v16 offset:49152
  ds_read_b128 v[136:139], v20 offset:49152
  v_lshl_or_b32 v228, v229, 4, v228
  v_mfma_f32_32x32x16_bf16 v[64:79], v[144:147], v[176:179], v[64:79]
  ds_read_b128 v[132:135], v16 offset:53248
  ds_read_b128 v[140:143], v20 offset:53248
  v_and_b32 v229, 1, v3
  v_lshl_or_b32 v224, v229, 3, v228
  v_mfma_f32_32x32x16_bf16 v[116:131], v[168:171], v[176:179], v[116:131]
  s_add_u32 m0, s59, 0
  s_nop 0
  buffer_load_dwordx4 v39, s[20:23], s29 offen offset:0 lds
  v_xor_b32 v225, 64, v224
  v_add_u32 v226, 0x10000, v224
  v_mfma_f32_32x32x16_bf16 v[80:95], v[168:171], v[172:175], v[80:95]
  buffer_load_dwordx4 v39, s[72:75], s29 offen offset:1024 lds
  v_add_u32 v227, 0x10000, v225
  s_waitcnt lgkmcnt(2)
  v_mfma_f32_32x32x16_bf16 v[40:55], v[96:99], v[136:139], v[40:55]
  ds_read_b128 v[144:147], v17 offset:49152
  ds_read_b128 v[172:175], v21 offset:49152
  s_waitcnt lgkmcnt(2)
  v_mfma_f32_32x32x16_bf16 v[64:79], v[96:99], v[140:143], v[64:79]
  ds_read_b128 v[168:171], v17 offset:53248
  ds_read_b128 v[176:179], v21 offset:53248
  s_add_u32 m0, s59, 2048
  s_nop 0
  buffer_load_dwordx4 v39, s[20:23], s6 offen offset:0 lds
  ds_read_b32 v63, v62 offset:49152
  v_mfma_f32_32x32x16_bf16 v[116:131], v[132:135], v[140:143], v[116:131]
  buffer_load_dwordx4 v39, s[72:75], s6 offen offset:1024 lds
  v_mfma_f32_32x32x16_bf16 v[80:95], v[132:135], v[136:139], v[80:95]
  s_add_u32 m0, s59, 16384
  s_nop 0
  buffer_load_dwordx4 v39, s[20:23], s7 offen offset:0 lds
  s_waitcnt lgkmcnt(3)
  v_mfma_f32_32x32x16_bf16 v[40:55], v[144:147], v[172:175], v[40:55]
  ds_read_b128 v[96:99], v18 offset:49152
  ds_read_b128 v[136:139], v22 offset:49152
  s_waitcnt lgkmcnt(3)
  v_mfma_f32_32x32x16_bf16 v[64:79], v[144:147], v[176:179], v[64:79]
  ds_read_b128 v[132:135], v18 offset:53248
  ds_read_b128 v[140:143], v22 offset:53248
  buffer_load_dwordx4 v39, s[72:75], s7 offen offset:1024 lds
  v_mfma_f32_32x32x16_bf16 v[116:131], v[168:171], v[176:179], v[116:131]
  s_add_u32 m0, s59, 18432
  s_nop 0
  buffer_load_dwordx4 v39, s[20:23], s8 offen offset:0 lds
  v_mfma_f32_32x32x16_bf16 v[80:95], v[168:171], v[172:175], v[80:95]
  buffer_load_dwordx4 v39, s[72:75], s8 offen offset:1024 lds
  s_waitcnt lgkmcnt(2)
  v_mfma_f32_32x32x16_bf16 v[40:55], v[96:99], v[136:139], v[40:55]
  ds_read_b128 v[144:147], v19 offset:49152
  ds_read_b128 v[172:175], v23 offset:49152
  s_waitcnt lgkmcnt(2)
  v_mfma_f32_32x32x16_bf16 v[64:79], v[96:99], v[140:143], v[64:79]
  ds_read_b128 v[168:171], v19 offset:53248
  ds_read_b128 v[176:179], v23 offset:53248
  v_mfma_f32_32x32x16_bf16 v[116:131], v[132:135], v[140:143], v[116:131]
  v_dot2c_f32_bf16 v164, v63, v163
  v_mfma_f32_32x32x16_bf16 v[80:95], v[132:135], v[136:139], v[80:95]
  s_waitcnt lgkmcnt(2)
  v_mfma_f32_32x32x16_bf16 v[40:55], v[144:147], v[172:175], v[40:55]
  s_waitcnt lgkmcnt(0)
  v_mfma_f32_32x32x16_bf16 v[64:79], v[144:147], v[176:179], v[64:79]
  v_mfma_f32_32x32x16_bf16 v[116:131], v[168:171], v[176:179], v[116:131]
  v_mfma_f32_32x32x16_bf16 v[80:95], v[168:171], v[172:175], v[80:95]
  s_nop 7
  v_pk_fma_f32 v[234:235], v[210:211], v[40:41], v[42:43] op_sel:[0,0,0] op_sel_hi:[0,1,1]
  s_nop 0
  v_pk_fma_f32 v[228:229], v[210:211], v[64:65], v[66:67] op_sel:[0,0,0] op_sel_hi:[0,1,1]
  v_pk_fma_f32 v[234:235], v[210:211], v[64:65], v[234:235] op_sel:[1,0,0] op_sel_hi:[1,1,1] neg_lo:[1,0,0] neg_hi:[1,0,0]
  v_pk_fma_f32 v[228:229], v[210:211], v[40:41], v[228:229] op_sel:[1,0,0] op_sel_hi:[1,1,1]
  v_pk_fma_f32 v[8:9], v[210:211], v[234:235], v[44:45] op_sel:[0,0,0] op_sel_hi:[0,1,1]
  v_pk_fma_f32 v[10:11], v[210:211], v[228:229], v[68:69] op_sel:[0,0,0] op_sel_hi:[0,1,1]
  v_pk_fma_f32 v[8:9], v[210:211], v[228:229], v[8:9] op_sel:[1,0,0] op_sel_hi:[1,1,1] neg_lo:[1,0,0] neg_hi:[1,0,0]
  v_pk_fma_f32 v[10:11], v[210:211], v[234:235], v[10:11] op_sel:[1,0,0] op_sel_hi:[1,1,1]
  v_pk_fma_f32 v[234:235], v[210:211], v[8:9], v[46:47] op_sel:[0,0,0] op_sel_hi:[0,1,1]
  v_pk_fma_f32 v[228:229], v[210:211], v[10:11], v[70:71] op_sel:[0,0,0] op_sel_hi:[0,1,1]
  v_pk_fma_f32 v[234:235], v[210:211], v[10:11], v[234:235] op_sel:[1,0,0] op_sel_hi:[1,1,1] neg_lo:[1,0,0] neg_hi:[1,0,0]
  v_pk_fma_f32 v[228:229], v[210:211], v[8:9], v[228:229] op_sel:[1,0,0] op_sel_hi:[1,1,1]
  v_pk_fma_f32 v[8:9], v[210:211], v[234:235], v[48:49] op_sel:[0,0,0] op_sel_hi:[0,1,1]
  v_pk_fma_f32 v[10:11], v[210:211], v[228:229], v[72:73] op_sel:[0,0,0] op_sel_hi:[0,1,1]
  v_pk_fma_f32 v[8:9], v[210:211], v[228:229], v[8:9] op_sel:[1,0,0] op_sel_hi:[1,1,1] neg_lo:[1,0,0] neg_hi:[1,0,0]
  v_pk_fma_f32 v[10:11], v[210:211], v[234:235], v[10:11] op_sel:[1,0,0] op_sel_hi:[1,1,1]
  v_pk_fma_f32 v[234:235], v[210:211], v[8:9], v[50:51] op_sel:[0,0,0] op_sel_hi:[0,1,1]
  v_pk_fma_f32 v[228:229], v[210:211], v[10:11], v[74:75] op_sel:[0,0,0] op_sel_hi:[0,1,1]
  v_pk_fma_f32 v[234:235], v[210:211], v[10:11], v[234:235] op_sel:[1,0,0] op_sel_hi:[1,1,1] neg_lo:[1,0,0] neg_hi:[1,0,0]
  v_pk_fma_f32 v[228:229], v[210:211], v[8:9], v[228:229] op_sel:[1,0,0] op_sel_hi:[1,1,1]
  v_pk_fma_f32 v[8:9], v[210:211], v[234:235], v[52:53] op_sel:[0,0,0] op_sel_hi:[0,1,1]
  v_pk_fma_f32 v[10:11], v[210:211], v[228:229], v[76:77] op_sel:[0,0,0] op_sel_hi:[0,1,1]
  v_pk_fma_f32 v[8:9], v[210:211], v[228:229], v[8:9] op_sel:[1,0,0] op_sel_hi:[1,1,1] neg_lo:[1,0,0] neg_hi:[1,0,0]
  v_pk_fma_f32 v[10:11], v[210:211], v[234:235], v[10:11] op_sel:[1,0,0] op_sel_hi:[1,1,1]
  v_pk_fma_f32 v[234:235], v[210:211], v[8:9], v[54:55] op_sel:[0,0,0] op_sel_hi:[0,1,1]
  v_pk_fma_f32 v[228:229], v[210:211], v[10:11], v[78:79] op_sel:[0,0,0] op_sel_hi:[0,1,1]
  v_pk_fma_f32 v[234:235], v[210:211], v[10:11], v[234:235] op_sel:[1,0,0] op_sel_hi:[1,1,1] neg_lo:[1,0,0] neg_hi:[1,0,0]
  v_pk_fma_f32 v[228:229], v[210:211], v[8:9], v[228:229] op_sel:[1,0,0] op_sel_hi:[1,1,1]
  v_pk_fma_f32 v[8:9], v[210:211], v[234:235], v[80:81] op_sel:[0,0,0] op_sel_hi:[0,1,1]
  v_pk_fma_f32 v[10:11], v[210:211], v[228:229], v[116:117] op_sel:[0,0,0] op_sel_hi:[0,1,1]
  v_pk_fma_f32 v[8:9], v[210:211], v[228:229], v[8:9] op_sel:[1,0,0] op_sel_hi:[1,1,1] neg_lo:[1,0,0] neg_hi:[1,0,0]
  v_pk_fma_f32 v[10:11], v[210:211], v[234:235], v[10:11] op_sel:[1,0,0] op_sel_hi:[1,1,1]
  v_pk_fma_f32 v[234:235], v[210:211], v[8:9], v[82:83] op_sel:[0,0,0] op_sel_hi:[0,1,1]
  v_pk_fma_f32 v[228:229], v[210:211], v[10:11], v[118:119] op_sel:[0,0,0] op_sel_hi:[0,1,1]
  v_pk_fma_f32 v[234:235], v[210:211], v[10:11], v[234:235] op_sel:[1,0,0] op_sel_hi:[1,1,1] neg_lo:[1,0,0] neg_hi:[1,0,0]
  v_pk_fma_f32 v[228:229], v[210:211], v[8:9], v[228:229] op_sel:[1,0,0] op_sel_hi:[1,1,1]
  v_pk_fma_f32 v[8:9], v[210:211], v[234:235], v[84:85] op_sel:[0,0,0] op_sel_hi:[0,1,1]
  v_pk_fma_f32 v[10:11], v[210:211], v[228:229], v[120:121] op_sel:[0,0,0] op_sel_hi:[0,1,1]
  v_pk_fma_f32 v[8:9], v[210:211], v[228:229], v[8:9] op_sel:[1,0,0] op_sel_hi:[1,1,1] neg_lo:[1,0,0] neg_hi:[1,0,0]
  v_pk_fma_f32 v[10:11], v[210:211], v[234:235], v[10:11] op_sel:[1,0,0] op_sel_hi:[1,1,1]
  v_pk_fma_f32 v[234:235], v[210:211], v[8:9], v[86:87] op_sel:[0,0,0] op_sel_hi:[0,1,1]
  v_pk_fma_f32 v[228:229], v[210:211], v[10:11], v[122:123] op_sel:[0,0,0] op_sel_hi:[0,1,1]
  v_pk_fma_f32 v[234:235], v[210:211], v[10:11], v[234:235] op_sel:[1,0,0] op_sel_hi:[1,1,1] neg_lo:[1,0,0] neg_hi:[1,0,0]
  v_pk_fma_f32 v[228:229], v[210:211], v[8:9], v[228:229] op_sel:[1,0,0] op_sel_hi:[1,1,1]
  v_pk_fma_f32 v[8:9], v[210:211], v[234:235], v[88:89] op_sel:[0,0,0] op_sel_hi:[0,1,1]
  v_pk_fma_f32 v[10:11], v[210:211], v[228:229], v[124:125] op_sel:[0,0,0] op_sel_hi:[0,1,1]
  v_pk_fma_f32 v[8:9], v[210:211], v[228:229], v[8:9] op_sel:[1,0,0] op_sel_hi:[1,1,1] neg_lo:[1,0,0] neg_hi:[1,0,0]
  v_pk_fma_f32 v[10:11], v[210:211], v[234:235], v[10:11] op_sel:[1,0,0] op_sel_hi:[1,1,1]
  v_pk_fma_f32 v[234:235], v[210:211], v[8:9], v[90:91] op_sel:[0,0,0] op_sel_hi:[0,1,1]
  v_pk_fma_f32 v[228:229], v[210:211], v[10:11], v[126:127] op_sel:[0,0,0] op_sel_hi:[0,1,1]
  v_pk_fma_f32 v[234:235], v[210:211], v[10:11], v[234:235] op_sel:[1,0,0] op_sel_hi:[1,1,1] neg_lo:[1,0,0] neg_hi:[1,0,0]
  v_pk_fma_f32 v[228:229], v[210:211], v[8:9], v[228:229] op_sel:[1,0,0] op_sel_hi:[1,1,1]
  v_pk_fma_f32 v[8:9], v[210:211], v[234:235], v[92:93] op_sel:[0,0,0] op_sel_hi:[0,1,1]
  v_pk_fma_f32 v[10:11], v[210:211], v[228:229], v[128:129] op_sel:[0,0,0] op_sel_hi:[0,1,1]
  v_pk_fma_f32 v[8:9], v[210:211], v[228:229], v[8:9] op_sel:[1,0,0] op_sel_hi:[1,1,1] neg_lo:[1,0,0] neg_hi:[1,0,0]
  v_pk_fma_f32 v[10:11], v[210:211], v[234:235], v[10:11] op_sel:[1,0,0] op_sel_hi:[1,1,1]
  v_pk_fma_f32 v[234:235], v[210:211], v[8:9], v[94:95] op_sel:[0,0,0] op_sel_hi:[0,1,1]
  v_pk_fma_f32 v[228:229], v[210:211], v[10:11], v[130:131] op_sel:[0,0,0] op_sel_hi:[0,1,1]
  v_pk_fma_f32 v[234:235], v[210:211], v[10:11], v[234:235] op_sel:[1,0,0] op_sel_hi:[1,1,1] neg_lo:[1,0,0] neg_hi:[1,0,0]
  v_pk_fma_f32 v[228:229], v[210:211], v[8:9], v[228:229] op_sel:[1,0,0] op_sel_hi:[1,1,1]
  v_fma_f32 v8, v212, v234, v235
  v_fma_f32 v9, v212, v228, v229
  v_fma_f32 v8, -v213, v228, v8
  v_fma_f32 v9, v213, v234, v9
  v_mov_b32 v10, v8
  v_mov_b32 v11, v9
  s_nop 0
  v_permlane32_swap_b32 v8, v10
  v_permlane32_swap_b32 v9, v11
  v_fma_f32 v10, v214, v8, v10
  v_fma_f32 v11, v214, v9, v11
  v_fma_f32 v10, -v215, v9, v10
  v_fma_f32 v11, v215, v8, v11
  ds_write_b64 v209, v[10:11]
  s_waitcnt vmcnt(16)
  v_cmp_ne_u32 vcc, 1, v231
  s_nop 0
  s_cbranch_vccz gated_mix__spectral_gfnet__ssm_conv_s5__prompt_kernel_skip24
  s_mov_b32 s24, 0
gated_mix__spectral_gfnet__ssm_conv_s5__prompt_kernel_poll25:
  s_sleep 16
  buffer_load_dword v231, v7, s[16:19], 0 offen sc1
  s_waitcnt vmcnt(0)
  v_cmp_ne_u32 vcc, 1, v231
  s_nop 0
  s_cbranch_vccz gated_mix__spectral_gfnet__ssm_conv_s5__prompt_kernel_pollout26
  s_add_u32 s24, s24, 1
  s_cmp_lt_u32 s24, 1048576
  s_cbranch_scc1 gated_mix__spectral_gfnet__ssm_conv_s5__prompt_kernel_poll25
gated_mix__spectral_gfnet__ssm_conv_s5__prompt_kernel_pollout26:
gated_mix__spectral_gfnet__ssm_conv_s5__prompt_kernel_skip24:
  s_waitcnt lgkmcnt(0)
  s_barrier
  v_and_b32 v209, 0xfffffbff, v209
  ds_read_b64 v[230:231], v209
  s_cmp_lt_u32 s3, 2
  s_cbranch_scc1 gated_mix__spectral_gfnet__ssm_conv_s5__prompt_kernel_skip27
  s_waitcnt lgkmcnt(0)
  v_fma_f32 v10, v216, v230, v10
  s_waitcnt lgkmcnt(0)
  v_fma_f32 v11, v216, v231, v11
  s_waitcnt lgkmcnt(0)
  v_fma_f32 v10, -v217, v231, v10
  s_waitcnt lgkmcnt(0)
  v_fma_f32 v11, v217, v230, v11
  v_min_u32 v10, -2, v10
  v_min_u32 v11, -2, v11
  s_mov_b32 exec_hi, 0
  buffer_store_dwordx2 v[10:11], v56, s[60:63], 0 offen sc1
  s_mov_b64 exec, -1
gated_mix__spectral_gfnet__ssm_conv_s5__prompt_kernel_skip27:
  v_lshrrev_b32 v6, 5, v1
  v_lshl_add_u32 v56, v6, 12, v56
  v_add_u32 v56, 512, v56
  v_and_b32 v62, 3, v2
  v_lshlrev_b32 v6, 6, v62
  v_lshrrev_b32 v62, 2, v2
  v_lshl_or_b32 v6, v62, 4, v6
  v_lshl_or_b32 v6, v3, 12, v6
  s_mul_i32 s24, s11, 16384
  s_lshl_b32 s25, s3, 8
  s_add_u32 s24, s24, s25
  buffer_load_dwordx4 v[12:15], v6, s[12:15], s24 offen offset:0 sc1
  buffer_load_dwordx4 v[16:19], v6, s[12:15], s24 offen offset:1024 sc1
  buffer_load_dwordx4 v[20:23], v6, s[12:15], s24 offen offset:2048 sc1
  buffer_load_dwordx4 v[96:99], v6, s[12:15], s24 offen offset:3072 sc1
  v_pk_mul_f32 v[134:135], v[220:221], v[40:41] op_sel:[1,0] op_sel_hi:[1,1]
  v_pk_mul_f32 v[40:41], v[220:221], v[40:41] op_sel:[0,0] op_sel_hi:[0,1]
  v_pk_fma_f32 v[40:41], v[220:221], v[64:65], v[40:41] op_sel:[1,0,0] op_sel_hi:[1,1,1] neg_lo:[1,0,0] neg_hi:[1,0,0]
  v_pk_fma_f32 v[64:65], v[220:221], v[64:65], v[134:135] op_sel:[0,0,0] op_sel_hi:[0,1,1]
  v_pk_mul_f32 v[132:133], v[220:221], v[42:43] op_sel:[1,0] op_sel_hi:[1,1]
  v_pk_mul_f32 v[42:43], v[220:221], v[42:43] op_sel:[0,0] op_sel_hi:[0,1]
  v_pk_fma_f32 v[42:43], v[220:221], v[66:67], v[42:43] op_sel:[1,0,0] op_sel_hi:[1,1,1] neg_lo:[1,0,0] neg_hi:[1,0,0]
  v_pk_fma_f32 v[66:67], v[220:221], v[66:67], v[132:133] op_sel:[0,0,0] op_sel_hi:[0,1,1]
  v_pk_mul_f32 v[134:135], v[220:221], v[44:45] op_sel:[1,0] op_sel_hi:[1,1]
  v_pk_mul_f32 v[44:45], v[220:221], v[44:45] op_sel:[0,0] op_sel_hi:[0,1]
  v_pk_fma_f32 v[44:45], v[220:221], v[68:69], v[44:45] op_sel:[1,0,0] op_sel_hi:[1,1,1] neg_lo:[1,0,0] neg_hi:[1,0,0]
  v_pk_fma_f32 v[68:69], v[220:221], v[68:69], v[134:135] op_sel:[0,0,0] op_sel_hi:[0,1,1]
  v_pk_mul_f32 v[132:133], v[220:221], v[46:47] op_sel:[1,0] op_sel_hi:[1,1]
  v_pk_mul_f32 v[46:47], v[220:221], v[46:47] op_sel:[0,0] op_sel_hi:[0,1]
  v_pk_fma_f32 v[46:47], v[220:221], v[70:71], v[46:47] op_sel:[1,0,0] op_sel_hi:[1,1,1] neg_lo:[1,0,0] neg_hi:[1,0,0]
  v_pk_fma_f32 v[70:71], v[220:221], v[70:71], v[132:133] op_sel:[0,0,0] op_sel_hi:[0,1,1]
  v_pk_mul_f32 v[134:135], v[220:221], v[48:49] op_sel:[1,0] op_sel_hi:[1,1]
  v_pk_mul_f32 v[48:49], v[220:221], v[48:49] op_sel:[0,0] op_sel_hi:[0,1]
  v_pk_fma_f32 v[48:49], v[220:221], v[72:73], v[48:49] op_sel:[1,0,0] op_sel_hi:[1,1,1] neg_lo:[1,0,0] neg_hi:[1,0,0]
  v_pk_fma_f32 v[72:73], v[220:221], v[72:73], v[134:135] op_sel:[0,0,0] op_sel_hi:[0,1,1]
  v_pk_mul_f32 v[132:133], v[220:221], v[50:51] op_sel:[1,0] op_sel_hi:[1,1]
  v_pk_mul_f32 v[50:51], v[220:221], v[50:51] op_sel:[0,0] op_sel_hi:[0,1]
  v_pk_fma_f32 v[50:51], v[220:221], v[74:75], v[50:51] op_sel:[1,0,0] op_sel_hi:[1,1,1] neg_lo:[1,0,0] neg_hi:[1,0,0]
  v_pk_fma_f32 v[74:75], v[220:221], v[74:75], v[132:133] op_sel:[0,0,0] op_sel_hi:[0,1,1]
  v_pk_mul_f32 v[134:135], v[220:221], v[52:53] op_sel:[1,0] op_sel_hi:[1,1]
  s_add_u32 m0, s59, 81920
  s_nop 0
  buffer_load_dwordx4 v39, s[20:23], s9 offen offset:0 lds
  v_pk_mul_f32 v[52:53], v[220:221], v[52:53] op_sel:[0,0] op_sel_hi:[0,1]
  v_pk_fma_f32 v[52:53], v[220:221], v[76:77], v[52:53] op_sel:[1,0,0] op_sel_hi:[1,1,1] neg_lo:[1,0,0] neg_hi:[1,0,0]
  v_pk_fma_f32 v[76:77], v[220:221], v[76:77], v[134:135] op_sel:[0,0,0] op_sel_hi:[0,1,1]
  v_pk_mul_f32 v[132:133], v[220:221], v[54:55] op_sel:[1,0] op_sel_hi:[1,1]
  v_pk_mul_f32 v[54:55], v[220:221], v[54:55] op_sel:[0,0] op_sel_hi:[0,1]
  v_pk_fma_f32 v[54:55], v[220:221], v[78:79], v[54:55] op_sel:[1,0,0] op_sel_hi:[1,1,1] neg_lo:[1,0,0] neg_hi:[1,0,0]
  v_pk_fma_f32 v[78:79], v[220:221], v[78:79], v[132:133] op_sel:[0,0,0] op_sel_hi:[0,1,1]
  v_pk_mul_f32 v[134:135], v[220:221], v[80:81] op_sel:[1,0] op_sel_hi:[1,1]
  buffer_load_dwordx4 v39, s[72:75], s9 offen offset:1024 lds
  v_pk_mul_f32 v[80:81], v[220:221], v[80:81] op_sel:[0,0] op_sel_hi:[0,1]
  v_pk_fma_f32 v[80:81], v[220:221], v[116:117], v[80:81] op_sel:[1,0,0] op_sel_hi:[1,1,1] neg_lo:[1,0,0] neg_hi:[1,0,0]
  v_pk_fma_f32 v[116:117], v[220:221], v[116:117], v[134:135] op_sel:[0,0,0] op_sel_hi:[0,1,1]
  v_pk_mul_f32 v[132:133], v[220:221], v[82:83] op_sel:[1,0] op_sel_hi:[1,1]
  v_pk_mul_f32 v[82:83], v[220:221], v[82:83] op_sel:[0,0] op_sel_hi:[0,1]
  v_pk_fma_f32 v[82:83], v[220:221], v[118:119], v[82:83] op_sel:[1,0,0] op_sel_hi:[1,1,1] neg_lo:[1,0,0] neg_hi:[1,0,0]
  v_pk_fma_f32 v[118:119], v[220:221], v[118:119], v[132:133] op_sel:[0,0,0] op_sel_hi:[0,1,1]
  v_pk_mul_f32 v[134:135], v[220:221], v[84:85] op_sel:[1,0] op_sel_hi:[1,1]
  s_add_u32 m0, s59, 83968
  s_nop 0
  buffer_load_dwordx4 v39, s[20:23], s32 offen offset:0 lds
  v_pk_mul_f32 v[84:85], v[220:221], v[84:85] op_sel:[0,0] op_sel_hi:[0,1]
  v_pk_fma_f32 v[84:85], v[220:221], v[120:121], v[84:85] op_sel:[1,0,0] op_sel_hi:[1,1,1] neg_lo:[1,0,0] neg_hi:[1,0,0]
  v_pk_fma_f32 v[120:121], v[220:221], v[120:121], v[134:135] op_sel:[0,0,0] op_sel_hi:[0,1,1]
  v_pk_mul_f32 v[132:133], v[220:221], v[86:87] op_sel:[1,0] op_sel_hi:[1,1]
  v_pk_mul_f32 v[86:87], v[220:221], v[86:87] op_sel:[0,0] op_sel_hi:[0,1]
  v_pk_fma_f32 v[86:87], v[220:221], v[122:123], v[86:87] op_sel:[1,0,0] op_sel_hi:[1,1,1] neg_lo:[1,0,0] neg_hi:[1,0,0]
  v_pk_fma_f32 v[122:123], v[220:221], v[122:123], v[132:133] op_sel:[0,0,0] op_sel_hi:[0,1,1]
  v_pk_mul_f32 v[134:135], v[220:221], v[88:89] op_sel:[1,0] op_sel_hi:[1,1]
  buffer_load_dwordx4 v39, s[72:75], s32 offen offset:1024 lds
  v_pk_mul_f32 v[88:89], v[220:221], v[88:89] op_sel:[0,0] op_sel_hi:[0,1]
  v_pk_fma_f32 v[88:89], v[220:221], v[124:125], v[88:89] op_sel:[1,0,0] op_sel_hi:[1,1,1] neg_lo:[1,0,0] neg_hi:[1,0,0]
  v_pk_fma_f32 v[124:125], v[220:221], v[124:125], v[134:135] op_sel:[0,0,0] op_sel_hi:[0,1,1]
  v_pk_mul_f32 v[132:133], v[220:221], v[90:91] op_sel:[1,0] op_sel_hi:[1,1]
  v_pk_mul_f32 v[90:91], v[220:221], v[90:91] op_sel:[0,0] op_sel_hi:[0,1]
  v_pk_fma_f32 v[90:91], v[220:221], v[126:127], v[90:91] op_sel:[1,0,0] op_sel_hi:[1,1,1] neg_lo:[1,0,0] neg_hi:[1,0,0]
  v_pk_fma_f32 v[126:127], v[220:221], v[126:127], v[132:133] op_sel:[0,0,0] op_sel_hi:[0,1,1]
  v_pk_mul_f32 v[134:135], v[220:221], v[92:93] op_sel:[1,0] op_sel_hi:[1,1]
  s_add_u32 m0, s59, 32768
  s_nop 0
  buffer_load_dwordx4 v39, s[20:23], s33 offen offset:0 lds
  v_pk_mul_f32 v[92:93], v[220:221], v[92:93] op_sel:[0,0] op_sel_hi:[0,1]
  v_pk_fma_f32 v[92:93], v[220:221], v[128:129], v[92:93] op_sel:[1,0,0] op_sel_hi:[1,1,1] neg_lo:[1,0,0] neg_hi:[1,0,0]
  v_pk_fma_f32 v[128:129], v[220:221], v[128:129], v[134:135] op_sel:[0,0,0] op_sel_hi:[0,1,1]
  v_pk_mul_f32 v[132:133], v[220:221], v[94:95] op_sel:[1,0] op_sel_hi:[1,1]
  v_pk_mul_f32 v[94:95], v[220:221], v[94:95] op_sel:[0,0] op_sel_hi:[0,1]
  v_pk_fma_f32 v[94:95], v[220:221], v[130:131], v[94:95] op_sel:[1,0,0] op_sel_hi:[1,1,1] neg_lo:[1,0,0] neg_hi:[1,0,0]
  v_pk_fma_f32 v[130:131], v[220:221], v[130:131], v[132:133] op_sel:[0,0,0] op_sel_hi:[0,1,1]
  v_pk_mul_f32 v[10:11], v[220:221], v[216:217] op_sel:[0,0] op_sel_hi:[0,1]
  buffer_load_dwordx4 v39, s[72:75], s33 offen offset:1024 lds
  v_pk_fma_f32 v[10:11], v[220:221], v[216:217], v[10:11] op_sel:[1,1,0] op_sel_hi:[1,0,1] neg_lo:[1,0,0]
  s_cmp_ge_u32 s3, 2
  s_cbranch_scc1 gated_mix__spectral_gfnet__ssm_conv_s5__prompt_kernel_skip28
  v_mov_b32 v10, v220
  v_mov_b32 v11, v221
  s_waitcnt lgkmcnt(0)
  v_mov_b32 v230, 0
  s_waitcnt lgkmcnt(0)
  v_mov_b32 v231, 0
gated_mix__spectral_gfnet__ssm_conv_s5__prompt_kernel_skip28:
  v_pk_mul_f32 v[136:137], v[214:215], v[10:11] op_sel:[0,0] op_sel_hi:[0,1]
  v_pk_fma_f32 v[136:137], v[214:215], v[10:11], v[136:137] op_sel:[1,1,0] op_sel_hi:[1,0,1] neg_lo:[1,0,0]
  s_waitcnt lgkmcnt(0)
  v_pk_fma_f32 v[8:9], v[214:215], v[230:231], v[8:9] op_sel:[0,0,0] op_sel_hi:[0,1,1]
  v_pk_fma_f32 v[8:9], v[214:215], v[230:231], v[8:9] op_sel:[1,1,0] op_sel_hi:[1,0,1] neg_lo:[1,0,0]
  s_mov_b32 exec_lo, 0
  v_mov_b32 v10, v136
  v_mov_b32 v11, v137
  v_mov_b32 v230, v8
  v_mov_b32 v231, v9
  s_mov_b64 exec, -1
  s_add_u32 m0, s59, 34816
  s_nop 0
  buffer_load_dwordx4 v39, s[20:23], s58 offen offset:0 lds
  v_mov_b32 v235, v228
  v_pk_mul_f32 v[132:133], v[212:213], v[10:11] op_sel:[0,0] op_sel_hi:[0,1]
  v_pk_fma_f32 v[132:133], v[212:213], v[10:11], v[132:133] op_sel:[1,1,0] op_sel_hi:[1,0,1] neg_lo:[1,0,0]
  v_pk_fma_f32 v[234:235], v[212:213], v[230:231], v[234:235] op_sel:[0,0,0] op_sel_hi:[0,1,1]
  v_pk_fma_f32 v[234:235], v[212:213], v[230:231], v[234:235] op_sel:[1,1,0] op_sel_hi:[1,0,1] neg_lo:[1,0,0]
  v_pk_mul_f32 v[134:135], v[220:221], v[234:235] op_sel:[0,0] op_sel_hi:[0,1]
  v_pk_fma_f32 v[134:135], v[220:221], v[234:235], v[134:135] op_sel:[1,1,0] op_sel_hi:[1,0,1] neg_lo:[1,0,0]
  v_pk_mul_f32 v[136:137], v[220:221], v[230:231] op_sel:[0,0] op_sel_hi:[0,1]
  buffer_load_dwordx4 v39, s[72:75], s58 offen offset:1024 lds
  v_pk_fma_f32 v[136:137], v[220:221], v[230:231], v[136:137] op_sel:[1,1,0] op_sel_hi:[1,0,1] neg_lo:[1,0,0]
  buffer_load_dwordx2 v[8:9], v56, s[60:63], 0 offen offset:0 sc1
  buffer_load_dwordx2 v[138:139], v56, s[60:63], 0 offen offset:512 sc1
  buffer_load_dwordx2 v[216:217], v56, s[60:63], 0 offen offset:1024 sc1
  buffer_load_dwordx2 v[234:235], v56, s[60:63], 0 offen offset:1536 sc1
  buffer_load_dwordx2 v[140:141], v56, s[60:63], 0 offen offset:2048 sc1
  buffer_load_dwordx2 v[142:143], v56, s[60:63], 0 offen offset:2560 sc1
  buffer_load_dwordx2 v[144:145], v56, s[60:63], 0 offen offset:3072 sc1
  buffer_load_dwordx2 v[146:147], v56, s[60:63], 0 offen offset:3584 sc1
  s_add_u32 m0, s28, 114688
  s_nop 0
  buffer_load_dwordx4 v100, s[64:67], s43 offen offset:0 lds
  v_mov_b32 v165, v164
  s_lshl_b32 s12, s3, 3
  s_add_u32 s12, s12, 155648
  v_permlane16_swap_b32 v164, v165
  v_add_f32 v164, v164, v165
  s_nop 1
  v_add_f32 v164, v164, v164 row_ror:8 row_mask:0xf bank_mask:0xf
  s_nop 1
  v_add_f32 v164, v164, v164 row_ror:4 row_mask:0xf bank_mask:0xf
  s_nop 1
  v_add_f32 v164, v164, v164 row_ror:2 row_mask:0xf bank_mask:0xf
  buffer_load_dwordx4 v101, s[64:67], s43 offen offset:1024 lds
  s_nop 0
  v_add_f32 v164, v164, v164 row_ror:1 row_mask:0xf bank_mask:0xf
  v_cvt_pk_bf16_f32 v164, v164, v164
  v_and_b32 v164, 0xffff0000, v164
  v_mul_f32 v164, 0xbfb8aa3b, v164
  v_exp_f32 v164, v164
  v_lshrrev_b32 v63, 5, v1
  v_add_f32 v164, 1.0, v164
  s_add_u32 m0, s28, 116736
  s_nop 0
  buffer_load_dwordx4 v102, s[64:67], s43 offen offset:0 lds
  v_rcp_f32 v164, v164
  v_lshl_add_u32 v63, v63, 2, s12
  v_cvt_pk_bf16_f32 v164, v164, v164
  v_and_b32 v164, 0xffff0000, v164
  ds_write_b32 v63, v164
  v_and_b32 v6, 7, v2
  v_lshlrev_b32 v209, 2, v3
  buffer_load_dwordx4 v103, s[64:67], s43 offen offset:1024 lds
  v_xor_b32 v6, v6, v209
  v_lshlrev_b32 v6, 4, v6
  v_lshl_or_b32 v6, v2, 10, v6
  s_lshl_b32 s12, s3, 8
  s_add_u32 s12, s12, 49152
  v_add_u32 v6, s12, v6
  s_waitcnt vmcnt(23)
  v_mov_b32 v148, v12
  s_waitcnt vmcnt(22)
  v_mov_b32 v149, v16
  s_waitcnt vmcnt(21)
  v_mov_b32 v150, v20
  s_waitcnt vmcnt(20)
  v_mov_b32 v151, v96
  v_mov_b32 v152, v13
  v_mov_b32 v153, v17
  v_mov_b32 v154, v21
  v_mov_b32 v155, v97
  v_mfma_f32_16x16x32_bf16 v[156:159], v[148:151], v[108:111], 0
  v_mfma_f32_16x16x32_bf16 v[160:163], v[148:151], v[112:115], 0
  v_mfma_f32_16x16x32_bf16 v[168:171], v[152:155], v[108:111], 0
  v_mfma_f32_16x16x32_bf16 v[172:175], v[152:155], v[112:115], 0
  v_mov_b32 v148, v14
  v_mov_b32 v149, v18
  v_mov_b32 v150, v22
  v_mov_b32 v151, v98
  v_mov_b32 v152, v15
  v_mov_b32 v153, v19
  v_mov_b32 v154, v23
  v_mov_b32 v155, v99
  v_xor_b32 v209, 0, v6
  v_cvt_pk_bf16_f32 v96, v156, v160
  v_cvt_pk_bf16_f32 v97, v157, v161
  v_cvt_pk_bf16_f32 v98, v158, v162
  v_cvt_pk_bf16_f32 v99, v159, v163
  ds_write_b128 v209, v[96:99]
  v_mfma_f32_16x16x32_bf16 v[156:159], v[148:151], v[108:111], 0
  v_mfma_f32_16x16x32_bf16 v[160:163], v[148:151], v[112:115], 0
  v_xor_b32 v209, 16, v6
  v_cvt_pk_bf16_f32 v12, v168, v172
  v_cvt_pk_bf16_f32 v13, v169, v173
  v_cvt_pk_bf16_f32 v14, v170, v174
  v_cvt_pk_bf16_f32 v15, v171, v175
  ds_write_b128 v209, v[12:15]
  v_mfma_f32_16x16x32_bf16 v[168:171], v[152:155], v[108:111], 0
  v_mfma_f32_16x16x32_bf16 v[172:175], v[152:155], v[112:115], 0
  v_xor_b32 v209, 32, v6
  v_cvt_pk_bf16_f32 v16, v156, v160
  v_cvt_pk_bf16_f32 v17, v157, v161
  v_cvt_pk_bf16_f32 v18, v158, v162
  v_cvt_pk_bf16_f32 v19, v159, v163
  ds_write_b128 v209, v[16:19]
  v_xor_b32 v209, 48, v6
  s_nop 0
  v_cvt_pk_bf16_f32 v20, v168, v172
  v_cvt_pk_bf16_f32 v21, v169, v173
  v_cvt_pk_bf16_f32 v22, v170, v174
  v_cvt_pk_bf16_f32 v23, v171, v175
  ds_write_b128 v209, v[20:23]
  s_waitcnt vmcnt(4)
  v_max_u32 v6, v8, v9
  v_max3_u32 v6, v6, v138, v139
  v_max3_u32 v6, v6, v216, v217
  v_max3_u32 v6, v6, v234, v235
  v_max3_u32 v6, v6, v140, v141
  v_max3_u32 v6, v6, v142, v143
  v_max3_u32 v6, v6, v144, v145
  v_max3_u32 v6, v6, v146, v147
  v_cmp_eq_u32 vcc, -1, v6
  s_nop 0
  s_cbranch_vccz gated_mix__spectral_gfnet__ssm_conv_s5__prompt_kernel_skip29
  s_mov_b32 s12, 0
gated_mix__spectral_gfnet__ssm_conv_s5__prompt_kernel_lb30:
  buffer_load_dwordx2 v[8:9], v56, s[60:63], 0 offen offset:0 sc1
  buffer_load_dwordx2 v[138:139], v56, s[60:63], 0 offen offset:512 sc1
  buffer_load_dwordx2 v[216:217], v56, s[60:63], 0 offen offset:1024 sc1
  buffer_load_dwordx2 v[234:235], v56, s[60:63], 0 offen offset:1536 sc1
  buffer_load_dwordx2 v[140:141], v56, s[60:63], 0 offen offset:2048 sc1
  buffer_load_dwordx2 v[142:143], v56, s[60:63], 0 offen offset:2560 sc1
  buffer_load_dwordx2 v[144:145], v56, s[60:63], 0 offen offset:3072 sc1
  buffer_load_dwordx2 v[146:147], v56, s[60:63], 0 offen offset:3584 sc1
  s_waitcnt vmcnt(0)
  v_max_u32 v6, v8, v9
  v_max3_u32 v6, v6, v138, v139
  v_max3_u32 v6, v6, v216, v217
  v_max3_u32 v6, v6, v234, v235
  v_max3_u32 v6, v6, v140, v141
  v_max3_u32 v6, v6, v142, v143
  v_max3_u32 v6, v6, v144, v145
  v_max3_u32 v6, v6, v146, v147
  v_cmp_eq_u32 vcc, -1, v6
  s_nop 0
  s_cbranch_vccz gated_mix__spectral_gfnet__ssm_conv_s5__prompt_kernel_lbout31
  s_add_u32 s12, s12, 1
  s_cmp_lt_u32 s12, 1048576
  s_cbranch_scc1 gated_mix__spectral_gfnet__ssm_conv_s5__prompt_kernel_lb30
gated_mix__spectral_gfnet__ssm_conv_s5__prompt_kernel_lbout31:
gated_mix__spectral_gfnet__ssm_conv_s5__prompt_kernel_skip29:
  v_pk_fma_f32 v[144:145], v[222:223], v[146:147], v[144:145] op_sel:[0,0,0] op_sel_hi:[0,1,1]
  v_pk_fma_f32 v[144:145], v[222:223], v[146:147], v[144:145] op_sel:[1,1,0] op_sel_hi:[1,0,1] neg_lo:[1,0,0]
  v_pk_fma_f32 v[142:143], v[222:223], v[144:145], v[142:143] op_sel:[0,0,0] op_sel_hi:[0,1,1]
  v_pk_fma_f32 v[142:143], v[222:223], v[144:145], v[142:143] op_sel:[1,1,0] op_sel_hi:[1,0,1] neg_lo:[1,0,0]
  v_pk_fma_f32 v[140:141], v[222:223], v[142:143], v[140:141] op_sel:[0,0,0] op_sel_hi:[0,1,1]
  v_pk_fma_f32 v[140:141], v[222:223], v[142:143], v[140:141] op_sel:[1,1,0] op_sel_hi:[1,0,1] neg_lo:[1,0,0]
  v_pk_fma_f32 v[234:235], v[222:223], v[140:141], v[234:235] op_sel:[0,0,0] op_sel_hi:[0,1,1]
  v_pk_fma_f32 v[234:235], v[222:223], v[140:141], v[234:235] op_sel:[1,1,0] op_sel_hi:[1,0,1] neg_lo:[1,0,0]
  v_pk_fma_f32 v[216:217], v[222:223], v[234:235], v[216:217] op_sel:[0,0,0] op_sel_hi:[0,1,1]
  v_pk_fma_f32 v[216:217], v[222:223], v[234:235], v[216:217] op_sel:[1,1,0] op_sel_hi:[1,0,1] neg_lo:[1,0,0]
  v_pk_fma_f32 v[138:139], v[222:223], v[216:217], v[138:139] op_sel:[0,0,0] op_sel_hi:[0,1,1]
  v_pk_fma_f32 v[138:139], v[222:223], v[216:217], v[138:139] op_sel:[1,1,0] op_sel_hi:[1,0,1] neg_lo:[1,0,0]
  v_pk_fma_f32 v[8:9], v[222:223], v[138:139], v[8:9] op_sel:[0,0,0] op_sel_hi:[0,1,1]
  v_pk_fma_f32 v[8:9], v[222:223], v[138:139], v[8:9] op_sel:[1,1,0] op_sel_hi:[1,0,1] neg_lo:[1,0,0]
  v_mov_b32 v138, v8
  v_mov_b32 v139, v9
  s_nop 0
  v_permlane32_swap_b32 v8, v138
  v_permlane32_swap_b32 v9, v139
  v_pk_fma_f32 v[8:9], v[218:219], v[138:139], v[8:9] op_sel:[0,0,0] op_sel_hi:[0,1,1]
  v_pk_fma_f32 v[8:9], v[218:219], v[138:139], v[8:9] op_sel:[1,1,0] op_sel_hi:[1,0,1] neg_lo:[1,0,0]
  v_pk_fma_f32 v[136:137], v[10:11], v[8:9], v[136:137] op_sel:[0,0,0] op_sel_hi:[0,1,1]
  v_pk_fma_f32 v[136:137], v[10:11], v[8:9], v[136:137] op_sel:[1,1,0] op_sel_hi:[1,0,1] neg_lo:[1,0,0]
  v_pk_fma_f32 v[134:135], v[132:133], v[8:9], v[134:135] op_sel:[0,0,0] op_sel_hi:[0,1,1]
  v_pk_fma_f32 v[134:135], v[132:133], v[8:9], v[134:135] op_sel:[1,1,0] op_sel_hi:[1,0,1] neg_lo:[1,0,0]
  v_swap_b32 v137, v134
  v_pk_fma_f32 v[40:41], v[210:211], v[136:137], v[40:41] op_sel:[0,0,0] op_sel_hi:[0,1,1]
  v_pk_fma_f32 v[64:65], v[210:211], v[134:135], v[64:65] op_sel:[0,0,0] op_sel_hi:[0,1,1]
  v_pk_fma_f32 v[40:41], v[210:211], v[134:135], v[40:41] op_sel:[1,0,0] op_sel_hi:[1,1,1] neg_lo:[1,0,0] neg_hi:[1,0,0]
  v_pk_fma_f32 v[64:65], v[210:211], v[136:137], v[64:65] op_sel:[1,0,0] op_sel_hi:[1,1,1]
  v_cvt_pk_bf16_f32 v12, v40, v41
  v_cvt_pk_bf16_f32 v13, -v64, -v65
  v_pk_fma_f32 v[42:43], v[210:211], v[40:41], v[42:43] op_sel:[0,0,0] op_sel_hi:[0,1,1]
  v_pk_fma_f32 v[66:67], v[210:211], v[64:65], v[66:67] op_sel:[0,0,0] op_sel_hi:[0,1,1]
  v_pk_fma_f32 v[42:43], v[210:211], v[64:65], v[42:43] op_sel:[1,0,0] op_sel_hi:[1,1,1] neg_lo:[1,0,0] neg_hi:[1,0,0]
  v_pk_fma_f32 v[66:67], v[210:211], v[40:41], v[66:67] op_sel:[1,0,0] op_sel_hi:[1,1,1]
  v_cvt_pk_bf16_f32 v14, v42, v43
  v_cvt_pk_bf16_f32 v15, -v66, -v67
  v_pk_fma_f32 v[44:45], v[210:211], v[42:43], v[44:45] op_sel:[0,0,0] op_sel_hi:[0,1,1]
  v_pk_fma_f32 v[68:69], v[210:211], v[66:67], v[68:69] op_sel:[0,0,0] op_sel_hi:[0,1,1]
  v_permlane32_swap_b32 v12, v13
  v_permlane32_swap_b32 v14, v15
  v_pk_fma_f32 v[44:45], v[210:211], v[66:67], v[44:45] op_sel:[1,0,0] op_sel_hi:[1,1,1] neg_lo:[1,0,0] neg_hi:[1,0,0]
  v_pk_fma_f32 v[68:69], v[210:211], v[42:43], v[68:69] op_sel:[1,0,0] op_sel_hi:[1,1,1]
  v_permlane16_swap_b32 v12, v14
  v_permlane16_swap_b32 v13, v15
  buffer_store_dwordx4 v[12:15], v57, s[84:87], s81 offen sc1
  s_add_u32 s81, s81, 1048576
  v_cvt_pk_bf16_f32 v16, v44, v45
  v_cvt_pk_bf16_f32 v17, -v68, -v69
  v_pk_fma_f32 v[46:47], v[210:211], v[44:45], v[46:47] op_sel:[0,0,0] op_sel_hi:[0,1,1]
  v_pk_fma_f32 v[70:71], v[210:211], v[68:69], v[70:71] op_sel:[0,0,0] op_sel_hi:[0,1,1]
  v_pk_fma_f32 v[46:47], v[210:211], v[68:69], v[46:47] op_sel:[1,0,0] op_sel_hi:[1,1,1] neg_lo:[1,0,0] neg_hi:[1,0,0]
  v_pk_fma_f32 v[70:71], v[210:211], v[44:45], v[70:71] op_sel:[1,0,0] op_sel_hi:[1,1,1]
  v_cvt_pk_bf16_f32 v18, v46, v47
  v_cvt_pk_bf16_f32 v19, -v70, -v71
  v_pk_fma_f32 v[48:49], v[210:211], v[46:47], v[48:49] op_sel:[0,0,0] op_sel_hi:[0,1,1]
  v_pk_fma_f32 v[72:73], v[210:211], v[70:71], v[72:73] op_sel:[0,0,0] op_sel_hi:[0,1,1]
  v_permlane32_swap_b32 v16, v17
  v_permlane32_swap_b32 v18, v19
  v_pk_fma_f32 v[48:49], v[210:211], v[70:71], v[48:49] op_sel:[1,0,0] op_sel_hi:[1,1,1] neg_lo:[1,0,0] neg_hi:[1,0,0]
  v_pk_fma_f32 v[72:73], v[210:211], v[46:47], v[72:73] op_sel:[1,0,0] op_sel_hi:[1,1,1]
  v_permlane16_swap_b32 v16, v18
  v_permlane16_swap_b32 v17, v19
  buffer_store_dwordx4 v[16:19], v57, s[84:87], s81 offen sc1
  s_add_u32 s81, s81, 1048576
  v_cvt_pk_bf16_f32 v20, v48, v49
  v_cvt_pk_bf16_f32 v21, -v72, -v73
  v_pk_fma_f32 v[50:51], v[210:211], v[48:49], v[50:51] op_sel:[0,0,0] op_sel_hi:[0,1,1]
  v_pk_fma_f32 v[74:75], v[210:211], v[72:73], v[74:75] op_sel:[0,0,0] op_sel_hi:[0,1,1]
  v_pk_fma_f32 v[50:51], v[210:211], v[72:73], v[50:51] op_sel:[1,0,0] op_sel_hi:[1,1,1] neg_lo:[1,0,0] neg_hi:[1,0,0]
  v_pk_fma_f32 v[74:75], v[210:211], v[48:49], v[74:75] op_sel:[1,0,0] op_sel_hi:[1,1,1]
  v_cvt_pk_bf16_f32 v22, v50, v51
  v_cvt_pk_bf16_f32 v23, -v74, -v75
  v_pk_fma_f32 v[52:53], v[210:211], v[50:51], v[52:53] op_sel:[0,0,0] op_sel_hi:[0,1,1]
  v_pk_fma_f32 v[76:77], v[210:211], v[74:75], v[76:77] op_sel:[0,0,0] op_sel_hi:[0,1,1]
  v_permlane32_swap_b32 v20, v21
  v_permlane32_swap_b32 v22, v23
  v_pk_fma_f32 v[52:53], v[210:211], v[74:75], v[52:53] op_sel:[1,0,0] op_sel_hi:[1,1,1] neg_lo:[1,0,0] neg_hi:[1,0,0]
  v_pk_fma_f32 v[76:77], v[210:211], v[50:51], v[76:77] op_sel:[1,0,0] op_sel_hi:[1,1,1]
  v_permlane16_swap_b32 v20, v22
  v_permlane16_swap_b32 v21, v23
  buffer_store_dwordx4 v[20:23], v57, s[84:87], s81 offen sc1
  s_add_u32 s81, s81, 1048576
  v_cvt_pk_bf16_f32 v12, v52, v53
  v_cvt_pk_bf16_f32 v13, -v76, -v77
  v_pk_fma_f32 v[54:55], v[210:211], v[52:53], v[54:55] op_sel:[0,0,0] op_sel_hi:[0,1,1]
  v_pk_fma_f32 v[78:79], v[210:211], v[76:77], v[78:79] op_sel:[0,0,0] op_sel_hi:[0,1,1]
  v_pk_fma_f32 v[54:55], v[210:211], v[76:77], v[54:55] op_sel:[1,0,0] op_sel_hi:[1,1,1] neg_lo:[1,0,0] neg_hi:[1,0,0]
  v_pk_fma_f32 v[78:79], v[210:211], v[52:53], v[78:79] op_sel:[1,0,0] op_sel_hi:[1,1,1]
  v_cvt_pk_bf16_f32 v14, v54, v55
  v_cvt_pk_bf16_f32 v15, -v78, -v79
  v_pk_fma_f32 v[80:81], v[210:211], v[54:55], v[80:81] op_sel:[0,0,0] op_sel_hi:[0,1,1]
  v_pk_fma_f32 v[116:117], v[210:211], v[78:79], v[116:117] op_sel:[0,0,0] op_sel_hi:[0,1,1]
  v_permlane32_swap_b32 v12, v13
  v_permlane32_swap_b32 v14, v15
  v_pk_fma_f32 v[80:81], v[210:211], v[78:79], v[80:81] op_sel:[1,0,0] op_sel_hi:[1,1,1] neg_lo:[1,0,0] neg_hi:[1,0,0]
  v_pk_fma_f32 v[116:117], v[210:211], v[54:55], v[116:117] op_sel:[1,0,0] op_sel_hi:[1,1,1]
  v_permlane16_swap_b32 v12, v14
  v_permlane16_swap_b32 v13, v15
  buffer_store_dwordx4 v[12:15], v57, s[84:87], s81 offen sc1
  s_add_u32 s81, s81, 1048576
  v_cvt_pk_bf16_f32 v16, v80, v81
  v_cvt_pk_bf16_f32 v17, -v116, -v117
  v_pk_fma_f32 v[82:83], v[210:211], v[80:81], v[82:83] op_sel:[0,0,0] op_sel_hi:[0,1,1]
  v_pk_fma_f32 v[118:119], v[210:211], v[116:117], v[118:119] op_sel:[0,0,0] op_sel_hi:[0,1,1]
  v_pk_fma_f32 v[82:83], v[210:211], v[116:117], v[82:83] op_sel:[1,0,0] op_sel_hi:[1,1,1] neg_lo:[1,0,0] neg_hi:[1,0,0]
  v_pk_fma_f32 v[118:119], v[210:211], v[80:81], v[118:119] op_sel:[1,0,0] op_sel_hi:[1,1,1]
  v_cvt_pk_bf16_f32 v18, v82, v83
  v_cvt_pk_bf16_f32 v19, -v118, -v119
  v_pk_fma_f32 v[84:85], v[210:211], v[82:83], v[84:85] op_sel:[0,0,0] op_sel_hi:[0,1,1]
  v_pk_fma_f32 v[120:121], v[210:211], v[118:119], v[120:121] op_sel:[0,0,0] op_sel_hi:[0,1,1]
  v_permlane32_swap_b32 v16, v17
  v_permlane32_swap_b32 v18, v19
  v_pk_fma_f32 v[84:85], v[210:211], v[118:119], v[84:85] op_sel:[1,0,0] op_sel_hi:[1,1,1] neg_lo:[1,0,0] neg_hi:[1,0,0]
  v_pk_fma_f32 v[120:121], v[210:211], v[82:83], v[120:121] op_sel:[1,0,0] op_sel_hi:[1,1,1]
  v_permlane16_swap_b32 v16, v18
  v_permlane16_swap_b32 v17, v19
  buffer_store_dwordx4 v[16:19], v57, s[84:87], s81 offen sc1
  s_add_u32 s81, s81, 1048576
  v_cvt_pk_bf16_f32 v20, v84, v85
  v_cvt_pk_bf16_f32 v21, -v120, -v121
  v_pk_fma_f32 v[86:87], v[210:211], v[84:85], v[86:87] op_sel:[0,0,0] op_sel_hi:[0,1,1]
  v_pk_fma_f32 v[122:123], v[210:211], v[120:121], v[122:123] op_sel:[0,0,0] op_sel_hi:[0,1,1]
  v_pk_fma_f32 v[86:87], v[210:211], v[120:121], v[86:87] op_sel:[1,0,0] op_sel_hi:[1,1,1] neg_lo:[1,0,0] neg_hi:[1,0,0]
  v_pk_fma_f32 v[122:123], v[210:211], v[84:85], v[122:123] op_sel:[1,0,0] op_sel_hi:[1,1,1]
  v_cvt_pk_bf16_f32 v22, v86, v87
  v_cvt_pk_bf16_f32 v23, -v122, -v123
  v_pk_fma_f32 v[88:89], v[210:211], v[86:87], v[88:89] op_sel:[0,0,0] op_sel_hi:[0,1,1]
  v_pk_fma_f32 v[124:125], v[210:211], v[122:123], v[124:125] op_sel:[0,0,0] op_sel_hi:[0,1,1]
  v_permlane32_swap_b32 v20, v21
  v_permlane32_swap_b32 v22, v23
  v_pk_fma_f32 v[88:89], v[210:211], v[122:123], v[88:89] op_sel:[1,0,0] op_sel_hi:[1,1,1] neg_lo:[1,0,0] neg_hi:[1,0,0]
  v_pk_fma_f32 v[124:125], v[210:211], v[86:87], v[124:125] op_sel:[1,0,0] op_sel_hi:[1,1,1]
  v_permlane16_swap_b32 v20, v22
  v_permlane16_swap_b32 v21, v23
  buffer_store_dwordx4 v[20:23], v57, s[84:87], s81 offen sc1
  s_add_u32 s81, s81, 1048576
  v_cvt_pk_bf16_f32 v12, v88, v89
  v_cvt_pk_bf16_f32 v13, -v124, -v125
  v_pk_fma_f32 v[90:91], v[210:211], v[88:89], v[90:91] op_sel:[0,0,0] op_sel_hi:[0,1,1]
  v_pk_fma_f32 v[126:127], v[210:211], v[124:125], v[126:127] op_sel:[0,0,0] op_sel_hi:[0,1,1]
  v_pk_fma_f32 v[90:91], v[210:211], v[124:125], v[90:91] op_sel:[1,0,0] op_sel_hi:[1,1,1] neg_lo:[1,0,0] neg_hi:[1,0,0]
  v_pk_fma_f32 v[126:127], v[210:211], v[88:89], v[126:127] op_sel:[1,0,0] op_sel_hi:[1,1,1]
  v_cvt_pk_bf16_f32 v14, v90, v91
  v_cvt_pk_bf16_f32 v15, -v126, -v127
  v_pk_fma_f32 v[92:93], v[210:211], v[90:91], v[92:93] op_sel:[0,0,0] op_sel_hi:[0,1,1]
  v_pk_fma_f32 v[128:129], v[210:211], v[126:127], v[128:129] op_sel:[0,0,0] op_sel_hi:[0,1,1]
  v_permlane32_swap_b32 v12, v13
  v_permlane32_swap_b32 v14, v15
  v_pk_fma_f32 v[92:93], v[210:211], v[126:127], v[92:93] op_sel:[1,0,0] op_sel_hi:[1,1,1] neg_lo:[1,0,0] neg_hi:[1,0,0]
  v_pk_fma_f32 v[128:129], v[210:211], v[90:91], v[128:129] op_sel:[1,0,0] op_sel_hi:[1,1,1]
  v_permlane16_swap_b32 v12, v14
  v_permlane16_swap_b32 v13, v15
  buffer_store_dwordx4 v[12:15], v57, s[84:87], s81 offen sc1
  s_add_u32 s81, s81, 1048576
  v_cvt_pk_bf16_f32 v16, v92, v93
  v_cvt_pk_bf16_f32 v17, -v128, -v129
  v_pk_fma_f32 v[94:95], v[210:211], v[92:93], v[94:95] op_sel:[0,0,0] op_sel_hi:[0,1,1]
  v_pk_fma_f32 v[130:131], v[210:211], v[128:129], v[130:131] op_sel:[0,0,0] op_sel_hi:[0,1,1]
  v_pk_fma_f32 v[94:95], v[210:211], v[128:129], v[94:95] op_sel:[1,0,0] op_sel_hi:[1,1,1] neg_lo:[1,0,0] neg_hi:[1,0,0]
  v_pk_fma_f32 v[130:131], v[210:211], v[92:93], v[130:131] op_sel:[1,0,0] op_sel_hi:[1,1,1]
  v_cvt_pk_bf16_f32 v18, v94, v95
  v_cvt_pk_bf16_f32 v19, -v130, -v131
  v_permlane32_swap_b32 v16, v17
  s_nop 0
  v_permlane32_swap_b32 v18, v19
  s_nop 1
  v_permlane16_swap_b32 v16, v18
  v_permlane16_swap_b32 v17, v19
  buffer_store_dwordx4 v[16:19], v57, s[84:87], s81 offen sc1
  s_cmp_lg_u32 s4, 0
  s_cbranch_scc1 gated_mix__spectral_gfnet__ssm_conv_s5__prompt_kernel_skip32
  s_mul_i32 exec_lo, s80, 0x300
  s_or_b32 exec_lo, exec_lo, 0xff
  s_mov_b32 exec_hi, 0
  ds_read_u16_d16_hi v64, v208
  ds_read_u16_d16_hi v65, v208 offset:1024
  s_waitcnt lgkmcnt(1)
  v_add_f32 v64, v64, v232
  s_waitcnt lgkmcnt(0)
  v_sub_f32 v65, v65, v233
  v_mul_f32 v64, 0.5, v64
  v_mul_f32 v65, 0.5, v65
  v_cvt_pk_bf16_f32 v64, v64, v65
  ds_write_b16 v208, v64
  ds_write_b16_d16_hi v208, v64 offset:1024
  s_mov_b64 exec, -1
gated_mix__spectral_gfnet__ssm_conv_s5__prompt_kernel_skip32:
  s_cmp_eq_u32 s80, 0
  s_cbranch_scc1 gated_mix__spectral_gfnet__ssm_conv_s5__prompt_kernel_skip33
  v_add_u32 v39, 147456, v204
  ds_read_u16_d16_hi v64, v39 offset:0
  ds_read_u16_d16_hi v68, v39 offset:1024
  ds_read_u16_d16_hi v65, v39 offset:128
  ds_read_u16_d16_hi v69, v39 offset:1152
  ds_read_u16_d16_hi v66, v39 offset:256
  ds_read_u16_d16_hi v70, v39 offset:1280
  ds_read_u16_d16_hi v67, v39 offset:384
  ds_read_u16_d16_hi v71, v39 offset:1408
gated_mix__spectral_gfnet__ssm_conv_s5__prompt_kernel_skip33:
  ds_read_u16_d16_hi v8, v204 offset:0
  ds_read_u16_d16_hi v12, v204 offset:1024
  ds_read_u16_d16_hi v9, v204 offset:128
  ds_read_u16_d16_hi v13, v204 offset:1152
  ds_read_u16_d16_hi v10, v204 offset:256
  ds_read_u16_d16_hi v14, v204 offset:1280
  ds_read_u16_d16_hi v11, v204 offset:384
  ds_read_u16_d16_hi v15, v204 offset:1408
  ds_read_u16_d16_hi v16, v204 offset:16384
  ds_read_u16_d16_hi v20, v204 offset:17408
  ds_read_u16_d16_hi v17, v204 offset:16512
  ds_read_u16_d16_hi v21, v204 offset:17536
  ds_read_u16_d16_hi v18, v204 offset:16640
  ds_read_u16_d16_hi v22, v204 offset:17664
  ds_read_u16_d16_hi v19, v204 offset:16768
  ds_read_u16_d16_hi v23, v204 offset:17792
  v_add_u32 v39, 81920, v204
  ds_read_u16_d16_hi v40, v39 offset:0
  ds_read_u16_d16_hi v44, v39 offset:1024
  ds_read_u16_d16_hi v41, v39 offset:128
  ds_read_u16_d16_hi v45, v39 offset:1152
  ds_read_u16_d16_hi v42, v39 offset:256
  ds_read_u16_d16_hi v46, v39 offset:1280
  ds_read_u16_d16_hi v43, v39 offset:384
  ds_read_u16_d16_hi v47, v39 offset:1408
  ds_read_u16_d16_hi v48, v204 offset:32768
  ds_read_u16_d16_hi v52, v204 offset:33792
  ds_read_u16_d16_hi v49, v204 offset:32896
  ds_read_u16_d16_hi v53, v204 offset:33920
  ds_read_u16_d16_hi v50, v204 offset:33024
  ds_read_u16_d16_hi v54, v204 offset:34048
  ds_read_u16_d16_hi v51, v204 offset:33152
  ds_read_u16_d16_hi v55, v204 offset:34176
  v_xor_b32 v106, 0x30000, v106
  v_xor_b32 v107, 0x30000, v107
  ds_read_b128 a[0:3], v106 offset:0
  ds_read_b128 a[4:7], v107 offset:0
  ds_read_b128 a[8:11], v106 offset:2048
  ds_read_b128 a[12:15], v107 offset:2048
  v_xor_b32 v106, 0x30000, v106
  v_xor_b32 v107, 0x30000, v107
  ds_read_b128 a[16:19], v106 offset:0
  ds_read_b128 a[20:23], v107 offset:0
  ds_read_b128 a[24:27], v106 offset:2048
  ds_read_b128 a[28:31], v107 offset:2048
  s_waitcnt vmcnt(8)
  ds_read_b128 a[32:35], v106 offset:49152
  ds_read_b128 a[36:39], v107 offset:49152
  ds_read_b128 a[40:43], v106 offset:51200
  ds_read_b128 a[44:47], v107 offset:51200
  s_waitcnt lgkmcnt(12)
  v_pk_mul_f32 v[12:13], v[206:207], v[12:13] op_sel_hi:[0,1]
  v_pk_mul_f32 v[14:15], v[206:207], v[14:15] op_sel_hi:[0,1]
  v_pk_mul_f32 v[20:21], v[206:207], v[20:21] op_sel_hi:[0,1]
  v_pk_mul_f32 v[22:23], v[206:207], v[22:23] op_sel_hi:[0,1]
  v_pk_mul_f32 v[44:45], v[206:207], v[44:45] op_sel_hi:[0,1]
  v_pk_mul_f32 v[46:47], v[206:207], v[46:47] op_sel_hi:[0,1]
  v_pk_mul_f32 v[52:53], v[206:207], v[52:53] op_sel_hi:[0,1]
  v_pk_mul_f32 v[54:55], v[206:207], v[54:55] op_sel_hi:[0,1]
  v_pk_mul_f32 v[68:69], v[206:207], v[68:69] op_sel_hi:[0,1]
  v_pk_mul_f32 v[70:71], v[206:207], v[70:71] op_sel_hi:[0,1]
  s_cmp_lg_u32 s3, 3
  s_cbranch_scc1 gated_mix__spectral_gfnet__ssm_conv_s5__prompt_kernel_skip35
  s_getpc_b64 s[6:7]
gated_mix__spectral_gfnet__ssm_conv_s5__prompt_kernel_pc34:
  s_lshr_b32 s29, s2, 3
  s_mul_i32 s29, s29, 512
  v_min_u32 v56, 3, v1
  v_lshl_add_u32 v56, v56, 7, s29
  v_min_u32 v56, gated_mix__spectral_gfnet__ssm_conv_s5__prompt_kernel_end-gated_mix__spectral_gfnet__ssm_conv_s5__prompt_kernel_pc34, v56
  v_mov_b32 v57, 0
  v_lshl_add_u64 v[56:57], v[56:57], 0, s[6:7]
  global_load_dword v4, v[56:57], off
gated_mix__spectral_gfnet__ssm_conv_s5__prompt_kernel_skip35:
  s_barrier
  s_cmp_lg_u32 s3, 0
  s_cbranch_scc1 gated_mix__spectral_gfnet__ssm_conv_s5__prompt_kernel_skip36
  v_lshlrev_b32 v56, 2, v2
  v_add_u32 v57, 155648, v56
  ds_read_b32 v57, v57
  s_lshl_b32 s29, s39, 11
  s_lshl_b32 s6, s38, 7
  s_add_u32 s29, s29, s6
  s_mov_b64 exec, 0xffff
  s_waitcnt lgkmcnt(0)
  buffer_store_dword v57, v56, s[76:79], s29 offen sc1
  s_mov_b64 exec, -1
gated_mix__spectral_gfnet__ssm_conv_s5__prompt_kernel_skip36:
  s_lshr_b32 s29, s41, 3
  s_lshl2_add_u32 s29, s29, s3
  s_lshl_b32 s29, s29, 12
  v_lshl_add_u32 v6, v1, 7, s29
  s_add_u32 m0, s28, 98304
  s_nop 0
  buffer_load_dwordx4 v100, s[68:71], s43 offen offset:0 lds
  s_and_b32 s29, s3, 1
  s_lshl_b32 s29, s29, 2
  v_xor_b32 v56, s29, v1
  s_lshl_b32 s29, s3, 12
  s_add_u32 s29, s29, 49152
  v_lshl_add_u32 v57, v56, 4, s29
  v_xor_b32 v56, 0, v57
  ds_read_b128 v[72:75], v56 offset:0
  v_xor_b32 v56, 16, v57
  ds_read_b128 v[76:79], v56 offset:1024
  v_xor_b32 v56, 32, v57
  ds_read_b128 v[80:83], v56 offset:2048
  v_xor_b32 v56, 48, v57
  ds_read_b128 v[84:87], v56 offset:3072
  s_waitcnt lgkmcnt(3)
  v_mfma_f32_16x16x32_bf16 v[88:91], v[72:75], v[180:183], 0
  v_mfma_f32_16x16x32_bf16 v[92:95], v[72:75], v[184:187], 0
  buffer_load_dwordx4 v101, s[68:71], s43 offen offset:1024 lds
  s_waitcnt lgkmcnt(2)
  v_mfma_f32_16x16x32_bf16 v[96:99], v[76:79], v[180:183], 0
  v_mfma_f32_16x16x32_bf16 v[108:111], v[76:79], v[184:187], 0
  s_waitcnt lgkmcnt(1)
  v_mfma_f32_16x16x32_bf16 v[112:115], v[80:83], v[180:183], 0
  v_mfma_f32_16x16x32_bf16 v[116:119], v[80:83], v[184:187], 0
  s_waitcnt lgkmcnt(0)
  v_mfma_f32_16x16x32_bf16 v[120:123], v[84:87], v[180:183], 0
  s_add_u32 m0, s28, 100352
  s_nop 0
  buffer_load_dwordx4 v102, s[68:71], s43 offen offset:0 lds
  v_mfma_f32_16x16x32_bf16 v[124:127], v[84:87], v[184:187], 0
  v_pk_mul_f32 v[128:129], v[88:89], v[188:189]
  v_pk_mul_f32 v[130:131], v[92:93], v[188:189]
  v_pk_fma_f32 v[128:129], v[92:93], v[192:193], v[128:129]
  v_pk_fma_f32 v[130:131], v[88:89], v[192:193], v[130:131] neg_lo:[0,1,0] neg_hi:[0,1,0]
  v_cvt_pk_bf16_f32 v72, v128, v130
  v_cvt_pk_bf16_f32 v73, v129, v131
  v_pk_mul_f32 v[128:129], v[90:91], v[190:191]
  v_pk_mul_f32 v[130:131], v[94:95], v[190:191]
  v_pk_fma_f32 v[128:129], v[94:95], v[194:195], v[128:129]
  v_pk_fma_f32 v[130:131], v[90:91], v[194:195], v[130:131] neg_lo:[0,1,0] neg_hi:[0,1,0]
  v_cvt_pk_bf16_f32 v74, v128, v130
  v_cvt_pk_bf16_f32 v75, v129, v131
  v_pk_mul_f32 v[128:129], v[96:97], v[188:189]
  v_pk_mul_f32 v[130:131], v[108:109], v[188:189]
  v_pk_fma_f32 v[128:129], v[108:109], v[192:193], v[128:129]
  v_pk_fma_f32 v[130:131], v[96:97], v[192:193], v[130:131] neg_lo:[0,1,0] neg_hi:[0,1,0]
  buffer_load_dwordx4 v103, s[68:71], s43 offen offset:1024 lds
  s_add_u32 s43, s43, 128
  s_and_b32 s43, s43, 0x3ff
  v_cvt_pk_bf16_f32 v76, v128, v130
  v_cvt_pk_bf16_f32 v77, v129, v131
  v_pk_mul_f32 v[128:129], v[98:99], v[190:191]
  v_pk_mul_f32 v[130:131], v[110:111], v[190:191]
  v_pk_fma_f32 v[128:129], v[110:111], v[194:195], v[128:129]
  v_pk_fma_f32 v[130:131], v[98:99], v[194:195], v[130:131] neg_lo:[0,1,0] neg_hi:[0,1,0]
  v_cvt_pk_bf16_f32 v78, v128, v130
  v_cvt_pk_bf16_f32 v79, v129, v131
  v_mfma_f32_16x16x32_bf16 v[88:91], a[224:227], v[72:75], 0
  v_mfma_f32_16x16x32_bf16 v[92:95], a[228:231], v[72:75], 0
  v_pk_mul_f32 v[128:129], v[112:113], v[188:189]
  v_pk_mul_f32 v[130:131], v[116:117], v[188:189]
  v_pk_fma_f32 v[128:129], v[116:117], v[192:193], v[128:129]
  v_pk_fma_f32 v[130:131], v[112:113], v[192:193], v[130:131] neg_lo:[0,1,0] neg_hi:[0,1,0]
  s_add_u32 m0, s28, 131072
  s_nop 0
  buffer_load_dwordx4 v100, s[64:67], s43 offen offset:0 lds
  v_cvt_pk_bf16_f32 v80, v128, v130
  v_cvt_pk_bf16_f32 v81, v129, v131
  v_pk_mul_f32 v[128:129], v[114:115], v[190:191]
  v_pk_mul_f32 v[130:131], v[118:119], v[190:191]
  v_pk_fma_f32 v[128:129], v[118:119], v[194:195], v[128:129]
  v_pk_fma_f32 v[130:131], v[114:115], v[194:195], v[130:131] neg_lo:[0,1,0] neg_hi:[0,1,0]
  v_cvt_pk_bf16_f32 v82, v128, v130
  v_cvt_pk_bf16_f32 v83, v129, v131
  v_mfma_f32_16x16x32_bf16 v[96:99], a[224:227], v[76:79], 0
  v_mfma_f32_16x16x32_bf16 v[108:111], a[228:231], v[76:79], 0
  v_pk_mul_f32 v[128:129], v[120:121], v[188:189]
  v_pk_mul_f32 v[130:131], v[124:125], v[188:189]
  v_pk_fma_f32 v[128:129], v[124:125], v[192:193], v[128:129]
  v_pk_fma_f32 v[130:131], v[120:121], v[192:193], v[130:131] neg_lo:[0,1,0] neg_hi:[0,1,0]
  buffer_load_dwordx4 v101, s[64:67], s43 offen offset:1024 lds
  v_cvt_pk_bf16_f32 v84, v128, v130
  v_cvt_pk_bf16_f32 v85, v129, v131
  v_pk_mul_f32 v[128:129], v[122:123], v[190:191]
  v_pk_mul_f32 v[130:131], v[126:127], v[190:191]
  v_pk_fma_f32 v[128:129], v[126:127], v[194:195], v[128:129]
  v_pk_fma_f32 v[130:131], v[122:123], v[194:195], v[130:131] neg_lo:[0,1,0] neg_hi:[0,1,0]
  v_cvt_pk_bf16_f32 v86, v128, v130
  v_cvt_pk_bf16_f32 v87, v129, v131
  v_mfma_f32_16x16x32_bf16 v[112:115], a[224:227], v[80:83], 0
  v_mfma_f32_16x16x32_bf16 v[116:119], a[228:231], v[80:83], 0
  v_mfma_f32_16x16x32_bf16 v[120:123], a[224:227], v[84:87], 0
  s_add_u32 m0, s28, 133120
  s_nop 0
  buffer_load_dwordx4 v102, s[64:67], s43 offen offset:0 lds
  v_mfma_f32_16x16x32_bf16 v[124:127], a[228:231], v[84:87], 0
  s_waitcnt vmcnt(7)
  s_barrier
  s_cmp_lg_u32 s3, 0
  s_cbranch_scc1 gated_mix__spectral_gfnet__ssm_conv_s5__prompt_kernel_skip37
  s_mov_b64 exec, 65535
  buffer_store_dword v5, v38, s[16:19], s57 offen sc1
  s_mov_b64 exec, -1
gated_mix__spectral_gfnet__ssm_conv_s5__prompt_kernel_skip37:
  s_cmp_eq_u32 s10, 0
  s_cbranch_scc1 gated_mix__spectral_gfnet__ssm_conv_s5__prompt_kernel_skip38
  v_pk_mul_f32 v[128:129], v[88:89], v[64:65]
  v_pk_mul_f32 v[130:131], v[92:93], v[64:65]
  v_pk_fma_f32 v[128:129], v[92:93], v[68:69], v[128:129] neg_lo:[0,1,0] neg_hi:[0,1,0]
  v_pk_fma_f32 v[130:131], v[88:89], v[68:69], v[130:131]
  v_cvt_pk_bf16_f32 v132, v128, v130
  v_cvt_pk_bf16_f32 v133, v129, v131
  v_pk_mul_f32 v[128:129], v[90:91], v[66:67]
  v_pk_mul_f32 v[130:131], v[94:95], v[66:67]
  v_pk_fma_f32 v[128:129], v[94:95], v[70:71], v[128:129] neg_lo:[0,1,0] neg_hi:[0,1,0]
  v_pk_fma_f32 v[130:131], v[90:91], v[70:71], v[130:131]
  v_cvt_pk_bf16_f32 v134, v128, v130
  v_cvt_pk_bf16_f32 v135, v129, v131
  s_nop 1
  v_mfma_f32_16x16x32_bf16 v[64:67], v[132:135], a[232:235], 0
  v_mfma_f32_16x16x32_bf16 v[68:71], v[132:135], a[236:239], 0
  s_nop 6
  v_pk_mul_f32 v[128:129], v[64:65], v[196:197]
  v_pk_mul_f32 v[130:131], v[68:69], v[196:197]
  v_pk_fma_f32 v[128:129], v[68:69], v[200:201], v[128:129] neg_lo:[0,1,0] neg_hi:[0,1,0]
  v_pk_fma_f32 v[130:131], v[64:65], v[200:201], v[130:131]
  v_cvt_pk_bf16_f32 v132, v128, v130
  v_cvt_pk_bf16_f32 v133, v129, v131
  v_pk_mul_f32 v[128:129], v[66:67], v[198:199]
  v_pk_mul_f32 v[130:131], v[70:71], v[198:199]
  v_pk_fma_f32 v[128:129], v[70:71], v[202:203], v[128:129] neg_lo:[0,1,0] neg_hi:[0,1,0]
  v_pk_fma_f32 v[130:131], v[66:67], v[202:203], v[130:131]
  v_cvt_pk_bf16_f32 v134, v128, v130
  v_cvt_pk_bf16_f32 v135, v129, v131
  s_nop 1
  v_mfma_f32_16x16x32_bf16 v[64:67], a[240:243], v[132:135], 0
  v_mfma_f32_16x16x32_bf16 v[68:71], a[244:247], v[132:135], 0
gated_mix__spectral_gfnet__ssm_conv_s5__prompt_kernel_skip38:
  v_pk_mul_f32 v[128:129], v[88:89], v[8:9]
  v_pk_mul_f32 v[130:131], v[92:93], v[8:9]
  v_pk_fma_f32 v[128:129], v[92:93], v[12:13], v[128:129] neg_lo:[0,1,0] neg_hi:[0,1,0]
  v_pk_fma_f32 v[130:131], v[88:89], v[12:13], v[130:131]
  v_cvt_pk_bf16_f32 v72, v128, v130
  v_cvt_pk_bf16_f32 v73, v129, v131
  v_pk_mul_f32 v[128:129], v[90:91], v[10:11]
  v_pk_mul_f32 v[130:131], v[94:95], v[10:11]
  v_pk_fma_f32 v[128:129], v[94:95], v[14:15], v[128:129] neg_lo:[0,1,0] neg_hi:[0,1,0]
  v_pk_fma_f32 v[130:131], v[90:91], v[14:15], v[130:131]
  v_cvt_pk_bf16_f32 v74, v128, v130
  buffer_load_dwordx4 v103, s[64:67], s43 offen offset:1024 lds
  v_cvt_pk_bf16_f32 v75, v129, v131
  v_pk_mul_f32 v[128:129], v[96:97], v[16:17]
  v_pk_mul_f32 v[130:131], v[108:109], v[16:17]
  v_pk_fma_f32 v[128:129], v[108:109], v[20:21], v[128:129] neg_lo:[0,1,0] neg_hi:[0,1,0]
  v_pk_fma_f32 v[130:131], v[96:97], v[20:21], v[130:131]
  v_cvt_pk_bf16_f32 v76, v128, v130
  v_cvt_pk_bf16_f32 v77, v129, v131
  v_pk_mul_f32 v[128:129], v[98:99], v[18:19]
  v_pk_mul_f32 v[130:131], v[110:111], v[18:19]
  v_pk_fma_f32 v[128:129], v[110:111], v[22:23], v[128:129] neg_lo:[0,1,0] neg_hi:[0,1,0]
  v_pk_fma_f32 v[130:131], v[98:99], v[22:23], v[130:131]
  v_cvt_pk_bf16_f32 v78, v128, v130
  v_cvt_pk_bf16_f32 v79, v129, v131
  v_mfma_f32_16x16x32_bf16 v[88:91], v[72:75], a[232:235], 0
  v_mfma_f32_16x16x32_bf16 v[92:95], v[72:75], a[236:239], 0
  s_add_u32 m0, s28, 65536
  s_nop 0
  buffer_load_dwordx4 v100, s[68:71], s43 offen offset:0 lds
  v_pk_mul_f32 v[128:129], v[112:113], v[40:41]
  v_pk_mul_f32 v[130:131], v[116:117], v[40:41]
  v_pk_fma_f32 v[128:129], v[116:117], v[44:45], v[128:129] neg_lo:[0,1,0] neg_hi:[0,1,0]
  v_pk_fma_f32 v[130:131], v[112:113], v[44:45], v[130:131]
  v_cvt_pk_bf16_f32 v80, v128, v130
  v_cvt_pk_bf16_f32 v81, v129, v131
  v_pk_mul_f32 v[128:129], v[114:115], v[42:43]
  v_pk_mul_f32 v[130:131], v[118:119], v[42:43]
  v_pk_fma_f32 v[128:129], v[118:119], v[46:47], v[128:129] neg_lo:[0,1,0] neg_hi:[0,1,0]
  v_pk_fma_f32 v[130:131], v[114:115], v[46:47], v[130:131]
  v_cvt_pk_bf16_f32 v82, v128, v130
  v_cvt_pk_bf16_f32 v83, v129, v131
  v_mfma_f32_16x16x32_bf16 v[96:99], v[76:79], a[232:235], 0
  v_mfma_f32_16x16x32_bf16 v[108:111], v[76:79], a[236:239], 0
  buffer_load_dwordx4 v101, s[68:71], s43 offen offset:1024 lds
  v_pk_mul_f32 v[128:129], v[120:121], v[48:49]
  v_pk_mul_f32 v[130:131], v[124:125], v[48:49]
  v_pk_fma_f32 v[128:129], v[124:125], v[52:53], v[128:129] neg_lo:[0,1,0] neg_hi:[0,1,0]
  v_pk_fma_f32 v[130:131], v[120:121], v[52:53], v[130:131]
  v_cvt_pk_bf16_f32 v84, v128, v130
  v_cvt_pk_bf16_f32 v85, v129, v131
  v_pk_mul_f32 v[128:129], v[122:123], v[50:51]
  v_pk_mul_f32 v[130:131], v[126:127], v[50:51]
  v_pk_fma_f32 v[128:129], v[126:127], v[54:55], v[128:129] neg_lo:[0,1,0] neg_hi:[0,1,0]
  v_pk_fma_f32 v[130:131], v[122:123], v[54:55], v[130:131]
  v_cvt_pk_bf16_f32 v86, v128, v130
  v_cvt_pk_bf16_f32 v87, v129, v131
  v_mfma_f32_16x16x32_bf16 v[112:115], v[80:83], a[232:235], 0
  v_mfma_f32_16x16x32_bf16 v[116:119], v[80:83], a[236:239], 0
  s_add_u32 m0, s28, 67584
  s_nop 0
  buffer_load_dwordx4 v102, s[68:71], s43 offen offset:0 lds
  v_mfma_f32_16x16x32_bf16 v[120:123], v[84:87], a[232:235], 0
  v_mfma_f32_16x16x32_bf16 v[124:127], v[84:87], a[236:239], 0
  v_pk_mul_f32 v[128:129], v[88:89], v[196:197]
  v_pk_mul_f32 v[130:131], v[92:93], v[196:197]
  v_pk_fma_f32 v[128:129], v[92:93], v[200:201], v[128:129] neg_lo:[0,1,0] neg_hi:[0,1,0]
  v_pk_fma_f32 v[130:131], v[88:89], v[200:201], v[130:131]
  v_cvt_pk_bf16_f32 v72, v128, v130
  v_cvt_pk_bf16_f32 v73, v129, v131
  v_pk_mul_f32 v[128:129], v[90:91], v[198:199]
  v_pk_mul_f32 v[130:131], v[94:95], v[198:199]
  v_pk_fma_f32 v[128:129], v[94:95], v[202:203], v[128:129] neg_lo:[0,1,0] neg_hi:[0,1,0]
  v_pk_fma_f32 v[130:131], v[90:91], v[202:203], v[130:131]
  v_cvt_pk_bf16_f32 v74, v128, v130
  v_cvt_pk_bf16_f32 v75, v129, v131
  buffer_load_dwordx4 v103, s[68:71], s43 offen offset:1024 lds
  s_add_u32 s43, s43, 128
  s_and_b32 s43, s43, 0x3ff
  v_pk_mul_f32 v[128:129], v[96:97], v[196:197]
  v_pk_mul_f32 v[130:131], v[108:109], v[196:197]
  v_pk_fma_f32 v[128:129], v[108:109], v[200:201], v[128:129] neg_lo:[0,1,0] neg_hi:[0,1,0]
  v_pk_fma_f32 v[130:131], v[96:97], v[200:201], v[130:131]
  v_cvt_pk_bf16_f32 v76, v128, v130
  v_cvt_pk_bf16_f32 v77, v129, v131
  v_pk_mul_f32 v[128:129], v[98:99], v[198:199]
  v_pk_mul_f32 v[130:131], v[110:111], v[198:199]
  v_pk_fma_f32 v[128:129], v[110:111], v[202:203], v[128:129] neg_lo:[0,1,0] neg_hi:[0,1,0]
  v_pk_fma_f32 v[130:131], v[98:99], v[202:203], v[130:131]
  v_cvt_pk_bf16_f32 v78, v128, v130
  v_cvt_pk_bf16_f32 v79, v129, v131
  v_mfma_f32_16x16x32_bf16 v[88:91], a[240:243], v[72:75], 0
  v_mfma_f32_16x16x32_bf16 v[92:95], a[244:247], v[72:75], 0
  s_add_u32 m0, s28, 114688
  s_nop 0
  buffer_load_dwordx4 v100, s[64:67], s43 offen offset:0 lds
  v_pk_mul_f32 v[128:129], v[112:113], v[196:197]
  v_pk_mul_f32 v[130:131], v[116:117], v[196:197]
  v_pk_fma_f32 v[128:129], v[116:117], v[200:201], v[128:129] neg_lo:[0,1,0] neg_hi:[0,1,0]
  v_pk_fma_f32 v[130:131], v[112:113], v[200:201], v[130:131]
  v_cvt_pk_bf16_f32 v80, v128, v130
  v_cvt_pk_bf16_f32 v81, v129, v131
  v_pk_mul_f32 v[128:129], v[114:115], v[198:199]
  v_pk_mul_f32 v[130:131], v[118:119], v[198:199]
  v_pk_fma_f32 v[128:129], v[118:119], v[202:203], v[128:129] neg_lo:[0,1,0] neg_hi:[0,1,0]
  v_pk_fma_f32 v[130:131], v[114:115], v[202:203], v[130:131]
  v_cvt_pk_bf16_f32 v82, v128, v130
  v_cvt_pk_bf16_f32 v83, v129, v131
  v_mfma_f32_16x16x32_bf16 v[96:99], a[240:243], v[76:79], 0
  v_mfma_f32_16x16x32_bf16 v[108:111], a[244:247], v[76:79], 0
  buffer_load_dwordx4 v101, s[64:67], s43 offen offset:1024 lds
  v_pk_mul_f32 v[128:129], v[120:121], v[196:197]
  v_pk_mul_f32 v[130:131], v[124:125], v[196:197]
  v_pk_fma_f32 v[128:129], v[124:125], v[200:201], v[128:129] neg_lo:[0,1,0] neg_hi:[0,1,0]
  v_pk_fma_f32 v[130:131], v[120:121], v[200:201], v[130:131]
  v_cvt_pk_bf16_f32 v84, v128, v130
  v_cvt_pk_bf16_f32 v85, v129, v131
  v_pk_mul_f32 v[128:129], v[122:123], v[198:199]
  v_pk_mul_f32 v[130:131], v[126:127], v[198:199]
  v_pk_fma_f32 v[128:129], v[126:127], v[202:203], v[128:129] neg_lo:[0,1,0] neg_hi:[0,1,0]
  v_pk_fma_f32 v[130:131], v[122:123], v[202:203], v[130:131]
  v_cvt_pk_bf16_f32 v86, v128, v130
  v_cvt_pk_bf16_f32 v87, v129, v131
  v_mfma_f32_16x16x32_bf16 v[112:115], a[240:243], v[80:83], 0
  v_mfma_f32_16x16x32_bf16 v[116:119], a[244:247], v[80:83], 0
  s_add_u32 m0, s28, 116736
  s_nop 0
  buffer_load_dwordx4 v102, s[64:67], s43 offen offset:0 lds
  v_mfma_f32_16x16x32_bf16 v[120:123], a[240:243], v[84:87], 0
  v_mfma_f32_16x16x32_bf16 v[124:127], a[244:247], v[84:87], 0
  v_lshlrev_b32 v56, 12, v3
  v_lshl_add_u32 v56, v2, 4, v56
  s_lshl_b32 s29, s3, 8
  s_add_u32 s29, s29, 147456
  v_add_u32 v56, s29, v56
  s_sub_u32 s29, s10, 1
  s_or_b32 s29, s29, s3
  s_cmp_lg_u32 s29, 0
  s_cbranch_scc1 gated_mix__spectral_gfnet__ssm_conv_s5__prompt_kernel_skip39
  v_mov_b32 v92, v68
  v_mov_b32 v93, v69
  v_mov_b32 v94, v70
  v_mov_b32 v95, v71
gated_mix__spectral_gfnet__ssm_conv_s5__prompt_kernel_skip39:
  v_cvt_pk_bf16_f32 v72, v88, v92
  v_cvt_pk_bf16_f32 v73, v96, v108
  v_cvt_pk_bf16_f32 v74, v112, v116
  buffer_load_dwordx4 v103, s[64:67], s43 offen offset:1024 lds
  v_cvt_pk_bf16_f32 v75, v120, v124
  ds_write_b128 v56, v[72:75] offset:0
  v_cvt_pk_bf16_f32 v76, v89, v93
  v_cvt_pk_bf16_f32 v77, v97, v109
  v_cvt_pk_bf16_f32 v78, v113, v117
  v_cvt_pk_bf16_f32 v79, v121, v125
  ds_write_b128 v56, v[76:79] offset:1024
  v_cvt_pk_bf16_f32 v80, v90, v94
  v_cvt_pk_bf16_f32 v81, v98, v110
  v_cvt_pk_bf16_f32 v82, v114, v118
  v_cvt_pk_bf16_f32 v83, v122, v126
  ds_write_b128 v56, v[80:83] offset:2048
  v_cvt_pk_bf16_f32 v84, v91, v95
  v_cvt_pk_bf16_f32 v85, v99, v111
  v_cvt_pk_bf16_f32 v86, v115, v119
  v_cvt_pk_bf16_f32 v87, v123, v127
  ds_write_b128 v56, v[84:87] offset:3072
  s_add_u32 m0, s28, 0
  s_nop 0
  buffer_load_dwordx4 v100, s[68:71], s43 offen offset:0 lds
  buffer_load_dwordx4 v101, s[68:71], s43 offen offset:1024 lds
  s_add_u32 m0, s28, 2048
  s_nop 0
  buffer_load_dwordx4 v102, s[68:71], s43 offen offset:0 lds
  buffer_load_dwordx4 v103, s[68:71], s43 offen offset:1024 lds
  s_add_u32 s43, s43, 128
  s_and_b32 s43, s43, 0x3ff
  s_add_u32 m0, s28, 16384
  s_nop 0
  buffer_load_dwordx4 v100, s[64:67], s43 offen offset:0 lds
  buffer_load_dwordx4 v101, s[64:67], s43 offen offset:1024 lds
  s_add_u32 m0, s28, 18432
  s_nop 0
  buffer_load_dwordx4 v102, s[64:67], s43 offen offset:0 lds
  buffer_load_dwordx4 v103, s[64:67], s43 offen offset:1024 lds
  s_waitcnt lgkmcnt(0)
  s_barrier
  s_lshl_b32 s29, s3, 12
  s_add_u32 s29, s29, 147456
  v_lshl_add_u32 v56, v1, 4, s29
  ds_read_b128 v[8:11], v56 offset:0
  ds_read_b128 v[12:15], v56 offset:1024
  ds_read_b128 v[16:19], v56 offset:2048
  ds_read_b128 v[20:23], v56 offset:3072
  s_mov_b32 s29, 1048576
  v_mul_lo_u32 v56, v3, s29
  v_lshl_add_u32 v56, v2, 2, v56
  s_mul_i32 s6, s3, 65536
  s_lshr_b32 s29, s37, 4
  s_lshl_b32 s29, s29, 12
  s_add_u32 s6, s6, s29
  s_lshl_b32 s29, s36, 10
  s_add_u32 s6, s6, s29
  s_and_b32 s29, s37, 15
  s_lshl_b32 s29, s29, 6
  s_add_u32 s6, s6, s29
  s_waitcnt lgkmcnt(3)
  v_mfma_f32_16x16x32_bf16 v[40:43], a[248:251], v[8:11], 0
  v_mfma_f32_16x16x32_bf16 v[44:47], a[252:255], v[8:11], 0
  s_waitcnt lgkmcnt(2)
  v_mfma_f32_16x16x32_bf16 v[48:51], a[248:251], v[12:15], 0
  v_mfma_f32_16x16x32_bf16 v[52:55], a[252:255], v[12:15], 0
  s_waitcnt lgkmcnt(1)
  v_mfma_f32_16x16x32_bf16 v[64:67], a[248:251], v[16:19], 0
  v_mfma_f32_16x16x32_bf16 v[68:71], a[252:255], v[16:19], 0
  s_waitcnt lgkmcnt(0)
  v_mfma_f32_16x16x32_bf16 v[72:75], a[248:251], v[20:23], 0
  v_mfma_f32_16x16x32_bf16 v[76:79], a[252:255], v[20:23], 0
  v_cvt_pk_bf16_f32 v8, v40, v44
  v_cvt_pk_bf16_f32 v9, v41, v45
  v_cvt_pk_bf16_f32 v10, v42, v46
  v_cvt_pk_bf16_f32 v11, v43, v47
  v_cvt_pk_bf16_f32 v12, v48, v52
  v_cvt_pk_bf16_f32 v13, v49, v53
  v_cvt_pk_bf16_f32 v14, v50, v54
  v_cvt_pk_bf16_f32 v15, v51, v55
  v_cvt_pk_bf16_f32 v16, v64, v68
  v_cvt_pk_bf16_f32 v17, v65, v69
  v_cvt_pk_bf16_f32 v18, v66, v70
  v_cvt_pk_bf16_f32 v19, v67, v71
  v_cvt_pk_bf16_f32 v20, v72, v76
  v_cvt_pk_bf16_f32 v21, v73, v77
  v_cvt_pk_bf16_f32 v22, v74, v78
  v_cvt_pk_bf16_f32 v23, v75, v79
  s_mov_b64 exec, 0xffffffff
  buffer_load_dword v39, v6, s[16:19], s57 offen sc1
  s_mov_b64 exec, -1
  s_waitcnt vmcnt(21)
  ds_read_b128 a[48:51], v106 offset:32768
  ds_read_b128 a[52:55], v107 offset:32768
  ds_read_b128 a[56:59], v106 offset:34816
  ds_read_b128 a[60:63], v107 offset:34816
  v_xor_b32 v106, 0x30000, v106
  v_xor_b32 v107, 0x30000, v107
  s_waitcnt vmcnt(17)
  ds_read_b128 a[64:67], v106 offset:0
  ds_read_b128 a[68:71], v107 offset:0
  ds_read_b128 a[72:75], v106 offset:2048
  ds_read_b128 a[76:79], v107 offset:2048
  v_xor_b32 v106, 0x30000, v106
  v_xor_b32 v107, 0x30000, v107
  s_waitcnt vmcnt(13)
  ds_read_b128 a[80:83], v106 offset:0
  ds_read_b128 a[84:87], v107 offset:0
  ds_read_b128 a[88:91], v106 offset:2048
  ds_read_b128 a[92:95], v107 offset:2048
  s_waitcnt vmcnt(9)
  ds_read_b128 a[96:99], v106 offset:49152
  ds_read_b128 a[100:103], v107 offset:49152
  ds_read_b128 a[104:107], v106 offset:51200
  ds_read_b128 a[108:111], v107 offset:51200
  s_waitcnt vmcnt(5)
  ds_read_b128 a[112:115], v104 offset:0
  ds_read_b128 a[116:119], v105 offset:0
  ds_read_b128 a[120:123], v104 offset:2048
  ds_read_b128 a[124:127], v105 offset:2048
  s_waitcnt vmcnt(1)
  ds_read_b128 a[128:131], v104 offset:16384
  ds_read_b128 a[132:135], v105 offset:16384
  ds_read_b128 a[136:139], v104 offset:18432
  ds_read_b128 a[140:143], v105 offset:18432
  buffer_store_dword v8, v56, s[88:91], s6 offen sc1
  s_add_u32 s6, s6, 262144
  buffer_store_dword v9, v56, s[88:91], s6 offen sc1
  s_add_u32 s6, s6, 262144
  buffer_store_dword v10, v56, s[88:91], s6 offen sc1
  s_add_u32 s6, s6, 262144
  buffer_store_dword v11, v56, s[88:91], s6 offen sc1
  s_sub_u32 s6, s6, 770048
  buffer_store_dword v12, v56, s[88:91], s6 offen sc1
  s_add_u32 s6, s6, 262144
  buffer_store_dword v13, v56, s[88:91], s6 offen sc1
  s_add_u32 s6, s6, 262144
  buffer_store_dword v14, v56, s[88:91], s6 offen sc1
  s_add_u32 s6, s6, 262144
  buffer_store_dword v15, v56, s[88:91], s6 offen sc1
  s_sub_u32 s6, s6, 770048
  buffer_store_dword v16, v56, s[88:91], s6 offen sc1
  s_add_u32 s6, s6, 262144
  buffer_store_dword v17, v56, s[88:91], s6 offen sc1
  s_add_u32 s6, s6, 262144
  buffer_store_dword v18, v56, s[88:91], s6 offen sc1
  s_add_u32 s6, s6, 262144
  buffer_store_dword v19, v56, s[88:91], s6 offen sc1
  s_sub_u32 s6, s6, 770048
  buffer_store_dword v20, v56, s[88:91], s6 offen sc1
  s_add_u32 s6, s6, 262144
  buffer_store_dword v21, v56, s[88:91], s6 offen sc1
  s_add_u32 s6, s6, 262144
  buffer_store_dword v22, v56, s[88:91], s6 offen sc1
  s_add_u32 s6, s6, 262144
  buffer_store_dword v23, v56, s[88:91], s6 offen sc1
  v_mfma_f32_16x16x16_bf16 v[8:11], v[166:167], v[60:61], 0
  v_mfma_f32_16x16x16_bf16 v[12:15], v[24:25], v[60:61], 0
  v_mfma_f32_16x16x16_bf16 v[16:19], v[26:27], v[60:61], 0
  v_mfma_f32_16x16x16_bf16 v[20:23], v[28:29], v[60:61], 0
  v_mfma_f32_16x16x16_bf16 v[64:67], v[30:31], v[60:61], 0
  v_mfma_f32_16x16x16_bf16 v[68:71], v[32:33], v[60:61], 0
  v_mfma_f32_16x16x16_bf16 v[72:75], v[34:35], v[60:61], 0
  v_mfma_f32_16x16x16_bf16 v[76:79], v[36:37], v[60:61], 0
  s_waitcnt vmcnt(16)
  v_cmp_ne_u32 vcc, 1, v39
  s_nop 0
  s_and_b64 vcc, vcc, 0xffffffff
  s_cbranch_vccz gated_mix__spectral_gfnet__ssm_conv_s5__prompt_kernel_skip40
  s_mov_b32 s29, 0
gated_mix__spectral_gfnet__ssm_conv_s5__prompt_kernel_poll41:
  s_sleep 5
  s_mov_b64 exec, 0xffffffff
  buffer_load_dword v39, v6, s[16:19], s57 offen sc1
  s_mov_b64 exec, -1
  s_waitcnt vmcnt(0)
  v_cmp_ne_u32 vcc, 1, v39
  s_nop 0
  s_and_b64 vcc, vcc, 0xffffffff
  s_cbranch_vccz gated_mix__spectral_gfnet__ssm_conv_s5__prompt_kernel_pollout42
  s_add_u32 s29, s29, 1
  s_cmp_lt_u32 s29, 1048576
  s_cbranch_scc1 gated_mix__spectral_gfnet__ssm_conv_s5__prompt_kernel_poll41
gated_mix__spectral_gfnet__ssm_conv_s5__prompt_kernel_pollout42:
gated_mix__spectral_gfnet__ssm_conv_s5__prompt_kernel_skip40:
  s_waitcnt lgkmcnt(0)
  s_barrier
  s_add_u32 m0, s83, 0
  s_nop 0
  buffer_load_dwordx4 v58, s[84:87], s82 offen offset:0 sc1 lds
  buffer_load_dwordx4 v58, s[84:87], s82 offen offset:1024 sc1 lds
  buffer_load_dwordx4 v58, s[84:87], s82 offen offset:2048 sc1 lds
  s_and_b32 s29, s41, 8
  s_lshl_b32 s29, s29, 2
  v_lshrrev_b32 v6, 1, v3
  v_lshl_add_u32 v6, v6, 3, s29
  v_and_b32 v56, 1, v3
  v_lshl_add_u32 v6, v56, 1, v6
  v_cmp_eq_u32 vcc, 0, v6
  v_cvt_f32_u32 v57, v6
  v_bfe_i32 v36, v3, 0, 1
  v_and_b32 v36, 0x80008000, v36
  v_xor_b32 v37, 0x80000000, v36
  s_lshl_b32 s29, s29, 1
  buffer_load_dwordx4 v58, s[84:87], s82 offen offset:3072 sc1 lds
  s_add_u32 s82, s82, 32768
  s_and_b32 s82, s82, 0x3ffff
  s_xor_b32 s29, s29, 64
  v_add_u32 v6, s29, v2
  v_cvt_f32_u32 v6, v6
  v_mul_f32 v6, 0x3c000000, v6
  v_mul_f32 v56, v6, v57
  v_fmamk_f32 v184, v6, 0x0, v56
  v_fmamk_f32 v185, v6, 0x3f800000, v56
  v_fmamk_f32 v186, v6, 0x40800000, v56
  v_fmamk_f32 v187, v6, 0x40a00000, v56
  v_fmamk_f32 v188, v6, 0x41800000, v56
  v_fmamk_f32 v189, v6, 0x41880000, v56
  v_fmamk_f32 v190, v6, 0x41a00000, v56
  s_add_u32 m0, s83, 16384
  s_nop 0
  buffer_load_dwordx4 v58, s[84:87], s82 offen offset:0 sc1 lds
  v_fmamk_f32 v191, v6, 0x41a80000, v56
  v_cos_f32 v192, v184
  v_cos_f32 v193, v185
  v_cos_f32 v194, v186
  v_cos_f32 v195, v187
  v_cos_f32 v196, v188
  v_cos_f32 v197, v189
  buffer_load_dwordx4 v58, s[84:87], s82 offen offset:1024 sc1 lds
  v_cos_f32 v198, v190
  v_cos_f32 v199, v191
  v_sin_f32 v184, v184
  v_sin_f32 v185, v185
  v_sin_f32 v186, v186
  v_sin_f32 v187, v187
  buffer_load_dwordx4 v58, s[84:87], s82 offen offset:2048 sc1 lds
  v_sin_f32 v188, v188
  v_sin_f32 v189, v189
  v_sin_f32 v190, v190
  v_sin_f32 v191, v191
  v_lshlrev_b32 v56, 31, v2
  v_or_b32 v56, 0x3f003f00, v56
  v_cvt_pk_bf16_f32 v24, v192, -v184
  v_cvt_pk_bf16_f32 v25, v193, -v185
  buffer_load_dwordx4 v58, s[84:87], s82 offen offset:3072 sc1 lds
  s_add_u32 s82, s82, 32768
  s_and_b32 s82, s82, 0x3ffff
  v_cvt_pk_bf16_f32 v26, v194, -v186
  v_cvt_pk_bf16_f32 v27, v195, -v187
  v_cvt_pk_bf16_f32 v28, v196, -v188
  v_cvt_pk_bf16_f32 v29, v197, -v189
  v_cvt_pk_bf16_f32 v30, v198, -v190
  v_cvt_pk_bf16_f32 v31, v199, -v191
  v_cndmask_b32 v24, v24, v56, vcc
  v_xor_b32 v164, v36, v24
  v_alignbit_b32 v165, v25, v25, 16
  v_xor_b32 v165, v37, v165
  v_xor_b32 v166, v36, v26
  v_alignbit_b32 v167, v27, v27, 16
  s_add_u32 m0, s28, 98304
  s_nop 0
  buffer_load_dwordx4 v100, s[68:71], s43 offen offset:0 lds
  v_xor_b32 v167, v37, v167
  v_xor_b32 v172, v36, v28
  v_alignbit_b32 v173, v29, v29, 16
  v_xor_b32 v173, v37, v173
  v_xor_b32 v174, v36, v30
  v_alignbit_b32 v175, v31, v31, 16
  v_xor_b32 v175, v37, v175
  v_add_f32 v6, 0x3e000000, v6
  v_mul_f32 v56, v6, v57
  v_fmamk_f32 v184, v6, 0x0, v56
  v_fmamk_f32 v185, v6, 0x3f800000, v56
  v_fmamk_f32 v186, v6, 0x40800000, v56
  buffer_load_dwordx4 v101, s[68:71], s43 offen offset:1024 lds
  v_fmamk_f32 v187, v6, 0x40a00000, v56
  v_fmamk_f32 v188, v6, 0x41800000, v56
  v_fmamk_f32 v189, v6, 0x41880000, v56
  v_fmamk_f32 v190, v6, 0x41a00000, v56
  v_fmamk_f32 v191, v6, 0x41a80000, v56
  v_cos_f32 v192, v184
  v_cos_f32 v193, v185
  v_cos_f32 v194, v186
  v_cos_f32 v195, v187
  s_add_u32 m0, s28, 100352
  s_nop 0
  buffer_load_dwordx4 v102, s[68:71], s43 offen offset:0 lds
  v_cos_f32 v196, v188
  v_cos_f32 v197, v189
  v_cos_f32 v198, v190
  v_cos_f32 v199, v191
  v_sin_f32 v184, v184
  v_sin_f32 v185, v185
  buffer_load_dwordx4 v103, s[68:71], s43 offen offset:1024 lds
  s_add_u32 s43, s43, 128
  s_and_b32 s43, s43, 0x3ff
  v_sin_f32 v186, v186
  v_sin_f32 v187, v187
  v_sin_f32 v188, v188
  v_sin_f32 v189, v189
  v_sin_f32 v190, v190
  v_sin_f32 v191, v191
  v_lshlrev_b32 v56, 31, v2
  v_or_b32 v56, 0x3f003f00, v56
  v_cvt_pk_bf16_f32 v32, v192, -v184
  v_cvt_pk_bf16_f32 v33, v193, -v185
  v_cvt_pk_bf16_f32 v34, v194, -v186
  v_cvt_pk_bf16_f32 v35, v195, -v187
  v_cvt_pk_bf16_f32 v60, v196, -v188
  v_cvt_pk_bf16_f32 v61, v197, -v189
  v_cvt_pk_bf16_f32 v62, v198, -v190
  v_cvt_pk_bf16_f32 v63, v199, -v191
  v_cndmask_b32 v32, v32, v56, vcc
  v_xor_b32 v176, v36, v32
  v_alignbit_b32 v177, v33, v33, 16
  v_xor_b32 v177, v37, v177
  v_xor_b32 v178, v36, v34
  v_alignbit_b32 v179, v35, v35, 16
  v_xor_b32 v179, v37, v179
  v_xor_b32 v180, v36, v60
  v_alignbit_b32 v181, v61, v61, 16
  v_xor_b32 v181, v37, v181
  v_xor_b32 v182, v36, v62
  v_alignbit_b32 v183, v63, v63, 16
  v_xor_b32 v183, v37, v183
  s_waitcnt vmcnt(12)
  s_waitcnt vmcnt(8)
  s_barrier
  ds_read_b64_tr_b16 v[96:97], v224 offset:0
  ds_read_b64_tr_b16 v[98:99], v225 offset:0
  ds_read_b64_tr_b16 v[108:109], v224 offset:2048
  ds_read_b64_tr_b16 v[110:111], v225 offset:2048
  ds_read_b64_tr_b16 v[112:113], v224 offset:4096
  ds_read_b64_tr_b16 v[114:115], v225 offset:4096
  ds_read_b64_tr_b16 v[116:117], v224 offset:6144
  ds_read_b64_tr_b16 v[118:119], v225 offset:6144
  ds_read_b64_tr_b16 v[120:121], v224 offset:256
  ds_read_b64_tr_b16 v[122:123], v225 offset:256
  ds_read_b64_tr_b16 v[124:125], v224 offset:2304
  ds_read_b64_tr_b16 v[126:127], v225 offset:2304
  ds_read_b64_tr_b16 v[128:129], v224 offset:4352
  ds_read_b64_tr_b16 v[130:131], v225 offset:4352
  ds_read_b64_tr_b16 v[132:133], v224 offset:6400
  ds_read_b64_tr_b16 v[134:135], v225 offset:6400
  s_cmp_lg_u32 s3, 0
  s_cbranch_scc1 gated_mix__spectral_gfnet__ssm_conv_s5__prompt_kernel_skip43
  s_mov_b64 exec, 1
  buffer_store_dword v5, v59, s[16:19], s56 offen sc1
  s_mov_b64 exec, -1
gated_mix__spectral_gfnet__ssm_conv_s5__prompt_kernel_skip43:
  s_waitcnt lgkmcnt(0)
  v_mfma_f32_16x16x32_bf16 v[8:11], v[96:99], a[0:3], v[8:11]
  ds_read_b64_tr_b16 v[136:137], v224 offset:8192
  ds_read_b64_tr_b16 v[138:139], v225 offset:8192
  v_mfma_f32_16x16x32_bf16 v[40:43], v[96:99], a[8:11], 0
  ds_read_b64_tr_b16 v[140:141], v224 offset:10240
  ds_read_b64_tr_b16 v[142:143], v225 offset:10240
  v_mfma_f32_16x16x32_bf16 v[44:47], v[108:111], a[8:11], 0
  ds_read_b64_tr_b16 v[144:145], v224 offset:12288
  ds_read_b64_tr_b16 v[146:147], v225 offset:12288
  v_mfma_f32_16x16x32_bf16 v[12:15], v[108:111], a[0:3], v[12:15]
  ds_read_b64_tr_b16 v[148:149], v224 offset:14336
  ds_read_b64_tr_b16 v[150:151], v225 offset:14336
  v_mfma_f32_16x16x32_bf16 v[16:19], v[112:115], a[0:3], v[16:19]
  ds_read_b64_tr_b16 v[152:153], v224 offset:8448
  ds_read_b64_tr_b16 v[154:155], v225 offset:8448
  v_mfma_f32_16x16x32_bf16 v[48:51], v[112:115], a[8:11], 0
  ds_read_b64_tr_b16 v[156:157], v224 offset:10496
  ds_read_b64_tr_b16 v[158:159], v225 offset:10496
  v_mfma_f32_16x16x32_bf16 v[52:55], v[116:119], a[8:11], 0
  ds_read_b64_tr_b16 v[160:161], v224 offset:12544
  ds_read_b64_tr_b16 v[162:163], v225 offset:12544
  v_mfma_f32_16x16x32_bf16 v[20:23], v[116:119], a[0:3], v[20:23]
  ds_read_b64_tr_b16 v[168:169], v224 offset:14592
  ds_read_b64_tr_b16 v[170:171], v225 offset:14592
  v_mfma_f32_16x16x32_bf16 v[8:11], v[120:123], a[4:7], v[8:11]
  s_add_u32 m0, s83, 32768
  s_nop 0
  buffer_load_dwordx4 v58, s[84:87], s82 offen offset:0 sc1 lds
  s_mov_b32 s12, s30
  s_mov_b32 s13, s31
  v_mfma_f32_16x16x32_bf16 v[40:43], v[120:123], a[12:15], v[40:43]
  s_mov_b32 s14, 8388608
  s_mov_b32 s15, 0x20000
  v_mfma_f32_16x16x32_bf16 v[44:47], v[124:127], a[12:15], v[44:47]
  buffer_load_dwordx4 v58, s[84:87], s82 offen offset:1024 sc1 lds
  s_mov_b32 s20, s34
  s_mov_b32 s21, s35
  v_mfma_f32_16x16x32_bf16 v[12:15], v[124:127], a[4:7], v[12:15]
  s_mov_b32 s22, 4194304
  s_mov_b32 s23, 0x20000
  v_mfma_f32_16x16x32_bf16 v[16:19], v[128:131], a[4:7], v[16:19]
  buffer_load_dwordx4 v58, s[84:87], s82 offen offset:2048 sc1 lds
  v_lshlrev_b32 v36, 4, v1
  v_lshrrev_b32 v39, 5, v1
  v_mfma_f32_16x16x32_bf16 v[48:51], v[128:131], a[12:15], v[48:51]
  v_lshlrev_b32 v6, 9, v39
  v_lshlrev_b32 v37, 7, v39
  v_mfma_f32_16x16x32_bf16 v[52:55], v[132:135], a[12:15], v[52:55]
  buffer_load_dwordx4 v58, s[84:87], s82 offen offset:3072 sc1 lds
  s_add_u32 s82, s82, 32768
  s_and_b32 s82, s82, 0x3ffff
  v_bfe_u32 v39, v1, 3, 2
  v_lshl_or_b32 v6, v39, 6, v6
  v_mfma_f32_16x16x32_bf16 v[20:23], v[132:135], a[4:7], v[20:23]
  v_and_b32 v39, 3, v1
  v_lshl_or_b32 v6, v39, 4, v6
  s_waitcnt vmcnt(8) lgkmcnt(0)
  s_barrier
  v_mfma_f32_16x16x32_bf16 v[8:11], v[136:139], a[16:19], v[8:11]
  ds_read_b64_tr_b16 v[96:97], v224 offset:16384
  ds_read_b64_tr_b16 v[98:99], v225 offset:16384
  v_mfma_f32_16x16x32_bf16 v[40:43], v[136:139], a[24:27], v[40:43]
  ds_read_b64_tr_b16 v[108:109], v224 offset:18432
  ds_read_b64_tr_b16 v[110:111], v225 offset:18432
  v_mfma_f32_16x16x32_bf16 v[44:47], v[140:143], a[24:27], v[44:47]
  ds_read_b64_tr_b16 v[112:113], v224 offset:20480
  ds_read_b64_tr_b16 v[114:115], v225 offset:20480
  v_mfma_f32_16x16x32_bf16 v[12:15], v[140:143], a[16:19], v[12:15]
  ds_read_b64_tr_b16 v[116:117], v224 offset:22528
  ds_read_b64_tr_b16 v[118:119], v225 offset:22528
  v_mfma_f32_16x16x32_bf16 v[16:19], v[144:147], a[16:19], v[16:19]
  ds_read_b64_tr_b16 v[120:121], v224 offset:16640
  ds_read_b64_tr_b16 v[122:123], v225 offset:16640
  v_mfma_f32_16x16x32_bf16 v[48:51], v[144:147], a[24:27], v[48:51]
  ds_read_b64_tr_b16 v[124:125], v224 offset:18688
  ds_read_b64_tr_b16 v[126:127], v225 offset:18688
  v_mfma_f32_16x16x32_bf16 v[52:55], v[148:151], a[24:27], v[52:55]
  ds_read_b64_tr_b16 v[128:129], v224 offset:20736
  ds_read_b64_tr_b16 v[130:131], v225 offset:20736
  v_mfma_f32_16x16x32_bf16 v[20:23], v[148:151], a[16:19], v[20:23]
  ds_read_b64_tr_b16 v[132:133], v224 offset:22784
  ds_read_b64_tr_b16 v[134:135], v225 offset:22784
  v_mfma_f32_16x16x32_bf16 v[8:11], v[152:155], a[20:23], v[8:11]
  s_add_u32 m0, s28, 114688
  s_nop 0
  buffer_load_dwordx4 v100, s[64:67], s43 offen offset:0 lds
  v_and_b32 v39, 4, v1
  v_lshl_or_b32 v6, v39, 1, v6
  v_mfma_f32_16x16x32_bf16 v[40:43], v[152:155], a[28:31], v[40:43]
  s_lshl_b32 s9, s3, 12
  s_add_u32 s9, s9, 131072
  v_mfma_f32_16x16x32_bf16 v[44:47], v[156:159], a[28:31], v[44:47]
  buffer_load_dwordx4 v101, s[64:67], s43 offen offset:1024 lds
  v_add_u32 v6, s9, v6
  v_and_or_b32 v37, v1, 16, v37
  v_mfma_f32_16x16x32_bf16 v[12:15], v[156:159], a[20:23], v[12:15]
  s_lshl_b32 s9, s41, 6
  v_lshl_add_u32 v56, v2, 2, s9
  v_mfma_f32_16x16x32_bf16 v[16:19], v[160:163], a[20:23], v[16:19]
  s_add_u32 m0, s28, 116736
  s_nop 0
  buffer_load_dwordx4 v102, s[64:67], s43 offen offset:0 lds
  v_lshl_or_b32 v56, v3, 18, v56
  v_xor_b32 v57, 512, v56
  v_mfma_f32_16x16x32_bf16 v[48:51], v[160:163], a[28:31], v[48:51]
  s_lshr_b32 s9, s41, 3
  s_lshl_b32 s29, s9, 10
  v_mfma_f32_16x16x32_bf16 v[52:55], v[168:171], a[28:31], v[52:55]
  buffer_load_dwordx4 v103, s[64:67], s43 offen offset:1024 lds
  s_add_u32 s29, s29, s40
  s_lshl2_add_u32 s29, s29, s3
  v_mfma_f32_16x16x32_bf16 v[20:23], v[168:171], a[20:23], v[20:23]
  s_lshl_b32 s29, s29, 10
  s_xor_b32 s6, s9, 1
  s_waitcnt lgkmcnt(0)
  v_mfma_f32_16x16x32_bf16 v[8:11], v[96:99], a[32:35], v[8:11]
  ds_read_b64_tr_b16 v[136:137], v224 offset:24576
  ds_read_b64_tr_b16 v[138:139], v225 offset:24576
  v_mfma_f32_16x16x32_bf16 v[40:43], v[96:99], a[40:43], v[40:43]
  ds_read_b64_tr_b16 v[140:141], v224 offset:26624
  ds_read_b64_tr_b16 v[142:143], v225 offset:26624
  v_mfma_f32_16x16x32_bf16 v[44:47], v[108:111], a[40:43], v[44:47]
  ds_read_b64_tr_b16 v[144:145], v224 offset:28672
  ds_read_b64_tr_b16 v[146:147], v225 offset:28672
  v_mfma_f32_16x16x32_bf16 v[12:15], v[108:111], a[32:35], v[12:15]
  ds_read_b64_tr_b16 v[148:149], v224 offset:30720
  ds_read_b64_tr_b16 v[150:151], v225 offset:30720
  v_mfma_f32_16x16x32_bf16 v[16:19], v[112:115], a[32:35], v[16:19]
  ds_read_b64_tr_b16 v[152:153], v224 offset:24832
  ds_read_b64_tr_b16 v[154:155], v225 offset:24832
  v_mfma_f32_16x16x32_bf16 v[48:51], v[112:115], a[40:43], v[48:51]
  ds_read_b64_tr_b16 v[156:157], v224 offset:26880
  ds_read_b64_tr_b16 v[158:159], v225 offset:26880
  v_mfma_f32_16x16x32_bf16 v[52:55], v[116:119], a[40:43], v[52:55]
  ds_read_b64_tr_b16 v[160:161], v224 offset:28928
  ds_read_b64_tr_b16 v[162:163], v225 offset:28928
  v_mfma_f32_16x16x32_bf16 v[20:23], v[116:119], a[32:35], v[20:23]
  ds_read_b64_tr_b16 v[168:169], v224 offset:30976
  ds_read_b64_tr_b16 v[170:171], v225 offset:30976
  v_mfma_f32_16x16x32_bf16 v[8:11], v[120:123], a[36:39], v[8:11]
  s_add_u32 m0, s83, 49152
  s_nop 0
  buffer_load_dwordx4 v58, s[84:87], s82 offen offset:0 sc1 lds
  s_lshl1_add_u32 s6, s40, s6
  s_lshl_b32 s6, s6, 10
  v_mfma_f32_16x16x32_bf16 v[40:43], v[120:123], a[44:47], v[40:43]
  s_lshl4_add_u32 s7, s40, s41
  s_and_b32 s8, s3, 2
  v_mfma_f32_16x16x32_bf16 v[44:47], v[124:127], a[44:47], v[44:47]
  buffer_load_dwordx4 v58, s[84:87], s82 offen offset:1024 sc1 lds
  s_lshl_b32 s8, s8, 2
  s_xor_b32 s8, s8, s7
  v_mfma_f32_16x16x32_bf16 v[12:15], v[124:127], a[36:39], v[12:15]
  s_lshl1_add_u32 s8, s8, s9
  s_and_b32 s9, s3, 1
  v_mfma_f32_16x16x32_bf16 v[16:19], v[128:131], a[36:39], v[16:19]
  buffer_load_dwordx4 v58, s[84:87], s82 offen offset:2048 sc1 lds
  s_lshl1_add_u32 s8, s8, s9
  s_lshl_b32 s8, s8, 12
  v_mfma_f32_16x16x32_bf16 v[48:51], v[128:131], a[44:47], v[48:51]
  s_lshl2_add_u32 s7, s7, s3
  s_lshl_b32 s7, s7, 13
  v_mfma_f32_16x16x32_bf16 v[52:55], v[132:135], a[44:47], v[52:55]
  buffer_load_dwordx4 v58, s[84:87], s82 offen offset:3072 sc1 lds
  s_add_u32 s82, s82, 32768
  s_and_b32 s82, s82, 0x3ffff
  s_lshr_b32 s9, s41, 3
  s_or_b32 s9, s9, s3
  v_mfma_f32_16x16x32_bf16 v[20:23], v[132:135], a[36:39], v[20:23]
  s_and_b32 s9, s9, 1
  s_lshr_b32 s7, s7, 1
  s_waitcnt vmcnt(12)
  ds_read_b128 a[144:147], v106 offset:32768
  ds_read_b128 a[148:151], v107 offset:32768
  ds_read_b128 a[152:155], v106 offset:34816
  ds_read_b128 a[156:159], v107 offset:34816
  s_waitcnt vmcnt(8) lgkmcnt(4)
  s_barrier
  v_mfma_f32_16x16x32_bf16 v[8:11], v[136:139], a[48:51], v[8:11]
  ds_read_b64_tr_b16 v[96:97], v224 offset:32768
  ds_read_b64_tr_b16 v[98:99], v225 offset:32768
  v_mfma_f32_16x16x32_bf16 v[40:43], v[136:139], a[56:59], v[40:43]
  ds_read_b64_tr_b16 v[108:109], v224 offset:34816
  ds_read_b64_tr_b16 v[110:111], v225 offset:34816
  v_mfma_f32_16x16x32_bf16 v[44:47], v[140:143], a[56:59], v[44:47]
  ds_read_b64_tr_b16 v[112:113], v224 offset:36864
  ds_read_b64_tr_b16 v[114:115], v225 offset:36864
  v_mfma_f32_16x16x32_bf16 v[12:15], v[140:143], a[48:51], v[12:15]
  ds_read_b64_tr_b16 v[116:117], v224 offset:38912
  ds_read_b64_tr_b16 v[118:119], v225 offset:38912
  v_mfma_f32_16x16x32_bf16 v[16:19], v[144:147], a[48:51], v[16:19]
  ds_read_b64_tr_b16 v[120:121], v224 offset:33024
  ds_read_b64_tr_b16 v[122:123], v225 offset:33024
  v_mfma_f32_16x16x32_bf16 v[48:51], v[144:147], a[56:59], v[48:51]
  ds_read_b64_tr_b16 v[124:125], v224 offset:35072
  ds_read_b64_tr_b16 v[126:127], v225 offset:35072
  v_mfma_f32_16x16x32_bf16 v[52:55], v[148:151], a[56:59], v[52:55]
  ds_read_b64_tr_b16 v[128:129], v224 offset:37120
  ds_read_b64_tr_b16 v[130:131], v225 offset:37120
  v_mfma_f32_16x16x32_bf16 v[20:23], v[148:151], a[48:51], v[20:23]
  ds_read_b64_tr_b16 v[132:133], v224 offset:39168
  ds_read_b64_tr_b16 v[134:135], v225 offset:39168
  v_mfma_f32_16x16x32_bf16 v[8:11], v[152:155], a[52:55], v[8:11]
  s_add_u32 m0, s28, 147456
  s_nop 0
  buffer_load_dwordx4 v100, s[68:71], s43 offen offset:0 lds
  s_mov_b32 s32, 0x07060302
  v_mfma_f32_16x16x32_bf16 v[40:43], v[152:155], a[60:63], v[40:43]
  v_mfma_f32_16x16x32_bf16 v[44:47], v[156:159], a[60:63], v[44:47]
  buffer_load_dwordx4 v101, s[68:71], s43 offen offset:1024 lds
  v_mfma_f32_16x16x32_bf16 v[12:15], v[156:159], a[52:55], v[12:15]
  v_mfma_f32_16x16x32_bf16 v[16:19], v[160:163], a[52:55], v[16:19]
  s_add_u32 m0, s28, 149504
  s_nop 0
  buffer_load_dwordx4 v102, s[68:71], s43 offen offset:0 lds
  v_mfma_f32_16x16x32_bf16 v[48:51], v[160:163], a[60:63], v[48:51]
  v_mfma_f32_16x16x32_bf16 v[52:55], v[168:171], a[60:63], v[52:55]
  buffer_load_dwordx4 v103, s[68:71], s43 offen offset:1024 lds
  s_add_u32 s43, s43, 128
  s_and_b32 s43, s43, 0x3ff
  v_mfma_f32_16x16x32_bf16 v[20:23], v[168:171], a[52:55], v[20:23]
  s_waitcnt lgkmcnt(0)
  v_mfma_f32_16x16x32_bf16 v[8:11], v[96:99], a[64:67], v[8:11]
  ds_read_b64_tr_b16 v[136:137], v224 offset:40960
  ds_read_b64_tr_b16 v[138:139], v225 offset:40960
  v_mfma_f32_16x16x32_bf16 v[40:43], v[96:99], a[72:75], v[40:43]
  ds_read_b64_tr_b16 v[140:141], v224 offset:43008
  ds_read_b64_tr_b16 v[142:143], v225 offset:43008
  v_mfma_f32_16x16x32_bf16 v[44:47], v[108:111], a[72:75], v[44:47]
  ds_read_b64_tr_b16 v[144:145], v224 offset:45056
  ds_read_b64_tr_b16 v[146:147], v225 offset:45056
  v_mfma_f32_16x16x32_bf16 v[12:15], v[108:111], a[64:67], v[12:15]
  ds_read_b64_tr_b16 v[148:149], v224 offset:47104
  ds_read_b64_tr_b16 v[150:151], v225 offset:47104
  v_mfma_f32_16x16x32_bf16 v[16:19], v[112:115], a[64:67], v[16:19]
  ds_read_b64_tr_b16 v[152:153], v224 offset:41216
  ds_read_b64_tr_b16 v[154:155], v225 offset:41216
  v_mfma_f32_16x16x32_bf16 v[48:51], v[112:115], a[72:75], v[48:51]
  ds_read_b64_tr_b16 v[156:157], v224 offset:43264
  ds_read_b64_tr_b16 v[158:159], v225 offset:43264
  v_mfma_f32_16x16x32_bf16 v[52:55], v[116:119], a[72:75], v[52:55]
  ds_read_b64_tr_b16 v[160:161], v224 offset:45312
  ds_read_b64_tr_b16 v[162:163], v225 offset:45312
  v_mfma_f32_16x16x32_bf16 v[20:23], v[116:119], a[64:67], v[20:23]
  ds_read_b64_tr_b16 v[168:169], v224 offset:47360
  ds_read_b64_tr_b16 v[170:171], v225 offset:47360
  v_mfma_f32_16x16x32_bf16 v[8:11], v[120:123], a[68:71], v[8:11]
  s_add_u32 m0, s83, 65536
  s_nop 0
  buffer_load_dwordx4 v58, s[84:87], s82 offen offset:0 sc1 lds
  v_mfma_f32_16x16x32_bf16 v[40:43], v[120:123], a[76:79], v[40:43]
  v_mfma_f32_16x16x32_bf16 v[44:47], v[124:127], a[76:79], v[44:47]
  buffer_load_dwordx4 v58, s[84:87], s82 offen offset:1024 sc1 lds
  v_mfma_f32_16x16x32_bf16 v[12:15], v[124:127], a[68:71], v[12:15]
  v_mfma_f32_16x16x32_bf16 v[16:19], v[128:131], a[68:71], v[16:19]
  buffer_load_dwordx4 v58, s[84:87], s82 offen offset:2048 sc1 lds
  v_mfma_f32_16x16x32_bf16 v[48:51], v[128:131], a[76:79], v[48:51]
  v_mfma_f32_16x16x32_bf16 v[52:55], v[132:135], a[76:79], v[52:55]
  buffer_load_dwordx4 v58, s[84:87], s82 offen offset:3072 sc1 lds
  s_add_u32 s82, s82, 32768
  s_and_b32 s82, s82, 0x3ffff
  v_mfma_f32_16x16x32_bf16 v[20:23], v[132:135], a[68:71], v[20:23]
  s_waitcnt vmcnt(12)
  ds_read_b128 a[160:163], v106 offset:49152
  ds_read_b128 a[164:167], v107 offset:49152
  ds_read_b128 a[168:171], v106 offset:51200
  ds_read_b128 a[172:175], v107 offset:51200
  s_waitcnt vmcnt(8) lgkmcnt(4)
  s_barrier
  v_mfma_f32_16x16x32_bf16 v[8:11], v[136:139], a[80:83], v[8:11]
  ds_read_b64_tr_b16 v[96:97], v224 offset:49152
  ds_read_b64_tr_b16 v[98:99], v225 offset:49152
  v_mfma_f32_16x16x32_bf16 v[40:43], v[136:139], a[88:91], v[40:43]
  ds_read_b64_tr_b16 v[108:109], v224 offset:51200
  ds_read_b64_tr_b16 v[110:111], v225 offset:51200
  v_mfma_f32_16x16x32_bf16 v[44:47], v[140:143], a[88:91], v[44:47]
  ds_read_b64_tr_b16 v[112:113], v224 offset:53248
  ds_read_b64_tr_b16 v[114:115], v225 offset:53248
  v_mfma_f32_16x16x32_bf16 v[12:15], v[140:143], a[80:83], v[12:15]
  ds_read_b64_tr_b16 v[116:117], v224 offset:55296
  ds_read_b64_tr_b16 v[118:119], v225 offset:55296
  v_mfma_f32_16x16x32_bf16 v[16:19], v[144:147], a[80:83], v[16:19]
  ds_read_b64_tr_b16 v[120:121], v224 offset:49408
  ds_read_b64_tr_b16 v[122:123], v225 offset:49408
  v_mfma_f32_16x16x32_bf16 v[48:51], v[144:147], a[88:91], v[48:51]
  ds_read_b64_tr_b16 v[124:125], v224 offset:51456
  ds_read_b64_tr_b16 v[126:127], v225 offset:51456
  v_mfma_f32_16x16x32_bf16 v[52:55], v[148:151], a[88:91], v[52:55]
  ds_read_b64_tr_b16 v[128:129], v224 offset:53504
  ds_read_b64_tr_b16 v[130:131], v225 offset:53504
  v_mfma_f32_16x16x32_bf16 v[20:23], v[148:151], a[80:83], v[20:23]
  ds_read_b64_tr_b16 v[132:133], v224 offset:55552
  ds_read_b64_tr_b16 v[134:135], v225 offset:55552
  v_mfma_f32_16x16x32_bf16 v[8:11], v[152:155], a[84:87], v[8:11]
  s_add_u32 m0, s28, 98304
  s_nop 0
  buffer_load_dwordx4 v100, s[64:67], s43 offen offset:0 lds
  v_mfma_f32_16x16x32_bf16 v[40:43], v[152:155], a[92:95], v[40:43]
  v_mfma_f32_16x16x32_bf16 v[44:47], v[156:159], a[92:95], v[44:47]
  buffer_load_dwordx4 v101, s[64:67], s43 offen offset:1024 lds
  v_mfma_f32_16x16x32_bf16 v[12:15], v[156:159], a[84:87], v[12:15]
  v_mfma_f32_16x16x32_bf16 v[16:19], v[160:163], a[84:87], v[16:19]
  s_add_u32 m0, s28, 100352
  s_nop 0
  buffer_load_dwordx4 v102, s[64:67], s43 offen offset:0 lds
  v_mfma_f32_16x16x32_bf16 v[48:51], v[160:163], a[92:95], v[48:51]
  v_mfma_f32_16x16x32_bf16 v[52:55], v[168:171], a[92:95], v[52:55]
  buffer_load_dwordx4 v103, s[64:67], s43 offen offset:1024 lds
  v_mfma_f32_16x16x32_bf16 v[20:23], v[168:171], a[84:87], v[20:23]
  s_waitcnt lgkmcnt(0)
  v_mfma_f32_16x16x32_bf16 v[8:11], v[96:99], a[96:99], v[8:11]
  ds_read_b64_tr_b16 v[136:137], v224 offset:57344
  ds_read_b64_tr_b16 v[138:139], v225 offset:57344
  v_mfma_f32_16x16x32_bf16 v[40:43], v[96:99], a[104:107], v[40:43]
  ds_read_b64_tr_b16 v[140:141], v224 offset:59392
  ds_read_b64_tr_b16 v[142:143], v225 offset:59392
  v_mfma_f32_16x16x32_bf16 v[44:47], v[108:111], a[104:107], v[44:47]
  ds_read_b64_tr_b16 v[144:145], v224 offset:61440
  ds_read_b64_tr_b16 v[146:147], v225 offset:61440
  v_mfma_f32_16x16x32_bf16 v[12:15], v[108:111], a[96:99], v[12:15]
  ds_read_b64_tr_b16 v[148:149], v224 offset:63488
  ds_read_b64_tr_b16 v[150:151], v225 offset:63488
  v_mfma_f32_16x16x32_bf16 v[16:19], v[112:115], a[96:99], v[16:19]
  ds_read_b64_tr_b16 v[152:153], v224 offset:57600
  ds_read_b64_tr_b16 v[154:155], v225 offset:57600
  v_mfma_f32_16x16x32_bf16 v[48:51], v[112:115], a[104:107], v[48:51]
  ds_read_b64_tr_b16 v[156:157], v224 offset:59648
  ds_read_b64_tr_b16 v[158:159], v225 offset:59648
  v_mfma_f32_16x16x32_bf16 v[52:55], v[116:119], a[104:107], v[52:55]
  ds_read_b64_tr_b16 v[160:161], v224 offset:61696
  ds_read_b64_tr_b16 v[162:163], v225 offset:61696
  v_mfma_f32_16x16x32_bf16 v[20:23], v[116:119], a[96:99], v[20:23]
  ds_read_b64_tr_b16 v[168:169], v224 offset:63744
  ds_read_b64_tr_b16 v[170:171], v225 offset:63744
  v_mfma_f32_16x16x32_bf16 v[8:11], v[120:123], a[100:103], v[8:11]
  s_add_u32 m0, s83, 81920
  s_nop 0
  buffer_load_dwordx4 v58, s[84:87], s82 offen offset:0 sc1 lds
  v_mfma_f32_16x16x32_bf16 v[40:43], v[120:123], a[108:111], v[40:43]
  v_mfma_f32_16x16x32_bf16 v[44:47], v[124:127], a[108:111], v[44:47]
  buffer_load_dwordx4 v58, s[84:87], s82 offen offset:1024 sc1 lds
  v_mfma_f32_16x16x32_bf16 v[12:15], v[124:127], a[100:103], v[12:15]
  v_mfma_f32_16x16x32_bf16 v[16:19], v[128:131], a[100:103], v[16:19]
  buffer_load_dwordx4 v58, s[84:87], s82 offen offset:2048 sc1 lds
  v_mfma_f32_16x16x32_bf16 v[48:51], v[128:131], a[108:111], v[48:51]
  v_mfma_f32_16x16x32_bf16 v[52:55], v[132:135], a[108:111], v[52:55]
  buffer_load_dwordx4 v58, s[84:87], s82 offen offset:3072 sc1 lds
  s_add_u32 s82, s82, 32768
  s_and_b32 s82, s82, 0x3ffff
  v_mfma_f32_16x16x32_bf16 v[20:23], v[132:135], a[100:103], v[20:23]
  v_xor_b32 v106, 0x30000, v106
  v_xor_b32 v107, 0x30000, v107
  s_waitcnt vmcnt(12)
  ds_read_b128 a[176:179], v106 offset:16384
  ds_read_b128 a[180:183], v107 offset:16384
  ds_read_b128 a[184:187], v106 offset:18432
  ds_read_b128 a[188:191], v107 offset:18432
  s_waitcnt vmcnt(8) lgkmcnt(4)
  s_barrier
  v_mfma_f32_16x16x32_bf16 v[8:11], v[136:139], a[112:115], v[8:11]
  ds_read_b64_tr_b16 v[96:97], v226 offset:0
  ds_read_b64_tr_b16 v[98:99], v227 offset:0
  v_mfma_f32_16x16x32_bf16 v[40:43], v[136:139], a[120:123], v[40:43]
  ds_read_b64_tr_b16 v[108:109], v226 offset:2048
  ds_read_b64_tr_b16 v[110:111], v227 offset:2048
  v_mfma_f32_16x16x32_bf16 v[44:47], v[140:143], a[120:123], v[44:47]
  ds_read_b64_tr_b16 v[112:113], v226 offset:4096
  ds_read_b64_tr_b16 v[114:115], v227 offset:4096
  v_mfma_f32_16x16x32_bf16 v[12:15], v[140:143], a[112:115], v[12:15]
  ds_read_b64_tr_b16 v[116:117], v226 offset:6144
  ds_read_b64_tr_b16 v[118:119], v227 offset:6144
  v_mfma_f32_16x16x32_bf16 v[16:19], v[144:147], a[112:115], v[16:19]
  ds_read_b64_tr_b16 v[120:121], v226 offset:256
  ds_read_b64_tr_b16 v[122:123], v227 offset:256
  v_mfma_f32_16x16x32_bf16 v[48:51], v[144:147], a[120:123], v[48:51]
  ds_read_b64_tr_b16 v[124:125], v226 offset:2304
  ds_read_b64_tr_b16 v[126:127], v227 offset:2304
  v_mfma_f32_16x16x32_bf16 v[52:55], v[148:151], a[120:123], v[52:55]
  ds_read_b64_tr_b16 v[128:129], v226 offset:4352
  ds_read_b64_tr_b16 v[130:131], v227 offset:4352
  v_mfma_f32_16x16x32_bf16 v[20:23], v[148:151], a[112:115], v[20:23]
  ds_read_b64_tr_b16 v[132:133], v226 offset:6400
  ds_read_b64_tr_b16 v[134:135], v227 offset:6400
  v_mfma_f32_16x16x32_bf16 v[8:11], v[152:155], a[116:119], v[8:11]
  s_add_u32 m0, s28, 114688
  s_nop 0
  buffer_load_dwordx4 v100, s[68:71], s43 offen offset:0 lds
  v_mfma_f32_16x16x32_bf16 v[40:43], v[152:155], a[124:127], v[40:43]
  v_mfma_f32_16x16x32_bf16 v[44:47], v[156:159], a[124:127], v[44:47]
  buffer_load_dwordx4 v101, s[68:71], s43 offen offset:1024 lds
  v_mfma_f32_16x16x32_bf16 v[12:15], v[156:159], a[116:119], v[12:15]
  v_mfma_f32_16x16x32_bf16 v[16:19], v[160:163], a[116:119], v[16:19]
  s_add_u32 m0, s28, 116736
  s_nop 0
  buffer_load_dwordx4 v102, s[68:71], s43 offen offset:0 lds
  v_mfma_f32_16x16x32_bf16 v[48:51], v[160:163], a[124:127], v[48:51]
  v_mfma_f32_16x16x32_bf16 v[52:55], v[168:171], a[124:127], v[52:55]
  buffer_load_dwordx4 v103, s[68:71], s43 offen offset:1024 lds
  s_add_u32 s43, s43, 128
  s_and_b32 s43, s43, 0x3ff
  v_mfma_f32_16x16x32_bf16 v[20:23], v[168:171], a[116:119], v[20:23]
  buffer_load_dword v184, v7, s[16:19], s56 offen sc1
  s_waitcnt lgkmcnt(0)
  v_mfma_f32_16x16x32_bf16 v[8:11], v[96:99], a[128:131], v[8:11]
  ds_read_b64_tr_b16 v[136:137], v226 offset:8192
  ds_read_b64_tr_b16 v[138:139], v227 offset:8192
  v_mfma_f32_16x16x32_bf16 v[40:43], v[96:99], a[136:139], v[40:43]
  ds_read_b64_tr_b16 v[140:141], v226 offset:10240
  ds_read_b64_tr_b16 v[142:143], v227 offset:10240
  v_mfma_f32_16x16x32_bf16 v[44:47], v[108:111], a[136:139], v[44:47]
  ds_read_b64_tr_b16 v[144:145], v226 offset:12288
  ds_read_b64_tr_b16 v[146:147], v227 offset:12288
  v_mfma_f32_16x16x32_bf16 v[12:15], v[108:111], a[128:131], v[12:15]
  ds_read_b64_tr_b16 v[148:149], v226 offset:14336
  ds_read_b64_tr_b16 v[150:151], v227 offset:14336
  v_mfma_f32_16x16x32_bf16 v[16:19], v[112:115], a[128:131], v[16:19]
  ds_read_b64_tr_b16 v[152:153], v226 offset:8448
  ds_read_b64_tr_b16 v[154:155], v227 offset:8448
  v_mfma_f32_16x16x32_bf16 v[48:51], v[112:115], a[136:139], v[48:51]
  ds_read_b64_tr_b16 v[156:157], v226 offset:10496
  ds_read_b64_tr_b16 v[158:159], v227 offset:10496
  v_mfma_f32_16x16x32_bf16 v[52:55], v[116:119], a[136:139], v[52:55]
  ds_read_b64_tr_b16 v[160:161], v226 offset:12544
  ds_read_b64_tr_b16 v[162:163], v227 offset:12544
  v_mfma_f32_16x16x32_bf16 v[20:23], v[116:119], a[128:131], v[20:23]
  ds_read_b64_tr_b16 v[168:169], v226 offset:14592
  ds_read_b64_tr_b16 v[170:171], v227 offset:14592
  v_mfma_f32_16x16x32_bf16 v[8:11], v[120:123], a[132:135], v[8:11]
  s_add_u32 m0, s83, 0
  s_nop 0
  buffer_load_dwordx4 v58, s[84:87], s82 offen offset:0 sc1 lds
  v_mfma_f32_16x16x32_bf16 v[40:43], v[120:123], a[140:143], v[40:43]
  v_mfma_f32_16x16x32_bf16 v[44:47], v[124:127], a[140:143], v[44:47]
  buffer_load_dwordx4 v58, s[84:87], s82 offen offset:1024 sc1 lds
  v_mfma_f32_16x16x32_bf16 v[12:15], v[124:127], a[132:135], v[12:15]
  v_mfma_f32_16x16x32_bf16 v[16:19], v[128:131], a[132:135], v[16:19]
  buffer_load_dwordx4 v58, s[84:87], s82 offen offset:2048 sc1 lds
  v_mfma_f32_16x16x32_bf16 v[48:51], v[128:131], a[140:143], v[48:51]
  v_mfma_f32_16x16x32_bf16 v[52:55], v[132:135], a[140:143], v[52:55]
  buffer_load_dwordx4 v58, s[84:87], s82 offen offset:3072 sc1 lds
  s_add_u32 s82, s82, 32768
  s_and_b32 s82, s82, 0x3ffff
  v_mfma_f32_16x16x32_bf16 v[20:23], v[132:135], a[132:135], v[20:23]
  v_xor_b32 v106, 0x30000, v106
  v_xor_b32 v107, 0x30000, v107
  s_waitcnt vmcnt(13)
  ds_read_b128 a[192:195], v106 offset:32768
  ds_read_b128 a[196:199], v107 offset:32768
  ds_read_b128 a[200:203], v106 offset:34816
  ds_read_b128 a[204:207], v107 offset:34816
  s_waitcnt vmcnt(9) lgkmcnt(4)
  s_barrier
  v_mfma_f32_16x16x32_bf16 v[8:11], v[136:139], a[144:147], v[8:11]
  ds_read_b64_tr_b16 v[96:97], v226 offset:16384
  ds_read_b64_tr_b16 v[98:99], v227 offset:16384
  v_mfma_f32_16x16x32_bf16 v[40:43], v[136:139], a[152:155], v[40:43]
  ds_read_b64_tr_b16 v[108:109], v226 offset:18432
  ds_read_b64_tr_b16 v[110:111], v227 offset:18432
  v_mfma_f32_16x16x32_bf16 v[44:47], v[140:143], a[152:155], v[44:47]
  ds_read_b64_tr_b16 v[112:113], v226 offset:20480
  ds_read_b64_tr_b16 v[114:115], v227 offset:20480
  v_mfma_f32_16x16x32_bf16 v[12:15], v[140:143], a[144:147], v[12:15]
  ds_read_b64_tr_b16 v[116:117], v226 offset:22528
  ds_read_b64_tr_b16 v[118:119], v227 offset:22528
  v_mfma_f32_16x16x32_bf16 v[16:19], v[144:147], a[144:147], v[16:19]
  ds_read_b64_tr_b16 v[120:121], v226 offset:16640
  ds_read_b64_tr_b16 v[122:123], v227 offset:16640
  v_mfma_f32_16x16x32_bf16 v[48:51], v[144:147], a[152:155], v[48:51]
  ds_read_b64_tr_b16 v[124:125], v226 offset:18688
  ds_read_b64_tr_b16 v[126:127], v227 offset:18688
  v_mfma_f32_16x16x32_bf16 v[52:55], v[148:151], a[152:155], v[52:55]
  ds_read_b64_tr_b16 v[128:129], v226 offset:20736
  ds_read_b64_tr_b16 v[130:131], v227 offset:20736
  v_mfma_f32_16x16x32_bf16 v[20:23], v[148:151], a[144:147], v[20:23]
  ds_read_b64_tr_b16 v[132:133], v226 offset:22784
  ds_read_b64_tr_b16 v[134:135], v227 offset:22784
  v_mfma_f32_16x16x32_bf16 v[8:11], v[152:155], a[148:151], v[8:11]
  s_add_u32 m0, s28, 147456
  s_nop 0
  buffer_load_dwordx4 v100, s[64:67], s43 offen offset:0 lds
  v_mfma_f32_16x16x32_bf16 v[40:43], v[152:155], a[156:159], v[40:43]
  v_mfma_f32_16x16x32_bf16 v[44:47], v[156:159], a[156:159], v[44:47]
  buffer_load_dwordx4 v101, s[64:67], s43 offen offset:1024 lds
  v_mfma_f32_16x16x32_bf16 v[12:15], v[156:159], a[148:151], v[12:15]
  v_mfma_f32_16x16x32_bf16 v[16:19], v[160:163], a[148:151], v[16:19]
  s_add_u32 m0, s28, 149504
  s_nop 0
  buffer_load_dwordx4 v102, s[64:67], s43 offen offset:0 lds
  v_mfma_f32_16x16x32_bf16 v[48:51], v[160:163], a[156:159], v[48:51]
  v_mfma_f32_16x16x32_bf16 v[52:55], v[168:171], a[156:159], v[52:55]
  buffer_load_dwordx4 v103, s[64:67], s43 offen offset:1024 lds
  v_mfma_f32_16x16x32_bf16 v[20:23], v[168:171], a[148:151], v[20:23]
  s_cmp_lg_u32 s3, 1
  s_cbranch_scc1 gated_mix__spectral_gfnet__ssm_conv_s5__prompt_kernel_skip45
  s_getpc_b64 s[58:59]
gated_mix__spectral_gfnet__ssm_conv_s5__prompt_kernel_pc44:
  s_lshr_b32 s33, s2, 3
  s_mul_i32 s33, s33, 512
  v_min_u32 v186, 3, v1
  v_lshl_add_u32 v186, v186, 7, s33
  v_min_u32 v186, gated_mix__spectral_gfnet__ssm_conv_s5__prompt_kernel_end-gated_mix__spectral_gfnet__ssm_conv_s5__prompt_kernel_pc44, v186
  v_mov_b32 v187, 0
  v_lshl_add_u64 v[186:187], v[186:187], 0, s[58:59]
  global_load_dword v4, v[186:187], off
gated_mix__spectral_gfnet__ssm_conv_s5__prompt_kernel_skip45:
  s_waitcnt lgkmcnt(0)
  v_mfma_f32_16x16x32_bf16 v[8:11], v[96:99], a[160:163], v[8:11]
  ds_read_b64_tr_b16 v[136:137], v226 offset:24576
  ds_read_b64_tr_b16 v[138:139], v227 offset:24576
  v_mfma_f32_16x16x32_bf16 v[40:43], v[96:99], a[168:171], v[40:43]
  ds_read_b64_tr_b16 v[140:141], v226 offset:26624
  ds_read_b64_tr_b16 v[142:143], v227 offset:26624
  v_mfma_f32_16x16x32_bf16 v[44:47], v[108:111], a[168:171], v[44:47]
  ds_read_b64_tr_b16 v[144:145], v226 offset:28672
  ds_read_b64_tr_b16 v[146:147], v227 offset:28672
  v_mfma_f32_16x16x32_bf16 v[12:15], v[108:111], a[160:163], v[12:15]
  ds_read_b64_tr_b16 v[148:149], v226 offset:30720
  ds_read_b64_tr_b16 v[150:151], v227 offset:30720
  v_mfma_f32_16x16x32_bf16 v[16:19], v[112:115], a[160:163], v[16:19]
  ds_read_b64_tr_b16 v[152:153], v226 offset:24832
  ds_read_b64_tr_b16 v[154:155], v227 offset:24832
  v_mfma_f32_16x16x32_bf16 v[48:51], v[112:115], a[168:171], v[48:51]
  ds_read_b64_tr_b16 v[156:157], v226 offset:26880
  ds_read_b64_tr_b16 v[158:159], v227 offset:26880
  v_mfma_f32_16x16x32_bf16 v[52:55], v[116:119], a[168:171], v[52:55]
  ds_read_b64_tr_b16 v[160:161], v226 offset:28928
  ds_read_b64_tr_b16 v[162:163], v227 offset:28928
  v_mfma_f32_16x16x32_bf16 v[20:23], v[116:119], a[160:163], v[20:23]
  ds_read_b64_tr_b16 v[168:169], v226 offset:30976
  ds_read_b64_tr_b16 v[170:171], v227 offset:30976
  v_mfma_f32_16x16x32_bf16 v[8:11], v[120:123], a[164:167], v[8:11]
  s_add_u32 m0, s83, 16384
  s_nop 0
  buffer_load_dwordx4 v58, s[84:87], s82 offen offset:0 sc1 lds
  v_mfma_f32_16x16x32_bf16 v[40:43], v[120:123], a[172:175], v[40:43]
  v_mfma_f32_16x16x32_bf16 v[44:47], v[124:127], a[172:175], v[44:47]
  buffer_load_dwordx4 v58, s[84:87], s82 offen offset:1024 sc1 lds
  v_mfma_f32_16x16x32_bf16 v[12:15], v[124:127], a[164:167], v[12:15]
  v_mfma_f32_16x16x32_bf16 v[16:19], v[128:131], a[164:167], v[16:19]
  buffer_load_dwordx4 v58, s[84:87], s82 offen offset:2048 sc1 lds
  v_mfma_f32_16x16x32_bf16 v[48:51], v[128:131], a[172:175], v[48:51]
  v_mfma_f32_16x16x32_bf16 v[52:55], v[132:135], a[172:175], v[52:55]
  buffer_load_dwordx4 v58, s[84:87], s82 offen offset:3072 sc1 lds
  s_add_u32 s82, s82, 32768
  s_and_b32 s82, s82, 0x3ffff
  v_xor_b32 v58, 8192, v58
  v_mfma_f32_16x16x32_bf16 v[20:23], v[132:135], a[164:167], v[20:23]
  s_waitcnt vmcnt(13)
  ds_read_b128 a[208:211], v106 offset:49152
  ds_read_b128 a[212:215], v107 offset:49152
  ds_read_b128 a[216:219], v106 offset:51200
  ds_read_b128 a[220:223], v107 offset:51200
  s_waitcnt vmcnt(12)
  v_cmp_ne_u32 vcc, 1, v184
  s_nop 0
  s_cbranch_vccz gated_mix__spectral_gfnet__ssm_conv_s5__prompt_kernel_skip46
  s_mov_b32 s33, 0
gated_mix__spectral_gfnet__ssm_conv_s5__prompt_kernel_poll47:
  s_sleep 16
  buffer_load_dword v184, v7, s[16:19], s56 offen sc1
  s_waitcnt vmcnt(0)
  v_cmp_ne_u32 vcc, 1, v184
  s_nop 0
  s_cbranch_vccz gated_mix__spectral_gfnet__ssm_conv_s5__prompt_kernel_pollout48
  s_add_u32 s33, s33, 1
  s_cmp_lt_u32 s33, 1048576
  s_cbranch_scc1 gated_mix__spectral_gfnet__ssm_conv_s5__prompt_kernel_poll47
gated_mix__spectral_gfnet__ssm_conv_s5__prompt_kernel_pollout48:
gated_mix__spectral_gfnet__ssm_conv_s5__prompt_kernel_skip46:
  s_waitcnt vmcnt(8) lgkmcnt(4)
  s_barrier
  v_mfma_f32_16x16x32_bf16 v[8:11], v[136:139], a[176:179], v[8:11]
  ds_read_b64_tr_b16 v[96:97], v224 offset:0
  ds_read_b64_tr_b16 v[98:99], v225 offset:0
  v_mfma_f32_16x16x32_bf16 v[40:43], v[136:139], a[184:187], v[40:43]
  ds_read_b64_tr_b16 v[108:109], v224 offset:2048
  ds_read_b64_tr_b16 v[110:111], v225 offset:2048
  v_mfma_f32_16x16x32_bf16 v[44:47], v[140:143], a[184:187], v[44:47]
  ds_read_b64_tr_b16 v[112:113], v224 offset:4096
  ds_read_b64_tr_b16 v[114:115], v225 offset:4096
  v_mfma_f32_16x16x32_bf16 v[12:15], v[140:143], a[176:179], v[12:15]
  ds_read_b64_tr_b16 v[116:117], v224 offset:6144
  ds_read_b64_tr_b16 v[118:119], v225 offset:6144
  v_mfma_f32_16x16x32_bf16 v[16:19], v[144:147], a[176:179], v[16:19]
  ds_read_b64_tr_b16 v[120:121], v224 offset:256
  ds_read_b64_tr_b16 v[122:123], v225 offset:256
  v_mfma_f32_16x16x32_bf16 v[48:51], v[144:147], a[184:187], v[48:51]
  ds_read_b64_tr_b16 v[124:125], v224 offset:2304
  ds_read_b64_tr_b16 v[126:127], v225 offset:2304
  v_mfma_f32_16x16x32_bf16 v[52:55], v[148:151], a[184:187], v[52:55]
  ds_read_b64_tr_b16 v[128:129], v224 offset:4352
  ds_read_b64_tr_b16 v[130:131], v225 offset:4352
  v_mfma_f32_16x16x32_bf16 v[20:23], v[148:151], a[176:179], v[20:23]
  ds_read_b64_tr_b16 v[132:133], v224 offset:6400
  ds_read_b64_tr_b16 v[134:135], v225 offset:6400
  v_mfma_f32_16x16x32_bf16 v[8:11], v[152:155], a[180:183], v[8:11]
  s_add_u32 m0, s28, 98304
  s_nop 0
  buffer_load_dwordx4 v100, s[68:71], s43 offen offset:0 lds
  v_mfma_f32_16x16x32_bf16 v[40:43], v[152:155], a[188:191], v[40:43]
  v_mfma_f32_16x16x32_bf16 v[44:47], v[156:159], a[188:191], v[44:47]
  buffer_load_dwordx4 v101, s[68:71], s43 offen offset:1024 lds
  v_mfma_f32_16x16x32_bf16 v[12:15], v[156:159], a[180:183], v[12:15]
  v_mfma_f32_16x16x32_bf16 v[16:19], v[160:163], a[180:183], v[16:19]
  s_add_u32 m0, s28, 100352
  s_nop 0
  buffer_load_dwordx4 v102, s[68:71], s43 offen offset:0 lds
  v_mfma_f32_16x16x32_bf16 v[48:51], v[160:163], a[188:191], v[48:51]
  v_mfma_f32_16x16x32_bf16 v[52:55], v[168:171], a[188:191], v[52:55]
  buffer_load_dwordx4 v103, s[68:71], s43 offen offset:1024 lds
  s_add_u32 s43, s43, 128
  s_and_b32 s43, s43, 0x3ff
  v_mfma_f32_16x16x32_bf16 v[20:23], v[168:171], a[180:183], v[20:23]
  buffer_load_dwordx4 v[100:103], v36, s[88:91], s8 offen offset:0 sc1
  buffer_load_dwordx4 v[184:187], v36, s[88:91], s8 offen offset:1024 sc1
  buffer_load_dwordx4 v[188:191], v36, s[88:91], s8 offen offset:2048 sc1
  buffer_load_dwordx4 v[192:195], v36, s[88:91], s8 offen offset:3072 sc1
  s_waitcnt lgkmcnt(0)
  v_mfma_f32_16x16x32_bf16 v[8:11], v[96:99], a[192:195], v[8:11]
  ds_read_b64_tr_b16 v[136:137], v224 offset:8192
  ds_read_b64_tr_b16 v[138:139], v225 offset:8192
  v_mfma_f32_16x16x32_bf16 v[40:43], v[96:99], a[200:203], v[40:43]
  ds_read_b64_tr_b16 v[140:141], v224 offset:10240
  ds_read_b64_tr_b16 v[142:143], v225 offset:10240
  v_mfma_f32_16x16x32_bf16 v[44:47], v[108:111], a[200:203], v[44:47]
  ds_read_b64_tr_b16 v[144:145], v224 offset:12288
  ds_read_b64_tr_b16 v[146:147], v225 offset:12288
  v_mfma_f32_16x16x32_bf16 v[12:15], v[108:111], a[192:195], v[12:15]
  ds_read_b64_tr_b16 v[148:149], v224 offset:14336
  ds_read_b64_tr_b16 v[150:151], v225 offset:14336
  v_mfma_f32_16x16x32_bf16 v[16:19], v[112:115], a[192:195], v[16:19]
  ds_read_b64_tr_b16 v[152:153], v224 offset:8448
  ds_read_b64_tr_b16 v[154:155], v225 offset:8448
  v_mfma_f32_16x16x32_bf16 v[48:51], v[112:115], a[200:203], v[48:51]
  ds_read_b64_tr_b16 v[156:157], v224 offset:10496
  ds_read_b64_tr_b16 v[158:159], v225 offset:10496
  v_mfma_f32_16x16x32_bf16 v[52:55], v[116:119], a[200:203], v[52:55]
  ds_read_b64_tr_b16 v[160:161], v224 offset:12544
  ds_read_b64_tr_b16 v[162:163], v225 offset:12544
  v_mfma_f32_16x16x32_bf16 v[20:23], v[116:119], a[192:195], v[20:23]
  ds_read_b64_tr_b16 v[168:169], v224 offset:14592
  ds_read_b64_tr_b16 v[170:171], v225 offset:14592
  v_mfma_f32_16x16x32_bf16 v[8:11], v[120:123], a[196:199], v[8:11]
  s_lshr_b32 m0, s3, 1
  s_lshl_b32 m0, m0, 15
  s_add_u32 s82, s82, m0
  s_and_b32 s82, s82, 0x3ffff
  s_and_b32 m0, s3, 1
  s_lshl_b32 m0, m0, 14
  v_and_b32 v58, 0xffffafff, v58
  v_or_b32 v58, m0, v58
  s_add_u32 m0, s83, 32768
  s_nop 0
  buffer_load_dwordx4 v58, s[84:87], s82 offen offset:0 sc1 lds
  v_mfma_f32_16x16x32_bf16 v[40:43], v[120:123], a[204:207], v[40:43]
  v_mfma_f32_16x16x32_bf16 v[44:47], v[124:127], a[204:207], v[44:47]
  buffer_load_dwordx4 v58, s[84:87], s82 offen offset:1024 sc1 lds
  v_mfma_f32_16x16x32_bf16 v[12:15], v[124:127], a[196:199], v[12:15]
  v_mfma_f32_16x16x32_bf16 v[16:19], v[128:131], a[196:199], v[16:19]
  buffer_load_dwordx4 v58, s[84:87], s82 offen offset:2048 sc1 lds
  v_mfma_f32_16x16x32_bf16 v[48:51], v[128:131], a[204:207], v[48:51]
  v_mfma_f32_16x16x32_bf16 v[52:55], v[132:135], a[204:207], v[52:55]
  buffer_load_dwordx4 v58, s[84:87], s82 offen offset:3072 sc1 lds
  s_add_u32 s82, s82, 65536
  s_and_b32 s82, s82, 0x3ffff
  v_mfma_f32_16x16x32_bf16 v[20:23], v[132:135], a[196:199], v[20:23]
  v_xor_b32 v106, 0x30000, v106
  v_xor_b32 v107, 0x30000, v107
  s_waitcnt vmcnt(16)
  ds_read_b128 a[224:227], v106 offset:16384
  ds_read_b128 a[228:231], v107 offset:16384
  ds_read_b128 a[232:235], v106 offset:18432
  ds_read_b128 a[236:239], v107 offset:18432
  s_waitcnt vmcnt(12) lgkmcnt(4)
  s_barrier
  v_mfma_f32_16x16x32_bf16 v[8:11], v[136:139], a[208:211], v[8:11]
  ds_read_b64_tr_b16 v[96:97], v224 offset:16384
  ds_read_b64_tr_b16 v[98:99], v225 offset:16384
  v_mfma_f32_16x16x32_bf16 v[40:43], v[136:139], a[216:219], v[40:43]
  ds_read_b64_tr_b16 v[108:109], v224 offset:18432
  ds_read_b64_tr_b16 v[110:111], v225 offset:18432
  v_mfma_f32_16x16x32_bf16 v[44:47], v[140:143], a[216:219], v[44:47]
  ds_read_b64_tr_b16 v[112:113], v224 offset:20480
  ds_read_b64_tr_b16 v[114:115], v225 offset:20480
  v_mfma_f32_16x16x32_bf16 v[12:15], v[140:143], a[208:211], v[12:15]
  ds_read_b64_tr_b16 v[116:117], v224 offset:22528
  ds_read_b64_tr_b16 v[118:119], v225 offset:22528
  v_mfma_f32_16x16x32_bf16 v[16:19], v[144:147], a[208:211], v[16:19]
  ds_read_b64_tr_b16 v[120:121], v224 offset:16640
  ds_read_b64_tr_b16 v[122:123], v225 offset:16640
  v_mfma_f32_16x16x32_bf16 v[48:51], v[144:147], a[216:219], v[48:51]
  ds_read_b64_tr_b16 v[124:125], v224 offset:18688
  ds_read_b64_tr_b16 v[126:127], v225 offset:18688
  v_mfma_f32_16x16x32_bf16 v[52:55], v[148:151], a[216:219], v[52:55]
  ds_read_b64_tr_b16 v[128:129], v224 offset:20736
  ds_read_b64_tr_b16 v[130:131], v225 offset:20736
  v_mfma_f32_16x16x32_bf16 v[20:23], v[148:151], a[208:211], v[20:23]
  ds_read_b64_tr_b16 v[132:133], v224 offset:22784
  ds_read_b64_tr_b16 v[134:135], v225 offset:22784
  v_mfma_f32_16x16x32_bf16 v[8:11], v[152:155], a[212:215], v[8:11]
  s_add_u32 m0, s83, 49152
  s_nop 0
  buffer_load_dwordx4 v58, s[84:87], s82 offen offset:0 sc1 lds
  s_lshl_b32 s28, s3, 10
  s_add_u32 s28, s28, 131072
  v_lshl_add_u32 v39, v1, 4, s28
  s_waitcnt vmcnt(8)
  v_lshlrev_b32 v196, 16, v100
  v_and_b32 v198, 0xffff0000, v100
  v_lshlrev_b32 v197, 16, v101
  v_and_b32 v199, 0xffff0000, v101
  s_waitcnt vmcnt(7)
  v_lshlrev_b32 v200, 16, v184
  v_and_b32 v202, 0xffff0000, v184
  v_lshlrev_b32 v201, 16, v185
  v_and_b32 v203, 0xffff0000, v185
  s_waitcnt vmcnt(6)
  v_lshlrev_b32 v204, 16, v188
  v_and_b32 v206, 0xffff0000, v188
  v_lshlrev_b32 v205, 16, v189
  v_and_b32 v207, 0xffff0000, v189
  s_waitcnt vmcnt(5)
  v_lshlrev_b32 v208, 16, v192
  v_and_b32 v210, 0xffff0000, v192
  v_lshlrev_b32 v209, 16, v193
  v_and_b32 v211, 0xffff0000, v193
  v_pk_add_f32 v[212:213], v[196:197], v[204:205]
  v_pk_add_f32 v[216:217], v[196:197], v[204:205] neg_lo:[0,1] neg_hi:[0,1]
  v_pk_add_f32 v[220:221], v[200:201], v[208:209]
  v_pk_add_f32 v[214:215], v[198:199], v[206:207]
  v_pk_add_f32 v[218:219], v[198:199], v[206:207] neg_lo:[0,1] neg_hi:[0,1]
  v_pk_add_f32 v[222:223], v[202:203], v[210:211]
  v_pk_add_f32 v[228:229], v[210:211], v[202:203] neg_lo:[0,1] neg_hi:[0,1]
  v_pk_add_f32 v[230:231], v[200:201], v[208:209] neg_lo:[0,1] neg_hi:[0,1]
  s_cmp_lg_u32 s9, 0
  s_cbranch_scc1 gated_mix__spectral_gfnet__ssm_conv_s5__prompt_kernel_skip49
  s_mov_b64 exec, 15
  v_pk_add_f32 v[220:221], v[200:201], v[200:201]
  v_pk_add_f32 v[222:223], v[208:209], v[208:209]
  v_pk_add_f32 v[228:229], v[202:203], v[202:203] neg_lo:[1,1] neg_hi:[1,1]
  v_pk_add_f32 v[230:231], v[210:211], v[210:211] neg_lo:[1,1] neg_hi:[1,1]
  s_mov_b64 exec, -1
gated_mix__spectral_gfnet__ssm_conv_s5__prompt_kernel_skip49:
  v_pk_add_f32 v[196:197], v[212:213], v[220:221]
  v_cvt_pk_bf16_f32 v232, v196, v197
  v_pk_add_f32 v[198:199], v[214:215], v[222:223]
  v_cvt_pk_bf16_f32 v233, v198, v199
  v_pk_add_f32 v[200:201], v[216:217], v[228:229]
  v_cvt_pk_bf16_f32 v234, v200, v201
  v_pk_add_f32 v[202:203], v[218:219], v[230:231]
  v_cvt_pk_bf16_f32 v235, v202, v203
  v_pk_add_f32 v[204:205], v[212:213], v[220:221] neg_lo:[0,1] neg_hi:[0,1]
  v_cvt_pk_bf16_f32 v236, v204, v205
  v_pk_add_f32 v[206:207], v[214:215], v[222:223] neg_lo:[0,1] neg_hi:[0,1]
  v_cvt_pk_bf16_f32 v237, v206, v207
  v_pk_add_f32 v[208:209], v[216:217], v[228:229] neg_lo:[0,1] neg_hi:[0,1]
  v_cvt_pk_bf16_f32 v238, v208, v209
  v_pk_add_f32 v[210:211], v[218:219], v[230:231] neg_lo:[0,1] neg_hi:[0,1]
  v_cvt_pk_bf16_f32 v239, v210, v211
  v_lshlrev_b32 v196, 16, v102
  v_and_b32 v198, 0xffff0000, v102
  v_lshlrev_b32 v197, 16, v103
  v_and_b32 v199, 0xffff0000, v103
  v_lshlrev_b32 v200, 16, v186
  v_and_b32 v202, 0xffff0000, v186
  v_lshlrev_b32 v201, 16, v187
  v_and_b32 v203, 0xffff0000, v187
  v_lshlrev_b32 v204, 16, v190
  v_and_b32 v206, 0xffff0000, v190
  v_lshlrev_b32 v205, 16, v191
  v_and_b32 v207, 0xffff0000, v191
  v_lshlrev_b32 v208, 16, v194
  v_and_b32 v210, 0xffff0000, v194
  v_lshlrev_b32 v209, 16, v195
  v_and_b32 v211, 0xffff0000, v195
  v_pk_add_f32 v[212:213], v[196:197], v[204:205]
  v_pk_add_f32 v[216:217], v[196:197], v[204:205] neg_lo:[0,1] neg_hi:[0,1]
  v_pk_add_f32 v[220:221], v[200:201], v[208:209]
  v_pk_add_f32 v[214:215], v[198:199], v[206:207]
  v_pk_add_f32 v[218:219], v[198:199], v[206:207] neg_lo:[0,1] neg_hi:[0,1]
  v_pk_add_f32 v[222:223], v[202:203], v[210:211]
  v_pk_add_f32 v[228:229], v[210:211], v[202:203] neg_lo:[0,1] neg_hi:[0,1]
  v_pk_add_f32 v[230:231], v[200:201], v[208:209] neg_lo:[0,1] neg_hi:[0,1]
  s_cmp_lg_u32 s9, 0
  s_cbranch_scc1 gated_mix__spectral_gfnet__ssm_conv_s5__prompt_kernel_skip50
  s_mov_b64 exec, 15
  v_pk_add_f32 v[220:221], v[200:201], v[200:201]
  v_pk_add_f32 v[222:223], v[208:209], v[208:209]
  v_pk_add_f32 v[228:229], v[202:203], v[202:203] neg_lo:[1,1] neg_hi:[1,1]
  v_pk_add_f32 v[230:231], v[210:211], v[210:211] neg_lo:[1,1] neg_hi:[1,1]
  s_mov_b64 exec, -1
gated_mix__spectral_gfnet__ssm_conv_s5__prompt_kernel_skip50:
  v_pk_add_f32 v[196:197], v[212:213], v[220:221]
  v_cvt_pk_bf16_f32 v101, v196, v197
  v_pk_add_f32 v[198:199], v[214:215], v[222:223]
  v_cvt_pk_bf16_f32 v103, v198, v199
  v_pk_add_f32 v[200:201], v[216:217], v[228:229]
  v_cvt_pk_bf16_f32 v185, v200, v201
  v_pk_add_f32 v[202:203], v[218:219], v[230:231]
  v_cvt_pk_bf16_f32 v187, v202, v203
  v_pk_add_f32 v[204:205], v[212:213], v[220:221] neg_lo:[0,1] neg_hi:[0,1]
  v_cvt_pk_bf16_f32 v189, v204, v205
  v_pk_add_f32 v[206:207], v[214:215], v[222:223] neg_lo:[0,1] neg_hi:[0,1]
  v_cvt_pk_bf16_f32 v191, v206, v207
  v_pk_add_f32 v[208:209], v[216:217], v[228:229] neg_lo:[0,1] neg_hi:[0,1]
  v_cvt_pk_bf16_f32 v193, v208, v209
  v_pk_add_f32 v[210:211], v[218:219], v[230:231] neg_lo:[0,1] neg_hi:[0,1]
  v_cvt_pk_bf16_f32 v195, v210, v211
  v_mov_b32 v100, v232
  v_mov_b32 v102, v233
  ds_write_b128 v39, v[100:103] offset:0
  v_mov_b32 v184, v234
  v_mov_b32 v186, v235
  ds_write_b128 v39, v[184:187] offset:4096
  v_mov_b32 v188, v236
  v_mov_b32 v190, v237
  ds_write_b128 v39, v[188:191] offset:8192
  v_mov_b32 v192, v238
  v_mov_b32 v194, v239
  ds_write_b128 v39, v[192:195] offset:12288
  v_mfma_f32_16x16x32_bf16 v[40:43], v[152:155], a[220:223], v[40:43]
  v_mfma_f32_16x16x32_bf16 v[44:47], v[156:159], a[220:223], v[44:47]
  buffer_load_dwordx4 v58, s[84:87], s82 offen offset:1024 sc1 lds
  v_mfma_f32_16x16x32_bf16 v[12:15], v[156:159], a[212:215], v[12:15]
  v_mfma_f32_16x16x32_bf16 v[16:19], v[160:163], a[212:215], v[16:19]
  buffer_load_dwordx4 v58, s[84:87], s82 offen offset:2048 sc1 lds
  v_mfma_f32_16x16x32_bf16 v[48:51], v[160:163], a[220:223], v[48:51]
  v_mfma_f32_16x16x32_bf16 v[52:55], v[168:171], a[220:223], v[52:55]
  buffer_load_dwordx4 v58, s[84:87], s82 offen offset:3072 sc1 lds
  s_add_u32 s82, s82, 65536
  s_and_b32 s82, s82, 0x3ffff
  v_mfma_f32_16x16x32_bf16 v[20:23], v[168:171], a[212:215], v[20:23]
  s_waitcnt lgkmcnt(4)
  v_mfma_f32_16x16x32_bf16 v[8:11], v[96:99], a[224:227], v[8:11]
  ds_read_b64_tr_b16 v[136:137], v224 offset:24576
  ds_read_b64_tr_b16 v[138:139], v225 offset:24576
  v_mfma_f32_16x16x32_bf16 v[40:43], v[96:99], a[232:235], v[40:43]
  ds_read_b64_tr_b16 v[140:141], v224 offset:26624
  ds_read_b64_tr_b16 v[142:143], v225 offset:26624
  v_mfma_f32_16x16x32_bf16 v[44:47], v[108:111], a[232:235], v[44:47]
  ds_read_b64_tr_b16 v[144:145], v224 offset:28672
  ds_read_b64_tr_b16 v[146:147], v225 offset:28672
  v_mfma_f32_16x16x32_bf16 v[12:15], v[108:111], a[224:227], v[12:15]
  ds_read_b64_tr_b16 v[148:149], v224 offset:30720
  ds_read_b64_tr_b16 v[150:151], v225 offset:30720
  v_mfma_f32_16x16x32_bf16 v[16:19], v[112:115], a[224:227], v[16:19]
  ds_read_b64_tr_b16 v[152:153], v224 offset:24832
  ds_read_b64_tr_b16 v[154:155], v225 offset:24832
  v_mfma_f32_16x16x32_bf16 v[48:51], v[112:115], a[232:235], v[48:51]
  ds_read_b64_tr_b16 v[156:157], v224 offset:26880
  ds_read_b64_tr_b16 v[158:159], v225 offset:26880
  v_mfma_f32_16x16x32_bf16 v[52:55], v[116:119], a[232:235], v[52:55]
  ds_read_b64_tr_b16 v[160:161], v224 offset:28928
  ds_read_b64_tr_b16 v[162:163], v225 offset:28928
  v_mfma_f32_16x16x32_bf16 v[20:23], v[116:119], a[224:227], v[20:23]
  ds_read_b64_tr_b16 v[168:169], v224 offset:30976
  ds_read_b64_tr_b16 v[170:171], v225 offset:30976
  v_mfma_f32_16x16x32_bf16 v[8:11], v[120:123], a[228:231], v[8:11]
  s_add_u32 m0, s83, 65536
  s_nop 0
  buffer_load_dwordx4 v58, s[84:87], s82 offen offset:0 sc1 lds
  v_mfma_f32_16x16x32_bf16 v[40:43], v[120:123], a[236:239], v[40:43]
  v_mfma_f32_16x16x32_bf16 v[44:47], v[124:127], a[236:239], v[44:47]
  buffer_load_dwordx4 v58, s[84:87], s82 offen offset:1024 sc1 lds
  v_mfma_f32_16x16x32_bf16 v[12:15], v[124:127], a[228:231], v[12:15]
  v_mfma_f32_16x16x32_bf16 v[16:19], v[128:131], a[228:231], v[16:19]
  buffer_load_dwordx4 v58, s[84:87], s82 offen offset:2048 sc1 lds
  v_mfma_f32_16x16x32_bf16 v[48:51], v[128:131], a[236:239], v[48:51]
  v_mfma_f32_16x16x32_bf16 v[52:55], v[132:135], a[236:239], v[52:55]
  buffer_load_dwordx4 v58, s[84:87], s82 offen offset:3072 sc1 lds
  s_add_u32 s82, s82, 65536
  s_and_b32 s82, s82, 0x3ffff
  v_mfma_f32_16x16x32_bf16 v[20:23], v[132:135], a[228:231], v[20:23]
  v_xor_b32 v106, 0x30000, v106
  v_xor_b32 v107, 0x30000, v107
  ds_read_b128 a[240:243], v106 offset:32768
  ds_read_b128 a[244:247], v107 offset:32768
  ds_read_b128 a[248:251], v106 offset:34816
  ds_read_b128 a[252:255], v107 offset:34816
  s_waitcnt lgkmcnt(15)
  s_waitcnt vmcnt(8) lgkmcnt(4)
  s_barrier
  s_waitcnt lgkmcnt(3)
  v_mfma_f32_16x16x32_bf16 v[8:11], v[136:139], a[240:243], v[8:11]
  ds_read_b64_tr_b16 v[96:97], v224 offset:32768
  ds_read_b64_tr_b16 v[98:99], v225 offset:32768
  s_waitcnt lgkmcnt(3)
  v_mfma_f32_16x16x32_bf16 v[40:43], v[136:139], a[248:251], v[40:43]
  ds_read_b64_tr_b16 v[108:109], v224 offset:34816
  ds_read_b64_tr_b16 v[110:111], v225 offset:34816
  v_mfma_f32_16x16x32_bf16 v[44:47], v[140:143], a[248:251], v[44:47]
  ds_read_b64_tr_b16 v[112:113], v224 offset:36864
  ds_read_b64_tr_b16 v[114:115], v225 offset:36864
  v_mfma_f32_16x16x32_bf16 v[12:15], v[140:143], a[240:243], v[12:15]
  ds_read_b64_tr_b16 v[116:117], v224 offset:38912
  ds_read_b64_tr_b16 v[118:119], v225 offset:38912
  v_mfma_f32_16x16x32_bf16 v[16:19], v[144:147], a[240:243], v[16:19]
  ds_read_b64_tr_b16 v[120:121], v224 offset:33024
  ds_read_b64_tr_b16 v[122:123], v225 offset:33024
  v_mfma_f32_16x16x32_bf16 v[48:51], v[144:147], a[248:251], v[48:51]
  ds_read_b64_tr_b16 v[124:125], v224 offset:35072
  ds_read_b64_tr_b16 v[126:127], v225 offset:35072
  v_mfma_f32_16x16x32_bf16 v[52:55], v[148:151], a[248:251], v[52:55]
  ds_read_b64_tr_b16 v[128:129], v224 offset:37120
  ds_read_b64_tr_b16 v[130:131], v225 offset:37120
  v_mfma_f32_16x16x32_bf16 v[20:23], v[148:151], a[240:243], v[20:23]
  ds_read_b64_tr_b16 v[132:133], v224 offset:39168
  ds_read_b64_tr_b16 v[134:135], v225 offset:39168
  v_mfma_f32_16x16x32_bf16 v[8:11], v[152:155], a[244:247], v[8:11]
  s_add_u32 m0, s83, 81920
  s_nop 0
  buffer_load_dwordx4 v58, s[84:87], s82 offen offset:0 sc1 lds
  s_waitcnt lgkmcnt(15)
  v_mfma_f32_16x16x32_bf16 v[40:43], v[152:155], a[252:255], v[40:43]
  v_mfma_f32_16x16x32_bf16 v[44:47], v[156:159], a[252:255], v[44:47]
  buffer_load_dwordx4 v58, s[84:87], s82 offen offset:1024 sc1 lds
  v_mfma_f32_16x16x32_bf16 v[12:15], v[156:159], a[244:247], v[12:15]
  v_mfma_f32_16x16x32_bf16 v[16:19], v[160:163], a[244:247], v[16:19]
  buffer_load_dwordx4 v58, s[84:87], s82 offen offset:2048 sc1 lds
  v_mfma_f32_16x16x32_bf16 v[48:51], v[160:163], a[252:255], v[48:51]
  v_mfma_f32_16x16x32_bf16 v[52:55], v[168:171], a[252:255], v[52:55]
  buffer_load_dwordx4 v58, s[84:87], s82 offen offset:3072 sc1 lds
  s_add_u32 s82, s82, 65536
  s_and_b32 s82, s82, 0x3ffff
  v_xor_b32 v58, 4096, v58
  v_mfma_f32_16x16x32_bf16 v[20:23], v[168:171], a[244:247], v[20:23]
  buffer_load_dwordx4 v[228:231], v37, s[76:79], s6 offen offset:0 sc1
  buffer_load_dwordx4 v[232:235], v37, s[76:79], s6 offen offset:256 sc1
  buffer_load_dwordx4 v[236:239], v37, s[76:79], s6 offen offset:512 sc1
  buffer_load_dwordx4 v[240:243], v37, s[76:79], s6 offen offset:768 sc1
  ds_read_b64_tr_b16 v[100:101], v6 offset:0
  ds_read_b64_tr_b16 v[102:103], v6 offset:256
  ds_read_b64_tr_b16 v[104:105], v6 offset:1024
  ds_read_b64_tr_b16 v[106:107], v6 offset:1280
  ds_read_b64_tr_b16 v[184:185], v6 offset:2048
  ds_read_b64_tr_b16 v[186:187], v6 offset:2304
  ds_read_b64_tr_b16 v[188:189], v6 offset:3072
  ds_read_b64_tr_b16 v[190:191], v6 offset:3328
  s_waitcnt lgkmcnt(8)
  v_mfma_f32_16x16x32_bf16 v[64:67], v[96:99], a[0:3], v[64:67]
  ds_read_b64_tr_b16 v[136:137], v224 offset:40960
  ds_read_b64_tr_b16 v[138:139], v225 offset:40960
  v_mfma_f32_16x16x32_bf16 v[80:83], v[96:99], a[8:11], 0
  ds_read_b64_tr_b16 v[140:141], v224 offset:43008
  ds_read_b64_tr_b16 v[142:143], v225 offset:43008
  v_mfma_f32_16x16x32_bf16 v[84:87], v[108:111], a[8:11], 0
  ds_read_b64_tr_b16 v[144:145], v224 offset:45056
  ds_read_b64_tr_b16 v[146:147], v225 offset:45056
  v_mfma_f32_16x16x32_bf16 v[68:71], v[108:111], a[0:3], v[68:71]
  ds_read_b64_tr_b16 v[148:149], v224 offset:47104
  ds_read_b64_tr_b16 v[150:151], v225 offset:47104
  v_mfma_f32_16x16x32_bf16 v[64:67], v[112:115], a[16:19], v[64:67]
  ds_read_b64_tr_b16 v[152:153], v224 offset:41216
  ds_read_b64_tr_b16 v[154:155], v225 offset:41216
  v_mfma_f32_16x16x32_bf16 v[80:83], v[112:115], a[24:27], v[80:83]
  ds_read_b64_tr_b16 v[156:157], v224 offset:43264
  ds_read_b64_tr_b16 v[158:159], v225 offset:43264
  v_mfma_f32_16x16x32_bf16 v[84:87], v[116:119], a[24:27], v[84:87]
  ds_read_b64_tr_b16 v[160:161], v224 offset:45312
  ds_read_b64_tr_b16 v[162:163], v225 offset:45312
  v_mfma_f32_16x16x32_bf16 v[68:71], v[116:119], a[16:19], v[68:71]
  ds_read_b64_tr_b16 v[168:169], v224 offset:47360
  ds_read_b64_tr_b16 v[170:171], v225 offset:47360
  v_mfma_f32_16x16x32_bf16 v[64:67], v[120:123], a[4:7], v[64:67]
  s_add_u32 m0, s83, 0
  s_nop 0
  buffer_load_dwordx4 v58, s[84:87], s82 offen offset:0 sc1 lds
  s_waitcnt lgkmcnt(15)
  v_mfma_f32_16x16x32_bf16 v[192:195], v[24:27], v[100:103], 0
  s_waitcnt lgkmcnt(15)
  v_mfma_f32_16x16x32_bf16 v[208:211], v[24:27], v[184:187], 0
  v_mfma_f32_16x16x32_bf16 v[80:83], v[120:123], a[12:15], v[80:83]
  v_mfma_f32_16x16x32_bf16 v[196:199], v[32:35], v[100:103], 0
  v_mfma_f32_16x16x32_bf16 v[212:215], v[32:35], v[184:187], 0
  v_mfma_f32_16x16x32_bf16 v[84:87], v[124:127], a[12:15], v[84:87]
  buffer_load_dwordx4 v58, s[84:87], s82 offen offset:1024 sc1 lds
  v_mfma_f32_16x16x32_bf16 v[200:203], v[164:167], v[100:103], 0
  v_mfma_f32_16x16x32_bf16 v[216:219], v[164:167], v[184:187], 0
  v_mfma_f32_16x16x32_bf16 v[68:71], v[124:127], a[4:7], v[68:71]
  v_mfma_f32_16x16x32_bf16 v[204:207], v[176:179], v[100:103], 0
  v_mfma_f32_16x16x32_bf16 v[220:223], v[176:179], v[184:187], 0
  v_mfma_f32_16x16x32_bf16 v[64:67], v[128:131], a[20:23], v[64:67]
  buffer_load_dwordx4 v58, s[84:87], s82 offen offset:2048 sc1 lds
  v_mfma_f32_16x16x32_bf16 v[192:195], v[28:31], v[104:107], v[192:195]
  s_waitcnt lgkmcnt(15)
  v_mfma_f32_16x16x32_bf16 v[208:211], v[28:31], v[188:191], v[208:211]
  v_mfma_f32_16x16x32_bf16 v[80:83], v[128:131], a[28:31], v[80:83]
  v_mfma_f32_16x16x32_bf16 v[196:199], v[60:63], v[104:107], v[196:199]
  v_mfma_f32_16x16x32_bf16 v[212:215], v[60:63], v[188:191], v[212:215]
  v_mfma_f32_16x16x32_bf16 v[84:87], v[132:135], a[28:31], v[84:87]
  buffer_load_dwordx4 v58, s[84:87], s82 offen offset:3072 sc1 lds
  s_add_u32 s82, s82, 65536
  s_and_b32 s82, s82, 0x3ffff
  v_mfma_f32_16x16x32_bf16 v[200:203], v[172:175], v[104:107], v[200:203]
  v_mfma_f32_16x16x32_bf16 v[216:219], v[172:175], v[188:191], v[216:219]
  v_mfma_f32_16x16x32_bf16 v[68:71], v[132:135], a[20:23], v[68:71]
  v_mfma_f32_16x16x32_bf16 v[204:207], v[180:183], v[104:107], v[204:207]
  v_mfma_f32_16x16x32_bf16 v[220:223], v[180:183], v[188:191], v[220:223]
  s_waitcnt vmcnt(12) lgkmcnt(0)
  s_barrier
  v_mfma_f32_16x16x32_bf16 v[64:67], v[136:139], a[32:35], v[64:67]
  ds_read_b64_tr_b16 v[96:97], v224 offset:49152
  ds_read_b64_tr_b16 v[98:99], v225 offset:49152
  v_mfma_f32_16x16x32_bf16 v[80:83], v[136:139], a[40:43], v[80:83]
  ds_read_b64_tr_b16 v[108:109], v224 offset:51200
  ds_read_b64_tr_b16 v[110:111], v225 offset:51200
  v_mfma_f32_16x16x32_bf16 v[84:87], v[140:143], a[40:43], v[84:87]
  ds_read_b64_tr_b16 v[112:113], v224 offset:53248
  ds_read_b64_tr_b16 v[114:115], v225 offset:53248
  v_mfma_f32_16x16x32_bf16 v[68:71], v[140:143], a[32:35], v[68:71]
  ds_read_b64_tr_b16 v[116:117], v224 offset:55296
  ds_read_b64_tr_b16 v[118:119], v225 offset:55296
  v_mfma_f32_16x16x32_bf16 v[64:67], v[144:147], a[48:51], v[64:67]
  ds_read_b64_tr_b16 v[120:121], v224 offset:49408
  ds_read_b64_tr_b16 v[122:123], v225 offset:49408
  v_mfma_f32_16x16x32_bf16 v[80:83], v[144:147], a[56:59], v[80:83]
  ds_read_b64_tr_b16 v[124:125], v224 offset:51456
  ds_read_b64_tr_b16 v[126:127], v225 offset:51456
  v_mfma_f32_16x16x32_bf16 v[84:87], v[148:151], a[56:59], v[84:87]
  ds_read_b64_tr_b16 v[128:129], v224 offset:53504
  ds_read_b64_tr_b16 v[130:131], v225 offset:53504
  v_mfma_f32_16x16x32_bf16 v[68:71], v[148:151], a[48:51], v[68:71]
  ds_read_b64_tr_b16 v[132:133], v224 offset:55552
  ds_read_b64_tr_b16 v[134:135], v225 offset:55552
  v_mfma_f32_16x16x32_bf16 v[64:67], v[152:155], a[36:39], v[64:67]
  s_add_u32 m0, s83, 16384
  s_nop 0
  buffer_load_dwordx4 v58, s[84:87], s82 offen offset:0 sc1 lds
  v_xor_b32 v25, 0x80008000, v25
  v_xor_b32 v27, 0x80008000, v27
  v_xor_b32 v29, 0x80008000, v29
  v_xor_b32 v31, 0x80008000, v31
  v_xor_b32 v33, 0x80008000, v33
  v_xor_b32 v35, 0x80008000, v35
  v_mfma_f32_16x16x32_bf16 v[80:83], v[152:155], a[44:47], v[80:83]
  v_xor_b32 v61, 0x80008000, v61
  v_xor_b32 v63, 0x80008000, v63
  v_xor_b32 v165, 0x80008000, v165
  v_xor_b32 v167, 0x80008000, v167
  v_xor_b32 v173, 0x80008000, v173
  v_xor_b32 v175, 0x80008000, v175
  v_mfma_f32_16x16x32_bf16 v[84:87], v[156:159], a[44:47], v[84:87]
  buffer_load_dwordx4 v58, s[84:87], s82 offen offset:1024 sc1 lds
  v_xor_b32 v177, 0x80008000, v177
  v_xor_b32 v179, 0x80008000, v179
  v_xor_b32 v181, 0x80008000, v181
  v_xor_b32 v183, 0x80008000, v183
  v_pk_add_f32 v[192:193], v[192:193], v[8:9] neg_lo:[0,1] neg_hi:[0,1]
  v_pk_add_f32 v[194:195], v[194:195], v[10:11] neg_lo:[0,1] neg_hi:[0,1]
  v_mfma_f32_16x16x32_bf16 v[68:71], v[156:159], a[36:39], v[68:71]
  s_waitcnt vmcnt(9)
  v_pk_fma_f32 v[8:9], v[228:229], v[192:193], v[8:9]
  v_pk_fma_f32 v[10:11], v[230:231], v[194:195], v[10:11]
  v_perm_b32 v8, v9, v8, s32
  v_perm_b32 v9, v11, v10, s32
  v_or_b32 v8, 0x10001, v8
  v_or_b32 v9, 0x10001, v9
  v_mfma_f32_16x16x32_bf16 v[64:67], v[160:163], a[52:55], v[64:67]
  buffer_load_dwordx4 v58, s[84:87], s82 offen offset:2048 sc1 lds
  v_pk_add_f32 v[196:197], v[196:197], v[12:13] neg_lo:[0,1] neg_hi:[0,1]
  v_pk_add_f32 v[198:199], v[198:199], v[14:15] neg_lo:[0,1] neg_hi:[0,1]
  s_waitcnt vmcnt(9)
  v_pk_fma_f32 v[12:13], v[232:233], v[196:197], v[12:13]
  v_pk_fma_f32 v[14:15], v[234:235], v[198:199], v[14:15]
  v_perm_b32 v10, v13, v12, s32
  v_perm_b32 v11, v15, v14, s32
  v_mfma_f32_16x16x32_bf16 v[80:83], v[160:163], a[60:63], v[80:83]
  v_or_b32 v10, 0x10001, v10
  v_or_b32 v11, 0x10001, v11
  buffer_store_dwordx4 v[8:11], v36, s[20:23], s7 offen offset:0 sc1
  v_pk_add_f32 v[200:201], v[200:201], v[16:17] neg_lo:[0,1] neg_hi:[0,1]
  v_pk_add_f32 v[202:203], v[202:203], v[18:19] neg_lo:[0,1] neg_hi:[0,1]
  s_waitcnt vmcnt(9)
  v_pk_fma_f32 v[16:17], v[236:237], v[200:201], v[16:17]
  v_mfma_f32_16x16x32_bf16 v[84:87], v[168:171], a[60:63], v[84:87]
  buffer_load_dwordx4 v58, s[84:87], s82 offen offset:3072 sc1 lds
  s_add_u32 s82, s82, 65536
  s_and_b32 s82, s82, 0x3ffff
  v_pk_fma_f32 v[18:19], v[238:239], v[202:203], v[18:19]
  v_perm_b32 v12, v17, v16, s32
  v_perm_b32 v13, v19, v18, s32
  v_or_b32 v12, 0x10001, v12
  v_or_b32 v13, 0x10001, v13
  v_pk_add_f32 v[204:205], v[204:205], v[20:21] neg_lo:[0,1] neg_hi:[0,1]
  v_mfma_f32_16x16x32_bf16 v[68:71], v[168:171], a[52:55], v[68:71]
  v_pk_add_f32 v[206:207], v[206:207], v[22:23] neg_lo:[0,1] neg_hi:[0,1]
  s_waitcnt vmcnt(9)
  v_pk_fma_f32 v[20:21], v[240:241], v[204:205], v[20:21]
  v_pk_fma_f32 v[22:23], v[242:243], v[206:207], v[22:23]
  v_perm_b32 v14, v21, v20, s32
  v_perm_b32 v15, v23, v22, s32
  v_or_b32 v14, 0x10001, v14
  s_waitcnt lgkmcnt(0)
  v_mfma_f32_16x16x32_bf16 v[64:67], v[96:99], a[64:67], v[64:67]
  ds_read_b64_tr_b16 v[136:137], v224 offset:57344
  ds_read_b64_tr_b16 v[138:139], v225 offset:57344
  v_mfma_f32_16x16x32_bf16 v[80:83], v[96:99], a[72:75], v[80:83]
  ds_read_b64_tr_b16 v[140:141], v224 offset:59392
  ds_read_b64_tr_b16 v[142:143], v225 offset:59392
  v_mfma_f32_16x16x32_bf16 v[84:87], v[108:111], a[72:75], v[84:87]
  ds_read_b64_tr_b16 v[144:145], v224 offset:61440
  ds_read_b64_tr_b16 v[146:147], v225 offset:61440
  v_mfma_f32_16x16x32_bf16 v[68:71], v[108:111], a[64:67], v[68:71]
  ds_read_b64_tr_b16 v[148:149], v224 offset:63488
  ds_read_b64_tr_b16 v[150:151], v225 offset:63488
  v_mfma_f32_16x16x32_bf16 v[64:67], v[112:115], a[80:83], v[64:67]
  ds_read_b64_tr_b16 v[152:153], v224 offset:57600
  ds_read_b64_tr_b16 v[154:155], v225 offset:57600
  v_mfma_f32_16x16x32_bf16 v[80:83], v[112:115], a[88:91], v[80:83]
  ds_read_b64_tr_b16 v[156:157], v224 offset:59648
  ds_read_b64_tr_b16 v[158:159], v225 offset:59648
  v_mfma_f32_16x16x32_bf16 v[84:87], v[116:119], a[88:91], v[84:87]
  ds_read_b64_tr_b16 v[160:161], v224 offset:61696
  ds_read_b64_tr_b16 v[162:163], v225 offset:61696
  v_mfma_f32_16x16x32_bf16 v[68:71], v[116:119], a[80:83], v[68:71]
  ds_read_b64_tr_b16 v[168:169], v224 offset:63744
  ds_read_b64_tr_b16 v[170:171], v225 offset:63744
  v_mfma_f32_16x16x32_bf16 v[64:67], v[120:123], a[68:71], v[64:67]
  s_add_u32 m0, s83, 32768
  s_nop 0
  buffer_load_dwordx4 v58, s[84:87], s82 offen offset:0 sc1 lds
  v_or_b32 v15, 0x10001, v15
  buffer_store_dwordx4 v[12:15], v36, s[20:23], s7 offen offset:1024 sc1
  v_pk_add_f32 v[208:209], v[208:209], v[40:41] neg_lo:[0,1] neg_hi:[0,1]
  v_pk_add_f32 v[210:211], v[210:211], v[42:43] neg_lo:[0,1] neg_hi:[0,1]
  v_pk_fma_f32 v[40:41], v[228:229], v[208:209], v[40:41]
  v_pk_fma_f32 v[42:43], v[230:231], v[210:211], v[42:43]
  v_mfma_f32_16x16x32_bf16 v[80:83], v[120:123], a[76:79], v[80:83]
  v_perm_b32 v16, v41, v40, s32
  v_perm_b32 v17, v43, v42, s32
  v_or_b32 v16, 0x10001, v16
  v_or_b32 v17, 0x10001, v17
  v_pk_add_f32 v[212:213], v[212:213], v[44:45] neg_lo:[0,1] neg_hi:[0,1]
  v_pk_add_f32 v[214:215], v[214:215], v[46:47] neg_lo:[0,1] neg_hi:[0,1]
  v_mfma_f32_16x16x32_bf16 v[84:87], v[124:127], a[76:79], v[84:87]
  buffer_load_dwordx4 v58, s[84:87], s82 offen offset:1024 sc1 lds
  v_pk_fma_f32 v[44:45], v[232:233], v[212:213], v[44:45]
  v_pk_fma_f32 v[46:47], v[234:235], v[214:215], v[46:47]
  v_perm_b32 v18, v45, v44, s32
  v_perm_b32 v19, v47, v46, s32
  v_or_b32 v18, 0x10001, v18
  v_or_b32 v19, 0x10001, v19
  v_mfma_f32_16x16x32_bf16 v[68:71], v[124:127], a[68:71], v[68:71]
  buffer_store_dwordx4 v[16:19], v36, s[20:23], s7 offen offset:2048 sc1
  v_pk_add_f32 v[216:217], v[216:217], v[48:49] neg_lo:[0,1] neg_hi:[0,1]
  v_pk_add_f32 v[218:219], v[218:219], v[50:51] neg_lo:[0,1] neg_hi:[0,1]
  v_pk_fma_f32 v[48:49], v[236:237], v[216:217], v[48:49]
  v_pk_fma_f32 v[50:51], v[238:239], v[218:219], v[50:51]
  v_perm_b32 v20, v49, v48, s32
  v_mfma_f32_16x16x32_bf16 v[64:67], v[128:131], a[84:87], v[64:67]
  buffer_load_dwordx4 v58, s[84:87], s82 offen offset:2048 sc1 lds
  v_perm_b32 v21, v51, v50, s32
  v_or_b32 v20, 0x10001, v20
  v_or_b32 v21, 0x10001, v21
  v_pk_add_f32 v[220:221], v[220:221], v[52:53] neg_lo:[0,1] neg_hi:[0,1]
  v_pk_add_f32 v[222:223], v[222:223], v[54:55] neg_lo:[0,1] neg_hi:[0,1]
  v_pk_fma_f32 v[52:53], v[240:241], v[220:221], v[52:53]
  v_mfma_f32_16x16x32_bf16 v[80:83], v[128:131], a[92:95], v[80:83]
  v_pk_fma_f32 v[54:55], v[242:243], v[222:223], v[54:55]
  v_perm_b32 v22, v53, v52, s32
  v_perm_b32 v23, v55, v54, s32
  v_or_b32 v22, 0x10001, v22
  v_or_b32 v23, 0x10001, v23
  buffer_store_dwordx4 v[20:23], v36, s[20:23], s7 offen offset:3072 sc1
  v_mfma_f32_16x16x32_bf16 v[84:87], v[132:135], a[92:95], v[84:87]
  buffer_load_dwordx4 v58, s[84:87], s82 offen offset:3072 sc1 lds
  s_add_u32 s82, s82, 65536
  s_and_b32 s82, s82, 0x3ffff
  s_xor_b32 s6, s6, 1024
  s_xor_b32 s7, s7, 131072
  v_mfma_f32_16x16x32_bf16 v[68:71], v[132:135], a[84:87], v[68:71]
  s_waitcnt lgkmcnt(0)
  v_mfma_f32_16x16x32_bf16 v[64:67], v[136:139], a[96:99], v[64:67]
  ds_read_b64_tr_b16 v[96:97], v226 offset:0
  ds_read_b64_tr_b16 v[98:99], v227 offset:0
  v_mfma_f32_16x16x32_bf16 v[80:83], v[136:139], a[104:107], v[80:83]
  ds_read_b64_tr_b16 v[108:109], v226 offset:2048
  ds_read_b64_tr_b16 v[110:111], v227 offset:2048
  v_mfma_f32_16x16x32_bf16 v[84:87], v[140:143], a[104:107], v[84:87]
  ds_read_b64_tr_b16 v[112:113], v226 offset:4096
  ds_read_b64_tr_b16 v[114:115], v227 offset:4096
  v_mfma_f32_16x16x32_bf16 v[68:71], v[140:143], a[96:99], v[68:71]
  ds_read_b64_tr_b16 v[116:117], v226 offset:6144
  ds_read_b64_tr_b16 v[118:119], v227 offset:6144
  v_mfma_f32_16x16x32_bf16 v[64:67], v[144:147], a[112:115], v[64:67]
  ds_read_b64_tr_b16 v[120:121], v226 offset:256
  ds_read_b64_tr_b16 v[122:123], v227 offset:256
  v_mfma_f32_16x16x32_bf16 v[80:83], v[144:147], a[120:123], v[80:83]
  ds_read_b64_tr_b16 v[124:125], v226 offset:2304
  ds_read_b64_tr_b16 v[126:127], v227 offset:2304
  v_mfma_f32_16x16x32_bf16 v[84:87], v[148:151], a[120:123], v[84:87]
  ds_read_b64_tr_b16 v[128:129], v226 offset:4352
  ds_read_b64_tr_b16 v[130:131], v227 offset:4352
  v_mfma_f32_16x16x32_bf16 v[68:71], v[148:151], a[112:115], v[68:71]
  ds_read_b64_tr_b16 v[132:133], v226 offset:6400
  ds_read_b64_tr_b16 v[134:135], v227 offset:6400
  v_mfma_f32_16x16x32_bf16 v[64:67], v[152:155], a[100:103], v[64:67]
  v_mfma_f32_16x16x32_bf16 v[80:83], v[152:155], a[108:111], v[80:83]
  v_mfma_f32_16x16x32_bf16 v[84:87], v[156:159], a[108:111], v[84:87]
  v_mfma_f32_16x16x32_bf16 v[68:71], v[156:159], a[100:103], v[68:71]
  v_mfma_f32_16x16x32_bf16 v[64:67], v[160:163], a[116:119], v[64:67]
  v_mfma_f32_16x16x32_bf16 v[80:83], v[160:163], a[124:127], v[80:83]
  v_mfma_f32_16x16x32_bf16 v[84:87], v[168:171], a[124:127], v[84:87]
  v_mfma_f32_16x16x32_bf16 v[68:71], v[168:171], a[116:119], v[68:71]
  s_waitcnt lgkmcnt(0)
  v_mfma_f32_16x16x32_bf16 v[64:67], v[96:99], a[128:131], v[64:67]
  ds_read_b64_tr_b16 v[136:137], v226 offset:8192
  ds_read_b64_tr_b16 v[138:139], v227 offset:8192
  v_mfma_f32_16x16x32_bf16 v[80:83], v[96:99], a[136:139], v[80:83]
  ds_read_b64_tr_b16 v[140:141], v226 offset:10240
  ds_read_b64_tr_b16 v[142:143], v227 offset:10240
  v_mfma_f32_16x16x32_bf16 v[84:87], v[108:111], a[136:139], v[84:87]
  ds_read_b64_tr_b16 v[144:145], v226 offset:12288
  ds_read_b64_tr_b16 v[146:147], v227 offset:12288
  v_mfma_f32_16x16x32_bf16 v[68:71], v[108:111], a[128:131], v[68:71]
  ds_read_b64_tr_b16 v[148:149], v226 offset:14336
  ds_read_b64_tr_b16 v[150:151], v227 offset:14336
  v_mfma_f32_16x16x32_bf16 v[64:67], v[112:115], a[144:147], v[64:67]
  ds_read_b64_tr_b16 v[152:153], v226 offset:8448
  ds_read_b64_tr_b16 v[154:155], v227 offset:8448
  v_mfma_f32_16x16x32_bf16 v[80:83], v[112:115], a[152:155], v[80:83]
  ds_read_b64_tr_b16 v[156:157], v226 offset:10496
  ds_read_b64_tr_b16 v[158:159], v227 offset:10496
  v_mfma_f32_16x16x32_bf16 v[84:87], v[116:119], a[152:155], v[84:87]
  ds_read_b64_tr_b16 v[160:161], v226 offset:12544
  ds_read_b64_tr_b16 v[162:163], v227 offset:12544
  v_mfma_f32_16x16x32_bf16 v[68:71], v[116:119], a[144:147], v[68:71]
  ds_read_b64_tr_b16 v[168:169], v226 offset:14592
  ds_read_b64_tr_b16 v[170:171], v227 offset:14592
  v_mfma_f32_16x16x32_bf16 v[64:67], v[120:123], a[132:135], v[64:67]
  v_mfma_f32_16x16x32_bf16 v[80:83], v[120:123], a[140:143], v[80:83]
  v_mfma_f32_16x16x32_bf16 v[84:87], v[124:127], a[140:143], v[84:87]
  v_mfma_f32_16x16x32_bf16 v[68:71], v[124:127], a[132:135], v[68:71]
  v_mfma_f32_16x16x32_bf16 v[64:67], v[128:131], a[148:151], v[64:67]
  v_mfma_f32_16x16x32_bf16 v[80:83], v[128:131], a[156:159], v[80:83]
  v_mfma_f32_16x16x32_bf16 v[84:87], v[132:135], a[156:159], v[84:87]
  v_mfma_f32_16x16x32_bf16 v[68:71], v[132:135], a[148:151], v[68:71]
  s_waitcnt vmcnt(12) lgkmcnt(0)
  s_barrier
  v_mfma_f32_16x16x32_bf16 v[64:67], v[136:139], a[160:163], v[64:67]
  ds_read_b64_tr_b16 v[96:97], v226 offset:16384
  ds_read_b64_tr_b16 v[98:99], v227 offset:16384
  v_mfma_f32_16x16x32_bf16 v[80:83], v[136:139], a[168:171], v[80:83]
  ds_read_b64_tr_b16 v[108:109], v226 offset:18432
  ds_read_b64_tr_b16 v[110:111], v227 offset:18432
  v_mfma_f32_16x16x32_bf16 v[84:87], v[140:143], a[168:171], v[84:87]
  ds_read_b64_tr_b16 v[112:113], v226 offset:20480
  ds_read_b64_tr_b16 v[114:115], v227 offset:20480
  v_mfma_f32_16x16x32_bf16 v[68:71], v[140:143], a[160:163], v[68:71]
  ds_read_b64_tr_b16 v[116:117], v226 offset:22528
  ds_read_b64_tr_b16 v[118:119], v227 offset:22528
  v_mfma_f32_16x16x32_bf16 v[64:67], v[144:147], a[176:179], v[64:67]
  ds_read_b64_tr_b16 v[120:121], v226 offset:16640
  ds_read_b64_tr_b16 v[122:123], v227 offset:16640
  v_mfma_f32_16x16x32_bf16 v[80:83], v[144:147], a[184:187], v[80:83]
  ds_read_b64_tr_b16 v[124:125], v226 offset:18688
  ds_read_b64_tr_b16 v[126:127], v227 offset:18688
  v_mfma_f32_16x16x32_bf16 v[84:87], v[148:151], a[184:187], v[84:87]
  ds_read_b64_tr_b16 v[128:129], v226 offset:20736
  ds_read_b64_tr_b16 v[130:131], v227 offset:20736
  v_mfma_f32_16x16x32_bf16 v[68:71], v[148:151], a[176:179], v[68:71]
  ds_read_b64_tr_b16 v[132:133], v226 offset:22784
  ds_read_b64_tr_b16 v[134:135], v227 offset:22784
  v_mfma_f32_16x16x32_bf16 v[64:67], v[152:155], a[164:167], v[64:67]
  s_add_u32 m0, s83, 49152
  s_nop 0
  buffer_load_dwordx4 v58, s[84:87], s82 offen offset:0 sc1 lds
  v_mfma_f32_16x16x32_bf16 v[80:83], v[152:155], a[172:175], v[80:83]
  v_mfma_f32_16x16x32_bf16 v[84:87], v[156:159], a[172:175], v[84:87]
  buffer_load_dwordx4 v58, s[84:87], s82 offen offset:1024 sc1 lds
  v_mfma_f32_16x16x32_bf16 v[68:71], v[156:159], a[164:167], v[68:71]
  v_mfma_f32_16x16x32_bf16 v[64:67], v[160:163], a[180:183], v[64:67]
  buffer_load_dwordx4 v58, s[84:87], s82 offen offset:2048 sc1 lds
  v_mfma_f32_16x16x32_bf16 v[80:83], v[160:163], a[188:191], v[80:83]
  v_mfma_f32_16x16x32_bf16 v[84:87], v[168:171], a[188:191], v[84:87]
  buffer_load_dwordx4 v58, s[84:87], s82 offen offset:3072 sc1 lds
  s_add_u32 s82, s82, 65536
  s_and_b32 s82, s82, 0x3ffff
  v_mfma_f32_16x16x32_bf16 v[68:71], v[168:171], a[180:183], v[68:71]
  s_waitcnt lgkmcnt(0)
  v_mfma_f32_16x16x32_bf16 v[64:67], v[96:99], a[192:195], v[64:67]
  ds_read_b64_tr_b16 v[136:137], v226 offset:24576
  ds_read_b64_tr_b16 v[138:139], v227 offset:24576
  v_mfma_f32_16x16x32_bf16 v[80:83], v[96:99], a[200:203], v[80:83]
  ds_read_b64_tr_b16 v[140:141], v226 offset:26624
  ds_read_b64_tr_b16 v[142:143], v227 offset:26624
  v_mfma_f32_16x16x32_bf16 v[84:87], v[108:111], a[200:203], v[84:87]
  ds_read_b64_tr_b16 v[144:145], v226 offset:28672
  ds_read_b64_tr_b16 v[146:147], v227 offset:28672
  v_mfma_f32_16x16x32_bf16 v[68:71], v[108:111], a[192:195], v[68:71]
  ds_read_b64_tr_b16 v[148:149], v226 offset:30720
  ds_read_b64_tr_b16 v[150:151], v227 offset:30720
  v_mfma_f32_16x16x32_bf16 v[64:67], v[112:115], a[208:211], v[64:67]
  ds_read_b64_tr_b16 v[152:153], v226 offset:24832
  ds_read_b64_tr_b16 v[154:155], v227 offset:24832
  v_mfma_f32_16x16x32_bf16 v[80:83], v[112:115], a[216:219], v[80:83]
  ds_read_b64_tr_b16 v[156:157], v226 offset:26880
  ds_read_b64_tr_b16 v[158:159], v227 offset:26880
  v_mfma_f32_16x16x32_bf16 v[84:87], v[116:119], a[216:219], v[84:87]
  ds_read_b64_tr_b16 v[160:161], v226 offset:28928
  ds_read_b64_tr_b16 v[162:163], v227 offset:28928
  v_mfma_f32_16x16x32_bf16 v[68:71], v[116:119], a[208:211], v[68:71]
  ds_read_b64_tr_b16 v[168:169], v226 offset:30976
  ds_read_b64_tr_b16 v[170:171], v227 offset:30976
  v_mfma_f32_16x16x32_bf16 v[64:67], v[120:123], a[196:199], v[64:67]
  v_mfma_f32_16x16x32_bf16 v[80:83], v[120:123], a[204:207], v[80:83]
  v_mfma_f32_16x16x32_bf16 v[84:87], v[124:127], a[204:207], v[84:87]
  v_mfma_f32_16x16x32_bf16 v[68:71], v[124:127], a[196:199], v[68:71]
  v_mfma_f32_16x16x32_bf16 v[64:67], v[128:131], a[212:215], v[64:67]
  v_mfma_f32_16x16x32_bf16 v[80:83], v[128:131], a[220:223], v[80:83]
  v_mfma_f32_16x16x32_bf16 v[84:87], v[132:135], a[220:223], v[84:87]
  v_mfma_f32_16x16x32_bf16 v[68:71], v[132:135], a[212:215], v[68:71]
  buffer_load_dwordx4 v[228:231], v37, s[76:79], s6 offen offset:0 sc1
  buffer_load_dwordx4 v[232:235], v37, s[76:79], s6 offen offset:256 sc1
  buffer_load_dwordx4 v[236:239], v37, s[76:79], s6 offen offset:512 sc1
  buffer_load_dwordx4 v[240:243], v37, s[76:79], s6 offen offset:768 sc1
  s_waitcnt lgkmcnt(0)
  v_mfma_f32_16x16x32_bf16 v[64:67], v[136:139], a[224:227], v[64:67]
  ds_read_b64_tr_b16 v[96:97], v224 offset:0
  ds_read_b64_tr_b16 v[98:99], v225 offset:0
  v_mfma_f32_16x16x32_bf16 v[80:83], v[136:139], a[232:235], v[80:83]
  ds_read_b64_tr_b16 v[108:109], v224 offset:2048
  ds_read_b64_tr_b16 v[110:111], v225 offset:2048
  v_mfma_f32_16x16x32_bf16 v[84:87], v[140:143], a[232:235], v[84:87]
  ds_read_b64_tr_b16 v[112:113], v224 offset:4096
  ds_read_b64_tr_b16 v[114:115], v225 offset:4096
  v_mfma_f32_16x16x32_bf16 v[68:71], v[140:143], a[224:227], v[68:71]
  ds_read_b64_tr_b16 v[116:117], v224 offset:6144
  ds_read_b64_tr_b16 v[118:119], v225 offset:6144
  v_mfma_f32_16x16x32_bf16 v[64:67], v[144:147], a[240:243], v[64:67]
  ds_read_b64_tr_b16 v[120:121], v224 offset:256
  ds_read_b64_tr_b16 v[122:123], v225 offset:256
  v_mfma_f32_16x16x32_bf16 v[80:83], v[144:147], a[248:251], v[80:83]
  ds_read_b64_tr_b16 v[124:125], v224 offset:2304
  ds_read_b64_tr_b16 v[126:127], v225 offset:2304
  v_mfma_f32_16x16x32_bf16 v[84:87], v[148:151], a[248:251], v[84:87]
  ds_read_b64_tr_b16 v[128:129], v224 offset:4352
  ds_read_b64_tr_b16 v[130:131], v225 offset:4352
  v_mfma_f32_16x16x32_bf16 v[68:71], v[148:151], a[240:243], v[68:71]
  ds_read_b64_tr_b16 v[132:133], v224 offset:6400
  ds_read_b64_tr_b16 v[134:135], v225 offset:6400
  v_mfma_f32_16x16x32_bf16 v[64:67], v[152:155], a[228:231], v[64:67]
  v_mfma_f32_16x16x32_bf16 v[80:83], v[152:155], a[236:239], v[80:83]
  buffer_load_dwordx4 v[16:19], v36, s[20:23], s7 offen offset:0 sc1
  v_mfma_f32_16x16x32_bf16 v[84:87], v[156:159], a[236:239], v[84:87]
  v_mfma_f32_16x16x32_bf16 v[68:71], v[156:159], a[228:231], v[68:71]
  buffer_load_dwordx4 v[20:23], v36, s[20:23], s7 offen offset:1024 sc1
  v_mfma_f32_16x16x32_bf16 v[64:67], v[160:163], a[244:247], v[64:67]
  v_mfma_f32_16x16x32_bf16 v[80:83], v[160:163], a[252:255], v[80:83]
  buffer_load_dwordx4 v[8:11], v36, s[20:23], s7 offen offset:2048 sc1
  v_mfma_f32_16x16x32_bf16 v[84:87], v[168:171], a[252:255], v[84:87]
  v_mfma_f32_16x16x32_bf16 v[68:71], v[168:171], a[244:247], v[68:71]
  buffer_load_dwordx4 v[12:15], v36, s[20:23], s7 offen offset:3072 sc1
  s_waitcnt lgkmcnt(0)
  v_mfma_f32_16x16x32_bf16 v[72:75], v[96:99], a[0:3], v[72:75]
  ds_read_b64_tr_b16 v[136:137], v224 offset:8192
  ds_read_b64_tr_b16 v[138:139], v225 offset:8192
  v_mfma_f32_16x16x32_bf16 v[88:91], v[96:99], a[8:11], 0
  ds_read_b64_tr_b16 v[140:141], v224 offset:10240
  ds_read_b64_tr_b16 v[142:143], v225 offset:10240
  v_mfma_f32_16x16x32_bf16 v[92:95], v[108:111], a[8:11], 0
  ds_read_b64_tr_b16 v[144:145], v224 offset:12288
  ds_read_b64_tr_b16 v[146:147], v225 offset:12288
  v_mfma_f32_16x16x32_bf16 v[76:79], v[108:111], a[0:3], v[76:79]
  ds_read_b64_tr_b16 v[148:149], v224 offset:14336
  ds_read_b64_tr_b16 v[150:151], v225 offset:14336
  v_mfma_f32_16x16x32_bf16 v[72:75], v[112:115], a[16:19], v[72:75]
  ds_read_b64_tr_b16 v[152:153], v224 offset:8448
  ds_read_b64_tr_b16 v[154:155], v225 offset:8448
  v_mfma_f32_16x16x32_bf16 v[88:91], v[112:115], a[24:27], v[88:91]
  ds_read_b64_tr_b16 v[156:157], v224 offset:10496
  ds_read_b64_tr_b16 v[158:159], v225 offset:10496
  v_mfma_f32_16x16x32_bf16 v[92:95], v[116:119], a[24:27], v[92:95]
  ds_read_b64_tr_b16 v[160:161], v224 offset:12544
  ds_read_b64_tr_b16 v[162:163], v225 offset:12544
  v_mfma_f32_16x16x32_bf16 v[76:79], v[116:119], a[16:19], v[76:79]
  ds_read_b64_tr_b16 v[168:169], v224 offset:14592
  ds_read_b64_tr_b16 v[170:171], v225 offset:14592
  v_mfma_f32_16x16x32_bf16 v[72:75], v[120:123], a[4:7], v[72:75]
  v_mfma_f32_16x16x32_bf16 v[192:195], v[24:27], v[100:103], 0
  v_mfma_f32_16x16x32_bf16 v[208:211], v[24:27], v[184:187], 0
  v_mfma_f32_16x16x32_bf16 v[88:91], v[120:123], a[12:15], v[88:91]
  v_mfma_f32_16x16x32_bf16 v[196:199], v[32:35], v[100:103], 0
  v_mfma_f32_16x16x32_bf16 v[212:215], v[32:35], v[184:187], 0
  v_mfma_f32_16x16x32_bf16 v[92:95], v[124:127], a[12:15], v[92:95]
  v_mfma_f32_16x16x32_bf16 v[200:203], v[164:167], v[100:103], 0
  v_mfma_f32_16x16x32_bf16 v[216:219], v[164:167], v[184:187], 0
  v_mfma_f32_16x16x32_bf16 v[76:79], v[124:127], a[4:7], v[76:79]
  v_mfma_f32_16x16x32_bf16 v[204:207], v[176:179], v[100:103], 0
  v_mfma_f32_16x16x32_bf16 v[220:223], v[176:179], v[184:187], 0
  v_mfma_f32_16x16x32_bf16 v[72:75], v[128:131], a[20:23], v[72:75]
  v_mfma_f32_16x16x32_bf16 v[192:195], v[28:31], v[104:107], v[192:195]
  v_mfma_f32_16x16x32_bf16 v[208:211], v[28:31], v[188:191], v[208:211]
  v_mfma_f32_16x16x32_bf16 v[88:91], v[128:131], a[28:31], v[88:91]
  v_mfma_f32_16x16x32_bf16 v[196:199], v[60:63], v[104:107], v[196:199]
  v_mfma_f32_16x16x32_bf16 v[212:215], v[60:63], v[188:191], v[212:215]
  v_mfma_f32_16x16x32_bf16 v[92:95], v[132:135], a[28:31], v[92:95]
  v_mfma_f32_16x16x32_bf16 v[200:203], v[172:175], v[104:107], v[200:203]
  v_mfma_f32_16x16x32_bf16 v[216:219], v[172:175], v[188:191], v[216:219]
  v_mfma_f32_16x16x32_bf16 v[76:79], v[132:135], a[20:23], v[76:79]
  v_mfma_f32_16x16x32_bf16 v[204:207], v[180:183], v[104:107], v[204:207]
  v_mfma_f32_16x16x32_bf16 v[220:223], v[180:183], v[188:191], v[220:223]
  s_waitcnt vmcnt(8) lgkmcnt(0)
  s_barrier
  v_mfma_f32_16x16x32_bf16 v[72:75], v[136:139], a[32:35], v[72:75]
  ds_read_b64_tr_b16 v[96:97], v224 offset:16384
  ds_read_b64_tr_b16 v[98:99], v225 offset:16384
  v_mfma_f32_16x16x32_bf16 v[88:91], v[136:139], a[40:43], v[88:91]
  ds_read_b64_tr_b16 v[108:109], v224 offset:18432
  ds_read_b64_tr_b16 v[110:111], v225 offset:18432
  v_mfma_f32_16x16x32_bf16 v[92:95], v[140:143], a[40:43], v[92:95]
  ds_read_b64_tr_b16 v[112:113], v224 offset:20480
  ds_read_b64_tr_b16 v[114:115], v225 offset:20480
  v_mfma_f32_16x16x32_bf16 v[76:79], v[140:143], a[32:35], v[76:79]
  ds_read_b64_tr_b16 v[116:117], v224 offset:22528
  ds_read_b64_tr_b16 v[118:119], v225 offset:22528
  v_mfma_f32_16x16x32_bf16 v[72:75], v[144:147], a[48:51], v[72:75]
  ds_read_b64_tr_b16 v[120:121], v224 offset:16640
  ds_read_b64_tr_b16 v[122:123], v225 offset:16640
  v_mfma_f32_16x16x32_bf16 v[88:91], v[144:147], a[56:59], v[88:91]
  ds_read_b64_tr_b16 v[124:125], v224 offset:18688
  ds_read_b64_tr_b16 v[126:127], v225 offset:18688
  v_mfma_f32_16x16x32_bf16 v[92:95], v[148:151], a[56:59], v[92:95]
  ds_read_b64_tr_b16 v[128:129], v224 offset:20736
  ds_read_b64_tr_b16 v[130:131], v225 offset:20736
  v_mfma_f32_16x16x32_bf16 v[76:79], v[148:151], a[48:51], v[76:79]
  ds_read_b64_tr_b16 v[132:133], v224 offset:22784
  ds_read_b64_tr_b16 v[134:135], v225 offset:22784
  v_mfma_f32_16x16x32_bf16 v[72:75], v[152:155], a[36:39], v[72:75]
  s_waitcnt vmcnt(0)
  v_and_b32 v40, 1, v8
  v_bitop3_b32 v40, v40, v9, v10 bitop3:0x80
  v_bitop3_b32 v40, v40, v11, v12 bitop3:0x80
  v_bitop3_b32 v40, v40, v13, v14 bitop3:0x80
  v_bitop3_b32 v40, v40, v15, v16 bitop3:0x80
  v_bitop3_b32 v40, v40, v17, v18 bitop3:0x80
  v_bitop3_b32 v40, v40, v19, v20 bitop3:0x80
  v_bitop3_b32 v40, v40, v21, v22 bitop3:0x80
  v_and_b32 v40, v40, v23
  v_cmp_eq_u32 vcc, 0, v40
  s_nop 0
  s_cbranch_vccz gated_mix__spectral_gfnet__ssm_conv_s5__prompt_kernel_skip51
  s_mov_b32 s28, 0
gated_mix__spectral_gfnet__ssm_conv_s5__prompt_kernel_px52:
  s_sleep 2
  buffer_load_dwordx4 v[16:19], v36, s[20:23], s7 offen offset:0 sc1
  buffer_load_dwordx4 v[20:23], v36, s[20:23], s7 offen offset:1024 sc1
  buffer_load_dwordx4 v[8:11], v36, s[20:23], s7 offen offset:2048 sc1
  buffer_load_dwordx4 v[12:15], v36, s[20:23], s7 offen offset:3072 sc1
  s_waitcnt vmcnt(0)
  v_and_b32 v40, 1, v8
  v_bitop3_b32 v40, v40, v9, v10 bitop3:0x80
  v_bitop3_b32 v40, v40, v11, v12 bitop3:0x80
  v_bitop3_b32 v40, v40, v13, v14 bitop3:0x80
  v_bitop3_b32 v40, v40, v15, v16 bitop3:0x80
  v_bitop3_b32 v40, v40, v17, v18 bitop3:0x80
  v_bitop3_b32 v40, v40, v19, v20 bitop3:0x80
  v_bitop3_b32 v40, v40, v21, v22 bitop3:0x80
  v_and_b32 v40, v40, v23
  v_cmp_eq_u32 vcc, 0, v40
  s_nop 0
  s_cbranch_vccz gated_mix__spectral_gfnet__ssm_conv_s5__prompt_kernel_pxout53
  s_add_u32 s28, s28, 1
  s_cmp_lt_u32 s28, 1048576
  s_cbranch_scc1 gated_mix__spectral_gfnet__ssm_conv_s5__prompt_kernel_px52
gated_mix__spectral_gfnet__ssm_conv_s5__prompt_kernel_pxout53:
gated_mix__spectral_gfnet__ssm_conv_s5__prompt_kernel_skip51:
  v_mfma_f32_16x16x32_bf16 v[88:91], v[152:155], a[44:47], v[88:91]
  v_mfma_f32_16x16x32_bf16 v[92:95], v[156:159], a[44:47], v[92:95]
  v_mfma_f32_16x16x32_bf16 v[76:79], v[156:159], a[36:39], v[76:79]
  v_mfma_f32_16x16x32_bf16 v[72:75], v[160:163], a[52:55], v[72:75]
  v_mfma_f32_16x16x32_bf16 v[88:91], v[160:163], a[60:63], v[88:91]
  v_mfma_f32_16x16x32_bf16 v[92:95], v[168:171], a[60:63], v[92:95]
  v_mfma_f32_16x16x32_bf16 v[76:79], v[168:171], a[52:55], v[76:79]
  s_waitcnt lgkmcnt(0)
  v_mfma_f32_16x16x32_bf16 v[72:75], v[96:99], a[64:67], v[72:75]
  ds_read_b64_tr_b16 v[136:137], v224 offset:24576
  ds_read_b64_tr_b16 v[138:139], v225 offset:24576
  v_mfma_f32_16x16x32_bf16 v[88:91], v[96:99], a[72:75], v[88:91]
  ds_read_b64_tr_b16 v[140:141], v224 offset:26624
  ds_read_b64_tr_b16 v[142:143], v225 offset:26624
  v_mfma_f32_16x16x32_bf16 v[92:95], v[108:111], a[72:75], v[92:95]
  ds_read_b64_tr_b16 v[144:145], v224 offset:28672
  ds_read_b64_tr_b16 v[146:147], v225 offset:28672
  v_mfma_f32_16x16x32_bf16 v[76:79], v[108:111], a[64:67], v[76:79]
  ds_read_b64_tr_b16 v[148:149], v224 offset:30720
  ds_read_b64_tr_b16 v[150:151], v225 offset:30720
  v_mfma_f32_16x16x32_bf16 v[72:75], v[112:115], a[80:83], v[72:75]
  ds_read_b64_tr_b16 v[152:153], v224 offset:24832
  ds_read_b64_tr_b16 v[154:155], v225 offset:24832
  v_mfma_f32_16x16x32_bf16 v[88:91], v[112:115], a[88:91], v[88:91]
  ds_read_b64_tr_b16 v[156:157], v224 offset:26880
  ds_read_b64_tr_b16 v[158:159], v225 offset:26880
  v_mfma_f32_16x16x32_bf16 v[92:95], v[116:119], a[88:91], v[92:95]
  ds_read_b64_tr_b16 v[160:161], v224 offset:28928
  ds_read_b64_tr_b16 v[162:163], v225 offset:28928
  v_mfma_f32_16x16x32_bf16 v[76:79], v[116:119], a[80:83], v[76:79]
  ds_read_b64_tr_b16 v[168:169], v224 offset:30976
  ds_read_b64_tr_b16 v[170:171], v225 offset:30976
  v_mfma_f32_16x16x32_bf16 v[72:75], v[120:123], a[68:71], v[72:75]
  v_pk_add_f32 v[192:193], v[192:193], v[64:65] neg_lo:[0,1] neg_hi:[0,1]
  v_pk_add_f32 v[194:195], v[194:195], v[66:67] neg_lo:[0,1] neg_hi:[0,1]
  v_pk_fma_f32 v[64:65], v[228:229], v[192:193], v[64:65]
  v_pk_fma_f32 v[66:67], v[230:231], v[194:195], v[66:67]
  v_lshlrev_b32 v40, 16, v8
  v_and_b32 v41, 0xffff0000, v8
  v_pk_add_f32 v[64:65], v[64:65], v[40:41]
  v_lshlrev_b32 v42, 16, v9
  v_and_b32 v43, 0xffff0000, v9
  v_pk_add_f32 v[66:67], v[66:67], v[42:43]
  v_pk_add_f32 v[208:209], v[208:209], v[80:81] neg_lo:[0,1] neg_hi:[0,1]
  v_pk_add_f32 v[210:211], v[210:211], v[82:83] neg_lo:[0,1] neg_hi:[0,1]
  v_pk_fma_f32 v[80:81], v[228:229], v[208:209], v[80:81]
  v_pk_fma_f32 v[82:83], v[230:231], v[210:211], v[82:83]
  v_lshlrev_b32 v44, 16, v16
  v_and_b32 v45, 0xffff0000, v16
  v_pk_add_f32 v[80:81], v[80:81], v[44:45]
  v_lshlrev_b32 v46, 16, v17
  v_and_b32 v47, 0xffff0000, v17
  v_pk_add_f32 v[82:83], v[82:83], v[46:47]
  v_mfma_f32_16x16x32_bf16 v[88:91], v[120:123], a[76:79], v[88:91]
  v_mfma_f32_16x16x32_bf16 v[92:95], v[124:127], a[76:79], v[92:95]
  v_mfma_f32_16x16x32_bf16 v[76:79], v[124:127], a[68:71], v[76:79]
  v_mfma_f32_16x16x32_bf16 v[72:75], v[128:131], a[84:87], v[72:75]
  buffer_store_dword v64, v56, s[12:15], s29 offen sc1
  v_mfma_f32_16x16x32_bf16 v[88:91], v[128:131], a[92:95], v[88:91]
  v_mfma_f32_16x16x32_bf16 v[92:95], v[132:135], a[92:95], v[92:95]
  v_mfma_f32_16x16x32_bf16 v[76:79], v[132:135], a[84:87], v[76:79]
  s_waitcnt lgkmcnt(0)
  v_mfma_f32_16x16x32_bf16 v[72:75], v[136:139], a[96:99], v[72:75]
  ds_read_b64_tr_b16 v[96:97], v224 offset:32768
  ds_read_b64_tr_b16 v[98:99], v225 offset:32768
  buffer_store_dword v80, v57, s[12:15], s29 offen sc1
  v_mfma_f32_16x16x32_bf16 v[88:91], v[136:139], a[104:107], v[88:91]
  ds_read_b64_tr_b16 v[108:109], v224 offset:34816
  ds_read_b64_tr_b16 v[110:111], v225 offset:34816
  s_add_u32 s29, s29, 65536
  v_mfma_f32_16x16x32_bf16 v[92:95], v[140:143], a[104:107], v[92:95]
  ds_read_b64_tr_b16 v[112:113], v224 offset:36864
  ds_read_b64_tr_b16 v[114:115], v225 offset:36864
  v_mfma_f32_16x16x32_bf16 v[76:79], v[140:143], a[96:99], v[76:79]
  ds_read_b64_tr_b16 v[116:117], v224 offset:38912
  ds_read_b64_tr_b16 v[118:119], v225 offset:38912
  v_mfma_f32_16x16x32_bf16 v[72:75], v[144:147], a[112:115], v[72:75]
  ds_read_b64_tr_b16 v[120:121], v224 offset:33024
  ds_read_b64_tr_b16 v[122:123], v225 offset:33024
  buffer_store_dword v65, v56, s[12:15], s29 offen sc1
  v_mfma_f32_16x16x32_bf16 v[88:91], v[144:147], a[120:123], v[88:91]
  ds_read_b64_tr_b16 v[124:125], v224 offset:35072
  ds_read_b64_tr_b16 v[126:127], v225 offset:35072
  v_mfma_f32_16x16x32_bf16 v[92:95], v[148:151], a[120:123], v[92:95]
  ds_read_b64_tr_b16 v[128:129], v224 offset:37120
  ds_read_b64_tr_b16 v[130:131], v225 offset:37120
  v_mfma_f32_16x16x32_bf16 v[76:79], v[148:151], a[112:115], v[76:79]
  ds_read_b64_tr_b16 v[132:133], v224 offset:39168
  ds_read_b64_tr_b16 v[134:135], v225 offset:39168
  v_mfma_f32_16x16x32_bf16 v[72:75], v[152:155], a[100:103], v[72:75]
  buffer_store_dword v81, v57, s[12:15], s29 offen sc1
  v_mfma_f32_16x16x32_bf16 v[88:91], v[152:155], a[108:111], v[88:91]
  s_add_u32 s29, s29, 65536
  v_mfma_f32_16x16x32_bf16 v[92:95], v[156:159], a[108:111], v[92:95]
  v_mfma_f32_16x16x32_bf16 v[76:79], v[156:159], a[100:103], v[76:79]
  v_mfma_f32_16x16x32_bf16 v[72:75], v[160:163], a[116:119], v[72:75]
  buffer_store_dword v66, v56, s[12:15], s29 offen sc1
  v_mfma_f32_16x16x32_bf16 v[88:91], v[160:163], a[124:127], v[88:91]
  v_mfma_f32_16x16x32_bf16 v[92:95], v[168:171], a[124:127], v[92:95]
  v_mfma_f32_16x16x32_bf16 v[76:79], v[168:171], a[116:119], v[76:79]
  s_waitcnt lgkmcnt(0)
  v_mfma_f32_16x16x32_bf16 v[72:75], v[96:99], a[128:131], v[72:75]
  ds_read_b64_tr_b16 v[136:137], v224 offset:40960
  ds_read_b64_tr_b16 v[138:139], v225 offset:40960
  buffer_store_dword v82, v57, s[12:15], s29 offen sc1
  v_mfma_f32_16x16x32_bf16 v[88:91], v[96:99], a[136:139], v[88:91]
  ds_read_b64_tr_b16 v[140:141], v224 offset:43008
  ds_read_b64_tr_b16 v[142:143], v225 offset:43008
  s_add_u32 s29, s29, 65536
  v_mfma_f32_16x16x32_bf16 v[92:95], v[108:111], a[136:139], v[92:95]
  ds_read_b64_tr_b16 v[144:145], v224 offset:45056
  ds_read_b64_tr_b16 v[146:147], v225 offset:45056
  v_mfma_f32_16x16x32_bf16 v[76:79], v[108:111], a[128:131], v[76:79]
  ds_read_b64_tr_b16 v[148:149], v224 offset:47104
  ds_read_b64_tr_b16 v[150:151], v225 offset:47104
  v_mfma_f32_16x16x32_bf16 v[72:75], v[112:115], a[144:147], v[72:75]
  ds_read_b64_tr_b16 v[152:153], v224 offset:41216
  ds_read_b64_tr_b16 v[154:155], v225 offset:41216
  buffer_store_dword v67, v56, s[12:15], s29 offen sc1
  v_mfma_f32_16x16x32_bf16 v[88:91], v[112:115], a[152:155], v[88:91]
  ds_read_b64_tr_b16 v[156:157], v224 offset:43264
  ds_read_b64_tr_b16 v[158:159], v225 offset:43264
  v_mfma_f32_16x16x32_bf16 v[92:95], v[116:119], a[152:155], v[92:95]
  ds_read_b64_tr_b16 v[160:161], v224 offset:45312
  ds_read_b64_tr_b16 v[162:163], v225 offset:45312
  v_mfma_f32_16x16x32_bf16 v[76:79], v[116:119], a[144:147], v[76:79]
  ds_read_b64_tr_b16 v[168:169], v224 offset:47360
  ds_read_b64_tr_b16 v[170:171], v225 offset:47360
  v_mfma_f32_16x16x32_bf16 v[72:75], v[120:123], a[132:135], v[72:75]
  buffer_store_dword v83, v57, s[12:15], s29 offen sc1
  v_mfma_f32_16x16x32_bf16 v[88:91], v[120:123], a[140:143], v[88:91]
  s_add_u32 s29, s29, 851968
  v_pk_add_f32 v[196:197], v[196:197], v[68:69] neg_lo:[0,1] neg_hi:[0,1]
  v_pk_add_f32 v[198:199], v[198:199], v[70:71] neg_lo:[0,1] neg_hi:[0,1]
  v_pk_fma_f32 v[68:69], v[232:233], v[196:197], v[68:69]
  v_pk_fma_f32 v[70:71], v[234:235], v[198:199], v[70:71]
  v_lshlrev_b32 v48, 16, v10
  v_and_b32 v49, 0xffff0000, v10
  v_pk_add_f32 v[68:69], v[68:69], v[48:49]
  v_lshlrev_b32 v50, 16, v11
  v_and_b32 v51, 0xffff0000, v11
  v_pk_add_f32 v[70:71], v[70:71], v[50:51]
  v_pk_add_f32 v[212:213], v[212:213], v[84:85] neg_lo:[0,1] neg_hi:[0,1]
  v_pk_add_f32 v[214:215], v[214:215], v[86:87] neg_lo:[0,1] neg_hi:[0,1]
  v_pk_fma_f32 v[84:85], v[232:233], v[212:213], v[84:85]
  v_pk_fma_f32 v[86:87], v[234:235], v[214:215], v[86:87]
  v_lshlrev_b32 v52, 16, v18
  v_and_b32 v53, 0xffff0000, v18
  v_pk_add_f32 v[84:85], v[84:85], v[52:53]
  v_lshlrev_b32 v54, 16, v19
  v_and_b32 v55, 0xffff0000, v19
  v_pk_add_f32 v[86:87], v[86:87], v[54:55]
  v_mfma_f32_16x16x32_bf16 v[92:95], v[124:127], a[140:143], v[92:95]
  v_mfma_f32_16x16x32_bf16 v[76:79], v[124:127], a[132:135], v[76:79]
  v_mfma_f32_16x16x32_bf16 v[72:75], v[128:131], a[148:151], v[72:75]
  buffer_store_dword v68, v56, s[12:15], s29 offen sc1
  v_mfma_f32_16x16x32_bf16 v[88:91], v[128:131], a[156:159], v[88:91]
  v_mfma_f32_16x16x32_bf16 v[92:95], v[132:135], a[156:159], v[92:95]
  v_mfma_f32_16x16x32_bf16 v[76:79], v[132:135], a[148:151], v[76:79]
  s_waitcnt lgkmcnt(0)
  v_mfma_f32_16x16x32_bf16 v[72:75], v[136:139], a[160:163], v[72:75]
  ds_read_b64_tr_b16 v[96:97], v224 offset:49152
  ds_read_b64_tr_b16 v[98:99], v225 offset:49152
  buffer_store_dword v84, v57, s[12:15], s29 offen sc1
  v_mfma_f32_16x16x32_bf16 v[88:91], v[136:139], a[168:171], v[88:91]
  ds_read_b64_tr_b16 v[108:109], v224 offset:51200
  ds_read_b64_tr_b16 v[110:111], v225 offset:51200
  s_add_u32 s29, s29, 65536
  v_mfma_f32_16x16x32_bf16 v[92:95], v[140:143], a[168:171], v[92:95]
  ds_read_b64_tr_b16 v[112:113], v224 offset:53248
  ds_read_b64_tr_b16 v[114:115], v225 offset:53248
  v_mfma_f32_16x16x32_bf16 v[76:79], v[140:143], a[160:163], v[76:79]
  ds_read_b64_tr_b16 v[116:117], v224 offset:55296
  ds_read_b64_tr_b16 v[118:119], v225 offset:55296
  v_mfma_f32_16x16x32_bf16 v[72:75], v[144:147], a[176:179], v[72:75]
  ds_read_b64_tr_b16 v[120:121], v224 offset:49408
  ds_read_b64_tr_b16 v[122:123], v225 offset:49408
  buffer_store_dword v69, v56, s[12:15], s29 offen sc1
  v_mfma_f32_16x16x32_bf16 v[88:91], v[144:147], a[184:187], v[88:91]
  ds_read_b64_tr_b16 v[124:125], v224 offset:51456
  ds_read_b64_tr_b16 v[126:127], v225 offset:51456
  v_mfma_f32_16x16x32_bf16 v[92:95], v[148:151], a[184:187], v[92:95]
  ds_read_b64_tr_b16 v[128:129], v224 offset:53504
  ds_read_b64_tr_b16 v[130:131], v225 offset:53504
  v_mfma_f32_16x16x32_bf16 v[76:79], v[148:151], a[176:179], v[76:79]
  ds_read_b64_tr_b16 v[132:133], v224 offset:55552
  ds_read_b64_tr_b16 v[134:135], v225 offset:55552
  v_mfma_f32_16x16x32_bf16 v[72:75], v[152:155], a[164:167], v[72:75]
  buffer_store_dword v85, v57, s[12:15], s29 offen sc1
  v_mfma_f32_16x16x32_bf16 v[88:91], v[152:155], a[172:175], v[88:91]
  s_add_u32 s29, s29, 65536
  v_mfma_f32_16x16x32_bf16 v[92:95], v[156:159], a[172:175], v[92:95]
  v_mfma_f32_16x16x32_bf16 v[76:79], v[156:159], a[164:167], v[76:79]
  v_mfma_f32_16x16x32_bf16 v[72:75], v[160:163], a[180:183], v[72:75]
  buffer_store_dword v70, v56, s[12:15], s29 offen sc1
  v_mfma_f32_16x16x32_bf16 v[88:91], v[160:163], a[188:191], v[88:91]
  v_mfma_f32_16x16x32_bf16 v[92:95], v[168:171], a[188:191], v[92:95]
  v_mfma_f32_16x16x32_bf16 v[76:79], v[168:171], a[180:183], v[76:79]
  s_waitcnt lgkmcnt(0)
  v_mfma_f32_16x16x32_bf16 v[72:75], v[96:99], a[192:195], v[72:75]
  ds_read_b64_tr_b16 v[136:137], v224 offset:57344
  ds_read_b64_tr_b16 v[138:139], v225 offset:57344
  buffer_store_dword v86, v57, s[12:15], s29 offen sc1
  v_mfma_f32_16x16x32_bf16 v[88:91], v[96:99], a[200:203], v[88:91]
  ds_read_b64_tr_b16 v[140:141], v224 offset:59392
  ds_read_b64_tr_b16 v[142:143], v225 offset:59392
  s_add_u32 s29, s29, 65536
  v_mfma_f32_16x16x32_bf16 v[92:95], v[108:111], a[200:203], v[92:95]
  ds_read_b64_tr_b16 v[144:145], v224 offset:61440
  ds_read_b64_tr_b16 v[146:147], v225 offset:61440
  v_mfma_f32_16x16x32_bf16 v[76:79], v[108:111], a[192:195], v[76:79]
  ds_read_b64_tr_b16 v[148:149], v224 offset:63488
  ds_read_b64_tr_b16 v[150:151], v225 offset:63488
  v_mfma_f32_16x16x32_bf16 v[72:75], v[112:115], a[208:211], v[72:75]
  ds_read_b64_tr_b16 v[152:153], v224 offset:57600
  ds_read_b64_tr_b16 v[154:155], v225 offset:57600
  buffer_store_dword v71, v56, s[12:15], s29 offen sc1
  v_mfma_f32_16x16x32_bf16 v[88:91], v[112:115], a[216:219], v[88:91]
  ds_read_b64_tr_b16 v[156:157], v224 offset:59648
  ds_read_b64_tr_b16 v[158:159], v225 offset:59648
  v_mfma_f32_16x16x32_bf16 v[92:95], v[116:119], a[216:219], v[92:95]
  ds_read_b64_tr_b16 v[160:161], v224 offset:61696
  ds_read_b64_tr_b16 v[162:163], v225 offset:61696
  v_mfma_f32_16x16x32_bf16 v[76:79], v[116:119], a[208:211], v[76:79]
  ds_read_b64_tr_b16 v[168:169], v224 offset:63744
  ds_read_b64_tr_b16 v[170:171], v225 offset:63744
  v_mfma_f32_16x16x32_bf16 v[72:75], v[120:123], a[196:199], v[72:75]
  buffer_store_dword v87, v57, s[12:15], s29 offen sc1
  v_mfma_f32_16x16x32_bf16 v[88:91], v[120:123], a[204:207], v[88:91]
  s_add_u32 s29, s29, 851968
  v_mfma_f32_16x16x32_bf16 v[92:95], v[124:127], a[204:207], v[92:95]
  v_mfma_f32_16x16x32_bf16 v[76:79], v[124:127], a[196:199], v[76:79]
  v_mfma_f32_16x16x32_bf16 v[72:75], v[128:131], a[212:215], v[72:75]
  v_mfma_f32_16x16x32_bf16 v[88:91], v[128:131], a[220:223], v[88:91]
  v_mfma_f32_16x16x32_bf16 v[92:95], v[132:135], a[220:223], v[92:95]
  v_mfma_f32_16x16x32_bf16 v[76:79], v[132:135], a[212:215], v[76:79]
  s_waitcnt lgkmcnt(0)
  v_mfma_f32_16x16x32_bf16 v[72:75], v[136:139], a[224:227], v[72:75]
  v_mfma_f32_16x16x32_bf16 v[88:91], v[136:139], a[232:235], v[88:91]
  v_mfma_f32_16x16x32_bf16 v[92:95], v[140:143], a[232:235], v[92:95]
  v_mfma_f32_16x16x32_bf16 v[76:79], v[140:143], a[224:227], v[76:79]
  v_mfma_f32_16x16x32_bf16 v[72:75], v[144:147], a[240:243], v[72:75]
  v_mfma_f32_16x16x32_bf16 v[88:91], v[144:147], a[248:251], v[88:91]
  v_mfma_f32_16x16x32_bf16 v[92:95], v[148:151], a[248:251], v[92:95]
  v_mfma_f32_16x16x32_bf16 v[76:79], v[148:151], a[240:243], v[76:79]
  v_mfma_f32_16x16x32_bf16 v[72:75], v[152:155], a[228:231], v[72:75]
  v_mfma_f32_16x16x32_bf16 v[88:91], v[152:155], a[236:239], v[88:91]
  v_mfma_f32_16x16x32_bf16 v[92:95], v[156:159], a[236:239], v[92:95]
  v_mfma_f32_16x16x32_bf16 v[76:79], v[156:159], a[228:231], v[76:79]
  v_mfma_f32_16x16x32_bf16 v[72:75], v[160:163], a[244:247], v[72:75]
  v_mfma_f32_16x16x32_bf16 v[88:91], v[160:163], a[252:255], v[88:91]
  v_mfma_f32_16x16x32_bf16 v[92:95], v[168:171], a[252:255], v[92:95]
  v_mfma_f32_16x16x32_bf16 v[76:79], v[168:171], a[244:247], v[76:79]
  s_nop 4
  v_pk_add_f32 v[200:201], v[200:201], v[72:73] neg_lo:[0,1] neg_hi:[0,1]
  v_pk_add_f32 v[202:203], v[202:203], v[74:75] neg_lo:[0,1] neg_hi:[0,1]
  v_pk_fma_f32 v[72:73], v[236:237], v[200:201], v[72:73]
  v_pk_fma_f32 v[74:75], v[238:239], v[202:203], v[74:75]
  v_lshlrev_b32 v40, 16, v12
  v_and_b32 v41, 0xffff0000, v12
  v_pk_add_f32 v[72:73], v[72:73], v[40:41]
  v_lshlrev_b32 v42, 16, v13
  v_and_b32 v43, 0xffff0000, v13
  v_pk_add_f32 v[74:75], v[74:75], v[42:43]
  v_pk_add_f32 v[216:217], v[216:217], v[88:89] neg_lo:[0,1] neg_hi:[0,1]
  v_pk_add_f32 v[218:219], v[218:219], v[90:91] neg_lo:[0,1] neg_hi:[0,1]
  v_pk_fma_f32 v[88:89], v[236:237], v[216:217], v[88:89]
  v_pk_fma_f32 v[90:91], v[238:239], v[218:219], v[90:91]
  v_lshlrev_b32 v44, 16, v20
  v_and_b32 v45, 0xffff0000, v20
  v_pk_add_f32 v[88:89], v[88:89], v[44:45]
  v_lshlrev_b32 v46, 16, v21
  v_and_b32 v47, 0xffff0000, v21
  v_pk_add_f32 v[90:91], v[90:91], v[46:47]
  buffer_store_dword v72, v56, s[12:15], s29 offen sc1
  buffer_store_dword v88, v57, s[12:15], s29 offen sc1
  s_add_u32 s29, s29, 65536
  buffer_store_dword v73, v56, s[12:15], s29 offen sc1
  buffer_store_dword v89, v57, s[12:15], s29 offen sc1
  s_add_u32 s29, s29, 65536
  buffer_store_dword v74, v56, s[12:15], s29 offen sc1
  buffer_store_dword v90, v57, s[12:15], s29 offen sc1
  s_add_u32 s29, s29, 65536
  buffer_store_dword v75, v56, s[12:15], s29 offen sc1
  buffer_store_dword v91, v57, s[12:15], s29 offen sc1
  s_add_u32 s29, s29, 851968
  v_pk_add_f32 v[204:205], v[204:205], v[76:77] neg_lo:[0,1] neg_hi:[0,1]
  v_pk_add_f32 v[206:207], v[206:207], v[78:79] neg_lo:[0,1] neg_hi:[0,1]
  v_pk_fma_f32 v[76:77], v[240:241], v[204:205], v[76:77]
  v_pk_fma_f32 v[78:79], v[242:243], v[206:207], v[78:79]
  v_lshlrev_b32 v48, 16, v14
  v_and_b32 v49, 0xffff0000, v14
  v_pk_add_f32 v[76:77], v[76:77], v[48:49]
  v_lshlrev_b32 v50, 16, v15
  v_and_b32 v51, 0xffff0000, v15
  v_pk_add_f32 v[78:79], v[78:79], v[50:51]
  v_pk_add_f32 v[220:221], v[220:221], v[92:93] neg_lo:[0,1] neg_hi:[0,1]
  v_pk_add_f32 v[222:223], v[222:223], v[94:95] neg_lo:[0,1] neg_hi:[0,1]
  v_pk_fma_f32 v[92:93], v[240:241], v[220:221], v[92:93]
  v_pk_fma_f32 v[94:95], v[242:243], v[222:223], v[94:95]
  v_lshlrev_b32 v52, 16, v22
  v_and_b32 v53, 0xffff0000, v22
  v_pk_add_f32 v[92:93], v[92:93], v[52:53]
  v_lshlrev_b32 v54, 16, v23
  v_and_b32 v55, 0xffff0000, v23
  v_pk_add_f32 v[94:95], v[94:95], v[54:55]
  buffer_store_dword v76, v56, s[12:15], s29 offen sc1
  buffer_store_dword v92, v57, s[12:15], s29 offen sc1
  s_add_u32 s29, s29, 65536
  buffer_store_dword v77, v56, s[12:15], s29 offen sc1
  buffer_store_dword v93, v57, s[12:15], s29 offen sc1
  s_add_u32 s29, s29, 65536
  buffer_store_dword v78, v56, s[12:15], s29 offen sc1
  buffer_store_dword v94, v57, s[12:15], s29 offen sc1
  s_add_u32 s29, s29, 65536
  buffer_store_dword v79, v56, s[12:15], s29 offen sc1
  buffer_store_dword v95, v57, s[12:15], s29 offen sc1
gated_mix__spectral_gfnet__ssm_conv_s5__prompt_kernel_end:
  s_endpgm
.section .rodata,"a"
.p2align 6
.amdhsa_kernel gated_mix__spectral_gfnet__ssm_conv_s5__prompt_kernel
  .amdhsa_next_free_vgpr 500
  .amdhsa_next_free_sgpr 102
  .amdhsa_accum_offset 244
  .amdhsa_group_segment_fixed_size 0
  .amdhsa_kernarg_size 128
  .amdhsa_user_sgpr_count 2
  .amdhsa_user_sgpr_kernarg_segment_ptr 1
  .amdhsa_system_sgpr_workgroup_id_x 1
  .amdhsa_float_denorm_mode_32 3
.end_amdhsa_kernel
```

```asm
; @launch grid=(256,1,1) block=(256,1,1) lds=163840
.amdgcn_target "amdgcn-amd-amdhsa--gfx950"
.text
.p2align 8
.globl gated_mix__spectral_gfnet__ssm_conv_s5__prompt_kernel
.type gated_mix__spectral_gfnet__ssm_conv_s5__prompt_kernel,@function
gated_mix__spectral_gfnet__ssm_conv_s5__prompt_kernel:
  s_cmp_ge_u32 s2, 256
  s_cbranch_scc1 gated_mix__spectral_gfnet__ssm_conv_s5__prompt_kernel_end
  s_load_dwordx16 s[4:19], s[0:1], 0
  s_load_dwordx16 s[20:35], s[0:1], 64
  v_readfirstlane_b32 s3, v0
  v_and_b32 v1, 63, v0
  v_and_b32 v2, 15, v0
  v_bfe_u32 v3, v0, 4, 2
  s_bfe_u32 s36, s2, 0x20003
  s_lshr_b32 s43, s2, 5
  s_lshr_b32 s3, s3, 6
  s_and_b32 s38, s2, 3
  s_lshl2_add_u32 s38, s38, s36
  s_bfe_u32 s39, s2, 0x10002
  s_lshl3_add_u32 s39, s39, s43
  s_and_b32 s42, s2, 1
  s_lshl3_add_u32 s40, s42, s43
  s_lshl1_add_u32 s42, s43, s42
  s_bfe_u32 s41, s2, 0x20001
  s_lshl2_add_u32 s41, s41, s36
  s_and_b32 s37, s2, 7
  s_lshl3_add_u32 s37, s37, s43
  s_cmp_lg_u32 s3, 0
  s_cbranch_scc1 gated_mix__spectral_gfnet__ssm_conv_s5__prompt_kernel_skip2
  s_getpc_b64 s[44:45]
gated_mix__spectral_gfnet__ssm_conv_s5__prompt_kernel_pc1:
  s_lshr_b32 s43, s2, 3
  s_mul_i32 s43, s43, 1280
  v_min_u32 v6, 9, v1
  v_lshl_add_u32 v6, v6, 7, s43
  v_min_u32 v6, gated_mix__spectral_gfnet__ssm_conv_s5__prompt_kernel_end-gated_mix__spectral_gfnet__ssm_conv_s5__prompt_kernel_pc1, v6
  v_mov_b32 v7, 0
  v_lshl_add_u64 v[6:7], v[6:7], 0, s[44:45]
  global_load_dword v4, v[6:7], off
gated_mix__spectral_gfnet__ssm_conv_s5__prompt_kernel_skip2:
  s_mov_b32 s46, 4194304
  s_mov_b32 s47, 0x20000
  s_mov_b32 s50, 2097152
  s_mov_b32 s51, 0x20000
  v_bfe_u32 v6, v1, 1, 2
  v_xor_b32 v6, v6, v3
  v_lshlrev_b32 v5, 9, v6
  v_and_b32 v6, 1, v1
  v_lshl_or_b32 v5, v6, 4, v5
  v_lshrrev_b32 v6, 3, v1
  v_lshl_or_b32 v5, v6, 15, v5
  s_lshl_b32 s43, s3, 9
  s_add_u32 s43, s43, s40
  s_lshl_b32 s43, s43, 6
  s_add_u32 s43, s43, s41
  s_lshl_b32 s43, s43, 5
  s_lshl_b32 m0, s3, 12
  s_add_u32 m0, m0, 131072
  s_waitcnt lgkmcnt(0)
  s_mov_b64 s[44:45], s[4:5]
  buffer_load_dwordx4 v5, s[44:47], s43 offen offset:0 lds
  s_add_u32 s43, s43, 261120
  buffer_load_dwordx4 v5, s[44:47], s43 offen offset:1024 lds
  s_add_u32 s43, s43, 261120
  buffer_load_dwordx4 v5, s[44:47], s43 offen offset:2048 lds
  s_add_u32 s43, s43, 261120
  buffer_load_dwordx4 v5, s[44:47], s43 offen offset:3072 lds
  v_and_b32 v6, 7, v1
  v_xor_b32 v6, v6, v3
  v_lshlrev_b32 v6, 4, v6
  v_lshrrev_b32 v7, 3, v1
  v_lshl_or_b32 v12, v7, 11, v6
  v_and_b32 v7, 32, v1
  v_lshl_or_b32 v8, v7, 11, v6
  v_and_b32 v7, 8, v1
  v_lshl_or_b32 v8, v7, 12, v8
  v_and_b32 v7, 16, v1
  v_lshl_or_b32 v8, v7, 7, v8
  s_lshr_b32 s52, s3, 1
  s_lshl1_add_u32 s53, s39, s52
  s_lshl_b32 s53, s53, 16
  v_add_u32 v12, s53, v12
  s_lshl1_add_u32 s53, s38, s52
  s_and_b32 s52, s3, 1
  s_lshl3_add_u32 s53, s53, s52
  s_lshl_b32 s53, s53, 14
  v_add_u32 v8, s53, v8
  v_xor_b32 v9, 64, v8
  v_xor_b32 v13, 64, v12
  v_add_u32 v9, 3072, v9
  v_add_u32 v13, 15360, v13
  v_add_u32 v10, 6144, v8
  v_add_u32 v14, 30720, v12
  v_add_u32 v11, 6144, v9
  v_add_u32 v15, 30720, v13
  s_lshl_b32 s53, s3, 12
  s_add_u32 s54, s53, 65536
  s_lshl_b32 s43, s38, 7
  s_bitcmp1_b32 s3, 0
  s_cselect_b64 s[48:49], s[18:19], s[16:17]
  s_lshl_b32 s10, s37, 2
  s_add_u32 s10, s10, s36
  s_cmp_eq_u32 s10, 3
  s_cselect_b32 s55, 1, s36
  s_cselect_b32 s4, 64, s37
  s_and_b32 s5, s10, 0xfd
  s_cmp_eq_u32 s5, 0
  s_cselect_b32 s5, 1, 0
  v_cvt_f32_u32 v5, v2
  v_cvt_f32_u32 v6, v3
  v_mul_f32 v6, 4.0, v6
  s_cmp_lg_u32 s3, 0
  s_cbranch_scc1 gated_mix__spectral_gfnet__ssm_conv_s5__prompt_kernel_skip3
  v_cvt_f32_u32 v42, s5
  v_mul_f32 v42, 0xc4700000, v42
  v_cmp_lt_u32 vcc, 7, v2
  v_cvt_f32_u32 v41, s4
  s_nop 0
  v_cndmask_b32 v42, 0, v42, vcc
  v_add_f32 v41, v41, v42
  v_fmamk_f32 v7, v5, 0x43000000, v41
  v_mul_f32 v7, 0x3a000000, v7
  v_mul_f32 v40, v7, v6
  v_fmamk_f32 v32, v7, 0x0, v40
  v_fmamk_f32 v33, v7, 0x3f800000, v40
  v_fmamk_f32 v34, v7, 0x40000000, v40
  v_fmamk_f32 v35, v7, 0x40400000, v40
  v_cos_f32 v36, v32
  v_cos_f32 v37, v33
  v_cos_f32 v38, v34
  v_cos_f32 v39, v35
  v_sin_f32 v32, v32
  v_sin_f32 v33, v33
  v_sin_f32 v34, v34
  v_sin_f32 v35, v35
  v_cvt_pk_bf16_f32 v16, v36, v32
  v_cvt_pk_bf16_f32 v20, -v32, v36
  v_cvt_pk_bf16_f32 v17, v37, v33
  v_cvt_pk_bf16_f32 v21, -v33, v37
  v_cvt_pk_bf16_f32 v18, v38, v34
  v_cvt_pk_bf16_f32 v22, -v34, v38
  v_cvt_pk_bf16_f32 v19, v39, v35
  v_cvt_pk_bf16_f32 v23, -v35, v39
  v_xor_b32 v41, 3, v2
  v_cndmask_b32 v41, v2, v41, vcc
  v_cvt_f32_u32 v7, v41
  v_mul_f32 v7, 0x3d800000, v7
  v_mul_f32 v40, v7, v6
  v_fmamk_f32 v32, v7, 0x0, v40
  v_fmamk_f32 v33, v7, 0x3f800000, v40
  v_fmamk_f32 v34, v7, 0x40000000, v40
  v_fmamk_f32 v35, v7, 0x40400000, v40
  v_cos_f32 v36, v32
  v_cos_f32 v37, v33
  v_cos_f32 v38, v34
  v_cos_f32 v39, v35
  v_sin_f32 v32, v32
  v_sin_f32 v33, v33
  v_sin_f32 v34, v34
  v_sin_f32 v35, v35
  v_cvt_pk_bf16_f32 v24, v36, v32
  v_cvt_pk_bf16_f32 v28, -v32, v36
  v_cvt_pk_bf16_f32 v25, v37, v33
  v_cvt_pk_bf16_f32 v29, -v33, v37
  v_cvt_pk_bf16_f32 v26, v38, v34
  v_cvt_pk_bf16_f32 v30, -v34, v38
  v_cvt_pk_bf16_f32 v27, v39, v35
  v_cvt_pk_bf16_f32 v31, -v35, v39
  s_cmp_eq_u32 s5, 0
  s_cbranch_scc1 gated_mix__spectral_gfnet__ssm_conv_s5__prompt_kernel_skip4
  v_cndmask_b32 v41, 0, 16, vcc
  v_and_b32 v16, 0xffff, v16
  v_lshlrev_b32 v16, v41, v16
  v_and_b32 v17, 0xffff, v17
  v_lshlrev_b32 v17, v41, v17
  v_and_b32 v18, 0xffff, v18
  v_lshlrev_b32 v18, v41, v18
  v_and_b32 v19, 0xffff, v19
  v_lshlrev_b32 v19, v41, v19
  v_and_b32 v20, 0xffff, v20
  v_lshlrev_b32 v20, v41, v20
  v_and_b32 v21, 0xffff, v21
  v_lshlrev_b32 v21, v41, v21
  v_and_b32 v22, 0xffff, v22
  v_lshlrev_b32 v22, v41, v22
  v_and_b32 v23, 0xffff, v23
  v_lshlrev_b32 v23, v41, v23
  v_cmp_eq_u32 vcc, 0, v2
  v_mov_b32 v41, 0x3f80
  s_nop 0
  v_cndmask_b32 v20, v20, v41, vcc
  v_mov_b32 v41, 0xbf80
  v_cndmask_b32 v21, v21, v41, vcc
  v_mov_b32 v41, 0x3f80
  v_cndmask_b32 v22, v22, v41, vcc
  v_mov_b32 v41, 0xbf80
  v_cndmask_b32 v23, v23, v41, vcc
gated_mix__spectral_gfnet__ssm_conv_s5__prompt_kernel_skip4:
gated_mix__spectral_gfnet__ssm_conv_s5__prompt_kernel_skip3:
  s_cmp_lg_u32 s3, 1
  s_cbranch_scc1 gated_mix__spectral_gfnet__ssm_conv_s5__prompt_kernel_skip5
  v_cvt_f32_u32 v42, s5
  v_mul_f32 v42, 0xc4700000, v42
  v_cmp_lt_u32 vcc, 1, v3
  v_cvt_f32_u32 v41, s4
  s_nop 0
  v_cndmask_b32 v42, 0, v42, vcc
  v_add_f32 v41, v41, v42
  v_fmamk_f32 v41, v6, 0x43000000, v41
  v_mul_f32 v40, v41, v5
  v_mul_f32 v40, 0x3a000000, v40
  v_mul_f32 v7, 0x3d800000, v5
  v_fmamk_f32 v32, v7, 0x0, v40
  v_fmamk_f32 v33, v7, 0x3f800000, v40
  v_fmamk_f32 v34, v7, 0x40000000, v40
  v_fmamk_f32 v35, v7, 0x40400000, v40
  v_cos_f32 v36, v32
  v_cos_f32 v37, v33
  v_cos_f32 v38, v34
  v_cos_f32 v39, v35
  v_sin_f32 v32, v32
  v_sin_f32 v33, v33
  v_sin_f32 v34, v34
  v_sin_f32 v35, v35
  v_cvt_pk_bf16_f32 v16, v36, -v32
  v_cvt_pk_bf16_f32 v20, v32, v36
  v_cvt_pk_bf16_f32 v17, v37, -v33
  v_cvt_pk_bf16_f32 v21, v33, v37
  v_cvt_pk_bf16_f32 v18, v38, -v34
  v_cvt_pk_bf16_f32 v22, v34, v38
  v_cvt_pk_bf16_f32 v19, v39, -v35
  v_cvt_pk_bf16_f32 v23, v35, v39
  v_add_f32 v41, 0x40400000, v6
  v_cndmask_b32 v41, v6, v41, vcc
  v_mul_f32 v40, v7, v41
  v_cndmask_b32 v7, v7, -v7, vcc
  v_fmamk_f32 v32, v7, 0x0, v40
  v_fmamk_f32 v33, v7, 0x3f800000, v40
  v_fmamk_f32 v34, v7, 0x40000000, v40
  v_fmamk_f32 v35, v7, 0x40400000, v40
  v_cos_f32 v36, v32
  v_cos_f32 v37, v33
  v_cos_f32 v38, v34
  v_cos_f32 v39, v35
  v_sin_f32 v32, v32
  v_sin_f32 v33, v33
  v_sin_f32 v34, v34
  v_sin_f32 v35, v35
  v_cvt_pk_bf16_f32 v24, v36, -v32
  v_cvt_pk_bf16_f32 v28, v32, v36
  v_cvt_pk_bf16_f32 v25, v37, -v33
  v_cvt_pk_bf16_f32 v29, v33, v37
  v_cvt_pk_bf16_f32 v26, v38, -v34
  v_cvt_pk_bf16_f32 v30, v34, v38
  v_cvt_pk_bf16_f32 v27, v39, -v35
  v_cvt_pk_bf16_f32 v31, v35, v39
  s_cmp_eq_u32 s5, 0
  s_cbranch_scc1 gated_mix__spectral_gfnet__ssm_conv_s5__prompt_kernel_skip6
  v_lshlrev_b32 v41, 16, v16
  v_and_b32 v42, 0xffff0000, v16
  v_add_f32 v41, v41, v41
  v_add_f32 v42, v42, v42
  v_cvt_pk_bf16_f32 v41, v41, v42
  v_cndmask_b32 v16, v41, 0, vcc
  v_cndmask_b32 v20, 0, v41, vcc
  v_lshlrev_b32 v41, 16, v17
  v_and_b32 v42, 0xffff0000, v17
  v_add_f32 v41, v41, v41
  v_add_f32 v42, v42, v42
  v_cvt_pk_bf16_f32 v41, v41, v42
  v_cndmask_b32 v17, v41, 0, vcc
  v_cndmask_b32 v21, 0, v41, vcc
  v_lshlrev_b32 v41, 16, v18
  v_and_b32 v42, 0xffff0000, v18
  v_add_f32 v41, v41, v41
  v_add_f32 v42, v42, v42
  v_cvt_pk_bf16_f32 v41, v41, v42
  v_cndmask_b32 v18, v41, 0, vcc
  v_cndmask_b32 v22, 0, v41, vcc
  v_lshlrev_b32 v41, 16, v19
  v_and_b32 v42, 0xffff0000, v19
  v_add_f32 v41, v41, v41
  v_add_f32 v42, v42, v42
  v_cvt_pk_bf16_f32 v41, v41, v42
  v_cndmask_b32 v19, v41, 0, vcc
  v_cndmask_b32 v23, 0, v41, vcc
  v_lshlrev_b32 v41, 31, v2
  v_or_b32 v41, 0x3f803f80, v41
  v_cmp_eq_u32 vcc, 0, v3
  s_nop 1
  v_cndmask_b32 v16, v16, v41, vcc
gated_mix__spectral_gfnet__ssm_conv_s5__prompt_kernel_skip6:
gated_mix__spectral_gfnet__ssm_conv_s5__prompt_kernel_skip5:
  s_cmp_lg_u32 s3, 2
  s_cbranch_scc1 gated_mix__spectral_gfnet__ssm_conv_s5__prompt_kernel_skip7
  v_cvt_f32_u32 v42, s55
  v_fma_f32 v41, v5, 4.0, v42
  v_mul_f32 v7, 0x3c800000, v41
  v_mul_f32 v40, v7, v6
  v_fmamk_f32 v32, v7, 0x0, v40
  v_fmamk_f32 v33, v7, 0x3f800000, v40
  v_fmamk_f32 v34, v7, 0x40000000, v40
  v_fmamk_f32 v35, v7, 0x40400000, v40
  v_cos_f32 v36, v32
  v_cos_f32 v37, v33
  v_cos_f32 v38, v34
  v_cos_f32 v39, v35
  v_sin_f32 v32, v32
  v_sin_f32 v33, v33
  v_sin_f32 v34, v34
  v_sin_f32 v35, v35
  v_cvt_pk_bf16_f32 v16, v36, v32
  v_cvt_pk_bf16_f32 v20, -v32, v36
  v_cvt_pk_bf16_f32 v17, v37, v33
  v_cvt_pk_bf16_f32 v21, -v33, v37
  v_cvt_pk_bf16_f32 v18, v38, v34
  v_cvt_pk_bf16_f32 v22, -v34, v38
  v_cvt_pk_bf16_f32 v19, v39, v35
  v_cvt_pk_bf16_f32 v23, -v35, v39
  v_mul_f32 v7, 0x3d800000, v7
  v_mul_f32 v40, 0x3d800000, v40
  v_fmamk_f32 v32, v7, 0x0, v40
  v_fmamk_f32 v33, v7, 0x3f800000, v40
  v_fmamk_f32 v34, v7, 0x40000000, v40
  v_fmamk_f32 v35, v7, 0x40400000, v40
  v_cos_f32 v24, v32
  v_cos_f32 v25, v33
  v_cos_f32 v26, v34
  v_cos_f32 v27, v35
  v_sin_f32 v28, v32
  v_sin_f32 v29, v33
  v_sin_f32 v30, v34
  v_sin_f32 v31, v35
gated_mix__spectral_gfnet__ssm_conv_s5__prompt_kernel_skip7:
  s_cmp_lg_u32 s3, 3
  s_cbranch_scc1 gated_mix__spectral_gfnet__ssm_conv_s5__prompt_kernel_skip8
  v_cvt_f32_u32 v42, s55
  v_fma_f32 v41, v6, 4.0, v42
  v_mul_f32 v40, v41, v5
  v_mul_f32 v40, 0x3c800000, v40
  v_mul_f32 v7, 0x3d800000, v5
  v_fmamk_f32 v32, v7, 0x0, v40
  v_fmamk_f32 v33, v7, 0x3f800000, v40
  v_fmamk_f32 v34, v7, 0x40000000, v40
  v_fmamk_f32 v35, v7, 0x40400000, v40
  v_cos_f32 v36, v32
  v_cos_f32 v37, v33
  v_cos_f32 v38, v34
  v_cos_f32 v39, v35
  v_sin_f32 v32, v32
  v_sin_f32 v33, v33
  v_sin_f32 v34, v34
  v_sin_f32 v35, v35
  v_cvt_pk_bf16_f32 v16, v36, -v32
  v_cvt_pk_bf16_f32 v20, v32, v36
  v_cvt_pk_bf16_f32 v17, v37, -v33
  v_cvt_pk_bf16_f32 v21, v33, v37
  v_cvt_pk_bf16_f32 v18, v38, -v34
  v_cvt_pk_bf16_f32 v22, v34, v38
  v_cvt_pk_bf16_f32 v19, v39, -v35
  v_cvt_pk_bf16_f32 v23, v35, v39
  v_mul_f32 v7, 0x3d800000, v7
  v_mul_f32 v40, 0x3d800000, v40
  v_fmamk_f32 v32, v7, 0x0, v40
  v_fmamk_f32 v33, v7, 0x3f800000, v40
  v_fmamk_f32 v34, v7, 0x40000000, v40
  v_fmamk_f32 v35, v7, 0x40400000, v40
  v_cos_f32 v24, v32
  v_cos_f32 v25, v33
  v_cos_f32 v26, v34
  v_cos_f32 v27, v35
  v_sin_f32 v28, v32
  v_sin_f32 v29, v33
  v_sin_f32 v30, v34
  v_sin_f32 v31, v35
  v_mul_f32 v24, 0x35800000, v24
  v_mul_f32 v25, 0x35800000, v25
  v_mul_f32 v26, 0x35800000, v26
  v_mul_f32 v27, 0x35800000, v27
  v_mul_f32 v28, 0x35800000, v28
  v_mul_f32 v29, 0x35800000, v29
  v_mul_f32 v30, 0x35800000, v30
  v_mul_f32 v31, 0x35800000, v31
gated_mix__spectral_gfnet__ssm_conv_s5__prompt_kernel_skip8:
  s_lshl_b32 s11, s3, 12
  s_add_u32 s11, s11, 147456
  v_lshl_add_u32 v41, v1, 4, s11
  ds_write_b128 v41, v[16:19] offset:0
  ds_write_b128 v41, v[20:23] offset:1024
  ds_write_b128 v41, v[24:27] offset:2048
  ds_write_b128 v41, v[28:31] offset:3072
  v_bfe_u32 v6, v1, 1, 3
  v_lshrrev_b32 v7, 5, v1
  v_xor_b32 v6, v6, v7
  v_lshlrev_b32 v6, 4, v6
  v_and_b32 v7, 31, v1
  v_lshl_or_b32 v6, v7, 7, v6
  s_lshr_b32 s52, s3, 1
  v_lshl_add_u32 v16, s52, 13, v6
  s_and_b32 s52, s3, 1
  s_or_b32 s52, s52, 8
  v_lshl_add_u32 v20, s52, 13, v6
  v_xor_b32 v17, 32, v16
  v_xor_b32 v21, 32, v20
  v_xor_b32 v18, 64, v16
  v_xor_b32 v22, 64, v20
  v_xor_b32 v19, 96, v16
  v_xor_b32 v23, 96, v20
  s_add_u32 s16, s34, 20316160
  s_addc_u32 s17, s35, 0
  s_mov_b32 s18, 40960
  s_mov_b32 s19, 0x20000
  v_mov_b32 v5, 0
  v_lshlrev_b32 v6, 4, v0
  s_mov_b32 s11, 4096
  s_cmp_lg_u32 s2, 0
  s_cbranch_scc1 gated_mix__spectral_gfnet__ssm_conv_s5__prompt_kernel_skip9
  v_mov_b32 v24, 0
  v_mov_b32 v25, 0
  v_mov_b32 v26, 0
  v_mov_b32 v27, 0
  buffer_store_dwordx4 v[24:27], v6, s[16:19], 0 offen sc1
  buffer_store_dwordx4 v[24:27], v6, s[16:19], s11 offen sc1
gated_mix__spectral_gfnet__ssm_conv_s5__prompt_kernel_skip9:
  s_mov_b32 s56, s28
  s_mov_b32 s57, s29
  s_mov_b32 s58, 2048
  s_mov_b32 s59, 0x20000
  s_mov_b32 s60, s34
  s_mov_b32 s61, s35
  s_mov_b32 s62, 4194304
  s_mov_b32 s63, 0x20000
  s_lshl_b32 s28, s3, 4
  v_add_u32 v75, s28, v2
  v_cvt_f32_u32 v7, v75
  v_mul_f32 v7, 0x3c000000, v7
  s_add_u32 m0, s54, 0
  s_nop 0
  buffer_load_dwordx4 v12, s[48:51], s43 offen offset:0  lds
  v_lshrrev_b32 v73, 1, v3
  v_lshlrev_b32 v73, 4, v73
  v_and_b32 v74, 1, v3
  v_lshl_add_u32 v73, v74, 2, v73
  v_cvt_f32_u32 v72, v73
  buffer_load_dwordx4 v13, s[48:51], s43 offen offset:1024  lds
  v_mul_f32 v72, v72, v7
  v_cmp_eq_u32 vcc, 0, v75
  v_fmamk_f32 v56, v7, 0x0, v72
  v_fmamk_f32 v57, v7, 0x3f800000, v72
  v_fmamk_f32 v58, v7, 0x40000000, v72
  buffer_load_dwordx4 v14, s[48:51], s43 offen offset:2048  lds
  v_fmamk_f32 v59, v7, 0x40400000, v72
  v_fmamk_f32 v60, v7, 0x41000000, v72
  v_fmamk_f32 v61, v7, 0x41100000, v72
  v_fmamk_f32 v62, v7, 0x41200000, v72
  v_fmamk_f32 v63, v7, 0x41300000, v72
  buffer_load_dwordx4 v15, s[48:51], s43 offen offset:3072  lds
  v_cos_f32 v64, v56
  v_cos_f32 v65, v57
  v_cos_f32 v66, v58
  s_add_u32 m0, s53, 0
  s_nop 0
  buffer_load_dwordx4 v8, s[44:47], s43 offen offset:0  lds
  v_cos_f32 v67, v59
  v_cos_f32 v68, v60
  v_cos_f32 v69, v61
  buffer_load_dwordx4 v9, s[44:47], s43 offen offset:1024  lds
  v_cos_f32 v70, v62
  v_cos_f32 v71, v63
  v_sin_f32 v56, v56
  buffer_load_dwordx4 v10, s[44:47], s43 offen offset:2048  lds
  v_sin_f32 v57, v57
  v_sin_f32 v58, v58
  v_sin_f32 v59, v59
  buffer_load_dwordx4 v11, s[44:47], s43 offen offset:3072  lds
  s_add_u32 s43, s43, 128
  s_and_b32 s43, s43, 0x7ff
  v_sin_f32 v60, v60
  v_sin_f32 v61, v61
  v_sin_f32 v62, v62
  v_sin_f32 v63, v63
  v_mov_b32 v72, 0x80008000
  v_bfe_i32 v74, v2, 0, 1
  v_bfe_i32 v73, v2, 1, 1
  v_cmp_ne_u32 s[64:65], 0, v74
  v_and_b32 v74, v72, v74
  v_and_b32 v73, v72, v73
  v_xor_b32 v75, v73, v74
  v_mov_b32 v7, 0xbf803f80
  v_cvt_pk_bf16_f32 v24, v64, v65
  v_cvt_pk_bf16_f32 v40, -v56, -v57
  v_cndmask_b32 v40, v40, v7, vcc
  v_cvt_pk_bf16_f32 v25, v66, v67
  v_cvt_pk_bf16_f32 v41, -v58, -v59
  v_cndmask_b32 v41, v41, v7, vcc
  v_cvt_pk_bf16_f32 v26, v68, v69
  v_cvt_pk_bf16_f32 v42, -v60, -v61
  v_cndmask_b32 v42, v42, v7, vcc
  v_cvt_pk_bf16_f32 v27, v70, v71
  v_cvt_pk_bf16_f32 v43, -v62, -v63
  v_cndmask_b32 v43, v43, v7, vcc
  v_cndmask_b32 v28, v24, v40, s[64:65]
  v_cndmask_b32 v44, v40, v24, s[64:65]
  v_xor_b32 v32, v74, v24
  v_xor_b32 v48, v74, v40
  v_xor_b32 v36, v75, v28
  v_xor_b32 v52, v73, v44
  v_xor_b32 v28, v73, v28
  v_xor_b32 v44, v75, v44
  v_cndmask_b32 v29, v25, v41, s[64:65]
  v_cndmask_b32 v45, v41, v25, s[64:65]
  v_xor_b32 v33, v74, v25
  v_xor_b32 v49, v74, v41
  v_xor_b32 v37, v75, v29
  v_xor_b32 v53, v73, v45
  v_xor_b32 v29, v73, v29
  v_xor_b32 v45, v75, v45
  v_cndmask_b32 v30, v26, v42, s[64:65]
  v_cndmask_b32 v46, v42, v26, s[64:65]
  v_xor_b32 v34, v74, v26
  v_xor_b32 v50, v74, v42
  v_xor_b32 v38, v75, v30
  v_xor_b32 v54, v73, v46
  v_xor_b32 v30, v73, v30
  v_xor_b32 v46, v75, v46
  v_cndmask_b32 v31, v27, v43, s[64:65]
  v_cndmask_b32 v47, v43, v27, s[64:65]
  v_xor_b32 v35, v74, v27
  v_xor_b32 v51, v74, v43
  v_xor_b32 v39, v75, v31
  v_xor_b32 v55, v73, v47
  v_xor_b32 v31, v73, v31
  v_xor_b32 v47, v75, v47
  s_mov_b32 s64, s32
  s_mov_b32 s65, s33
  s_mov_b32 s66, 256
  s_mov_b32 s67, 0x20000
  s_and_b32 s28, s2, 7
  s_lshl_b32 s28, s28, 8
  s_add_u32 s28, s28, s2
  s_and_b32 s28, s28, -8
  s_lshl_b32 s28, s28, 1
  v_mov_b32 v56, s28
  s_lshl_b32 s28, s39, 14
  s_add_u32 s70, s28, 19988480
  s_add_u32 s68, s34, s70
  s_addc_u32 s69, s35, 0
  s_mov_b32 s70, 8192
  s_mov_b32 s71, 0x20000
  s_lshl4_add_u32 s28, s39, s38
  s_lshl_b32 s28, s28, 7
  v_lshl_add_u32 v57, v2, 2, s28
  s_mov_b32 s28, 8192
  v_mov_b32 v7, 1
  s_lshl_b32 s29, s38, 7
  v_lshl_add_u32 v58, v1, 4, s29
  v_and_b32 v58, 0x7ff, v58
  s_add_u32 m0, s53, 49152
  s_nop 0
  buffer_load_dwordx4 v58, s[56:59], 0 offen lds
  v_xor_b32 v58, 1024, v58
  s_add_u32 m0, s53, 50176
  s_nop 0
  buffer_load_dwordx4 v58, s[56:59], 0 offen lds
  s_and_b32 s29, s3, 1
  s_lshl1_add_u32 s29, s39, s29
  s_lshl_b32 s29, s29, 6
  v_and_b32 v64, 31, v1
  v_lshl_add_u32 v64, v64, 1, s29
  s_lshl4_add_u32 s29, s3, s41
  s_lshl_b32 s29, s29, 5
  v_lshl_add_u32 v65, v2, 1, s29
  global_load_ushort v58, v64, s[12:13]
  global_load_ushort v59, v64, s[14:15]
  global_load_ushort v60, v64, s[24:25]
  global_load_short_d16_hi v62, v65, s[26:27]
  s_waitcnt vmcnt(14) lgkmcnt(0)
  s_barrier
  s_add_u32 m0, s54, 16384
  s_nop 0
  buffer_load_dwordx4 v12, s[48:51], s43 offen offset:0  lds
  v_bfe_u32 v61, v1, 2, 3
  v_lshrrev_b32 v68, 5, v1
  v_lshl_or_b32 v61, v68, 4, v61
  v_lshlrev_b32 v61, 7, v61
  v_and_b32 v68, 3, v1
  v_lshl_or_b32 v61, v68, 3, v61
  v_add_u32 v61, 131072, v61
  v_bfe_u32 v68, v1, 3, 2
  v_xor_b32 v64, 0, v68
  v_lshl_add_u32 v64, v64, 5, v61
  v_xor_b32 v65, 1, v68
  v_lshl_add_u32 v65, v65, 5, v61
  v_xor_b32 v66, 2, v68
  buffer_load_dwordx4 v13, s[48:51], s43 offen offset:1024  lds
  v_lshl_add_u32 v66, v66, 5, v61
  v_xor_b32 v67, 3, v68
  v_lshl_add_u32 v67, v67, 5, v61
  ds_read_b64_tr_b16 v[104:105], v64 offset:0
  ds_read_b64_tr_b16 v[106:107], v64 offset:1024
  ds_read_b64_tr_b16 v[108:109], v64 offset:4096
  ds_read_b64_tr_b16 v[110:111], v64 offset:5120
  ds_read_b64_tr_b16 v[112:113], v64 offset:8192
  ds_read_b64_tr_b16 v[114:115], v64 offset:9216
  ds_read_b64_tr_b16 v[116:117], v64 offset:12288
  ds_read_b64_tr_b16 v[118:119], v64 offset:13312
  ds_read_b64_tr_b16 v[120:121], v66 offset:0
  ds_read_b64_tr_b16 v[122:123], v66 offset:1024
  buffer_load_dwordx4 v14, s[48:51], s43 offen offset:2048  lds
  ds_read_b64_tr_b16 v[124:125], v66 offset:4096
  ds_read_b64_tr_b16 v[126:127], v66 offset:5120
  ds_read_b64_tr_b16 v[128:129], v66 offset:8192
  ds_read_b64_tr_b16 v[130:131], v66 offset:9216
  ds_read_b64_tr_b16 v[132:133], v66 offset:12288
  ds_read_b64_tr_b16 v[134:135], v66 offset:13312
  ds_read_b64_tr_b16 v[136:137], v65 offset:0
  ds_read_b64_tr_b16 v[138:139], v65 offset:1024
  ds_read_b64_tr_b16 v[140:141], v65 offset:4096
  ds_read_b64_tr_b16 v[142:143], v65 offset:5120
  ds_read_b64_tr_b16 v[144:145], v65 offset:8192
  ds_read_b64_tr_b16 v[146:147], v65 offset:9216
  ds_read_b64_tr_b16 v[148:149], v65 offset:12288
  buffer_load_dwordx4 v15, s[48:51], s43 offen offset:3072  lds
  ds_read_b64_tr_b16 v[150:151], v65 offset:13312
  s_waitcnt lgkmcnt(15)
  v_mfma_f32_16x16x32_bf16 v[72:75], v[24:27], v[104:107], 0
  v_mfma_f32_16x16x32_bf16 v[76:79], v[40:43], v[104:107], 0
  s_waitcnt lgkmcnt(15)
  v_mfma_f32_16x16x32_bf16 v[72:75], v[28:31], v[108:111], v[72:75]
  s_add_u32 m0, s53, 16384
  s_nop 0
  buffer_load_dwordx4 v8, s[44:47], s43 offen offset:0  lds
  v_mfma_f32_16x16x32_bf16 v[76:79], v[44:47], v[108:111], v[76:79]
  s_waitcnt lgkmcnt(15)
  v_mfma_f32_16x16x32_bf16 v[72:75], v[32:35], v[112:115], v[72:75]
  v_mfma_f32_16x16x32_bf16 v[76:79], v[48:51], v[112:115], v[76:79]
  s_waitcnt lgkmcnt(15)
  v_mfma_f32_16x16x32_bf16 v[72:75], v[36:39], v[116:119], v[72:75]
  buffer_load_dwordx4 v9, s[44:47], s43 offen offset:1024  lds
  v_mfma_f32_16x16x32_bf16 v[76:79], v[52:55], v[116:119], v[76:79]
  ds_read_b64_tr_b16 v[104:105], v67 offset:0
  ds_read_b64_tr_b16 v[106:107], v67 offset:1024
  ds_read_b64_tr_b16 v[108:109], v67 offset:4096
  ds_read_b64_tr_b16 v[110:111], v67 offset:5120
  ds_read_b64_tr_b16 v[112:113], v67 offset:8192
  ds_read_b64_tr_b16 v[114:115], v67 offset:9216
  ds_read_b64_tr_b16 v[116:117], v67 offset:12288
  ds_read_b64_tr_b16 v[118:119], v67 offset:13312
  s_waitcnt lgkmcnt(15)
  v_mfma_f32_16x16x32_bf16 v[88:91], v[24:27], v[120:123], 0
  buffer_load_dwordx4 v10, s[44:47], s43 offen offset:2048  lds
  v_mfma_f32_16x16x32_bf16 v[92:95], v[40:43], v[120:123], 0
  s_waitcnt lgkmcnt(15)
  v_mfma_f32_16x16x32_bf16 v[88:91], v[28:31], v[124:127], v[88:91]
  v_mfma_f32_16x16x32_bf16 v[92:95], v[44:47], v[124:127], v[92:95]
  s_waitcnt lgkmcnt(15)
  v_mfma_f32_16x16x32_bf16 v[88:91], v[32:35], v[128:131], v[88:91]
  buffer_load_dwordx4 v11, s[44:47], s43 offen offset:3072  lds
  s_add_u32 s43, s43, 128
  s_and_b32 s43, s43, 0x7ff
  v_mfma_f32_16x16x32_bf16 v[92:95], v[48:51], v[128:131], v[92:95]
  s_waitcnt lgkmcnt(15)
  v_mfma_f32_16x16x32_bf16 v[88:91], v[36:39], v[132:135], v[88:91]
  v_mfma_f32_16x16x32_bf16 v[92:95], v[52:55], v[132:135], v[92:95]
  s_waitcnt lgkmcnt(14)
  v_mfma_f32_16x16x32_bf16 v[80:83], v[24:27], v[136:139], 0
  s_add_u32 m0, s54, 32768
  s_nop 0
  buffer_load_dwordx4 v12, s[48:51], s43 offen offset:0  lds
  v_mfma_f32_16x16x32_bf16 v[84:87], v[40:43], v[136:139], 0
  s_waitcnt lgkmcnt(12)
  v_mfma_f32_16x16x32_bf16 v[80:83], v[28:31], v[140:143], v[80:83]
  v_mfma_f32_16x16x32_bf16 v[84:87], v[44:47], v[140:143], v[84:87]
  s_waitcnt lgkmcnt(10)
  v_mfma_f32_16x16x32_bf16 v[80:83], v[32:35], v[144:147], v[80:83]
  buffer_load_dwordx4 v13, s[48:51], s43 offen offset:1024  lds
  v_mfma_f32_16x16x32_bf16 v[84:87], v[48:51], v[144:147], v[84:87]
  s_waitcnt lgkmcnt(8)
  v_mfma_f32_16x16x32_bf16 v[80:83], v[36:39], v[148:151], v[80:83]
  v_mfma_f32_16x16x32_bf16 v[84:87], v[52:55], v[148:151], v[84:87]
  s_waitcnt lgkmcnt(6)
  v_mfma_f32_16x16x32_bf16 v[96:99], v[24:27], v[104:107], 0
  buffer_load_dwordx4 v14, s[48:51], s43 offen offset:2048  lds
  v_mfma_f32_16x16x32_bf16 v[100:103], v[40:43], v[104:107], 0
  s_waitcnt lgkmcnt(4)
  v_mfma_f32_16x16x32_bf16 v[96:99], v[28:31], v[108:111], v[96:99]
  v_mfma_f32_16x16x32_bf16 v[100:103], v[44:47], v[108:111], v[100:103]
  s_waitcnt lgkmcnt(2)
  v_mfma_f32_16x16x32_bf16 v[96:99], v[32:35], v[112:115], v[96:99]
  buffer_load_dwordx4 v15, s[48:51], s43 offen offset:3072  lds
  v_mfma_f32_16x16x32_bf16 v[100:103], v[48:51], v[112:115], v[100:103]
  s_waitcnt lgkmcnt(0)
  v_mfma_f32_16x16x32_bf16 v[96:99], v[36:39], v[116:119], v[96:99]
  v_mfma_f32_16x16x32_bf16 v[100:103], v[52:55], v[116:119], v[100:103]
  v_pk_add_f32 v[120:121], v[72:73], v[88:89]
  s_add_u32 m0, s53, 32768
  s_nop 0
  buffer_load_dwordx4 v8, s[44:47], s43 offen offset:0  lds
  v_pk_add_f32 v[128:129], v[72:73], v[88:89] neg_lo:[0,1] neg_hi:[0,1]
  v_pk_add_f32 v[122:123], v[74:75], v[90:91]
  v_pk_add_f32 v[130:131], v[74:75], v[90:91] neg_lo:[0,1] neg_hi:[0,1]
  v_pk_add_f32 v[124:125], v[76:77], v[92:93]
  v_pk_add_f32 v[132:133], v[76:77], v[92:93] neg_lo:[0,1] neg_hi:[0,1]
  v_pk_add_f32 v[126:127], v[78:79], v[94:95]
  v_pk_add_f32 v[134:135], v[78:79], v[94:95] neg_lo:[0,1] neg_hi:[0,1]
  v_pk_add_f32 v[136:137], v[80:81], v[96:97]
  v_pk_add_f32 v[144:145], v[80:81], v[96:97] neg_lo:[0,1] neg_hi:[0,1]
  v_pk_add_f32 v[138:139], v[82:83], v[98:99]
  v_pk_add_f32 v[146:147], v[82:83], v[98:99] neg_lo:[0,1] neg_hi:[0,1]
  v_pk_add_f32 v[140:141], v[84:85], v[100:101]
  v_pk_add_f32 v[148:149], v[84:85], v[100:101] neg_lo:[0,1] neg_hi:[0,1]
  buffer_load_dwordx4 v9, s[44:47], s43 offen offset:1024  lds
  v_pk_add_f32 v[142:143], v[86:87], v[102:103]
  v_pk_add_f32 v[150:151], v[86:87], v[102:103] neg_lo:[0,1] neg_hi:[0,1]
  s_lshr_b32 s29, s3, 1
  s_lshr_b32 s32, s39, 1
  s_lshl3_add_u32 s29, s29, s32
  s_and_b32 s32, s3, 1
  s_lshl1_add_u32 s29, s29, s32
  s_and_b32 s32, s39, 1
  s_lshl1_add_u32 s29, s29, s32
  s_lshl_b32 s32, s29, 8
  v_lshl_add_u32 v69, v1, 2, s32
  s_and_b32 s29, s29, 7
  s_lshl_b32 s29, s29, 2
  buffer_load_dwordx4 v10, s[44:47], s43 offen offset:2048  lds
  v_and_b32 v70, 31, v1
  v_xor_b32 v70, s29, v70
  v_lshl_add_u32 v70, v70, 2, s53
  v_mov_b32 v184, 0
  s_mov_b32 s33, 0x3f803f80
  s_waitcnt vmcnt(19)
  ds_read_u16_d16_hi v152, v70 offset:49152
  ds_read_u16_d16_hi v153, v70 offset:49154
  ds_read_u16_d16_hi v154, v70 offset:49280
  ds_read_u16_d16_hi v155, v70 offset:49282
  ds_read_u16_d16_hi v156, v70 offset:49408
  ds_read_u16_d16_hi v157, v70 offset:49410
  ds_read_u16_d16_hi v158, v70 offset:49536
  ds_read_u16_d16_hi v159, v70 offset:49538
  buffer_load_dwordx4 v11, s[44:47], s43 offen offset:3072  lds
  s_add_u32 s43, s43, 128
  s_and_b32 s43, s43, 0x7ff
  ds_read_u16_d16_hi v160, v70 offset:49664
  ds_read_u16_d16_hi v161, v70 offset:49666
  ds_read_u16_d16_hi v162, v70 offset:49792
  ds_read_u16_d16_hi v163, v70 offset:49794
  ds_read_u16_d16_hi v164, v70 offset:49920
  ds_read_u16_d16_hi v165, v70 offset:49922
  ds_read_u16_d16_hi v166, v70 offset:50048
  ds_read_u16_d16_hi v167, v70 offset:50050
  ds_read_u16_d16_hi v168, v70 offset:50176
  ds_read_u16_d16_hi v169, v70 offset:50178
  ds_read_u16_d16_hi v170, v70 offset:50304
  ds_read_u16_d16_hi v171, v70 offset:50306
  ds_read_u16_d16_hi v172, v70 offset:50432
  s_add_u32 m0, s54, 49152
  s_nop 0
  buffer_load_dwordx4 v12, s[48:51], s43 offen offset:0  lds
  ds_read_u16_d16_hi v173, v70 offset:50434
  ds_read_u16_d16_hi v174, v70 offset:50560
  ds_read_u16_d16_hi v175, v70 offset:50562
  ds_read_u16_d16_hi v176, v70 offset:50688
  ds_read_u16_d16_hi v177, v70 offset:50690
  ds_read_u16_d16_hi v178, v70 offset:50816
  ds_read_u16_d16_hi v179, v70 offset:50818
  ds_read_u16_d16_hi v180, v70 offset:50944
  ds_read_u16_d16_hi v181, v70 offset:50946
  ds_read_u16_d16_hi v182, v70 offset:51072
  ds_read_u16_d16_hi v183, v70 offset:51074
  v_pk_add_f32 v[72:73], v[120:121], v[136:137]
  v_pk_add_f32 v[88:89], v[120:121], v[136:137] neg_lo:[0,1] neg_hi:[0,1]
  buffer_load_dwordx4 v13, s[48:51], s43 offen offset:1024  lds
  v_pk_add_f32 v[76:77], v[124:125], v[140:141]
  v_pk_add_f32 v[92:93], v[124:125], v[140:141] neg_lo:[0,1] neg_hi:[0,1]
  v_pk_add_f32 v[80:81], v[128:129], v[148:149]
  v_pk_add_f32 v[84:85], v[132:133], v[144:145] neg_lo:[0,1] neg_hi:[0,1]
  v_pk_add_f32 v[96:97], v[128:129], v[148:149] neg_lo:[0,1] neg_hi:[0,1]
  v_pk_add_f32 v[100:101], v[132:133], v[144:145]
  v_pk_add_f32 v[74:75], v[122:123], v[138:139]
  v_pk_add_f32 v[90:91], v[122:123], v[138:139] neg_lo:[0,1] neg_hi:[0,1]
  v_pk_add_f32 v[78:79], v[126:127], v[142:143]
  v_pk_add_f32 v[94:95], v[126:127], v[142:143] neg_lo:[0,1] neg_hi:[0,1]
  v_pk_add_f32 v[82:83], v[130:131], v[150:151]
  v_pk_add_f32 v[86:87], v[134:135], v[146:147] neg_lo:[0,1] neg_hi:[0,1]
  v_pk_add_f32 v[98:99], v[130:131], v[150:151] neg_lo:[0,1] neg_hi:[0,1]
  buffer_load_dwordx4 v14, s[48:51], s43 offen offset:2048  lds
  v_pk_add_f32 v[102:103], v[134:135], v[146:147]
  v_cmp_gt_u32 vcc, 16, v0
  s_nop 1
  v_cndmask_b32 v80, v80, v128, vcc
  v_cndmask_b32 v84, v84, -v144, vcc
  v_cndmask_b32 v96, v96, v132, vcc
  v_cndmask_b32 v100, v100, -v148, vcc
  v_cvt_pk_bf16_f32 v104, v72, v76
  v_cvt_pk_bf16_f32 v105, v80, v84
  v_cvt_pk_bf16_f32 v106, v88, v92
  v_cvt_pk_bf16_f32 v107, v96, v100
  v_cvt_pk_bf16_f32 v108, v73, v77
  v_cvt_pk_bf16_f32 v109, v81, v85
  v_cvt_pk_bf16_f32 v110, v89, v93
  buffer_load_dwordx4 v15, s[48:51], s43 offen offset:3072  lds
  v_cvt_pk_bf16_f32 v111, v97, v101
  v_cvt_pk_bf16_f32 v112, v74, v78
  v_cvt_pk_bf16_f32 v113, v82, v86
  v_cvt_pk_bf16_f32 v114, v90, v94
  v_cvt_pk_bf16_f32 v115, v98, v102
  v_cvt_pk_bf16_f32 v116, v75, v79
  v_cvt_pk_bf16_f32 v117, v83, v87
  v_cvt_pk_bf16_f32 v118, v91, v95
  v_cvt_pk_bf16_f32 v119, v99, v103
  v_and_b32 v104, -2, v104
  v_and_b32 v105, -2, v105
  v_and_b32 v106, -2, v106
  v_and_b32 v107, -2, v107
  s_waitcnt lgkmcnt(0)
  s_add_u32 m0, s53, 49152
  s_nop 0
  buffer_load_dwordx4 v8, s[44:47], s43 offen offset:0  lds
  v_and_b32 v108, -2, v108
  v_and_b32 v109, -2, v109
  v_and_b32 v110, -2, v110
  v_and_b32 v111, -2, v111
  v_and_b32 v112, -2, v112
  v_and_b32 v113, -2, v113
  v_and_b32 v114, -2, v114
  v_and_b32 v115, -2, v115
  v_and_b32 v116, -2, v116
  v_and_b32 v117, -2, v117
  v_and_b32 v118, -2, v118
  v_and_b32 v119, -2, v119
  s_mov_b32 s29, 262144
  buffer_load_dwordx4 v9, s[44:47], s43 offen offset:1024  lds
  v_mul_lo_u32 v61, v3, s29
  v_lshl_add_u32 v61, v2, 2, v61
  s_mul_i32 s29, s3, 1048576
  s_lshl_b32 s32, s40, 10
  s_add_u32 s29, s29, s32
  s_lshl_b32 s32, s41, 6
  s_add_u32 s29, s29, s32
  s_lshr_b32 s32, s41, 3
  s_lshl_b32 s32, s32, 13
  s_add_u32 s32, s32, 131072
  v_lshl_add_u32 v39, v2, 7, s32
  v_lshl_add_u32 v39, v3, 3, v39
  v_bfe_u32 v68, v2, 1, 2
  buffer_load_dwordx4 v10, s[44:47], s43 offen offset:2048  lds
  v_xor_b32 v68, s3, v68
  v_lshl_add_u32 v39, v68, 5, v39
  v_xor_b32 v38, 8192, v39
  ds_read_b64 v[186:187], v38 offset:0
  ds_read_b64 v[24:25], v38 offset:2048
  ds_read_b64 v[26:27], v38 offset:4096
  ds_read_b64 v[28:29], v38 offset:6144
  ds_read_b64 v[30:31], v39 offset:0
  ds_read_b64 v[32:33], v39 offset:2048
  ds_read_b64 v[34:35], v39 offset:4096
  ds_read_b64 v[36:37], v39 offset:6144
  buffer_load_dwordx4 v11, s[44:47], s43 offen offset:3072  lds
  s_add_u32 s43, s43, 128
  s_and_b32 s43, s43, 0x7ff
  s_barrier
  ds_read_b128 v[64:67], v16 offset:0
  ds_read_b128 v[140:143], v20 offset:0
  ds_read_b128 v[136:139], v16 offset:4096
  ds_read_b128 v[144:147], v20 offset:4096
  s_waitcnt lgkmcnt(2)
  v_mfma_f32_32x32x16_bf16 v[40:55], v[64:67], v[140:143], 0
  ds_read_b128 v[148:151], v17 offset:0
  ds_read_b128 v[192:195], v21 offset:0
  buffer_store_dword v104, v61, s[60:63], s29 offen sc1
  s_add_u32 s29, s29, 16384
  buffer_store_dword v105, v61, s[60:63], s29 offen sc1
  ds_read_u16_d16_hi v185, v69 offset:0
  ds_read_u16_d16_hi v70, v69 offset:2
  s_waitcnt lgkmcnt(4)
  v_mfma_f32_32x32x16_bf16 v[72:87], v[64:67], v[144:147], 0
  ds_read_b128 v[188:191], v17 offset:4096
  ds_read_b128 v[196:199], v21 offset:4096
  s_add_u32 s29, s29, 16384
  buffer_store_dword v106, v61, s[60:63], s29 offen sc1
  v_mfma_f32_32x32x16_bf16 v[120:135], v[136:139], v[144:147], 0
  s_add_u32 s29, s29, 16384
  buffer_store_dword v107, v61, s[60:63], s29 offen sc1
  v_mfma_f32_32x32x16_bf16 v[88:103], v[136:139], v[140:143], 0
  s_add_u32 s29, s29, 16384
  buffer_store_dword v108, v61, s[60:63], s29 offen sc1
  s_waitcnt lgkmcnt(4)
  v_mfma_f32_32x32x16_bf16 v[40:55], v[148:151], v[192:195], v[40:55]
  ds_read_b128 v[64:67], v18 offset:0
  ds_read_b128 v[140:143], v22 offset:0
  s_add_u32 s29, s29, 16384
  buffer_store_dword v109, v61, s[60:63], s29 offen sc1
  s_waitcnt lgkmcnt(2)
  v_mfma_f32_32x32x16_bf16 v[72:87], v[148:151], v[196:199], v[72:87]
  ds_read_b128 v[136:139], v18 offset:4096
  ds_read_b128 v[144:147], v22 offset:4096
  s_add_u32 s29, s29, 16384
  buffer_store_dword v110, v61, s[60:63], s29 offen sc1
  v_mfma_f32_32x32x16_bf16 v[120:135], v[188:191], v[196:199], v[120:135]
  s_add_u32 s29, s29, 16384
  buffer_store_dword v111, v61, s[60:63], s29 offen sc1
  v_mfma_f32_32x32x16_bf16 v[88:103], v[188:191], v[192:195], v[88:103]
  s_add_u32 s29, s29, 16384
  buffer_store_dword v112, v61, s[60:63], s29 offen sc1
  v_mul_f32 v185, v185, v152
  v_mul_f32 v70, v70, v153
  s_waitcnt lgkmcnt(2)
  v_mfma_f32_32x32x16_bf16 v[40:55], v[64:67], v[140:143], v[40:55]
  ds_read_b128 v[148:151], v19 offset:0
  ds_read_b128 v[192:195], v23 offset:0
  s_add_u32 s29, s29, 16384
  buffer_store_dword v113, v61, s[60:63], s29 offen sc1
  s_add_u32 s29, s29, 16384
  s_waitcnt lgkmcnt(2)
  v_mfma_f32_32x32x16_bf16 v[72:87], v[64:67], v[144:147], v[72:87]
  ds_read_b128 v[188:191], v19 offset:4096
  ds_read_b128 v[196:199], v23 offset:4096
  buffer_store_dword v114, v61, s[60:63], s29 offen sc1
  s_add_u32 s29, s29, 16384
  v_cvt_pk_bf16_f32 v185, v185, v70
  v_mfma_f32_32x32x16_bf16 v[120:135], v[136:139], v[144:147], v[120:135]
  buffer_store_dword v115, v61, s[60:63], s29 offen sc1
  s_add_u32 s29, s29, 16384
  v_mfma_f32_32x32x16_bf16 v[88:103], v[136:139], v[140:143], v[88:103]
  buffer_store_dword v116, v61, s[60:63], s29 offen sc1
  s_add_u32 s29, s29, 16384
  s_waitcnt vmcnt(29) lgkmcnt(0)
  s_barrier
  v_mfma_f32_32x32x16_bf16 v[40:55], v[148:151], v[192:195], v[40:55]
  ds_read_b128 v[64:67], v16 offset:16384
  ds_read_b128 v[140:143], v20 offset:16384
  buffer_store_dword v117, v61, s[60:63], s29 offen sc1
  s_add_u32 s29, s29, 16384
  v_dot2c_f32_bf16 v184, s33, v185
  v_mfma_f32_32x32x16_bf16 v[72:87], v[148:151], v[196:199], v[72:87]
  ds_read_b128 v[136:139], v16 offset:20480
  ds_read_b128 v[144:147], v20 offset:20480
  buffer_store_dword v118, v61, s[60:63], s29 offen sc1
  s_add_u32 s29, s29, 16384
  v_mfma_f32_32x32x16_bf16 v[120:135], v[188:191], v[196:199], v[120:135]
  s_add_u32 m0, s54, 0
  s_nop 0
  buffer_load_dwordx4 v12, s[48:51], s43 offen offset:0  lds
  buffer_store_dword v119, v61, s[60:63], s29 offen sc1
  s_sub_u32 s29, 15, s38
  v_mfma_f32_32x32x16_bf16 v[88:103], v[188:191], v[192:195], v[88:103]
  buffer_load_dwordx4 v13, s[48:51], s43 offen offset:1024  lds
  s_lshl_b32 s29, s29, 9
  v_lshl_add_u32 v38, v0, 2, s29
  s_waitcnt lgkmcnt(2)
  v_mfma_f32_32x32x16_bf16 v[40:55], v[64:67], v[140:143], v[40:55]
  ds_read_b128 v[148:151], v17 offset:16384
  ds_read_b128 v[192:195], v21 offset:16384
  v_mov_b32 v39, -1
  s_cmp_ge_u32 s3, 2
  s_cbranch_scc1 gated_mix__spectral_gfnet__ssm_conv_s5__prompt_kernel_skip10
  buffer_store_dword v39, v38, s[68:71], 0 offen sc1
gated_mix__spectral_gfnet__ssm_conv_s5__prompt_kernel_skip10:
  ds_read_u16_d16_hi v185, v69 offset:16384
  ds_read_u16_d16_hi v70, v69 offset:16386
  s_waitcnt lgkmcnt(4)
  v_mfma_f32_32x32x16_bf16 v[72:87], v[64:67], v[144:147], v[72:87]
  ds_read_b128 v[188:191], v17 offset:20480
  ds_read_b128 v[196:199], v21 offset:20480
  v_mfma_f32_32x32x16_bf16 v[120:135], v[136:139], v[144:147], v[120:135]
  buffer_load_dwordx4 v14, s[48:51], s43 offen offset:2048  lds
  v_mfma_f32_32x32x16_bf16 v[88:103], v[136:139], v[140:143], v[88:103]
  buffer_load_dwordx4 v15, s[48:51], s43 offen offset:3072  lds
  s_waitcnt lgkmcnt(4)
  v_mfma_f32_32x32x16_bf16 v[40:55], v[148:151], v[192:195], v[40:55]
  ds_read_b128 v[64:67], v18 offset:16384
  ds_read_b128 v[140:143], v22 offset:16384
  s_cmp_lg_u32 s3, 0
  s_cbranch_scc1 gated_mix__spectral_gfnet__ssm_conv_s5__prompt_kernel_skip11
  s_mov_b64 exec, 65535
  buffer_store_dword v5, v57, s[16:19], s28 offen sc1
  s_mov_b64 exec, -1
gated_mix__spectral_gfnet__ssm_conv_s5__prompt_kernel_skip11:
  s_waitcnt lgkmcnt(2)
  v_mfma_f32_32x32x16_bf16 v[72:87], v[148:151], v[196:199], v[72:87]
  ds_read_b128 v[136:139], v18 offset:20480
  ds_read_b128 v[144:147], v22 offset:20480
  v_mfma_f32_32x32x16_bf16 v[120:135], v[188:191], v[196:199], v[120:135]
  s_add_u32 m0, s53, 0
  s_nop 0
  buffer_load_dwordx4 v8, s[44:47], s43 offen offset:0  lds
  v_mfma_f32_32x32x16_bf16 v[88:103], v[188:191], v[192:195], v[88:103]
  buffer_load_dwordx4 v9, s[44:47], s43 offen offset:1024  lds
  v_mul_f32 v185, v185, v154
  v_mul_f32 v70, v70, v155
  s_waitcnt lgkmcnt(2)
  v_mfma_f32_32x32x16_bf16 v[40:55], v[64:67], v[140:143], v[40:55]
  ds_read_b128 v[148:151], v19 offset:16384
  ds_read_b128 v[192:195], v23 offset:16384
  s_waitcnt lgkmcnt(2)
  v_mfma_f32_32x32x16_bf16 v[72:87], v[64:67], v[144:147], v[72:87]
  ds_read_b128 v[188:191], v19 offset:20480
  ds_read_b128 v[196:199], v23 offset:20480
  s_or_b32 s29, s3, s2
  v_cvt_pk_bf16_f32 v185, v185, v70
  v_mfma_f32_32x32x16_bf16 v[120:135], v[136:139], v[144:147], v[120:135]
  buffer_load_dwordx4 v10, s[44:47], s43 offen offset:2048  lds
  s_cmp_lg_u32 s29, 0
  s_cbranch_scc1 gated_mix__spectral_gfnet__ssm_conv_s5__prompt_kernel_skip12
  s_mov_b64 exec, 1
  buffer_store_dword v7, v5, s[64:67], 0 offen sc1
  s_mov_b64 exec, -1
gated_mix__spectral_gfnet__ssm_conv_s5__prompt_kernel_skip12:
  v_mfma_f32_32x32x16_bf16 v[88:103], v[136:139], v[140:143], v[88:103]
  buffer_load_dwordx4 v11, s[44:47], s43 offen offset:3072  lds
  s_add_u32 s43, s43, 128
  s_and_b32 s43, s43, 0x7ff
  s_waitcnt vmcnt(32) lgkmcnt(0)
  s_barrier
  v_mfma_f32_32x32x16_bf16 v[40:55], v[148:151], v[192:195], v[40:55]
  ds_read_b128 v[64:67], v16 offset:32768
  ds_read_b128 v[140:143], v20 offset:32768
  v_dot2c_f32_bf16 v184, s33, v185
  v_mfma_f32_32x32x16_bf16 v[72:87], v[148:151], v[196:199], v[72:87]
  ds_read_b128 v[136:139], v16 offset:36864
  ds_read_b128 v[144:147], v20 offset:36864
  v_mfma_f32_32x32x16_bf16 v[120:135], v[188:191], v[196:199], v[120:135]
  s_add_u32 m0, s54, 16384
  s_nop 0
  buffer_load_dwordx4 v12, s[48:51], s43 offen offset:0  lds
  v_mfma_f32_32x32x16_bf16 v[88:103], v[188:191], v[192:195], v[88:103]
  buffer_load_dwordx4 v13, s[48:51], s43 offen offset:1024  lds
  s_waitcnt lgkmcnt(2)
  v_mfma_f32_32x32x16_bf16 v[40:55], v[64:67], v[140:143], v[40:55]
  ds_read_b128 v[148:151], v17 offset:32768
  ds_read_b128 v[192:195], v21 offset:32768
  v_lshlrev_b32 v61, 4, v1
  v_add_u32 v61, 147456, v61
  ds_read_u16_d16_hi v185, v69 offset:32768
  ds_read_u16_d16_hi v70, v69 offset:32770
  s_waitcnt lgkmcnt(4)
  v_mfma_f32_32x32x16_bf16 v[72:87], v[64:67], v[144:147], v[72:87]
  ds_read_b128 v[188:191], v17 offset:36864
  ds_read_b128 v[196:199], v21 offset:36864
  ds_read_b128 v[104:107], v61 offset:0
  v_mfma_f32_32x32x16_bf16 v[120:135], v[136:139], v[144:147], v[120:135]
  buffer_load_dwordx4 v14, s[48:51], s43 offen offset:2048  lds
  ds_read_b128 v[108:111], v61 offset:1024
  v_mfma_f32_32x32x16_bf16 v[88:103], v[136:139], v[140:143], v[88:103]
  buffer_load_dwordx4 v15, s[48:51], s43 offen offset:3072  lds
  ds_read_b128 a[224:227], v61 offset:2048
  s_waitcnt lgkmcnt(7)
  v_mfma_f32_32x32x16_bf16 v[40:55], v[148:151], v[192:195], v[40:55]
  ds_read_b128 v[64:67], v18 offset:32768
  ds_read_b128 v[140:143], v22 offset:32768
  ds_read_b128 a[228:231], v61 offset:3072
  s_waitcnt lgkmcnt(6)
  v_mfma_f32_32x32x16_bf16 v[72:87], v[148:151], v[196:199], v[72:87]
  ds_read_b128 v[136:139], v18 offset:36864
  ds_read_b128 v[144:147], v22 offset:36864
  ds_read_b128 a[248:251], v61 offset:4096
  v_mfma_f32_32x32x16_bf16 v[120:135], v[188:191], v[196:199], v[120:135]
  s_add_u32 m0, s53, 16384
  s_nop 0
  buffer_load_dwordx4 v8, s[44:47], s43 offen offset:0  lds
  ds_read_b128 a[252:255], v61 offset:5120
  v_mfma_f32_32x32x16_bf16 v[88:103], v[188:191], v[192:195], v[88:103]
  buffer_load_dwordx4 v9, s[44:47], s43 offen offset:1024  lds
  ds_read_b128 a[232:235], v61 offset:6144
  v_mul_f32 v185, v185, v156
  v_mul_f32 v70, v70, v157
  s_waitcnt lgkmcnt(6)
  v_mfma_f32_32x32x16_bf16 v[40:55], v[64:67], v[140:143], v[40:55]
  ds_read_b128 v[148:151], v19 offset:32768
  ds_read_b128 v[192:195], v23 offset:32768
  ds_read_b128 a[236:239], v61 offset:7168
  s_waitcnt lgkmcnt(6)
  v_mfma_f32_32x32x16_bf16 v[72:87], v[64:67], v[144:147], v[72:87]
  ds_read_b128 v[188:191], v19 offset:36864
  ds_read_b128 v[196:199], v23 offset:36864
  ds_read_b128 v[112:115], v61 offset:8192
  v_cvt_pk_bf16_f32 v185, v185, v70
  v_mfma_f32_32x32x16_bf16 v[120:135], v[136:139], v[144:147], v[120:135]
  buffer_load_dwordx4 v10, s[44:47], s43 offen offset:2048  lds
  ds_read_b128 v[116:119], v61 offset:9216
  v_mfma_f32_32x32x16_bf16 v[88:103], v[136:139], v[140:143], v[88:103]
  buffer_load_dwordx4 v11, s[44:47], s43 offen offset:3072  lds
  s_add_u32 s43, s43, 128
  s_and_b32 s43, s43, 0x7ff
  ds_read_b128 v[200:203], v61 offset:10240
  s_waitcnt vmcnt(32) lgkmcnt(3)
  s_barrier
  v_mfma_f32_32x32x16_bf16 v[40:55], v[148:151], v[192:195], v[40:55]
  ds_read_b128 v[64:67], v16 offset:49152
  ds_read_b128 v[140:143], v20 offset:49152
  ds_read_b128 v[204:207], v61 offset:11264
  v_dot2c_f32_bf16 v184, s33, v185
  v_mfma_f32_32x32x16_bf16 v[72:87], v[148:151], v[196:199], v[72:87]
  ds_read_b128 v[136:139], v16 offset:53248
  ds_read_b128 v[144:147], v20 offset:53248
  ds_read_b128 a[240:243], v61 offset:12288
  v_mfma_f32_32x32x16_bf16 v[120:135], v[188:191], v[196:199], v[120:135]
  s_add_u32 m0, s54, 32768
  s_nop 0
  buffer_load_dwordx4 v12, s[48:51], s43 offen offset:0  lds
  ds_read_b128 a[244:247], v61 offset:13312
  v_mfma_f32_32x32x16_bf16 v[88:103], v[188:191], v[192:195], v[88:103]
  buffer_load_dwordx4 v13, s[48:51], s43 offen offset:1024  lds
  ds_read_b128 v[208:211], v61 offset:14336
  s_waitcnt lgkmcnt(6)
  v_mfma_f32_32x32x16_bf16 v[40:55], v[64:67], v[140:143], v[40:55]
  ds_read_b128 v[148:151], v17 offset:49152
  ds_read_b128 v[192:195], v21 offset:49152
  ds_read_b128 v[212:215], v61 offset:15360
  ds_read_u16_d16_hi v185, v69 offset:49152
  ds_read_u16_d16_hi v70, v69 offset:49154
  s_waitcnt lgkmcnt(8)
  v_mfma_f32_32x32x16_bf16 v[72:87], v[64:67], v[144:147], v[72:87]
  ds_read_b128 v[188:191], v17 offset:53248
  ds_read_b128 v[196:199], v21 offset:53248
  s_mov_b32 s12, s20
  v_mfma_f32_32x32x16_bf16 v[120:135], v[136:139], v[144:147], v[120:135]
  buffer_load_dwordx4 v14, s[48:51], s43 offen offset:2048  lds
  s_mov_b32 s13, s21
  v_mfma_f32_32x32x16_bf16 v[88:103], v[136:139], v[140:143], v[88:103]
  buffer_load_dwordx4 v15, s[48:51], s43 offen offset:3072  lds
  s_mov_b32 s14, 2097152
  s_waitcnt lgkmcnt(5)
  v_mfma_f32_32x32x16_bf16 v[40:55], v[148:151], v[192:195], v[40:55]
  ds_read_b128 v[64:67], v18 offset:49152
  ds_read_b128 v[140:143], v22 offset:49152
  s_mov_b32 s15, 0x20000
  s_waitcnt lgkmcnt(2)
  v_mfma_f32_32x32x16_bf16 v[72:87], v[148:151], v[196:199], v[72:87]
  ds_read_b128 v[136:139], v18 offset:53248
  ds_read_b128 v[144:147], v22 offset:53248
  s_mov_b32 s24, s22
  v_mfma_f32_32x32x16_bf16 v[120:135], v[188:191], v[196:199], v[120:135]
  s_add_u32 m0, s53, 32768
  s_nop 0
  buffer_load_dwordx4 v8, s[44:47], s43 offen offset:0  lds
  s_mov_b32 s25, s23
  v_mfma_f32_32x32x16_bf16 v[88:103], v[188:191], v[192:195], v[88:103]
  buffer_load_dwordx4 v9, s[44:47], s43 offen offset:1024  lds
  s_mov_b32 s26, 2097152
  v_mul_f32 v185, v185, v158
  v_mul_f32 v70, v70, v159
  s_waitcnt lgkmcnt(2)
  v_mfma_f32_32x32x16_bf16 v[40:55], v[64:67], v[140:143], v[40:55]
  ds_read_b128 v[148:151], v19 offset:49152
  ds_read_b128 v[192:195], v23 offset:49152
  s_mov_b32 s27, 0x20000
  s_waitcnt lgkmcnt(2)
  v_mfma_f32_32x32x16_bf16 v[72:87], v[64:67], v[144:147], v[72:87]
  ds_read_b128 v[188:191], v19 offset:53248
  ds_read_b128 v[196:199], v23 offset:53248
  v_and_b32 v38, 7, v1
  v_xor_b32 v38, v38, v3
  v_cvt_pk_bf16_f32 v185, v185, v70
  v_mfma_f32_32x32x16_bf16 v[120:135], v[136:139], v[144:147], v[120:135]
  buffer_load_dwordx4 v10, s[44:47], s43 offen offset:2048  lds
  v_and_b32 v39, 4, v38
  v_mfma_f32_32x32x16_bf16 v[88:103], v[136:139], v[140:143], v[88:103]
  buffer_load_dwordx4 v11, s[44:47], s43 offen offset:3072  lds
  s_add_u32 s43, s43, 128
  s_and_b32 s43, s43, 0x7ff
  v_lshlrev_b32 v216, 4, v39
  s_waitcnt vmcnt(16) lgkmcnt(0)
  s_barrier
  v_mfma_f32_32x32x16_bf16 v[40:55], v[148:151], v[192:195], v[40:55]
  ds_read_b128 v[64:67], v16 offset:0
  ds_read_b128 v[140:143], v20 offset:0
  v_and_b32 v39, 1, v38
  v_dot2c_f32_bf16 v184, s33, v185
  v_mfma_f32_32x32x16_bf16 v[72:87], v[148:151], v[196:199], v[72:87]
  ds_read_b128 v[136:139], v16 offset:4096
  ds_read_b128 v[144:147], v20 offset:4096
  v_lshl_or_b32 v216, v39, 5, v216
  v_mfma_f32_32x32x16_bf16 v[120:135], v[188:191], v[196:199], v[120:135]
  s_add_u32 m0, s54, 49152
  s_nop 0
  buffer_load_dwordx4 v12, s[48:51], s43 offen offset:0  lds
  v_and_b32 v39, 2, v38
  v_mfma_f32_32x32x16_bf16 v[88:103], v[188:191], v[192:195], v[88:103]
  buffer_load_dwordx4 v13, s[48:51], s43 offen offset:1024  lds
  v_lshl_or_b32 v216, v39, 3, v216
  s_waitcnt lgkmcnt(2)
  v_mfma_f32_32x32x16_bf16 v[40:55], v[64:67], v[140:143], v[40:55]
  ds_read_b128 v[148:151], v17 offset:0
  ds_read_b128 v[192:195], v21 offset:0
  v_lshrrev_b32 v39, 3, v1
  ds_read_u16_d16_hi v185, v69 offset:0
  ds_read_u16_d16_hi v70, v69 offset:2
  s_waitcnt lgkmcnt(4)
  v_mfma_f32_32x32x16_bf16 v[72:87], v[64:67], v[144:147], v[72:87]
  ds_read_b128 v[188:191], v17 offset:4096
  ds_read_b128 v[196:199], v21 offset:4096
  v_lshl_or_b32 v216, v39, 11, v216
  v_mfma_f32_32x32x16_bf16 v[120:135], v[136:139], v[144:147], v[120:135]
  buffer_load_dwordx4 v14, s[48:51], s43 offen offset:2048  lds
  s_lshl4_add_u32 s20, s3, s41
  v_mfma_f32_32x32x16_bf16 v[88:103], v[136:139], v[140:143], v[88:103]
  buffer_load_dwordx4 v15, s[48:51], s43 offen offset:3072  lds
  s_lshl_b32 s20, s20, 15
  s_waitcnt lgkmcnt(4)
  v_mfma_f32_32x32x16_bf16 v[40:55], v[148:151], v[192:195], v[40:55]
  ds_read_b128 v[64:67], v18 offset:0
  ds_read_b128 v[140:143], v22 offset:0
  s_lshr_b32 s29, s41, 3
  s_waitcnt lgkmcnt(2)
  v_mfma_f32_32x32x16_bf16 v[72:87], v[148:151], v[196:199], v[72:87]
  ds_read_b128 v[136:139], v18 offset:4096
  ds_read_b128 v[144:147], v22 offset:4096
  s_lshl_b32 s29, s29, 10
  v_mfma_f32_32x32x16_bf16 v[120:135], v[188:191], v[196:199], v[120:135]
  s_add_u32 m0, s53, 49152
  s_nop 0
  buffer_load_dwordx4 v8, s[44:47], s43 offen offset:0  lds
  s_add_u32 s20, s20, s29
  v_mfma_f32_32x32x16_bf16 v[88:103], v[188:191], v[192:195], v[88:103]
  buffer_load_dwordx4 v9, s[44:47], s43 offen offset:1024  lds
  v_add_u32 v216, s20, v216
  v_mul_f32 v185, v185, v160
  v_mul_f32 v70, v70, v161
  s_waitcnt lgkmcnt(2)
  v_mfma_f32_32x32x16_bf16 v[40:55], v[64:67], v[140:143], v[40:55]
  ds_read_b128 v[148:151], v19 offset:0
  ds_read_b128 v[192:195], v23 offset:0
  v_xor_b32 v218, 262144, v216
  s_waitcnt lgkmcnt(2)
  v_mfma_f32_32x32x16_bf16 v[72:87], v[64:67], v[144:147], v[72:87]
  ds_read_b128 v[188:191], v19 offset:4096
  ds_read_b128 v[196:199], v23 offset:4096
  v_xor_b32 v217, 64, v216
  v_cvt_pk_bf16_f32 v185, v185, v70
  v_mfma_f32_32x32x16_bf16 v[120:135], v[136:139], v[144:147], v[120:135]
  buffer_load_dwordx4 v10, s[44:47], s43 offen offset:2048  lds
  v_xor_b32 v219, 64, v218
  v_mfma_f32_32x32x16_bf16 v[88:103], v[136:139], v[140:143], v[88:103]
  buffer_load_dwordx4 v11, s[44:47], s43 offen offset:3072  lds
  s_add_u32 s43, s43, 128
  s_and_b32 s43, s43, 0x7ff
  v_add_u32 v217, 15360, v217
  s_waitcnt vmcnt(16) lgkmcnt(0)
  s_barrier
  v_mfma_f32_32x32x16_bf16 v[40:55], v[148:151], v[192:195], v[40:55]
  ds_read_b128 v[64:67], v16 offset:16384
  ds_read_b128 v[140:143], v20 offset:16384
  v_add_u32 v219, 15360, v219
  v_dot2c_f32_bf16 v184, s33, v185
  v_mfma_f32_32x32x16_bf16 v[72:87], v[148:151], v[196:199], v[72:87]
  ds_read_b128 v[136:139], v16 offset:20480
  ds_read_b128 v[144:147], v20 offset:20480
  s_cmp_lg_u32 s3, 1
  s_cbranch_scc1 gated_mix__spectral_gfnet__ssm_conv_s5__prompt_kernel_skip15
  s_getpc_b64 s[94:95]
gated_mix__spectral_gfnet__ssm_conv_s5__prompt_kernel_pc14:
  s_lshr_b32 s96, s2, 3
  s_mul_i32 s96, s96, 512
  v_min_u32 v248, 3, v1
  v_lshl_add_u32 v248, v248, 7, s96
  v_min_u32 v248, gated_mix__spectral_gfnet__ssm_conv_s5__prompt_kernel_end-gated_mix__spectral_gfnet__ssm_conv_s5__prompt_kernel_pc14, v248
  v_mov_b32 v249, 0
  v_lshl_add_u64 v[248:249], v[248:249], 0, s[94:95]
  global_load_dword v4, v[248:249], off
gated_mix__spectral_gfnet__ssm_conv_s5__prompt_kernel_skip15:
  s_and_b32 s29, s40, 7
  v_mfma_f32_32x32x16_bf16 v[120:135], v[188:191], v[196:199], v[120:135]
  s_add_u32 m0, s54, 0
  s_nop 0
  buffer_load_dwordx4 v12, s[48:51], s43 offen offset:0  lds
  s_lshl_b32 s29, s29, 7
  v_mfma_f32_32x32x16_bf16 v[88:103], v[188:191], v[192:195], v[88:103]
  buffer_load_dwordx4 v13, s[48:51], s43 offen offset:1024  lds
  s_lshl_b32 s32, s3, 12
  s_waitcnt lgkmcnt(2)
  v_mfma_f32_32x32x16_bf16 v[40:55], v[64:67], v[140:143], v[40:55]
  ds_read_b128 v[148:151], v17 offset:16384
  ds_read_b128 v[192:195], v21 offset:16384
  v_lshrrev_b32 v38, 1, v2
  ds_read_u16_d16_hi v185, v69 offset:16384
  ds_read_u16_d16_hi v70, v69 offset:16386
  s_waitcnt lgkmcnt(4)
  v_mfma_f32_32x32x16_bf16 v[72:87], v[64:67], v[144:147], v[72:87]
  ds_read_b128 v[188:191], v17 offset:20480
  ds_read_b128 v[196:199], v21 offset:20480
  v_xor_b32 v38, v38, v3
  v_mfma_f32_32x32x16_bf16 v[120:135], v[136:139], v[144:147], v[120:135]
  buffer_load_dwordx4 v14, s[48:51], s43 offen offset:2048  lds
  v_lshlrev_b32 v38, 4, v38
  v_mfma_f32_32x32x16_bf16 v[88:103], v[136:139], v[140:143], v[88:103]
  buffer_load_dwordx4 v15, s[48:51], s43 offen offset:3072  lds
  v_lshl_or_b32 v38, v2, 7, v38
  v_add_u32 v220, s32, v38
  s_waitcnt lgkmcnt(4)
  v_mfma_f32_32x32x16_bf16 v[40:55], v[148:151], v[192:195], v[40:55]
  ds_read_b128 v[64:67], v18 offset:16384
  ds_read_b128 v[140:143], v22 offset:16384
  v_xor_b32 v221, 64, v220
  s_waitcnt lgkmcnt(2)
  v_mfma_f32_32x32x16_bf16 v[72:87], v[148:151], v[196:199], v[72:87]
  ds_read_b128 v[136:139], v18 offset:20480
  ds_read_b128 v[144:147], v22 offset:20480
  v_add_u32 v222, 0x10000, v220
  v_mfma_f32_32x32x16_bf16 v[120:135], v[188:191], v[196:199], v[120:135]
  s_add_u32 m0, s53, 0
  s_nop 0
  buffer_load_dwordx4 v8, s[44:47], s43 offen offset:0  lds
  v_add_u32 v223, 0x10000, v221
  v_mfma_f32_32x32x16_bf16 v[88:103], v[188:191], v[192:195], v[88:103]
  buffer_load_dwordx4 v9, s[44:47], s43 offen offset:1024  lds
  s_mov_b32 s20, s6
  v_mul_f32 v185, v185, v162
  v_mul_f32 v70, v70, v163
  s_waitcnt lgkmcnt(2)
  v_mfma_f32_32x32x16_bf16 v[40:55], v[64:67], v[140:143], v[40:55]
  ds_read_b128 v[148:151], v19 offset:16384
  ds_read_b128 v[192:195], v23 offset:16384
  s_mov_b32 s21, s7
  s_waitcnt lgkmcnt(2)
  v_mfma_f32_32x32x16_bf16 v[72:87], v[64:67], v[144:147], v[72:87]
  ds_read_b128 v[188:191], v19 offset:20480
  ds_read_b128 v[196:199], v23 offset:20480
  s_mov_b32 s22, 2101248
  v_cvt_pk_bf16_f32 v185, v185, v70
  v_mfma_f32_32x32x16_bf16 v[120:135], v[136:139], v[144:147], v[120:135]
  buffer_load_dwordx4 v10, s[44:47], s43 offen offset:2048  lds
  s_mov_b32 s23, 0x20000
  v_mfma_f32_32x32x16_bf16 v[88:103], v[136:139], v[140:143], v[88:103]
  buffer_load_dwordx4 v11, s[44:47], s43 offen offset:3072  lds
  s_add_u32 s43, s43, 128
  s_and_b32 s43, s43, 0x7ff
  s_sub_u32 s56, s8, 1024
  s_subb_u32 s57, s9, 0
  s_waitcnt vmcnt(16) lgkmcnt(0)
  s_barrier
  v_mfma_f32_32x32x16_bf16 v[40:55], v[148:151], v[192:195], v[40:55]
  ds_read_b128 v[64:67], v16 offset:32768
  ds_read_b128 v[140:143], v20 offset:32768
  v_dot2c_f32_bf16 v184, s33, v185
  v_mfma_f32_32x32x16_bf16 v[72:87], v[148:151], v[196:199], v[72:87]
  ds_read_b128 v[136:139], v16 offset:36864
  ds_read_b128 v[144:147], v20 offset:36864
  buffer_load_dword v246, v5, s[64:67], 0 offen sc1
  s_mov_b32 s58, 2102272
  v_mfma_f32_32x32x16_bf16 v[120:135], v[188:191], v[196:199], v[120:135]
  s_add_u32 m0, s54, 16384
  s_nop 0
  buffer_load_dwordx4 v12, s[48:51], s43 offen offset:0  lds
  s_mov_b32 s59, 0x20000
  v_mfma_f32_32x32x16_bf16 v[88:103], v[188:191], v[192:195], v[88:103]
  buffer_load_dwordx4 v13, s[48:51], s43 offen offset:1024  lds
  s_lshl_b32 s6, s3, 9
  s_waitcnt lgkmcnt(2)
  v_mfma_f32_32x32x16_bf16 v[40:55], v[64:67], v[140:143], v[40:55]
  ds_read_b128 v[148:151], v17 offset:32768
  ds_read_b128 v[192:195], v21 offset:32768
  s_add_u32 s6, s6, s4
  ds_read_u16_d16_hi v185, v69 offset:32768
  ds_read_u16_d16_hi v70, v69 offset:32770
  s_waitcnt lgkmcnt(4)
  v_mfma_f32_32x32x16_bf16 v[72:87], v[64:67], v[144:147], v[72:87]
  ds_read_b128 v[188:191], v17 offset:36864
  ds_read_b128 v[196:199], v21 offset:36864
  s_lshr_b32 s78, s3, 1
  v_mfma_f32_32x32x16_bf16 v[120:135], v[136:139], v[144:147], v[120:135]
  buffer_load_dwordx4 v14, s[48:51], s43 offen offset:2048  lds
  s_and_b32 s78, s78, s5
  v_mfma_f32_32x32x16_bf16 v[88:103], v[136:139], v[140:143], v[88:103]
  buffer_load_dwordx4 v15, s[48:51], s43 offen offset:3072  lds
  s_mul_i32 s78, s78, 960
  s_waitcnt lgkmcnt(4)
  v_mfma_f32_32x32x16_bf16 v[40:55], v[148:151], v[192:195], v[40:55]
  ds_read_b128 v[64:67], v18 offset:32768
  ds_read_b128 v[140:143], v22 offset:32768
  s_sub_u32 s78, s6, s78
  s_waitcnt lgkmcnt(2)
  v_mfma_f32_32x32x16_bf16 v[72:87], v[148:151], v[196:199], v[72:87]
  ds_read_b128 v[136:139], v18 offset:36864
  ds_read_b128 v[144:147], v22 offset:36864
  s_mul_i32 s6, s78, 1026
  v_mfma_f32_32x32x16_bf16 v[120:135], v[188:191], v[196:199], v[120:135]
  s_add_u32 m0, s53, 16384
  s_nop 0
  buffer_load_dwordx4 v8, s[44:47], s43 offen offset:0  lds
  s_lshl1_add_u32 s6, s55, s6
  v_mfma_f32_32x32x16_bf16 v[88:103], v[188:191], v[192:195], v[88:103]
  buffer_load_dwordx4 v9, s[44:47], s43 offen offset:1024  lds
  s_sub_u32 s7, 2101256, s6
  v_mul_f32 v185, v185, v164
  v_mul_f32 v70, v70, v165
  s_waitcnt lgkmcnt(2)
  v_mfma_f32_32x32x16_bf16 v[40:55], v[64:67], v[140:143], v[40:55]
  ds_read_b128 v[148:151], v19 offset:32768
  ds_read_b128 v[192:195], v23 offset:32768
  s_and_b32 s79, s6, 2
  s_waitcnt lgkmcnt(2)
  v_mfma_f32_32x32x16_bf16 v[72:87], v[64:67], v[144:147], v[72:87]
  ds_read_b128 v[188:191], v19 offset:36864
  ds_read_b128 v[196:199], v23 offset:36864
  s_and_b32 s6, s6, -4
  v_cvt_pk_bf16_f32 v185, v185, v70
  v_mfma_f32_32x32x16_bf16 v[120:135], v[136:139], v[144:147], v[120:135]
  buffer_load_dwordx4 v10, s[44:47], s43 offen offset:2048  lds
  s_and_b32 s7, s7, -4
  v_mfma_f32_32x32x16_bf16 v[88:103], v[136:139], v[140:143], v[88:103]
  buffer_load_dwordx4 v11, s[44:47], s43 offen offset:3072  lds
  s_add_u32 s43, s43, 128
  s_and_b32 s43, s43, 0x7ff
  s_add_u32 s8, s6, 131328
  s_waitcnt vmcnt(17) lgkmcnt(0)
  s_barrier
  v_mfma_f32_32x32x16_bf16 v[40:55], v[148:151], v[192:195], v[40:55]
  ds_read_b128 v[64:67], v16 offset:49152
  ds_read_b128 v[140:143], v20 offset:49152
  s_sub_u32 s9, s7, 131328
  s_add_u32 s72, s6, 262656
  v_dot2c_f32_bf16 v184, s33, v185
  v_mfma_f32_32x32x16_bf16 v[72:87], v[148:151], v[196:199], v[72:87]
  ds_read_b128 v[136:139], v16 offset:53248
  ds_read_b128 v[144:147], v20 offset:53248
  s_sub_u32 s73, s7, 262656
  v_mfma_f32_32x32x16_bf16 v[120:135], v[188:191], v[196:199], v[120:135]
  s_add_u32 m0, s54, 32768
  s_nop 0
  buffer_load_dwordx4 v12, s[48:51], s43 offen offset:0  lds
  s_add_u32 s74, s6, 393984
  v_mfma_f32_32x32x16_bf16 v[88:103], v[188:191], v[192:195], v[88:103]
  buffer_load_dwordx4 v13, s[48:51], s43 offen offset:1024  lds
  s_sub_u32 s75, s7, 393984
  s_waitcnt lgkmcnt(2)
  v_mfma_f32_32x32x16_bf16 v[40:55], v[64:67], v[140:143], v[40:55]
  ds_read_b128 v[148:151], v17 offset:49152
  ds_read_b128 v[192:195], v21 offset:49152
  s_cmp_eq_u32 s78, 0
  s_cselect_b32 s78, 2101248, 0
  s_cselect_b32 s77, s5, 0
  ds_read_u16_d16_hi v185, v69 offset:49152
  ds_read_u16_d16_hi v70, v69 offset:49154
  s_waitcnt lgkmcnt(4)
  v_mfma_f32_32x32x16_bf16 v[72:87], v[64:67], v[144:147], v[72:87]
  ds_read_b128 v[188:191], v17 offset:53248
  ds_read_b128 v[196:199], v21 offset:53248
  v_mfma_f32_32x32x16_bf16 v[120:135], v[136:139], v[144:147], v[120:135]
  buffer_load_dwordx4 v14, s[48:51], s43 offen offset:2048  lds
  v_mfma_f32_32x32x16_bf16 v[88:103], v[136:139], v[140:143], v[88:103]
  buffer_load_dwordx4 v15, s[48:51], s43 offen offset:3072  lds
  s_sub_u32 s7, s7, s78
  s_waitcnt lgkmcnt(4)
  v_mfma_f32_32x32x16_bf16 v[40:55], v[148:151], v[192:195], v[40:55]
  ds_read_b128 v[64:67], v18 offset:49152
  ds_read_b128 v[140:143], v22 offset:49152
  s_lshl_b32 s76, s3, 12
  s_waitcnt lgkmcnt(2)
  v_mfma_f32_32x32x16_bf16 v[72:87], v[148:151], v[196:199], v[72:87]
  ds_read_b128 v[136:139], v18 offset:53248
  ds_read_b128 v[144:147], v22 offset:53248
  s_add_u32 s79, s79, s76
  v_mfma_f32_32x32x16_bf16 v[120:135], v[188:191], v[196:199], v[120:135]
  s_add_u32 m0, s53, 32768
  s_nop 0
  buffer_load_dwordx4 v8, s[44:47], s43 offen offset:0  lds
  v_lshlrev_b32 v61, 4, v1
  v_mfma_f32_32x32x16_bf16 v[88:103], v[188:191], v[192:195], v[88:103]
  buffer_load_dwordx4 v9, s[44:47], s43 offen offset:1024  lds
  v_lshlrev_b32 v38, 9, v3
  v_mul_f32 v185, v185, v166
  v_mul_f32 v70, v70, v167
  s_waitcnt lgkmcnt(2)
  v_mfma_f32_32x32x16_bf16 v[40:55], v[64:67], v[140:143], v[40:55]
  ds_read_b128 v[148:151], v19 offset:49152
  ds_read_b128 v[192:195], v23 offset:49152
  v_lshl_add_u32 v38, v2, 3, v38
  s_waitcnt lgkmcnt(2)
  v_mfma_f32_32x32x16_bf16 v[72:87], v[64:67], v[144:147], v[72:87]
  ds_read_b128 v[188:191], v19 offset:53248
  ds_read_b128 v[196:199], v23 offset:53248
  v_sub_u32 v225, 3704, v38
  v_cvt_pk_bf16_f32 v185, v185, v70
  v_mfma_f32_32x32x16_bf16 v[120:135], v[136:139], v[144:147], v[120:135]
  buffer_load_dwordx4 v10, s[44:47], s43 offen offset:2048  lds
  v_cmp_lt_u32 vcc, 1, v3
  v_mfma_f32_32x32x16_bf16 v[88:103], v[136:139], v[140:143], v[88:103]
  buffer_load_dwordx4 v11, s[44:47], s43 offen offset:3072  lds
  s_add_u32 s43, s43, 128
  s_and_b32 s43, s43, 0x7ff
  v_cndmask_b32 v38, v38, v225, vcc
  s_waitcnt vmcnt(17) lgkmcnt(0)
  s_barrier
  v_mfma_f32_32x32x16_bf16 v[40:55], v[148:151], v[192:195], v[40:55]
  ds_read_b128 v[64:67], v16 offset:0
  ds_read_b128 v[140:143], v20 offset:0
  v_cndmask_b32 v224, 1.0, -1.0, vcc
  v_dot2c_f32_bf16 v184, s33, v185
  v_mfma_f32_32x32x16_bf16 v[72:87], v[148:151], v[196:199], v[72:87]
  ds_read_b128 v[136:139], v16 offset:4096
  ds_read_b128 v[144:147], v20 offset:4096
  v_add_u32 v38, s79, v38
  v_mfma_f32_32x32x16_bf16 v[120:135], v[188:191], v[196:199], v[120:135]
  s_add_u32 m0, s54, 49152
  s_nop 0
  buffer_load_dwordx4 v12, s[48:51], s43 offen offset:0  lds
  v_mov_b32 v39, 1050624
  v_mfma_f32_32x32x16_bf16 v[88:103], v[188:191], v[192:195], v[88:103]
  buffer_load_dwordx4 v13, s[48:51], s43 offen offset:1024  lds
  v_mov_b32 v68, 147456
  s_waitcnt lgkmcnt(2)
  v_mfma_f32_32x32x16_bf16 v[40:55], v[64:67], v[140:143], v[40:55]
  ds_read_b128 v[148:151], v17 offset:0
  ds_read_b128 v[192:195], v21 offset:0
  s_cmp_lg_u32 s55, 0
  s_cbranch_scc1 gated_mix__spectral_gfnet__ssm_conv_s5__prompt_kernel_skip13
  s_sub_u32 s78, s7, 8
  v_writelane_b32 v39, s78, 0
  v_writelane_b32 v39, s6, 1
  s_mov_b32 s78, 0
  v_writelane_b32 v68, s78, 0
  v_writelane_b32 v68, s78, 1
  s_sub_u32 s78, s9, 8
  v_writelane_b32 v39, s78, 2
  v_writelane_b32 v39, s8, 3
  s_mov_b32 s78, 16384
  v_writelane_b32 v68, s78, 2
  v_writelane_b32 v68, s78, 3
  s_sub_u32 s78, s73, 8
  v_writelane_b32 v39, s78, 4
  v_writelane_b32 v39, s72, 5
  s_mov_b32 s78, 81920
  v_writelane_b32 v68, s78, 4
  v_writelane_b32 v68, s78, 5
  s_sub_u32 s78, s75, 8
  v_writelane_b32 v39, s78, 6
  v_writelane_b32 v39, s74, 7
  s_mov_b32 s78, 32768
  v_writelane_b32 v68, s78, 6
  v_writelane_b32 v68, s78, 7
  v_and_b32 v225, 1, v1
  v_lshl_add_u32 v39, v225, 10, v39
  s_and_b32 s78, s79, 2
  v_add_u32 v39, s78, v39
  v_mul_u32_u24 v225, 3064, v225
  v_add3_u32 v68, v68, v225, s79
gated_mix__spectral_gfnet__ssm_conv_s5__prompt_kernel_skip13:
  ds_read_u16_d16_hi v185, v69 offset:0
  ds_read_u16_d16_hi v70, v69 offset:2
  s_waitcnt lgkmcnt(4)
  v_mfma_f32_32x32x16_bf16 v[72:87], v[64:67], v[144:147], v[72:87]
  ds_read_b128 v[188:191], v17 offset:4096
  ds_read_b128 v[196:199], v21 offset:4096
  v_mfma_f32_32x32x16_bf16 v[120:135], v[136:139], v[144:147], v[120:135]
  buffer_load_dwordx4 v14, s[48:51], s43 offen offset:2048  lds
  v_mfma_f32_32x32x16_bf16 v[88:103], v[136:139], v[140:143], v[88:103]
  buffer_load_dwordx4 v15, s[48:51], s43 offen offset:3072  lds
  s_waitcnt lgkmcnt(4)
  v_mfma_f32_32x32x16_bf16 v[40:55], v[148:151], v[192:195], v[40:55]
  ds_read_b128 v[64:67], v18 offset:0
  ds_read_b128 v[140:143], v22 offset:0
  s_waitcnt lgkmcnt(2)
  v_mfma_f32_32x32x16_bf16 v[72:87], v[148:151], v[196:199], v[72:87]
  ds_read_b128 v[136:139], v18 offset:4096
  ds_read_b128 v[144:147], v22 offset:4096
  v_mfma_f32_32x32x16_bf16 v[120:135], v[188:191], v[196:199], v[120:135]
  s_add_u32 m0, s53, 49152
  s_nop 0
  buffer_load_dwordx4 v8, s[44:47], s43 offen offset:0  lds
  v_mfma_f32_32x32x16_bf16 v[88:103], v[188:191], v[192:195], v[88:103]
  buffer_load_dwordx4 v9, s[44:47], s43 offen offset:1024  lds
  v_mul_f32 v185, v185, v168
  v_mul_f32 v70, v70, v169
  s_waitcnt lgkmcnt(2)
  v_mfma_f32_32x32x16_bf16 v[40:55], v[64:67], v[140:143], v[40:55]
  ds_read_b128 v[148:151], v19 offset:0
  ds_read_b128 v[192:195], v23 offset:0
  s_waitcnt lgkmcnt(2)
  v_mfma_f32_32x32x16_bf16 v[72:87], v[64:67], v[144:147], v[72:87]
  ds_read_b128 v[188:191], v19 offset:4096
  ds_read_b128 v[196:199], v23 offset:4096
  v_cvt_pk_bf16_f32 v185, v185, v70
  v_mfma_f32_32x32x16_bf16 v[120:135], v[136:139], v[144:147], v[120:135]
  buffer_load_dwordx4 v10, s[44:47], s43 offen offset:2048  lds
  v_mfma_f32_32x32x16_bf16 v[88:103], v[136:139], v[140:143], v[88:103]
  buffer_load_dwordx4 v11, s[44:47], s43 offen offset:3072  lds
  s_add_u32 s43, s43, 128
  s_and_b32 s43, s43, 0x7ff
  s_waitcnt vmcnt(16) lgkmcnt(0)
  s_barrier
  v_mfma_f32_32x32x16_bf16 v[40:55], v[148:151], v[192:195], v[40:55]
  ds_read_b128 v[64:67], v16 offset:16384
  ds_read_b128 v[140:143], v20 offset:16384
  v_dot2c_f32_bf16 v184, s33, v185
  v_mfma_f32_32x32x16_bf16 v[72:87], v[148:151], v[196:199], v[72:87]
  ds_read_b128 v[136:139], v16 offset:20480
  ds_read_b128 v[144:147], v20 offset:20480
  v_cmp_ne_u32 vcc, 1, v246
  s_nop 0
  s_cbranch_vccz gated_mix__spectral_gfnet__ssm_conv_s5__prompt_kernel_skip16
  s_mov_b32 s94, 0
gated_mix__spectral_gfnet__ssm_conv_s5__prompt_kernel_poll17:
  s_sleep 16
  buffer_load_dword v246, v5, s[64:67], 0 offen sc1
  s_waitcnt vmcnt(0)
  v_cmp_ne_u32 vcc, 1, v246
  s_nop 0
  s_cbranch_vccz gated_mix__spectral_gfnet__ssm_conv_s5__prompt_kernel_pollout18
  s_add_u32 s94, s94, 1
  s_cmp_lt_u32 s94, 1048576
  s_cbranch_scc1 gated_mix__spectral_gfnet__ssm_conv_s5__prompt_kernel_poll17
gated_mix__spectral_gfnet__ssm_conv_s5__prompt_kernel_pollout18:
gated_mix__spectral_gfnet__ssm_conv_s5__prompt_kernel_skip16:
  s_cmp_lg_u32 s3, 0
  s_cbranch_scc1 gated_mix__spectral_gfnet__ssm_conv_s5__prompt_kernel_skip19
  s_mov_b64 exec, 1
  buffer_store_dword v7, v56, s[16:19], 0 offen sc1
  s_mov_b64 exec, -1
gated_mix__spectral_gfnet__ssm_conv_s5__prompt_kernel_skip19:
  v_mfma_f32_32x32x16_bf16 v[120:135], v[188:191], v[196:199], v[120:135]
  s_add_u32 m0, s54, 0
  s_nop 0
  buffer_load_dwordx4 v12, s[48:51], s43 offen offset:0  lds
  v_mfma_f32_32x32x16_bf16 v[88:103], v[188:191], v[192:195], v[88:103]
  buffer_load_dwordx4 v13, s[48:51], s43 offen offset:1024  lds
  s_waitcnt lgkmcnt(2)
  v_mfma_f32_32x32x16_bf16 v[40:55], v[64:67], v[140:143], v[40:55]
  ds_read_b128 v[148:151], v17 offset:16384
  ds_read_b128 v[192:195], v21 offset:16384
  ds_read_u16_d16_hi v185, v69 offset:16384
  ds_read_u16_d16_hi v70, v69 offset:16386
  s_waitcnt lgkmcnt(4)
  v_mfma_f32_32x32x16_bf16 v[72:87], v[64:67], v[144:147], v[72:87]
  ds_read_b128 v[188:191], v17 offset:20480
  ds_read_b128 v[196:199], v21 offset:20480
  v_mfma_f32_32x32x16_bf16 v[120:135], v[136:139], v[144:147], v[120:135]
  buffer_load_dwordx4 v14, s[48:51], s43 offen offset:2048  lds
  v_mfma_f32_32x32x16_bf16 v[88:103], v[136:139], v[140:143], v[88:103]
  buffer_load_dwordx4 v15, s[48:51], s43 offen offset:3072  lds
  s_waitcnt lgkmcnt(4)
  v_mfma_f32_32x32x16_bf16 v[40:55], v[148:151], v[192:195], v[40:55]
  ds_read_b128 v[64:67], v18 offset:16384
  ds_read_b128 v[140:143], v22 offset:16384
  s_waitcnt lgkmcnt(2)
  v_mfma_f32_32x32x16_bf16 v[72:87], v[148:151], v[196:199], v[72:87]
  ds_read_b128 v[136:139], v18 offset:20480
  ds_read_b128 v[144:147], v22 offset:20480
  v_mfma_f32_32x32x16_bf16 v[120:135], v[188:191], v[196:199], v[120:135]
  s_add_u32 m0, s53, 0
  s_nop 0
  buffer_load_dwordx4 v8, s[44:47], s43 offen offset:0  lds
  v_mfma_f32_32x32x16_bf16 v[88:103], v[188:191], v[192:195], v[88:103]
  buffer_load_dwordx4 v9, s[44:47], s43 offen offset:1024  lds
  v_mul_f32 v185, v185, v170
  v_mul_f32 v70, v70, v171
  s_waitcnt lgkmcnt(2)
  v_mfma_f32_32x32x16_bf16 v[40:55], v[64:67], v[140:143], v[40:55]
  ds_read_b128 v[148:151], v19 offset:16384
  ds_read_b128 v[192:195], v23 offset:16384
  s_waitcnt lgkmcnt(2)
  v_mfma_f32_32x32x16_bf16 v[72:87], v[64:67], v[144:147], v[72:87]
  ds_read_b128 v[188:191], v19 offset:20480
  ds_read_b128 v[196:199], v23 offset:20480
  v_cvt_pk_bf16_f32 v185, v185, v70
  v_mfma_f32_32x32x16_bf16 v[120:135], v[136:139], v[144:147], v[120:135]
  buffer_load_dwordx4 v10, s[44:47], s43 offen offset:2048  lds
  v_mfma_f32_32x32x16_bf16 v[88:103], v[136:139], v[140:143], v[88:103]
  buffer_load_dwordx4 v11, s[44:47], s43 offen offset:3072  lds
  s_add_u32 s43, s43, 128
  s_and_b32 s43, s43, 0x7ff
  s_waitcnt vmcnt(16) lgkmcnt(0)
  s_barrier
  v_mfma_f32_32x32x16_bf16 v[40:55], v[148:151], v[192:195], v[40:55]
  ds_read_b128 v[64:67], v16 offset:32768
  ds_read_b128 v[140:143], v20 offset:32768
  v_dot2c_f32_bf16 v184, s33, v185
  v_mfma_f32_32x32x16_bf16 v[72:87], v[148:151], v[196:199], v[72:87]
  ds_read_b128 v[136:139], v16 offset:36864
  ds_read_b128 v[144:147], v20 offset:36864
  v_mfma_f32_32x32x16_bf16 v[120:135], v[188:191], v[196:199], v[120:135]
  s_add_u32 m0, s54, 16384
  s_nop 0
  buffer_load_dwordx4 v12, s[48:51], s43 offen offset:0  lds
  v_mfma_f32_32x32x16_bf16 v[88:103], v[188:191], v[192:195], v[88:103]
  buffer_load_dwordx4 v13, s[48:51], s43 offen offset:1024  lds
  s_waitcnt lgkmcnt(2)
  v_mfma_f32_32x32x16_bf16 v[40:55], v[64:67], v[140:143], v[40:55]
  ds_read_b128 v[148:151], v17 offset:32768
  ds_read_b128 v[192:195], v21 offset:32768
  v_lshlrev_b32 v58, 16, v58
  v_lshlrev_b32 v59, 16, v59
  ds_read_u16_d16_hi v185, v69 offset:32768
  ds_read_u16_d16_hi v70, v69 offset:32770
  s_waitcnt lgkmcnt(4)
  v_mfma_f32_32x32x16_bf16 v[72:87], v[64:67], v[144:147], v[72:87]
  ds_read_b128 v[188:191], v17 offset:36864
  ds_read_b128 v[196:199], v21 offset:36864
  v_lshlrev_b32 v60, 16, v60
  v_mul_f32 v60, 0x3fb8aa3b, v60
  v_mfma_f32_32x32x16_bf16 v[120:135], v[136:139], v[144:147], v[120:135]
  buffer_load_dwordx4 v14, s[48:51], s43 offen offset:2048  lds
  v_exp_f32 v60, v60
  s_nop 0
  v_cvt_pk_bf16_f32 v60, v60, v60
  v_mfma_f32_32x32x16_bf16 v[88:103], v[136:139], v[140:143], v[88:103]
  buffer_load_dwordx4 v15, s[48:51], s43 offen offset:3072  lds
  v_and_b32 v60, 0xffff0000, v60
  v_mul_f32 v240, v60, v58
  s_waitcnt lgkmcnt(4)
  v_mfma_f32_32x32x16_bf16 v[40:55], v[148:151], v[192:195], v[40:55]
  ds_read_b128 v[64:67], v18 offset:32768
  ds_read_b128 v[140:143], v22 offset:32768
  v_mul_f32 v241, v60, v59
  s_waitcnt lgkmcnt(2)
  v_mfma_f32_32x32x16_bf16 v[72:87], v[148:151], v[196:199], v[72:87]
  ds_read_b128 v[136:139], v18 offset:36864
  ds_read_b128 v[144:147], v22 offset:36864
  v_mul_f32 v240, 0x3fb8aa3b, v240
  v_mul_f32 v241, 0.15915494, v241
  v_mfma_f32_32x32x16_bf16 v[120:135], v[188:191], v[196:199], v[120:135]
  s_add_u32 m0, s53, 16384
  s_nop 0
  buffer_load_dwordx4 v8, s[44:47], s43 offen offset:0  lds
  v_exp_f32 v240, v240
  v_rndne_f32 v242, v241
  v_mfma_f32_32x32x16_bf16 v[88:103], v[188:191], v[192:195], v[88:103]
  buffer_load_dwordx4 v9, s[44:47], s43 offen offset:1024  lds
  v_sub_f32 v241, v241, v242
  v_cos_f32 v242, v241
  v_mul_f32 v185, v185, v172
  v_mul_f32 v70, v70, v173
  s_waitcnt lgkmcnt(2)
  v_mfma_f32_32x32x16_bf16 v[40:55], v[64:67], v[140:143], v[40:55]
  ds_read_b128 v[148:151], v19 offset:32768
  ds_read_b128 v[192:195], v23 offset:32768
  v_sin_f32 v243, v241
  v_mul_f32 v226, v240, v242
  s_waitcnt lgkmcnt(2)
  v_mfma_f32_32x32x16_bf16 v[72:87], v[64:67], v[144:147], v[72:87]
  ds_read_b128 v[188:191], v19 offset:36864
  ds_read_b128 v[196:199], v23 offset:36864
  v_mul_f32 v227, v240, v243
  v_cvt_pk_bf16_f32 v185, v185, v70
  v_mfma_f32_32x32x16_bf16 v[120:135], v[136:139], v[144:147], v[120:135]
  buffer_load_dwordx4 v10, s[44:47], s43 offen offset:2048  lds
  v_mul_f32 v240, v58, v58
  v_fma_f32 v240, v59, v59, v240
  v_mfma_f32_32x32x16_bf16 v[88:103], v[136:139], v[140:143], v[88:103]
  buffer_load_dwordx4 v11, s[44:47], s43 offen offset:3072  lds
  s_add_u32 s43, s43, 128
  s_and_b32 s43, s43, 0x7ff
  v_rcp_f32 v240, v240
  v_add_f32 v241, -1.0, v226
  s_waitcnt vmcnt(16) lgkmcnt(0)
  s_barrier
  v_mfma_f32_32x32x16_bf16 v[40:55], v[148:151], v[192:195], v[40:55]
  ds_read_b128 v[64:67], v16 offset:49152
  ds_read_b128 v[140:143], v20 offset:49152
  v_add_f32 v240, v240, v240
  v_mul_f32 v242, v241, v58
  v_dot2c_f32_bf16 v184, s33, v185
  v_mfma_f32_32x32x16_bf16 v[72:87], v[148:151], v[196:199], v[72:87]
  ds_read_b128 v[136:139], v16 offset:53248
  ds_read_b128 v[144:147], v20 offset:53248
  s_lshl_b32 s94, s36, 2
  s_add_u32 s94, s94, s3
  s_lshl_b32 s94, s94, 7
  s_add_u32 s94, s94, s37
  s_sub_u32 s95, 2048, s94
  s_and_b32 s95, s95, 2047
  s_mul_i32 s94, s94, 1026
  s_mul_i32 s95, s95, 1026
  s_sub_u32 s95, s95, s94
  v_and_b32 v248, 1, v3
  v_mul_lo_u32 v248, v248, s95
  v_lshl_add_u32 v246, v2, 7, s94
  v_add_u32 v246, v246, v248
  v_and_b32 v246, -4, v246
  s_mov_b64 exec, 0x01ff01ff
  buffer_load_dword v4, v246, s[20:23], 0 offen
  buffer_load_dword v4, v246, s[56:59], 0 offen offset:1024
  s_mov_b64 exec, -1
  v_fma_f32 v242, v227, v59, v242
  v_mul_f32 v243, v227, v58
  v_mfma_f32_32x32x16_bf16 v[120:135], v[188:191], v[196:199], v[120:135]
  s_add_u32 m0, s54, 32768
  s_nop 0
  buffer_load_dwordx4 v12, s[48:51], s43 offen offset:0  lds
  v_fma_f32 v243, -v241, v59, v243
  v_mfma_f32_32x32x16_bf16 v[88:103], v[188:191], v[192:195], v[88:103]
  buffer_load_dwordx4 v13, s[48:51], s43 offen offset:1024  lds
  v_mul_f32 v236, v242, v240
  v_mul_f32 v237, v243, v240
  s_waitcnt lgkmcnt(2)
  v_mfma_f32_32x32x16_bf16 v[40:55], v[64:67], v[140:143], v[40:55]
  ds_read_b128 v[148:151], v17 offset:49152
  ds_read_b128 v[192:195], v21 offset:49152
  v_mul_f32 v240, v227, v227
  v_mul_f32 v229, v226, v227
  ds_read_u16_d16_hi v185, v69 offset:49152
  ds_read_u16_d16_hi v70, v69 offset:49154
  s_waitcnt lgkmcnt(4)
  v_mfma_f32_32x32x16_bf16 v[72:87], v[64:67], v[144:147], v[72:87]
  ds_read_b128 v[188:191], v17 offset:53248
  ds_read_b128 v[196:199], v21 offset:53248
  v_fma_f32 v228, v226, v226, -v240
  v_add_f32 v229, v229, v229
  v_mfma_f32_32x32x16_bf16 v[120:135], v[136:139], v[144:147], v[120:135]
  buffer_load_dwordx4 v14, s[48:51], s43 offen offset:2048  lds
  v_mul_f32 v240, v229, v229
  v_mfma_f32_32x32x16_bf16 v[88:103], v[136:139], v[140:143], v[88:103]
  buffer_load_dwordx4 v15, s[48:51], s43 offen offset:3072  lds
  v_mul_f32 v229, v228, v229
  v_fma_f32 v228, v228, v228, -v240
  s_waitcnt lgkmcnt(4)
  v_mfma_f32_32x32x16_bf16 v[40:55], v[148:151], v[192:195], v[40:55]
  ds_read_b128 v[64:67], v18 offset:49152
  ds_read_b128 v[140:143], v22 offset:49152
  v_add_f32 v229, v229, v229
  v_mul_f32 v240, v229, v229
  s_waitcnt lgkmcnt(2)
  v_mfma_f32_32x32x16_bf16 v[72:87], v[148:151], v[196:199], v[72:87]
  ds_read_b128 v[136:139], v18 offset:53248
  ds_read_b128 v[144:147], v22 offset:53248
  v_mul_f32 v229, v228, v229
  v_fma_f32 v228, v228, v228, -v240
  v_mfma_f32_32x32x16_bf16 v[120:135], v[188:191], v[196:199], v[120:135]
  s_add_u32 m0, s53, 32768
  s_nop 0
  buffer_load_dwordx4 v8, s[44:47], s43 offen offset:0  lds
  v_add_f32 v229, v229, v229
  v_mul_f32 v240, v229, v229
  v_mfma_f32_32x32x16_bf16 v[88:103], v[188:191], v[192:195], v[88:103]
  buffer_load_dwordx4 v9, s[44:47], s43 offen offset:1024  lds
  v_mul_f32 v229, v228, v229
  v_mul_f32 v185, v185, v174
  v_mul_f32 v70, v70, v175
  s_waitcnt lgkmcnt(2)
  v_mfma_f32_32x32x16_bf16 v[40:55], v[64:67], v[140:143], v[40:55]
  ds_read_b128 v[148:151], v19 offset:49152
  ds_read_b128 v[192:195], v23 offset:49152
  v_fma_f32 v228, v228, v228, -v240
  v_add_f32 v229, v229, v229
  s_waitcnt lgkmcnt(2)
  v_mfma_f32_32x32x16_bf16 v[72:87], v[64:67], v[144:147], v[72:87]
  ds_read_b128 v[188:191], v19 offset:53248
  ds_read_b128 v[196:199], v23 offset:53248
  v_mul_f32 v240, v229, v229
  v_mul_f32 v231, v228, v229
  v_cvt_pk_bf16_f32 v185, v185, v70
  v_mfma_f32_32x32x16_bf16 v[120:135], v[136:139], v[144:147], v[120:135]
  buffer_load_dwordx4 v10, s[44:47], s43 offen offset:2048  lds
  v_fma_f32 v230, v228, v228, -v240
  v_add_f32 v231, v231, v231
  v_mfma_f32_32x32x16_bf16 v[88:103], v[136:139], v[140:143], v[88:103]
  buffer_load_dwordx4 v11, s[44:47], s43 offen offset:3072  lds
  s_add_u32 s43, s43, 128
  s_and_b32 s43, s43, 0x7ff
  v_mul_f32 v240, v231, v231
  v_mul_f32 v233, v230, v231
  s_waitcnt vmcnt(18) lgkmcnt(0)
  s_barrier
  v_mfma_f32_32x32x16_bf16 v[40:55], v[148:151], v[192:195], v[40:55]
  ds_read_b128 v[64:67], v16 offset:0
  ds_read_b128 v[140:143], v20 offset:0
  v_fma_f32 v232, v230, v230, -v240
  v_dot2c_f32_bf16 v184, s33, v185
  v_mfma_f32_32x32x16_bf16 v[72:87], v[148:151], v[196:199], v[72:87]
  ds_read_b128 v[136:139], v16 offset:4096
  ds_read_b128 v[144:147], v20 offset:4096
  s_cmp_lg_u32 s3, 2
  s_cbranch_scc1 gated_mix__spectral_gfnet__ssm_conv_s5__prompt_kernel_skip21
  s_getpc_b64 s[94:95]
gated_mix__spectral_gfnet__ssm_conv_s5__prompt_kernel_pc20:
  s_lshr_b32 s96, s2, 3
  s_mul_i32 s96, s96, 512
  v_min_u32 v248, 3, v1
  v_lshl_add_u32 v248, v248, 7, s96
  v_min_u32 v248, gated_mix__spectral_gfnet__ssm_conv_s5__prompt_kernel_end-gated_mix__spectral_gfnet__ssm_conv_s5__prompt_kernel_pc20, v248
  v_mov_b32 v249, 0
  v_lshl_add_u64 v[248:249], v[248:249], 0, s[94:95]
  global_load_dword v4, v[248:249], off
gated_mix__spectral_gfnet__ssm_conv_s5__prompt_kernel_skip21:
  v_add_f32 v233, v233, v233
  v_mul_f32 v240, v233, v233
  v_mfma_f32_32x32x16_bf16 v[120:135], v[188:191], v[196:199], v[120:135]
  s_add_u32 m0, s54, 49152
  s_nop 0
  buffer_load_dwordx4 v12, s[48:51], s43 offen offset:0  lds
  v_mul_f32 v239, v232, v233
  v_fma_f32 v238, v232, v232, -v240
  v_mfma_f32_32x32x16_bf16 v[88:103], v[188:191], v[192:195], v[88:103]
  buffer_load_dwordx4 v13, s[48:51], s43 offen offset:1024  lds
  v_add_f32 v239, v239, v239
  v_mul_f32 v240, v239, v239
  s_waitcnt lgkmcnt(2)
  v_mfma_f32_32x32x16_bf16 v[40:55], v[64:67], v[140:143], v[40:55]
  ds_read_b128 v[148:151], v17 offset:0
  ds_read_b128 v[192:195], v21 offset:0
  v_mul_f32 v235, v238, v239
  ds_read_u16_d16_hi v185, v69 offset:0
  ds_read_u16_d16_hi v70, v69 offset:2
  s_waitcnt lgkmcnt(4)
  v_mfma_f32_32x32x16_bf16 v[72:87], v[64:67], v[144:147], v[72:87]
  ds_read_b128 v[188:191], v17 offset:4096
  ds_read_b128 v[196:199], v21 offset:4096
  v_fma_f32 v234, v238, v238, -v240
  v_add_f32 v235, v235, v235
  v_mfma_f32_32x32x16_bf16 v[120:135], v[136:139], v[144:147], v[120:135]
  buffer_load_dwordx4 v14, s[48:51], s43 offen offset:2048  lds
  v_mul_f32 v240, v235, v235
  v_mul_f32 v235, v234, v235
  v_mfma_f32_32x32x16_bf16 v[88:103], v[136:139], v[140:143], v[88:103]
  buffer_load_dwordx4 v15, s[48:51], s43 offen offset:3072  lds
  v_fma_f32 v234, v234, v234, -v240
  v_add_f32 v235, v235, v235
  s_waitcnt lgkmcnt(4)
  v_mfma_f32_32x32x16_bf16 v[40:55], v[148:151], v[192:195], v[40:55]
  ds_read_b128 v[64:67], v18 offset:0
  ds_read_b128 v[140:143], v22 offset:0
  v_mul_f32 v240, v235, v235
  v_mul_f32 v235, v234, v235
  s_waitcnt lgkmcnt(2)
  v_mfma_f32_32x32x16_bf16 v[72:87], v[148:151], v[196:199], v[72:87]
  ds_read_b128 v[136:139], v18 offset:4096
  ds_read_b128 v[144:147], v22 offset:4096
  v_fma_f32 v234, v234, v234, -v240
  v_mfma_f32_32x32x16_bf16 v[120:135], v[188:191], v[196:199], v[120:135]
  s_add_u32 m0, s53, 49152
  s_nop 0
  buffer_load_dwordx4 v8, s[44:47], s43 offen offset:0  lds
  v_add_f32 v235, v235, v235
  v_and_b32 v58, 1, v2
  v_mfma_f32_32x32x16_bf16 v[88:103], v[188:191], v[192:195], v[88:103]
  buffer_load_dwordx4 v9, s[44:47], s43 offen offset:1024  lds
  v_lshlrev_b32 v58, 4, v58
  v_xor_b32 v58, 16, v58
  v_mul_f32 v185, v185, v176
  v_mul_f32 v70, v70, v177
  s_waitcnt lgkmcnt(2)
  v_mfma_f32_32x32x16_bf16 v[40:55], v[64:67], v[140:143], v[40:55]
  ds_read_b128 v[148:151], v19 offset:0
  ds_read_b128 v[192:195], v23 offset:0
  v_lshrrev_b32 v58, v58, v62
  v_lshrrev_b32 v59, 1, v2
  s_waitcnt lgkmcnt(2)
  v_mfma_f32_32x32x16_bf16 v[72:87], v[64:67], v[144:147], v[72:87]
  ds_read_b128 v[188:191], v19 offset:4096
  ds_read_b128 v[196:199], v23 offset:4096
  v_lshlrev_b32 v63, 1, v3
  v_sub_u32 v59, v59, v63
  v_cvt_pk_bf16_f32 v185, v185, v70
  v_mfma_f32_32x32x16_bf16 v[120:135], v[136:139], v[144:147], v[120:135]
  buffer_load_dwordx4 v10, s[44:47], s43 offen offset:2048  lds
  v_cmp_eq_u32 vcc, 0, v59
  v_mfma_f32_32x32x16_bf16 v[88:103], v[136:139], v[140:143], v[88:103]
  buffer_load_dwordx4 v11, s[44:47], s43 offen offset:3072  lds
  s_add_u32 s43, s43, 128
  s_and_b32 s43, s43, 0x7ff
  v_cndmask_b32 v62, 0, v58, vcc
  v_cmp_eq_u32 vcc, 1, v59
  s_waitcnt vmcnt(18) lgkmcnt(0)
  s_barrier
  v_mfma_f32_32x32x16_bf16 v[40:55], v[148:151], v[192:195], v[40:55]
  ds_read_b128 v[64:67], v16 offset:16384
  ds_read_b128 v[140:143], v20 offset:16384
  v_cndmask_b32 v63, 0, v58, vcc
  v_lshlrev_b32 v60, 3, v0
  v_dot2c_f32_bf16 v184, s33, v185
  v_mfma_f32_32x32x16_bf16 v[72:87], v[148:151], v[196:199], v[72:87]
  ds_read_b128 v[136:139], v16 offset:20480
  ds_read_b128 v[144:147], v20 offset:20480
  v_add_u32 v60, 151552, v60
  s_sub_u32 s78, 15, s38
  v_mfma_f32_32x32x16_bf16 v[120:135], v[188:191], v[196:199], v[120:135]
  buffer_load_dword v247, v6, s[16:19], 0 offen sc1
  s_cmp_eq_u32 s77, 0
  s_cbranch_scc1 gated_mix__spectral_gfnet__ssm_conv_s5__prompt_kernel_skip22
  s_add_u32 s94, s6, 1050624
  s_mov_b32 m0, 147456
  s_nop 0
  buffer_load_dwordx4 v61, s[20:23], s94 offen lds
  buffer_load_dwordx4 v61, s[56:59], s94 offen offset:1024 lds
  s_add_u32 s94, s7, 1050624
  s_mov_b32 m0, 149504
  s_nop 0
  buffer_load_dwordx4 v61, s[20:23], s94 offen lds
  buffer_load_dwordx4 v61, s[56:59], s94 offen offset:1024 lds
gated_mix__spectral_gfnet__ssm_conv_s5__prompt_kernel_skip22:
  s_cmp_lg_u32 s55, 0
  s_cbranch_scc1 gated_mix__spectral_gfnet__ssm_conv_s5__prompt_kernel_skip23
  s_mov_b64 exec, 0x3ff
  buffer_load_short_d16_hi v248, v39, s[20:23], 0 offen
  buffer_load_short_d16_hi v249, v39, s[56:59], 0 offen offset:1024
  s_mov_b64 exec, -1
gated_mix__spectral_gfnet__ssm_conv_s5__prompt_kernel_skip23:
  s_lshl_b32 s78, s78, 9
  s_and_b32 s79, s3, 1
  v_mfma_f32_32x32x16_bf16 v[88:103], v[188:191], v[192:195], v[88:103]
  s_add_u32 m0, s32, 131072
  s_nop 0
  buffer_load_dwordx4 v216, s[12:15], s29 offen offset:0 lds
  s_lshl_b32 s79, s79, 8
  s_waitcnt lgkmcnt(2)
  v_mfma_f32_32x32x16_bf16 v[40:55], v[64:67], v[140:143], v[40:55]
  ds_read_b128 v[148:151], v17 offset:16384
  ds_read_b128 v[192:195], v21 offset:16384
  s_add_u32 s78, s78, s79
  v_and_b32 v71, 31, v1
  ds_read_u16_d16_hi v185, v69 offset:16384
  ds_read_u16_d16_hi v70, v69 offset:16386
  s_waitcnt lgkmcnt(4)
  v_mfma_f32_32x32x16_bf16 v[72:87], v[64:67], v[144:147], v[72:87]
  ds_read_b128 v[188:191], v17 offset:20480
  ds_read_b128 v[196:199], v21 offset:20480
  v_lshl_add_u32 v71, v71, 3, s78
  s_lshl_b32 s79, s38, 1
  v_mfma_f32_32x32x16_bf16 v[120:135], v[136:139], v[144:147], v[120:135]
  buffer_load_dwordx4 v217, s[12:15], s29 offen offset:1024 lds
  s_lshr_b32 s80, s3, 1
  s_add_u32 s79, s79, s80
  v_mfma_f32_32x32x16_bf16 v[88:103], v[136:139], v[140:143], v[88:103]
  s_add_u32 m0, s32, 133120
  s_nop 0
  buffer_load_dwordx4 v218, s[12:15], s29 offen offset:0 lds
  s_lshl_b32 s78, s79, 9
  s_waitcnt lgkmcnt(4)
  v_mfma_f32_32x32x16_bf16 v[40:55], v[148:151], v[192:195], v[40:55]
  ds_read_b128 v[64:67], v18 offset:16384
  ds_read_b128 v[140:143], v22 offset:16384
  s_and_b32 s79, s79, 3
  s_lshl_b32 s79, s79, 2
  s_waitcnt lgkmcnt(2)
  v_mfma_f32_32x32x16_bf16 v[72:87], v[148:151], v[196:199], v[72:87]
  ds_read_b128 v[136:139], v18 offset:20480
  ds_read_b128 v[144:147], v22 offset:20480
  v_xor_b32 v58, s79, v2
  v_lshlrev_b32 v58, 4, v58
  v_mfma_f32_32x32x16_bf16 v[120:135], v[188:191], v[196:199], v[120:135]
  buffer_load_dwordx4 v219, s[12:15], s29 offen offset:1024 lds
  v_lshrrev_b32 v59, 1, v3
  v_lshl_or_b32 v58, v59, 14, v58
  v_mfma_f32_32x32x16_bf16 v[88:103], v[188:191], v[192:195], v[88:103]
  s_add_u32 m0, s32, 65536
  s_nop 0
  buffer_load_dwordx4 v216, s[24:27], s29 offen offset:0 lds
  v_and_b32 v59, 1, v3
  v_lshl_or_b32 v58, v59, 19, v58
  v_mul_f32 v185, v185, v178
  v_mul_f32 v70, v70, v179
  s_waitcnt lgkmcnt(2)
  v_mfma_f32_32x32x16_bf16 v[40:55], v[64:67], v[140:143], v[40:55]
  ds_read_b128 v[148:151], v19 offset:16384
  ds_read_b128 v[192:195], v23 offset:16384
  s_and_b32 s80, s3, 1
  s_waitcnt lgkmcnt(2)
  v_mfma_f32_32x32x16_bf16 v[72:87], v[64:67], v[144:147], v[72:87]
  ds_read_b128 v[188:191], v19 offset:20480
  ds_read_b128 v[196:199], v23 offset:20480
  s_lshl_b32 s80, s80, 8
  s_add_u32 s78, s78, s80
  v_cvt_pk_bf16_f32 v185, v185, v70
  v_mfma_f32_32x32x16_bf16 v[120:135], v[136:139], v[144:147], v[120:135]
  buffer_load_dwordx4 v217, s[24:27], s29 offen offset:1024 lds
  s_lshl_b32 s80, s39, 15
  s_add_u32 s78, s78, s80
  v_mfma_f32_32x32x16_bf16 v[88:103], v[136:139], v[140:143], v[88:103]
  s_add_u32 m0, s32, 67584
  s_nop 0
  buffer_load_dwordx4 v218, s[24:27], s29 offen offset:0 lds
  s_add_u32 s80, s34, 10485760
  s_addc_u32 s81, s35, 0
  s_waitcnt vmcnt(16) lgkmcnt(0)
  s_barrier
  v_mfma_f32_32x32x16_bf16 v[40:55], v[148:151], v[192:195], v[40:55]
  ds_read_b128 v[64:67], v16 offset:32768
  ds_read_b128 v[140:143], v20 offset:32768
  s_mov_b32 s82, 8388608
  s_mov_b32 s83, 0x20000
  v_dot2c_f32_bf16 v184, s33, v185
  v_mfma_f32_32x32x16_bf16 v[72:87], v[148:151], v[196:199], v[72:87]
  ds_read_b128 v[136:139], v16 offset:36864
  ds_read_b128 v[144:147], v20 offset:36864
  s_add_u32 s84, s34, 5242880
  s_addc_u32 s85, s35, 0
  v_mfma_f32_32x32x16_bf16 v[120:135], v[188:191], v[196:199], v[120:135]
  buffer_load_dwordx4 v219, s[24:27], s29 offen offset:1024 lds
  s_add_u32 s29, s29, 128
  s_and_b32 s29, s29, 0x3ff
  s_mov_b32 s86, 4194304
  v_mfma_f32_32x32x16_bf16 v[88:103], v[188:191], v[192:195], v[88:103]
  s_mov_b32 s87, 0x20000
  s_add_u32 s88, s34, 19922944
  s_addc_u32 s89, s35, 0
  s_waitcnt lgkmcnt(2)
  v_mfma_f32_32x32x16_bf16 v[40:55], v[64:67], v[140:143], v[40:55]
  ds_read_b128 v[148:151], v17 offset:32768
  ds_read_b128 v[192:195], v21 offset:32768
  s_mov_b32 s90, 32768
  ds_read_u16_d16_hi v185, v69 offset:32768
  ds_read_u16_d16_hi v70, v69 offset:32770
  s_waitcnt lgkmcnt(4)
  v_mfma_f32_32x32x16_bf16 v[72:87], v[64:67], v[144:147], v[72:87]
  ds_read_b128 v[188:191], v17 offset:36864
  ds_read_b128 v[196:199], v21 offset:36864
  s_mov_b32 s91, 0x20000
  v_mfma_f32_32x32x16_bf16 v[120:135], v[136:139], v[144:147], v[120:135]
  s_lshr_b32 s93, s41, 3
  s_mul_i32 s92, s93, 253952
  v_mfma_f32_32x32x16_bf16 v[88:103], v[136:139], v[140:143], v[88:103]
  s_lshl_b32 s79, s40, 19
  s_add_u32 s92, s92, s79
  s_waitcnt lgkmcnt(4)
  v_mfma_f32_32x32x16_bf16 v[40:55], v[148:151], v[192:195], v[40:55]
  ds_read_b128 v[64:67], v18 offset:32768
  ds_read_b128 v[140:143], v22 offset:32768
  s_lshr_b32 s93, s3, 1
  s_lshl1_add_u32 s93, s93, s3
  s_waitcnt lgkmcnt(2)
  v_mfma_f32_32x32x16_bf16 v[72:87], v[148:151], v[196:199], v[72:87]
  ds_read_b128 v[136:139], v18 offset:36864
  ds_read_b128 v[144:147], v22 offset:36864
  s_add_u32 s93, s93, 2
  s_lshl_b32 s93, s93, 12
  v_mfma_f32_32x32x16_bf16 v[120:135], v[188:191], v[196:199], v[120:135]
  s_add_u32 s92, s92, s93
  v_mfma_f32_32x32x16_bf16 v[88:103], v[188:191], v[192:195], v[88:103]
  v_lshl_add_u32 v59, v1, 4, s92
  s_and_b32 s79, s40, 7
  v_mul_f32 v185, v185, v180
  v_mul_f32 v70, v70, v181
  s_waitcnt lgkmcnt(2)
  v_mfma_f32_32x32x16_bf16 v[40:55], v[64:67], v[140:143], v[40:55]
  ds_read_b128 v[148:151], v19 offset:32768
  ds_read_b128 v[192:195], v23 offset:32768
  s_lshl_b32 s79, s79, 15
  s_lshl_b32 s92, s3, 12
  s_waitcnt lgkmcnt(2)
  v_mfma_f32_32x32x16_bf16 v[72:87], v[64:67], v[144:147], v[72:87]
  ds_read_b128 v[188:191], v19 offset:36864
  ds_read_b128 v[196:199], v23 offset:36864
  v_and_b32 v244, 3, v1
  v_and_b32 v245, 2, v3
  v_cvt_pk_bf16_f32 v185, v185, v70
  v_mfma_f32_32x32x16_bf16 v[120:135], v[136:139], v[144:147], v[120:135]
  v_xor_b32 v245, v245, v244
  v_lshlrev_b32 v244, 9, v244
  v_mfma_f32_32x32x16_bf16 v[88:103], v[136:139], v[140:143], v[88:103]
  v_lshl_or_b32 v244, v245, 6, v244
  s_waitcnt vmcnt(9) lgkmcnt(0)
  s_barrier
  v_mfma_f32_32x32x16_bf16 v[40:55], v[148:151], v[192:195], v[40:55]
  ds_read_b128 v[64:67], v16 offset:49152
  ds_read_b128 v[140:143], v20 offset:49152
  v_bfe_u32 v245, v1, 2, 2
  v_lshl_or_b32 v244, v245, 4, v244
  v_dot2c_f32_bf16 v184, s33, v185
  v_mfma_f32_32x32x16_bf16 v[72:87], v[148:151], v[196:199], v[72:87]
  ds_read_b128 v[136:139], v16 offset:53248
  ds_read_b128 v[144:147], v20 offset:53248
  v_and_b32 v245, 1, v3
  v_lshl_or_b32 v240, v245, 3, v244
  v_mfma_f32_32x32x16_bf16 v[120:135], v[188:191], v[196:199], v[120:135]
  s_add_u32 m0, s76, 0
  s_nop 0
  buffer_load_dwordx4 v61, s[20:23], s6 offen offset:0 lds
  v_xor_b32 v241, 64, v240
  v_add_u32 v242, 0x10000, v240
  v_mfma_f32_32x32x16_bf16 v[88:103], v[188:191], v[192:195], v[88:103]
  buffer_load_dwordx4 v61, s[56:59], s6 offen offset:1024 lds
  v_add_u32 v243, 0x10000, v241
  s_waitcnt lgkmcnt(2)
  v_mfma_f32_32x32x16_bf16 v[40:55], v[64:67], v[140:143], v[40:55]
  ds_read_b128 v[148:151], v17 offset:49152
  ds_read_b128 v[192:195], v21 offset:49152
  ds_read_u16_d16_hi v185, v69 offset:49152
  ds_read_u16_d16_hi v70, v69 offset:49154
  s_waitcnt lgkmcnt(4)
  v_mfma_f32_32x32x16_bf16 v[72:87], v[64:67], v[144:147], v[72:87]
  ds_read_b128 v[188:191], v17 offset:53248
  ds_read_b128 v[196:199], v21 offset:53248
  s_add_u32 m0, s76, 2048
  s_nop 0
  buffer_load_dwordx4 v61, s[20:23], s7 offen offset:0 lds
  v_mfma_f32_32x32x16_bf16 v[120:135], v[136:139], v[144:147], v[120:135]
  buffer_load_dwordx4 v61, s[56:59], s7 offen offset:1024 lds
  v_mfma_f32_32x32x16_bf16 v[88:103], v[136:139], v[140:143], v[88:103]
  s_add_u32 m0, s76, 16384
  s_nop 0
  buffer_load_dwordx4 v61, s[20:23], s8 offen offset:0 lds
  s_waitcnt lgkmcnt(4)
  v_mfma_f32_32x32x16_bf16 v[40:55], v[148:151], v[192:195], v[40:55]
  ds_read_b128 v[64:67], v18 offset:49152
  ds_read_b128 v[140:143], v22 offset:49152
  s_waitcnt lgkmcnt(2)
  v_mfma_f32_32x32x16_bf16 v[72:87], v[148:151], v[196:199], v[72:87]
  ds_read_b128 v[136:139], v18 offset:53248
  ds_read_b128 v[144:147], v22 offset:53248
  buffer_load_dwordx4 v61, s[56:59], s8 offen offset:1024 lds
  v_mfma_f32_32x32x16_bf16 v[120:135], v[188:191], v[196:199], v[120:135]
  s_add_u32 m0, s76, 18432
  s_nop 0
  buffer_load_dwordx4 v61, s[20:23], s9 offen offset:0 lds
  v_mfma_f32_32x32x16_bf16 v[88:103], v[188:191], v[192:195], v[88:103]
  buffer_load_dwordx4 v61, s[56:59], s9 offen offset:1024 lds
  v_mul_f32 v185, v185, v182
  v_mul_f32 v70, v70, v183
  s_waitcnt lgkmcnt(2)
  v_mfma_f32_32x32x16_bf16 v[40:55], v[64:67], v[140:143], v[40:55]
  ds_read_b128 v[148:151], v19 offset:49152
  ds_read_b128 v[192:195], v23 offset:49152
  s_waitcnt lgkmcnt(2)
  v_mfma_f32_32x32x16_bf16 v[72:87], v[64:67], v[144:147], v[72:87]
  ds_read_b128 v[188:191], v19 offset:53248
  ds_read_b128 v[196:199], v23 offset:53248
  v_cvt_pk_bf16_f32 v185, v185, v70
  v_mfma_f32_32x32x16_bf16 v[120:135], v[136:139], v[144:147], v[120:135]
  v_mfma_f32_32x32x16_bf16 v[88:103], v[136:139], v[140:143], v[88:103]
  s_waitcnt lgkmcnt(2)
  v_mfma_f32_32x32x16_bf16 v[40:55], v[148:151], v[192:195], v[40:55]
  v_dot2c_f32_bf16 v184, s33, v185
  s_waitcnt lgkmcnt(0)
  v_mfma_f32_32x32x16_bf16 v[72:87], v[148:151], v[196:199], v[72:87]
  v_mfma_f32_32x32x16_bf16 v[120:135], v[188:191], v[196:199], v[120:135]
  v_mfma_f32_32x32x16_bf16 v[88:103], v[188:191], v[192:195], v[88:103]
  s_nop 6
  v_pk_fma_f32 v[250:251], v[226:227], v[40:41], v[42:43] op_sel:[0,0,0] op_sel_hi:[0,1,1]
  s_nop 1
  v_pk_fma_f32 v[244:245], v[226:227], v[72:73], v[74:75] op_sel:[0,0,0] op_sel_hi:[0,1,1]
  v_pk_fma_f32 v[250:251], v[226:227], v[72:73], v[250:251] op_sel:[1,0,0] op_sel_hi:[1,1,1] neg_lo:[1,0,0] neg_hi:[1,0,0]
  v_pk_fma_f32 v[244:245], v[226:227], v[40:41], v[244:245] op_sel:[1,0,0] op_sel_hi:[1,1,1]
  v_pk_fma_f32 v[8:9], v[226:227], v[250:251], v[44:45] op_sel:[0,0,0] op_sel_hi:[0,1,1]
  v_pk_fma_f32 v[10:11], v[226:227], v[244:245], v[76:77] op_sel:[0,0,0] op_sel_hi:[0,1,1]
  v_pk_fma_f32 v[8:9], v[226:227], v[244:245], v[8:9] op_sel:[1,0,0] op_sel_hi:[1,1,1] neg_lo:[1,0,0] neg_hi:[1,0,0]
  v_pk_fma_f32 v[10:11], v[226:227], v[250:251], v[10:11] op_sel:[1,0,0] op_sel_hi:[1,1,1]
  v_pk_fma_f32 v[250:251], v[226:227], v[8:9], v[46:47] op_sel:[0,0,0] op_sel_hi:[0,1,1]
  v_pk_fma_f32 v[244:245], v[226:227], v[10:11], v[78:79] op_sel:[0,0,0] op_sel_hi:[0,1,1]
  v_pk_fma_f32 v[250:251], v[226:227], v[10:11], v[250:251] op_sel:[1,0,0] op_sel_hi:[1,1,1] neg_lo:[1,0,0] neg_hi:[1,0,0]
  v_pk_fma_f32 v[244:245], v[226:227], v[8:9], v[244:245] op_sel:[1,0,0] op_sel_hi:[1,1,1]
  v_pk_fma_f32 v[8:9], v[226:227], v[250:251], v[48:49] op_sel:[0,0,0] op_sel_hi:[0,1,1]
  v_pk_fma_f32 v[10:11], v[226:227], v[244:245], v[80:81] op_sel:[0,0,0] op_sel_hi:[0,1,1]
  v_pk_fma_f32 v[8:9], v[226:227], v[244:245], v[8:9] op_sel:[1,0,0] op_sel_hi:[1,1,1] neg_lo:[1,0,0] neg_hi:[1,0,0]
  v_pk_fma_f32 v[10:11], v[226:227], v[250:251], v[10:11] op_sel:[1,0,0] op_sel_hi:[1,1,1]
  v_pk_fma_f32 v[250:251], v[226:227], v[8:9], v[50:51] op_sel:[0,0,0] op_sel_hi:[0,1,1]
  v_pk_fma_f32 v[244:245], v[226:227], v[10:11], v[82:83] op_sel:[0,0,0] op_sel_hi:[0,1,1]
  v_pk_fma_f32 v[250:251], v[226:227], v[10:11], v[250:251] op_sel:[1,0,0] op_sel_hi:[1,1,1] neg_lo:[1,0,0] neg_hi:[1,0,0]
  v_pk_fma_f32 v[244:245], v[226:227], v[8:9], v[244:245] op_sel:[1,0,0] op_sel_hi:[1,1,1]
  v_pk_fma_f32 v[8:9], v[226:227], v[250:251], v[52:53] op_sel:[0,0,0] op_sel_hi:[0,1,1]
  v_pk_fma_f32 v[10:11], v[226:227], v[244:245], v[84:85] op_sel:[0,0,0] op_sel_hi:[0,1,1]
  v_pk_fma_f32 v[8:9], v[226:227], v[244:245], v[8:9] op_sel:[1,0,0] op_sel_hi:[1,1,1] neg_lo:[1,0,0] neg_hi:[1,0,0]
  v_pk_fma_f32 v[10:11], v[226:227], v[250:251], v[10:11] op_sel:[1,0,0] op_sel_hi:[1,1,1]
  v_pk_fma_f32 v[250:251], v[226:227], v[8:9], v[54:55] op_sel:[0,0,0] op_sel_hi:[0,1,1]
  v_pk_fma_f32 v[244:245], v[226:227], v[10:11], v[86:87] op_sel:[0,0,0] op_sel_hi:[0,1,1]
  v_pk_fma_f32 v[250:251], v[226:227], v[10:11], v[250:251] op_sel:[1,0,0] op_sel_hi:[1,1,1] neg_lo:[1,0,0] neg_hi:[1,0,0]
  v_pk_fma_f32 v[244:245], v[226:227], v[8:9], v[244:245] op_sel:[1,0,0] op_sel_hi:[1,1,1]
  v_pk_fma_f32 v[8:9], v[226:227], v[250:251], v[88:89] op_sel:[0,0,0] op_sel_hi:[0,1,1]
  v_pk_fma_f32 v[10:11], v[226:227], v[244:245], v[120:121] op_sel:[0,0,0] op_sel_hi:[0,1,1]
  v_pk_fma_f32 v[8:9], v[226:227], v[244:245], v[8:9] op_sel:[1,0,0] op_sel_hi:[1,1,1] neg_lo:[1,0,0] neg_hi:[1,0,0]
  v_pk_fma_f32 v[10:11], v[226:227], v[250:251], v[10:11] op_sel:[1,0,0] op_sel_hi:[1,1,1]
  v_pk_fma_f32 v[250:251], v[226:227], v[8:9], v[90:91] op_sel:[0,0,0] op_sel_hi:[0,1,1]
  v_pk_fma_f32 v[244:245], v[226:227], v[10:11], v[122:123] op_sel:[0,0,0] op_sel_hi:[0,1,1]
  v_pk_fma_f32 v[250:251], v[226:227], v[10:11], v[250:251] op_sel:[1,0,0] op_sel_hi:[1,1,1] neg_lo:[1,0,0] neg_hi:[1,0,0]
  v_pk_fma_f32 v[244:245], v[226:227], v[8:9], v[244:245] op_sel:[1,0,0] op_sel_hi:[1,1,1]
  v_pk_fma_f32 v[8:9], v[226:227], v[250:251], v[92:93] op_sel:[0,0,0] op_sel_hi:[0,1,1]
  v_pk_fma_f32 v[10:11], v[226:227], v[244:245], v[124:125] op_sel:[0,0,0] op_sel_hi:[0,1,1]
  v_pk_fma_f32 v[8:9], v[226:227], v[244:245], v[8:9] op_sel:[1,0,0] op_sel_hi:[1,1,1] neg_lo:[1,0,0] neg_hi:[1,0,0]
  v_pk_fma_f32 v[10:11], v[226:227], v[250:251], v[10:11] op_sel:[1,0,0] op_sel_hi:[1,1,1]
  v_pk_fma_f32 v[250:251], v[226:227], v[8:9], v[94:95] op_sel:[0,0,0] op_sel_hi:[0,1,1]
  v_pk_fma_f32 v[244:245], v[226:227], v[10:11], v[126:127] op_sel:[0,0,0] op_sel_hi:[0,1,1]
  v_pk_fma_f32 v[250:251], v[226:227], v[10:11], v[250:251] op_sel:[1,0,0] op_sel_hi:[1,1,1] neg_lo:[1,0,0] neg_hi:[1,0,0]
  v_pk_fma_f32 v[244:245], v[226:227], v[8:9], v[244:245] op_sel:[1,0,0] op_sel_hi:[1,1,1]
  v_pk_fma_f32 v[8:9], v[226:227], v[250:251], v[96:97] op_sel:[0,0,0] op_sel_hi:[0,1,1]
  v_pk_fma_f32 v[10:11], v[226:227], v[244:245], v[128:129] op_sel:[0,0,0] op_sel_hi:[0,1,1]
  v_pk_fma_f32 v[8:9], v[226:227], v[244:245], v[8:9] op_sel:[1,0,0] op_sel_hi:[1,1,1] neg_lo:[1,0,0] neg_hi:[1,0,0]
  v_pk_fma_f32 v[10:11], v[226:227], v[250:251], v[10:11] op_sel:[1,0,0] op_sel_hi:[1,1,1]
  v_pk_fma_f32 v[250:251], v[226:227], v[8:9], v[98:99] op_sel:[0,0,0] op_sel_hi:[0,1,1]
  v_pk_fma_f32 v[244:245], v[226:227], v[10:11], v[130:131] op_sel:[0,0,0] op_sel_hi:[0,1,1]
  v_pk_fma_f32 v[250:251], v[226:227], v[10:11], v[250:251] op_sel:[1,0,0] op_sel_hi:[1,1,1] neg_lo:[1,0,0] neg_hi:[1,0,0]
  v_pk_fma_f32 v[244:245], v[226:227], v[8:9], v[244:245] op_sel:[1,0,0] op_sel_hi:[1,1,1]
  v_pk_fma_f32 v[8:9], v[226:227], v[250:251], v[100:101] op_sel:[0,0,0] op_sel_hi:[0,1,1]
  v_pk_fma_f32 v[10:11], v[226:227], v[244:245], v[132:133] op_sel:[0,0,0] op_sel_hi:[0,1,1]
  v_pk_fma_f32 v[8:9], v[226:227], v[244:245], v[8:9] op_sel:[1,0,0] op_sel_hi:[1,1,1] neg_lo:[1,0,0] neg_hi:[1,0,0]
  v_pk_fma_f32 v[10:11], v[226:227], v[250:251], v[10:11] op_sel:[1,0,0] op_sel_hi:[1,1,1]
  v_pk_fma_f32 v[250:251], v[226:227], v[8:9], v[102:103] op_sel:[0,0,0] op_sel_hi:[0,1,1]
  v_pk_fma_f32 v[244:245], v[226:227], v[10:11], v[134:135] op_sel:[0,0,0] op_sel_hi:[0,1,1]
  v_pk_fma_f32 v[250:251], v[226:227], v[10:11], v[250:251] op_sel:[1,0,0] op_sel_hi:[1,1,1] neg_lo:[1,0,0] neg_hi:[1,0,0]
  v_pk_fma_f32 v[244:245], v[226:227], v[8:9], v[244:245] op_sel:[1,0,0] op_sel_hi:[1,1,1]
  v_fma_f32 v8, v228, v250, v251
  v_fma_f32 v9, v228, v244, v245
  v_fma_f32 v8, -v229, v244, v8
  v_fma_f32 v9, v229, v250, v9
  v_mov_b32 v10, v8
  v_mov_b32 v11, v9
  s_nop 0
  v_permlane32_swap_b32 v8, v10
  v_permlane32_swap_b32 v9, v11
  v_fma_f32 v10, v230, v8, v10
  v_fma_f32 v11, v230, v9, v11
  v_fma_f32 v10, -v231, v9, v10
  v_fma_f32 v11, v231, v8, v11
  ds_write_b64 v60, v[10:11]
  s_waitcnt vmcnt(16)
  v_cmp_ne_u32 vcc, 1, v247
  s_nop 0
  s_cbranch_vccz gated_mix__spectral_gfnet__ssm_conv_s5__prompt_kernel_skip24
  s_mov_b32 s33, 0
gated_mix__spectral_gfnet__ssm_conv_s5__prompt_kernel_poll25:
  s_sleep 16
  buffer_load_dword v247, v6, s[16:19], 0 offen sc1
  s_waitcnt vmcnt(0)
  v_cmp_ne_u32 vcc, 1, v247
  s_nop 0
  s_cbranch_vccz gated_mix__spectral_gfnet__ssm_conv_s5__prompt_kernel_pollout26
  s_add_u32 s33, s33, 1
  s_cmp_lt_u32 s33, 1048576
  s_cbranch_scc1 gated_mix__spectral_gfnet__ssm_conv_s5__prompt_kernel_poll25
gated_mix__spectral_gfnet__ssm_conv_s5__prompt_kernel_pollout26:
gated_mix__spectral_gfnet__ssm_conv_s5__prompt_kernel_skip24:
  s_waitcnt lgkmcnt(0)
  s_barrier
  v_and_b32 v60, 0xfffffbff, v60
  ds_read_b64 v[246:247], v60
  s_cmp_lt_u32 s3, 2
  s_cbranch_scc1 gated_mix__spectral_gfnet__ssm_conv_s5__prompt_kernel_skip27
  s_waitcnt lgkmcnt(0)
  v_fma_f32 v10, v232, v246, v10
  s_waitcnt lgkmcnt(0)
  v_fma_f32 v11, v232, v247, v11
  s_waitcnt lgkmcnt(0)
  v_fma_f32 v10, -v233, v247, v10
  s_waitcnt lgkmcnt(0)
  v_fma_f32 v11, v233, v246, v11
  v_min_u32 v10, -2, v10
  v_min_u32 v11, -2, v11
  s_mov_b32 exec_hi, 0
  buffer_store_dwordx2 v[10:11], v71, s[68:71], 0 offen sc1
  s_mov_b64 exec, -1
gated_mix__spectral_gfnet__ssm_conv_s5__prompt_kernel_skip27:
  v_lshrrev_b32 v5, 5, v1
  v_lshl_add_u32 v71, v5, 12, v71
  v_add_u32 v71, 512, v71
  v_and_b32 v60, 3, v2
  v_lshlrev_b32 v5, 6, v60
  v_lshrrev_b32 v60, 2, v2
  v_lshl_or_b32 v5, v60, 4, v5
  v_lshl_or_b32 v5, v3, 12, v5
  s_mul_i32 s33, s10, 16384
  s_lshl_b32 s43, s3, 8
  s_add_u32 s33, s33, s43
  buffer_load_dwordx4 v[12:15], v5, s[60:63], s33 offen offset:0 sc1
  buffer_load_dwordx4 v[16:19], v5, s[60:63], s33 offen offset:1024 sc1
  buffer_load_dwordx4 v[20:23], v5, s[60:63], s33 offen offset:2048 sc1
  buffer_load_dwordx4 v[64:67], v5, s[60:63], s33 offen offset:3072 sc1
  v_pk_mul_f32 v[138:139], v[236:237], v[40:41] op_sel:[1,0] op_sel_hi:[1,1]
  v_pk_mul_f32 v[40:41], v[236:237], v[40:41] op_sel:[0,0] op_sel_hi:[0,1]
  v_pk_fma_f32 v[40:41], v[236:237], v[72:73], v[40:41] op_sel:[1,0,0] op_sel_hi:[1,1,1] neg_lo:[1,0,0] neg_hi:[1,0,0]
  v_pk_fma_f32 v[72:73], v[236:237], v[72:73], v[138:139] op_sel:[0,0,0] op_sel_hi:[0,1,1]
  v_pk_mul_f32 v[136:137], v[236:237], v[42:43] op_sel:[1,0] op_sel_hi:[1,1]
  v_pk_mul_f32 v[42:43], v[236:237], v[42:43] op_sel:[0,0] op_sel_hi:[0,1]
  v_pk_fma_f32 v[42:43], v[236:237], v[74:75], v[42:43] op_sel:[1,0,0] op_sel_hi:[1,1,1] neg_lo:[1,0,0] neg_hi:[1,0,0]
  v_pk_fma_f32 v[74:75], v[236:237], v[74:75], v[136:137] op_sel:[0,0,0] op_sel_hi:[0,1,1]
  v_pk_mul_f32 v[138:139], v[236:237], v[44:45] op_sel:[1,0] op_sel_hi:[1,1]
  v_pk_mul_f32 v[44:45], v[236:237], v[44:45] op_sel:[0,0] op_sel_hi:[0,1]
  v_pk_fma_f32 v[44:45], v[236:237], v[76:77], v[44:45] op_sel:[1,0,0] op_sel_hi:[1,1,1] neg_lo:[1,0,0] neg_hi:[1,0,0]
  v_pk_fma_f32 v[76:77], v[236:237], v[76:77], v[138:139] op_sel:[0,0,0] op_sel_hi:[0,1,1]
  v_pk_mul_f32 v[136:137], v[236:237], v[46:47] op_sel:[1,0] op_sel_hi:[1,1]
  v_pk_mul_f32 v[46:47], v[236:237], v[46:47] op_sel:[0,0] op_sel_hi:[0,1]
  v_pk_fma_f32 v[46:47], v[236:237], v[78:79], v[46:47] op_sel:[1,0,0] op_sel_hi:[1,1,1] neg_lo:[1,0,0] neg_hi:[1,0,0]
  v_pk_fma_f32 v[78:79], v[236:237], v[78:79], v[136:137] op_sel:[0,0,0] op_sel_hi:[0,1,1]
  v_pk_mul_f32 v[138:139], v[236:237], v[48:49] op_sel:[1,0] op_sel_hi:[1,1]
  v_pk_mul_f32 v[48:49], v[236:237], v[48:49] op_sel:[0,0] op_sel_hi:[0,1]
  v_pk_fma_f32 v[48:49], v[236:237], v[80:81], v[48:49] op_sel:[1,0,0] op_sel_hi:[1,1,1] neg_lo:[1,0,0] neg_hi:[1,0,0]
  v_pk_fma_f32 v[80:81], v[236:237], v[80:81], v[138:139] op_sel:[0,0,0] op_sel_hi:[0,1,1]
  v_pk_mul_f32 v[136:137], v[236:237], v[50:51] op_sel:[1,0] op_sel_hi:[1,1]
  v_pk_mul_f32 v[50:51], v[236:237], v[50:51] op_sel:[0,0] op_sel_hi:[0,1]
  v_pk_fma_f32 v[50:51], v[236:237], v[82:83], v[50:51] op_sel:[1,0,0] op_sel_hi:[1,1,1] neg_lo:[1,0,0] neg_hi:[1,0,0]
  v_pk_fma_f32 v[82:83], v[236:237], v[82:83], v[136:137] op_sel:[0,0,0] op_sel_hi:[0,1,1]
  v_pk_mul_f32 v[138:139], v[236:237], v[52:53] op_sel:[1,0] op_sel_hi:[1,1]
  s_add_u32 m0, s76, 81920
  s_nop 0
  buffer_load_dwordx4 v61, s[20:23], s72 offen offset:0 lds
  v_pk_mul_f32 v[52:53], v[236:237], v[52:53] op_sel:[0,0] op_sel_hi:[0,1]
  v_pk_fma_f32 v[52:53], v[236:237], v[84:85], v[52:53] op_sel:[1,0,0] op_sel_hi:[1,1,1] neg_lo:[1,0,0] neg_hi:[1,0,0]
  v_pk_fma_f32 v[84:85], v[236:237], v[84:85], v[138:139] op_sel:[0,0,0] op_sel_hi:[0,1,1]
  v_pk_mul_f32 v[136:137], v[236:237], v[54:55] op_sel:[1,0] op_sel_hi:[1,1]
  v_pk_mul_f32 v[54:55], v[236:237], v[54:55] op_sel:[0,0] op_sel_hi:[0,1]
  v_pk_fma_f32 v[54:55], v[236:237], v[86:87], v[54:55] op_sel:[1,0,0] op_sel_hi:[1,1,1] neg_lo:[1,0,0] neg_hi:[1,0,0]
  v_pk_fma_f32 v[86:87], v[236:237], v[86:87], v[136:137] op_sel:[0,0,0] op_sel_hi:[0,1,1]
  v_pk_mul_f32 v[138:139], v[236:237], v[88:89] op_sel:[1,0] op_sel_hi:[1,1]
  buffer_load_dwordx4 v61, s[56:59], s72 offen offset:1024 lds
  v_pk_mul_f32 v[88:89], v[236:237], v[88:89] op_sel:[0,0] op_sel_hi:[0,1]
  v_pk_fma_f32 v[88:89], v[236:237], v[120:121], v[88:89] op_sel:[1,0,0] op_sel_hi:[1,1,1] neg_lo:[1,0,0] neg_hi:[1,0,0]
  v_pk_fma_f32 v[120:121], v[236:237], v[120:121], v[138:139] op_sel:[0,0,0] op_sel_hi:[0,1,1]
  v_pk_mul_f32 v[136:137], v[236:237], v[90:91] op_sel:[1,0] op_sel_hi:[1,1]
  v_pk_mul_f32 v[90:91], v[236:237], v[90:91] op_sel:[0,0] op_sel_hi:[0,1]
  v_pk_fma_f32 v[90:91], v[236:237], v[122:123], v[90:91] op_sel:[1,0,0] op_sel_hi:[1,1,1] neg_lo:[1,0,0] neg_hi:[1,0,0]
  v_pk_fma_f32 v[122:123], v[236:237], v[122:123], v[136:137] op_sel:[0,0,0] op_sel_hi:[0,1,1]
  v_pk_mul_f32 v[138:139], v[236:237], v[92:93] op_sel:[1,0] op_sel_hi:[1,1]
  s_add_u32 m0, s76, 83968
  s_nop 0
  buffer_load_dwordx4 v61, s[20:23], s73 offen offset:0 lds
  v_pk_mul_f32 v[92:93], v[236:237], v[92:93] op_sel:[0,0] op_sel_hi:[0,1]
  v_pk_fma_f32 v[92:93], v[236:237], v[124:125], v[92:93] op_sel:[1,0,0] op_sel_hi:[1,1,1] neg_lo:[1,0,0] neg_hi:[1,0,0]
  v_pk_fma_f32 v[124:125], v[236:237], v[124:125], v[138:139] op_sel:[0,0,0] op_sel_hi:[0,1,1]
  v_pk_mul_f32 v[136:137], v[236:237], v[94:95] op_sel:[1,0] op_sel_hi:[1,1]
  v_pk_mul_f32 v[94:95], v[236:237], v[94:95] op_sel:[0,0] op_sel_hi:[0,1]
  v_pk_fma_f32 v[94:95], v[236:237], v[126:127], v[94:95] op_sel:[1,0,0] op_sel_hi:[1,1,1] neg_lo:[1,0,0] neg_hi:[1,0,0]
  v_pk_fma_f32 v[126:127], v[236:237], v[126:127], v[136:137] op_sel:[0,0,0] op_sel_hi:[0,1,1]
  v_pk_mul_f32 v[138:139], v[236:237], v[96:97] op_sel:[1,0] op_sel_hi:[1,1]
  buffer_load_dwordx4 v61, s[56:59], s73 offen offset:1024 lds
  v_pk_mul_f32 v[96:97], v[236:237], v[96:97] op_sel:[0,0] op_sel_hi:[0,1]
  v_pk_fma_f32 v[96:97], v[236:237], v[128:129], v[96:97] op_sel:[1,0,0] op_sel_hi:[1,1,1] neg_lo:[1,0,0] neg_hi:[1,0,0]
  v_pk_fma_f32 v[128:129], v[236:237], v[128:129], v[138:139] op_sel:[0,0,0] op_sel_hi:[0,1,1]
  v_pk_mul_f32 v[136:137], v[236:237], v[98:99] op_sel:[1,0] op_sel_hi:[1,1]
  v_pk_mul_f32 v[98:99], v[236:237], v[98:99] op_sel:[0,0] op_sel_hi:[0,1]
  v_pk_fma_f32 v[98:99], v[236:237], v[130:131], v[98:99] op_sel:[1,0,0] op_sel_hi:[1,1,1] neg_lo:[1,0,0] neg_hi:[1,0,0]
  v_pk_fma_f32 v[130:131], v[236:237], v[130:131], v[136:137] op_sel:[0,0,0] op_sel_hi:[0,1,1]
  v_pk_mul_f32 v[138:139], v[236:237], v[100:101] op_sel:[1,0] op_sel_hi:[1,1]
  s_add_u32 m0, s76, 32768
  s_nop 0
  buffer_load_dwordx4 v61, s[20:23], s74 offen offset:0 lds
  v_pk_mul_f32 v[100:101], v[236:237], v[100:101] op_sel:[0,0] op_sel_hi:[0,1]
  v_pk_fma_f32 v[100:101], v[236:237], v[132:133], v[100:101] op_sel:[1,0,0] op_sel_hi:[1,1,1] neg_lo:[1,0,0] neg_hi:[1,0,0]
  v_pk_fma_f32 v[132:133], v[236:237], v[132:133], v[138:139] op_sel:[0,0,0] op_sel_hi:[0,1,1]
  v_pk_mul_f32 v[136:137], v[236:237], v[102:103] op_sel:[1,0] op_sel_hi:[1,1]
  v_pk_mul_f32 v[102:103], v[236:237], v[102:103] op_sel:[0,0] op_sel_hi:[0,1]
  v_pk_fma_f32 v[102:103], v[236:237], v[134:135], v[102:103] op_sel:[1,0,0] op_sel_hi:[1,1,1] neg_lo:[1,0,0] neg_hi:[1,0,0]
  v_pk_fma_f32 v[134:135], v[236:237], v[134:135], v[136:137] op_sel:[0,0,0] op_sel_hi:[0,1,1]
  v_pk_mul_f32 v[10:11], v[236:237], v[232:233] op_sel:[0,0] op_sel_hi:[0,1]
  buffer_load_dwordx4 v61, s[56:59], s74 offen offset:1024 lds
  v_pk_fma_f32 v[10:11], v[236:237], v[232:233], v[10:11] op_sel:[1,1,0] op_sel_hi:[1,0,1] neg_lo:[1,0,0]
  s_cmp_ge_u32 s3, 2
  s_cbranch_scc1 gated_mix__spectral_gfnet__ssm_conv_s5__prompt_kernel_skip28
  v_mov_b32 v10, v236
  v_mov_b32 v11, v237
  s_waitcnt lgkmcnt(0)
  v_mov_b32 v246, 0
  s_waitcnt lgkmcnt(0)
  v_mov_b32 v247, 0
gated_mix__spectral_gfnet__ssm_conv_s5__prompt_kernel_skip28:
  v_pk_mul_f32 v[140:141], v[230:231], v[10:11] op_sel:[0,0] op_sel_hi:[0,1]
  v_pk_fma_f32 v[140:141], v[230:231], v[10:11], v[140:141] op_sel:[1,1,0] op_sel_hi:[1,0,1] neg_lo:[1,0,0]
  s_waitcnt lgkmcnt(0)
  v_pk_fma_f32 v[8:9], v[230:231], v[246:247], v[8:9] op_sel:[0,0,0] op_sel_hi:[0,1,1]
  v_pk_fma_f32 v[8:9], v[230:231], v[246:247], v[8:9] op_sel:[1,1,0] op_sel_hi:[1,0,1] neg_lo:[1,0,0]
  s_mov_b32 exec_lo, 0
  v_mov_b32 v10, v140
  v_mov_b32 v11, v141
  v_mov_b32 v246, v8
  v_mov_b32 v247, v9
  s_mov_b64 exec, -1
  s_add_u32 m0, s76, 34816
  s_nop 0
  buffer_load_dwordx4 v61, s[20:23], s75 offen offset:0 lds
  v_mov_b32 v251, v244
  v_pk_mul_f32 v[136:137], v[228:229], v[10:11] op_sel:[0,0] op_sel_hi:[0,1]
  v_pk_fma_f32 v[136:137], v[228:229], v[10:11], v[136:137] op_sel:[1,1,0] op_sel_hi:[1,0,1] neg_lo:[1,0,0]
  v_pk_fma_f32 v[250:251], v[228:229], v[246:247], v[250:251] op_sel:[0,0,0] op_sel_hi:[0,1,1]
  v_pk_fma_f32 v[250:251], v[228:229], v[246:247], v[250:251] op_sel:[1,1,0] op_sel_hi:[1,0,1] neg_lo:[1,0,0]
  v_pk_mul_f32 v[138:139], v[236:237], v[250:251] op_sel:[0,0] op_sel_hi:[0,1]
  v_pk_fma_f32 v[138:139], v[236:237], v[250:251], v[138:139] op_sel:[1,1,0] op_sel_hi:[1,0,1] neg_lo:[1,0,0]
  v_pk_mul_f32 v[140:141], v[236:237], v[246:247] op_sel:[0,0] op_sel_hi:[0,1]
  buffer_load_dwordx4 v61, s[56:59], s75 offen offset:1024 lds
  v_pk_fma_f32 v[140:141], v[236:237], v[246:247], v[140:141] op_sel:[1,1,0] op_sel_hi:[1,0,1] neg_lo:[1,0,0]
  buffer_load_dwordx2 v[8:9], v71, s[68:71], 0 offen offset:0 sc1
  buffer_load_dwordx2 v[142:143], v71, s[68:71], 0 offen offset:512 sc1
  buffer_load_dwordx2 v[232:233], v71, s[68:71], 0 offen offset:1024 sc1
  buffer_load_dwordx2 v[250:251], v71, s[68:71], 0 offen offset:1536 sc1
  buffer_load_dwordx2 v[144:145], v71, s[68:71], 0 offen offset:2048 sc1
  buffer_load_dwordx2 v[146:147], v71, s[68:71], 0 offen offset:2560 sc1
  buffer_load_dwordx2 v[148:149], v71, s[68:71], 0 offen offset:3072 sc1
  buffer_load_dwordx2 v[150:151], v71, s[68:71], 0 offen offset:3584 sc1
  s_add_u32 m0, s32, 114688
  s_nop 0
  buffer_load_dwordx4 v216, s[12:15], s29 offen offset:0 lds
  v_mov_b32 v185, v184
  s_lshl_b32 s33, s3, 3
  s_add_u32 s33, s33, 155648
  v_permlane16_swap_b32 v184, v185
  v_add_f32 v184, v184, v185
  s_nop 1
  v_add_f32 v184, v184, v184 row_ror:8 row_mask:0xf bank_mask:0xf
  s_nop 1
  v_add_f32 v184, v184, v184 row_ror:4 row_mask:0xf bank_mask:0xf
  s_nop 1
  v_add_f32 v184, v184, v184 row_ror:2 row_mask:0xf bank_mask:0xf
  buffer_load_dwordx4 v217, s[12:15], s29 offen offset:1024 lds
  s_nop 0
  v_add_f32 v184, v184, v184 row_ror:1 row_mask:0xf bank_mask:0xf
  v_cvt_pk_bf16_f32 v184, v184, v184
  v_and_b32 v184, 0xffff0000, v184
  v_mul_f32 v184, 0xbfb8aa3b, v184
  v_exp_f32 v184, v184
  v_lshrrev_b32 v70, 5, v1
  v_add_f32 v184, 1.0, v184
  s_add_u32 m0, s32, 116736
  s_nop 0
  buffer_load_dwordx4 v218, s[12:15], s29 offen offset:0 lds
  v_rcp_f32 v184, v184
  v_lshl_add_u32 v70, v70, 2, s33
  v_cvt_pk_bf16_f32 v184, v184, v184
  v_and_b32 v184, 0xffff0000, v184
  ds_write_b32 v70, v184
  v_and_b32 v5, 7, v2
  v_lshlrev_b32 v60, 2, v3
  buffer_load_dwordx4 v219, s[12:15], s29 offen offset:1024 lds
  v_xor_b32 v5, v5, v60
  v_lshlrev_b32 v5, 4, v5
  v_lshl_or_b32 v5, v2, 10, v5
  s_lshl_b32 s33, s3, 8
  s_add_u32 s33, s33, 49152
  v_add_u32 v5, s33, v5
  s_waitcnt vmcnt(23)
  v_mov_b32 v152, v12
  s_waitcnt vmcnt(22)
  v_mov_b32 v153, v16
  s_waitcnt vmcnt(21)
  v_mov_b32 v154, v20
  s_waitcnt vmcnt(20)
  v_mov_b32 v155, v64
  v_mov_b32 v156, v13
  v_mov_b32 v157, v17
  v_mov_b32 v158, v21
  v_mov_b32 v159, v65
  v_mfma_f32_16x16x32_bf16 v[160:163], v[152:155], v[104:107], 0
  v_mfma_f32_16x16x32_bf16 v[164:167], v[152:155], v[108:111], 0
  v_mfma_f32_16x16x32_bf16 v[168:171], v[156:159], v[104:107], 0
  v_mfma_f32_16x16x32_bf16 v[172:175], v[156:159], v[108:111], 0
  v_mov_b32 v152, v14
  v_mov_b32 v153, v18
  v_mov_b32 v154, v22
  v_mov_b32 v155, v66
  v_mov_b32 v156, v15
  v_mov_b32 v157, v19
  v_mov_b32 v158, v23
  v_mov_b32 v159, v67
  v_xor_b32 v60, 0, v5
  v_cvt_pk_bf16_f32 v64, v160, v164
  v_cvt_pk_bf16_f32 v65, v161, v165
  v_cvt_pk_bf16_f32 v66, v162, v166
  v_cvt_pk_bf16_f32 v67, v163, v167
  ds_write_b128 v60, v[64:67]
  v_mfma_f32_16x16x32_bf16 v[160:163], v[152:155], v[104:107], 0
  v_mfma_f32_16x16x32_bf16 v[164:167], v[152:155], v[108:111], 0
  v_xor_b32 v60, 16, v5
  v_cvt_pk_bf16_f32 v12, v168, v172
  v_cvt_pk_bf16_f32 v13, v169, v173
  v_cvt_pk_bf16_f32 v14, v170, v174
  v_cvt_pk_bf16_f32 v15, v171, v175
  ds_write_b128 v60, v[12:15]
  v_mfma_f32_16x16x32_bf16 v[168:171], v[156:159], v[104:107], 0
  v_mfma_f32_16x16x32_bf16 v[172:175], v[156:159], v[108:111], 0
  v_xor_b32 v60, 32, v5
  v_cvt_pk_bf16_f32 v16, v160, v164
  v_cvt_pk_bf16_f32 v17, v161, v165
  v_cvt_pk_bf16_f32 v18, v162, v166
  v_cvt_pk_bf16_f32 v19, v163, v167
  ds_write_b128 v60, v[16:19]
  v_xor_b32 v60, 48, v5
  s_nop 0
  v_cvt_pk_bf16_f32 v20, v168, v172
  v_cvt_pk_bf16_f32 v21, v169, v173
  v_cvt_pk_bf16_f32 v22, v170, v174
  v_cvt_pk_bf16_f32 v23, v171, v175
  ds_write_b128 v60, v[20:23]
  s_waitcnt vmcnt(4)
  v_max_u32 v5, v8, v9
  v_max3_u32 v5, v5, v142, v143
  v_max3_u32 v5, v5, v232, v233
  v_max3_u32 v5, v5, v250, v251
  v_max3_u32 v5, v5, v144, v145
  v_max3_u32 v5, v5, v146, v147
  v_max3_u32 v5, v5, v148, v149
  v_max3_u32 v5, v5, v150, v151
  v_cmp_eq_u32 vcc, -1, v5
  s_nop 0
  s_cbranch_vccz gated_mix__spectral_gfnet__ssm_conv_s5__prompt_kernel_skip29
  s_mov_b32 s33, 0
gated_mix__spectral_gfnet__ssm_conv_s5__prompt_kernel_lb30:
  buffer_load_dwordx2 v[8:9], v71, s[68:71], 0 offen offset:0 sc1
  buffer_load_dwordx2 v[142:143], v71, s[68:71], 0 offen offset:512 sc1
  buffer_load_dwordx2 v[232:233], v71, s[68:71], 0 offen offset:1024 sc1
  buffer_load_dwordx2 v[250:251], v71, s[68:71], 0 offen offset:1536 sc1
  buffer_load_dwordx2 v[144:145], v71, s[68:71], 0 offen offset:2048 sc1
  buffer_load_dwordx2 v[146:147], v71, s[68:71], 0 offen offset:2560 sc1
  buffer_load_dwordx2 v[148:149], v71, s[68:71], 0 offen offset:3072 sc1
  buffer_load_dwordx2 v[150:151], v71, s[68:71], 0 offen offset:3584 sc1
  s_waitcnt vmcnt(0)
  v_max_u32 v5, v8, v9
  v_max3_u32 v5, v5, v142, v143
  v_max3_u32 v5, v5, v232, v233
  v_max3_u32 v5, v5, v250, v251
  v_max3_u32 v5, v5, v144, v145
  v_max3_u32 v5, v5, v146, v147
  v_max3_u32 v5, v5, v148, v149
  v_max3_u32 v5, v5, v150, v151
  v_cmp_eq_u32 vcc, -1, v5
  s_nop 0
  s_cbranch_vccz gated_mix__spectral_gfnet__ssm_conv_s5__prompt_kernel_lbout31
  s_add_u32 s33, s33, 1
  s_cmp_lt_u32 s33, 1048576
  s_cbranch_scc1 gated_mix__spectral_gfnet__ssm_conv_s5__prompt_kernel_lb30
gated_mix__spectral_gfnet__ssm_conv_s5__prompt_kernel_lbout31:
gated_mix__spectral_gfnet__ssm_conv_s5__prompt_kernel_skip29:
  v_pk_fma_f32 v[148:149], v[238:239], v[150:151], v[148:149] op_sel:[0,0,0] op_sel_hi:[0,1,1]
  v_pk_fma_f32 v[148:149], v[238:239], v[150:151], v[148:149] op_sel:[1,1,0] op_sel_hi:[1,0,1] neg_lo:[1,0,0]
  v_pk_fma_f32 v[146:147], v[238:239], v[148:149], v[146:147] op_sel:[0,0,0] op_sel_hi:[0,1,1]
  v_pk_fma_f32 v[146:147], v[238:239], v[148:149], v[146:147] op_sel:[1,1,0] op_sel_hi:[1,0,1] neg_lo:[1,0,0]
  v_pk_fma_f32 v[144:145], v[238:239], v[146:147], v[144:145] op_sel:[0,0,0] op_sel_hi:[0,1,1]
  v_pk_fma_f32 v[144:145], v[238:239], v[146:147], v[144:145] op_sel:[1,1,0] op_sel_hi:[1,0,1] neg_lo:[1,0,0]
  v_pk_fma_f32 v[250:251], v[238:239], v[144:145], v[250:251] op_sel:[0,0,0] op_sel_hi:[0,1,1]
  v_pk_fma_f32 v[250:251], v[238:239], v[144:145], v[250:251] op_sel:[1,1,0] op_sel_hi:[1,0,1] neg_lo:[1,0,0]
  v_pk_fma_f32 v[232:233], v[238:239], v[250:251], v[232:233] op_sel:[0,0,0] op_sel_hi:[0,1,1]
  v_pk_fma_f32 v[232:233], v[238:239], v[250:251], v[232:233] op_sel:[1,1,0] op_sel_hi:[1,0,1] neg_lo:[1,0,0]
  v_pk_fma_f32 v[142:143], v[238:239], v[232:233], v[142:143] op_sel:[0,0,0] op_sel_hi:[0,1,1]
  v_pk_fma_f32 v[142:143], v[238:239], v[232:233], v[142:143] op_sel:[1,1,0] op_sel_hi:[1,0,1] neg_lo:[1,0,0]
  v_pk_fma_f32 v[8:9], v[238:239], v[142:143], v[8:9] op_sel:[0,0,0] op_sel_hi:[0,1,1]
  v_pk_fma_f32 v[8:9], v[238:239], v[142:143], v[8:9] op_sel:[1,1,0] op_sel_hi:[1,0,1] neg_lo:[1,0,0]
  v_mov_b32 v142, v8
  v_mov_b32 v143, v9
  s_nop 0
  v_permlane32_swap_b32 v8, v142
  v_permlane32_swap_b32 v9, v143
  v_pk_fma_f32 v[8:9], v[234:235], v[142:143], v[8:9] op_sel:[0,0,0] op_sel_hi:[0,1,1]
  v_pk_fma_f32 v[8:9], v[234:235], v[142:143], v[8:9] op_sel:[1,1,0] op_sel_hi:[1,0,1] neg_lo:[1,0,0]
  v_pk_fma_f32 v[140:141], v[10:11], v[8:9], v[140:141] op_sel:[0,0,0] op_sel_hi:[0,1,1]
  v_pk_fma_f32 v[140:141], v[10:11], v[8:9], v[140:141] op_sel:[1,1,0] op_sel_hi:[1,0,1] neg_lo:[1,0,0]
  v_pk_fma_f32 v[138:139], v[136:137], v[8:9], v[138:139] op_sel:[0,0,0] op_sel_hi:[0,1,1]
  v_pk_fma_f32 v[138:139], v[136:137], v[8:9], v[138:139] op_sel:[1,1,0] op_sel_hi:[1,0,1] neg_lo:[1,0,0]
  v_swap_b32 v141, v138
  v_pk_fma_f32 v[40:41], v[226:227], v[140:141], v[40:41] op_sel:[0,0,0] op_sel_hi:[0,1,1]
  v_pk_fma_f32 v[72:73], v[226:227], v[138:139], v[72:73] op_sel:[0,0,0] op_sel_hi:[0,1,1]
  v_pk_fma_f32 v[40:41], v[226:227], v[138:139], v[40:41] op_sel:[1,0,0] op_sel_hi:[1,1,1] neg_lo:[1,0,0] neg_hi:[1,0,0]
  v_pk_fma_f32 v[72:73], v[226:227], v[140:141], v[72:73] op_sel:[1,0,0] op_sel_hi:[1,1,1]
  v_cvt_pk_bf16_f32 v12, v40, v41
  v_cvt_pk_bf16_f32 v13, -v72, -v73
  v_pk_fma_f32 v[42:43], v[226:227], v[40:41], v[42:43] op_sel:[0,0,0] op_sel_hi:[0,1,1]
  v_pk_fma_f32 v[74:75], v[226:227], v[72:73], v[74:75] op_sel:[0,0,0] op_sel_hi:[0,1,1]
  v_pk_fma_f32 v[42:43], v[226:227], v[72:73], v[42:43] op_sel:[1,0,0] op_sel_hi:[1,1,1] neg_lo:[1,0,0] neg_hi:[1,0,0]
  v_pk_fma_f32 v[74:75], v[226:227], v[40:41], v[74:75] op_sel:[1,0,0] op_sel_hi:[1,1,1]
  v_cvt_pk_bf16_f32 v14, v42, v43
  v_cvt_pk_bf16_f32 v15, -v74, -v75
  v_pk_fma_f32 v[44:45], v[226:227], v[42:43], v[44:45] op_sel:[0,0,0] op_sel_hi:[0,1,1]
  v_pk_fma_f32 v[76:77], v[226:227], v[74:75], v[76:77] op_sel:[0,0,0] op_sel_hi:[0,1,1]
  v_permlane32_swap_b32 v12, v13
  v_permlane32_swap_b32 v14, v15
  v_pk_fma_f32 v[44:45], v[226:227], v[74:75], v[44:45] op_sel:[1,0,0] op_sel_hi:[1,1,1] neg_lo:[1,0,0] neg_hi:[1,0,0]
  v_pk_fma_f32 v[76:77], v[226:227], v[42:43], v[76:77] op_sel:[1,0,0] op_sel_hi:[1,1,1]
  v_permlane16_swap_b32 v12, v14
  v_permlane16_swap_b32 v13, v15
  buffer_store_dwordx4 v[12:15], v58, s[80:83], s78 offen sc1
  s_add_u32 s78, s78, 1048576
  v_cvt_pk_bf16_f32 v16, v44, v45
  v_cvt_pk_bf16_f32 v17, -v76, -v77
  v_pk_fma_f32 v[46:47], v[226:227], v[44:45], v[46:47] op_sel:[0,0,0] op_sel_hi:[0,1,1]
  v_pk_fma_f32 v[78:79], v[226:227], v[76:77], v[78:79] op_sel:[0,0,0] op_sel_hi:[0,1,1]
  v_pk_fma_f32 v[46:47], v[226:227], v[76:77], v[46:47] op_sel:[1,0,0] op_sel_hi:[1,1,1] neg_lo:[1,0,0] neg_hi:[1,0,0]
  v_pk_fma_f32 v[78:79], v[226:227], v[44:45], v[78:79] op_sel:[1,0,0] op_sel_hi:[1,1,1]
  v_cvt_pk_bf16_f32 v18, v46, v47
  v_cvt_pk_bf16_f32 v19, -v78, -v79
  v_pk_fma_f32 v[48:49], v[226:227], v[46:47], v[48:49] op_sel:[0,0,0] op_sel_hi:[0,1,1]
  v_pk_fma_f32 v[80:81], v[226:227], v[78:79], v[80:81] op_sel:[0,0,0] op_sel_hi:[0,1,1]
  v_permlane32_swap_b32 v16, v17
  v_permlane32_swap_b32 v18, v19
  v_pk_fma_f32 v[48:49], v[226:227], v[78:79], v[48:49] op_sel:[1,0,0] op_sel_hi:[1,1,1] neg_lo:[1,0,0] neg_hi:[1,0,0]
  v_pk_fma_f32 v[80:81], v[226:227], v[46:47], v[80:81] op_sel:[1,0,0] op_sel_hi:[1,1,1]
  v_permlane16_swap_b32 v16, v18
  v_permlane16_swap_b32 v17, v19
  buffer_store_dwordx4 v[16:19], v58, s[80:83], s78 offen sc1
  s_add_u32 s78, s78, 1048576
  v_cvt_pk_bf16_f32 v20, v48, v49
  v_cvt_pk_bf16_f32 v21, -v80, -v81
  v_pk_fma_f32 v[50:51], v[226:227], v[48:49], v[50:51] op_sel:[0,0,0] op_sel_hi:[0,1,1]
  v_pk_fma_f32 v[82:83], v[226:227], v[80:81], v[82:83] op_sel:[0,0,0] op_sel_hi:[0,1,1]
  v_pk_fma_f32 v[50:51], v[226:227], v[80:81], v[50:51] op_sel:[1,0,0] op_sel_hi:[1,1,1] neg_lo:[1,0,0] neg_hi:[1,0,0]
  v_pk_fma_f32 v[82:83], v[226:227], v[48:49], v[82:83] op_sel:[1,0,0] op_sel_hi:[1,1,1]
  v_cvt_pk_bf16_f32 v22, v50, v51
  v_cvt_pk_bf16_f32 v23, -v82, -v83
  v_pk_fma_f32 v[52:53], v[226:227], v[50:51], v[52:53] op_sel:[0,0,0] op_sel_hi:[0,1,1]
  v_pk_fma_f32 v[84:85], v[226:227], v[82:83], v[84:85] op_sel:[0,0,0] op_sel_hi:[0,1,1]
  v_permlane32_swap_b32 v20, v21
  v_permlane32_swap_b32 v22, v23
  v_pk_fma_f32 v[52:53], v[226:227], v[82:83], v[52:53] op_sel:[1,0,0] op_sel_hi:[1,1,1] neg_lo:[1,0,0] neg_hi:[1,0,0]
  v_pk_fma_f32 v[84:85], v[226:227], v[50:51], v[84:85] op_sel:[1,0,0] op_sel_hi:[1,1,1]
  v_permlane16_swap_b32 v20, v22
  v_permlane16_swap_b32 v21, v23
  buffer_store_dwordx4 v[20:23], v58, s[80:83], s78 offen sc1
  s_add_u32 s78, s78, 1048576
  v_cvt_pk_bf16_f32 v12, v52, v53
  v_cvt_pk_bf16_f32 v13, -v84, -v85
  v_pk_fma_f32 v[54:55], v[226:227], v[52:53], v[54:55] op_sel:[0,0,0] op_sel_hi:[0,1,1]
  v_pk_fma_f32 v[86:87], v[226:227], v[84:85], v[86:87] op_sel:[0,0,0] op_sel_hi:[0,1,1]
  v_pk_fma_f32 v[54:55], v[226:227], v[84:85], v[54:55] op_sel:[1,0,0] op_sel_hi:[1,1,1] neg_lo:[1,0,0] neg_hi:[1,0,0]
  v_pk_fma_f32 v[86:87], v[226:227], v[52:53], v[86:87] op_sel:[1,0,0] op_sel_hi:[1,1,1]
  v_cvt_pk_bf16_f32 v14, v54, v55
  v_cvt_pk_bf16_f32 v15, -v86, -v87
  v_pk_fma_f32 v[88:89], v[226:227], v[54:55], v[88:89] op_sel:[0,0,0] op_sel_hi:[0,1,1]
  v_pk_fma_f32 v[120:121], v[226:227], v[86:87], v[120:121] op_sel:[0,0,0] op_sel_hi:[0,1,1]
  v_permlane32_swap_b32 v12, v13
  v_permlane32_swap_b32 v14, v15
  v_pk_fma_f32 v[88:89], v[226:227], v[86:87], v[88:89] op_sel:[1,0,0] op_sel_hi:[1,1,1] neg_lo:[1,0,0] neg_hi:[1,0,0]
  v_pk_fma_f32 v[120:121], v[226:227], v[54:55], v[120:121] op_sel:[1,0,0] op_sel_hi:[1,1,1]
  v_permlane16_swap_b32 v12, v14
  v_permlane16_swap_b32 v13, v15
  buffer_store_dwordx4 v[12:15], v58, s[80:83], s78 offen sc1
  s_add_u32 s78, s78, 1048576
  v_cvt_pk_bf16_f32 v16, v88, v89
  v_cvt_pk_bf16_f32 v17, -v120, -v121
  v_pk_fma_f32 v[90:91], v[226:227], v[88:89], v[90:91] op_sel:[0,0,0] op_sel_hi:[0,1,1]
  v_pk_fma_f32 v[122:123], v[226:227], v[120:121], v[122:123] op_sel:[0,0,0] op_sel_hi:[0,1,1]
  v_pk_fma_f32 v[90:91], v[226:227], v[120:121], v[90:91] op_sel:[1,0,0] op_sel_hi:[1,1,1] neg_lo:[1,0,0] neg_hi:[1,0,0]
  v_pk_fma_f32 v[122:123], v[226:227], v[88:89], v[122:123] op_sel:[1,0,0] op_sel_hi:[1,1,1]
  v_cvt_pk_bf16_f32 v18, v90, v91
  v_cvt_pk_bf16_f32 v19, -v122, -v123
  v_pk_fma_f32 v[92:93], v[226:227], v[90:91], v[92:93] op_sel:[0,0,0] op_sel_hi:[0,1,1]
  v_pk_fma_f32 v[124:125], v[226:227], v[122:123], v[124:125] op_sel:[0,0,0] op_sel_hi:[0,1,1]
  v_permlane32_swap_b32 v16, v17
  v_permlane32_swap_b32 v18, v19
  v_pk_fma_f32 v[92:93], v[226:227], v[122:123], v[92:93] op_sel:[1,0,0] op_sel_hi:[1,1,1] neg_lo:[1,0,0] neg_hi:[1,0,0]
  v_pk_fma_f32 v[124:125], v[226:227], v[90:91], v[124:125] op_sel:[1,0,0] op_sel_hi:[1,1,1]
  v_permlane16_swap_b32 v16, v18
  v_permlane16_swap_b32 v17, v19
  buffer_store_dwordx4 v[16:19], v58, s[80:83], s78 offen sc1
  s_add_u32 s78, s78, 1048576
  v_cvt_pk_bf16_f32 v20, v92, v93
  v_cvt_pk_bf16_f32 v21, -v124, -v125
  v_pk_fma_f32 v[94:95], v[226:227], v[92:93], v[94:95] op_sel:[0,0,0] op_sel_hi:[0,1,1]
  v_pk_fma_f32 v[126:127], v[226:227], v[124:125], v[126:127] op_sel:[0,0,0] op_sel_hi:[0,1,1]
  v_pk_fma_f32 v[94:95], v[226:227], v[124:125], v[94:95] op_sel:[1,0,0] op_sel_hi:[1,1,1] neg_lo:[1,0,0] neg_hi:[1,0,0]
  v_pk_fma_f32 v[126:127], v[226:227], v[92:93], v[126:127] op_sel:[1,0,0] op_sel_hi:[1,1,1]
  v_cvt_pk_bf16_f32 v22, v94, v95
  v_cvt_pk_bf16_f32 v23, -v126, -v127
  v_pk_fma_f32 v[96:97], v[226:227], v[94:95], v[96:97] op_sel:[0,0,0] op_sel_hi:[0,1,1]
  v_pk_fma_f32 v[128:129], v[226:227], v[126:127], v[128:129] op_sel:[0,0,0] op_sel_hi:[0,1,1]
  v_permlane32_swap_b32 v20, v21
  v_permlane32_swap_b32 v22, v23
  v_pk_fma_f32 v[96:97], v[226:227], v[126:127], v[96:97] op_sel:[1,0,0] op_sel_hi:[1,1,1] neg_lo:[1,0,0] neg_hi:[1,0,0]
  v_pk_fma_f32 v[128:129], v[226:227], v[94:95], v[128:129] op_sel:[1,0,0] op_sel_hi:[1,1,1]
  v_permlane16_swap_b32 v20, v22
  v_permlane16_swap_b32 v21, v23
  buffer_store_dwordx4 v[20:23], v58, s[80:83], s78 offen sc1
  s_add_u32 s78, s78, 1048576
  v_cvt_pk_bf16_f32 v12, v96, v97
  v_cvt_pk_bf16_f32 v13, -v128, -v129
  v_pk_fma_f32 v[98:99], v[226:227], v[96:97], v[98:99] op_sel:[0,0,0] op_sel_hi:[0,1,1]
  v_pk_fma_f32 v[130:131], v[226:227], v[128:129], v[130:131] op_sel:[0,0,0] op_sel_hi:[0,1,1]
  v_pk_fma_f32 v[98:99], v[226:227], v[128:129], v[98:99] op_sel:[1,0,0] op_sel_hi:[1,1,1] neg_lo:[1,0,0] neg_hi:[1,0,0]
  v_pk_fma_f32 v[130:131], v[226:227], v[96:97], v[130:131] op_sel:[1,0,0] op_sel_hi:[1,1,1]
  v_cvt_pk_bf16_f32 v14, v98, v99
  v_cvt_pk_bf16_f32 v15, -v130, -v131
  v_pk_fma_f32 v[100:101], v[226:227], v[98:99], v[100:101] op_sel:[0,0,0] op_sel_hi:[0,1,1]
  v_pk_fma_f32 v[132:133], v[226:227], v[130:131], v[132:133] op_sel:[0,0,0] op_sel_hi:[0,1,1]
  v_permlane32_swap_b32 v12, v13
  v_permlane32_swap_b32 v14, v15
  v_pk_fma_f32 v[100:101], v[226:227], v[130:131], v[100:101] op_sel:[1,0,0] op_sel_hi:[1,1,1] neg_lo:[1,0,0] neg_hi:[1,0,0]
  v_pk_fma_f32 v[132:133], v[226:227], v[98:99], v[132:133] op_sel:[1,0,0] op_sel_hi:[1,1,1]
  v_permlane16_swap_b32 v12, v14
  v_permlane16_swap_b32 v13, v15
  buffer_store_dwordx4 v[12:15], v58, s[80:83], s78 offen sc1
  s_add_u32 s78, s78, 1048576
  v_cvt_pk_bf16_f32 v16, v100, v101
  v_cvt_pk_bf16_f32 v17, -v132, -v133
  v_pk_fma_f32 v[102:103], v[226:227], v[100:101], v[102:103] op_sel:[0,0,0] op_sel_hi:[0,1,1]
  v_pk_fma_f32 v[134:135], v[226:227], v[132:133], v[134:135] op_sel:[0,0,0] op_sel_hi:[0,1,1]
  v_pk_fma_f32 v[102:103], v[226:227], v[132:133], v[102:103] op_sel:[1,0,0] op_sel_hi:[1,1,1] neg_lo:[1,0,0] neg_hi:[1,0,0]
  v_pk_fma_f32 v[134:135], v[226:227], v[100:101], v[134:135] op_sel:[1,0,0] op_sel_hi:[1,1,1]
  v_cvt_pk_bf16_f32 v18, v102, v103
  v_cvt_pk_bf16_f32 v19, -v134, -v135
  v_permlane32_swap_b32 v16, v17
  s_nop 0
  v_permlane32_swap_b32 v18, v19
  s_nop 1
  v_permlane16_swap_b32 v16, v18
  v_permlane16_swap_b32 v17, v19
  buffer_store_dwordx4 v[16:19], v58, s[80:83], s78 offen sc1
  s_cmp_lg_u32 s55, 0
  s_cbranch_scc1 gated_mix__spectral_gfnet__ssm_conv_s5__prompt_kernel_skip32
  s_mul_i32 exec_lo, s77, 0x300
  s_or_b32 exec_lo, exec_lo, 0xff
  s_mov_b32 exec_hi, 0
  ds_read_u16_d16_hi v64, v68
  ds_read_u16_d16_hi v65, v68 offset:1024
  s_waitcnt lgkmcnt(1)
  v_add_f32 v64, v64, v248
  s_waitcnt lgkmcnt(0)
  v_sub_f32 v65, v65, v249
  v_mul_f32 v64, 0.5, v64
  v_mul_f32 v65, 0.5, v65
  v_cvt_pk_bf16_f32 v64, v64, v65
  ds_write_b16 v68, v64
  ds_write_b16_d16_hi v68, v64 offset:1024
  s_mov_b64 exec, -1
gated_mix__spectral_gfnet__ssm_conv_s5__prompt_kernel_skip32:
  s_cmp_eq_u32 s77, 0
  s_cbranch_scc1 gated_mix__spectral_gfnet__ssm_conv_s5__prompt_kernel_skip33
  v_add_u32 v61, 147456, v38
  ds_read_u16_d16_hi v64, v61 offset:0
  ds_read_u16_d16_hi v72, v61 offset:1024
  ds_read_u16_d16_hi v65, v61 offset:128
  ds_read_u16_d16_hi v73, v61 offset:1152
  ds_read_u16_d16_hi v66, v61 offset:256
  ds_read_u16_d16_hi v74, v61 offset:1280
  ds_read_u16_d16_hi v67, v61 offset:384
  ds_read_u16_d16_hi v75, v61 offset:1408
gated_mix__spectral_gfnet__ssm_conv_s5__prompt_kernel_skip33:
  ds_read_u16_d16_hi v8, v38 offset:0
  ds_read_u16_d16_hi v12, v38 offset:1024
  ds_read_u16_d16_hi v9, v38 offset:128
  ds_read_u16_d16_hi v13, v38 offset:1152
  ds_read_u16_d16_hi v10, v38 offset:256
  ds_read_u16_d16_hi v14, v38 offset:1280
  ds_read_u16_d16_hi v11, v38 offset:384
  ds_read_u16_d16_hi v15, v38 offset:1408
  ds_read_u16_d16_hi v16, v38 offset:16384
  ds_read_u16_d16_hi v20, v38 offset:17408
  ds_read_u16_d16_hi v17, v38 offset:16512
  ds_read_u16_d16_hi v21, v38 offset:17536
  ds_read_u16_d16_hi v18, v38 offset:16640
  ds_read_u16_d16_hi v22, v38 offset:17664
  ds_read_u16_d16_hi v19, v38 offset:16768
  ds_read_u16_d16_hi v23, v38 offset:17792
  v_add_u32 v61, 81920, v38
  ds_read_u16_d16_hi v40, v61 offset:0
  ds_read_u16_d16_hi v44, v61 offset:1024
  ds_read_u16_d16_hi v41, v61 offset:128
  ds_read_u16_d16_hi v45, v61 offset:1152
  ds_read_u16_d16_hi v42, v61 offset:256
  ds_read_u16_d16_hi v46, v61 offset:1280
  ds_read_u16_d16_hi v43, v61 offset:384
  ds_read_u16_d16_hi v47, v61 offset:1408
  ds_read_u16_d16_hi v48, v38 offset:32768
  ds_read_u16_d16_hi v52, v38 offset:33792
  ds_read_u16_d16_hi v49, v38 offset:32896
  ds_read_u16_d16_hi v53, v38 offset:33920
  ds_read_u16_d16_hi v50, v38 offset:33024
  ds_read_u16_d16_hi v54, v38 offset:34048
  ds_read_u16_d16_hi v51, v38 offset:33152
  ds_read_u16_d16_hi v55, v38 offset:34176
  v_xor_b32 v222, 0x30000, v222
  v_xor_b32 v223, 0x30000, v223
  ds_read_b128 a[0:3], v222 offset:0
  ds_read_b128 a[4:7], v223 offset:0
  ds_read_b128 a[8:11], v222 offset:2048
  ds_read_b128 a[12:15], v223 offset:2048
  v_xor_b32 v222, 0x30000, v222
  v_xor_b32 v223, 0x30000, v223
  ds_read_b128 a[16:19], v222 offset:0
  ds_read_b128 a[20:23], v223 offset:0
  ds_read_b128 a[24:27], v222 offset:2048
  ds_read_b128 a[28:31], v223 offset:2048
  s_waitcnt vmcnt(8)
  ds_read_b128 a[32:35], v222 offset:49152
  ds_read_b128 a[36:39], v223 offset:49152
  ds_read_b128 a[40:43], v222 offset:51200
  ds_read_b128 a[44:47], v223 offset:51200
  s_waitcnt lgkmcnt(12)
  v_pk_mul_f32 v[12:13], v[224:225], v[12:13] op_sel_hi:[0,1]
  v_pk_mul_f32 v[14:15], v[224:225], v[14:15] op_sel_hi:[0,1]
  v_pk_mul_f32 v[20:21], v[224:225], v[20:21] op_sel_hi:[0,1]
  v_pk_mul_f32 v[22:23], v[224:225], v[22:23] op_sel_hi:[0,1]
  v_pk_mul_f32 v[44:45], v[224:225], v[44:45] op_sel_hi:[0,1]
  v_pk_mul_f32 v[46:47], v[224:225], v[46:47] op_sel_hi:[0,1]
  v_pk_mul_f32 v[52:53], v[224:225], v[52:53] op_sel_hi:[0,1]
  v_pk_mul_f32 v[54:55], v[224:225], v[54:55] op_sel_hi:[0,1]
  v_pk_mul_f32 v[72:73], v[224:225], v[72:73] op_sel_hi:[0,1]
  v_pk_mul_f32 v[74:75], v[224:225], v[74:75] op_sel_hi:[0,1]
  s_cmp_lg_u32 s3, 3
  s_cbranch_scc1 gated_mix__spectral_gfnet__ssm_conv_s5__prompt_kernel_skip35
  s_getpc_b64 s[6:7]
gated_mix__spectral_gfnet__ssm_conv_s5__prompt_kernel_pc34:
  s_lshr_b32 s33, s2, 3
  s_mul_i32 s33, s33, 512
  v_min_u32 v38, 3, v1
  v_lshl_add_u32 v38, v38, 7, s33
  v_min_u32 v38, gated_mix__spectral_gfnet__ssm_conv_s5__prompt_kernel_end-gated_mix__spectral_gfnet__ssm_conv_s5__prompt_kernel_pc34, v38
  v_mov_b32 v39, 0
  v_lshl_add_u64 v[38:39], v[38:39], 0, s[6:7]
  global_load_dword v4, v[38:39], off
gated_mix__spectral_gfnet__ssm_conv_s5__prompt_kernel_skip35:
  s_barrier
  s_cmp_lg_u32 s3, 0
  s_cbranch_scc1 gated_mix__spectral_gfnet__ssm_conv_s5__prompt_kernel_skip36
  v_lshlrev_b32 v38, 2, v2
  v_add_u32 v39, 155648, v38
  ds_read_b32 v39, v39
  s_lshl_b32 s33, s39, 11
  s_lshl_b32 s43, s38, 7
  s_add_u32 s33, s33, s43
  s_mov_b64 exec, 0xffff
  s_waitcnt lgkmcnt(0)
  buffer_store_dword v39, v38, s[88:91], s33 offen sc1
  s_mov_b64 exec, -1
gated_mix__spectral_gfnet__ssm_conv_s5__prompt_kernel_skip36:
  s_lshr_b32 s33, s41, 3
  s_lshl2_add_u32 s33, s33, s3
  s_lshl_b32 s33, s33, 12
  v_lshl_add_u32 v5, v1, 7, s33
  s_add_u32 m0, s32, 98304
  s_nop 0
  buffer_load_dwordx4 v216, s[24:27], s29 offen offset:0 lds
  s_and_b32 s33, s3, 1
  s_lshl_b32 s33, s33, 2
  v_xor_b32 v38, s33, v1
  s_lshl_b32 s33, s3, 12
  s_add_u32 s33, s33, 49152
  v_lshl_add_u32 v39, v38, 4, s33
  v_xor_b32 v38, 0, v39
  ds_read_b128 v[68:71], v38 offset:0
  v_xor_b32 v38, 16, v39
  ds_read_b128 v[76:79], v38 offset:1024
  v_xor_b32 v38, 32, v39
  ds_read_b128 v[80:83], v38 offset:2048
  v_xor_b32 v38, 48, v39
  ds_read_b128 v[84:87], v38 offset:3072
  s_waitcnt lgkmcnt(3)
  v_mfma_f32_16x16x32_bf16 v[88:91], v[68:71], v[112:115], 0
  v_mfma_f32_16x16x32_bf16 v[92:95], v[68:71], v[116:119], 0
  buffer_load_dwordx4 v217, s[24:27], s29 offen offset:1024 lds
  s_waitcnt lgkmcnt(2)
  v_mfma_f32_16x16x32_bf16 v[96:99], v[76:79], v[112:115], 0
  v_mfma_f32_16x16x32_bf16 v[100:103], v[76:79], v[116:119], 0
  s_waitcnt lgkmcnt(1)
  v_mfma_f32_16x16x32_bf16 v[104:107], v[80:83], v[112:115], 0
  v_mfma_f32_16x16x32_bf16 v[108:111], v[80:83], v[116:119], 0
  s_waitcnt lgkmcnt(0)
  v_mfma_f32_16x16x32_bf16 v[120:123], v[84:87], v[112:115], 0
  s_add_u32 m0, s32, 100352
  s_nop 0
  buffer_load_dwordx4 v218, s[24:27], s29 offen offset:0 lds
  v_mfma_f32_16x16x32_bf16 v[124:127], v[84:87], v[116:119], 0
  v_pk_mul_f32 v[128:129], v[88:89], v[200:201]
  v_pk_mul_f32 v[130:131], v[92:93], v[200:201]
  v_pk_fma_f32 v[128:129], v[92:93], v[204:205], v[128:129]
  v_pk_fma_f32 v[130:131], v[88:89], v[204:205], v[130:131] neg_lo:[0,1,0] neg_hi:[0,1,0]
  v_cvt_pk_bf16_f32 v68, v128, v130
  v_cvt_pk_bf16_f32 v69, v129, v131
  v_pk_mul_f32 v[128:129], v[90:91], v[202:203]
  v_pk_mul_f32 v[130:131], v[94:95], v[202:203]
  v_pk_fma_f32 v[128:129], v[94:95], v[206:207], v[128:129]
  v_pk_fma_f32 v[130:131], v[90:91], v[206:207], v[130:131] neg_lo:[0,1,0] neg_hi:[0,1,0]
  v_cvt_pk_bf16_f32 v70, v128, v130
  v_cvt_pk_bf16_f32 v71, v129, v131
  v_pk_mul_f32 v[128:129], v[96:97], v[200:201]
  v_pk_mul_f32 v[130:131], v[100:101], v[200:201]
  v_pk_fma_f32 v[128:129], v[100:101], v[204:205], v[128:129]
  v_pk_fma_f32 v[130:131], v[96:97], v[204:205], v[130:131] neg_lo:[0,1,0] neg_hi:[0,1,0]
  buffer_load_dwordx4 v219, s[24:27], s29 offen offset:1024 lds
  s_add_u32 s29, s29, 128
  s_and_b32 s29, s29, 0x3ff
  v_cvt_pk_bf16_f32 v76, v128, v130
  v_cvt_pk_bf16_f32 v77, v129, v131
  v_pk_mul_f32 v[128:129], v[98:99], v[202:203]
  v_pk_mul_f32 v[130:131], v[102:103], v[202:203]
  v_pk_fma_f32 v[128:129], v[102:103], v[206:207], v[128:129]
  v_pk_fma_f32 v[130:131], v[98:99], v[206:207], v[130:131] neg_lo:[0,1,0] neg_hi:[0,1,0]
  v_cvt_pk_bf16_f32 v78, v128, v130
  v_cvt_pk_bf16_f32 v79, v129, v131
  v_mfma_f32_16x16x32_bf16 v[88:91], a[224:227], v[68:71], 0
  v_mfma_f32_16x16x32_bf16 v[92:95], a[228:231], v[68:71], 0
  v_pk_mul_f32 v[128:129], v[104:105], v[200:201]
  v_pk_mul_f32 v[130:131], v[108:109], v[200:201]
  v_pk_fma_f32 v[128:129], v[108:109], v[204:205], v[128:129]
  v_pk_fma_f32 v[130:131], v[104:105], v[204:205], v[130:131] neg_lo:[0,1,0] neg_hi:[0,1,0]
  s_add_u32 m0, s32, 131072
  s_nop 0
  buffer_load_dwordx4 v216, s[12:15], s29 offen offset:0 lds
  v_cvt_pk_bf16_f32 v80, v128, v130
  v_cvt_pk_bf16_f32 v81, v129, v131
  v_pk_mul_f32 v[128:129], v[106:107], v[202:203]
  v_pk_mul_f32 v[130:131], v[110:111], v[202:203]
  v_pk_fma_f32 v[128:129], v[110:111], v[206:207], v[128:129]
  v_pk_fma_f32 v[130:131], v[106:107], v[206:207], v[130:131] neg_lo:[0,1,0] neg_hi:[0,1,0]
  v_cvt_pk_bf16_f32 v82, v128, v130
  v_cvt_pk_bf16_f32 v83, v129, v131
  v_mfma_f32_16x16x32_bf16 v[96:99], a[224:227], v[76:79], 0
  v_mfma_f32_16x16x32_bf16 v[100:103], a[228:231], v[76:79], 0
  v_pk_mul_f32 v[128:129], v[120:121], v[200:201]
  v_pk_mul_f32 v[130:131], v[124:125], v[200:201]
  v_pk_fma_f32 v[128:129], v[124:125], v[204:205], v[128:129]
  v_pk_fma_f32 v[130:131], v[120:121], v[204:205], v[130:131] neg_lo:[0,1,0] neg_hi:[0,1,0]
  buffer_load_dwordx4 v217, s[12:15], s29 offen offset:1024 lds
  v_cvt_pk_bf16_f32 v84, v128, v130
  v_cvt_pk_bf16_f32 v85, v129, v131
  v_pk_mul_f32 v[128:129], v[122:123], v[202:203]
  v_pk_mul_f32 v[130:131], v[126:127], v[202:203]
  v_pk_fma_f32 v[128:129], v[126:127], v[206:207], v[128:129]
  v_pk_fma_f32 v[130:131], v[122:123], v[206:207], v[130:131] neg_lo:[0,1,0] neg_hi:[0,1,0]
  v_cvt_pk_bf16_f32 v86, v128, v130
  v_cvt_pk_bf16_f32 v87, v129, v131
  v_mfma_f32_16x16x32_bf16 v[104:107], a[224:227], v[80:83], 0
  v_mfma_f32_16x16x32_bf16 v[108:111], a[228:231], v[80:83], 0
  v_mfma_f32_16x16x32_bf16 v[120:123], a[224:227], v[84:87], 0
  s_add_u32 m0, s32, 133120
  s_nop 0
  buffer_load_dwordx4 v218, s[12:15], s29 offen offset:0 lds
  v_mfma_f32_16x16x32_bf16 v[124:127], a[228:231], v[84:87], 0
  s_waitcnt vmcnt(7)
  s_barrier
  s_cmp_lg_u32 s3, 0
  s_cbranch_scc1 gated_mix__spectral_gfnet__ssm_conv_s5__prompt_kernel_skip37
  s_mov_b64 exec, 65535
  buffer_store_dword v7, v57, s[16:19], s28 offen sc1
  s_mov_b64 exec, -1
gated_mix__spectral_gfnet__ssm_conv_s5__prompt_kernel_skip37:
  s_cmp_eq_u32 s5, 0
  s_cbranch_scc1 gated_mix__spectral_gfnet__ssm_conv_s5__prompt_kernel_skip38
  v_pk_mul_f32 v[128:129], v[88:89], v[64:65]
  v_pk_mul_f32 v[130:131], v[92:93], v[64:65]
  v_pk_fma_f32 v[128:129], v[92:93], v[72:73], v[128:129] neg_lo:[0,1,0] neg_hi:[0,1,0]
  v_pk_fma_f32 v[130:131], v[88:89], v[72:73], v[130:131]
  v_cvt_pk_bf16_f32 v132, v128, v130
  v_cvt_pk_bf16_f32 v133, v129, v131
  v_pk_mul_f32 v[128:129], v[90:91], v[66:67]
  v_pk_mul_f32 v[130:131], v[94:95], v[66:67]
  v_pk_fma_f32 v[128:129], v[94:95], v[74:75], v[128:129] neg_lo:[0,1,0] neg_hi:[0,1,0]
  v_pk_fma_f32 v[130:131], v[90:91], v[74:75], v[130:131]
  v_cvt_pk_bf16_f32 v134, v128, v130
  v_cvt_pk_bf16_f32 v135, v129, v131
  s_nop 1
  v_mfma_f32_16x16x32_bf16 v[64:67], v[132:135], a[232:235], 0
  v_mfma_f32_16x16x32_bf16 v[72:75], v[132:135], a[236:239], 0
  s_nop 6
  v_pk_mul_f32 v[128:129], v[64:65], v[208:209]
  v_pk_mul_f32 v[130:131], v[72:73], v[208:209]
  v_pk_fma_f32 v[128:129], v[72:73], v[212:213], v[128:129] neg_lo:[0,1,0] neg_hi:[0,1,0]
  v_pk_fma_f32 v[130:131], v[64:65], v[212:213], v[130:131]
  v_cvt_pk_bf16_f32 v132, v128, v130
  v_cvt_pk_bf16_f32 v133, v129, v131
  v_pk_mul_f32 v[128:129], v[66:67], v[210:211]
  v_pk_mul_f32 v[130:131], v[74:75], v[210:211]
  v_pk_fma_f32 v[128:129], v[74:75], v[214:215], v[128:129] neg_lo:[0,1,0] neg_hi:[0,1,0]
  v_pk_fma_f32 v[130:131], v[66:67], v[214:215], v[130:131]
  v_cvt_pk_bf16_f32 v134, v128, v130
  v_cvt_pk_bf16_f32 v135, v129, v131
  s_nop 1
  v_mfma_f32_16x16x32_bf16 v[64:67], a[240:243], v[132:135], 0
  v_mfma_f32_16x16x32_bf16 v[72:75], a[244:247], v[132:135], 0
gated_mix__spectral_gfnet__ssm_conv_s5__prompt_kernel_skip38:
  v_pk_mul_f32 v[128:129], v[88:89], v[8:9]
  v_pk_mul_f32 v[130:131], v[92:93], v[8:9]
  v_pk_fma_f32 v[128:129], v[92:93], v[12:13], v[128:129] neg_lo:[0,1,0] neg_hi:[0,1,0]
  v_pk_fma_f32 v[130:131], v[88:89], v[12:13], v[130:131]
  v_cvt_pk_bf16_f32 v68, v128, v130
  v_cvt_pk_bf16_f32 v69, v129, v131
  v_pk_mul_f32 v[128:129], v[90:91], v[10:11]
  v_pk_mul_f32 v[130:131], v[94:95], v[10:11]
  v_pk_fma_f32 v[128:129], v[94:95], v[14:15], v[128:129] neg_lo:[0,1,0] neg_hi:[0,1,0]
  v_pk_fma_f32 v[130:131], v[90:91], v[14:15], v[130:131]
  v_cvt_pk_bf16_f32 v70, v128, v130
  buffer_load_dwordx4 v219, s[12:15], s29 offen offset:1024 lds
  v_cvt_pk_bf16_f32 v71, v129, v131
  v_pk_mul_f32 v[128:129], v[96:97], v[16:17]
  v_pk_mul_f32 v[130:131], v[100:101], v[16:17]
  v_pk_fma_f32 v[128:129], v[100:101], v[20:21], v[128:129] neg_lo:[0,1,0] neg_hi:[0,1,0]
  v_pk_fma_f32 v[130:131], v[96:97], v[20:21], v[130:131]
  v_cvt_pk_bf16_f32 v76, v128, v130
  v_cvt_pk_bf16_f32 v77, v129, v131
  v_pk_mul_f32 v[128:129], v[98:99], v[18:19]
  v_pk_mul_f32 v[130:131], v[102:103], v[18:19]
  v_pk_fma_f32 v[128:129], v[102:103], v[22:23], v[128:129] neg_lo:[0,1,0] neg_hi:[0,1,0]
  v_pk_fma_f32 v[130:131], v[98:99], v[22:23], v[130:131]
  v_cvt_pk_bf16_f32 v78, v128, v130
  v_cvt_pk_bf16_f32 v79, v129, v131
  v_mfma_f32_16x16x32_bf16 v[88:91], v[68:71], a[232:235], 0
  v_mfma_f32_16x16x32_bf16 v[92:95], v[68:71], a[236:239], 0
  s_add_u32 m0, s32, 65536
  s_nop 0
  buffer_load_dwordx4 v216, s[24:27], s29 offen offset:0 lds
  v_pk_mul_f32 v[128:129], v[104:105], v[40:41]
  v_pk_mul_f32 v[130:131], v[108:109], v[40:41]
  v_pk_fma_f32 v[128:129], v[108:109], v[44:45], v[128:129] neg_lo:[0,1,0] neg_hi:[0,1,0]
  v_pk_fma_f32 v[130:131], v[104:105], v[44:45], v[130:131]
  v_cvt_pk_bf16_f32 v80, v128, v130
  v_cvt_pk_bf16_f32 v81, v129, v131
  v_pk_mul_f32 v[128:129], v[106:107], v[42:43]
  v_pk_mul_f32 v[130:131], v[110:111], v[42:43]
  v_pk_fma_f32 v[128:129], v[110:111], v[46:47], v[128:129] neg_lo:[0,1,0] neg_hi:[0,1,0]
  v_pk_fma_f32 v[130:131], v[106:107], v[46:47], v[130:131]
  v_cvt_pk_bf16_f32 v82, v128, v130
  v_cvt_pk_bf16_f32 v83, v129, v131
  v_mfma_f32_16x16x32_bf16 v[96:99], v[76:79], a[232:235], 0
  v_mfma_f32_16x16x32_bf16 v[100:103], v[76:79], a[236:239], 0
  buffer_load_dwordx4 v217, s[24:27], s29 offen offset:1024 lds
  v_pk_mul_f32 v[128:129], v[120:121], v[48:49]
  v_pk_mul_f32 v[130:131], v[124:125], v[48:49]
  v_pk_fma_f32 v[128:129], v[124:125], v[52:53], v[128:129] neg_lo:[0,1,0] neg_hi:[0,1,0]
  v_pk_fma_f32 v[130:131], v[120:121], v[52:53], v[130:131]
  v_cvt_pk_bf16_f32 v84, v128, v130
  v_cvt_pk_bf16_f32 v85, v129, v131
  v_pk_mul_f32 v[128:129], v[122:123], v[50:51]
  v_pk_mul_f32 v[130:131], v[126:127], v[50:51]
  v_pk_fma_f32 v[128:129], v[126:127], v[54:55], v[128:129] neg_lo:[0,1,0] neg_hi:[0,1,0]
  v_pk_fma_f32 v[130:131], v[122:123], v[54:55], v[130:131]
  v_cvt_pk_bf16_f32 v86, v128, v130
  v_cvt_pk_bf16_f32 v87, v129, v131
  v_mfma_f32_16x16x32_bf16 v[104:107], v[80:83], a[232:235], 0
  v_mfma_f32_16x16x32_bf16 v[108:111], v[80:83], a[236:239], 0
  s_add_u32 m0, s32, 67584
  s_nop 0
  buffer_load_dwordx4 v218, s[24:27], s29 offen offset:0 lds
  v_mfma_f32_16x16x32_bf16 v[120:123], v[84:87], a[232:235], 0
  v_mfma_f32_16x16x32_bf16 v[124:127], v[84:87], a[236:239], 0
  v_pk_mul_f32 v[128:129], v[88:89], v[208:209]
  v_pk_mul_f32 v[130:131], v[92:93], v[208:209]
  v_pk_fma_f32 v[128:129], v[92:93], v[212:213], v[128:129] neg_lo:[0,1,0] neg_hi:[0,1,0]
  v_pk_fma_f32 v[130:131], v[88:89], v[212:213], v[130:131]
  v_cvt_pk_bf16_f32 v68, v128, v130
  v_cvt_pk_bf16_f32 v69, v129, v131
  v_pk_mul_f32 v[128:129], v[90:91], v[210:211]
  v_pk_mul_f32 v[130:131], v[94:95], v[210:211]
  v_pk_fma_f32 v[128:129], v[94:95], v[214:215], v[128:129] neg_lo:[0,1,0] neg_hi:[0,1,0]
  v_pk_fma_f32 v[130:131], v[90:91], v[214:215], v[130:131]
  v_cvt_pk_bf16_f32 v70, v128, v130
  v_cvt_pk_bf16_f32 v71, v129, v131
  buffer_load_dwordx4 v219, s[24:27], s29 offen offset:1024 lds
  s_add_u32 s29, s29, 128
  s_and_b32 s29, s29, 0x3ff
  v_pk_mul_f32 v[128:129], v[96:97], v[208:209]
  v_pk_mul_f32 v[130:131], v[100:101], v[208:209]
  v_pk_fma_f32 v[128:129], v[100:101], v[212:213], v[128:129] neg_lo:[0,1,0] neg_hi:[0,1,0]
  v_pk_fma_f32 v[130:131], v[96:97], v[212:213], v[130:131]
  v_cvt_pk_bf16_f32 v76, v128, v130
  v_cvt_pk_bf16_f32 v77, v129, v131
  v_pk_mul_f32 v[128:129], v[98:99], v[210:211]
  v_pk_mul_f32 v[130:131], v[102:103], v[210:211]
  v_pk_fma_f32 v[128:129], v[102:103], v[214:215], v[128:129] neg_lo:[0,1,0] neg_hi:[0,1,0]
  v_pk_fma_f32 v[130:131], v[98:99], v[214:215], v[130:131]
  v_cvt_pk_bf16_f32 v78, v128, v130
  v_cvt_pk_bf16_f32 v79, v129, v131
  v_mfma_f32_16x16x32_bf16 v[88:91], a[240:243], v[68:71], 0
  v_mfma_f32_16x16x32_bf16 v[92:95], a[244:247], v[68:71], 0
  s_add_u32 m0, s32, 114688
  s_nop 0
  buffer_load_dwordx4 v216, s[12:15], s29 offen offset:0 lds
  v_pk_mul_f32 v[128:129], v[104:105], v[208:209]
  v_pk_mul_f32 v[130:131], v[108:109], v[208:209]
  v_pk_fma_f32 v[128:129], v[108:109], v[212:213], v[128:129] neg_lo:[0,1,0] neg_hi:[0,1,0]
  v_pk_fma_f32 v[130:131], v[104:105], v[212:213], v[130:131]
  v_cvt_pk_bf16_f32 v80, v128, v130
  v_cvt_pk_bf16_f32 v81, v129, v131
  v_pk_mul_f32 v[128:129], v[106:107], v[210:211]
  v_pk_mul_f32 v[130:131], v[110:111], v[210:211]
  v_pk_fma_f32 v[128:129], v[110:111], v[214:215], v[128:129] neg_lo:[0,1,0] neg_hi:[0,1,0]
  v_pk_fma_f32 v[130:131], v[106:107], v[214:215], v[130:131]
  v_cvt_pk_bf16_f32 v82, v128, v130
  v_cvt_pk_bf16_f32 v83, v129, v131
  v_mfma_f32_16x16x32_bf16 v[96:99], a[240:243], v[76:79], 0
  v_mfma_f32_16x16x32_bf16 v[100:103], a[244:247], v[76:79], 0
  buffer_load_dwordx4 v217, s[12:15], s29 offen offset:1024 lds
  v_pk_mul_f32 v[128:129], v[120:121], v[208:209]
  v_pk_mul_f32 v[130:131], v[124:125], v[208:209]
  v_pk_fma_f32 v[128:129], v[124:125], v[212:213], v[128:129] neg_lo:[0,1,0] neg_hi:[0,1,0]
  v_pk_fma_f32 v[130:131], v[120:121], v[212:213], v[130:131]
  v_cvt_pk_bf16_f32 v84, v128, v130
  v_cvt_pk_bf16_f32 v85, v129, v131
  v_pk_mul_f32 v[128:129], v[122:123], v[210:211]
  v_pk_mul_f32 v[130:131], v[126:127], v[210:211]
  v_pk_fma_f32 v[128:129], v[126:127], v[214:215], v[128:129] neg_lo:[0,1,0] neg_hi:[0,1,0]
  v_pk_fma_f32 v[130:131], v[122:123], v[214:215], v[130:131]
  v_cvt_pk_bf16_f32 v86, v128, v130
  v_cvt_pk_bf16_f32 v87, v129, v131
  v_mfma_f32_16x16x32_bf16 v[104:107], a[240:243], v[80:83], 0
  v_mfma_f32_16x16x32_bf16 v[108:111], a[244:247], v[80:83], 0
  s_add_u32 m0, s32, 116736
  s_nop 0
  buffer_load_dwordx4 v218, s[12:15], s29 offen offset:0 lds
  v_mfma_f32_16x16x32_bf16 v[120:123], a[240:243], v[84:87], 0
  v_mfma_f32_16x16x32_bf16 v[124:127], a[244:247], v[84:87], 0
  v_lshlrev_b32 v38, 12, v3
  v_lshl_add_u32 v38, v2, 4, v38
  s_lshl_b32 s33, s3, 8
  s_add_u32 s33, s33, 147456
  v_add_u32 v38, s33, v38
  s_sub_u32 s33, s5, 1
  s_or_b32 s33, s33, s3
  s_cmp_lg_u32 s33, 0
  s_cbranch_scc1 gated_mix__spectral_gfnet__ssm_conv_s5__prompt_kernel_skip39
  v_mov_b32 v92, v72
  v_mov_b32 v93, v73
  v_mov_b32 v94, v74
  v_mov_b32 v95, v75
gated_mix__spectral_gfnet__ssm_conv_s5__prompt_kernel_skip39:
  v_cvt_pk_bf16_f32 v68, v88, v92
  v_cvt_pk_bf16_f32 v69, v96, v100
  v_cvt_pk_bf16_f32 v70, v104, v108
  buffer_load_dwordx4 v219, s[12:15], s29 offen offset:1024 lds
  v_cvt_pk_bf16_f32 v71, v120, v124
  ds_write_b128 v38, v[68:71] offset:0
  v_cvt_pk_bf16_f32 v76, v89, v93
  v_cvt_pk_bf16_f32 v77, v97, v101
  v_cvt_pk_bf16_f32 v78, v105, v109
  v_cvt_pk_bf16_f32 v79, v121, v125
  ds_write_b128 v38, v[76:79] offset:1024
  v_cvt_pk_bf16_f32 v80, v90, v94
  v_cvt_pk_bf16_f32 v81, v98, v102
  v_cvt_pk_bf16_f32 v82, v106, v110
  v_cvt_pk_bf16_f32 v83, v122, v126
  ds_write_b128 v38, v[80:83] offset:2048
  v_cvt_pk_bf16_f32 v84, v91, v95
  v_cvt_pk_bf16_f32 v85, v99, v103
  v_cvt_pk_bf16_f32 v86, v107, v111
  v_cvt_pk_bf16_f32 v87, v123, v127
  ds_write_b128 v38, v[84:87] offset:3072
  s_add_u32 m0, s32, 0
  s_nop 0
  buffer_load_dwordx4 v216, s[24:27], s29 offen offset:0 lds
  buffer_load_dwordx4 v217, s[24:27], s29 offen offset:1024 lds
  s_add_u32 m0, s32, 2048
  s_nop 0
  buffer_load_dwordx4 v218, s[24:27], s29 offen offset:0 lds
  buffer_load_dwordx4 v219, s[24:27], s29 offen offset:1024 lds
  s_add_u32 s29, s29, 128
  s_and_b32 s29, s29, 0x3ff
  s_add_u32 m0, s32, 16384
  s_nop 0
  buffer_load_dwordx4 v216, s[12:15], s29 offen offset:0 lds
  buffer_load_dwordx4 v217, s[12:15], s29 offen offset:1024 lds
  s_add_u32 m0, s32, 18432
  s_nop 0
  buffer_load_dwordx4 v218, s[12:15], s29 offen offset:0 lds
  buffer_load_dwordx4 v219, s[12:15], s29 offen offset:1024 lds
  s_waitcnt lgkmcnt(0)
  s_barrier
  s_lshl_b32 s33, s3, 12
  s_add_u32 s33, s33, 147456
  v_lshl_add_u32 v38, v1, 4, s33
  ds_read_b128 v[8:11], v38 offset:0
  ds_read_b128 v[12:15], v38 offset:1024
  ds_read_b128 v[16:19], v38 offset:2048
  ds_read_b128 v[20:23], v38 offset:3072
  s_mov_b32 s33, 1048576
  v_mul_lo_u32 v38, v3, s33
  v_lshl_add_u32 v38, v2, 2, v38
  s_mul_i32 s43, s3, 65536
  s_lshr_b32 s33, s37, 4
  s_lshl_b32 s33, s33, 12
  s_add_u32 s43, s43, s33
  s_lshl_b32 s33, s36, 10
  s_add_u32 s43, s43, s33
  s_and_b32 s33, s37, 15
  s_lshl_b32 s33, s33, 6
  s_add_u32 s43, s43, s33
  s_waitcnt lgkmcnt(3)
  v_mfma_f32_16x16x32_bf16 v[40:43], a[248:251], v[8:11], 0
  v_mfma_f32_16x16x32_bf16 v[44:47], a[252:255], v[8:11], 0
  s_waitcnt lgkmcnt(2)
  v_mfma_f32_16x16x32_bf16 v[48:51], a[248:251], v[12:15], 0
  v_mfma_f32_16x16x32_bf16 v[52:55], a[252:255], v[12:15], 0
  s_waitcnt lgkmcnt(1)
  v_mfma_f32_16x16x32_bf16 v[64:67], a[248:251], v[16:19], 0
  v_mfma_f32_16x16x32_bf16 v[68:71], a[252:255], v[16:19], 0
  s_waitcnt lgkmcnt(0)
  v_mfma_f32_16x16x32_bf16 v[72:75], a[248:251], v[20:23], 0
  v_mfma_f32_16x16x32_bf16 v[76:79], a[252:255], v[20:23], 0
  v_cvt_pk_bf16_f32 v8, v40, v44
  v_cvt_pk_bf16_f32 v9, v41, v45
  v_cvt_pk_bf16_f32 v10, v42, v46
  v_cvt_pk_bf16_f32 v11, v43, v47
  v_cvt_pk_bf16_f32 v12, v48, v52
  v_cvt_pk_bf16_f32 v13, v49, v53
  v_cvt_pk_bf16_f32 v14, v50, v54
  v_cvt_pk_bf16_f32 v15, v51, v55
  v_cvt_pk_bf16_f32 v16, v64, v68
  v_cvt_pk_bf16_f32 v17, v65, v69
  v_cvt_pk_bf16_f32 v18, v66, v70
  v_cvt_pk_bf16_f32 v19, v67, v71
  v_cvt_pk_bf16_f32 v20, v72, v76
  v_cvt_pk_bf16_f32 v21, v73, v77
  v_cvt_pk_bf16_f32 v22, v74, v78
  v_cvt_pk_bf16_f32 v23, v75, v79
  s_mov_b64 exec, 0xffffffff
  buffer_load_dword v58, v5, s[16:19], s28 offen sc1
  s_mov_b64 exec, -1
  s_waitcnt vmcnt(21)
  ds_read_b128 a[48:51], v222 offset:32768
  ds_read_b128 a[52:55], v223 offset:32768
  ds_read_b128 a[56:59], v222 offset:34816
  ds_read_b128 a[60:63], v223 offset:34816
  v_xor_b32 v222, 0x30000, v222
  v_xor_b32 v223, 0x30000, v223
  s_waitcnt vmcnt(17)
  ds_read_b128 a[64:67], v222 offset:0
  ds_read_b128 a[68:71], v223 offset:0
  ds_read_b128 a[72:75], v222 offset:2048
  ds_read_b128 a[76:79], v223 offset:2048
  v_xor_b32 v222, 0x30000, v222
  v_xor_b32 v223, 0x30000, v223
  s_waitcnt vmcnt(13)
  ds_read_b128 a[80:83], v222 offset:0
  ds_read_b128 a[84:87], v223 offset:0
  ds_read_b128 a[88:91], v222 offset:2048
  ds_read_b128 a[92:95], v223 offset:2048
  s_waitcnt vmcnt(9)
  ds_read_b128 a[96:99], v222 offset:49152
  ds_read_b128 a[100:103], v223 offset:49152
  ds_read_b128 a[104:107], v222 offset:51200
  ds_read_b128 a[108:111], v223 offset:51200
  s_waitcnt vmcnt(5)
  ds_read_b128 a[112:115], v220 offset:0
  ds_read_b128 a[116:119], v221 offset:0
  ds_read_b128 a[120:123], v220 offset:2048
  ds_read_b128 a[124:127], v221 offset:2048
  s_waitcnt vmcnt(1)
  ds_read_b128 a[128:131], v220 offset:16384
  ds_read_b128 a[132:135], v221 offset:16384
  ds_read_b128 a[136:139], v220 offset:18432
  ds_read_b128 a[140:143], v221 offset:18432
  buffer_store_dword v8, v38, s[84:87], s43 offen sc1
  s_add_u32 s43, s43, 262144
  buffer_store_dword v9, v38, s[84:87], s43 offen sc1
  s_add_u32 s43, s43, 262144
  buffer_store_dword v10, v38, s[84:87], s43 offen sc1
  s_add_u32 s43, s43, 262144
  buffer_store_dword v11, v38, s[84:87], s43 offen sc1
  s_sub_u32 s43, s43, 770048
  buffer_store_dword v12, v38, s[84:87], s43 offen sc1
  s_add_u32 s43, s43, 262144
  buffer_store_dword v13, v38, s[84:87], s43 offen sc1
  s_add_u32 s43, s43, 262144
  buffer_store_dword v14, v38, s[84:87], s43 offen sc1
  s_add_u32 s43, s43, 262144
  buffer_store_dword v15, v38, s[84:87], s43 offen sc1
  s_sub_u32 s43, s43, 770048
  buffer_store_dword v16, v38, s[84:87], s43 offen sc1
  s_add_u32 s43, s43, 262144
  buffer_store_dword v17, v38, s[84:87], s43 offen sc1
  s_add_u32 s43, s43, 262144
  buffer_store_dword v18, v38, s[84:87], s43 offen sc1
  s_add_u32 s43, s43, 262144
  buffer_store_dword v19, v38, s[84:87], s43 offen sc1
  s_sub_u32 s43, s43, 770048
  buffer_store_dword v20, v38, s[84:87], s43 offen sc1
  s_add_u32 s43, s43, 262144
  buffer_store_dword v21, v38, s[84:87], s43 offen sc1
  s_add_u32 s43, s43, 262144
  buffer_store_dword v22, v38, s[84:87], s43 offen sc1
  s_add_u32 s43, s43, 262144
  buffer_store_dword v23, v38, s[84:87], s43 offen sc1
  v_mfma_f32_16x16x16_bf16 v[8:11], v[186:187], v[62:63], 0
  v_mfma_f32_16x16x16_bf16 v[12:15], v[24:25], v[62:63], 0
  v_mfma_f32_16x16x16_bf16 v[16:19], v[26:27], v[62:63], 0
  v_mfma_f32_16x16x16_bf16 v[20:23], v[28:29], v[62:63], 0
  v_mfma_f32_16x16x16_bf16 v[64:67], v[30:31], v[62:63], 0
  v_mfma_f32_16x16x16_bf16 v[68:71], v[32:33], v[62:63], 0
  v_mfma_f32_16x16x16_bf16 v[72:75], v[34:35], v[62:63], 0
  v_mfma_f32_16x16x16_bf16 v[76:79], v[36:37], v[62:63], 0
  s_waitcnt vmcnt(16)
  v_cmp_ne_u32 vcc, 1, v58
  s_nop 0
  s_and_b64 vcc, vcc, 0xffffffff
  s_cbranch_vccz gated_mix__spectral_gfnet__ssm_conv_s5__prompt_kernel_skip40
  s_mov_b32 s33, 0
gated_mix__spectral_gfnet__ssm_conv_s5__prompt_kernel_poll41:
  s_sleep 5
  s_mov_b64 exec, 0xffffffff
  buffer_load_dword v58, v5, s[16:19], s28 offen sc1
  s_mov_b64 exec, -1
  s_waitcnt vmcnt(0)
  v_cmp_ne_u32 vcc, 1, v58
  s_nop 0
  s_and_b64 vcc, vcc, 0xffffffff
  s_cbranch_vccz gated_mix__spectral_gfnet__ssm_conv_s5__prompt_kernel_pollout42
  s_add_u32 s33, s33, 1
  s_cmp_lt_u32 s33, 1048576
  s_cbranch_scc1 gated_mix__spectral_gfnet__ssm_conv_s5__prompt_kernel_poll41
gated_mix__spectral_gfnet__ssm_conv_s5__prompt_kernel_pollout42:
gated_mix__spectral_gfnet__ssm_conv_s5__prompt_kernel_skip40:
  s_waitcnt lgkmcnt(0)
  s_barrier
  s_add_u32 m0, s92, 0
  s_nop 0
  buffer_load_dwordx4 v59, s[80:83], s79 offen offset:0 sc1 lds
  buffer_load_dwordx4 v59, s[80:83], s79 offen offset:1024 sc1 lds
  buffer_load_dwordx4 v59, s[80:83], s79 offen offset:2048 sc1 lds
  s_and_b32 s33, s41, 8
  s_lshl_b32 s33, s33, 2
  v_lshrrev_b32 v5, 1, v3
  v_lshl_add_u32 v5, v5, 3, s33
  v_and_b32 v58, 1, v3
  v_lshl_add_u32 v5, v58, 1, v5
  v_cmp_eq_u32 vcc, 0, v5
  v_cvt_f32_u32 v188, v5
  v_bfe_i32 v190, v3, 0, 1
  v_and_b32 v190, 0x80008000, v190
  v_xor_b32 v191, 0x80000000, v190
  s_lshl_b32 s33, s33, 1
  buffer_load_dwordx4 v59, s[80:83], s79 offen offset:3072 sc1 lds
  s_add_u32 s79, s79, 32768
  s_and_b32 s79, s79, 0x3ffff
  s_xor_b32 s33, s33, 64
  v_add_u32 v5, s33, v2
  v_cvt_f32_u32 v5, v5
  v_mul_f32 v5, 0x3c000000, v5
  v_mul_f32 v58, v5, v188
  v_fmamk_f32 v172, v5, 0x0, v58
  v_fmamk_f32 v173, v5, 0x3f800000, v58
  v_fmamk_f32 v174, v5, 0x40800000, v58
  v_fmamk_f32 v175, v5, 0x40a00000, v58
  v_fmamk_f32 v176, v5, 0x41800000, v58
  v_fmamk_f32 v177, v5, 0x41880000, v58
  v_fmamk_f32 v178, v5, 0x41a00000, v58
  s_add_u32 m0, s92, 16384
  s_nop 0
  buffer_load_dwordx4 v59, s[80:83], s79 offen offset:0 sc1 lds
  v_fmamk_f32 v179, v5, 0x41a80000, v58
  v_cos_f32 v180, v172
  v_cos_f32 v181, v173
  v_cos_f32 v182, v174
  v_cos_f32 v183, v175
  v_cos_f32 v184, v176
  v_cos_f32 v185, v177
  buffer_load_dwordx4 v59, s[80:83], s79 offen offset:1024 sc1 lds
  v_cos_f32 v186, v178
  v_cos_f32 v187, v179
  v_sin_f32 v172, v172
  v_sin_f32 v173, v173
  v_sin_f32 v174, v174
  v_sin_f32 v175, v175
  buffer_load_dwordx4 v59, s[80:83], s79 offen offset:2048 sc1 lds
  v_sin_f32 v176, v176
  v_sin_f32 v177, v177
  v_sin_f32 v178, v178
  v_sin_f32 v179, v179
  v_lshlrev_b32 v58, 31, v2
  v_or_b32 v58, 0x3f003f00, v58
  v_cvt_pk_bf16_f32 v24, v180, -v172
  v_cvt_pk_bf16_f32 v25, v181, -v173
  buffer_load_dwordx4 v59, s[80:83], s79 offen offset:3072 sc1 lds
  s_add_u32 s79, s79, 32768
  s_and_b32 s79, s79, 0x3ffff
  v_cvt_pk_bf16_f32 v26, v182, -v174
  v_cvt_pk_bf16_f32 v27, v183, -v175
  v_cvt_pk_bf16_f32 v28, v184, -v176
  v_cvt_pk_bf16_f32 v29, v185, -v177
  v_cvt_pk_bf16_f32 v30, v186, -v178
  v_cvt_pk_bf16_f32 v31, v187, -v179
  v_cndmask_b32 v24, v24, v58, vcc
  v_xor_b32 v60, v190, v24
  v_alignbit_b32 v61, v25, v25, 16
  v_xor_b32 v61, v191, v61
  v_xor_b32 v62, v190, v26
  v_alignbit_b32 v63, v27, v27, 16
  s_add_u32 m0, s32, 98304
  s_nop 0
  buffer_load_dwordx4 v216, s[24:27], s29 offen offset:0 lds
  v_xor_b32 v63, v191, v63
  v_xor_b32 v160, v190, v28
  v_alignbit_b32 v161, v29, v29, 16
  v_xor_b32 v161, v191, v161
  v_xor_b32 v162, v190, v30
  v_alignbit_b32 v163, v31, v31, 16
  v_xor_b32 v163, v191, v163
  v_add_f32 v5, 0x3e000000, v5
  v_mul_f32 v58, v5, v188
  v_fmamk_f32 v172, v5, 0x0, v58
  v_fmamk_f32 v173, v5, 0x3f800000, v58
  v_fmamk_f32 v174, v5, 0x40800000, v58
  buffer_load_dwordx4 v217, s[24:27], s29 offen offset:1024 lds
  v_fmamk_f32 v175, v5, 0x40a00000, v58
  v_fmamk_f32 v176, v5, 0x41800000, v58
  v_fmamk_f32 v177, v5, 0x41880000, v58
  v_fmamk_f32 v178, v5, 0x41a00000, v58
  v_fmamk_f32 v179, v5, 0x41a80000, v58
  v_cos_f32 v180, v172
  v_cos_f32 v181, v173
  v_cos_f32 v182, v174
  v_cos_f32 v183, v175
  s_add_u32 m0, s32, 100352
  s_nop 0
  buffer_load_dwordx4 v218, s[24:27], s29 offen offset:0 lds
  v_cos_f32 v184, v176
  v_cos_f32 v185, v177
  v_cos_f32 v186, v178
  v_cos_f32 v187, v179
  v_sin_f32 v172, v172
  v_sin_f32 v173, v173
  buffer_load_dwordx4 v219, s[24:27], s29 offen offset:1024 lds
  s_add_u32 s29, s29, 128
  s_and_b32 s29, s29, 0x3ff
  v_sin_f32 v174, v174
  v_sin_f32 v175, v175
  v_sin_f32 v176, v176
  v_sin_f32 v177, v177
  v_sin_f32 v178, v178
  v_sin_f32 v179, v179
  v_lshlrev_b32 v58, 31, v2
  v_or_b32 v58, 0x3f003f00, v58
  v_cvt_pk_bf16_f32 v32, v180, -v172
  v_cvt_pk_bf16_f32 v33, v181, -v173
  v_cvt_pk_bf16_f32 v34, v182, -v174
  v_cvt_pk_bf16_f32 v35, v183, -v175
  v_cvt_pk_bf16_f32 v36, v184, -v176
  v_cvt_pk_bf16_f32 v37, v185, -v177
  v_cvt_pk_bf16_f32 v38, v186, -v178
  v_cvt_pk_bf16_f32 v39, v187, -v179
  v_cndmask_b32 v32, v32, v58, vcc
  v_xor_b32 v164, v190, v32
  v_alignbit_b32 v165, v33, v33, 16
  v_xor_b32 v165, v191, v165
  v_xor_b32 v166, v190, v34
  v_alignbit_b32 v167, v35, v35, 16
  v_xor_b32 v167, v191, v167
  v_xor_b32 v168, v190, v36
  v_alignbit_b32 v169, v37, v37, 16
  v_xor_b32 v169, v191, v169
  v_xor_b32 v170, v190, v38
  v_alignbit_b32 v171, v39, v39, 16
  v_xor_b32 v171, v191, v171
  s_waitcnt vmcnt(12)
  s_waitcnt vmcnt(8)
  s_barrier
  ds_read_b64_tr_b16 v[96:97], v240 offset:0
  ds_read_b64_tr_b16 v[98:99], v241 offset:0
  ds_read_b64_tr_b16 v[100:101], v240 offset:2048
  ds_read_b64_tr_b16 v[102:103], v241 offset:2048
  ds_read_b64_tr_b16 v[104:105], v240 offset:4096
  ds_read_b64_tr_b16 v[106:107], v241 offset:4096
  ds_read_b64_tr_b16 v[108:109], v240 offset:6144
  ds_read_b64_tr_b16 v[110:111], v241 offset:6144
  ds_read_b64_tr_b16 v[112:113], v240 offset:256
  ds_read_b64_tr_b16 v[114:115], v241 offset:256
  ds_read_b64_tr_b16 v[116:117], v240 offset:2304
  ds_read_b64_tr_b16 v[118:119], v241 offset:2304
  ds_read_b64_tr_b16 v[120:121], v240 offset:4352
  ds_read_b64_tr_b16 v[122:123], v241 offset:4352
  ds_read_b64_tr_b16 v[124:125], v240 offset:6400
  ds_read_b64_tr_b16 v[126:127], v241 offset:6400
  s_cmp_lg_u32 s3, 0
  s_cbranch_scc1 gated_mix__spectral_gfnet__ssm_conv_s5__prompt_kernel_skip43
  s_mov_b64 exec, 1
  buffer_store_dword v7, v56, s[16:19], s11 offen sc1
  s_mov_b64 exec, -1
gated_mix__spectral_gfnet__ssm_conv_s5__prompt_kernel_skip43:
  s_waitcnt lgkmcnt(0)
  v_mfma_f32_16x16x32_bf16 v[8:11], v[96:99], a[0:3], v[8:11]
  ds_read_b64_tr_b16 v[128:129], v240 offset:8192
  ds_read_b64_tr_b16 v[130:131], v241 offset:8192
  v_mfma_f32_16x16x32_bf16 v[40:43], v[96:99], a[8:11], 0
  ds_read_b64_tr_b16 v[132:133], v240 offset:10240
  ds_read_b64_tr_b16 v[134:135], v241 offset:10240
  v_mfma_f32_16x16x32_bf16 v[44:47], v[100:103], a[8:11], 0
  ds_read_b64_tr_b16 v[136:137], v240 offset:12288
  ds_read_b64_tr_b16 v[138:139], v241 offset:12288
  v_mfma_f32_16x16x32_bf16 v[12:15], v[100:103], a[0:3], v[12:15]
  ds_read_b64_tr_b16 v[140:141], v240 offset:14336
  ds_read_b64_tr_b16 v[142:143], v241 offset:14336
  v_mfma_f32_16x16x32_bf16 v[16:19], v[104:107], a[0:3], v[16:19]
  ds_read_b64_tr_b16 v[144:145], v240 offset:8448
  ds_read_b64_tr_b16 v[146:147], v241 offset:8448
  v_mfma_f32_16x16x32_bf16 v[48:51], v[104:107], a[8:11], 0
  ds_read_b64_tr_b16 v[148:149], v240 offset:10496
  ds_read_b64_tr_b16 v[150:151], v241 offset:10496
  v_mfma_f32_16x16x32_bf16 v[52:55], v[108:111], a[8:11], 0
  ds_read_b64_tr_b16 v[152:153], v240 offset:12544
  ds_read_b64_tr_b16 v[154:155], v241 offset:12544
  v_mfma_f32_16x16x32_bf16 v[20:23], v[108:111], a[0:3], v[20:23]
  ds_read_b64_tr_b16 v[156:157], v240 offset:14592
  ds_read_b64_tr_b16 v[158:159], v241 offset:14592
  v_mfma_f32_16x16x32_bf16 v[8:11], v[112:115], a[4:7], v[8:11]
  s_add_u32 m0, s92, 32768
  s_nop 0
  buffer_load_dwordx4 v59, s[80:83], s79 offen offset:0 sc1 lds
  s_mov_b32 s20, s30
  s_mov_b32 s21, s31
  v_mfma_f32_16x16x32_bf16 v[40:43], v[112:115], a[12:15], v[40:43]
  s_mov_b32 s22, 8388608
  s_mov_b32 s23, 0x20000
  v_mfma_f32_16x16x32_bf16 v[44:47], v[116:119], a[12:15], v[44:47]
  buffer_load_dwordx4 v59, s[80:83], s79 offen offset:1024 sc1 lds
  s_mov_b32 s44, s34
  s_mov_b32 s45, s35
  v_mfma_f32_16x16x32_bf16 v[12:15], v[116:119], a[4:7], v[12:15]
  s_mov_b32 s46, 4194304
  s_mov_b32 s47, 0x20000
  v_mfma_f32_16x16x32_bf16 v[16:19], v[120:123], a[4:7], v[16:19]
  buffer_load_dwordx4 v59, s[80:83], s79 offen offset:2048 sc1 lds
  v_lshlrev_b32 v58, 4, v1
  v_lshrrev_b32 v175, 5, v1
  v_mfma_f32_16x16x32_bf16 v[48:51], v[120:123], a[12:15], v[48:51]
  v_lshlrev_b32 v5, 9, v175
  v_lshlrev_b32 v174, 7, v175
  v_mfma_f32_16x16x32_bf16 v[52:55], v[124:127], a[12:15], v[52:55]
  buffer_load_dwordx4 v59, s[80:83], s79 offen offset:3072 sc1 lds
  s_add_u32 s79, s79, 32768
  s_and_b32 s79, s79, 0x3ffff
  v_bfe_u32 v175, v1, 3, 2
  v_lshl_or_b32 v5, v175, 6, v5
  v_mfma_f32_16x16x32_bf16 v[20:23], v[124:127], a[4:7], v[20:23]
  v_and_b32 v175, 3, v1
  v_lshl_or_b32 v5, v175, 4, v5
  s_waitcnt vmcnt(8) lgkmcnt(0)
  s_barrier
  v_mfma_f32_16x16x32_bf16 v[8:11], v[128:131], a[16:19], v[8:11]
  ds_read_b64_tr_b16 v[96:97], v240 offset:16384
  ds_read_b64_tr_b16 v[98:99], v241 offset:16384
  v_mfma_f32_16x16x32_bf16 v[40:43], v[128:131], a[24:27], v[40:43]
  ds_read_b64_tr_b16 v[100:101], v240 offset:18432
  ds_read_b64_tr_b16 v[102:103], v241 offset:18432
  v_mfma_f32_16x16x32_bf16 v[44:47], v[132:135], a[24:27], v[44:47]
  ds_read_b64_tr_b16 v[104:105], v240 offset:20480
  ds_read_b64_tr_b16 v[106:107], v241 offset:20480
  v_mfma_f32_16x16x32_bf16 v[12:15], v[132:135], a[16:19], v[12:15]
  ds_read_b64_tr_b16 v[108:109], v240 offset:22528
  ds_read_b64_tr_b16 v[110:111], v241 offset:22528
  v_mfma_f32_16x16x32_bf16 v[16:19], v[136:139], a[16:19], v[16:19]
  ds_read_b64_tr_b16 v[112:113], v240 offset:16640
  ds_read_b64_tr_b16 v[114:115], v241 offset:16640
  v_mfma_f32_16x16x32_bf16 v[48:51], v[136:139], a[24:27], v[48:51]
  ds_read_b64_tr_b16 v[116:117], v240 offset:18688
  ds_read_b64_tr_b16 v[118:119], v241 offset:18688
  v_mfma_f32_16x16x32_bf16 v[52:55], v[140:143], a[24:27], v[52:55]
  ds_read_b64_tr_b16 v[120:121], v240 offset:20736
  ds_read_b64_tr_b16 v[122:123], v241 offset:20736
  v_mfma_f32_16x16x32_bf16 v[20:23], v[140:143], a[16:19], v[20:23]
  ds_read_b64_tr_b16 v[124:125], v240 offset:22784
  ds_read_b64_tr_b16 v[126:127], v241 offset:22784
  v_mfma_f32_16x16x32_bf16 v[8:11], v[144:147], a[20:23], v[8:11]
  s_add_u32 m0, s32, 114688
  s_nop 0
  buffer_load_dwordx4 v216, s[12:15], s29 offen offset:0 lds
  v_and_b32 v175, 4, v1
  v_lshl_or_b32 v5, v175, 1, v5
  v_mfma_f32_16x16x32_bf16 v[40:43], v[144:147], a[28:31], v[40:43]
  s_lshl_b32 s8, s3, 12
  s_add_u32 s8, s8, 131072
  v_mfma_f32_16x16x32_bf16 v[44:47], v[148:151], a[28:31], v[44:47]
  buffer_load_dwordx4 v217, s[12:15], s29 offen offset:1024 lds
  v_add_u32 v5, s8, v5
  v_and_or_b32 v174, v1, 16, v174
  v_mfma_f32_16x16x32_bf16 v[12:15], v[148:151], a[20:23], v[12:15]
  s_lshl_b32 s8, s41, 6
  v_lshl_add_u32 v172, v2, 2, s8
  v_mfma_f32_16x16x32_bf16 v[16:19], v[152:155], a[20:23], v[16:19]
  s_add_u32 m0, s32, 116736
  s_nop 0
  buffer_load_dwordx4 v218, s[12:15], s29 offen offset:0 lds
  v_lshl_or_b32 v172, v3, 18, v172
  v_xor_b32 v173, 512, v172
  v_mfma_f32_16x16x32_bf16 v[48:51], v[152:155], a[28:31], v[48:51]
  s_lshr_b32 s8, s41, 3
  s_lshl_b32 s33, s8, 10
  v_mfma_f32_16x16x32_bf16 v[52:55], v[156:159], a[28:31], v[52:55]
  buffer_load_dwordx4 v219, s[12:15], s29 offen offset:1024 lds
  s_add_u32 s33, s33, s40
  s_lshl2_add_u32 s33, s33, s3
  v_mfma_f32_16x16x32_bf16 v[20:23], v[156:159], a[20:23], v[20:23]
  s_lshl_b32 s33, s33, 10
  s_xor_b32 s43, s8, 1
  s_waitcnt lgkmcnt(0)
  v_mfma_f32_16x16x32_bf16 v[8:11], v[96:99], a[32:35], v[8:11]
  ds_read_b64_tr_b16 v[128:129], v240 offset:24576
  ds_read_b64_tr_b16 v[130:131], v241 offset:24576
  v_mfma_f32_16x16x32_bf16 v[40:43], v[96:99], a[40:43], v[40:43]
  ds_read_b64_tr_b16 v[132:133], v240 offset:26624
  ds_read_b64_tr_b16 v[134:135], v241 offset:26624
  v_mfma_f32_16x16x32_bf16 v[44:47], v[100:103], a[40:43], v[44:47]
  ds_read_b64_tr_b16 v[136:137], v240 offset:28672
  ds_read_b64_tr_b16 v[138:139], v241 offset:28672
  v_mfma_f32_16x16x32_bf16 v[12:15], v[100:103], a[32:35], v[12:15]
  ds_read_b64_tr_b16 v[140:141], v240 offset:30720
  ds_read_b64_tr_b16 v[142:143], v241 offset:30720
  v_mfma_f32_16x16x32_bf16 v[16:19], v[104:107], a[32:35], v[16:19]
  ds_read_b64_tr_b16 v[144:145], v240 offset:24832
  ds_read_b64_tr_b16 v[146:147], v241 offset:24832
  v_mfma_f32_16x16x32_bf16 v[48:51], v[104:107], a[40:43], v[48:51]
  ds_read_b64_tr_b16 v[148:149], v240 offset:26880
  ds_read_b64_tr_b16 v[150:151], v241 offset:26880
  v_mfma_f32_16x16x32_bf16 v[52:55], v[108:111], a[40:43], v[52:55]
  ds_read_b64_tr_b16 v[152:153], v240 offset:28928
  ds_read_b64_tr_b16 v[154:155], v241 offset:28928
  v_mfma_f32_16x16x32_bf16 v[20:23], v[108:111], a[32:35], v[20:23]
  ds_read_b64_tr_b16 v[156:157], v240 offset:30976
  ds_read_b64_tr_b16 v[158:159], v241 offset:30976
  v_mfma_f32_16x16x32_bf16 v[8:11], v[112:115], a[36:39], v[8:11]
  s_add_u32 m0, s92, 49152
  s_nop 0
  buffer_load_dwordx4 v59, s[80:83], s79 offen offset:0 sc1 lds
  s_lshl1_add_u32 s43, s40, s43
  s_lshl_b32 s43, s43, 10
  v_mfma_f32_16x16x32_bf16 v[40:43], v[112:115], a[44:47], v[40:43]
  s_lshl4_add_u32 s6, s40, s41
  s_and_b32 s7, s3, 2
  v_mfma_f32_16x16x32_bf16 v[44:47], v[116:119], a[44:47], v[44:47]
  buffer_load_dwordx4 v59, s[80:83], s79 offen offset:1024 sc1 lds
  s_lshl_b32 s7, s7, 2
  s_xor_b32 s7, s7, s6
  v_mfma_f32_16x16x32_bf16 v[12:15], v[116:119], a[36:39], v[12:15]
  s_lshl1_add_u32 s7, s7, s8
  s_and_b32 s8, s3, 1
  v_mfma_f32_16x16x32_bf16 v[16:19], v[120:123], a[36:39], v[16:19]
  buffer_load_dwordx4 v59, s[80:83], s79 offen offset:2048 sc1 lds
  s_lshl1_add_u32 s7, s7, s8
  s_lshl_b32 s7, s7, 12
  v_mfma_f32_16x16x32_bf16 v[48:51], v[120:123], a[44:47], v[48:51]
  s_lshl2_add_u32 s6, s6, s3
  s_lshl_b32 s6, s6, 13
  v_mfma_f32_16x16x32_bf16 v[52:55], v[124:127], a[44:47], v[52:55]
  buffer_load_dwordx4 v59, s[80:83], s79 offen offset:3072 sc1 lds
  s_add_u32 s79, s79, 32768
  s_and_b32 s79, s79, 0x3ffff
  s_lshr_b32 s8, s41, 3
  s_or_b32 s8, s8, s3
  v_mfma_f32_16x16x32_bf16 v[20:23], v[124:127], a[36:39], v[20:23]
  s_and_b32 s8, s8, 1
  s_lshr_b32 s6, s6, 1
  s_waitcnt vmcnt(12)
  ds_read_b128 a[144:147], v222 offset:32768
  ds_read_b128 a[148:151], v223 offset:32768
  ds_read_b128 a[152:155], v222 offset:34816
  ds_read_b128 a[156:159], v223 offset:34816
  s_waitcnt vmcnt(8) lgkmcnt(4)
  s_barrier
  v_mfma_f32_16x16x32_bf16 v[8:11], v[128:131], a[48:51], v[8:11]
  ds_read_b64_tr_b16 v[96:97], v240 offset:32768
  ds_read_b64_tr_b16 v[98:99], v241 offset:32768
  v_mfma_f32_16x16x32_bf16 v[40:43], v[128:131], a[56:59], v[40:43]
  ds_read_b64_tr_b16 v[100:101], v240 offset:34816
  ds_read_b64_tr_b16 v[102:103], v241 offset:34816
  v_mfma_f32_16x16x32_bf16 v[44:47], v[132:135], a[56:59], v[44:47]
  ds_read_b64_tr_b16 v[104:105], v240 offset:36864
  ds_read_b64_tr_b16 v[106:107], v241 offset:36864
  v_mfma_f32_16x16x32_bf16 v[12:15], v[132:135], a[48:51], v[12:15]
  ds_read_b64_tr_b16 v[108:109], v240 offset:38912
  ds_read_b64_tr_b16 v[110:111], v241 offset:38912
  v_mfma_f32_16x16x32_bf16 v[16:19], v[136:139], a[48:51], v[16:19]
  ds_read_b64_tr_b16 v[112:113], v240 offset:33024
  ds_read_b64_tr_b16 v[114:115], v241 offset:33024
  v_mfma_f32_16x16x32_bf16 v[48:51], v[136:139], a[56:59], v[48:51]
  ds_read_b64_tr_b16 v[116:117], v240 offset:35072
  ds_read_b64_tr_b16 v[118:119], v241 offset:35072
  v_mfma_f32_16x16x32_bf16 v[52:55], v[140:143], a[56:59], v[52:55]
  ds_read_b64_tr_b16 v[120:121], v240 offset:37120
  ds_read_b64_tr_b16 v[122:123], v241 offset:37120
  v_mfma_f32_16x16x32_bf16 v[20:23], v[140:143], a[48:51], v[20:23]
  ds_read_b64_tr_b16 v[124:125], v240 offset:39168
  ds_read_b64_tr_b16 v[126:127], v241 offset:39168
  v_mfma_f32_16x16x32_bf16 v[8:11], v[144:147], a[52:55], v[8:11]
  s_add_u32 m0, s32, 147456
  s_nop 0
  buffer_load_dwordx4 v216, s[24:27], s29 offen offset:0 lds
  s_mov_b32 s9, 0x07060302
  v_mfma_f32_16x16x32_bf16 v[40:43], v[144:147], a[60:63], v[40:43]
  v_mfma_f32_16x16x32_bf16 v[44:47], v[148:151], a[60:63], v[44:47]
  buffer_load_dwordx4 v217, s[24:27], s29 offen offset:1024 lds
  v_mfma_f32_16x16x32_bf16 v[12:15], v[148:151], a[52:55], v[12:15]
  v_mfma_f32_16x16x32_bf16 v[16:19], v[152:155], a[52:55], v[16:19]
  s_add_u32 m0, s32, 149504
  s_nop 0
  buffer_load_dwordx4 v218, s[24:27], s29 offen offset:0 lds
  v_mfma_f32_16x16x32_bf16 v[48:51], v[152:155], a[60:63], v[48:51]
  v_mfma_f32_16x16x32_bf16 v[52:55], v[156:159], a[60:63], v[52:55]
  buffer_load_dwordx4 v219, s[24:27], s29 offen offset:1024 lds
  s_add_u32 s29, s29, 128
  s_and_b32 s29, s29, 0x3ff
  v_mfma_f32_16x16x32_bf16 v[20:23], v[156:159], a[52:55], v[20:23]
  s_waitcnt lgkmcnt(0)
  v_mfma_f32_16x16x32_bf16 v[8:11], v[96:99], a[64:67], v[8:11]
  ds_read_b64_tr_b16 v[128:129], v240 offset:40960
  ds_read_b64_tr_b16 v[130:131], v241 offset:40960
  v_mfma_f32_16x16x32_bf16 v[40:43], v[96:99], a[72:75], v[40:43]
  ds_read_b64_tr_b16 v[132:133], v240 offset:43008
  ds_read_b64_tr_b16 v[134:135], v241 offset:43008
  v_mfma_f32_16x16x32_bf16 v[44:47], v[100:103], a[72:75], v[44:47]
  ds_read_b64_tr_b16 v[136:137], v240 offset:45056
  ds_read_b64_tr_b16 v[138:139], v241 offset:45056
  v_mfma_f32_16x16x32_bf16 v[12:15], v[100:103], a[64:67], v[12:15]
  ds_read_b64_tr_b16 v[140:141], v240 offset:47104
  ds_read_b64_tr_b16 v[142:143], v241 offset:47104
  v_mfma_f32_16x16x32_bf16 v[16:19], v[104:107], a[64:67], v[16:19]
  ds_read_b64_tr_b16 v[144:145], v240 offset:41216
  ds_read_b64_tr_b16 v[146:147], v241 offset:41216
  v_mfma_f32_16x16x32_bf16 v[48:51], v[104:107], a[72:75], v[48:51]
  ds_read_b64_tr_b16 v[148:149], v240 offset:43264
  ds_read_b64_tr_b16 v[150:151], v241 offset:43264
  v_mfma_f32_16x16x32_bf16 v[52:55], v[108:111], a[72:75], v[52:55]
  ds_read_b64_tr_b16 v[152:153], v240 offset:45312
  ds_read_b64_tr_b16 v[154:155], v241 offset:45312
  v_mfma_f32_16x16x32_bf16 v[20:23], v[108:111], a[64:67], v[20:23]
  ds_read_b64_tr_b16 v[156:157], v240 offset:47360
  ds_read_b64_tr_b16 v[158:159], v241 offset:47360
  v_mfma_f32_16x16x32_bf16 v[8:11], v[112:115], a[68:71], v[8:11]
  s_add_u32 m0, s92, 65536
  s_nop 0
  buffer_load_dwordx4 v59, s[80:83], s79 offen offset:0 sc1 lds
  v_mfma_f32_16x16x32_bf16 v[40:43], v[112:115], a[76:79], v[40:43]
  v_mfma_f32_16x16x32_bf16 v[44:47], v[116:119], a[76:79], v[44:47]
  buffer_load_dwordx4 v59, s[80:83], s79 offen offset:1024 sc1 lds
  v_mfma_f32_16x16x32_bf16 v[12:15], v[116:119], a[68:71], v[12:15]
  v_mfma_f32_16x16x32_bf16 v[16:19], v[120:123], a[68:71], v[16:19]
  buffer_load_dwordx4 v59, s[80:83], s79 offen offset:2048 sc1 lds
  v_mfma_f32_16x16x32_bf16 v[48:51], v[120:123], a[76:79], v[48:51]
  v_mfma_f32_16x16x32_bf16 v[52:55], v[124:127], a[76:79], v[52:55]
  buffer_load_dwordx4 v59, s[80:83], s79 offen offset:3072 sc1 lds
  s_add_u32 s79, s79, 32768
  s_and_b32 s79, s79, 0x3ffff
  v_mfma_f32_16x16x32_bf16 v[20:23], v[124:127], a[68:71], v[20:23]
  s_waitcnt vmcnt(12)
  ds_read_b128 a[160:163], v222 offset:49152
  ds_read_b128 a[164:167], v223 offset:49152
  ds_read_b128 a[168:171], v222 offset:51200
  ds_read_b128 a[172:175], v223 offset:51200
  s_waitcnt vmcnt(8) lgkmcnt(4)
  s_barrier
  v_mfma_f32_16x16x32_bf16 v[8:11], v[128:131], a[80:83], v[8:11]
  ds_read_b64_tr_b16 v[96:97], v240 offset:49152
  ds_read_b64_tr_b16 v[98:99], v241 offset:49152
  v_mfma_f32_16x16x32_bf16 v[40:43], v[128:131], a[88:91], v[40:43]
  ds_read_b64_tr_b16 v[100:101], v240 offset:51200
  ds_read_b64_tr_b16 v[102:103], v241 offset:51200
  v_mfma_f32_16x16x32_bf16 v[44:47], v[132:135], a[88:91], v[44:47]
  ds_read_b64_tr_b16 v[104:105], v240 offset:53248
  ds_read_b64_tr_b16 v[106:107], v241 offset:53248
  v_mfma_f32_16x16x32_bf16 v[12:15], v[132:135], a[80:83], v[12:15]
  ds_read_b64_tr_b16 v[108:109], v240 offset:55296
  ds_read_b64_tr_b16 v[110:111], v241 offset:55296
  v_mfma_f32_16x16x32_bf16 v[16:19], v[136:139], a[80:83], v[16:19]
  ds_read_b64_tr_b16 v[112:113], v240 offset:49408
  ds_read_b64_tr_b16 v[114:115], v241 offset:49408
  v_mfma_f32_16x16x32_bf16 v[48:51], v[136:139], a[88:91], v[48:51]
  ds_read_b64_tr_b16 v[116:117], v240 offset:51456
  ds_read_b64_tr_b16 v[118:119], v241 offset:51456
  v_mfma_f32_16x16x32_bf16 v[52:55], v[140:143], a[88:91], v[52:55]
  ds_read_b64_tr_b16 v[120:121], v240 offset:53504
  ds_read_b64_tr_b16 v[122:123], v241 offset:53504
  v_mfma_f32_16x16x32_bf16 v[20:23], v[140:143], a[80:83], v[20:23]
  ds_read_b64_tr_b16 v[124:125], v240 offset:55552
  ds_read_b64_tr_b16 v[126:127], v241 offset:55552
  v_mfma_f32_16x16x32_bf16 v[8:11], v[144:147], a[84:87], v[8:11]
  s_add_u32 m0, s32, 98304
  s_nop 0
  buffer_load_dwordx4 v216, s[12:15], s29 offen offset:0 lds
  v_mfma_f32_16x16x32_bf16 v[40:43], v[144:147], a[92:95], v[40:43]
  v_mfma_f32_16x16x32_bf16 v[44:47], v[148:151], a[92:95], v[44:47]
  buffer_load_dwordx4 v217, s[12:15], s29 offen offset:1024 lds
  v_mfma_f32_16x16x32_bf16 v[12:15], v[148:151], a[84:87], v[12:15]
  v_mfma_f32_16x16x32_bf16 v[16:19], v[152:155], a[84:87], v[16:19]
  s_add_u32 m0, s32, 100352
  s_nop 0
  buffer_load_dwordx4 v218, s[12:15], s29 offen offset:0 lds
  v_mfma_f32_16x16x32_bf16 v[48:51], v[152:155], a[92:95], v[48:51]
  v_mfma_f32_16x16x32_bf16 v[52:55], v[156:159], a[92:95], v[52:55]
  buffer_load_dwordx4 v219, s[12:15], s29 offen offset:1024 lds
  v_mfma_f32_16x16x32_bf16 v[20:23], v[156:159], a[84:87], v[20:23]
  s_waitcnt lgkmcnt(0)
  v_mfma_f32_16x16x32_bf16 v[8:11], v[96:99], a[96:99], v[8:11]
  ds_read_b64_tr_b16 v[128:129], v240 offset:57344
  ds_read_b64_tr_b16 v[130:131], v241 offset:57344
  v_mfma_f32_16x16x32_bf16 v[40:43], v[96:99], a[104:107], v[40:43]
  ds_read_b64_tr_b16 v[132:133], v240 offset:59392
  ds_read_b64_tr_b16 v[134:135], v241 offset:59392
  v_mfma_f32_16x16x32_bf16 v[44:47], v[100:103], a[104:107], v[44:47]
  ds_read_b64_tr_b16 v[136:137], v240 offset:61440
  ds_read_b64_tr_b16 v[138:139], v241 offset:61440
  v_mfma_f32_16x16x32_bf16 v[12:15], v[100:103], a[96:99], v[12:15]
  ds_read_b64_tr_b16 v[140:141], v240 offset:63488
  ds_read_b64_tr_b16 v[142:143], v241 offset:63488
  v_mfma_f32_16x16x32_bf16 v[16:19], v[104:107], a[96:99], v[16:19]
  ds_read_b64_tr_b16 v[144:145], v240 offset:57600
  ds_read_b64_tr_b16 v[146:147], v241 offset:57600
  v_mfma_f32_16x16x32_bf16 v[48:51], v[104:107], a[104:107], v[48:51]
  ds_read_b64_tr_b16 v[148:149], v240 offset:59648
  ds_read_b64_tr_b16 v[150:151], v241 offset:59648
  v_mfma_f32_16x16x32_bf16 v[52:55], v[108:111], a[104:107], v[52:55]
  ds_read_b64_tr_b16 v[152:153], v240 offset:61696
  ds_read_b64_tr_b16 v[154:155], v241 offset:61696
  v_mfma_f32_16x16x32_bf16 v[20:23], v[108:111], a[96:99], v[20:23]
  ds_read_b64_tr_b16 v[156:157], v240 offset:63744
  ds_read_b64_tr_b16 v[158:159], v241 offset:63744
  v_mfma_f32_16x16x32_bf16 v[8:11], v[112:115], a[100:103], v[8:11]
  s_add_u32 m0, s92, 81920
  s_nop 0
  buffer_load_dwordx4 v59, s[80:83], s79 offen offset:0 sc1 lds
  v_mfma_f32_16x16x32_bf16 v[40:43], v[112:115], a[108:111], v[40:43]
  v_mfma_f32_16x16x32_bf16 v[44:47], v[116:119], a[108:111], v[44:47]
  buffer_load_dwordx4 v59, s[80:83], s79 offen offset:1024 sc1 lds
  v_mfma_f32_16x16x32_bf16 v[12:15], v[116:119], a[100:103], v[12:15]
  v_mfma_f32_16x16x32_bf16 v[16:19], v[120:123], a[100:103], v[16:19]
  buffer_load_dwordx4 v59, s[80:83], s79 offen offset:2048 sc1 lds
  v_mfma_f32_16x16x32_bf16 v[48:51], v[120:123], a[108:111], v[48:51]
  v_mfma_f32_16x16x32_bf16 v[52:55], v[124:127], a[108:111], v[52:55]
  buffer_load_dwordx4 v59, s[80:83], s79 offen offset:3072 sc1 lds
  s_add_u32 s79, s79, 32768
  s_and_b32 s79, s79, 0x3ffff
  v_mfma_f32_16x16x32_bf16 v[20:23], v[124:127], a[100:103], v[20:23]
  v_xor_b32 v222, 0x30000, v222
  v_xor_b32 v223, 0x30000, v223
  s_waitcnt vmcnt(12)
  ds_read_b128 a[176:179], v222 offset:16384
  ds_read_b128 a[180:183], v223 offset:16384
  ds_read_b128 a[184:187], v222 offset:18432
  ds_read_b128 a[188:191], v223 offset:18432
  s_waitcnt vmcnt(8) lgkmcnt(4)
  s_barrier
  v_mfma_f32_16x16x32_bf16 v[8:11], v[128:131], a[112:115], v[8:11]
  ds_read_b64_tr_b16 v[96:97], v242 offset:0
  ds_read_b64_tr_b16 v[98:99], v243 offset:0
  v_mfma_f32_16x16x32_bf16 v[40:43], v[128:131], a[120:123], v[40:43]
  ds_read_b64_tr_b16 v[100:101], v242 offset:2048
  ds_read_b64_tr_b16 v[102:103], v243 offset:2048
  v_mfma_f32_16x16x32_bf16 v[44:47], v[132:135], a[120:123], v[44:47]
  ds_read_b64_tr_b16 v[104:105], v242 offset:4096
  ds_read_b64_tr_b16 v[106:107], v243 offset:4096
  v_mfma_f32_16x16x32_bf16 v[12:15], v[132:135], a[112:115], v[12:15]
  ds_read_b64_tr_b16 v[108:109], v242 offset:6144
  ds_read_b64_tr_b16 v[110:111], v243 offset:6144
  v_mfma_f32_16x16x32_bf16 v[16:19], v[136:139], a[112:115], v[16:19]
  ds_read_b64_tr_b16 v[112:113], v242 offset:256
  ds_read_b64_tr_b16 v[114:115], v243 offset:256
  v_mfma_f32_16x16x32_bf16 v[48:51], v[136:139], a[120:123], v[48:51]
  ds_read_b64_tr_b16 v[116:117], v242 offset:2304
  ds_read_b64_tr_b16 v[118:119], v243 offset:2304
  v_mfma_f32_16x16x32_bf16 v[52:55], v[140:143], a[120:123], v[52:55]
  ds_read_b64_tr_b16 v[120:121], v242 offset:4352
  ds_read_b64_tr_b16 v[122:123], v243 offset:4352
  v_mfma_f32_16x16x32_bf16 v[20:23], v[140:143], a[112:115], v[20:23]
  ds_read_b64_tr_b16 v[124:125], v242 offset:6400
  ds_read_b64_tr_b16 v[126:127], v243 offset:6400
  v_mfma_f32_16x16x32_bf16 v[8:11], v[144:147], a[116:119], v[8:11]
  s_add_u32 m0, s32, 114688
  s_nop 0
  buffer_load_dwordx4 v216, s[24:27], s29 offen offset:0 lds
  v_mfma_f32_16x16x32_bf16 v[40:43], v[144:147], a[124:127], v[40:43]
  v_mfma_f32_16x16x32_bf16 v[44:47], v[148:151], a[124:127], v[44:47]
  buffer_load_dwordx4 v217, s[24:27], s29 offen offset:1024 lds
  v_mfma_f32_16x16x32_bf16 v[12:15], v[148:151], a[116:119], v[12:15]
  v_mfma_f32_16x16x32_bf16 v[16:19], v[152:155], a[116:119], v[16:19]
  s_add_u32 m0, s32, 116736
  s_nop 0
  buffer_load_dwordx4 v218, s[24:27], s29 offen offset:0 lds
  v_mfma_f32_16x16x32_bf16 v[48:51], v[152:155], a[124:127], v[48:51]
  v_mfma_f32_16x16x32_bf16 v[52:55], v[156:159], a[124:127], v[52:55]
  buffer_load_dwordx4 v219, s[24:27], s29 offen offset:1024 lds
  s_add_u32 s29, s29, 128
  s_and_b32 s29, s29, 0x3ff
  v_mfma_f32_16x16x32_bf16 v[20:23], v[156:159], a[116:119], v[20:23]
  buffer_load_dword v176, v6, s[16:19], s11 offen sc1
  s_waitcnt lgkmcnt(0)
  v_mfma_f32_16x16x32_bf16 v[8:11], v[96:99], a[128:131], v[8:11]
  ds_read_b64_tr_b16 v[128:129], v242 offset:8192
  ds_read_b64_tr_b16 v[130:131], v243 offset:8192
  v_mfma_f32_16x16x32_bf16 v[40:43], v[96:99], a[136:139], v[40:43]
  ds_read_b64_tr_b16 v[132:133], v242 offset:10240
  ds_read_b64_tr_b16 v[134:135], v243 offset:10240
  v_mfma_f32_16x16x32_bf16 v[44:47], v[100:103], a[136:139], v[44:47]
  ds_read_b64_tr_b16 v[136:137], v242 offset:12288
  ds_read_b64_tr_b16 v[138:139], v243 offset:12288
  v_mfma_f32_16x16x32_bf16 v[12:15], v[100:103], a[128:131], v[12:15]
  ds_read_b64_tr_b16 v[140:141], v242 offset:14336
  ds_read_b64_tr_b16 v[142:143], v243 offset:14336
  v_mfma_f32_16x16x32_bf16 v[16:19], v[104:107], a[128:131], v[16:19]
  ds_read_b64_tr_b16 v[144:145], v242 offset:8448
  ds_read_b64_tr_b16 v[146:147], v243 offset:8448
  v_mfma_f32_16x16x32_bf16 v[48:51], v[104:107], a[136:139], v[48:51]
  ds_read_b64_tr_b16 v[148:149], v242 offset:10496
  ds_read_b64_tr_b16 v[150:151], v243 offset:10496
  v_mfma_f32_16x16x32_bf16 v[52:55], v[108:111], a[136:139], v[52:55]
  ds_read_b64_tr_b16 v[152:153], v242 offset:12544
  ds_read_b64_tr_b16 v[154:155], v243 offset:12544
  v_mfma_f32_16x16x32_bf16 v[20:23], v[108:111], a[128:131], v[20:23]
  ds_read_b64_tr_b16 v[156:157], v242 offset:14592
  ds_read_b64_tr_b16 v[158:159], v243 offset:14592
  v_mfma_f32_16x16x32_bf16 v[8:11], v[112:115], a[132:135], v[8:11]
  s_add_u32 m0, s92, 0
  s_nop 0
  buffer_load_dwordx4 v59, s[80:83], s79 offen offset:0 sc1 lds
  v_mfma_f32_16x16x32_bf16 v[40:43], v[112:115], a[140:143], v[40:43]
  v_mfma_f32_16x16x32_bf16 v[44:47], v[116:119], a[140:143], v[44:47]
  buffer_load_dwordx4 v59, s[80:83], s79 offen offset:1024 sc1 lds
  v_mfma_f32_16x16x32_bf16 v[12:15], v[116:119], a[132:135], v[12:15]
  v_mfma_f32_16x16x32_bf16 v[16:19], v[120:123], a[132:135], v[16:19]
  buffer_load_dwordx4 v59, s[80:83], s79 offen offset:2048 sc1 lds
  v_mfma_f32_16x16x32_bf16 v[48:51], v[120:123], a[140:143], v[48:51]
  v_mfma_f32_16x16x32_bf16 v[52:55], v[124:127], a[140:143], v[52:55]
  buffer_load_dwordx4 v59, s[80:83], s79 offen offset:3072 sc1 lds
  s_add_u32 s79, s79, 32768
  s_and_b32 s79, s79, 0x3ffff
  v_mfma_f32_16x16x32_bf16 v[20:23], v[124:127], a[132:135], v[20:23]
  v_xor_b32 v222, 0x30000, v222
  v_xor_b32 v223, 0x30000, v223
  s_waitcnt vmcnt(13)
  ds_read_b128 a[192:195], v222 offset:32768
  ds_read_b128 a[196:199], v223 offset:32768
  ds_read_b128 a[200:203], v222 offset:34816
  ds_read_b128 a[204:207], v223 offset:34816
  s_waitcnt vmcnt(9) lgkmcnt(4)
  s_barrier
  v_mfma_f32_16x16x32_bf16 v[8:11], v[128:131], a[144:147], v[8:11]
  ds_read_b64_tr_b16 v[96:97], v242 offset:16384
  ds_read_b64_tr_b16 v[98:99], v243 offset:16384
  v_mfma_f32_16x16x32_bf16 v[40:43], v[128:131], a[152:155], v[40:43]
  ds_read_b64_tr_b16 v[100:101], v242 offset:18432
  ds_read_b64_tr_b16 v[102:103], v243 offset:18432
  v_mfma_f32_16x16x32_bf16 v[44:47], v[132:135], a[152:155], v[44:47]
  ds_read_b64_tr_b16 v[104:105], v242 offset:20480
  ds_read_b64_tr_b16 v[106:107], v243 offset:20480
  v_mfma_f32_16x16x32_bf16 v[12:15], v[132:135], a[144:147], v[12:15]
  ds_read_b64_tr_b16 v[108:109], v242 offset:22528
  ds_read_b64_tr_b16 v[110:111], v243 offset:22528
  v_mfma_f32_16x16x32_bf16 v[16:19], v[136:139], a[144:147], v[16:19]
  ds_read_b64_tr_b16 v[112:113], v242 offset:16640
  ds_read_b64_tr_b16 v[114:115], v243 offset:16640
  v_mfma_f32_16x16x32_bf16 v[48:51], v[136:139], a[152:155], v[48:51]
  ds_read_b64_tr_b16 v[116:117], v242 offset:18688
  ds_read_b64_tr_b16 v[118:119], v243 offset:18688
  v_mfma_f32_16x16x32_bf16 v[52:55], v[140:143], a[152:155], v[52:55]
  ds_read_b64_tr_b16 v[120:121], v242 offset:20736
  ds_read_b64_tr_b16 v[122:123], v243 offset:20736
  v_mfma_f32_16x16x32_bf16 v[20:23], v[140:143], a[144:147], v[20:23]
  ds_read_b64_tr_b16 v[124:125], v242 offset:22784
  ds_read_b64_tr_b16 v[126:127], v243 offset:22784
  v_mfma_f32_16x16x32_bf16 v[8:11], v[144:147], a[148:151], v[8:11]
  s_add_u32 m0, s32, 147456
  s_nop 0
  buffer_load_dwordx4 v216, s[12:15], s29 offen offset:0 lds
  v_mfma_f32_16x16x32_bf16 v[40:43], v[144:147], a[156:159], v[40:43]
  v_mfma_f32_16x16x32_bf16 v[44:47], v[148:151], a[156:159], v[44:47]
  buffer_load_dwordx4 v217, s[12:15], s29 offen offset:1024 lds
  v_mfma_f32_16x16x32_bf16 v[12:15], v[148:151], a[148:151], v[12:15]
  v_mfma_f32_16x16x32_bf16 v[16:19], v[152:155], a[148:151], v[16:19]
  s_add_u32 m0, s32, 149504
  s_nop 0
  buffer_load_dwordx4 v218, s[12:15], s29 offen offset:0 lds
  v_mfma_f32_16x16x32_bf16 v[48:51], v[152:155], a[156:159], v[48:51]
  v_mfma_f32_16x16x32_bf16 v[52:55], v[156:159], a[156:159], v[52:55]
  buffer_load_dwordx4 v219, s[12:15], s29 offen offset:1024 lds
  v_mfma_f32_16x16x32_bf16 v[20:23], v[156:159], a[148:151], v[20:23]
  s_cmp_lg_u32 s3, 1
  s_cbranch_scc1 gated_mix__spectral_gfnet__ssm_conv_s5__prompt_kernel_skip45
  s_getpc_b64 s[52:53]
gated_mix__spectral_gfnet__ssm_conv_s5__prompt_kernel_pc44:
  s_lshr_b32 s54, s2, 3
  s_mul_i32 s54, s54, 512
  v_min_u32 v178, 3, v1
  v_lshl_add_u32 v178, v178, 7, s54
  v_min_u32 v178, gated_mix__spectral_gfnet__ssm_conv_s5__prompt_kernel_end-gated_mix__spectral_gfnet__ssm_conv_s5__prompt_kernel_pc44, v178
  v_mov_b32 v179, 0
  v_lshl_add_u64 v[178:179], v[178:179], 0, s[52:53]
  global_load_dword v4, v[178:179], off
gated_mix__spectral_gfnet__ssm_conv_s5__prompt_kernel_skip45:
  s_waitcnt lgkmcnt(0)
  v_mfma_f32_16x16x32_bf16 v[8:11], v[96:99], a[160:163], v[8:11]
  ds_read_b64_tr_b16 v[128:129], v242 offset:24576
  ds_read_b64_tr_b16 v[130:131], v243 offset:24576
  v_mfma_f32_16x16x32_bf16 v[40:43], v[96:99], a[168:171], v[40:43]
  ds_read_b64_tr_b16 v[132:133], v242 offset:26624
  ds_read_b64_tr_b16 v[134:135], v243 offset:26624
  v_mfma_f32_16x16x32_bf16 v[44:47], v[100:103], a[168:171], v[44:47]
  ds_read_b64_tr_b16 v[136:137], v242 offset:28672
  ds_read_b64_tr_b16 v[138:139], v243 offset:28672
  v_mfma_f32_16x16x32_bf16 v[12:15], v[100:103], a[160:163], v[12:15]
  ds_read_b64_tr_b16 v[140:141], v242 offset:30720
  ds_read_b64_tr_b16 v[142:143], v243 offset:30720
  v_mfma_f32_16x16x32_bf16 v[16:19], v[104:107], a[160:163], v[16:19]
  ds_read_b64_tr_b16 v[144:145], v242 offset:24832
  ds_read_b64_tr_b16 v[146:147], v243 offset:24832
  v_mfma_f32_16x16x32_bf16 v[48:51], v[104:107], a[168:171], v[48:51]
  ds_read_b64_tr_b16 v[148:149], v242 offset:26880
  ds_read_b64_tr_b16 v[150:151], v243 offset:26880
  v_mfma_f32_16x16x32_bf16 v[52:55], v[108:111], a[168:171], v[52:55]
  ds_read_b64_tr_b16 v[152:153], v242 offset:28928
  ds_read_b64_tr_b16 v[154:155], v243 offset:28928
  v_mfma_f32_16x16x32_bf16 v[20:23], v[108:111], a[160:163], v[20:23]
  ds_read_b64_tr_b16 v[156:157], v242 offset:30976
  ds_read_b64_tr_b16 v[158:159], v243 offset:30976
  v_mfma_f32_16x16x32_bf16 v[8:11], v[112:115], a[164:167], v[8:11]
  s_add_u32 m0, s92, 16384
  s_nop 0
  buffer_load_dwordx4 v59, s[80:83], s79 offen offset:0 sc1 lds
  v_mfma_f32_16x16x32_bf16 v[40:43], v[112:115], a[172:175], v[40:43]
  v_mfma_f32_16x16x32_bf16 v[44:47], v[116:119], a[172:175], v[44:47]
  buffer_load_dwordx4 v59, s[80:83], s79 offen offset:1024 sc1 lds
  v_mfma_f32_16x16x32_bf16 v[12:15], v[116:119], a[164:167], v[12:15]
  v_mfma_f32_16x16x32_bf16 v[16:19], v[120:123], a[164:167], v[16:19]
  buffer_load_dwordx4 v59, s[80:83], s79 offen offset:2048 sc1 lds
  v_mfma_f32_16x16x32_bf16 v[48:51], v[120:123], a[172:175], v[48:51]
  v_mfma_f32_16x16x32_bf16 v[52:55], v[124:127], a[172:175], v[52:55]
  buffer_load_dwordx4 v59, s[80:83], s79 offen offset:3072 sc1 lds
  s_add_u32 s79, s79, 32768
  s_and_b32 s79, s79, 0x3ffff
  v_xor_b32 v59, 8192, v59
  v_mfma_f32_16x16x32_bf16 v[20:23], v[124:127], a[164:167], v[20:23]
  s_waitcnt vmcnt(13)
  ds_read_b128 a[208:211], v222 offset:49152
  ds_read_b128 a[212:215], v223 offset:49152
  ds_read_b128 a[216:219], v222 offset:51200
  ds_read_b128 a[220:223], v223 offset:51200
  s_waitcnt vmcnt(12)
  v_cmp_ne_u32 vcc, 1, v176
  s_nop 0
  s_cbranch_vccz gated_mix__spectral_gfnet__ssm_conv_s5__prompt_kernel_skip46
  s_mov_b32 s52, 0
gated_mix__spectral_gfnet__ssm_conv_s5__prompt_kernel_poll47:
  s_sleep 16
  buffer_load_dword v176, v6, s[16:19], s11 offen sc1
  s_waitcnt vmcnt(0)
  v_cmp_ne_u32 vcc, 1, v176
  s_nop 0
  s_cbranch_vccz gated_mix__spectral_gfnet__ssm_conv_s5__prompt_kernel_pollout48
  s_add_u32 s52, s52, 1
  s_cmp_lt_u32 s52, 1048576
  s_cbranch_scc1 gated_mix__spectral_gfnet__ssm_conv_s5__prompt_kernel_poll47
gated_mix__spectral_gfnet__ssm_conv_s5__prompt_kernel_pollout48:
gated_mix__spectral_gfnet__ssm_conv_s5__prompt_kernel_skip46:
  s_waitcnt vmcnt(8) lgkmcnt(4)
  s_barrier
  v_mfma_f32_16x16x32_bf16 v[8:11], v[128:131], a[176:179], v[8:11]
  ds_read_b64_tr_b16 v[96:97], v240 offset:0
  ds_read_b64_tr_b16 v[98:99], v241 offset:0
  v_mfma_f32_16x16x32_bf16 v[40:43], v[128:131], a[184:187], v[40:43]
  ds_read_b64_tr_b16 v[100:101], v240 offset:2048
  ds_read_b64_tr_b16 v[102:103], v241 offset:2048
  v_mfma_f32_16x16x32_bf16 v[44:47], v[132:135], a[184:187], v[44:47]
  ds_read_b64_tr_b16 v[104:105], v240 offset:4096
  ds_read_b64_tr_b16 v[106:107], v241 offset:4096
  v_mfma_f32_16x16x32_bf16 v[12:15], v[132:135], a[176:179], v[12:15]
  ds_read_b64_tr_b16 v[108:109], v240 offset:6144
  ds_read_b64_tr_b16 v[110:111], v241 offset:6144
  v_mfma_f32_16x16x32_bf16 v[16:19], v[136:139], a[176:179], v[16:19]
  ds_read_b64_tr_b16 v[112:113], v240 offset:256
  ds_read_b64_tr_b16 v[114:115], v241 offset:256
  v_mfma_f32_16x16x32_bf16 v[48:51], v[136:139], a[184:187], v[48:51]
  ds_read_b64_tr_b16 v[116:117], v240 offset:2304
  ds_read_b64_tr_b16 v[118:119], v241 offset:2304
  v_mfma_f32_16x16x32_bf16 v[52:55], v[140:143], a[184:187], v[52:55]
  ds_read_b64_tr_b16 v[120:121], v240 offset:4352
  ds_read_b64_tr_b16 v[122:123], v241 offset:4352
  v_mfma_f32_16x16x32_bf16 v[20:23], v[140:143], a[176:179], v[20:23]
  ds_read_b64_tr_b16 v[124:125], v240 offset:6400
  ds_read_b64_tr_b16 v[126:127], v241 offset:6400
  v_mfma_f32_16x16x32_bf16 v[8:11], v[144:147], a[180:183], v[8:11]
  s_add_u32 m0, s32, 98304
  s_nop 0
  buffer_load_dwordx4 v216, s[24:27], s29 offen offset:0 lds
  v_mfma_f32_16x16x32_bf16 v[40:43], v[144:147], a[188:191], v[40:43]
  v_mfma_f32_16x16x32_bf16 v[44:47], v[148:151], a[188:191], v[44:47]
  buffer_load_dwordx4 v217, s[24:27], s29 offen offset:1024 lds
  v_mfma_f32_16x16x32_bf16 v[12:15], v[148:151], a[180:183], v[12:15]
  v_mfma_f32_16x16x32_bf16 v[16:19], v[152:155], a[180:183], v[16:19]
  s_add_u32 m0, s32, 100352
  s_nop 0
  buffer_load_dwordx4 v218, s[24:27], s29 offen offset:0 lds
  v_mfma_f32_16x16x32_bf16 v[48:51], v[152:155], a[188:191], v[48:51]
  v_mfma_f32_16x16x32_bf16 v[52:55], v[156:159], a[188:191], v[52:55]
  buffer_load_dwordx4 v219, s[24:27], s29 offen offset:1024 lds
  s_add_u32 s29, s29, 128
  s_and_b32 s29, s29, 0x3ff
  v_mfma_f32_16x16x32_bf16 v[20:23], v[156:159], a[180:183], v[20:23]
  buffer_load_dwordx4 v[176:179], v58, s[84:87], s7 offen offset:0 sc1
  buffer_load_dwordx4 v[180:183], v58, s[84:87], s7 offen offset:1024 sc1
  buffer_load_dwordx4 v[184:187], v58, s[84:87], s7 offen offset:2048 sc1
  buffer_load_dwordx4 v[188:191], v58, s[84:87], s7 offen offset:3072 sc1
  s_waitcnt lgkmcnt(0)
  v_mfma_f32_16x16x32_bf16 v[8:11], v[96:99], a[192:195], v[8:11]
  ds_read_b64_tr_b16 v[128:129], v240 offset:8192
  ds_read_b64_tr_b16 v[130:131], v241 offset:8192
  v_mfma_f32_16x16x32_bf16 v[40:43], v[96:99], a[200:203], v[40:43]
  ds_read_b64_tr_b16 v[132:133], v240 offset:10240
  ds_read_b64_tr_b16 v[134:135], v241 offset:10240
  v_mfma_f32_16x16x32_bf16 v[44:47], v[100:103], a[200:203], v[44:47]
  ds_read_b64_tr_b16 v[136:137], v240 offset:12288
  ds_read_b64_tr_b16 v[138:139], v241 offset:12288
  v_mfma_f32_16x16x32_bf16 v[12:15], v[100:103], a[192:195], v[12:15]
  ds_read_b64_tr_b16 v[140:141], v240 offset:14336
  ds_read_b64_tr_b16 v[142:143], v241 offset:14336
  v_mfma_f32_16x16x32_bf16 v[16:19], v[104:107], a[192:195], v[16:19]
  ds_read_b64_tr_b16 v[144:145], v240 offset:8448
  ds_read_b64_tr_b16 v[146:147], v241 offset:8448
  v_mfma_f32_16x16x32_bf16 v[48:51], v[104:107], a[200:203], v[48:51]
  ds_read_b64_tr_b16 v[148:149], v240 offset:10496
  ds_read_b64_tr_b16 v[150:151], v241 offset:10496
  v_mfma_f32_16x16x32_bf16 v[52:55], v[108:111], a[200:203], v[52:55]
  ds_read_b64_tr_b16 v[152:153], v240 offset:12544
  ds_read_b64_tr_b16 v[154:155], v241 offset:12544
  v_mfma_f32_16x16x32_bf16 v[20:23], v[108:111], a[192:195], v[20:23]
  ds_read_b64_tr_b16 v[156:157], v240 offset:14592
  ds_read_b64_tr_b16 v[158:159], v241 offset:14592
  v_mfma_f32_16x16x32_bf16 v[8:11], v[112:115], a[196:199], v[8:11]
  s_lshr_b32 m0, s3, 1
  s_lshl_b32 m0, m0, 15
  s_add_u32 s79, s79, m0
  s_and_b32 s79, s79, 0x3ffff
  s_and_b32 m0, s3, 1
  s_lshl_b32 m0, m0, 14
  v_and_b32 v59, 0xffffafff, v59
  v_or_b32 v59, m0, v59
  s_add_u32 m0, s92, 32768
  s_nop 0
  buffer_load_dwordx4 v59, s[80:83], s79 offen offset:0 sc1 lds
  v_mfma_f32_16x16x32_bf16 v[40:43], v[112:115], a[204:207], v[40:43]
  v_mfma_f32_16x16x32_bf16 v[44:47], v[116:119], a[204:207], v[44:47]
  buffer_load_dwordx4 v59, s[80:83], s79 offen offset:1024 sc1 lds
  v_mfma_f32_16x16x32_bf16 v[12:15], v[116:119], a[196:199], v[12:15]
  v_mfma_f32_16x16x32_bf16 v[16:19], v[120:123], a[196:199], v[16:19]
  buffer_load_dwordx4 v59, s[80:83], s79 offen offset:2048 sc1 lds
  v_mfma_f32_16x16x32_bf16 v[48:51], v[120:123], a[204:207], v[48:51]
  v_mfma_f32_16x16x32_bf16 v[52:55], v[124:127], a[204:207], v[52:55]
  buffer_load_dwordx4 v59, s[80:83], s79 offen offset:3072 sc1 lds
  s_add_u32 s79, s79, 65536
  s_and_b32 s79, s79, 0x3ffff
  v_mfma_f32_16x16x32_bf16 v[20:23], v[124:127], a[196:199], v[20:23]
  v_xor_b32 v222, 0x30000, v222
  v_xor_b32 v223, 0x30000, v223
  s_waitcnt vmcnt(16)
  ds_read_b128 a[224:227], v222 offset:16384
  ds_read_b128 a[228:231], v223 offset:16384
  ds_read_b128 a[232:235], v222 offset:18432
  ds_read_b128 a[236:239], v223 offset:18432
  s_waitcnt vmcnt(12) lgkmcnt(4)
  s_barrier
  v_mfma_f32_16x16x32_bf16 v[8:11], v[128:131], a[208:211], v[8:11]
  ds_read_b64_tr_b16 v[96:97], v240 offset:16384
  ds_read_b64_tr_b16 v[98:99], v241 offset:16384
  v_mfma_f32_16x16x32_bf16 v[40:43], v[128:131], a[216:219], v[40:43]
  ds_read_b64_tr_b16 v[100:101], v240 offset:18432
  ds_read_b64_tr_b16 v[102:103], v241 offset:18432
  v_mfma_f32_16x16x32_bf16 v[44:47], v[132:135], a[216:219], v[44:47]
  ds_read_b64_tr_b16 v[104:105], v240 offset:20480
  ds_read_b64_tr_b16 v[106:107], v241 offset:20480
  v_mfma_f32_16x16x32_bf16 v[12:15], v[132:135], a[208:211], v[12:15]
  ds_read_b64_tr_b16 v[108:109], v240 offset:22528
  ds_read_b64_tr_b16 v[110:111], v241 offset:22528
  v_mfma_f32_16x16x32_bf16 v[16:19], v[136:139], a[208:211], v[16:19]
  ds_read_b64_tr_b16 v[112:113], v240 offset:16640
  ds_read_b64_tr_b16 v[114:115], v241 offset:16640
  v_mfma_f32_16x16x32_bf16 v[48:51], v[136:139], a[216:219], v[48:51]
  ds_read_b64_tr_b16 v[116:117], v240 offset:18688
  ds_read_b64_tr_b16 v[118:119], v241 offset:18688
  v_mfma_f32_16x16x32_bf16 v[52:55], v[140:143], a[216:219], v[52:55]
  ds_read_b64_tr_b16 v[120:121], v240 offset:20736
  ds_read_b64_tr_b16 v[122:123], v241 offset:20736
  v_mfma_f32_16x16x32_bf16 v[20:23], v[140:143], a[208:211], v[20:23]
  ds_read_b64_tr_b16 v[124:125], v240 offset:22784
  ds_read_b64_tr_b16 v[126:127], v241 offset:22784
  v_mfma_f32_16x16x32_bf16 v[8:11], v[144:147], a[212:215], v[8:11]
  s_add_u32 m0, s92, 49152
  s_nop 0
  buffer_load_dwordx4 v59, s[80:83], s79 offen offset:0 sc1 lds
  s_lshl_b32 s29, s3, 10
  s_add_u32 s29, s29, 131072
  v_lshl_add_u32 v175, v1, 4, s29
  s_waitcnt vmcnt(8)
  v_lshlrev_b32 v192, 16, v176
  v_lshlrev_b32 v193, 16, v177
  s_waitcnt vmcnt(7)
  v_lshlrev_b32 v194, 16, v180
  v_lshlrev_b32 v195, 16, v181
  s_waitcnt vmcnt(6)
  v_lshlrev_b32 v196, 16, v184
  v_lshlrev_b32 v197, 16, v185
  s_waitcnt vmcnt(5)
  v_lshlrev_b32 v198, 16, v188
  v_lshlrev_b32 v199, 16, v189
  v_pk_add_f32 v[200:201], v[192:193], v[196:197]
  v_pk_add_f32 v[204:205], v[192:193], v[196:197] neg_lo:[0,1] neg_hi:[0,1]
  v_pk_add_f32 v[208:209], v[194:195], v[198:199]
  v_pk_add_f32 v[202:203], v[176:177], v[184:185]
  v_pk_add_f32 v[206:207], v[176:177], v[184:185] neg_lo:[0,1] neg_hi:[0,1]
  v_pk_add_f32 v[210:211], v[180:181], v[188:189]
  v_pk_add_f32 v[212:213], v[188:189], v[180:181] neg_lo:[0,1] neg_hi:[0,1]
  v_pk_add_f32 v[214:215], v[194:195], v[198:199] neg_lo:[0,1] neg_hi:[0,1]
  s_cmp_lg_u32 s8, 0
  s_cbranch_scc1 gated_mix__spectral_gfnet__ssm_conv_s5__prompt_kernel_skip49
  s_mov_b64 exec, 15
  v_pk_add_f32 v[208:209], v[194:195], v[194:195]
  v_pk_add_f32 v[210:211], v[198:199], v[198:199]
  v_pk_add_f32 v[212:213], v[180:181], v[180:181] neg_lo:[1,1] neg_hi:[1,1]
  v_pk_add_f32 v[214:215], v[188:189], v[188:189] neg_lo:[1,1] neg_hi:[1,1]
  s_mov_b64 exec, -1
gated_mix__spectral_gfnet__ssm_conv_s5__prompt_kernel_skip49:
  v_pk_add_f32 v[192:193], v[200:201], v[208:209]
  v_pk_add_f32 v[176:177], v[202:203], v[210:211]
  v_cvt_pk_bf16_f32 v216, v192, v193
  v_cvt_pk_bf16_f32 v218, v176, v177
  v_pk_add_f32 v[194:195], v[204:205], v[212:213]
  v_pk_add_f32 v[180:181], v[206:207], v[214:215]
  v_cvt_pk_bf16_f32 v224, v194, v195
  v_cvt_pk_bf16_f32 v226, v180, v181
  v_pk_add_f32 v[196:197], v[200:201], v[208:209] neg_lo:[0,1] neg_hi:[0,1]
  v_pk_add_f32 v[184:185], v[202:203], v[210:211] neg_lo:[0,1] neg_hi:[0,1]
  v_cvt_pk_bf16_f32 v228, v196, v197
  v_cvt_pk_bf16_f32 v230, v184, v185
  v_pk_add_f32 v[198:199], v[204:205], v[212:213] neg_lo:[0,1] neg_hi:[0,1]
  v_pk_add_f32 v[188:189], v[206:207], v[214:215] neg_lo:[0,1] neg_hi:[0,1]
  v_cvt_pk_bf16_f32 v232, v198, v199
  v_cvt_pk_bf16_f32 v234, v188, v189
  v_lshlrev_b32 v192, 16, v178
  v_lshlrev_b32 v193, 16, v179
  v_lshlrev_b32 v194, 16, v182
  v_lshlrev_b32 v195, 16, v183
  v_lshlrev_b32 v196, 16, v186
  v_lshlrev_b32 v197, 16, v187
  v_lshlrev_b32 v198, 16, v190
  v_lshlrev_b32 v199, 16, v191
  v_pk_add_f32 v[200:201], v[192:193], v[196:197]
  v_pk_add_f32 v[204:205], v[192:193], v[196:197] neg_lo:[0,1] neg_hi:[0,1]
  v_pk_add_f32 v[208:209], v[194:195], v[198:199]
  v_pk_add_f32 v[202:203], v[178:179], v[186:187]
  v_pk_add_f32 v[206:207], v[178:179], v[186:187] neg_lo:[0,1] neg_hi:[0,1]
  v_pk_add_f32 v[210:211], v[182:183], v[190:191]
  v_pk_add_f32 v[212:213], v[190:191], v[182:183] neg_lo:[0,1] neg_hi:[0,1]
  v_pk_add_f32 v[214:215], v[194:195], v[198:199] neg_lo:[0,1] neg_hi:[0,1]
  s_cmp_lg_u32 s8, 0
  s_cbranch_scc1 gated_mix__spectral_gfnet__ssm_conv_s5__prompt_kernel_skip50
  s_mov_b64 exec, 15
  v_pk_add_f32 v[208:209], v[194:195], v[194:195]
  v_pk_add_f32 v[210:211], v[198:199], v[198:199]
  v_pk_add_f32 v[212:213], v[182:183], v[182:183] neg_lo:[1,1] neg_hi:[1,1]
  v_pk_add_f32 v[214:215], v[190:191], v[190:191] neg_lo:[1,1] neg_hi:[1,1]
  s_mov_b64 exec, -1
gated_mix__spectral_gfnet__ssm_conv_s5__prompt_kernel_skip50:
  v_pk_add_f32 v[192:193], v[200:201], v[208:209]
  v_pk_add_f32 v[178:179], v[202:203], v[210:211]
  v_cvt_pk_bf16_f32 v217, v192, v193
  v_cvt_pk_bf16_f32 v219, v178, v179
  ds_write_b128 v175, v[216:219] offset:0
  v_pk_add_f32 v[194:195], v[204:205], v[212:213]
  v_pk_add_f32 v[182:183], v[206:207], v[214:215]
  v_cvt_pk_bf16_f32 v225, v194, v195
  v_cvt_pk_bf16_f32 v227, v182, v183
  ds_write_b128 v175, v[224:227] offset:4096
  v_pk_add_f32 v[196:197], v[200:201], v[208:209] neg_lo:[0,1] neg_hi:[0,1]
  v_pk_add_f32 v[186:187], v[202:203], v[210:211] neg_lo:[0,1] neg_hi:[0,1]
  v_cvt_pk_bf16_f32 v229, v196, v197
  v_cvt_pk_bf16_f32 v231, v186, v187
  ds_write_b128 v175, v[228:231] offset:8192
  v_pk_add_f32 v[198:199], v[204:205], v[212:213] neg_lo:[0,1] neg_hi:[0,1]
  v_pk_add_f32 v[190:191], v[206:207], v[214:215] neg_lo:[0,1] neg_hi:[0,1]
  v_cvt_pk_bf16_f32 v233, v198, v199
  v_cvt_pk_bf16_f32 v235, v190, v191
  ds_write_b128 v175, v[232:235] offset:12288
  v_mfma_f32_16x16x32_bf16 v[40:43], v[144:147], a[220:223], v[40:43]
  v_mfma_f32_16x16x32_bf16 v[44:47], v[148:151], a[220:223], v[44:47]
  buffer_load_dwordx4 v59, s[80:83], s79 offen offset:1024 sc1 lds
  v_mfma_f32_16x16x32_bf16 v[12:15], v[148:151], a[212:215], v[12:15]
  v_mfma_f32_16x16x32_bf16 v[16:19], v[152:155], a[212:215], v[16:19]
  buffer_load_dwordx4 v59, s[80:83], s79 offen offset:2048 sc1 lds
  v_mfma_f32_16x16x32_bf16 v[48:51], v[152:155], a[220:223], v[48:51]
  v_mfma_f32_16x16x32_bf16 v[52:55], v[156:159], a[220:223], v[52:55]
  buffer_load_dwordx4 v59, s[80:83], s79 offen offset:3072 sc1 lds
  s_add_u32 s79, s79, 65536
  s_and_b32 s79, s79, 0x3ffff
  v_mfma_f32_16x16x32_bf16 v[20:23], v[156:159], a[212:215], v[20:23]
  s_waitcnt lgkmcnt(4)
  v_mfma_f32_16x16x32_bf16 v[8:11], v[96:99], a[224:227], v[8:11]
  ds_read_b64_tr_b16 v[128:129], v240 offset:24576
  ds_read_b64_tr_b16 v[130:131], v241 offset:24576
  v_mfma_f32_16x16x32_bf16 v[40:43], v[96:99], a[232:235], v[40:43]
  ds_read_b64_tr_b16 v[132:133], v240 offset:26624
  ds_read_b64_tr_b16 v[134:135], v241 offset:26624
  v_mfma_f32_16x16x32_bf16 v[44:47], v[100:103], a[232:235], v[44:47]
  ds_read_b64_tr_b16 v[136:137], v240 offset:28672
  ds_read_b64_tr_b16 v[138:139], v241 offset:28672
  v_mfma_f32_16x16x32_bf16 v[12:15], v[100:103], a[224:227], v[12:15]
  ds_read_b64_tr_b16 v[140:141], v240 offset:30720
  ds_read_b64_tr_b16 v[142:143], v241 offset:30720
  v_mfma_f32_16x16x32_bf16 v[16:19], v[104:107], a[224:227], v[16:19]
  ds_read_b64_tr_b16 v[144:145], v240 offset:24832
  ds_read_b64_tr_b16 v[146:147], v241 offset:24832
  v_mfma_f32_16x16x32_bf16 v[48:51], v[104:107], a[232:235], v[48:51]
  ds_read_b64_tr_b16 v[148:149], v240 offset:26880
  ds_read_b64_tr_b16 v[150:151], v241 offset:26880
  v_mfma_f32_16x16x32_bf16 v[52:55], v[108:111], a[232:235], v[52:55]
  ds_read_b64_tr_b16 v[152:153], v240 offset:28928
  ds_read_b64_tr_b16 v[154:155], v241 offset:28928
  v_mfma_f32_16x16x32_bf16 v[20:23], v[108:111], a[224:227], v[20:23]
  ds_read_b64_tr_b16 v[156:157], v240 offset:30976
  ds_read_b64_tr_b16 v[158:159], v241 offset:30976
  v_mfma_f32_16x16x32_bf16 v[8:11], v[112:115], a[228:231], v[8:11]
  s_add_u32 m0, s92, 65536
  s_nop 0
  buffer_load_dwordx4 v59, s[80:83], s79 offen offset:0 sc1 lds
  v_mfma_f32_16x16x32_bf16 v[40:43], v[112:115], a[236:239], v[40:43]
  v_mfma_f32_16x16x32_bf16 v[44:47], v[116:119], a[236:239], v[44:47]
  buffer_load_dwordx4 v59, s[80:83], s79 offen offset:1024 sc1 lds
  v_mfma_f32_16x16x32_bf16 v[12:15], v[116:119], a[228:231], v[12:15]
  v_mfma_f32_16x16x32_bf16 v[16:19], v[120:123], a[228:231], v[16:19]
  buffer_load_dwordx4 v59, s[80:83], s79 offen offset:2048 sc1 lds
  v_mfma_f32_16x16x32_bf16 v[48:51], v[120:123], a[236:239], v[48:51]
  v_mfma_f32_16x16x32_bf16 v[52:55], v[124:127], a[236:239], v[52:55]
  buffer_load_dwordx4 v59, s[80:83], s79 offen offset:3072 sc1 lds
  s_add_u32 s79, s79, 65536
  s_and_b32 s79, s79, 0x3ffff
  v_mfma_f32_16x16x32_bf16 v[20:23], v[124:127], a[228:231], v[20:23]
  v_xor_b32 v222, 0x30000, v222
  v_xor_b32 v223, 0x30000, v223
  ds_read_b128 a[240:243], v222 offset:32768
  ds_read_b128 a[244:247], v223 offset:32768
  ds_read_b128 a[248:251], v222 offset:34816
  ds_read_b128 a[252:255], v223 offset:34816
  s_waitcnt lgkmcnt(15)
  s_waitcnt vmcnt(8) lgkmcnt(4)
  s_barrier
  s_waitcnt lgkmcnt(3)
  v_mfma_f32_16x16x32_bf16 v[8:11], v[128:131], a[240:243], v[8:11]
  ds_read_b64_tr_b16 v[96:97], v240 offset:32768
  ds_read_b64_tr_b16 v[98:99], v241 offset:32768
  s_waitcnt lgkmcnt(3)
  v_mfma_f32_16x16x32_bf16 v[40:43], v[128:131], a[248:251], v[40:43]
  ds_read_b64_tr_b16 v[100:101], v240 offset:34816
  ds_read_b64_tr_b16 v[102:103], v241 offset:34816
  v_mfma_f32_16x16x32_bf16 v[44:47], v[132:135], a[248:251], v[44:47]
  ds_read_b64_tr_b16 v[104:105], v240 offset:36864
  ds_read_b64_tr_b16 v[106:107], v241 offset:36864
  v_mfma_f32_16x16x32_bf16 v[12:15], v[132:135], a[240:243], v[12:15]
  ds_read_b64_tr_b16 v[108:109], v240 offset:38912
  ds_read_b64_tr_b16 v[110:111], v241 offset:38912
  v_mfma_f32_16x16x32_bf16 v[16:19], v[136:139], a[240:243], v[16:19]
  ds_read_b64_tr_b16 v[112:113], v240 offset:33024
  ds_read_b64_tr_b16 v[114:115], v241 offset:33024
  v_mfma_f32_16x16x32_bf16 v[48:51], v[136:139], a[248:251], v[48:51]
  ds_read_b64_tr_b16 v[116:117], v240 offset:35072
  ds_read_b64_tr_b16 v[118:119], v241 offset:35072
  v_mfma_f32_16x16x32_bf16 v[52:55], v[140:143], a[248:251], v[52:55]
  ds_read_b64_tr_b16 v[120:121], v240 offset:37120
  ds_read_b64_tr_b16 v[122:123], v241 offset:37120
  v_mfma_f32_16x16x32_bf16 v[20:23], v[140:143], a[240:243], v[20:23]
  ds_read_b64_tr_b16 v[124:125], v240 offset:39168
  ds_read_b64_tr_b16 v[126:127], v241 offset:39168
  v_mfma_f32_16x16x32_bf16 v[8:11], v[144:147], a[244:247], v[8:11]
  s_add_u32 m0, s92, 81920
  s_nop 0
  buffer_load_dwordx4 v59, s[80:83], s79 offen offset:0 sc1 lds
  s_waitcnt lgkmcnt(15)
  v_mfma_f32_16x16x32_bf16 v[40:43], v[144:147], a[252:255], v[40:43]
  v_mfma_f32_16x16x32_bf16 v[44:47], v[148:151], a[252:255], v[44:47]
  buffer_load_dwordx4 v59, s[80:83], s79 offen offset:1024 sc1 lds
  v_mfma_f32_16x16x32_bf16 v[12:15], v[148:151], a[244:247], v[12:15]
  v_mfma_f32_16x16x32_bf16 v[16:19], v[152:155], a[244:247], v[16:19]
  buffer_load_dwordx4 v59, s[80:83], s79 offen offset:2048 sc1 lds
  v_mfma_f32_16x16x32_bf16 v[48:51], v[152:155], a[252:255], v[48:51]
  v_mfma_f32_16x16x32_bf16 v[52:55], v[156:159], a[252:255], v[52:55]
  buffer_load_dwordx4 v59, s[80:83], s79 offen offset:3072 sc1 lds
  s_add_u32 s79, s79, 65536
  s_and_b32 s79, s79, 0x3ffff
  v_xor_b32 v59, 4096, v59
  v_mfma_f32_16x16x32_bf16 v[20:23], v[156:159], a[244:247], v[20:23]
  buffer_load_dwordx4 v[224:227], v174, s[88:91], s43 offen offset:0 sc1
  buffer_load_dwordx4 v[228:231], v174, s[88:91], s43 offen offset:256 sc1
  buffer_load_dwordx4 v[232:235], v174, s[88:91], s43 offen offset:512 sc1
  buffer_load_dwordx4 v[236:239], v174, s[88:91], s43 offen offset:768 sc1
  ds_read_b64_tr_b16 v[176:177], v5 offset:0
  ds_read_b64_tr_b16 v[178:179], v5 offset:256
  ds_read_b64_tr_b16 v[180:181], v5 offset:1024
  ds_read_b64_tr_b16 v[182:183], v5 offset:1280
  ds_read_b64_tr_b16 v[184:185], v5 offset:2048
  ds_read_b64_tr_b16 v[186:187], v5 offset:2304
  ds_read_b64_tr_b16 v[188:189], v5 offset:3072
  ds_read_b64_tr_b16 v[190:191], v5 offset:3328
  s_waitcnt lgkmcnt(8)
  v_mfma_f32_16x16x32_bf16 v[64:67], v[96:99], a[0:3], v[64:67]
  ds_read_b64_tr_b16 v[128:129], v240 offset:40960
  ds_read_b64_tr_b16 v[130:131], v241 offset:40960
  v_mfma_f32_16x16x32_bf16 v[80:83], v[96:99], a[8:11], 0
  ds_read_b64_tr_b16 v[132:133], v240 offset:43008
  ds_read_b64_tr_b16 v[134:135], v241 offset:43008
  v_mfma_f32_16x16x32_bf16 v[84:87], v[100:103], a[8:11], 0
  ds_read_b64_tr_b16 v[136:137], v240 offset:45056
  ds_read_b64_tr_b16 v[138:139], v241 offset:45056
  v_mfma_f32_16x16x32_bf16 v[68:71], v[100:103], a[0:3], v[68:71]
  ds_read_b64_tr_b16 v[140:141], v240 offset:47104
  ds_read_b64_tr_b16 v[142:143], v241 offset:47104
  v_mfma_f32_16x16x32_bf16 v[64:67], v[104:107], a[16:19], v[64:67]
  ds_read_b64_tr_b16 v[144:145], v240 offset:41216
  ds_read_b64_tr_b16 v[146:147], v241 offset:41216
  v_mfma_f32_16x16x32_bf16 v[80:83], v[104:107], a[24:27], v[80:83]
  ds_read_b64_tr_b16 v[148:149], v240 offset:43264
  ds_read_b64_tr_b16 v[150:151], v241 offset:43264
  v_mfma_f32_16x16x32_bf16 v[84:87], v[108:111], a[24:27], v[84:87]
  ds_read_b64_tr_b16 v[152:153], v240 offset:45312
  ds_read_b64_tr_b16 v[154:155], v241 offset:45312
  v_mfma_f32_16x16x32_bf16 v[68:71], v[108:111], a[16:19], v[68:71]
  ds_read_b64_tr_b16 v[156:157], v240 offset:47360
  ds_read_b64_tr_b16 v[158:159], v241 offset:47360
  v_mfma_f32_16x16x32_bf16 v[64:67], v[112:115], a[4:7], v[64:67]
  s_add_u32 m0, s92, 0
  s_nop 0
  buffer_load_dwordx4 v59, s[80:83], s79 offen offset:0 sc1 lds
  s_waitcnt lgkmcnt(15)
  v_mfma_f32_16x16x32_bf16 v[192:195], v[24:27], v[176:179], 0
  s_waitcnt lgkmcnt(15)
  v_mfma_f32_16x16x32_bf16 v[208:211], v[24:27], v[184:187], 0
  v_mfma_f32_16x16x32_bf16 v[80:83], v[112:115], a[12:15], v[80:83]
  v_mfma_f32_16x16x32_bf16 v[196:199], v[32:35], v[176:179], 0
  v_mfma_f32_16x16x32_bf16 v[212:215], v[32:35], v[184:187], 0
  v_mfma_f32_16x16x32_bf16 v[84:87], v[116:119], a[12:15], v[84:87]
  buffer_load_dwordx4 v59, s[80:83], s79 offen offset:1024 sc1 lds
  v_mfma_f32_16x16x32_bf16 v[200:203], v[60:63], v[176:179], 0
  v_mfma_f32_16x16x32_bf16 v[216:219], v[60:63], v[184:187], 0
  v_mfma_f32_16x16x32_bf16 v[68:71], v[116:119], a[4:7], v[68:71]
  v_mfma_f32_16x16x32_bf16 v[204:207], v[164:167], v[176:179], 0
  v_mfma_f32_16x16x32_bf16 v[220:223], v[164:167], v[184:187], 0
  v_mfma_f32_16x16x32_bf16 v[64:67], v[120:123], a[20:23], v[64:67]
  buffer_load_dwordx4 v59, s[80:83], s79 offen offset:2048 sc1 lds
  v_mfma_f32_16x16x32_bf16 v[192:195], v[28:31], v[180:183], v[192:195]
  s_waitcnt lgkmcnt(15)
  v_mfma_f32_16x16x32_bf16 v[208:211], v[28:31], v[188:191], v[208:211]
  v_mfma_f32_16x16x32_bf16 v[80:83], v[120:123], a[28:31], v[80:83]
  v_mfma_f32_16x16x32_bf16 v[196:199], v[36:39], v[180:183], v[196:199]
  v_mfma_f32_16x16x32_bf16 v[212:215], v[36:39], v[188:191], v[212:215]
  v_mfma_f32_16x16x32_bf16 v[84:87], v[124:127], a[28:31], v[84:87]
  buffer_load_dwordx4 v59, s[80:83], s79 offen offset:3072 sc1 lds
  s_add_u32 s79, s79, 65536
  s_and_b32 s79, s79, 0x3ffff
  v_mfma_f32_16x16x32_bf16 v[200:203], v[160:163], v[180:183], v[200:203]
  v_mfma_f32_16x16x32_bf16 v[216:219], v[160:163], v[188:191], v[216:219]
  v_mfma_f32_16x16x32_bf16 v[68:71], v[124:127], a[20:23], v[68:71]
  v_mfma_f32_16x16x32_bf16 v[204:207], v[168:171], v[180:183], v[204:207]
  v_mfma_f32_16x16x32_bf16 v[220:223], v[168:171], v[188:191], v[220:223]
  s_waitcnt vmcnt(12) lgkmcnt(0)
  s_barrier
  v_mfma_f32_16x16x32_bf16 v[64:67], v[128:131], a[32:35], v[64:67]
  ds_read_b64_tr_b16 v[96:97], v240 offset:49152
  ds_read_b64_tr_b16 v[98:99], v241 offset:49152
  v_mfma_f32_16x16x32_bf16 v[80:83], v[128:131], a[40:43], v[80:83]
  ds_read_b64_tr_b16 v[100:101], v240 offset:51200
  ds_read_b64_tr_b16 v[102:103], v241 offset:51200
  v_mfma_f32_16x16x32_bf16 v[84:87], v[132:135], a[40:43], v[84:87]
  ds_read_b64_tr_b16 v[104:105], v240 offset:53248
  ds_read_b64_tr_b16 v[106:107], v241 offset:53248
  v_mfma_f32_16x16x32_bf16 v[68:71], v[132:135], a[32:35], v[68:71]
  ds_read_b64_tr_b16 v[108:109], v240 offset:55296
  ds_read_b64_tr_b16 v[110:111], v241 offset:55296
  v_mfma_f32_16x16x32_bf16 v[64:67], v[136:139], a[48:51], v[64:67]
  ds_read_b64_tr_b16 v[112:113], v240 offset:49408
  ds_read_b64_tr_b16 v[114:115], v241 offset:49408
  v_mfma_f32_16x16x32_bf16 v[80:83], v[136:139], a[56:59], v[80:83]
  ds_read_b64_tr_b16 v[116:117], v240 offset:51456
  ds_read_b64_tr_b16 v[118:119], v241 offset:51456
  v_mfma_f32_16x16x32_bf16 v[84:87], v[140:143], a[56:59], v[84:87]
  ds_read_b64_tr_b16 v[120:121], v240 offset:53504
  ds_read_b64_tr_b16 v[122:123], v241 offset:53504
  v_mfma_f32_16x16x32_bf16 v[68:71], v[140:143], a[48:51], v[68:71]
  ds_read_b64_tr_b16 v[124:125], v240 offset:55552
  ds_read_b64_tr_b16 v[126:127], v241 offset:55552
  v_mfma_f32_16x16x32_bf16 v[64:67], v[144:147], a[36:39], v[64:67]
  s_add_u32 m0, s92, 16384
  s_nop 0
  buffer_load_dwordx4 v59, s[80:83], s79 offen offset:0 sc1 lds
  v_xor_b32 v177, 0x80008000, v177
  v_xor_b32 v179, 0x80008000, v179
  v_xor_b32 v181, 0x80008000, v181
  v_xor_b32 v183, 0x80008000, v183
  v_xor_b32 v185, 0x80008000, v185
  v_xor_b32 v187, 0x80008000, v187
  v_xor_b32 v189, 0x80008000, v189
  v_xor_b32 v191, 0x80008000, v191
  v_pk_add_f32 v[192:193], v[192:193], v[8:9] neg_lo:[0,1] neg_hi:[0,1]
  v_pk_add_f32 v[194:195], v[194:195], v[10:11] neg_lo:[0,1] neg_hi:[0,1]
  s_waitcnt vmcnt(8)
  v_pk_fma_f32 v[8:9], v[224:225], v[192:193], v[8:9]
  v_pk_fma_f32 v[10:11], v[226:227], v[194:195], v[10:11]
  v_mfma_f32_16x16x32_bf16 v[80:83], v[144:147], a[44:47], v[80:83]
  v_pk_add_f32 v[208:209], v[208:209], v[40:41] neg_lo:[0,1] neg_hi:[0,1]
  v_pk_add_f32 v[210:211], v[210:211], v[42:43] neg_lo:[0,1] neg_hi:[0,1]
  v_pk_fma_f32 v[40:41], v[224:225], v[208:209], v[40:41]
  v_pk_fma_f32 v[42:43], v[226:227], v[210:211], v[42:43]
  v_or_b32_sdwa v40, v8, v7 dst_sel:WORD_0 dst_unused:UNUSED_PRESERVE src0_sel:WORD_1 src1_sel:WORD_0
  v_or_b32_sdwa v41, v9, v7 dst_sel:WORD_0 dst_unused:UNUSED_PRESERVE src0_sel:WORD_1 src1_sel:WORD_0
  v_or_b32_sdwa v42, v10, v7 dst_sel:WORD_0 dst_unused:UNUSED_PRESERVE src0_sel:WORD_1 src1_sel:WORD_0
  v_or_b32_sdwa v43, v11, v7 dst_sel:WORD_0 dst_unused:UNUSED_PRESERVE src0_sel:WORD_1 src1_sel:WORD_0
  s_nop 0
  buffer_store_dwordx4 v[40:43], v58, s[44:47], s6 offen offset:0 sc1
  v_pk_add_f32 v[196:197], v[196:197], v[12:13] neg_lo:[0,1] neg_hi:[0,1]
  v_pk_add_f32 v[198:199], v[198:199], v[14:15] neg_lo:[0,1] neg_hi:[0,1]
  s_waitcnt vmcnt(8)
  v_pk_fma_f32 v[12:13], v[228:229], v[196:197], v[12:13]
  v_mfma_f32_16x16x32_bf16 v[84:87], v[148:151], a[44:47], v[84:87]
  buffer_load_dwordx4 v59, s[80:83], s79 offen offset:1024 sc1 lds
  v_pk_fma_f32 v[14:15], v[230:231], v[198:199], v[14:15]
  v_pk_add_f32 v[212:213], v[212:213], v[44:45] neg_lo:[0,1] neg_hi:[0,1]
  v_pk_add_f32 v[214:215], v[214:215], v[46:47] neg_lo:[0,1] neg_hi:[0,1]
  v_pk_fma_f32 v[44:45], v[228:229], v[212:213], v[44:45]
  v_pk_fma_f32 v[46:47], v[230:231], v[214:215], v[46:47]
  v_or_b32_sdwa v44, v12, v7 dst_sel:WORD_0 dst_unused:UNUSED_PRESERVE src0_sel:WORD_1 src1_sel:WORD_0
  v_or_b32_sdwa v45, v13, v7 dst_sel:WORD_0 dst_unused:UNUSED_PRESERVE src0_sel:WORD_1 src1_sel:WORD_0
  v_or_b32_sdwa v46, v14, v7 dst_sel:WORD_0 dst_unused:UNUSED_PRESERVE src0_sel:WORD_1 src1_sel:WORD_0
  v_or_b32_sdwa v47, v15, v7 dst_sel:WORD_0 dst_unused:UNUSED_PRESERVE src0_sel:WORD_1 src1_sel:WORD_0
  s_nop 0
  buffer_store_dwordx4 v[44:47], v58, s[44:47], s6 offen offset:1024 sc1
  v_pk_add_f32 v[200:201], v[200:201], v[16:17] neg_lo:[0,1] neg_hi:[0,1]
  v_pk_add_f32 v[202:203], v[202:203], v[18:19] neg_lo:[0,1] neg_hi:[0,1]
  v_mfma_f32_16x16x32_bf16 v[68:71], v[148:151], a[36:39], v[68:71]
  s_waitcnt vmcnt(9)
  v_pk_fma_f32 v[16:17], v[232:233], v[200:201], v[16:17]
  v_pk_fma_f32 v[18:19], v[234:235], v[202:203], v[18:19]
  v_pk_add_f32 v[216:217], v[216:217], v[48:49] neg_lo:[0,1] neg_hi:[0,1]
  v_pk_add_f32 v[218:219], v[218:219], v[50:51] neg_lo:[0,1] neg_hi:[0,1]
  v_pk_fma_f32 v[48:49], v[232:233], v[216:217], v[48:49]
  v_pk_fma_f32 v[50:51], v[234:235], v[218:219], v[50:51]
  v_or_b32_sdwa v48, v16, v7 dst_sel:WORD_0 dst_unused:UNUSED_PRESERVE src0_sel:WORD_1 src1_sel:WORD_0
  v_or_b32_sdwa v49, v17, v7 dst_sel:WORD_0 dst_unused:UNUSED_PRESERVE src0_sel:WORD_1 src1_sel:WORD_0
  v_or_b32_sdwa v50, v18, v7 dst_sel:WORD_0 dst_unused:UNUSED_PRESERVE src0_sel:WORD_1 src1_sel:WORD_0
  v_or_b32_sdwa v51, v19, v7 dst_sel:WORD_0 dst_unused:UNUSED_PRESERVE src0_sel:WORD_1 src1_sel:WORD_0
  s_nop 0
  buffer_store_dwordx4 v[48:51], v58, s[44:47], s6 offen offset:2048 sc1
  v_pk_add_f32 v[204:205], v[204:205], v[20:21] neg_lo:[0,1] neg_hi:[0,1]
  v_mfma_f32_16x16x32_bf16 v[64:67], v[152:155], a[52:55], v[64:67]
  buffer_load_dwordx4 v59, s[80:83], s79 offen offset:2048 sc1 lds
  v_pk_add_f32 v[206:207], v[206:207], v[22:23] neg_lo:[0,1] neg_hi:[0,1]
  s_waitcnt vmcnt(10)
  v_pk_fma_f32 v[20:21], v[236:237], v[204:205], v[20:21]
  v_pk_fma_f32 v[22:23], v[238:239], v[206:207], v[22:23]
  v_pk_add_f32 v[220:221], v[220:221], v[52:53] neg_lo:[0,1] neg_hi:[0,1]
  v_pk_add_f32 v[222:223], v[222:223], v[54:55] neg_lo:[0,1] neg_hi:[0,1]
  v_pk_fma_f32 v[52:53], v[236:237], v[220:221], v[52:53]
  v_pk_fma_f32 v[54:55], v[238:239], v[222:223], v[54:55]
  v_or_b32_sdwa v52, v20, v7 dst_sel:WORD_0 dst_unused:UNUSED_PRESERVE src0_sel:WORD_1 src1_sel:WORD_0
  v_or_b32_sdwa v53, v21, v7 dst_sel:WORD_0 dst_unused:UNUSED_PRESERVE src0_sel:WORD_1 src1_sel:WORD_0
  v_or_b32_sdwa v54, v22, v7 dst_sel:WORD_0 dst_unused:UNUSED_PRESERVE src0_sel:WORD_1 src1_sel:WORD_0
  v_or_b32_sdwa v55, v23, v7 dst_sel:WORD_0 dst_unused:UNUSED_PRESERVE src0_sel:WORD_1 src1_sel:WORD_0
  s_nop 0
  buffer_store_dwordx4 v[52:55], v58, s[44:47], s6 offen offset:3072 sc1
  v_mfma_f32_16x16x32_bf16 v[80:83], v[152:155], a[60:63], v[80:83]
  s_xor_b32 s43, s43, 1024
  s_xor_b32 s6, s6, 131072
  v_mfma_f32_16x16x32_bf16 v[84:87], v[156:159], a[60:63], v[84:87]
  buffer_load_dwordx4 v59, s[80:83], s79 offen offset:3072 sc1 lds
  s_add_u32 s79, s79, 65536
  s_and_b32 s79, s79, 0x3ffff
  v_mfma_f32_16x16x32_bf16 v[68:71], v[156:159], a[52:55], v[68:71]
  s_waitcnt lgkmcnt(0)
  v_mfma_f32_16x16x32_bf16 v[64:67], v[96:99], a[64:67], v[64:67]
  ds_read_b64_tr_b16 v[128:129], v240 offset:57344
  ds_read_b64_tr_b16 v[130:131], v241 offset:57344
  v_mfma_f32_16x16x32_bf16 v[80:83], v[96:99], a[72:75], v[80:83]
  ds_read_b64_tr_b16 v[132:133], v240 offset:59392
  ds_read_b64_tr_b16 v[134:135], v241 offset:59392
  v_mfma_f32_16x16x32_bf16 v[84:87], v[100:103], a[72:75], v[84:87]
  ds_read_b64_tr_b16 v[136:137], v240 offset:61440
  ds_read_b64_tr_b16 v[138:139], v241 offset:61440
  v_mfma_f32_16x16x32_bf16 v[68:71], v[100:103], a[64:67], v[68:71]
  ds_read_b64_tr_b16 v[140:141], v240 offset:63488
  ds_read_b64_tr_b16 v[142:143], v241 offset:63488
  v_mfma_f32_16x16x32_bf16 v[64:67], v[104:107], a[80:83], v[64:67]
  ds_read_b64_tr_b16 v[144:145], v240 offset:57600
  ds_read_b64_tr_b16 v[146:147], v241 offset:57600
  v_mfma_f32_16x16x32_bf16 v[80:83], v[104:107], a[88:91], v[80:83]
  ds_read_b64_tr_b16 v[148:149], v240 offset:59648
  ds_read_b64_tr_b16 v[150:151], v241 offset:59648
  v_mfma_f32_16x16x32_bf16 v[84:87], v[108:111], a[88:91], v[84:87]
  ds_read_b64_tr_b16 v[152:153], v240 offset:61696
  ds_read_b64_tr_b16 v[154:155], v241 offset:61696
  v_mfma_f32_16x16x32_bf16 v[68:71], v[108:111], a[80:83], v[68:71]
  ds_read_b64_tr_b16 v[156:157], v240 offset:63744
  ds_read_b64_tr_b16 v[158:159], v241 offset:63744
  v_mfma_f32_16x16x32_bf16 v[64:67], v[112:115], a[68:71], v[64:67]
  s_add_u32 m0, s92, 32768
  s_nop 0
  buffer_load_dwordx4 v59, s[80:83], s79 offen offset:0 sc1 lds
  v_mfma_f32_16x16x32_bf16 v[80:83], v[112:115], a[76:79], v[80:83]
  v_mfma_f32_16x16x32_bf16 v[84:87], v[116:119], a[76:79], v[84:87]
  buffer_load_dwordx4 v59, s[80:83], s79 offen offset:1024 sc1 lds
  v_mfma_f32_16x16x32_bf16 v[68:71], v[116:119], a[68:71], v[68:71]
  v_mfma_f32_16x16x32_bf16 v[64:67], v[120:123], a[84:87], v[64:67]
  buffer_load_dwordx4 v59, s[80:83], s79 offen offset:2048 sc1 lds
  v_mfma_f32_16x16x32_bf16 v[80:83], v[120:123], a[92:95], v[80:83]
  v_mfma_f32_16x16x32_bf16 v[84:87], v[124:127], a[92:95], v[84:87]
  buffer_load_dwordx4 v59, s[80:83], s79 offen offset:3072 sc1 lds
  s_add_u32 s79, s79, 65536
  s_and_b32 s79, s79, 0x3ffff
  v_mfma_f32_16x16x32_bf16 v[68:71], v[124:127], a[84:87], v[68:71]
  s_waitcnt lgkmcnt(0)
  v_mfma_f32_16x16x32_bf16 v[64:67], v[128:131], a[96:99], v[64:67]
  ds_read_b64_tr_b16 v[96:97], v242 offset:0
  ds_read_b64_tr_b16 v[98:99], v243 offset:0
  v_mfma_f32_16x16x32_bf16 v[80:83], v[128:131], a[104:107], v[80:83]
  ds_read_b64_tr_b16 v[100:101], v242 offset:2048
  ds_read_b64_tr_b16 v[102:103], v243 offset:2048
  v_mfma_f32_16x16x32_bf16 v[84:87], v[132:135], a[104:107], v[84:87]
  ds_read_b64_tr_b16 v[104:105], v242 offset:4096
  ds_read_b64_tr_b16 v[106:107], v243 offset:4096
  v_mfma_f32_16x16x32_bf16 v[68:71], v[132:135], a[96:99], v[68:71]
  ds_read_b64_tr_b16 v[108:109], v242 offset:6144
  ds_read_b64_tr_b16 v[110:111], v243 offset:6144
  v_mfma_f32_16x16x32_bf16 v[64:67], v[136:139], a[112:115], v[64:67]
  ds_read_b64_tr_b16 v[112:113], v242 offset:256
  ds_read_b64_tr_b16 v[114:115], v243 offset:256
  v_mfma_f32_16x16x32_bf16 v[80:83], v[136:139], a[120:123], v[80:83]
  ds_read_b64_tr_b16 v[116:117], v242 offset:2304
  ds_read_b64_tr_b16 v[118:119], v243 offset:2304
  v_mfma_f32_16x16x32_bf16 v[84:87], v[140:143], a[120:123], v[84:87]
  ds_read_b64_tr_b16 v[120:121], v242 offset:4352
  ds_read_b64_tr_b16 v[122:123], v243 offset:4352
  v_mfma_f32_16x16x32_bf16 v[68:71], v[140:143], a[112:115], v[68:71]
  ds_read_b64_tr_b16 v[124:125], v242 offset:6400
  ds_read_b64_tr_b16 v[126:127], v243 offset:6400
  v_mfma_f32_16x16x32_bf16 v[64:67], v[144:147], a[100:103], v[64:67]
  v_mfma_f32_16x16x32_bf16 v[80:83], v[144:147], a[108:111], v[80:83]
  v_mfma_f32_16x16x32_bf16 v[84:87], v[148:151], a[108:111], v[84:87]
  v_mfma_f32_16x16x32_bf16 v[68:71], v[148:151], a[100:103], v[68:71]
  v_mfma_f32_16x16x32_bf16 v[64:67], v[152:155], a[116:119], v[64:67]
  v_mfma_f32_16x16x32_bf16 v[80:83], v[152:155], a[124:127], v[80:83]
  v_mfma_f32_16x16x32_bf16 v[84:87], v[156:159], a[124:127], v[84:87]
  v_mfma_f32_16x16x32_bf16 v[68:71], v[156:159], a[116:119], v[68:71]
  s_waitcnt lgkmcnt(0)
  v_mfma_f32_16x16x32_bf16 v[64:67], v[96:99], a[128:131], v[64:67]
  ds_read_b64_tr_b16 v[128:129], v242 offset:8192
  ds_read_b64_tr_b16 v[130:131], v243 offset:8192
  v_mfma_f32_16x16x32_bf16 v[80:83], v[96:99], a[136:139], v[80:83]
  ds_read_b64_tr_b16 v[132:133], v242 offset:10240
  ds_read_b64_tr_b16 v[134:135], v243 offset:10240
  v_mfma_f32_16x16x32_bf16 v[84:87], v[100:103], a[136:139], v[84:87]
  ds_read_b64_tr_b16 v[136:137], v242 offset:12288
  ds_read_b64_tr_b16 v[138:139], v243 offset:12288
  v_mfma_f32_16x16x32_bf16 v[68:71], v[100:103], a[128:131], v[68:71]
  ds_read_b64_tr_b16 v[140:141], v242 offset:14336
  ds_read_b64_tr_b16 v[142:143], v243 offset:14336
  v_mfma_f32_16x16x32_bf16 v[64:67], v[104:107], a[144:147], v[64:67]
  ds_read_b64_tr_b16 v[144:145], v242 offset:8448
  ds_read_b64_tr_b16 v[146:147], v243 offset:8448
  v_mfma_f32_16x16x32_bf16 v[80:83], v[104:107], a[152:155], v[80:83]
  ds_read_b64_tr_b16 v[148:149], v242 offset:10496
  ds_read_b64_tr_b16 v[150:151], v243 offset:10496
  v_mfma_f32_16x16x32_bf16 v[84:87], v[108:111], a[152:155], v[84:87]
  ds_read_b64_tr_b16 v[152:153], v242 offset:12544
  ds_read_b64_tr_b16 v[154:155], v243 offset:12544
  v_mfma_f32_16x16x32_bf16 v[68:71], v[108:111], a[144:147], v[68:71]
  ds_read_b64_tr_b16 v[156:157], v242 offset:14592
  ds_read_b64_tr_b16 v[158:159], v243 offset:14592
  v_mfma_f32_16x16x32_bf16 v[64:67], v[112:115], a[132:135], v[64:67]
  v_mfma_f32_16x16x32_bf16 v[80:83], v[112:115], a[140:143], v[80:83]
  v_mfma_f32_16x16x32_bf16 v[84:87], v[116:119], a[140:143], v[84:87]
  v_mfma_f32_16x16x32_bf16 v[68:71], v[116:119], a[132:135], v[68:71]
  v_mfma_f32_16x16x32_bf16 v[64:67], v[120:123], a[148:151], v[64:67]
  v_mfma_f32_16x16x32_bf16 v[80:83], v[120:123], a[156:159], v[80:83]
  v_mfma_f32_16x16x32_bf16 v[84:87], v[124:127], a[156:159], v[84:87]
  v_mfma_f32_16x16x32_bf16 v[68:71], v[124:127], a[148:151], v[68:71]
  s_waitcnt vmcnt(12) lgkmcnt(0)
  s_barrier
  v_mfma_f32_16x16x32_bf16 v[64:67], v[128:131], a[160:163], v[64:67]
  ds_read_b64_tr_b16 v[96:97], v242 offset:16384
  ds_read_b64_tr_b16 v[98:99], v243 offset:16384
  v_mfma_f32_16x16x32_bf16 v[80:83], v[128:131], a[168:171], v[80:83]
  ds_read_b64_tr_b16 v[100:101], v242 offset:18432
  ds_read_b64_tr_b16 v[102:103], v243 offset:18432
  v_mfma_f32_16x16x32_bf16 v[84:87], v[132:135], a[168:171], v[84:87]
  ds_read_b64_tr_b16 v[104:105], v242 offset:20480
  ds_read_b64_tr_b16 v[106:107], v243 offset:20480
  v_mfma_f32_16x16x32_bf16 v[68:71], v[132:135], a[160:163], v[68:71]
  ds_read_b64_tr_b16 v[108:109], v242 offset:22528
  ds_read_b64_tr_b16 v[110:111], v243 offset:22528
  v_mfma_f32_16x16x32_bf16 v[64:67], v[136:139], a[176:179], v[64:67]
  ds_read_b64_tr_b16 v[112:113], v242 offset:16640
  ds_read_b64_tr_b16 v[114:115], v243 offset:16640
  v_mfma_f32_16x16x32_bf16 v[80:83], v[136:139], a[184:187], v[80:83]
  ds_read_b64_tr_b16 v[116:117], v242 offset:18688
  ds_read_b64_tr_b16 v[118:119], v243 offset:18688
  v_mfma_f32_16x16x32_bf16 v[84:87], v[140:143], a[184:187], v[84:87]
  ds_read_b64_tr_b16 v[120:121], v242 offset:20736
  ds_read_b64_tr_b16 v[122:123], v243 offset:20736
  v_mfma_f32_16x16x32_bf16 v[68:71], v[140:143], a[176:179], v[68:71]
  ds_read_b64_tr_b16 v[124:125], v242 offset:22784
  ds_read_b64_tr_b16 v[126:127], v243 offset:22784
  v_mfma_f32_16x16x32_bf16 v[64:67], v[144:147], a[164:167], v[64:67]
  s_add_u32 m0, s92, 49152
  s_nop 0
  buffer_load_dwordx4 v59, s[80:83], s79 offen offset:0 sc1 lds
  v_mfma_f32_16x16x32_bf16 v[80:83], v[144:147], a[172:175], v[80:83]
  v_mfma_f32_16x16x32_bf16 v[84:87], v[148:151], a[172:175], v[84:87]
  buffer_load_dwordx4 v59, s[80:83], s79 offen offset:1024 sc1 lds
  v_mfma_f32_16x16x32_bf16 v[68:71], v[148:151], a[164:167], v[68:71]
  v_mfma_f32_16x16x32_bf16 v[64:67], v[152:155], a[180:183], v[64:67]
  buffer_load_dwordx4 v59, s[80:83], s79 offen offset:2048 sc1 lds
  v_mfma_f32_16x16x32_bf16 v[80:83], v[152:155], a[188:191], v[80:83]
  v_mfma_f32_16x16x32_bf16 v[84:87], v[156:159], a[188:191], v[84:87]
  buffer_load_dwordx4 v59, s[80:83], s79 offen offset:3072 sc1 lds
  s_add_u32 s79, s79, 65536
  s_and_b32 s79, s79, 0x3ffff
  v_mfma_f32_16x16x32_bf16 v[68:71], v[156:159], a[180:183], v[68:71]
  s_waitcnt lgkmcnt(0)
  v_mfma_f32_16x16x32_bf16 v[64:67], v[96:99], a[192:195], v[64:67]
  ds_read_b64_tr_b16 v[128:129], v242 offset:24576
  ds_read_b64_tr_b16 v[130:131], v243 offset:24576
  v_mfma_f32_16x16x32_bf16 v[80:83], v[96:99], a[200:203], v[80:83]
  ds_read_b64_tr_b16 v[132:133], v242 offset:26624
  ds_read_b64_tr_b16 v[134:135], v243 offset:26624
  v_mfma_f32_16x16x32_bf16 v[84:87], v[100:103], a[200:203], v[84:87]
  ds_read_b64_tr_b16 v[136:137], v242 offset:28672
  ds_read_b64_tr_b16 v[138:139], v243 offset:28672
  v_mfma_f32_16x16x32_bf16 v[68:71], v[100:103], a[192:195], v[68:71]
  ds_read_b64_tr_b16 v[140:141], v242 offset:30720
  ds_read_b64_tr_b16 v[142:143], v243 offset:30720
  v_mfma_f32_16x16x32_bf16 v[64:67], v[104:107], a[208:211], v[64:67]
  ds_read_b64_tr_b16 v[144:145], v242 offset:24832
  ds_read_b64_tr_b16 v[146:147], v243 offset:24832
  v_mfma_f32_16x16x32_bf16 v[80:83], v[104:107], a[216:219], v[80:83]
  ds_read_b64_tr_b16 v[148:149], v242 offset:26880
  ds_read_b64_tr_b16 v[150:151], v243 offset:26880
  v_mfma_f32_16x16x32_bf16 v[84:87], v[108:111], a[216:219], v[84:87]
  ds_read_b64_tr_b16 v[152:153], v242 offset:28928
  ds_read_b64_tr_b16 v[154:155], v243 offset:28928
  v_mfma_f32_16x16x32_bf16 v[68:71], v[108:111], a[208:211], v[68:71]
  ds_read_b64_tr_b16 v[156:157], v242 offset:30976
  ds_read_b64_tr_b16 v[158:159], v243 offset:30976
  v_mfma_f32_16x16x32_bf16 v[64:67], v[112:115], a[196:199], v[64:67]
  v_mfma_f32_16x16x32_bf16 v[80:83], v[112:115], a[204:207], v[80:83]
  v_mfma_f32_16x16x32_bf16 v[84:87], v[116:119], a[204:207], v[84:87]
  v_mfma_f32_16x16x32_bf16 v[68:71], v[116:119], a[196:199], v[68:71]
  v_mfma_f32_16x16x32_bf16 v[64:67], v[120:123], a[212:215], v[64:67]
  v_mfma_f32_16x16x32_bf16 v[80:83], v[120:123], a[220:223], v[80:83]
  v_mfma_f32_16x16x32_bf16 v[84:87], v[124:127], a[220:223], v[84:87]
  v_mfma_f32_16x16x32_bf16 v[68:71], v[124:127], a[212:215], v[68:71]
  buffer_load_dwordx4 v[224:227], v174, s[88:91], s43 offen offset:0 sc1
  buffer_load_dwordx4 v[228:231], v174, s[88:91], s43 offen offset:256 sc1
  buffer_load_dwordx4 v[232:235], v174, s[88:91], s43 offen offset:512 sc1
  buffer_load_dwordx4 v[236:239], v174, s[88:91], s43 offen offset:768 sc1
  s_waitcnt lgkmcnt(0)
  v_mfma_f32_16x16x32_bf16 v[64:67], v[128:131], a[224:227], v[64:67]
  ds_read_b64_tr_b16 v[96:97], v240 offset:0
  ds_read_b64_tr_b16 v[98:99], v241 offset:0
  v_mfma_f32_16x16x32_bf16 v[80:83], v[128:131], a[232:235], v[80:83]
  ds_read_b64_tr_b16 v[100:101], v240 offset:2048
  ds_read_b64_tr_b16 v[102:103], v241 offset:2048
  v_mfma_f32_16x16x32_bf16 v[84:87], v[132:135], a[232:235], v[84:87]
  ds_read_b64_tr_b16 v[104:105], v240 offset:4096
  ds_read_b64_tr_b16 v[106:107], v241 offset:4096
  v_mfma_f32_16x16x32_bf16 v[68:71], v[132:135], a[224:227], v[68:71]
  ds_read_b64_tr_b16 v[108:109], v240 offset:6144
  ds_read_b64_tr_b16 v[110:111], v241 offset:6144
  v_mfma_f32_16x16x32_bf16 v[64:67], v[136:139], a[240:243], v[64:67]
  ds_read_b64_tr_b16 v[112:113], v240 offset:256
  ds_read_b64_tr_b16 v[114:115], v241 offset:256
  v_mfma_f32_16x16x32_bf16 v[80:83], v[136:139], a[248:251], v[80:83]
  ds_read_b64_tr_b16 v[116:117], v240 offset:2304
  ds_read_b64_tr_b16 v[118:119], v241 offset:2304
  v_mfma_f32_16x16x32_bf16 v[84:87], v[140:143], a[248:251], v[84:87]
  ds_read_b64_tr_b16 v[120:121], v240 offset:4352
  ds_read_b64_tr_b16 v[122:123], v241 offset:4352
  v_mfma_f32_16x16x32_bf16 v[68:71], v[140:143], a[240:243], v[68:71]
  ds_read_b64_tr_b16 v[124:125], v240 offset:6400
  ds_read_b64_tr_b16 v[126:127], v241 offset:6400
  v_mfma_f32_16x16x32_bf16 v[64:67], v[144:147], a[228:231], v[64:67]
  v_mfma_f32_16x16x32_bf16 v[80:83], v[144:147], a[236:239], v[80:83]
  buffer_load_dwordx4 v[40:43], v58, s[44:47], s6 offen offset:0 sc1
  v_mfma_f32_16x16x32_bf16 v[84:87], v[148:151], a[236:239], v[84:87]
  v_mfma_f32_16x16x32_bf16 v[68:71], v[148:151], a[228:231], v[68:71]
  buffer_load_dwordx4 v[44:47], v58, s[44:47], s6 offen offset:1024 sc1
  v_mfma_f32_16x16x32_bf16 v[64:67], v[152:155], a[244:247], v[64:67]
  v_mfma_f32_16x16x32_bf16 v[80:83], v[152:155], a[252:255], v[80:83]
  buffer_load_dwordx4 v[48:51], v58, s[44:47], s6 offen offset:2048 sc1
  v_mfma_f32_16x16x32_bf16 v[84:87], v[156:159], a[252:255], v[84:87]
  v_mfma_f32_16x16x32_bf16 v[68:71], v[156:159], a[244:247], v[68:71]
  buffer_load_dwordx4 v[52:55], v58, s[44:47], s6 offen offset:3072 sc1
  s_waitcnt lgkmcnt(0)
  v_mfma_f32_16x16x32_bf16 v[72:75], v[96:99], a[0:3], v[72:75]
  ds_read_b64_tr_b16 v[128:129], v240 offset:8192
  ds_read_b64_tr_b16 v[130:131], v241 offset:8192
  v_mfma_f32_16x16x32_bf16 v[88:91], v[96:99], a[8:11], 0
  ds_read_b64_tr_b16 v[132:133], v240 offset:10240
  ds_read_b64_tr_b16 v[134:135], v241 offset:10240
  v_mfma_f32_16x16x32_bf16 v[92:95], v[100:103], a[8:11], 0
  ds_read_b64_tr_b16 v[136:137], v240 offset:12288
  ds_read_b64_tr_b16 v[138:139], v241 offset:12288
  v_mfma_f32_16x16x32_bf16 v[76:79], v[100:103], a[0:3], v[76:79]
  ds_read_b64_tr_b16 v[140:141], v240 offset:14336
  ds_read_b64_tr_b16 v[142:143], v241 offset:14336
  v_mfma_f32_16x16x32_bf16 v[72:75], v[104:107], a[16:19], v[72:75]
  ds_read_b64_tr_b16 v[144:145], v240 offset:8448
  ds_read_b64_tr_b16 v[146:147], v241 offset:8448
  v_mfma_f32_16x16x32_bf16 v[88:91], v[104:107], a[24:27], v[88:91]
  ds_read_b64_tr_b16 v[148:149], v240 offset:10496
  ds_read_b64_tr_b16 v[150:151], v241 offset:10496
  v_mfma_f32_16x16x32_bf16 v[92:95], v[108:111], a[24:27], v[92:95]
  ds_read_b64_tr_b16 v[152:153], v240 offset:12544
  ds_read_b64_tr_b16 v[154:155], v241 offset:12544
  v_mfma_f32_16x16x32_bf16 v[76:79], v[108:111], a[16:19], v[76:79]
  ds_read_b64_tr_b16 v[156:157], v240 offset:14592
  ds_read_b64_tr_b16 v[158:159], v241 offset:14592
  v_mfma_f32_16x16x32_bf16 v[72:75], v[112:115], a[4:7], v[72:75]
  v_mfma_f32_16x16x32_bf16 v[192:195], v[24:27], v[176:179], 0
  v_mfma_f32_16x16x32_bf16 v[208:211], v[24:27], v[184:187], 0
  v_mfma_f32_16x16x32_bf16 v[88:91], v[112:115], a[12:15], v[88:91]
  v_mfma_f32_16x16x32_bf16 v[196:199], v[32:35], v[176:179], 0
  v_mfma_f32_16x16x32_bf16 v[212:215], v[32:35], v[184:187], 0
  v_mfma_f32_16x16x32_bf16 v[92:95], v[116:119], a[12:15], v[92:95]
  v_mfma_f32_16x16x32_bf16 v[200:203], v[60:63], v[176:179], 0
  v_mfma_f32_16x16x32_bf16 v[216:219], v[60:63], v[184:187], 0
  v_mfma_f32_16x16x32_bf16 v[76:79], v[116:119], a[4:7], v[76:79]
  v_mfma_f32_16x16x32_bf16 v[204:207], v[164:167], v[176:179], 0
  v_mfma_f32_16x16x32_bf16 v[220:223], v[164:167], v[184:187], 0
  v_mfma_f32_16x16x32_bf16 v[72:75], v[120:123], a[20:23], v[72:75]
  v_mfma_f32_16x16x32_bf16 v[192:195], v[28:31], v[180:183], v[192:195]
  v_mfma_f32_16x16x32_bf16 v[208:211], v[28:31], v[188:191], v[208:211]
  v_mfma_f32_16x16x32_bf16 v[88:91], v[120:123], a[28:31], v[88:91]
  v_mfma_f32_16x16x32_bf16 v[196:199], v[36:39], v[180:183], v[196:199]
  v_mfma_f32_16x16x32_bf16 v[212:215], v[36:39], v[188:191], v[212:215]
  v_mfma_f32_16x16x32_bf16 v[92:95], v[124:127], a[28:31], v[92:95]
  v_mfma_f32_16x16x32_bf16 v[200:203], v[160:163], v[180:183], v[200:203]
  v_mfma_f32_16x16x32_bf16 v[216:219], v[160:163], v[188:191], v[216:219]
  v_mfma_f32_16x16x32_bf16 v[76:79], v[124:127], a[20:23], v[76:79]
  v_mfma_f32_16x16x32_bf16 v[204:207], v[168:171], v[180:183], v[204:207]
  v_mfma_f32_16x16x32_bf16 v[220:223], v[168:171], v[188:191], v[220:223]
  s_waitcnt vmcnt(8) lgkmcnt(0)
  s_barrier
  v_mfma_f32_16x16x32_bf16 v[72:75], v[128:131], a[32:35], v[72:75]
  ds_read_b64_tr_b16 v[96:97], v240 offset:16384
  ds_read_b64_tr_b16 v[98:99], v241 offset:16384
  v_mfma_f32_16x16x32_bf16 v[88:91], v[128:131], a[40:43], v[88:91]
  ds_read_b64_tr_b16 v[100:101], v240 offset:18432
  ds_read_b64_tr_b16 v[102:103], v241 offset:18432
  v_mfma_f32_16x16x32_bf16 v[92:95], v[132:135], a[40:43], v[92:95]
  ds_read_b64_tr_b16 v[104:105], v240 offset:20480
  ds_read_b64_tr_b16 v[106:107], v241 offset:20480
  v_mfma_f32_16x16x32_bf16 v[76:79], v[132:135], a[32:35], v[76:79]
  ds_read_b64_tr_b16 v[108:109], v240 offset:22528
  ds_read_b64_tr_b16 v[110:111], v241 offset:22528
  v_mfma_f32_16x16x32_bf16 v[72:75], v[136:139], a[48:51], v[72:75]
  ds_read_b64_tr_b16 v[112:113], v240 offset:16640
  ds_read_b64_tr_b16 v[114:115], v241 offset:16640
  v_mfma_f32_16x16x32_bf16 v[88:91], v[136:139], a[56:59], v[88:91]
  ds_read_b64_tr_b16 v[116:117], v240 offset:18688
  ds_read_b64_tr_b16 v[118:119], v241 offset:18688
  v_mfma_f32_16x16x32_bf16 v[92:95], v[140:143], a[56:59], v[92:95]
  ds_read_b64_tr_b16 v[120:121], v240 offset:20736
  ds_read_b64_tr_b16 v[122:123], v241 offset:20736
  v_mfma_f32_16x16x32_bf16 v[76:79], v[140:143], a[48:51], v[76:79]
  ds_read_b64_tr_b16 v[124:125], v240 offset:22784
  ds_read_b64_tr_b16 v[126:127], v241 offset:22784
  v_mfma_f32_16x16x32_bf16 v[72:75], v[144:147], a[36:39], v[72:75]
  s_waitcnt vmcnt(0)
  v_and_b32 v8, 1, v40
  v_bitop3_b32 v8, v8, v41, v42 bitop3:0x80
  v_bitop3_b32 v8, v8, v43, v44 bitop3:0x80
  v_bitop3_b32 v8, v8, v45, v46 bitop3:0x80
  v_bitop3_b32 v8, v8, v47, v48 bitop3:0x80
  v_bitop3_b32 v8, v8, v49, v50 bitop3:0x80
  v_bitop3_b32 v8, v8, v51, v52 bitop3:0x80
  v_bitop3_b32 v8, v8, v53, v54 bitop3:0x80
  v_and_b32 v8, v8, v55
  v_cmp_eq_u32 vcc, 0, v8
  s_nop 0
  s_cbranch_vccz gated_mix__spectral_gfnet__ssm_conv_s5__prompt_kernel_skip51
  s_mov_b32 s29, 0
gated_mix__spectral_gfnet__ssm_conv_s5__prompt_kernel_px52:
  s_sleep 2
  buffer_load_dwordx4 v[40:43], v58, s[44:47], s6 offen offset:0 sc1
  buffer_load_dwordx4 v[44:47], v58, s[44:47], s6 offen offset:1024 sc1
  buffer_load_dwordx4 v[48:51], v58, s[44:47], s6 offen offset:2048 sc1
  buffer_load_dwordx4 v[52:55], v58, s[44:47], s6 offen offset:3072 sc1
  s_waitcnt vmcnt(0)
  v_and_b32 v8, 1, v40
  v_bitop3_b32 v8, v8, v41, v42 bitop3:0x80
  v_bitop3_b32 v8, v8, v43, v44 bitop3:0x80
  v_bitop3_b32 v8, v8, v45, v46 bitop3:0x80
  v_bitop3_b32 v8, v8, v47, v48 bitop3:0x80
  v_bitop3_b32 v8, v8, v49, v50 bitop3:0x80
  v_bitop3_b32 v8, v8, v51, v52 bitop3:0x80
  v_bitop3_b32 v8, v8, v53, v54 bitop3:0x80
  v_and_b32 v8, v8, v55
  v_cmp_eq_u32 vcc, 0, v8
  s_nop 0
  s_cbranch_vccz gated_mix__spectral_gfnet__ssm_conv_s5__prompt_kernel_pxout53
  s_add_u32 s29, s29, 1
  s_cmp_lt_u32 s29, 1048576
  s_cbranch_scc1 gated_mix__spectral_gfnet__ssm_conv_s5__prompt_kernel_px52
gated_mix__spectral_gfnet__ssm_conv_s5__prompt_kernel_pxout53:
gated_mix__spectral_gfnet__ssm_conv_s5__prompt_kernel_skip51:
  v_mfma_f32_16x16x32_bf16 v[88:91], v[144:147], a[44:47], v[88:91]
  v_mfma_f32_16x16x32_bf16 v[92:95], v[148:151], a[44:47], v[92:95]
  v_mfma_f32_16x16x32_bf16 v[76:79], v[148:151], a[36:39], v[76:79]
  v_mfma_f32_16x16x32_bf16 v[72:75], v[152:155], a[52:55], v[72:75]
  v_mfma_f32_16x16x32_bf16 v[88:91], v[152:155], a[60:63], v[88:91]
  v_mfma_f32_16x16x32_bf16 v[92:95], v[156:159], a[60:63], v[92:95]
  v_mfma_f32_16x16x32_bf16 v[76:79], v[156:159], a[52:55], v[76:79]
  s_waitcnt lgkmcnt(0)
  v_mfma_f32_16x16x32_bf16 v[72:75], v[96:99], a[64:67], v[72:75]
  ds_read_b64_tr_b16 v[128:129], v240 offset:24576
  ds_read_b64_tr_b16 v[130:131], v241 offset:24576
  v_mfma_f32_16x16x32_bf16 v[88:91], v[96:99], a[72:75], v[88:91]
  ds_read_b64_tr_b16 v[132:133], v240 offset:26624
  ds_read_b64_tr_b16 v[134:135], v241 offset:26624
  v_mfma_f32_16x16x32_bf16 v[92:95], v[100:103], a[72:75], v[92:95]
  ds_read_b64_tr_b16 v[136:137], v240 offset:28672
  ds_read_b64_tr_b16 v[138:139], v241 offset:28672
  v_mfma_f32_16x16x32_bf16 v[76:79], v[100:103], a[64:67], v[76:79]
  ds_read_b64_tr_b16 v[140:141], v240 offset:30720
  ds_read_b64_tr_b16 v[142:143], v241 offset:30720
  v_mfma_f32_16x16x32_bf16 v[72:75], v[104:107], a[80:83], v[72:75]
  ds_read_b64_tr_b16 v[144:145], v240 offset:24832
  ds_read_b64_tr_b16 v[146:147], v241 offset:24832
  v_mfma_f32_16x16x32_bf16 v[88:91], v[104:107], a[88:91], v[88:91]
  ds_read_b64_tr_b16 v[148:149], v240 offset:26880
  ds_read_b64_tr_b16 v[150:151], v241 offset:26880
  v_mfma_f32_16x16x32_bf16 v[92:95], v[108:111], a[88:91], v[92:95]
  ds_read_b64_tr_b16 v[152:153], v240 offset:28928
  ds_read_b64_tr_b16 v[154:155], v241 offset:28928
  v_mfma_f32_16x16x32_bf16 v[76:79], v[108:111], a[80:83], v[76:79]
  ds_read_b64_tr_b16 v[156:157], v240 offset:30976
  ds_read_b64_tr_b16 v[158:159], v241 offset:30976
  v_mfma_f32_16x16x32_bf16 v[72:75], v[112:115], a[68:71], v[72:75]
  v_pk_add_f32 v[192:193], v[192:193], v[64:65] neg_lo:[0,1] neg_hi:[0,1]
  v_pk_add_f32 v[194:195], v[194:195], v[66:67] neg_lo:[0,1] neg_hi:[0,1]
  v_pk_fma_f32 v[64:65], v[224:225], v[192:193], v[64:65]
  v_pk_fma_f32 v[66:67], v[226:227], v[194:195], v[66:67]
  v_pk_add_f32 v[64:65], v[64:65], v[40:41]
  v_pk_add_f32 v[66:67], v[66:67], v[42:43]
  v_pk_add_f32 v[208:209], v[208:209], v[80:81] neg_lo:[0,1] neg_hi:[0,1]
  v_pk_add_f32 v[210:211], v[210:211], v[82:83] neg_lo:[0,1] neg_hi:[0,1]
  v_pk_fma_f32 v[80:81], v[224:225], v[208:209], v[80:81]
  v_pk_fma_f32 v[82:83], v[226:227], v[210:211], v[82:83]
  v_lshlrev_b32 v40, 16, v40
  v_lshlrev_b32 v41, 16, v41
  v_pk_add_f32 v[80:81], v[80:81], v[40:41]
  v_lshlrev_b32 v42, 16, v42
  v_lshlrev_b32 v43, 16, v43
  v_pk_add_f32 v[82:83], v[82:83], v[42:43]
  v_mfma_f32_16x16x32_bf16 v[88:91], v[112:115], a[76:79], v[88:91]
  v_mfma_f32_16x16x32_bf16 v[92:95], v[116:119], a[76:79], v[92:95]
  v_mfma_f32_16x16x32_bf16 v[76:79], v[116:119], a[68:71], v[76:79]
  v_mfma_f32_16x16x32_bf16 v[72:75], v[120:123], a[84:87], v[72:75]
  buffer_store_dword v64, v172, s[20:23], s33 offen sc1
  v_mfma_f32_16x16x32_bf16 v[88:91], v[120:123], a[92:95], v[88:91]
  v_mfma_f32_16x16x32_bf16 v[92:95], v[124:127], a[92:95], v[92:95]
  v_mfma_f32_16x16x32_bf16 v[76:79], v[124:127], a[84:87], v[76:79]
  s_waitcnt lgkmcnt(0)
  v_mfma_f32_16x16x32_bf16 v[72:75], v[128:131], a[96:99], v[72:75]
  ds_read_b64_tr_b16 v[96:97], v240 offset:32768
  ds_read_b64_tr_b16 v[98:99], v241 offset:32768
  buffer_store_dword v80, v173, s[20:23], s33 offen sc1
  v_mfma_f32_16x16x32_bf16 v[88:91], v[128:131], a[104:107], v[88:91]
  ds_read_b64_tr_b16 v[100:101], v240 offset:34816
  ds_read_b64_tr_b16 v[102:103], v241 offset:34816
  s_add_u32 s33, s33, 65536
  v_mfma_f32_16x16x32_bf16 v[92:95], v[132:135], a[104:107], v[92:95]
  ds_read_b64_tr_b16 v[104:105], v240 offset:36864
  ds_read_b64_tr_b16 v[106:107], v241 offset:36864
  v_mfma_f32_16x16x32_bf16 v[76:79], v[132:135], a[96:99], v[76:79]
  ds_read_b64_tr_b16 v[108:109], v240 offset:38912
  ds_read_b64_tr_b16 v[110:111], v241 offset:38912
  v_mfma_f32_16x16x32_bf16 v[72:75], v[136:139], a[112:115], v[72:75]
  ds_read_b64_tr_b16 v[112:113], v240 offset:33024
  ds_read_b64_tr_b16 v[114:115], v241 offset:33024
  buffer_store_dword v65, v172, s[20:23], s33 offen sc1
  v_mfma_f32_16x16x32_bf16 v[88:91], v[136:139], a[120:123], v[88:91]
  ds_read_b64_tr_b16 v[116:117], v240 offset:35072
  ds_read_b64_tr_b16 v[118:119], v241 offset:35072
  v_mfma_f32_16x16x32_bf16 v[92:95], v[140:143], a[120:123], v[92:95]
  ds_read_b64_tr_b16 v[120:121], v240 offset:37120
  ds_read_b64_tr_b16 v[122:123], v241 offset:37120
  v_mfma_f32_16x16x32_bf16 v[76:79], v[140:143], a[112:115], v[76:79]
  ds_read_b64_tr_b16 v[124:125], v240 offset:39168
  ds_read_b64_tr_b16 v[126:127], v241 offset:39168
  v_mfma_f32_16x16x32_bf16 v[72:75], v[144:147], a[100:103], v[72:75]
  buffer_store_dword v81, v173, s[20:23], s33 offen sc1
  v_mfma_f32_16x16x32_bf16 v[88:91], v[144:147], a[108:111], v[88:91]
  s_add_u32 s33, s33, 65536
  v_mfma_f32_16x16x32_bf16 v[92:95], v[148:151], a[108:111], v[92:95]
  v_mfma_f32_16x16x32_bf16 v[76:79], v[148:151], a[100:103], v[76:79]
  v_mfma_f32_16x16x32_bf16 v[72:75], v[152:155], a[116:119], v[72:75]
  buffer_store_dword v66, v172, s[20:23], s33 offen sc1
  v_mfma_f32_16x16x32_bf16 v[88:91], v[152:155], a[124:127], v[88:91]
  v_mfma_f32_16x16x32_bf16 v[92:95], v[156:159], a[124:127], v[92:95]
  v_mfma_f32_16x16x32_bf16 v[76:79], v[156:159], a[116:119], v[76:79]
  s_waitcnt lgkmcnt(0)
  v_mfma_f32_16x16x32_bf16 v[72:75], v[96:99], a[128:131], v[72:75]
  ds_read_b64_tr_b16 v[128:129], v240 offset:40960
  ds_read_b64_tr_b16 v[130:131], v241 offset:40960
  buffer_store_dword v82, v173, s[20:23], s33 offen sc1
  v_mfma_f32_16x16x32_bf16 v[88:91], v[96:99], a[136:139], v[88:91]
  ds_read_b64_tr_b16 v[132:133], v240 offset:43008
  ds_read_b64_tr_b16 v[134:135], v241 offset:43008
  s_add_u32 s33, s33, 65536
  v_mfma_f32_16x16x32_bf16 v[92:95], v[100:103], a[136:139], v[92:95]
  ds_read_b64_tr_b16 v[136:137], v240 offset:45056
  ds_read_b64_tr_b16 v[138:139], v241 offset:45056
  v_mfma_f32_16x16x32_bf16 v[76:79], v[100:103], a[128:131], v[76:79]
  ds_read_b64_tr_b16 v[140:141], v240 offset:47104
  ds_read_b64_tr_b16 v[142:143], v241 offset:47104
  v_mfma_f32_16x16x32_bf16 v[72:75], v[104:107], a[144:147], v[72:75]
  ds_read_b64_tr_b16 v[144:145], v240 offset:41216
  ds_read_b64_tr_b16 v[146:147], v241 offset:41216
  buffer_store_dword v67, v172, s[20:23], s33 offen sc1
  v_mfma_f32_16x16x32_bf16 v[88:91], v[104:107], a[152:155], v[88:91]
  ds_read_b64_tr_b16 v[148:149], v240 offset:43264
  ds_read_b64_tr_b16 v[150:151], v241 offset:43264
  v_mfma_f32_16x16x32_bf16 v[92:95], v[108:111], a[152:155], v[92:95]
  ds_read_b64_tr_b16 v[152:153], v240 offset:45312
  ds_read_b64_tr_b16 v[154:155], v241 offset:45312
  v_mfma_f32_16x16x32_bf16 v[76:79], v[108:111], a[144:147], v[76:79]
  ds_read_b64_tr_b16 v[156:157], v240 offset:47360
  ds_read_b64_tr_b16 v[158:159], v241 offset:47360
  v_mfma_f32_16x16x32_bf16 v[72:75], v[112:115], a[132:135], v[72:75]
  buffer_store_dword v83, v173, s[20:23], s33 offen sc1
  v_mfma_f32_16x16x32_bf16 v[88:91], v[112:115], a[140:143], v[88:91]
  s_add_u32 s33, s33, 851968
  v_pk_add_f32 v[196:197], v[196:197], v[68:69] neg_lo:[0,1] neg_hi:[0,1]
  v_pk_add_f32 v[198:199], v[198:199], v[70:71] neg_lo:[0,1] neg_hi:[0,1]
  v_pk_fma_f32 v[68:69], v[228:229], v[196:197], v[68:69]
  v_pk_fma_f32 v[70:71], v[230:231], v[198:199], v[70:71]
  v_pk_add_f32 v[68:69], v[68:69], v[44:45]
  v_pk_add_f32 v[70:71], v[70:71], v[46:47]
  v_pk_add_f32 v[212:213], v[212:213], v[84:85] neg_lo:[0,1] neg_hi:[0,1]
  v_pk_add_f32 v[214:215], v[214:215], v[86:87] neg_lo:[0,1] neg_hi:[0,1]
  v_pk_fma_f32 v[84:85], v[228:229], v[212:213], v[84:85]
  v_pk_fma_f32 v[86:87], v[230:231], v[214:215], v[86:87]
  v_lshlrev_b32 v44, 16, v44
  v_lshlrev_b32 v45, 16, v45
  v_pk_add_f32 v[84:85], v[84:85], v[44:45]
  v_lshlrev_b32 v46, 16, v46
  v_lshlrev_b32 v47, 16, v47
  v_pk_add_f32 v[86:87], v[86:87], v[46:47]
  v_mfma_f32_16x16x32_bf16 v[92:95], v[116:119], a[140:143], v[92:95]
  v_mfma_f32_16x16x32_bf16 v[76:79], v[116:119], a[132:135], v[76:79]
  v_mfma_f32_16x16x32_bf16 v[72:75], v[120:123], a[148:151], v[72:75]
  buffer_store_dword v68, v172, s[20:23], s33 offen sc1
  v_mfma_f32_16x16x32_bf16 v[88:91], v[120:123], a[156:159], v[88:91]
  v_mfma_f32_16x16x32_bf16 v[92:95], v[124:127], a[156:159], v[92:95]
  v_mfma_f32_16x16x32_bf16 v[76:79], v[124:127], a[148:151], v[76:79]
  s_waitcnt lgkmcnt(0)
  v_mfma_f32_16x16x32_bf16 v[72:75], v[128:131], a[160:163], v[72:75]
  ds_read_b64_tr_b16 v[96:97], v240 offset:49152
  ds_read_b64_tr_b16 v[98:99], v241 offset:49152
  buffer_store_dword v84, v173, s[20:23], s33 offen sc1
  v_mfma_f32_16x16x32_bf16 v[88:91], v[128:131], a[168:171], v[88:91]
  ds_read_b64_tr_b16 v[100:101], v240 offset:51200
  ds_read_b64_tr_b16 v[102:103], v241 offset:51200
  s_add_u32 s33, s33, 65536
  v_mfma_f32_16x16x32_bf16 v[92:95], v[132:135], a[168:171], v[92:95]
  ds_read_b64_tr_b16 v[104:105], v240 offset:53248
  ds_read_b64_tr_b16 v[106:107], v241 offset:53248
  v_mfma_f32_16x16x32_bf16 v[76:79], v[132:135], a[160:163], v[76:79]
  ds_read_b64_tr_b16 v[108:109], v240 offset:55296
  ds_read_b64_tr_b16 v[110:111], v241 offset:55296
  v_mfma_f32_16x16x32_bf16 v[72:75], v[136:139], a[176:179], v[72:75]
  ds_read_b64_tr_b16 v[112:113], v240 offset:49408
  ds_read_b64_tr_b16 v[114:115], v241 offset:49408
  buffer_store_dword v69, v172, s[20:23], s33 offen sc1
  v_mfma_f32_16x16x32_bf16 v[88:91], v[136:139], a[184:187], v[88:91]
  ds_read_b64_tr_b16 v[116:117], v240 offset:51456
  ds_read_b64_tr_b16 v[118:119], v241 offset:51456
  v_mfma_f32_16x16x32_bf16 v[92:95], v[140:143], a[184:187], v[92:95]
  ds_read_b64_tr_b16 v[120:121], v240 offset:53504
  ds_read_b64_tr_b16 v[122:123], v241 offset:53504
  v_mfma_f32_16x16x32_bf16 v[76:79], v[140:143], a[176:179], v[76:79]
  ds_read_b64_tr_b16 v[124:125], v240 offset:55552
  ds_read_b64_tr_b16 v[126:127], v241 offset:55552
  v_mfma_f32_16x16x32_bf16 v[72:75], v[144:147], a[164:167], v[72:75]
  buffer_store_dword v85, v173, s[20:23], s33 offen sc1
  v_mfma_f32_16x16x32_bf16 v[88:91], v[144:147], a[172:175], v[88:91]
  s_add_u32 s33, s33, 65536
  v_mfma_f32_16x16x32_bf16 v[92:95], v[148:151], a[172:175], v[92:95]
  v_mfma_f32_16x16x32_bf16 v[76:79], v[148:151], a[164:167], v[76:79]
  v_mfma_f32_16x16x32_bf16 v[72:75], v[152:155], a[180:183], v[72:75]
  buffer_store_dword v70, v172, s[20:23], s33 offen sc1
  v_mfma_f32_16x16x32_bf16 v[88:91], v[152:155], a[188:191], v[88:91]
  v_mfma_f32_16x16x32_bf16 v[92:95], v[156:159], a[188:191], v[92:95]
  v_mfma_f32_16x16x32_bf16 v[76:79], v[156:159], a[180:183], v[76:79]
  s_waitcnt lgkmcnt(0)
  v_mfma_f32_16x16x32_bf16 v[72:75], v[96:99], a[192:195], v[72:75]
  ds_read_b64_tr_b16 v[128:129], v240 offset:57344
  ds_read_b64_tr_b16 v[130:131], v241 offset:57344
  buffer_store_dword v86, v173, s[20:23], s33 offen sc1
  v_mfma_f32_16x16x32_bf16 v[88:91], v[96:99], a[200:203], v[88:91]
  ds_read_b64_tr_b16 v[132:133], v240 offset:59392
  ds_read_b64_tr_b16 v[134:135], v241 offset:59392
  s_add_u32 s33, s33, 65536
  v_mfma_f32_16x16x32_bf16 v[92:95], v[100:103], a[200:203], v[92:95]
  ds_read_b64_tr_b16 v[136:137], v240 offset:61440
  ds_read_b64_tr_b16 v[138:139], v241 offset:61440
  v_mfma_f32_16x16x32_bf16 v[76:79], v[100:103], a[192:195], v[76:79]
  ds_read_b64_tr_b16 v[140:141], v240 offset:63488
  ds_read_b64_tr_b16 v[142:143], v241 offset:63488
  v_mfma_f32_16x16x32_bf16 v[72:75], v[104:107], a[208:211], v[72:75]
  ds_read_b64_tr_b16 v[144:145], v240 offset:57600
  ds_read_b64_tr_b16 v[146:147], v241 offset:57600
  buffer_store_dword v71, v172, s[20:23], s33 offen sc1
  v_mfma_f32_16x16x32_bf16 v[88:91], v[104:107], a[216:219], v[88:91]
  ds_read_b64_tr_b16 v[148:149], v240 offset:59648
  ds_read_b64_tr_b16 v[150:151], v241 offset:59648
  v_mfma_f32_16x16x32_bf16 v[92:95], v[108:111], a[216:219], v[92:95]
  ds_read_b64_tr_b16 v[152:153], v240 offset:61696
  ds_read_b64_tr_b16 v[154:155], v241 offset:61696
  v_mfma_f32_16x16x32_bf16 v[76:79], v[108:111], a[208:211], v[76:79]
  ds_read_b64_tr_b16 v[156:157], v240 offset:63744
  ds_read_b64_tr_b16 v[158:159], v241 offset:63744
  v_mfma_f32_16x16x32_bf16 v[72:75], v[112:115], a[196:199], v[72:75]
  buffer_store_dword v87, v173, s[20:23], s33 offen sc1
  v_mfma_f32_16x16x32_bf16 v[88:91], v[112:115], a[204:207], v[88:91]
  s_add_u32 s33, s33, 851968
  v_mfma_f32_16x16x32_bf16 v[92:95], v[116:119], a[204:207], v[92:95]
  v_mfma_f32_16x16x32_bf16 v[76:79], v[116:119], a[196:199], v[76:79]
  v_mfma_f32_16x16x32_bf16 v[72:75], v[120:123], a[212:215], v[72:75]
  v_mfma_f32_16x16x32_bf16 v[88:91], v[120:123], a[220:223], v[88:91]
  v_mfma_f32_16x16x32_bf16 v[92:95], v[124:127], a[220:223], v[92:95]
  v_mfma_f32_16x16x32_bf16 v[76:79], v[124:127], a[212:215], v[76:79]
  s_waitcnt lgkmcnt(0)
  v_mfma_f32_16x16x32_bf16 v[72:75], v[128:131], a[224:227], v[72:75]
  v_mfma_f32_16x16x32_bf16 v[88:91], v[128:131], a[232:235], v[88:91]
  v_mfma_f32_16x16x32_bf16 v[92:95], v[132:135], a[232:235], v[92:95]
  v_mfma_f32_16x16x32_bf16 v[76:79], v[132:135], a[224:227], v[76:79]
  v_mfma_f32_16x16x32_bf16 v[72:75], v[136:139], a[240:243], v[72:75]
  v_mfma_f32_16x16x32_bf16 v[88:91], v[136:139], a[248:251], v[88:91]
  v_mfma_f32_16x16x32_bf16 v[92:95], v[140:143], a[248:251], v[92:95]
  v_mfma_f32_16x16x32_bf16 v[76:79], v[140:143], a[240:243], v[76:79]
  v_mfma_f32_16x16x32_bf16 v[72:75], v[144:147], a[228:231], v[72:75]
  v_mfma_f32_16x16x32_bf16 v[88:91], v[144:147], a[236:239], v[88:91]
  v_mfma_f32_16x16x32_bf16 v[92:95], v[148:151], a[236:239], v[92:95]
  v_mfma_f32_16x16x32_bf16 v[76:79], v[148:151], a[228:231], v[76:79]
  v_mfma_f32_16x16x32_bf16 v[72:75], v[152:155], a[244:247], v[72:75]
  v_mfma_f32_16x16x32_bf16 v[88:91], v[152:155], a[252:255], v[88:91]
  v_mfma_f32_16x16x32_bf16 v[92:95], v[156:159], a[252:255], v[92:95]
  v_mfma_f32_16x16x32_bf16 v[76:79], v[156:159], a[244:247], v[76:79]
  s_nop 4
  v_pk_add_f32 v[200:201], v[200:201], v[72:73] neg_lo:[0,1] neg_hi:[0,1]
  v_pk_add_f32 v[202:203], v[202:203], v[74:75] neg_lo:[0,1] neg_hi:[0,1]
  v_pk_fma_f32 v[72:73], v[232:233], v[200:201], v[72:73]
  v_pk_fma_f32 v[74:75], v[234:235], v[202:203], v[74:75]
  v_pk_add_f32 v[72:73], v[72:73], v[48:49]
  v_pk_add_f32 v[74:75], v[74:75], v[50:51]
  v_pk_add_f32 v[216:217], v[216:217], v[88:89] neg_lo:[0,1] neg_hi:[0,1]
  v_pk_add_f32 v[218:219], v[218:219], v[90:91] neg_lo:[0,1] neg_hi:[0,1]
  v_pk_fma_f32 v[88:89], v[232:233], v[216:217], v[88:89]
  v_pk_fma_f32 v[90:91], v[234:235], v[218:219], v[90:91]
  v_lshlrev_b32 v48, 16, v48
  v_lshlrev_b32 v49, 16, v49
  v_pk_add_f32 v[88:89], v[88:89], v[48:49]
  v_lshlrev_b32 v50, 16, v50
  v_lshlrev_b32 v51, 16, v51
  v_pk_add_f32 v[90:91], v[90:91], v[50:51]
  buffer_store_dword v72, v172, s[20:23], s33 offen sc1
  buffer_store_dword v88, v173, s[20:23], s33 offen sc1
  s_add_u32 s33, s33, 65536
  buffer_store_dword v73, v172, s[20:23], s33 offen sc1
  buffer_store_dword v89, v173, s[20:23], s33 offen sc1
  s_add_u32 s33, s33, 65536
  buffer_store_dword v74, v172, s[20:23], s33 offen sc1
  buffer_store_dword v90, v173, s[20:23], s33 offen sc1
  s_add_u32 s33, s33, 65536
  buffer_store_dword v75, v172, s[20:23], s33 offen sc1
  buffer_store_dword v91, v173, s[20:23], s33 offen sc1
  s_add_u32 s33, s33, 851968
  v_pk_add_f32 v[204:205], v[204:205], v[76:77] neg_lo:[0,1] neg_hi:[0,1]
  v_pk_add_f32 v[206:207], v[206:207], v[78:79] neg_lo:[0,1] neg_hi:[0,1]
  v_pk_fma_f32 v[76:77], v[236:237], v[204:205], v[76:77]
  v_pk_fma_f32 v[78:79], v[238:239], v[206:207], v[78:79]
  v_pk_add_f32 v[76:77], v[76:77], v[52:53]
  v_pk_add_f32 v[78:79], v[78:79], v[54:55]
  v_pk_add_f32 v[220:221], v[220:221], v[92:93] neg_lo:[0,1] neg_hi:[0,1]
  v_pk_add_f32 v[222:223], v[222:223], v[94:95] neg_lo:[0,1] neg_hi:[0,1]
  v_pk_fma_f32 v[92:93], v[236:237], v[220:221], v[92:93]
  v_pk_fma_f32 v[94:95], v[238:239], v[222:223], v[94:95]
  v_lshlrev_b32 v52, 16, v52
  v_lshlrev_b32 v53, 16, v53
  v_pk_add_f32 v[92:93], v[92:93], v[52:53]
  v_lshlrev_b32 v54, 16, v54
  v_lshlrev_b32 v55, 16, v55
  v_pk_add_f32 v[94:95], v[94:95], v[54:55]
  buffer_store_dword v76, v172, s[20:23], s33 offen sc1
  buffer_store_dword v92, v173, s[20:23], s33 offen sc1
  s_add_u32 s33, s33, 65536
  buffer_store_dword v77, v172, s[20:23], s33 offen sc1
  buffer_store_dword v93, v173, s[20:23], s33 offen sc1
  s_add_u32 s33, s33, 65536
  buffer_store_dword v78, v172, s[20:23], s33 offen sc1
  buffer_store_dword v94, v173, s[20:23], s33 offen sc1
  s_add_u32 s33, s33, 65536
  buffer_store_dword v79, v172, s[20:23], s33 offen sc1
  buffer_store_dword v95, v173, s[20:23], s33 offen sc1
gated_mix__spectral_gfnet__ssm_conv_s5__prompt_kernel_end:
  s_endpgm
.section .rodata,"a"
.p2align 6
.amdhsa_kernel gated_mix__spectral_gfnet__ssm_conv_s5__prompt_kernel
  .amdhsa_next_free_vgpr 508
  .amdhsa_next_free_sgpr 102
  .amdhsa_accum_offset 252
  .amdhsa_group_segment_fixed_size 0
  .amdhsa_kernarg_size 128
  .amdhsa_user_sgpr_count 2
  .amdhsa_user_sgpr_kernarg_segment_ptr 1
  .amdhsa_system_sgpr_workgroup_id_x 1
  .amdhsa_float_denorm_mode_32 3
.end_amdhsa_kernel
```

```asm
; @launch grid=(256,1,1) block=(256,1,1) lds=163840
.amdgcn_target "amdgcn-amd-amdhsa--gfx950"
.text
.p2align 12
.fill 832, 4, 0xbf800000
.p2align 8
.globl gated_mix__spectral_gfnet__ssm_conv_s5__prompt_kernel
.type gated_mix__spectral_gfnet__ssm_conv_s5__prompt_kernel,@function
gated_mix__spectral_gfnet__ssm_conv_s5__prompt_kernel:
  s_cmp_ge_u32 s2, 256
  s_cbranch_scc1 gated_mix__spectral_gfnet__ssm_conv_s5__prompt_kernel_end
  s_load_dwordx16 s[4:19], s[0:1], 0
  s_load_dwordx16 s[20:35], s[0:1], 64
  v_readfirstlane_b32 s3, v0
  v_and_b32 v1, 63, v0
  v_and_b32 v2, 15, v0
  v_bfe_u32 v3, v0, 4, 2
  s_bfe_u32 s36, s2, 0x20003
  s_lshr_b32 s43, s2, 5
  s_lshr_b32 s3, s3, 6
  s_and_b32 s38, s2, 3
  s_lshl2_add_u32 s38, s38, s36
  s_bfe_u32 s39, s2, 0x10002
  s_lshl3_add_u32 s39, s39, s43
  s_and_b32 s42, s2, 1
  s_lshl3_add_u32 s40, s42, s43
  s_lshl1_add_u32 s42, s43, s42
  s_bfe_u32 s41, s2, 0x20001
  s_lshl2_add_u32 s41, s41, s36
  s_and_b32 s37, s2, 7
  s_lshl3_add_u32 s37, s37, s43
  s_cmp_lg_u32 s3, 0
  s_cbranch_scc1 gated_mix__spectral_gfnet__ssm_conv_s5__prompt_kernel_skip2
  s_getpc_b64 s[44:45]
gated_mix__spectral_gfnet__ssm_conv_s5__prompt_kernel_pc1:
  s_lshr_b32 s43, s2, 3
  s_mul_i32 s43, s43, 1280
  v_min_u32 v6, 9, v1
  v_lshl_add_u32 v6, v6, 7, s43
  v_min_u32 v6, gated_mix__spectral_gfnet__ssm_conv_s5__prompt_kernel_end-gated_mix__spectral_gfnet__ssm_conv_s5__prompt_kernel_pc1, v6
  v_mov_b32 v7, 0
  v_lshl_add_u64 v[6:7], v[6:7], 0, s[44:45]
  global_load_dword v4, v[6:7], off
gated_mix__spectral_gfnet__ssm_conv_s5__prompt_kernel_skip2:
  s_mov_b32 s46, 4194304
  s_mov_b32 s47, 0x20000
  s_mov_b32 s50, 2097152
  s_mov_b32 s51, 0x20000
  v_bfe_u32 v6, v1, 1, 2
  v_xor_b32 v6, v6, v3
  v_lshlrev_b32 v5, 9, v6
  v_and_b32 v6, 1, v1
  v_lshl_or_b32 v5, v6, 4, v5
  v_lshrrev_b32 v6, 3, v1
  v_lshl_or_b32 v5, v6, 15, v5
  s_lshl_b32 s43, s3, 9
  s_add_u32 s43, s43, s40
  s_lshl_b32 s43, s43, 6
  s_add_u32 s43, s43, s41
  s_lshl_b32 s43, s43, 5
  s_lshl_b32 m0, s3, 12
  s_add_u32 m0, m0, 131072
  s_waitcnt lgkmcnt(0)
  s_mov_b64 s[44:45], s[4:5]
  buffer_load_dwordx4 v5, s[44:47], s43 offen offset:0 lds
  s_add_u32 s43, s43, 261120
  buffer_load_dwordx4 v5, s[44:47], s43 offen offset:1024 lds
  s_add_u32 s43, s43, 261120
  buffer_load_dwordx4 v5, s[44:47], s43 offen offset:2048 lds
  s_add_u32 s43, s43, 261120
  buffer_load_dwordx4 v5, s[44:47], s43 offen offset:3072 lds
  v_and_b32 v6, 7, v1
  v_xor_b32 v6, v6, v3
  v_lshlrev_b32 v6, 4, v6
  v_lshrrev_b32 v7, 3, v1
  v_lshl_or_b32 v12, v7, 11, v6
  v_and_b32 v7, 32, v1
  v_lshl_or_b32 v8, v7, 11, v6
  v_and_b32 v7, 8, v1
  v_lshl_or_b32 v8, v7, 12, v8
  v_and_b32 v7, 16, v1
  v_lshl_or_b32 v8, v7, 7, v8
  s_lshr_b32 s52, s3, 1
  s_lshl1_add_u32 s53, s39, s52
  s_lshl_b32 s53, s53, 16
  v_add_u32 v12, s53, v12
  s_lshl1_add_u32 s53, s38, s52
  s_and_b32 s52, s3, 1
  s_lshl3_add_u32 s53, s53, s52
  s_lshl_b32 s53, s53, 14
  v_add_u32 v8, s53, v8
  v_xor_b32 v9, 64, v8
  v_xor_b32 v13, 64, v12
  v_add_u32 v9, 3072, v9
  v_add_u32 v13, 15360, v13
  v_add_u32 v10, 6144, v8
  v_add_u32 v14, 30720, v12
  v_add_u32 v11, 6144, v9
  v_add_u32 v15, 30720, v13
  s_lshl_b32 s53, s3, 12
  s_add_u32 s54, s53, 65536
  s_lshl_b32 s43, s38, 7
  s_bitcmp1_b32 s3, 0
  s_cselect_b64 s[48:49], s[18:19], s[16:17]
  s_lshl_b32 s10, s37, 2
  s_add_u32 s10, s10, s36
  s_cmp_eq_u32 s10, 3
  s_cselect_b32 s55, 1, s36
  s_cselect_b32 s4, 64, s37
  s_and_b32 s5, s10, 0xfd
  s_cmp_eq_u32 s5, 0
  s_cselect_b32 s5, 1, 0
  v_cvt_f32_u32 v5, v2
  v_cvt_f32_u32 v6, v3
  v_mul_f32 v6, 4.0, v6
  s_cmp_lg_u32 s3, 0
  s_cbranch_scc1 gated_mix__spectral_gfnet__ssm_conv_s5__prompt_kernel_skip3
  v_cvt_f32_u32 v42, s5
  v_mul_f32 v42, 0xc4700000, v42
  v_cmp_lt_u32 vcc, 7, v2
  v_cvt_f32_u32 v41, s4
  s_nop 0
  v_cndmask_b32 v42, 0, v42, vcc
  v_add_f32 v41, v41, v42
  v_fmamk_f32 v7, v5, 0x43000000, v41
  v_mul_f32 v7, 0x3a000000, v7
  v_mul_f32 v40, v7, v6
  v_fmamk_f32 v32, v7, 0x0, v40
  v_fmamk_f32 v33, v7, 0x3f800000, v40
  v_fmamk_f32 v34, v7, 0x40000000, v40
  v_fmamk_f32 v35, v7, 0x40400000, v40
  v_cos_f32 v36, v32
  v_cos_f32 v37, v33
  v_cos_f32 v38, v34
  v_cos_f32 v39, v35
  v_sin_f32 v32, v32
  v_sin_f32 v33, v33
  v_sin_f32 v34, v34
  v_sin_f32 v35, v35
  v_cvt_pk_bf16_f32 v16, v36, v32
  v_cvt_pk_bf16_f32 v20, -v32, v36
  v_cvt_pk_bf16_f32 v17, v37, v33
  v_cvt_pk_bf16_f32 v21, -v33, v37
  v_cvt_pk_bf16_f32 v18, v38, v34
  v_cvt_pk_bf16_f32 v22, -v34, v38
  v_cvt_pk_bf16_f32 v19, v39, v35
  v_cvt_pk_bf16_f32 v23, -v35, v39
  v_xor_b32 v41, 3, v2
  v_cndmask_b32 v41, v2, v41, vcc
  v_cvt_f32_u32 v7, v41
  v_mul_f32 v7, 0x3d800000, v7
  v_mul_f32 v40, v7, v6
  v_fmamk_f32 v32, v7, 0x0, v40
  v_fmamk_f32 v33, v7, 0x3f800000, v40
  v_fmamk_f32 v34, v7, 0x40000000, v40
  v_fmamk_f32 v35, v7, 0x40400000, v40
  v_cos_f32 v36, v32
  v_cos_f32 v37, v33
  v_cos_f32 v38, v34
  v_cos_f32 v39, v35
  v_sin_f32 v32, v32
  v_sin_f32 v33, v33
  v_sin_f32 v34, v34
  v_sin_f32 v35, v35
  v_cvt_pk_bf16_f32 v24, v36, v32
  v_cvt_pk_bf16_f32 v28, -v32, v36
  v_cvt_pk_bf16_f32 v25, v37, v33
  v_cvt_pk_bf16_f32 v29, -v33, v37
  v_cvt_pk_bf16_f32 v26, v38, v34
  v_cvt_pk_bf16_f32 v30, -v34, v38
  v_cvt_pk_bf16_f32 v27, v39, v35
  v_cvt_pk_bf16_f32 v31, -v35, v39
  s_cmp_eq_u32 s5, 0
  s_cbranch_scc1 gated_mix__spectral_gfnet__ssm_conv_s5__prompt_kernel_skip4
  v_cndmask_b32 v41, 0, 16, vcc
  v_and_b32 v16, 0xffff, v16
  v_lshlrev_b32 v16, v41, v16
  v_and_b32 v17, 0xffff, v17
  v_lshlrev_b32 v17, v41, v17
  v_and_b32 v18, 0xffff, v18
  v_lshlrev_b32 v18, v41, v18
  v_and_b32 v19, 0xffff, v19
  v_lshlrev_b32 v19, v41, v19
  v_and_b32 v20, 0xffff, v20
  v_lshlrev_b32 v20, v41, v20
  v_and_b32 v21, 0xffff, v21
  v_lshlrev_b32 v21, v41, v21
  v_and_b32 v22, 0xffff, v22
  v_lshlrev_b32 v22, v41, v22
  v_and_b32 v23, 0xffff, v23
  v_lshlrev_b32 v23, v41, v23
  v_cmp_eq_u32 vcc, 0, v2
  v_mov_b32 v41, 0x3f80
  s_nop 0
  v_cndmask_b32 v20, v20, v41, vcc
  v_mov_b32 v41, 0xbf80
  v_cndmask_b32 v21, v21, v41, vcc
  v_mov_b32 v41, 0x3f80
  v_cndmask_b32 v22, v22, v41, vcc
  v_mov_b32 v41, 0xbf80
  v_cndmask_b32 v23, v23, v41, vcc
gated_mix__spectral_gfnet__ssm_conv_s5__prompt_kernel_skip4:
gated_mix__spectral_gfnet__ssm_conv_s5__prompt_kernel_skip3:
  s_cmp_lg_u32 s3, 1
  s_cbranch_scc1 gated_mix__spectral_gfnet__ssm_conv_s5__prompt_kernel_skip5
  v_cvt_f32_u32 v42, s5
  v_mul_f32 v42, 0xc4700000, v42
  v_cmp_lt_u32 vcc, 1, v3
  v_cvt_f32_u32 v41, s4
  s_nop 0
  v_cndmask_b32 v42, 0, v42, vcc
  v_add_f32 v41, v41, v42
  v_fmamk_f32 v41, v6, 0x43000000, v41
  v_mul_f32 v40, v41, v5
  v_mul_f32 v40, 0x3a000000, v40
  v_mul_f32 v7, 0x3d800000, v5
  v_fmamk_f32 v32, v7, 0x0, v40
  v_fmamk_f32 v33, v7, 0x3f800000, v40
  v_fmamk_f32 v34, v7, 0x40000000, v40
  v_fmamk_f32 v35, v7, 0x40400000, v40
  v_cos_f32 v36, v32
  v_cos_f32 v37, v33
  v_cos_f32 v38, v34
  v_cos_f32 v39, v35
  v_sin_f32 v32, v32
  v_sin_f32 v33, v33
  v_sin_f32 v34, v34
  v_sin_f32 v35, v35
  v_cvt_pk_bf16_f32 v16, v36, -v32
  v_cvt_pk_bf16_f32 v20, v32, v36
  v_cvt_pk_bf16_f32 v17, v37, -v33
  v_cvt_pk_bf16_f32 v21, v33, v37
  v_cvt_pk_bf16_f32 v18, v38, -v34
  v_cvt_pk_bf16_f32 v22, v34, v38
  v_cvt_pk_bf16_f32 v19, v39, -v35
  v_cvt_pk_bf16_f32 v23, v35, v39
  v_add_f32 v41, 0x40400000, v6
  v_cndmask_b32 v41, v6, v41, vcc
  v_mul_f32 v40, v7, v41
  v_cndmask_b32 v7, v7, -v7, vcc
  v_fmamk_f32 v32, v7, 0x0, v40
  v_fmamk_f32 v33, v7, 0x3f800000, v40
  v_fmamk_f32 v34, v7, 0x40000000, v40
  v_fmamk_f32 v35, v7, 0x40400000, v40
  v_cos_f32 v36, v32
  v_cos_f32 v37, v33
  v_cos_f32 v38, v34
  v_cos_f32 v39, v35
  v_sin_f32 v32, v32
  v_sin_f32 v33, v33
  v_sin_f32 v34, v34
  v_sin_f32 v35, v35
  v_cvt_pk_bf16_f32 v24, v36, -v32
  v_cvt_pk_bf16_f32 v28, v32, v36
  v_cvt_pk_bf16_f32 v25, v37, -v33
  v_cvt_pk_bf16_f32 v29, v33, v37
  v_cvt_pk_bf16_f32 v26, v38, -v34
  v_cvt_pk_bf16_f32 v30, v34, v38
  v_cvt_pk_bf16_f32 v27, v39, -v35
  v_cvt_pk_bf16_f32 v31, v35, v39
  s_cmp_eq_u32 s5, 0
  s_cbranch_scc1 gated_mix__spectral_gfnet__ssm_conv_s5__prompt_kernel_skip6
  v_lshlrev_b32 v41, 16, v16
  v_and_b32 v42, 0xffff0000, v16
  v_add_f32 v41, v41, v41
  v_add_f32 v42, v42, v42
  v_cvt_pk_bf16_f32 v41, v41, v42
  v_cndmask_b32 v16, v41, 0, vcc
  v_cndmask_b32 v20, 0, v41, vcc
  v_lshlrev_b32 v41, 16, v17
  v_and_b32 v42, 0xffff0000, v17
  v_add_f32 v41, v41, v41
  v_add_f32 v42, v42, v42
  v_cvt_pk_bf16_f32 v41, v41, v42
  v_cndmask_b32 v17, v41, 0, vcc
  v_cndmask_b32 v21, 0, v41, vcc
  v_lshlrev_b32 v41, 16, v18
  v_and_b32 v42, 0xffff0000, v18
  v_add_f32 v41, v41, v41
  v_add_f32 v42, v42, v42
  v_cvt_pk_bf16_f32 v41, v41, v42
  v_cndmask_b32 v18, v41, 0, vcc
  v_cndmask_b32 v22, 0, v41, vcc
  v_lshlrev_b32 v41, 16, v19
  v_and_b32 v42, 0xffff0000, v19
  v_add_f32 v41, v41, v41
  v_add_f32 v42, v42, v42
  v_cvt_pk_bf16_f32 v41, v41, v42
  v_cndmask_b32 v19, v41, 0, vcc
  v_cndmask_b32 v23, 0, v41, vcc
  v_lshlrev_b32 v41, 31, v2
  v_or_b32 v41, 0x3f803f80, v41
  v_cmp_eq_u32 vcc, 0, v3
  s_nop 1
  v_cndmask_b32 v16, v16, v41, vcc
gated_mix__spectral_gfnet__ssm_conv_s5__prompt_kernel_skip6:
gated_mix__spectral_gfnet__ssm_conv_s5__prompt_kernel_skip5:
  s_cmp_lg_u32 s3, 2
  s_cbranch_scc1 gated_mix__spectral_gfnet__ssm_conv_s5__prompt_kernel_skip7
  v_cvt_f32_u32 v42, s55
  v_fma_f32 v41, v5, 4.0, v42
  v_mul_f32 v7, 0x3c800000, v41
  v_mul_f32 v40, v7, v6
  v_fmamk_f32 v32, v7, 0x0, v40
  v_fmamk_f32 v33, v7, 0x3f800000, v40
  v_fmamk_f32 v34, v7, 0x40000000, v40
  v_fmamk_f32 v35, v7, 0x40400000, v40
  v_cos_f32 v36, v32
  v_cos_f32 v37, v33
  v_cos_f32 v38, v34
  v_cos_f32 v39, v35
  v_sin_f32 v32, v32
  v_sin_f32 v33, v33
  v_sin_f32 v34, v34
  v_sin_f32 v35, v35
  v_cvt_pk_bf16_f32 v16, v36, v32
  v_cvt_pk_bf16_f32 v20, -v32, v36
  v_cvt_pk_bf16_f32 v17, v37, v33
  v_cvt_pk_bf16_f32 v21, -v33, v37
  v_cvt_pk_bf16_f32 v18, v38, v34
  v_cvt_pk_bf16_f32 v22, -v34, v38
  v_cvt_pk_bf16_f32 v19, v39, v35
  v_cvt_pk_bf16_f32 v23, -v35, v39
  v_mul_f32 v7, 0x3d800000, v7
  v_mul_f32 v40, 0x3d800000, v40
  v_fmamk_f32 v32, v7, 0x0, v40
  v_fmamk_f32 v33, v7, 0x3f800000, v40
  v_fmamk_f32 v34, v7, 0x40000000, v40
  v_fmamk_f32 v35, v7, 0x40400000, v40
  v_cos_f32 v24, v32
  v_cos_f32 v25, v33
  v_cos_f32 v26, v34
  v_cos_f32 v27, v35
  v_sin_f32 v28, v32
  v_sin_f32 v29, v33
  v_sin_f32 v30, v34
  v_sin_f32 v31, v35
gated_mix__spectral_gfnet__ssm_conv_s5__prompt_kernel_skip7:
  s_cmp_lg_u32 s3, 3
  s_cbranch_scc1 gated_mix__spectral_gfnet__ssm_conv_s5__prompt_kernel_skip8
  v_cvt_f32_u32 v42, s55
  v_fma_f32 v41, v6, 4.0, v42
  v_mul_f32 v40, v41, v5
  v_mul_f32 v40, 0x3c800000, v40
  v_mul_f32 v7, 0x3d800000, v5
  v_fmamk_f32 v32, v7, 0x0, v40
  v_fmamk_f32 v33, v7, 0x3f800000, v40
  v_fmamk_f32 v34, v7, 0x40000000, v40
  v_fmamk_f32 v35, v7, 0x40400000, v40
  v_cos_f32 v36, v32
  v_cos_f32 v37, v33
  v_cos_f32 v38, v34
  v_cos_f32 v39, v35
  v_sin_f32 v32, v32
  v_sin_f32 v33, v33
  v_sin_f32 v34, v34
  v_sin_f32 v35, v35
  v_cvt_pk_bf16_f32 v16, v36, -v32
  v_cvt_pk_bf16_f32 v20, v32, v36
  v_cvt_pk_bf16_f32 v17, v37, -v33
  v_cvt_pk_bf16_f32 v21, v33, v37
  v_cvt_pk_bf16_f32 v18, v38, -v34
  v_cvt_pk_bf16_f32 v22, v34, v38
  v_cvt_pk_bf16_f32 v19, v39, -v35
  v_cvt_pk_bf16_f32 v23, v35, v39
  v_mul_f32 v7, 0x3d800000, v7
  v_mul_f32 v40, 0x3d800000, v40
  v_fmamk_f32 v32, v7, 0x0, v40
  v_fmamk_f32 v33, v7, 0x3f800000, v40
  v_fmamk_f32 v34, v7, 0x40000000, v40
  v_fmamk_f32 v35, v7, 0x40400000, v40
  v_cos_f32 v24, v32
  v_cos_f32 v25, v33
  v_cos_f32 v26, v34
  v_cos_f32 v27, v35
  v_sin_f32 v28, v32
  v_sin_f32 v29, v33
  v_sin_f32 v30, v34
  v_sin_f32 v31, v35
  v_mul_f32 v24, 0x35800000, v24
  v_mul_f32 v25, 0x35800000, v25
  v_mul_f32 v26, 0x35800000, v26
  v_mul_f32 v27, 0x35800000, v27
  v_mul_f32 v28, 0x35800000, v28
  v_mul_f32 v29, 0x35800000, v29
  v_mul_f32 v30, 0x35800000, v30
  v_mul_f32 v31, 0x35800000, v31
gated_mix__spectral_gfnet__ssm_conv_s5__prompt_kernel_skip8:
  s_lshl_b32 s11, s3, 12
  s_add_u32 s11, s11, 147456
  v_lshl_add_u32 v41, v1, 4, s11
  ds_write_b128 v41, v[16:19] offset:0
  ds_write_b128 v41, v[20:23] offset:1024
  ds_write_b128 v41, v[24:27] offset:2048
  ds_write_b128 v41, v[28:31] offset:3072
  v_bfe_u32 v6, v1, 1, 3
  v_lshrrev_b32 v7, 5, v1
  v_xor_b32 v6, v6, v7
  v_lshlrev_b32 v6, 4, v6
  v_and_b32 v7, 31, v1
  v_lshl_or_b32 v6, v7, 7, v6
  s_lshr_b32 s52, s3, 1
  v_lshl_add_u32 v16, s52, 13, v6
  s_and_b32 s52, s3, 1
  s_or_b32 s52, s52, 8
  v_lshl_add_u32 v20, s52, 13, v6
  v_xor_b32 v17, 32, v16
  v_xor_b32 v21, 32, v20
  v_xor_b32 v18, 64, v16
  v_xor_b32 v22, 64, v20
  v_xor_b32 v19, 96, v16
  v_xor_b32 v23, 96, v20
  s_add_u32 s16, s34, 20316160
  s_addc_u32 s17, s35, 0
  s_mov_b32 s18, 40960
  s_mov_b32 s19, 0x20000
  v_mov_b32 v5, 0
  v_lshlrev_b32 v6, 4, v0
  s_mov_b32 s11, 4096
  s_cmp_lg_u32 s2, 0
  s_cbranch_scc1 gated_mix__spectral_gfnet__ssm_conv_s5__prompt_kernel_skip9
  v_mov_b32 v24, 0
  v_mov_b32 v25, 0
  v_mov_b32 v26, 0
  v_mov_b32 v27, 0
  buffer_store_dwordx4 v[24:27], v6, s[16:19], 0 offen sc1
  buffer_store_dwordx4 v[24:27], v6, s[16:19], s11 offen sc1
gated_mix__spectral_gfnet__ssm_conv_s5__prompt_kernel_skip9:
  s_mov_b32 s56, s28
  s_mov_b32 s57, s29
  s_mov_b32 s58, 2048
  s_mov_b32 s59, 0x20000
  s_mov_b32 s60, s34
  s_mov_b32 s61, s35
  s_mov_b32 s62, 4194304
  s_mov_b32 s63, 0x20000
  s_lshl_b32 s28, s3, 4
  v_add_u32 v75, s28, v2
  v_cvt_f32_u32 v7, v75
  v_mul_f32 v7, 0x3c000000, v7
  s_add_u32 m0, s54, 0
  s_nop 0
  buffer_load_dwordx4 v12, s[48:51], s43 offen offset:0  lds
  v_lshrrev_b32 v73, 1, v3
  v_lshlrev_b32 v73, 4, v73
  v_and_b32 v74, 1, v3
  v_lshl_add_u32 v73, v74, 2, v73
  v_cvt_f32_u32 v72, v73
  buffer_load_dwordx4 v13, s[48:51], s43 offen offset:1024  lds
  v_mul_f32 v72, v72, v7
  v_cmp_eq_u32 vcc, 0, v75
  v_fmamk_f32 v56, v7, 0x0, v72
  v_fmamk_f32 v57, v7, 0x3f800000, v72
  v_fmamk_f32 v58, v7, 0x40000000, v72
  buffer_load_dwordx4 v14, s[48:51], s43 offen offset:2048  lds
  v_fmamk_f32 v59, v7, 0x40400000, v72
  v_fmamk_f32 v60, v7, 0x41000000, v72
  v_fmamk_f32 v61, v7, 0x41100000, v72
  v_fmamk_f32 v62, v7, 0x41200000, v72
  v_fmamk_f32 v63, v7, 0x41300000, v72
  buffer_load_dwordx4 v15, s[48:51], s43 offen offset:3072  lds
  v_cos_f32 v64, v56
  v_cos_f32 v65, v57
  v_cos_f32 v66, v58
  s_add_u32 m0, s53, 0
  s_nop 0
  buffer_load_dwordx4 v8, s[44:47], s43 offen offset:0  lds
  v_cos_f32 v67, v59
  v_cos_f32 v68, v60
  v_cos_f32 v69, v61
  buffer_load_dwordx4 v9, s[44:47], s43 offen offset:1024  lds
  v_cos_f32 v70, v62
  v_cos_f32 v71, v63
  v_sin_f32 v56, v56
  buffer_load_dwordx4 v10, s[44:47], s43 offen offset:2048  lds
  v_sin_f32 v57, v57
  v_sin_f32 v58, v58
  v_sin_f32 v59, v59
  buffer_load_dwordx4 v11, s[44:47], s43 offen offset:3072  lds
  s_add_u32 s43, s43, 128
  s_and_b32 s43, s43, 0x7ff
  v_sin_f32 v60, v60
  v_sin_f32 v61, v61
  v_sin_f32 v62, v62
  v_sin_f32 v63, v63
  v_mov_b32 v72, 0x80008000
  v_bfe_i32 v74, v2, 0, 1
  v_bfe_i32 v73, v2, 1, 1
  v_cmp_ne_u32 s[64:65], 0, v74
  v_and_b32 v74, v72, v74
  v_and_b32 v73, v72, v73
  v_xor_b32 v75, v73, v74
  v_mov_b32 v7, 0xbf803f80
  v_cvt_pk_bf16_f32 v24, v64, v65
  v_cvt_pk_bf16_f32 v40, -v56, -v57
  v_cndmask_b32 v40, v40, v7, vcc
  v_cvt_pk_bf16_f32 v25, v66, v67
  v_cvt_pk_bf16_f32 v41, -v58, -v59
  v_cndmask_b32 v41, v41, v7, vcc
  v_cvt_pk_bf16_f32 v26, v68, v69
  v_cvt_pk_bf16_f32 v42, -v60, -v61
  v_cndmask_b32 v42, v42, v7, vcc
  v_cvt_pk_bf16_f32 v27, v70, v71
  v_cvt_pk_bf16_f32 v43, -v62, -v63
  v_cndmask_b32 v43, v43, v7, vcc
  v_cndmask_b32 v28, v24, v40, s[64:65]
  v_cndmask_b32 v44, v40, v24, s[64:65]
  v_xor_b32 v32, v74, v24
  v_xor_b32 v48, v74, v40
  v_xor_b32 v36, v75, v28
  v_xor_b32 v52, v73, v44
  v_xor_b32 v28, v73, v28
  v_xor_b32 v44, v75, v44
  v_cndmask_b32 v29, v25, v41, s[64:65]
  v_cndmask_b32 v45, v41, v25, s[64:65]
  v_xor_b32 v33, v74, v25
  v_xor_b32 v49, v74, v41
  v_xor_b32 v37, v75, v29
  v_xor_b32 v53, v73, v45
  v_xor_b32 v29, v73, v29
  v_xor_b32 v45, v75, v45
  v_cndmask_b32 v30, v26, v42, s[64:65]
  v_cndmask_b32 v46, v42, v26, s[64:65]
  v_xor_b32 v34, v74, v26
  v_xor_b32 v50, v74, v42
  v_xor_b32 v38, v75, v30
  v_xor_b32 v54, v73, v46
  v_xor_b32 v30, v73, v30
  v_xor_b32 v46, v75, v46
  v_cndmask_b32 v31, v27, v43, s[64:65]
  v_cndmask_b32 v47, v43, v27, s[64:65]
  v_xor_b32 v35, v74, v27
  v_xor_b32 v51, v74, v43
  v_xor_b32 v39, v75, v31
  v_xor_b32 v55, v73, v47
  v_xor_b32 v31, v73, v31
  v_xor_b32 v47, v75, v47
  s_mov_b32 s64, s32
  s_mov_b32 s65, s33
  s_mov_b32 s66, 256
  s_mov_b32 s67, 0x20000
  s_and_b32 s28, s2, 7
  s_lshl_b32 s28, s28, 8
  s_add_u32 s28, s28, s2
  s_and_b32 s28, s28, -8
  s_lshl_b32 s28, s28, 1
  v_mov_b32 v56, s28
  s_lshl_b32 s28, s39, 14
  s_add_u32 s70, s28, 19988480
  s_add_u32 s68, s34, s70
  s_addc_u32 s69, s35, 0
  s_mov_b32 s70, 8192
  s_mov_b32 s71, 0x20000
  s_lshl4_add_u32 s28, s39, s38
  s_lshl_b32 s28, s28, 7
  v_lshl_add_u32 v57, v2, 2, s28
  s_mov_b32 s28, 8192
  v_mov_b32 v7, 1
  s_cmp_eq_u32 s3, 0
  s_cbranch_scc1 gated_mix__spectral_gfnet__ssm_conv_s5__prompt_kernel_isl0
  s_cmp_eq_u32 s3, 1
  s_cbranch_scc1 gated_mix__spectral_gfnet__ssm_conv_s5__prompt_kernel_isl1
  s_cmp_eq_u32 s3, 2
  s_cbranch_scc1 gated_mix__spectral_gfnet__ssm_conv_s5__prompt_kernel_isl2
  s_branch gated_mix__spectral_gfnet__ssm_conv_s5__prompt_kernel_isl3
gated_mix__spectral_gfnet__ssm_conv_s5__prompt_kernel_ret:
  s_nop 1
  s_lshl_b32 s29, s38, 7
  v_lshl_add_u32 v58, v1, 4, s29
  v_and_b32 v58, 0x7ff, v58
  s_add_u32 m0, s53, 49152
  s_nop 0
  buffer_load_dwordx4 v58, s[56:59], 0 offen lds
  v_xor_b32 v58, 1024, v58
  s_add_u32 m0, s53, 50176
  s_nop 0
  buffer_load_dwordx4 v58, s[56:59], 0 offen lds
  s_and_b32 s29, s3, 1
  s_lshl1_add_u32 s29, s39, s29
  s_lshl_b32 s29, s29, 6
  v_and_b32 v64, 31, v1
  v_lshl_add_u32 v64, v64, 1, s29
  s_lshl4_add_u32 s29, s3, s41
  s_lshl_b32 s29, s29, 5
  v_lshl_add_u32 v65, v2, 1, s29
  global_load_ushort v58, v64, s[12:13]
  global_load_ushort v59, v64, s[14:15]
  global_load_ushort v60, v64, s[24:25]
  global_load_short_d16_hi v62, v65, s[26:27]
  s_waitcnt vmcnt(14) lgkmcnt(0)
  s_barrier
  s_add_u32 m0, s54, 16384
  s_nop 0
  buffer_load_dwordx4 v12, s[48:51], s43 offen offset:0  lds
  v_bfe_u32 v61, v1, 2, 3
  v_lshrrev_b32 v68, 5, v1
  v_lshl_or_b32 v61, v68, 4, v61
  v_lshlrev_b32 v61, 7, v61
  v_and_b32 v68, 3, v1
  v_lshl_or_b32 v61, v68, 3, v61
  v_add_u32 v61, 131072, v61
  v_bfe_u32 v68, v1, 3, 2
  v_xor_b32 v64, 0, v68
  v_lshl_add_u32 v64, v64, 5, v61
  v_xor_b32 v65, 1, v68
  v_lshl_add_u32 v65, v65, 5, v61
  v_xor_b32 v66, 2, v68
  buffer_load_dwordx4 v13, s[48:51], s43 offen offset:1024  lds
  v_lshl_add_u32 v66, v66, 5, v61
  v_xor_b32 v67, 3, v68
  v_lshl_add_u32 v67, v67, 5, v61
  ds_read_b64_tr_b16 v[104:105], v64 offset:0
  ds_read_b64_tr_b16 v[106:107], v64 offset:1024
  ds_read_b64_tr_b16 v[108:109], v64 offset:4096
  ds_read_b64_tr_b16 v[110:111], v64 offset:5120
  ds_read_b64_tr_b16 v[112:113], v64 offset:8192
  ds_read_b64_tr_b16 v[114:115], v64 offset:9216
  ds_read_b64_tr_b16 v[116:117], v64 offset:12288
  ds_read_b64_tr_b16 v[118:119], v64 offset:13312
  ds_read_b64_tr_b16 v[120:121], v66 offset:0
  ds_read_b64_tr_b16 v[122:123], v66 offset:1024
  buffer_load_dwordx4 v14, s[48:51], s43 offen offset:2048  lds
  ds_read_b64_tr_b16 v[124:125], v66 offset:4096
  ds_read_b64_tr_b16 v[126:127], v66 offset:5120
  ds_read_b64_tr_b16 v[128:129], v66 offset:8192
  ds_read_b64_tr_b16 v[130:131], v66 offset:9216
  ds_read_b64_tr_b16 v[132:133], v66 offset:12288
  ds_read_b64_tr_b16 v[134:135], v66 offset:13312
  ds_read_b64_tr_b16 v[136:137], v65 offset:0
  ds_read_b64_tr_b16 v[138:139], v65 offset:1024
  ds_read_b64_tr_b16 v[140:141], v65 offset:4096
  ds_read_b64_tr_b16 v[142:143], v65 offset:5120
  ds_read_b64_tr_b16 v[144:145], v65 offset:8192
  ds_read_b64_tr_b16 v[146:147], v65 offset:9216
  ds_read_b64_tr_b16 v[148:149], v65 offset:12288
  buffer_load_dwordx4 v15, s[48:51], s43 offen offset:3072  lds
  ds_read_b64_tr_b16 v[150:151], v65 offset:13312
  s_waitcnt lgkmcnt(15)
  v_mfma_f32_16x16x32_bf16 v[72:75], v[24:27], v[104:107], 0
  v_mfma_f32_16x16x32_bf16 v[76:79], v[40:43], v[104:107], 0
  s_waitcnt lgkmcnt(15)
  v_mfma_f32_16x16x32_bf16 v[72:75], v[28:31], v[108:111], v[72:75]
  s_add_u32 m0, s53, 16384
  s_nop 0
  buffer_load_dwordx4 v8, s[44:47], s43 offen offset:0  lds
  v_mfma_f32_16x16x32_bf16 v[76:79], v[44:47], v[108:111], v[76:79]
  s_waitcnt lgkmcnt(15)
  v_mfma_f32_16x16x32_bf16 v[72:75], v[32:35], v[112:115], v[72:75]
  v_mfma_f32_16x16x32_bf16 v[76:79], v[48:51], v[112:115], v[76:79]
  s_waitcnt lgkmcnt(15)
  v_mfma_f32_16x16x32_bf16 v[72:75], v[36:39], v[116:119], v[72:75]
  buffer_load_dwordx4 v9, s[44:47], s43 offen offset:1024  lds
  v_mfma_f32_16x16x32_bf16 v[76:79], v[52:55], v[116:119], v[76:79]
  ds_read_b64_tr_b16 v[104:105], v67 offset:0
  ds_read_b64_tr_b16 v[106:107], v67 offset:1024
  ds_read_b64_tr_b16 v[108:109], v67 offset:4096
  ds_read_b64_tr_b16 v[110:111], v67 offset:5120
  ds_read_b64_tr_b16 v[112:113], v67 offset:8192
  ds_read_b64_tr_b16 v[114:115], v67 offset:9216
  ds_read_b64_tr_b16 v[116:117], v67 offset:12288
  ds_read_b64_tr_b16 v[118:119], v67 offset:13312
  s_waitcnt lgkmcnt(15)
  v_mfma_f32_16x16x32_bf16 v[88:91], v[24:27], v[120:123], 0
  buffer_load_dwordx4 v10, s[44:47], s43 offen offset:2048  lds
  v_mfma_f32_16x16x32_bf16 v[92:95], v[40:43], v[120:123], 0
  s_waitcnt lgkmcnt(15)
  v_mfma_f32_16x16x32_bf16 v[88:91], v[28:31], v[124:127], v[88:91]
  v_mfma_f32_16x16x32_bf16 v[92:95], v[44:47], v[124:127], v[92:95]
  s_waitcnt lgkmcnt(15)
  v_mfma_f32_16x16x32_bf16 v[88:91], v[32:35], v[128:131], v[88:91]
  buffer_load_dwordx4 v11, s[44:47], s43 offen offset:3072  lds
  s_add_u32 s43, s43, 128
  s_and_b32 s43, s43, 0x7ff
  v_mfma_f32_16x16x32_bf16 v[92:95], v[48:51], v[128:131], v[92:95]
  s_waitcnt lgkmcnt(15)
  v_mfma_f32_16x16x32_bf16 v[88:91], v[36:39], v[132:135], v[88:91]
  v_mfma_f32_16x16x32_bf16 v[92:95], v[52:55], v[132:135], v[92:95]
  s_waitcnt lgkmcnt(14)
  v_mfma_f32_16x16x32_bf16 v[80:83], v[24:27], v[136:139], 0
  s_add_u32 m0, s54, 32768
  s_nop 0
  buffer_load_dwordx4 v12, s[48:51], s43 offen offset:0  lds
  v_mfma_f32_16x16x32_bf16 v[84:87], v[40:43], v[136:139], 0
  s_waitcnt lgkmcnt(12)
  v_mfma_f32_16x16x32_bf16 v[80:83], v[28:31], v[140:143], v[80:83]
  v_mfma_f32_16x16x32_bf16 v[84:87], v[44:47], v[140:143], v[84:87]
  s_waitcnt lgkmcnt(10)
  v_mfma_f32_16x16x32_bf16 v[80:83], v[32:35], v[144:147], v[80:83]
  buffer_load_dwordx4 v13, s[48:51], s43 offen offset:1024  lds
  v_mfma_f32_16x16x32_bf16 v[84:87], v[48:51], v[144:147], v[84:87]
  s_waitcnt lgkmcnt(8)
  v_mfma_f32_16x16x32_bf16 v[80:83], v[36:39], v[148:151], v[80:83]
  v_mfma_f32_16x16x32_bf16 v[84:87], v[52:55], v[148:151], v[84:87]
  s_waitcnt lgkmcnt(6)
  v_mfma_f32_16x16x32_bf16 v[96:99], v[24:27], v[104:107], 0
  buffer_load_dwordx4 v14, s[48:51], s43 offen offset:2048  lds
  v_mfma_f32_16x16x32_bf16 v[100:103], v[40:43], v[104:107], 0
  s_waitcnt lgkmcnt(4)
  v_mfma_f32_16x16x32_bf16 v[96:99], v[28:31], v[108:111], v[96:99]
  v_mfma_f32_16x16x32_bf16 v[100:103], v[44:47], v[108:111], v[100:103]
  s_waitcnt lgkmcnt(2)
  v_mfma_f32_16x16x32_bf16 v[96:99], v[32:35], v[112:115], v[96:99]
  s_branch gated_mix__spectral_gfnet__ssm_conv_s5__prompt_kernel_isk0
gated_mix__spectral_gfnet__ssm_conv_s5__prompt_kernel_isl0:
  s_branch gated_mix__spectral_gfnet__ssm_conv_s5__prompt_kernel_isl4
gated_mix__spectral_gfnet__ssm_conv_s5__prompt_kernel_isk0:
  buffer_load_dwordx4 v15, s[48:51], s43 offen offset:3072  lds
  v_mfma_f32_16x16x32_bf16 v[100:103], v[48:51], v[112:115], v[100:103]
  s_waitcnt lgkmcnt(0)
  v_mfma_f32_16x16x32_bf16 v[96:99], v[36:39], v[116:119], v[96:99]
  v_mfma_f32_16x16x32_bf16 v[100:103], v[52:55], v[116:119], v[100:103]
  v_pk_add_f32 v[120:121], v[72:73], v[88:89]
  s_add_u32 m0, s53, 32768
  s_nop 0
  buffer_load_dwordx4 v8, s[44:47], s43 offen offset:0  lds
  v_pk_add_f32 v[128:129], v[72:73], v[88:89] neg_lo:[0,1] neg_hi:[0,1]
  v_pk_add_f32 v[122:123], v[74:75], v[90:91]
  v_pk_add_f32 v[130:131], v[74:75], v[90:91] neg_lo:[0,1] neg_hi:[0,1]
  v_pk_add_f32 v[124:125], v[76:77], v[92:93]
  v_pk_add_f32 v[132:133], v[76:77], v[92:93] neg_lo:[0,1] neg_hi:[0,1]
  v_pk_add_f32 v[126:127], v[78:79], v[94:95]
  v_pk_add_f32 v[134:135], v[78:79], v[94:95] neg_lo:[0,1] neg_hi:[0,1]
  v_pk_add_f32 v[136:137], v[80:81], v[96:97]
  v_pk_add_f32 v[144:145], v[80:81], v[96:97] neg_lo:[0,1] neg_hi:[0,1]
  v_pk_add_f32 v[138:139], v[82:83], v[98:99]
  v_pk_add_f32 v[146:147], v[82:83], v[98:99] neg_lo:[0,1] neg_hi:[0,1]
  v_pk_add_f32 v[140:141], v[84:85], v[100:101]
  v_pk_add_f32 v[148:149], v[84:85], v[100:101] neg_lo:[0,1] neg_hi:[0,1]
  buffer_load_dwordx4 v9, s[44:47], s43 offen offset:1024  lds
  v_pk_add_f32 v[142:143], v[86:87], v[102:103]
  v_pk_add_f32 v[150:151], v[86:87], v[102:103] neg_lo:[0,1] neg_hi:[0,1]
  s_lshr_b32 s29, s3, 1
  s_lshr_b32 s32, s39, 1
  s_lshl3_add_u32 s29, s29, s32
  s_and_b32 s32, s3, 1
  s_lshl1_add_u32 s29, s29, s32
  s_and_b32 s32, s39, 1
  s_lshl1_add_u32 s29, s29, s32
  s_lshl_b32 s32, s29, 8
  v_lshl_add_u32 v69, v1, 2, s32
  s_and_b32 s29, s29, 7
  s_lshl_b32 s29, s29, 2
  buffer_load_dwordx4 v10, s[44:47], s43 offen offset:2048  lds
  v_and_b32 v70, 31, v1
  v_xor_b32 v70, s29, v70
  v_lshl_add_u32 v70, v70, 2, s53
  v_mov_b32 v184, 0
  s_mov_b32 s33, 0x3f803f80
  s_waitcnt vmcnt(19)
  ds_read_u16_d16_hi v152, v70 offset:49152
  ds_read_u16_d16_hi v153, v70 offset:49154
  ds_read_u16_d16_hi v154, v70 offset:49280
  ds_read_u16_d16_hi v155, v70 offset:49282
  ds_read_u16_d16_hi v156, v70 offset:49408
  ds_read_u16_d16_hi v157, v70 offset:49410
  ds_read_u16_d16_hi v158, v70 offset:49536
  ds_read_u16_d16_hi v159, v70 offset:49538
  buffer_load_dwordx4 v11, s[44:47], s43 offen offset:3072  lds
  s_add_u32 s43, s43, 128
  s_and_b32 s43, s43, 0x7ff
  ds_read_u16_d16_hi v160, v70 offset:49664
  ds_read_u16_d16_hi v161, v70 offset:49666
  ds_read_u16_d16_hi v162, v70 offset:49792
  ds_read_u16_d16_hi v163, v70 offset:49794
  ds_read_u16_d16_hi v164, v70 offset:49920
  ds_read_u16_d16_hi v165, v70 offset:49922
  ds_read_u16_d16_hi v166, v70 offset:50048
  ds_read_u16_d16_hi v167, v70 offset:50050
  ds_read_u16_d16_hi v168, v70 offset:50176
  ds_read_u16_d16_hi v169, v70 offset:50178
  ds_read_u16_d16_hi v170, v70 offset:50304
  ds_read_u16_d16_hi v171, v70 offset:50306
  ds_read_u16_d16_hi v172, v70 offset:50432
  s_add_u32 m0, s54, 49152
  s_nop 0
  buffer_load_dwordx4 v12, s[48:51], s43 offen offset:0  lds
  ds_read_u16_d16_hi v173, v70 offset:50434
  ds_read_u16_d16_hi v174, v70 offset:50560
  ds_read_u16_d16_hi v175, v70 offset:50562
  ds_read_u16_d16_hi v176, v70 offset:50688
  ds_read_u16_d16_hi v177, v70 offset:50690
  ds_read_u16_d16_hi v178, v70 offset:50816
  ds_read_u16_d16_hi v179, v70 offset:50818
  ds_read_u16_d16_hi v180, v70 offset:50944
  ds_read_u16_d16_hi v181, v70 offset:50946
  ds_read_u16_d16_hi v182, v70 offset:51072
  ds_read_u16_d16_hi v183, v70 offset:51074
  v_pk_add_f32 v[72:73], v[120:121], v[136:137]
  v_pk_add_f32 v[88:89], v[120:121], v[136:137] neg_lo:[0,1] neg_hi:[0,1]
  buffer_load_dwordx4 v13, s[48:51], s43 offen offset:1024  lds
  v_pk_add_f32 v[76:77], v[124:125], v[140:141]
  v_pk_add_f32 v[92:93], v[124:125], v[140:141] neg_lo:[0,1] neg_hi:[0,1]
  v_pk_add_f32 v[80:81], v[128:129], v[148:149]
  v_pk_add_f32 v[84:85], v[132:133], v[144:145] neg_lo:[0,1] neg_hi:[0,1]
  v_pk_add_f32 v[96:97], v[128:129], v[148:149] neg_lo:[0,1] neg_hi:[0,1]
  v_pk_add_f32 v[100:101], v[132:133], v[144:145]
  v_pk_add_f32 v[74:75], v[122:123], v[138:139]
  v_pk_add_f32 v[90:91], v[122:123], v[138:139] neg_lo:[0,1] neg_hi:[0,1]
  v_pk_add_f32 v[78:79], v[126:127], v[142:143]
  v_pk_add_f32 v[94:95], v[126:127], v[142:143] neg_lo:[0,1] neg_hi:[0,1]
  v_pk_add_f32 v[82:83], v[130:131], v[150:151]
  v_pk_add_f32 v[86:87], v[134:135], v[146:147] neg_lo:[0,1] neg_hi:[0,1]
  v_pk_add_f32 v[98:99], v[130:131], v[150:151] neg_lo:[0,1] neg_hi:[0,1]
  buffer_load_dwordx4 v14, s[48:51], s43 offen offset:2048  lds
  v_pk_add_f32 v[102:103], v[134:135], v[146:147]
  v_cmp_gt_u32 vcc, 16, v0
  s_nop 1
  v_cndmask_b32 v80, v80, v128, vcc
  v_cndmask_b32 v84, v84, -v144, vcc
  v_cndmask_b32 v96, v96, v132, vcc
  v_cndmask_b32 v100, v100, -v148, vcc
  v_cvt_pk_bf16_f32 v104, v72, v76
  v_cvt_pk_bf16_f32 v105, v80, v84
  v_cvt_pk_bf16_f32 v106, v88, v92
  v_cvt_pk_bf16_f32 v107, v96, v100
  v_cvt_pk_bf16_f32 v108, v73, v77
  v_cvt_pk_bf16_f32 v109, v81, v85
  v_cvt_pk_bf16_f32 v110, v89, v93
  buffer_load_dwordx4 v15, s[48:51], s43 offen offset:3072  lds
  v_cvt_pk_bf16_f32 v111, v97, v101
  v_cvt_pk_bf16_f32 v112, v74, v78
  v_cvt_pk_bf16_f32 v113, v82, v86
  v_cvt_pk_bf16_f32 v114, v90, v94
  v_cvt_pk_bf16_f32 v115, v98, v102
  v_cvt_pk_bf16_f32 v116, v75, v79
  v_cvt_pk_bf16_f32 v117, v83, v87
  v_cvt_pk_bf16_f32 v118, v91, v95
  v_cvt_pk_bf16_f32 v119, v99, v103
  v_and_b32 v104, -2, v104
  v_and_b32 v105, -2, v105
  v_and_b32 v106, -2, v106
  v_and_b32 v107, -2, v107
  s_waitcnt lgkmcnt(0)
  s_add_u32 m0, s53, 49152
  s_nop 0
  buffer_load_dwordx4 v8, s[44:47], s43 offen offset:0  lds
  v_and_b32 v108, -2, v108
  v_and_b32 v109, -2, v109
  v_and_b32 v110, -2, v110
  v_and_b32 v111, -2, v111
  v_and_b32 v112, -2, v112
  v_and_b32 v113, -2, v113
  v_and_b32 v114, -2, v114
  v_and_b32 v115, -2, v115
  v_and_b32 v116, -2, v116
  v_and_b32 v117, -2, v117
  v_and_b32 v118, -2, v118
  v_and_b32 v119, -2, v119
  s_mov_b32 s29, 262144
  buffer_load_dwordx4 v9, s[44:47], s43 offen offset:1024  lds
  v_mul_lo_u32 v61, v3, s29
  v_lshl_add_u32 v61, v2, 2, v61
  s_mul_i32 s29, s3, 1048576
  s_lshl_b32 s32, s40, 10
  s_add_u32 s29, s29, s32
  s_lshl_b32 s32, s41, 6
  s_add_u32 s29, s29, s32
  s_lshr_b32 s32, s41, 3
  s_lshl_b32 s32, s32, 13
  s_add_u32 s32, s32, 131072
  v_lshl_add_u32 v39, v2, 7, s32
  v_lshl_add_u32 v39, v3, 3, v39
  v_bfe_u32 v68, v2, 1, 2
  buffer_load_dwordx4 v10, s[44:47], s43 offen offset:2048  lds
  v_xor_b32 v68, s3, v68
  v_lshl_add_u32 v39, v68, 5, v39
  v_xor_b32 v38, 8192, v39
  ds_read_b64 v[186:187], v38 offset:0
  ds_read_b64 v[24:25], v38 offset:2048
  ds_read_b64 v[26:27], v38 offset:4096
  ds_read_b64 v[28:29], v38 offset:6144
  ds_read_b64 v[30:31], v39 offset:0
  ds_read_b64 v[32:33], v39 offset:2048
  ds_read_b64 v[34:35], v39 offset:4096
  ds_read_b64 v[36:37], v39 offset:6144
  buffer_load_dwordx4 v11, s[44:47], s43 offen offset:3072  lds
  s_add_u32 s43, s43, 128
  s_and_b32 s43, s43, 0x7ff
  s_barrier
  ds_read_b128 v[64:67], v16 offset:0
  ds_read_b128 v[140:143], v20 offset:0
  ds_read_b128 v[136:139], v16 offset:4096
  ds_read_b128 v[144:147], v20 offset:4096
  s_waitcnt lgkmcnt(2)
  v_mfma_f32_32x32x16_bf16 v[40:55], v[64:67], v[140:143], 0
  ds_read_b128 v[148:151], v17 offset:0
  ds_read_b128 v[192:195], v21 offset:0
  buffer_store_dword v104, v61, s[60:63], s29 offen sc1
  s_add_u32 s29, s29, 16384
  buffer_store_dword v105, v61, s[60:63], s29 offen sc1
  ds_read_u16_d16_hi v185, v69 offset:0
  ds_read_u16_d16_hi v70, v69 offset:2
  s_waitcnt lgkmcnt(4)
  v_mfma_f32_32x32x16_bf16 v[72:87], v[64:67], v[144:147], 0
  ds_read_b128 v[188:191], v17 offset:4096
  ds_read_b128 v[196:199], v21 offset:4096
  s_add_u32 s29, s29, 16384
  buffer_store_dword v106, v61, s[60:63], s29 offen sc1
  v_mfma_f32_32x32x16_bf16 v[120:135], v[136:139], v[144:147], 0
  s_add_u32 s29, s29, 16384
  buffer_store_dword v107, v61, s[60:63], s29 offen sc1
  v_mfma_f32_32x32x16_bf16 v[88:103], v[136:139], v[140:143], 0
  s_add_u32 s29, s29, 16384
  buffer_store_dword v108, v61, s[60:63], s29 offen sc1
  s_waitcnt lgkmcnt(4)
  v_mfma_f32_32x32x16_bf16 v[40:55], v[148:151], v[192:195], v[40:55]
  ds_read_b128 v[64:67], v18 offset:0
  ds_read_b128 v[140:143], v22 offset:0
  s_add_u32 s29, s29, 16384
  buffer_store_dword v109, v61, s[60:63], s29 offen sc1
  s_waitcnt lgkmcnt(2)
  v_mfma_f32_32x32x16_bf16 v[72:87], v[148:151], v[196:199], v[72:87]
  ds_read_b128 v[136:139], v18 offset:4096
  ds_read_b128 v[144:147], v22 offset:4096
  s_add_u32 s29, s29, 16384
  buffer_store_dword v110, v61, s[60:63], s29 offen sc1
  v_mfma_f32_32x32x16_bf16 v[120:135], v[188:191], v[196:199], v[120:135]
  s_add_u32 s29, s29, 16384
  buffer_store_dword v111, v61, s[60:63], s29 offen sc1
  v_mfma_f32_32x32x16_bf16 v[88:103], v[188:191], v[192:195], v[88:103]
  s_add_u32 s29, s29, 16384
  buffer_store_dword v112, v61, s[60:63], s29 offen sc1
  v_mul_f32 v185, v185, v152
  v_mul_f32 v70, v70, v153
  s_waitcnt lgkmcnt(2)
  v_mfma_f32_32x32x16_bf16 v[40:55], v[64:67], v[140:143], v[40:55]
  ds_read_b128 v[148:151], v19 offset:0
  ds_read_b128 v[192:195], v23 offset:0
  s_add_u32 s29, s29, 16384
  buffer_store_dword v113, v61, s[60:63], s29 offen sc1
  s_add_u32 s29, s29, 16384
  s_waitcnt lgkmcnt(2)
  v_mfma_f32_32x32x16_bf16 v[72:87], v[64:67], v[144:147], v[72:87]
  ds_read_b128 v[188:191], v19 offset:4096
  ds_read_b128 v[196:199], v23 offset:4096
  buffer_store_dword v114, v61, s[60:63], s29 offen sc1
  s_add_u32 s29, s29, 16384
  v_cvt_pk_bf16_f32 v185, v185, v70
  v_mfma_f32_32x32x16_bf16 v[120:135], v[136:139], v[144:147], v[120:135]
  buffer_store_dword v115, v61, s[60:63], s29 offen sc1
  s_add_u32 s29, s29, 16384
  v_mfma_f32_32x32x16_bf16 v[88:103], v[136:139], v[140:143], v[88:103]
  buffer_store_dword v116, v61, s[60:63], s29 offen sc1
  s_add_u32 s29, s29, 16384
  s_waitcnt vmcnt(29) lgkmcnt(0)
  s_barrier
  v_mfma_f32_32x32x16_bf16 v[40:55], v[148:151], v[192:195], v[40:55]
  ds_read_b128 v[64:67], v16 offset:16384
  ds_read_b128 v[140:143], v20 offset:16384
  buffer_store_dword v117, v61, s[60:63], s29 offen sc1
  s_add_u32 s29, s29, 16384
  v_dot2c_f32_bf16 v184, s33, v185
  v_mfma_f32_32x32x16_bf16 v[72:87], v[148:151], v[196:199], v[72:87]
  ds_read_b128 v[136:139], v16 offset:20480
  ds_read_b128 v[144:147], v20 offset:20480
  buffer_store_dword v118, v61, s[60:63], s29 offen sc1
  s_add_u32 s29, s29, 16384
  v_mfma_f32_32x32x16_bf16 v[120:135], v[188:191], v[196:199], v[120:135]
  s_add_u32 m0, s54, 0
  s_nop 0
  buffer_load_dwordx4 v12, s[48:51], s43 offen offset:0  lds
  buffer_store_dword v119, v61, s[60:63], s29 offen sc1
  s_sub_u32 s29, 15, s38
  v_mfma_f32_32x32x16_bf16 v[88:103], v[188:191], v[192:195], v[88:103]
  buffer_load_dwordx4 v13, s[48:51], s43 offen offset:1024  lds
  s_lshl_b32 s29, s29, 9
  v_lshl_add_u32 v38, v0, 2, s29
  s_waitcnt lgkmcnt(2)
  v_mfma_f32_32x32x16_bf16 v[40:55], v[64:67], v[140:143], v[40:55]
  ds_read_b128 v[148:151], v17 offset:16384
  ds_read_b128 v[192:195], v21 offset:16384
  v_mov_b32 v39, -1
  s_cmp_ge_u32 s3, 2
  s_cbranch_scc1 gated_mix__spectral_gfnet__ssm_conv_s5__prompt_kernel_skip10
  buffer_store_dword v39, v38, s[68:71], 0 offen sc1
gated_mix__spectral_gfnet__ssm_conv_s5__prompt_kernel_skip10:
  ds_read_u16_d16_hi v185, v69 offset:16384
  ds_read_u16_d16_hi v70, v69 offset:16386
  s_waitcnt lgkmcnt(4)
  v_mfma_f32_32x32x16_bf16 v[72:87], v[64:67], v[144:147], v[72:87]
  ds_read_b128 v[188:191], v17 offset:20480
  ds_read_b128 v[196:199], v21 offset:20480
  v_mfma_f32_32x32x16_bf16 v[120:135], v[136:139], v[144:147], v[120:135]
  buffer_load_dwordx4 v14, s[48:51], s43 offen offset:2048  lds
  v_mfma_f32_32x32x16_bf16 v[88:103], v[136:139], v[140:143], v[88:103]
  buffer_load_dwordx4 v15, s[48:51], s43 offen offset:3072  lds
  s_waitcnt lgkmcnt(4)
  v_mfma_f32_32x32x16_bf16 v[40:55], v[148:151], v[192:195], v[40:55]
  ds_read_b128 v[64:67], v18 offset:16384
  ds_read_b128 v[140:143], v22 offset:16384
  s_cmp_lg_u32 s3, 0
  s_cbranch_scc1 gated_mix__spectral_gfnet__ssm_conv_s5__prompt_kernel_skip11
  s_mov_b64 exec, 65535
  buffer_store_dword v5, v57, s[16:19], s28 offen sc1
  s_mov_b64 exec, -1
gated_mix__spectral_gfnet__ssm_conv_s5__prompt_kernel_skip11:
  s_waitcnt lgkmcnt(2)
  v_mfma_f32_32x32x16_bf16 v[72:87], v[148:151], v[196:199], v[72:87]
  ds_read_b128 v[136:139], v18 offset:20480
  ds_read_b128 v[144:147], v22 offset:20480
  v_mfma_f32_32x32x16_bf16 v[120:135], v[188:191], v[196:199], v[120:135]
  s_add_u32 m0, s53, 0
  s_nop 0
  buffer_load_dwordx4 v8, s[44:47], s43 offen offset:0  lds
  v_mfma_f32_32x32x16_bf16 v[88:103], v[188:191], v[192:195], v[88:103]
  buffer_load_dwordx4 v9, s[44:47], s43 offen offset:1024  lds
  v_mul_f32 v185, v185, v154
  v_mul_f32 v70, v70, v155
  s_waitcnt lgkmcnt(2)
  v_mfma_f32_32x32x16_bf16 v[40:55], v[64:67], v[140:143], v[40:55]
  ds_read_b128 v[148:151], v19 offset:16384
  ds_read_b128 v[192:195], v23 offset:16384
  s_waitcnt lgkmcnt(2)
  v_mfma_f32_32x32x16_bf16 v[72:87], v[64:67], v[144:147], v[72:87]
  ds_read_b128 v[188:191], v19 offset:20480
  ds_read_b128 v[196:199], v23 offset:20480
  s_or_b32 s29, s3, s2
  v_cvt_pk_bf16_f32 v185, v185, v70
  v_mfma_f32_32x32x16_bf16 v[120:135], v[136:139], v[144:147], v[120:135]
  buffer_load_dwordx4 v10, s[44:47], s43 offen offset:2048  lds
  s_cmp_lg_u32 s29, 0
  s_cbranch_scc1 gated_mix__spectral_gfnet__ssm_conv_s5__prompt_kernel_skip12
  s_mov_b64 exec, 1
  buffer_store_dword v7, v5, s[64:67], 0 offen sc1
  s_mov_b64 exec, -1
gated_mix__spectral_gfnet__ssm_conv_s5__prompt_kernel_skip12:
  v_mfma_f32_32x32x16_bf16 v[88:103], v[136:139], v[140:143], v[88:103]
  buffer_load_dwordx4 v11, s[44:47], s43 offen offset:3072  lds
  s_add_u32 s43, s43, 128
  s_and_b32 s43, s43, 0x7ff
  s_waitcnt vmcnt(32) lgkmcnt(0)
  s_barrier
  v_mfma_f32_32x32x16_bf16 v[40:55], v[148:151], v[192:195], v[40:55]
  ds_read_b128 v[64:67], v16 offset:32768
  ds_read_b128 v[140:143], v20 offset:32768
  v_dot2c_f32_bf16 v184, s33, v185
  v_mfma_f32_32x32x16_bf16 v[72:87], v[148:151], v[196:199], v[72:87]
  ds_read_b128 v[136:139], v16 offset:36864
  ds_read_b128 v[144:147], v20 offset:36864
  v_mfma_f32_32x32x16_bf16 v[120:135], v[188:191], v[196:199], v[120:135]
  s_add_u32 m0, s54, 16384
  s_nop 0
  buffer_load_dwordx4 v12, s[48:51], s43 offen offset:0  lds
  v_mfma_f32_32x32x16_bf16 v[88:103], v[188:191], v[192:195], v[88:103]
  buffer_load_dwordx4 v13, s[48:51], s43 offen offset:1024  lds
  s_waitcnt lgkmcnt(2)
  v_mfma_f32_32x32x16_bf16 v[40:55], v[64:67], v[140:143], v[40:55]
  ds_read_b128 v[148:151], v17 offset:32768
  ds_read_b128 v[192:195], v21 offset:32768
  v_lshlrev_b32 v61, 4, v1
  v_add_u32 v61, 147456, v61
  ds_read_u16_d16_hi v185, v69 offset:32768
  ds_read_u16_d16_hi v70, v69 offset:32770
  s_waitcnt lgkmcnt(4)
  v_mfma_f32_32x32x16_bf16 v[72:87], v[64:67], v[144:147], v[72:87]
  ds_read_b128 v[188:191], v17 offset:36864
  ds_read_b128 v[196:199], v21 offset:36864
  ds_read_b128 v[104:107], v61 offset:0
  v_mfma_f32_32x32x16_bf16 v[120:135], v[136:139], v[144:147], v[120:135]
  buffer_load_dwordx4 v14, s[48:51], s43 offen offset:2048  lds
  ds_read_b128 v[108:111], v61 offset:1024
  v_mfma_f32_32x32x16_bf16 v[88:103], v[136:139], v[140:143], v[88:103]
  buffer_load_dwordx4 v15, s[48:51], s43 offen offset:3072  lds
  ds_read_b128 a[224:227], v61 offset:2048
  s_waitcnt lgkmcnt(7)
  v_mfma_f32_32x32x16_bf16 v[40:55], v[148:151], v[192:195], v[40:55]
  ds_read_b128 v[64:67], v18 offset:32768
  ds_read_b128 v[140:143], v22 offset:32768
  ds_read_b128 a[228:231], v61 offset:3072
  s_waitcnt lgkmcnt(6)
  v_mfma_f32_32x32x16_bf16 v[72:87], v[148:151], v[196:199], v[72:87]
  ds_read_b128 v[136:139], v18 offset:36864
  ds_read_b128 v[144:147], v22 offset:36864
  ds_read_b128 a[248:251], v61 offset:4096
  v_mfma_f32_32x32x16_bf16 v[120:135], v[188:191], v[196:199], v[120:135]
  s_add_u32 m0, s53, 16384
  s_nop 0
  buffer_load_dwordx4 v8, s[44:47], s43 offen offset:0  lds
  ds_read_b128 a[252:255], v61 offset:5120
  v_mfma_f32_32x32x16_bf16 v[88:103], v[188:191], v[192:195], v[88:103]
  buffer_load_dwordx4 v9, s[44:47], s43 offen offset:1024  lds
  ds_read_b128 a[232:235], v61 offset:6144
  v_mul_f32 v185, v185, v156
  v_mul_f32 v70, v70, v157
  s_waitcnt lgkmcnt(6)
  v_mfma_f32_32x32x16_bf16 v[40:55], v[64:67], v[140:143], v[40:55]
  ds_read_b128 v[148:151], v19 offset:32768
  ds_read_b128 v[192:195], v23 offset:32768
  ds_read_b128 a[236:239], v61 offset:7168
  s_waitcnt lgkmcnt(6)
  v_mfma_f32_32x32x16_bf16 v[72:87], v[64:67], v[144:147], v[72:87]
  ds_read_b128 v[188:191], v19 offset:36864
  ds_read_b128 v[196:199], v23 offset:36864
  ds_read_b128 v[112:115], v61 offset:8192
  v_cvt_pk_bf16_f32 v185, v185, v70
  v_mfma_f32_32x32x16_bf16 v[120:135], v[136:139], v[144:147], v[120:135]
  buffer_load_dwordx4 v10, s[44:47], s43 offen offset:2048  lds
  ds_read_b128 v[116:119], v61 offset:9216
  v_mfma_f32_32x32x16_bf16 v[88:103], v[136:139], v[140:143], v[88:103]
  buffer_load_dwordx4 v11, s[44:47], s43 offen offset:3072  lds
  s_add_u32 s43, s43, 128
  s_and_b32 s43, s43, 0x7ff
  ds_read_b128 v[200:203], v61 offset:10240
  s_waitcnt vmcnt(32) lgkmcnt(3)
  s_barrier
  v_mfma_f32_32x32x16_bf16 v[40:55], v[148:151], v[192:195], v[40:55]
  ds_read_b128 v[64:67], v16 offset:49152
  ds_read_b128 v[140:143], v20 offset:49152
  ds_read_b128 v[204:207], v61 offset:11264
  v_dot2c_f32_bf16 v184, s33, v185
  v_mfma_f32_32x32x16_bf16 v[72:87], v[148:151], v[196:199], v[72:87]
  ds_read_b128 v[136:139], v16 offset:53248
  ds_read_b128 v[144:147], v20 offset:53248
  ds_read_b128 a[240:243], v61 offset:12288
  v_mfma_f32_32x32x16_bf16 v[120:135], v[188:191], v[196:199], v[120:135]
  s_add_u32 m0, s54, 32768
  s_nop 0
  buffer_load_dwordx4 v12, s[48:51], s43 offen offset:0  lds
  ds_read_b128 a[244:247], v61 offset:13312
  v_mfma_f32_32x32x16_bf16 v[88:103], v[188:191], v[192:195], v[88:103]
  buffer_load_dwordx4 v13, s[48:51], s43 offen offset:1024  lds
  ds_read_b128 v[208:211], v61 offset:14336
  s_waitcnt lgkmcnt(6)
  v_mfma_f32_32x32x16_bf16 v[40:55], v[64:67], v[140:143], v[40:55]
  ds_read_b128 v[148:151], v17 offset:49152
  ds_read_b128 v[192:195], v21 offset:49152
  ds_read_b128 v[212:215], v61 offset:15360
  ds_read_u16_d16_hi v185, v69 offset:49152
  ds_read_u16_d16_hi v70, v69 offset:49154
  s_waitcnt lgkmcnt(8)
  v_mfma_f32_32x32x16_bf16 v[72:87], v[64:67], v[144:147], v[72:87]
  ds_read_b128 v[188:191], v17 offset:53248
  ds_read_b128 v[196:199], v21 offset:53248
  s_mov_b32 s12, s20
  v_mfma_f32_32x32x16_bf16 v[120:135], v[136:139], v[144:147], v[120:135]
  buffer_load_dwordx4 v14, s[48:51], s43 offen offset:2048  lds
  s_mov_b32 s13, s21
  v_mfma_f32_32x32x16_bf16 v[88:103], v[136:139], v[140:143], v[88:103]
  buffer_load_dwordx4 v15, s[48:51], s43 offen offset:3072  lds
  s_mov_b32 s14, 2097152
  s_waitcnt lgkmcnt(5)
  v_mfma_f32_32x32x16_bf16 v[40:55], v[148:151], v[192:195], v[40:55]
  ds_read_b128 v[64:67], v18 offset:49152
  ds_read_b128 v[140:143], v22 offset:49152
  s_mov_b32 s15, 0x20000
  s_waitcnt lgkmcnt(2)
  v_mfma_f32_32x32x16_bf16 v[72:87], v[148:151], v[196:199], v[72:87]
  ds_read_b128 v[136:139], v18 offset:53248
  ds_read_b128 v[144:147], v22 offset:53248
  s_mov_b32 s24, s22
  v_mfma_f32_32x32x16_bf16 v[120:135], v[188:191], v[196:199], v[120:135]
  s_add_u32 m0, s53, 32768
  s_nop 0
  buffer_load_dwordx4 v8, s[44:47], s43 offen offset:0  lds
  s_mov_b32 s25, s23
  v_mfma_f32_32x32x16_bf16 v[88:103], v[188:191], v[192:195], v[88:103]
  buffer_load_dwordx4 v9, s[44:47], s43 offen offset:1024  lds
  s_mov_b32 s26, 2097152
  v_mul_f32 v185, v185, v158
  v_mul_f32 v70, v70, v159
  s_waitcnt lgkmcnt(2)
  v_mfma_f32_32x32x16_bf16 v[40:55], v[64:67], v[140:143], v[40:55]
  ds_read_b128 v[148:151], v19 offset:49152
  ds_read_b128 v[192:195], v23 offset:49152
  s_mov_b32 s27, 0x20000
  s_waitcnt lgkmcnt(2)
  v_mfma_f32_32x32x16_bf16 v[72:87], v[64:67], v[144:147], v[72:87]
  ds_read_b128 v[188:191], v19 offset:53248
  ds_read_b128 v[196:199], v23 offset:53248
  v_and_b32 v38, 7, v1
  v_xor_b32 v38, v38, v3
  v_cvt_pk_bf16_f32 v185, v185, v70
  v_mfma_f32_32x32x16_bf16 v[120:135], v[136:139], v[144:147], v[120:135]
  buffer_load_dwordx4 v10, s[44:47], s43 offen offset:2048  lds
  v_and_b32 v39, 4, v38
  v_mfma_f32_32x32x16_bf16 v[88:103], v[136:139], v[140:143], v[88:103]
  buffer_load_dwordx4 v11, s[44:47], s43 offen offset:3072  lds
  s_add_u32 s43, s43, 128
  s_and_b32 s43, s43, 0x7ff
  v_lshlrev_b32 v216, 4, v39
  s_waitcnt vmcnt(16) lgkmcnt(0)
  s_barrier
  v_mfma_f32_32x32x16_bf16 v[40:55], v[148:151], v[192:195], v[40:55]
  ds_read_b128 v[64:67], v16 offset:0
  ds_read_b128 v[140:143], v20 offset:0
  v_and_b32 v39, 1, v38
  v_dot2c_f32_bf16 v184, s33, v185
  v_mfma_f32_32x32x16_bf16 v[72:87], v[148:151], v[196:199], v[72:87]
  ds_read_b128 v[136:139], v16 offset:4096
  ds_read_b128 v[144:147], v20 offset:4096
  v_lshl_or_b32 v216, v39, 5, v216
  v_mfma_f32_32x32x16_bf16 v[120:135], v[188:191], v[196:199], v[120:135]
  s_add_u32 m0, s54, 49152
  s_nop 0
  buffer_load_dwordx4 v12, s[48:51], s43 offen offset:0  lds
  v_and_b32 v39, 2, v38
  v_mfma_f32_32x32x16_bf16 v[88:103], v[188:191], v[192:195], v[88:103]
  buffer_load_dwordx4 v13, s[48:51], s43 offen offset:1024  lds
  v_lshl_or_b32 v216, v39, 3, v216
  s_waitcnt lgkmcnt(2)
  v_mfma_f32_32x32x16_bf16 v[40:55], v[64:67], v[140:143], v[40:55]
  ds_read_b128 v[148:151], v17 offset:0
  ds_read_b128 v[192:195], v21 offset:0
  v_lshrrev_b32 v39, 3, v1
  ds_read_u16_d16_hi v185, v69 offset:0
  ds_read_u16_d16_hi v70, v69 offset:2
  s_waitcnt lgkmcnt(4)
  v_mfma_f32_32x32x16_bf16 v[72:87], v[64:67], v[144:147], v[72:87]
  ds_read_b128 v[188:191], v17 offset:4096
  ds_read_b128 v[196:199], v21 offset:4096
  v_lshl_or_b32 v216, v39, 11, v216
  v_mfma_f32_32x32x16_bf16 v[120:135], v[136:139], v[144:147], v[120:135]
  buffer_load_dwordx4 v14, s[48:51], s43 offen offset:2048  lds
  s_lshl4_add_u32 s20, s3, s41
  v_mfma_f32_32x32x16_bf16 v[88:103], v[136:139], v[140:143], v[88:103]
  buffer_load_dwordx4 v15, s[48:51], s43 offen offset:3072  lds
  s_lshl_b32 s20, s20, 15
  s_waitcnt lgkmcnt(4)
  v_mfma_f32_32x32x16_bf16 v[40:55], v[148:151], v[192:195], v[40:55]
  ds_read_b128 v[64:67], v18 offset:0
  ds_read_b128 v[140:143], v22 offset:0
  s_lshr_b32 s29, s41, 3
  s_waitcnt lgkmcnt(2)
  v_mfma_f32_32x32x16_bf16 v[72:87], v[148:151], v[196:199], v[72:87]
  ds_read_b128 v[136:139], v18 offset:4096
  ds_read_b128 v[144:147], v22 offset:4096
  s_lshl_b32 s29, s29, 10
  v_mfma_f32_32x32x16_bf16 v[120:135], v[188:191], v[196:199], v[120:135]
  s_add_u32 m0, s53, 49152
  s_nop 0
  buffer_load_dwordx4 v8, s[44:47], s43 offen offset:0  lds
  s_add_u32 s20, s20, s29
  v_mfma_f32_32x32x16_bf16 v[88:103], v[188:191], v[192:195], v[88:103]
  buffer_load_dwordx4 v9, s[44:47], s43 offen offset:1024  lds
  v_add_u32 v216, s20, v216
  v_mul_f32 v185, v185, v160
  v_mul_f32 v70, v70, v161
  s_waitcnt lgkmcnt(2)
  v_mfma_f32_32x32x16_bf16 v[40:55], v[64:67], v[140:143], v[40:55]
  ds_read_b128 v[148:151], v19 offset:0
  ds_read_b128 v[192:195], v23 offset:0
  v_xor_b32 v218, 262144, v216
  s_waitcnt lgkmcnt(2)
  v_mfma_f32_32x32x16_bf16 v[72:87], v[64:67], v[144:147], v[72:87]
  ds_read_b128 v[188:191], v19 offset:4096
  ds_read_b128 v[196:199], v23 offset:4096
  v_xor_b32 v217, 64, v216
  v_cvt_pk_bf16_f32 v185, v185, v70
  v_mfma_f32_32x32x16_bf16 v[120:135], v[136:139], v[144:147], v[120:135]
  buffer_load_dwordx4 v10, s[44:47], s43 offen offset:2048  lds
  v_xor_b32 v219, 64, v218
  v_mfma_f32_32x32x16_bf16 v[88:103], v[136:139], v[140:143], v[88:103]
  buffer_load_dwordx4 v11, s[44:47], s43 offen offset:3072  lds
  s_add_u32 s43, s43, 128
  s_and_b32 s43, s43, 0x7ff
  v_add_u32 v217, 15360, v217
  s_waitcnt vmcnt(16) lgkmcnt(0)
  s_barrier
  v_mfma_f32_32x32x16_bf16 v[40:55], v[148:151], v[192:195], v[40:55]
  ds_read_b128 v[64:67], v16 offset:16384
  ds_read_b128 v[140:143], v20 offset:16384
  v_add_u32 v219, 15360, v219
  v_dot2c_f32_bf16 v184, s33, v185
  v_mfma_f32_32x32x16_bf16 v[72:87], v[148:151], v[196:199], v[72:87]
  ds_read_b128 v[136:139], v16 offset:20480
  ds_read_b128 v[144:147], v20 offset:20480
  s_and_b32 s29, s40, 7
  v_mfma_f32_32x32x16_bf16 v[120:135], v[188:191], v[196:199], v[120:135]
  s_add_u32 m0, s54, 0
  s_nop 0
  buffer_load_dwordx4 v12, s[48:51], s43 offen offset:0  lds
  s_lshl_b32 s29, s29, 7
  v_mfma_f32_32x32x16_bf16 v[88:103], v[188:191], v[192:195], v[88:103]
  buffer_load_dwordx4 v13, s[48:51], s43 offen offset:1024  lds
  s_lshl_b32 s32, s3, 12
  s_waitcnt lgkmcnt(2)
  v_mfma_f32_32x32x16_bf16 v[40:55], v[64:67], v[140:143], v[40:55]
  ds_read_b128 v[148:151], v17 offset:16384
  ds_read_b128 v[192:195], v21 offset:16384
  v_lshrrev_b32 v38, 1, v2
  ds_read_u16_d16_hi v185, v69 offset:16384
  ds_read_u16_d16_hi v70, v69 offset:16386
  s_waitcnt lgkmcnt(4)
  v_mfma_f32_32x32x16_bf16 v[72:87], v[64:67], v[144:147], v[72:87]
  ds_read_b128 v[188:191], v17 offset:20480
  ds_read_b128 v[196:199], v21 offset:20480
  v_xor_b32 v38, v38, v3
  v_mfma_f32_32x32x16_bf16 v[120:135], v[136:139], v[144:147], v[120:135]
  buffer_load_dwordx4 v14, s[48:51], s43 offen offset:2048  lds
  v_lshlrev_b32 v38, 4, v38
  v_mfma_f32_32x32x16_bf16 v[88:103], v[136:139], v[140:143], v[88:103]
  buffer_load_dwordx4 v15, s[48:51], s43 offen offset:3072  lds
  v_lshl_or_b32 v38, v2, 7, v38
  v_add_u32 v220, s32, v38
  s_waitcnt lgkmcnt(4)
  v_mfma_f32_32x32x16_bf16 v[40:55], v[148:151], v[192:195], v[40:55]
  ds_read_b128 v[64:67], v18 offset:16384
  ds_read_b128 v[140:143], v22 offset:16384
  v_xor_b32 v221, 64, v220
  s_branch gated_mix__spectral_gfnet__ssm_conv_s5__prompt_kernel_isk1
gated_mix__spectral_gfnet__ssm_conv_s5__prompt_kernel_isl1:
  s_branch gated_mix__spectral_gfnet__ssm_conv_s5__prompt_kernel_isl5
gated_mix__spectral_gfnet__ssm_conv_s5__prompt_kernel_isk1:
  s_waitcnt lgkmcnt(2)
  v_mfma_f32_32x32x16_bf16 v[72:87], v[148:151], v[196:199], v[72:87]
  ds_read_b128 v[136:139], v18 offset:20480
  ds_read_b128 v[144:147], v22 offset:20480
  v_add_u32 v222, 0x10000, v220
  v_mfma_f32_32x32x16_bf16 v[120:135], v[188:191], v[196:199], v[120:135]
  s_add_u32 m0, s53, 0
  s_nop 0
  buffer_load_dwordx4 v8, s[44:47], s43 offen offset:0  lds
  v_add_u32 v223, 0x10000, v221
  v_mfma_f32_32x32x16_bf16 v[88:103], v[188:191], v[192:195], v[88:103]
  buffer_load_dwordx4 v9, s[44:47], s43 offen offset:1024  lds
  s_mov_b32 s20, s6
  v_mul_f32 v185, v185, v162
  v_mul_f32 v70, v70, v163
  s_waitcnt lgkmcnt(2)
  v_mfma_f32_32x32x16_bf16 v[40:55], v[64:67], v[140:143], v[40:55]
  ds_read_b128 v[148:151], v19 offset:16384
  ds_read_b128 v[192:195], v23 offset:16384
  s_mov_b32 s21, s7
  s_waitcnt lgkmcnt(2)
  v_mfma_f32_32x32x16_bf16 v[72:87], v[64:67], v[144:147], v[72:87]
  ds_read_b128 v[188:191], v19 offset:20480
  ds_read_b128 v[196:199], v23 offset:20480
  s_mov_b32 s22, 2101248
  v_cvt_pk_bf16_f32 v185, v185, v70
  v_mfma_f32_32x32x16_bf16 v[120:135], v[136:139], v[144:147], v[120:135]
  buffer_load_dwordx4 v10, s[44:47], s43 offen offset:2048  lds
  s_mov_b32 s23, 0x20000
  v_mfma_f32_32x32x16_bf16 v[88:103], v[136:139], v[140:143], v[88:103]
  buffer_load_dwordx4 v11, s[44:47], s43 offen offset:3072  lds
  s_add_u32 s43, s43, 128
  s_and_b32 s43, s43, 0x7ff
  s_sub_u32 s56, s8, 1024
  s_subb_u32 s57, s9, 0
  s_waitcnt vmcnt(16) lgkmcnt(0)
  s_barrier
  v_mfma_f32_32x32x16_bf16 v[40:55], v[148:151], v[192:195], v[40:55]
  ds_read_b128 v[64:67], v16 offset:32768
  ds_read_b128 v[140:143], v20 offset:32768
  v_dot2c_f32_bf16 v184, s33, v185
  v_mfma_f32_32x32x16_bf16 v[72:87], v[148:151], v[196:199], v[72:87]
  ds_read_b128 v[136:139], v16 offset:36864
  ds_read_b128 v[144:147], v20 offset:36864
  buffer_load_dword v246, v5, s[64:67], 0 offen sc1
  s_mov_b32 s58, 2102272
  v_mfma_f32_32x32x16_bf16 v[120:135], v[188:191], v[196:199], v[120:135]
  s_add_u32 m0, s54, 16384
  s_nop 0
  buffer_load_dwordx4 v12, s[48:51], s43 offen offset:0  lds
  s_mov_b32 s59, 0x20000
  v_mfma_f32_32x32x16_bf16 v[88:103], v[188:191], v[192:195], v[88:103]
  buffer_load_dwordx4 v13, s[48:51], s43 offen offset:1024  lds
  s_lshl_b32 s6, s3, 9
  s_waitcnt lgkmcnt(2)
  v_mfma_f32_32x32x16_bf16 v[40:55], v[64:67], v[140:143], v[40:55]
  ds_read_b128 v[148:151], v17 offset:32768
  ds_read_b128 v[192:195], v21 offset:32768
  s_add_u32 s6, s6, s4
  ds_read_u16_d16_hi v185, v69 offset:32768
  ds_read_u16_d16_hi v70, v69 offset:32770
  s_waitcnt lgkmcnt(4)
  v_mfma_f32_32x32x16_bf16 v[72:87], v[64:67], v[144:147], v[72:87]
  ds_read_b128 v[188:191], v17 offset:36864
  ds_read_b128 v[196:199], v21 offset:36864
  s_lshr_b32 s78, s3, 1
  v_mfma_f32_32x32x16_bf16 v[120:135], v[136:139], v[144:147], v[120:135]
  buffer_load_dwordx4 v14, s[48:51], s43 offen offset:2048  lds
  s_and_b32 s78, s78, s5
  v_mfma_f32_32x32x16_bf16 v[88:103], v[136:139], v[140:143], v[88:103]
  buffer_load_dwordx4 v15, s[48:51], s43 offen offset:3072  lds
  s_mul_i32 s78, s78, 960
  s_waitcnt lgkmcnt(4)
  v_mfma_f32_32x32x16_bf16 v[40:55], v[148:151], v[192:195], v[40:55]
  ds_read_b128 v[64:67], v18 offset:32768
  ds_read_b128 v[140:143], v22 offset:32768
  s_sub_u32 s78, s6, s78
  s_waitcnt lgkmcnt(2)
  v_mfma_f32_32x32x16_bf16 v[72:87], v[148:151], v[196:199], v[72:87]
  ds_read_b128 v[136:139], v18 offset:36864
  ds_read_b128 v[144:147], v22 offset:36864
  s_mul_i32 s6, s78, 1026
  v_mfma_f32_32x32x16_bf16 v[120:135], v[188:191], v[196:199], v[120:135]
  s_add_u32 m0, s53, 16384
  s_nop 0
  buffer_load_dwordx4 v8, s[44:47], s43 offen offset:0  lds
  s_lshl1_add_u32 s6, s55, s6
  v_mfma_f32_32x32x16_bf16 v[88:103], v[188:191], v[192:195], v[88:103]
  buffer_load_dwordx4 v9, s[44:47], s43 offen offset:1024  lds
  s_sub_u32 s7, 2101256, s6
  v_mul_f32 v185, v185, v164
  v_mul_f32 v70, v70, v165
  s_waitcnt lgkmcnt(2)
  v_mfma_f32_32x32x16_bf16 v[40:55], v[64:67], v[140:143], v[40:55]
  ds_read_b128 v[148:151], v19 offset:32768
  ds_read_b128 v[192:195], v23 offset:32768
  s_and_b32 s79, s6, 2
  s_waitcnt lgkmcnt(2)
  v_mfma_f32_32x32x16_bf16 v[72:87], v[64:67], v[144:147], v[72:87]
  ds_read_b128 v[188:191], v19 offset:36864
  ds_read_b128 v[196:199], v23 offset:36864
  s_and_b32 s6, s6, -4
  v_cvt_pk_bf16_f32 v185, v185, v70
  v_mfma_f32_32x32x16_bf16 v[120:135], v[136:139], v[144:147], v[120:135]
  buffer_load_dwordx4 v10, s[44:47], s43 offen offset:2048  lds
  s_and_b32 s7, s7, -4
  v_mfma_f32_32x32x16_bf16 v[88:103], v[136:139], v[140:143], v[88:103]
  buffer_load_dwordx4 v11, s[44:47], s43 offen offset:3072  lds
  s_add_u32 s43, s43, 128
  s_and_b32 s43, s43, 0x7ff
  s_add_u32 s8, s6, 131328
  s_waitcnt vmcnt(17) lgkmcnt(0)
  s_barrier
  v_mfma_f32_32x32x16_bf16 v[40:55], v[148:151], v[192:195], v[40:55]
  ds_read_b128 v[64:67], v16 offset:49152
  ds_read_b128 v[140:143], v20 offset:49152
  s_sub_u32 s9, s7, 131328
  s_add_u32 s72, s6, 262656
  v_dot2c_f32_bf16 v184, s33, v185
  v_mfma_f32_32x32x16_bf16 v[72:87], v[148:151], v[196:199], v[72:87]
  ds_read_b128 v[136:139], v16 offset:53248
  ds_read_b128 v[144:147], v20 offset:53248
  s_sub_u32 s73, s7, 262656
  v_mfma_f32_32x32x16_bf16 v[120:135], v[188:191], v[196:199], v[120:135]
  s_add_u32 m0, s54, 32768
  s_nop 0
  buffer_load_dwordx4 v12, s[48:51], s43 offen offset:0  lds
  s_add_u32 s74, s6, 393984
  v_mfma_f32_32x32x16_bf16 v[88:103], v[188:191], v[192:195], v[88:103]
  buffer_load_dwordx4 v13, s[48:51], s43 offen offset:1024  lds
  s_sub_u32 s75, s7, 393984
  s_waitcnt lgkmcnt(2)
  v_mfma_f32_32x32x16_bf16 v[40:55], v[64:67], v[140:143], v[40:55]
  ds_read_b128 v[148:151], v17 offset:49152
  ds_read_b128 v[192:195], v21 offset:49152
  s_cmp_eq_u32 s78, 0
  s_cselect_b32 s78, 2101248, 0
  s_cselect_b32 s77, s5, 0
  ds_read_u16_d16_hi v185, v69 offset:49152
  ds_read_u16_d16_hi v70, v69 offset:49154
  s_waitcnt lgkmcnt(4)
  v_mfma_f32_32x32x16_bf16 v[72:87], v[64:67], v[144:147], v[72:87]
  ds_read_b128 v[188:191], v17 offset:53248
  ds_read_b128 v[196:199], v21 offset:53248
  v_mfma_f32_32x32x16_bf16 v[120:135], v[136:139], v[144:147], v[120:135]
  buffer_load_dwordx4 v14, s[48:51], s43 offen offset:2048  lds
  v_mfma_f32_32x32x16_bf16 v[88:103], v[136:139], v[140:143], v[88:103]
  buffer_load_dwordx4 v15, s[48:51], s43 offen offset:3072  lds
  s_sub_u32 s7, s7, s78
  s_waitcnt lgkmcnt(4)
  v_mfma_f32_32x32x16_bf16 v[40:55], v[148:151], v[192:195], v[40:55]
  ds_read_b128 v[64:67], v18 offset:49152
  ds_read_b128 v[140:143], v22 offset:49152
  s_lshl_b32 s76, s3, 12
  s_waitcnt lgkmcnt(2)
  v_mfma_f32_32x32x16_bf16 v[72:87], v[148:151], v[196:199], v[72:87]
  ds_read_b128 v[136:139], v18 offset:53248
  ds_read_b128 v[144:147], v22 offset:53248
  s_add_u32 s79, s79, s76
  v_mfma_f32_32x32x16_bf16 v[120:135], v[188:191], v[196:199], v[120:135]
  s_add_u32 m0, s53, 32768
  s_nop 0
  buffer_load_dwordx4 v8, s[44:47], s43 offen offset:0  lds
  v_lshlrev_b32 v61, 4, v1
  v_mfma_f32_32x32x16_bf16 v[88:103], v[188:191], v[192:195], v[88:103]
  buffer_load_dwordx4 v9, s[44:47], s43 offen offset:1024  lds
  v_lshlrev_b32 v38, 9, v3
  v_mul_f32 v185, v185, v166
  v_mul_f32 v70, v70, v167
  s_waitcnt lgkmcnt(2)
  v_mfma_f32_32x32x16_bf16 v[40:55], v[64:67], v[140:143], v[40:55]
  ds_read_b128 v[148:151], v19 offset:49152
  ds_read_b128 v[192:195], v23 offset:49152
  v_lshl_add_u32 v38, v2, 3, v38
  s_waitcnt lgkmcnt(2)
  v_mfma_f32_32x32x16_bf16 v[72:87], v[64:67], v[144:147], v[72:87]
  ds_read_b128 v[188:191], v19 offset:53248
  ds_read_b128 v[196:199], v23 offset:53248
  v_sub_u32 v225, 3704, v38
  v_cvt_pk_bf16_f32 v185, v185, v70
  v_mfma_f32_32x32x16_bf16 v[120:135], v[136:139], v[144:147], v[120:135]
  buffer_load_dwordx4 v10, s[44:47], s43 offen offset:2048  lds
  v_cmp_lt_u32 vcc, 1, v3
  v_mfma_f32_32x32x16_bf16 v[88:103], v[136:139], v[140:143], v[88:103]
  buffer_load_dwordx4 v11, s[44:47], s43 offen offset:3072  lds
  s_add_u32 s43, s43, 128
  s_and_b32 s43, s43, 0x7ff
  v_cndmask_b32 v38, v38, v225, vcc
  s_waitcnt vmcnt(17) lgkmcnt(0)
  s_barrier
  v_mfma_f32_32x32x16_bf16 v[40:55], v[148:151], v[192:195], v[40:55]
  ds_read_b128 v[64:67], v16 offset:0
  ds_read_b128 v[140:143], v20 offset:0
  v_cndmask_b32 v224, 1.0, -1.0, vcc
  v_dot2c_f32_bf16 v184, s33, v185
  v_mfma_f32_32x32x16_bf16 v[72:87], v[148:151], v[196:199], v[72:87]
  ds_read_b128 v[136:139], v16 offset:4096
  ds_read_b128 v[144:147], v20 offset:4096
  v_add_u32 v38, s79, v38
  v_mfma_f32_32x32x16_bf16 v[120:135], v[188:191], v[196:199], v[120:135]
  s_add_u32 m0, s54, 49152
  s_nop 0
  buffer_load_dwordx4 v12, s[48:51], s43 offen offset:0  lds
  v_mov_b32 v39, 1050624
  v_mfma_f32_32x32x16_bf16 v[88:103], v[188:191], v[192:195], v[88:103]
  buffer_load_dwordx4 v13, s[48:51], s43 offen offset:1024  lds
  v_mov_b32 v68, 147456
  s_waitcnt lgkmcnt(2)
  v_mfma_f32_32x32x16_bf16 v[40:55], v[64:67], v[140:143], v[40:55]
  ds_read_b128 v[148:151], v17 offset:0
  ds_read_b128 v[192:195], v21 offset:0
  s_cmp_lg_u32 s55, 0
  s_cbranch_scc1 gated_mix__spectral_gfnet__ssm_conv_s5__prompt_kernel_skip13
  s_sub_u32 s78, s7, 8
  v_writelane_b32 v39, s78, 0
  v_writelane_b32 v39, s6, 1
  s_mov_b32 s78, 0
  v_writelane_b32 v68, s78, 0
  v_writelane_b32 v68, s78, 1
  s_sub_u32 s78, s9, 8
  v_writelane_b32 v39, s78, 2
  v_writelane_b32 v39, s8, 3
  s_mov_b32 s78, 16384
  v_writelane_b32 v68, s78, 2
  v_writelane_b32 v68, s78, 3
  s_sub_u32 s78, s73, 8
  v_writelane_b32 v39, s78, 4
  v_writelane_b32 v39, s72, 5
  s_mov_b32 s78, 81920
  v_writelane_b32 v68, s78, 4
  v_writelane_b32 v68, s78, 5
  s_sub_u32 s78, s75, 8
  v_writelane_b32 v39, s78, 6
  v_writelane_b32 v39, s74, 7
  s_mov_b32 s78, 32768
  v_writelane_b32 v68, s78, 6
  v_writelane_b32 v68, s78, 7
  v_and_b32 v225, 1, v1
  v_lshl_add_u32 v39, v225, 10, v39
  s_and_b32 s78, s79, 2
  v_add_u32 v39, s78, v39
  v_mul_u32_u24 v225, 3064, v225
  v_add3_u32 v68, v68, v225, s79
gated_mix__spectral_gfnet__ssm_conv_s5__prompt_kernel_skip13:
  ds_read_u16_d16_hi v185, v69 offset:0
  ds_read_u16_d16_hi v70, v69 offset:2
  s_waitcnt lgkmcnt(4)
  v_mfma_f32_32x32x16_bf16 v[72:87], v[64:67], v[144:147], v[72:87]
  ds_read_b128 v[188:191], v17 offset:4096
  ds_read_b128 v[196:199], v21 offset:4096
  v_mfma_f32_32x32x16_bf16 v[120:135], v[136:139], v[144:147], v[120:135]
  buffer_load_dwordx4 v14, s[48:51], s43 offen offset:2048  lds
  v_mfma_f32_32x32x16_bf16 v[88:103], v[136:139], v[140:143], v[88:103]
  buffer_load_dwordx4 v15, s[48:51], s43 offen offset:3072  lds
  s_waitcnt lgkmcnt(4)
  v_mfma_f32_32x32x16_bf16 v[40:55], v[148:151], v[192:195], v[40:55]
  ds_read_b128 v[64:67], v18 offset:0
  ds_read_b128 v[140:143], v22 offset:0
  s_waitcnt lgkmcnt(2)
  v_mfma_f32_32x32x16_bf16 v[72:87], v[148:151], v[196:199], v[72:87]
  ds_read_b128 v[136:139], v18 offset:4096
  ds_read_b128 v[144:147], v22 offset:4096
  v_mfma_f32_32x32x16_bf16 v[120:135], v[188:191], v[196:199], v[120:135]
  s_add_u32 m0, s53, 49152
  s_nop 0
  buffer_load_dwordx4 v8, s[44:47], s43 offen offset:0  lds
  v_mfma_f32_32x32x16_bf16 v[88:103], v[188:191], v[192:195], v[88:103]
  buffer_load_dwordx4 v9, s[44:47], s43 offen offset:1024  lds
  v_mul_f32 v185, v185, v168
  v_mul_f32 v70, v70, v169
  s_waitcnt lgkmcnt(2)
  v_mfma_f32_32x32x16_bf16 v[40:55], v[64:67], v[140:143], v[40:55]
  ds_read_b128 v[148:151], v19 offset:0
  ds_read_b128 v[192:195], v23 offset:0
  s_waitcnt lgkmcnt(2)
  v_mfma_f32_32x32x16_bf16 v[72:87], v[64:67], v[144:147], v[72:87]
  ds_read_b128 v[188:191], v19 offset:4096
  ds_read_b128 v[196:199], v23 offset:4096
  v_cvt_pk_bf16_f32 v185, v185, v70
  v_mfma_f32_32x32x16_bf16 v[120:135], v[136:139], v[144:147], v[120:135]
  buffer_load_dwordx4 v10, s[44:47], s43 offen offset:2048  lds
  v_mfma_f32_32x32x16_bf16 v[88:103], v[136:139], v[140:143], v[88:103]
  buffer_load_dwordx4 v11, s[44:47], s43 offen offset:3072  lds
  s_add_u32 s43, s43, 128
  s_and_b32 s43, s43, 0x7ff
  s_waitcnt vmcnt(16) lgkmcnt(0)
  s_barrier
  v_mfma_f32_32x32x16_bf16 v[40:55], v[148:151], v[192:195], v[40:55]
  ds_read_b128 v[64:67], v16 offset:16384
  ds_read_b128 v[140:143], v20 offset:16384
  v_dot2c_f32_bf16 v184, s33, v185
  v_mfma_f32_32x32x16_bf16 v[72:87], v[148:151], v[196:199], v[72:87]
  ds_read_b128 v[136:139], v16 offset:20480
  ds_read_b128 v[144:147], v20 offset:20480
  v_cmp_ne_u32 vcc, 1, v246
  s_nop 0
  s_cbranch_vccz gated_mix__spectral_gfnet__ssm_conv_s5__prompt_kernel_skip14
  s_mov_b32 s94, 0
gated_mix__spectral_gfnet__ssm_conv_s5__prompt_kernel_poll15:
  s_sleep 16
  buffer_load_dword v246, v5, s[64:67], 0 offen sc1
  s_waitcnt vmcnt(0)
  v_cmp_ne_u32 vcc, 1, v246
  s_nop 0
  s_cbranch_vccz gated_mix__spectral_gfnet__ssm_conv_s5__prompt_kernel_pollout16
  s_add_u32 s94, s94, 1
  s_cmp_lt_u32 s94, 1048576
  s_cbranch_scc1 gated_mix__spectral_gfnet__ssm_conv_s5__prompt_kernel_poll15
gated_mix__spectral_gfnet__ssm_conv_s5__prompt_kernel_pollout16:
gated_mix__spectral_gfnet__ssm_conv_s5__prompt_kernel_skip14:
  s_cmp_lg_u32 s3, 0
  s_cbranch_scc1 gated_mix__spectral_gfnet__ssm_conv_s5__prompt_kernel_skip17
  s_mov_b64 exec, 1
  buffer_store_dword v7, v56, s[16:19], 0 offen sc1
  s_mov_b64 exec, -1
gated_mix__spectral_gfnet__ssm_conv_s5__prompt_kernel_skip17:
  v_mfma_f32_32x32x16_bf16 v[120:135], v[188:191], v[196:199], v[120:135]
  s_add_u32 m0, s54, 0
  s_nop 0
  buffer_load_dwordx4 v12, s[48:51], s43 offen offset:0  lds
  v_mfma_f32_32x32x16_bf16 v[88:103], v[188:191], v[192:195], v[88:103]
  buffer_load_dwordx4 v13, s[48:51], s43 offen offset:1024  lds
  s_waitcnt lgkmcnt(2)
  v_mfma_f32_32x32x16_bf16 v[40:55], v[64:67], v[140:143], v[40:55]
  ds_read_b128 v[148:151], v17 offset:16384
  ds_read_b128 v[192:195], v21 offset:16384
  ds_read_u16_d16_hi v185, v69 offset:16384
  ds_read_u16_d16_hi v70, v69 offset:16386
  s_waitcnt lgkmcnt(4)
  v_mfma_f32_32x32x16_bf16 v[72:87], v[64:67], v[144:147], v[72:87]
  ds_read_b128 v[188:191], v17 offset:20480
  ds_read_b128 v[196:199], v21 offset:20480
  v_mfma_f32_32x32x16_bf16 v[120:135], v[136:139], v[144:147], v[120:135]
  buffer_load_dwordx4 v14, s[48:51], s43 offen offset:2048  lds
  v_mfma_f32_32x32x16_bf16 v[88:103], v[136:139], v[140:143], v[88:103]
  buffer_load_dwordx4 v15, s[48:51], s43 offen offset:3072  lds
  s_waitcnt lgkmcnt(4)
  v_mfma_f32_32x32x16_bf16 v[40:55], v[148:151], v[192:195], v[40:55]
  ds_read_b128 v[64:67], v18 offset:16384
  ds_read_b128 v[140:143], v22 offset:16384
  s_waitcnt lgkmcnt(2)
  v_mfma_f32_32x32x16_bf16 v[72:87], v[148:151], v[196:199], v[72:87]
  ds_read_b128 v[136:139], v18 offset:20480
  ds_read_b128 v[144:147], v22 offset:20480
  v_mfma_f32_32x32x16_bf16 v[120:135], v[188:191], v[196:199], v[120:135]
  s_add_u32 m0, s53, 0
  s_nop 0
  buffer_load_dwordx4 v8, s[44:47], s43 offen offset:0  lds
  v_mfma_f32_32x32x16_bf16 v[88:103], v[188:191], v[192:195], v[88:103]
  buffer_load_dwordx4 v9, s[44:47], s43 offen offset:1024  lds
  v_mul_f32 v185, v185, v170
  v_mul_f32 v70, v70, v171
  s_waitcnt lgkmcnt(2)
  v_mfma_f32_32x32x16_bf16 v[40:55], v[64:67], v[140:143], v[40:55]
  ds_read_b128 v[148:151], v19 offset:16384
  ds_read_b128 v[192:195], v23 offset:16384
  s_waitcnt lgkmcnt(2)
  v_mfma_f32_32x32x16_bf16 v[72:87], v[64:67], v[144:147], v[72:87]
  ds_read_b128 v[188:191], v19 offset:20480
  ds_read_b128 v[196:199], v23 offset:20480
  v_cvt_pk_bf16_f32 v185, v185, v70
  v_mfma_f32_32x32x16_bf16 v[120:135], v[136:139], v[144:147], v[120:135]
  buffer_load_dwordx4 v10, s[44:47], s43 offen offset:2048  lds
  v_mfma_f32_32x32x16_bf16 v[88:103], v[136:139], v[140:143], v[88:103]
  buffer_load_dwordx4 v11, s[44:47], s43 offen offset:3072  lds
  s_add_u32 s43, s43, 128
  s_and_b32 s43, s43, 0x7ff
  s_waitcnt vmcnt(16) lgkmcnt(0)
  s_barrier
  v_mfma_f32_32x32x16_bf16 v[40:55], v[148:151], v[192:195], v[40:55]
  ds_read_b128 v[64:67], v16 offset:32768
  ds_read_b128 v[140:143], v20 offset:32768
  v_dot2c_f32_bf16 v184, s33, v185
  v_mfma_f32_32x32x16_bf16 v[72:87], v[148:151], v[196:199], v[72:87]
  ds_read_b128 v[136:139], v16 offset:36864
  ds_read_b128 v[144:147], v20 offset:36864
  v_mfma_f32_32x32x16_bf16 v[120:135], v[188:191], v[196:199], v[120:135]
  s_add_u32 m0, s54, 16384
  s_nop 0
  buffer_load_dwordx4 v12, s[48:51], s43 offen offset:0  lds
  v_mfma_f32_32x32x16_bf16 v[88:103], v[188:191], v[192:195], v[88:103]
  buffer_load_dwordx4 v13, s[48:51], s43 offen offset:1024  lds
  s_waitcnt lgkmcnt(2)
  v_mfma_f32_32x32x16_bf16 v[40:55], v[64:67], v[140:143], v[40:55]
  ds_read_b128 v[148:151], v17 offset:32768
  ds_read_b128 v[192:195], v21 offset:32768
  v_lshlrev_b32 v58, 16, v58
  v_lshlrev_b32 v59, 16, v59
  ds_read_u16_d16_hi v185, v69 offset:32768
  ds_read_u16_d16_hi v70, v69 offset:32770
  s_waitcnt lgkmcnt(4)
  v_mfma_f32_32x32x16_bf16 v[72:87], v[64:67], v[144:147], v[72:87]
  ds_read_b128 v[188:191], v17 offset:36864
  ds_read_b128 v[196:199], v21 offset:36864
  v_lshlrev_b32 v60, 16, v60
  v_mul_f32 v60, 0x3fb8aa3b, v60
  v_mfma_f32_32x32x16_bf16 v[120:135], v[136:139], v[144:147], v[120:135]
  buffer_load_dwordx4 v14, s[48:51], s43 offen offset:2048  lds
  v_exp_f32 v60, v60
  s_nop 0
  v_cvt_pk_bf16_f32 v60, v60, v60
  v_mfma_f32_32x32x16_bf16 v[88:103], v[136:139], v[140:143], v[88:103]
  buffer_load_dwordx4 v15, s[48:51], s43 offen offset:3072  lds
  v_and_b32 v60, 0xffff0000, v60
  v_mul_f32 v240, v60, v58
  s_waitcnt lgkmcnt(4)
  v_mfma_f32_32x32x16_bf16 v[40:55], v[148:151], v[192:195], v[40:55]
  ds_read_b128 v[64:67], v18 offset:32768
  ds_read_b128 v[140:143], v22 offset:32768
  v_mul_f32 v241, v60, v59
  s_waitcnt lgkmcnt(2)
  v_mfma_f32_32x32x16_bf16 v[72:87], v[148:151], v[196:199], v[72:87]
  ds_read_b128 v[136:139], v18 offset:36864
  ds_read_b128 v[144:147], v22 offset:36864
  v_mul_f32 v240, 0x3fb8aa3b, v240
  v_mul_f32 v241, 0.15915494, v241
  v_mfma_f32_32x32x16_bf16 v[120:135], v[188:191], v[196:199], v[120:135]
  s_add_u32 m0, s53, 16384
  s_nop 0
  buffer_load_dwordx4 v8, s[44:47], s43 offen offset:0  lds
  v_exp_f32 v240, v240
  v_rndne_f32 v242, v241
  v_mfma_f32_32x32x16_bf16 v[88:103], v[188:191], v[192:195], v[88:103]
  buffer_load_dwordx4 v9, s[44:47], s43 offen offset:1024  lds
  v_sub_f32 v241, v241, v242
  v_cos_f32 v242, v241
  v_mul_f32 v185, v185, v172
  v_mul_f32 v70, v70, v173
  s_waitcnt lgkmcnt(2)
  v_mfma_f32_32x32x16_bf16 v[40:55], v[64:67], v[140:143], v[40:55]
  ds_read_b128 v[148:151], v19 offset:32768
  ds_read_b128 v[192:195], v23 offset:32768
  v_sin_f32 v243, v241
  v_mul_f32 v226, v240, v242
  s_waitcnt lgkmcnt(2)
  v_mfma_f32_32x32x16_bf16 v[72:87], v[64:67], v[144:147], v[72:87]
  ds_read_b128 v[188:191], v19 offset:36864
  ds_read_b128 v[196:199], v23 offset:36864
  v_mul_f32 v227, v240, v243
  v_cvt_pk_bf16_f32 v185, v185, v70
  v_mfma_f32_32x32x16_bf16 v[120:135], v[136:139], v[144:147], v[120:135]
  buffer_load_dwordx4 v10, s[44:47], s43 offen offset:2048  lds
  v_mul_f32 v240, v58, v58
  v_fma_f32 v240, v59, v59, v240
  v_mfma_f32_32x32x16_bf16 v[88:103], v[136:139], v[140:143], v[88:103]
  buffer_load_dwordx4 v11, s[44:47], s43 offen offset:3072  lds
  s_add_u32 s43, s43, 128
  s_and_b32 s43, s43, 0x7ff
  v_rcp_f32 v240, v240
  v_add_f32 v241, -1.0, v226
  s_waitcnt vmcnt(16) lgkmcnt(0)
  s_barrier
  v_mfma_f32_32x32x16_bf16 v[40:55], v[148:151], v[192:195], v[40:55]
  ds_read_b128 v[64:67], v16 offset:49152
  ds_read_b128 v[140:143], v20 offset:49152
  v_add_f32 v240, v240, v240
  v_mul_f32 v242, v241, v58
  v_dot2c_f32_bf16 v184, s33, v185
  v_mfma_f32_32x32x16_bf16 v[72:87], v[148:151], v[196:199], v[72:87]
  ds_read_b128 v[136:139], v16 offset:53248
  ds_read_b128 v[144:147], v20 offset:53248
  s_lshl_b32 s94, s36, 2
  s_add_u32 s94, s94, s3
  s_lshl_b32 s94, s94, 7
  s_add_u32 s94, s94, s37
  s_sub_u32 s95, 2048, s94
  s_and_b32 s95, s95, 2047
  s_mul_i32 s94, s94, 1026
  s_mul_i32 s95, s95, 1026
  s_sub_u32 s95, s95, s94
  v_and_b32 v248, 1, v3
  v_mul_lo_u32 v248, v248, s95
  v_lshl_add_u32 v246, v2, 7, s94
  v_add_u32 v246, v246, v248
  v_and_b32 v246, -4, v246
  s_mov_b64 exec, 0x01ff01ff
  buffer_load_dword v4, v246, s[20:23], 0 offen
  buffer_load_dword v4, v246, s[56:59], 0 offen offset:1024
  s_mov_b64 exec, -1
  v_fma_f32 v242, v227, v59, v242
  v_mul_f32 v243, v227, v58
  v_mfma_f32_32x32x16_bf16 v[120:135], v[188:191], v[196:199], v[120:135]
  s_add_u32 m0, s54, 32768
  s_nop 0
  buffer_load_dwordx4 v12, s[48:51], s43 offen offset:0  lds
  v_fma_f32 v243, -v241, v59, v243
  v_mfma_f32_32x32x16_bf16 v[88:103], v[188:191], v[192:195], v[88:103]
  buffer_load_dwordx4 v13, s[48:51], s43 offen offset:1024  lds
  v_mul_f32 v236, v242, v240
  v_mul_f32 v237, v243, v240
  s_waitcnt lgkmcnt(2)
  v_mfma_f32_32x32x16_bf16 v[40:55], v[64:67], v[140:143], v[40:55]
  ds_read_b128 v[148:151], v17 offset:49152
  ds_read_b128 v[192:195], v21 offset:49152
  v_mul_f32 v240, v227, v227
  v_mul_f32 v229, v226, v227
  ds_read_u16_d16_hi v185, v69 offset:49152
  ds_read_u16_d16_hi v70, v69 offset:49154
  s_waitcnt lgkmcnt(4)
  v_mfma_f32_32x32x16_bf16 v[72:87], v[64:67], v[144:147], v[72:87]
  ds_read_b128 v[188:191], v17 offset:53248
  ds_read_b128 v[196:199], v21 offset:53248
  v_fma_f32 v228, v226, v226, -v240
  v_add_f32 v229, v229, v229
  v_mfma_f32_32x32x16_bf16 v[120:135], v[136:139], v[144:147], v[120:135]
  buffer_load_dwordx4 v14, s[48:51], s43 offen offset:2048  lds
  v_mul_f32 v240, v229, v229
  v_mfma_f32_32x32x16_bf16 v[88:103], v[136:139], v[140:143], v[88:103]
  buffer_load_dwordx4 v15, s[48:51], s43 offen offset:3072  lds
  v_mul_f32 v229, v228, v229
  v_fma_f32 v228, v228, v228, -v240
  s_waitcnt lgkmcnt(4)
  v_mfma_f32_32x32x16_bf16 v[40:55], v[148:151], v[192:195], v[40:55]
  ds_read_b128 v[64:67], v18 offset:49152
  ds_read_b128 v[140:143], v22 offset:49152
  v_add_f32 v229, v229, v229
  v_mul_f32 v240, v229, v229
  s_waitcnt lgkmcnt(2)
  v_mfma_f32_32x32x16_bf16 v[72:87], v[148:151], v[196:199], v[72:87]
  ds_read_b128 v[136:139], v18 offset:53248
  ds_read_b128 v[144:147], v22 offset:53248
  v_mul_f32 v229, v228, v229
  v_fma_f32 v228, v228, v228, -v240
  v_mfma_f32_32x32x16_bf16 v[120:135], v[188:191], v[196:199], v[120:135]
  s_add_u32 m0, s53, 32768
  s_nop 0
  buffer_load_dwordx4 v8, s[44:47], s43 offen offset:0  lds
  v_add_f32 v229, v229, v229
  v_mul_f32 v240, v229, v229
  v_mfma_f32_32x32x16_bf16 v[88:103], v[188:191], v[192:195], v[88:103]
  buffer_load_dwordx4 v9, s[44:47], s43 offen offset:1024  lds
  v_mul_f32 v229, v228, v229
  v_mul_f32 v185, v185, v174
  v_mul_f32 v70, v70, v175
  s_waitcnt lgkmcnt(2)
  v_mfma_f32_32x32x16_bf16 v[40:55], v[64:67], v[140:143], v[40:55]
  ds_read_b128 v[148:151], v19 offset:49152
  ds_read_b128 v[192:195], v23 offset:49152
  v_fma_f32 v228, v228, v228, -v240
  v_add_f32 v229, v229, v229
  s_waitcnt lgkmcnt(2)
  v_mfma_f32_32x32x16_bf16 v[72:87], v[64:67], v[144:147], v[72:87]
  ds_read_b128 v[188:191], v19 offset:53248
  ds_read_b128 v[196:199], v23 offset:53248
  v_mul_f32 v240, v229, v229
  v_mul_f32 v231, v228, v229
  v_cvt_pk_bf16_f32 v185, v185, v70
  v_mfma_f32_32x32x16_bf16 v[120:135], v[136:139], v[144:147], v[120:135]
  buffer_load_dwordx4 v10, s[44:47], s43 offen offset:2048  lds
  v_fma_f32 v230, v228, v228, -v240
  v_add_f32 v231, v231, v231
  v_mfma_f32_32x32x16_bf16 v[88:103], v[136:139], v[140:143], v[88:103]
  buffer_load_dwordx4 v11, s[44:47], s43 offen offset:3072  lds
  s_add_u32 s43, s43, 128
  s_and_b32 s43, s43, 0x7ff
  v_mul_f32 v240, v231, v231
  v_mul_f32 v233, v230, v231
  s_waitcnt vmcnt(18) lgkmcnt(0)
  s_barrier
  v_mfma_f32_32x32x16_bf16 v[40:55], v[148:151], v[192:195], v[40:55]
  ds_read_b128 v[64:67], v16 offset:0
  ds_read_b128 v[140:143], v20 offset:0
  v_fma_f32 v232, v230, v230, -v240
  v_dot2c_f32_bf16 v184, s33, v185
  v_mfma_f32_32x32x16_bf16 v[72:87], v[148:151], v[196:199], v[72:87]
  ds_read_b128 v[136:139], v16 offset:4096
  ds_read_b128 v[144:147], v20 offset:4096
  s_cmp_lg_u32 s3, 2
  s_cbranch_scc1 gated_mix__spectral_gfnet__ssm_conv_s5__prompt_kernel_skip19
  s_getpc_b64 s[94:95]
gated_mix__spectral_gfnet__ssm_conv_s5__prompt_kernel_pc18:
  s_lshr_b32 s96, s2, 3
  s_mul_i32 s96, s96, 512
  v_min_u32 v248, 3, v1
  v_lshl_add_u32 v248, v248, 7, s96
  v_min_u32 v248, gated_mix__spectral_gfnet__ssm_conv_s5__prompt_kernel_end-gated_mix__spectral_gfnet__ssm_conv_s5__prompt_kernel_pc18, v248
  v_mov_b32 v249, 0
  v_lshl_add_u64 v[248:249], v[248:249], 0, s[94:95]
  global_load_dword v4, v[248:249], off
gated_mix__spectral_gfnet__ssm_conv_s5__prompt_kernel_skip19:
  v_add_f32 v233, v233, v233
  v_mul_f32 v240, v233, v233
  v_mfma_f32_32x32x16_bf16 v[120:135], v[188:191], v[196:199], v[120:135]
  s_add_u32 m0, s54, 49152
  s_nop 0
  buffer_load_dwordx4 v12, s[48:51], s43 offen offset:0  lds
  v_mul_f32 v239, v232, v233
  v_fma_f32 v238, v232, v232, -v240
  v_mfma_f32_32x32x16_bf16 v[88:103], v[188:191], v[192:195], v[88:103]
  buffer_load_dwordx4 v13, s[48:51], s43 offen offset:1024  lds
  v_add_f32 v239, v239, v239
  v_mul_f32 v240, v239, v239
  s_waitcnt lgkmcnt(2)
  v_mfma_f32_32x32x16_bf16 v[40:55], v[64:67], v[140:143], v[40:55]
  ds_read_b128 v[148:151], v17 offset:0
  ds_read_b128 v[192:195], v21 offset:0
  v_mul_f32 v235, v238, v239
  ds_read_u16_d16_hi v185, v69 offset:0
  ds_read_u16_d16_hi v70, v69 offset:2
  s_waitcnt lgkmcnt(4)
  v_mfma_f32_32x32x16_bf16 v[72:87], v[64:67], v[144:147], v[72:87]
  ds_read_b128 v[188:191], v17 offset:4096
  ds_read_b128 v[196:199], v21 offset:4096
  v_fma_f32 v234, v238, v238, -v240
  v_add_f32 v235, v235, v235
  v_mfma_f32_32x32x16_bf16 v[120:135], v[136:139], v[144:147], v[120:135]
  buffer_load_dwordx4 v14, s[48:51], s43 offen offset:2048  lds
  v_mul_f32 v240, v235, v235
  v_mul_f32 v235, v234, v235
  v_mfma_f32_32x32x16_bf16 v[88:103], v[136:139], v[140:143], v[88:103]
  buffer_load_dwordx4 v15, s[48:51], s43 offen offset:3072  lds
  v_fma_f32 v234, v234, v234, -v240
  v_add_f32 v235, v235, v235
  s_waitcnt lgkmcnt(4)
  v_mfma_f32_32x32x16_bf16 v[40:55], v[148:151], v[192:195], v[40:55]
  ds_read_b128 v[64:67], v18 offset:0
  ds_read_b128 v[140:143], v22 offset:0
  v_mul_f32 v240, v235, v235
  v_mul_f32 v235, v234, v235
  s_waitcnt lgkmcnt(2)
  v_mfma_f32_32x32x16_bf16 v[72:87], v[148:151], v[196:199], v[72:87]
  ds_read_b128 v[136:139], v18 offset:4096
  ds_read_b128 v[144:147], v22 offset:4096
  s_branch gated_mix__spectral_gfnet__ssm_conv_s5__prompt_kernel_isk2
gated_mix__spectral_gfnet__ssm_conv_s5__prompt_kernel_isl2:
  s_branch gated_mix__spectral_gfnet__ssm_conv_s5__prompt_kernel_isl6
gated_mix__spectral_gfnet__ssm_conv_s5__prompt_kernel_isk2:
  v_fma_f32 v234, v234, v234, -v240
  v_mfma_f32_32x32x16_bf16 v[120:135], v[188:191], v[196:199], v[120:135]
  s_add_u32 m0, s53, 49152
  s_nop 0
  buffer_load_dwordx4 v8, s[44:47], s43 offen offset:0  lds
  v_add_f32 v235, v235, v235
  v_and_b32 v58, 1, v2
  v_mfma_f32_32x32x16_bf16 v[88:103], v[188:191], v[192:195], v[88:103]
  buffer_load_dwordx4 v9, s[44:47], s43 offen offset:1024  lds
  v_lshlrev_b32 v58, 4, v58
  v_xor_b32 v58, 16, v58
  v_mul_f32 v185, v185, v176
  v_mul_f32 v70, v70, v177
  s_waitcnt lgkmcnt(2)
  v_mfma_f32_32x32x16_bf16 v[40:55], v[64:67], v[140:143], v[40:55]
  ds_read_b128 v[148:151], v19 offset:0
  ds_read_b128 v[192:195], v23 offset:0
  v_lshrrev_b32 v58, v58, v62
  v_lshrrev_b32 v59, 1, v2
  s_waitcnt lgkmcnt(2)
  v_mfma_f32_32x32x16_bf16 v[72:87], v[64:67], v[144:147], v[72:87]
  ds_read_b128 v[188:191], v19 offset:4096
  ds_read_b128 v[196:199], v23 offset:4096
  v_lshlrev_b32 v63, 1, v3
  v_sub_u32 v59, v59, v63
  v_cvt_pk_bf16_f32 v185, v185, v70
  v_mfma_f32_32x32x16_bf16 v[120:135], v[136:139], v[144:147], v[120:135]
  buffer_load_dwordx4 v10, s[44:47], s43 offen offset:2048  lds
  v_cmp_eq_u32 vcc, 0, v59
  v_mfma_f32_32x32x16_bf16 v[88:103], v[136:139], v[140:143], v[88:103]
  buffer_load_dwordx4 v11, s[44:47], s43 offen offset:3072  lds
  s_add_u32 s43, s43, 128
  s_and_b32 s43, s43, 0x7ff
  v_cndmask_b32 v62, 0, v58, vcc
  v_cmp_eq_u32 vcc, 1, v59
  s_waitcnt vmcnt(18) lgkmcnt(0)
  s_barrier
  v_mfma_f32_32x32x16_bf16 v[40:55], v[148:151], v[192:195], v[40:55]
  ds_read_b128 v[64:67], v16 offset:16384
  ds_read_b128 v[140:143], v20 offset:16384
  v_cndmask_b32 v63, 0, v58, vcc
  v_lshlrev_b32 v60, 3, v0
  v_dot2c_f32_bf16 v184, s33, v185
  v_mfma_f32_32x32x16_bf16 v[72:87], v[148:151], v[196:199], v[72:87]
  ds_read_b128 v[136:139], v16 offset:20480
  ds_read_b128 v[144:147], v20 offset:20480
  v_add_u32 v60, 151552, v60
  s_sub_u32 s78, 15, s38
  v_mfma_f32_32x32x16_bf16 v[120:135], v[188:191], v[196:199], v[120:135]
  buffer_load_dword v247, v6, s[16:19], 0 offen sc1
  s_cmp_eq_u32 s77, 0
  s_cbranch_scc1 gated_mix__spectral_gfnet__ssm_conv_s5__prompt_kernel_skip20
  s_add_u32 s94, s6, 1050624
  s_mov_b32 m0, 147456
  s_nop 0
  buffer_load_dwordx4 v61, s[20:23], s94 offen lds
  buffer_load_dwordx4 v61, s[56:59], s94 offen offset:1024 lds
  s_add_u32 s94, s7, 1050624
  s_mov_b32 m0, 149504
  s_nop 0
  buffer_load_dwordx4 v61, s[20:23], s94 offen lds
  buffer_load_dwordx4 v61, s[56:59], s94 offen offset:1024 lds
gated_mix__spectral_gfnet__ssm_conv_s5__prompt_kernel_skip20:
  s_cmp_lg_u32 s55, 0
  s_cbranch_scc1 gated_mix__spectral_gfnet__ssm_conv_s5__prompt_kernel_skip21
  s_mov_b64 exec, 0x3ff
  buffer_load_short_d16_hi v248, v39, s[20:23], 0 offen
  buffer_load_short_d16_hi v249, v39, s[56:59], 0 offen offset:1024
  s_mov_b64 exec, -1
gated_mix__spectral_gfnet__ssm_conv_s5__prompt_kernel_skip21:
  s_lshl_b32 s78, s78, 9
  s_and_b32 s79, s3, 1
  v_mfma_f32_32x32x16_bf16 v[88:103], v[188:191], v[192:195], v[88:103]
  s_add_u32 m0, s32, 131072
  s_nop 0
  buffer_load_dwordx4 v216, s[12:15], s29 offen offset:0 lds
  s_lshl_b32 s79, s79, 8
  s_waitcnt lgkmcnt(2)
  v_mfma_f32_32x32x16_bf16 v[40:55], v[64:67], v[140:143], v[40:55]
  ds_read_b128 v[148:151], v17 offset:16384
  ds_read_b128 v[192:195], v21 offset:16384
  s_add_u32 s78, s78, s79
  v_and_b32 v71, 31, v1
  ds_read_u16_d16_hi v185, v69 offset:16384
  ds_read_u16_d16_hi v70, v69 offset:16386
  s_waitcnt lgkmcnt(4)
  v_mfma_f32_32x32x16_bf16 v[72:87], v[64:67], v[144:147], v[72:87]
  ds_read_b128 v[188:191], v17 offset:20480
  ds_read_b128 v[196:199], v21 offset:20480
  v_lshl_add_u32 v71, v71, 3, s78
  s_lshl_b32 s79, s38, 1
  v_mfma_f32_32x32x16_bf16 v[120:135], v[136:139], v[144:147], v[120:135]
  buffer_load_dwordx4 v217, s[12:15], s29 offen offset:1024 lds
  s_lshr_b32 s80, s3, 1
  s_add_u32 s79, s79, s80
  v_mfma_f32_32x32x16_bf16 v[88:103], v[136:139], v[140:143], v[88:103]
  s_add_u32 m0, s32, 133120
  s_nop 0
  buffer_load_dwordx4 v218, s[12:15], s29 offen offset:0 lds
  s_lshl_b32 s78, s79, 9
  s_waitcnt lgkmcnt(4)
  v_mfma_f32_32x32x16_bf16 v[40:55], v[148:151], v[192:195], v[40:55]
  ds_read_b128 v[64:67], v18 offset:16384
  ds_read_b128 v[140:143], v22 offset:16384
  s_and_b32 s79, s79, 3
  s_lshl_b32 s79, s79, 2
  s_waitcnt lgkmcnt(2)
  v_mfma_f32_32x32x16_bf16 v[72:87], v[148:151], v[196:199], v[72:87]
  ds_read_b128 v[136:139], v18 offset:20480
  ds_read_b128 v[144:147], v22 offset:20480
  v_xor_b32 v58, s79, v2
  v_lshlrev_b32 v58, 4, v58
  v_mfma_f32_32x32x16_bf16 v[120:135], v[188:191], v[196:199], v[120:135]
  buffer_load_dwordx4 v219, s[12:15], s29 offen offset:1024 lds
  v_lshrrev_b32 v59, 1, v3
  v_lshl_or_b32 v58, v59, 14, v58
  v_mfma_f32_32x32x16_bf16 v[88:103], v[188:191], v[192:195], v[88:103]
  s_add_u32 m0, s32, 65536
  s_nop 0
  buffer_load_dwordx4 v216, s[24:27], s29 offen offset:0 lds
  v_and_b32 v59, 1, v3
  v_lshl_or_b32 v58, v59, 19, v58
  v_mul_f32 v185, v185, v178
  v_mul_f32 v70, v70, v179
  s_waitcnt lgkmcnt(2)
  v_mfma_f32_32x32x16_bf16 v[40:55], v[64:67], v[140:143], v[40:55]
  ds_read_b128 v[148:151], v19 offset:16384
  ds_read_b128 v[192:195], v23 offset:16384
  s_and_b32 s80, s3, 1
  s_waitcnt lgkmcnt(2)
  v_mfma_f32_32x32x16_bf16 v[72:87], v[64:67], v[144:147], v[72:87]
  ds_read_b128 v[188:191], v19 offset:20480
  ds_read_b128 v[196:199], v23 offset:20480
  s_lshl_b32 s80, s80, 8
  s_add_u32 s78, s78, s80
  v_cvt_pk_bf16_f32 v185, v185, v70
  v_mfma_f32_32x32x16_bf16 v[120:135], v[136:139], v[144:147], v[120:135]
  buffer_load_dwordx4 v217, s[24:27], s29 offen offset:1024 lds
  s_lshl_b32 s80, s39, 15
  s_add_u32 s78, s78, s80
  v_mfma_f32_32x32x16_bf16 v[88:103], v[136:139], v[140:143], v[88:103]
  s_add_u32 m0, s32, 67584
  s_nop 0
  buffer_load_dwordx4 v218, s[24:27], s29 offen offset:0 lds
  s_add_u32 s80, s34, 10485760
  s_addc_u32 s81, s35, 0
  s_waitcnt vmcnt(16) lgkmcnt(0)
  s_barrier
  v_mfma_f32_32x32x16_bf16 v[40:55], v[148:151], v[192:195], v[40:55]
  ds_read_b128 v[64:67], v16 offset:32768
  ds_read_b128 v[140:143], v20 offset:32768
  s_mov_b32 s82, 8388608
  s_mov_b32 s83, 0x20000
  v_dot2c_f32_bf16 v184, s33, v185
  v_mfma_f32_32x32x16_bf16 v[72:87], v[148:151], v[196:199], v[72:87]
  ds_read_b128 v[136:139], v16 offset:36864
  ds_read_b128 v[144:147], v20 offset:36864
  s_add_u32 s84, s34, 5242880
  s_addc_u32 s85, s35, 0
  v_mfma_f32_32x32x16_bf16 v[120:135], v[188:191], v[196:199], v[120:135]
  buffer_load_dwordx4 v219, s[24:27], s29 offen offset:1024 lds
  s_add_u32 s29, s29, 128
  s_and_b32 s29, s29, 0x3ff
  s_mov_b32 s86, 4194304
  v_mfma_f32_32x32x16_bf16 v[88:103], v[188:191], v[192:195], v[88:103]
  s_mov_b32 s87, 0x20000
  s_add_u32 s88, s34, 19922944
  s_addc_u32 s89, s35, 0
  s_waitcnt lgkmcnt(2)
  v_mfma_f32_32x32x16_bf16 v[40:55], v[64:67], v[140:143], v[40:55]
  ds_read_b128 v[148:151], v17 offset:32768
  ds_read_b128 v[192:195], v21 offset:32768
  s_mov_b32 s90, 32768
  ds_read_u16_d16_hi v185, v69 offset:32768
  ds_read_u16_d16_hi v70, v69 offset:32770
  s_waitcnt lgkmcnt(4)
  v_mfma_f32_32x32x16_bf16 v[72:87], v[64:67], v[144:147], v[72:87]
  ds_read_b128 v[188:191], v17 offset:36864
  ds_read_b128 v[196:199], v21 offset:36864
  s_mov_b32 s91, 0x20000
  v_mfma_f32_32x32x16_bf16 v[120:135], v[136:139], v[144:147], v[120:135]
  s_lshr_b32 s93, s41, 3
  s_mul_i32 s92, s93, 253952
  v_mfma_f32_32x32x16_bf16 v[88:103], v[136:139], v[140:143], v[88:103]
  s_lshl_b32 s79, s40, 19
  s_add_u32 s92, s92, s79
  s_waitcnt lgkmcnt(4)
  v_mfma_f32_32x32x16_bf16 v[40:55], v[148:151], v[192:195], v[40:55]
  ds_read_b128 v[64:67], v18 offset:32768
  ds_read_b128 v[140:143], v22 offset:32768
  s_lshr_b32 s93, s3, 1
  s_lshl1_add_u32 s93, s93, s3
  s_waitcnt lgkmcnt(2)
  v_mfma_f32_32x32x16_bf16 v[72:87], v[148:151], v[196:199], v[72:87]
  ds_read_b128 v[136:139], v18 offset:36864
  ds_read_b128 v[144:147], v22 offset:36864
  s_add_u32 s93, s93, 2
  s_lshl_b32 s93, s93, 12
  v_mfma_f32_32x32x16_bf16 v[120:135], v[188:191], v[196:199], v[120:135]
  s_add_u32 s92, s92, s93
  v_mfma_f32_32x32x16_bf16 v[88:103], v[188:191], v[192:195], v[88:103]
  v_lshl_add_u32 v59, v1, 4, s92
  s_and_b32 s79, s40, 7
  v_mul_f32 v185, v185, v180
  v_mul_f32 v70, v70, v181
  s_waitcnt lgkmcnt(2)
  v_mfma_f32_32x32x16_bf16 v[40:55], v[64:67], v[140:143], v[40:55]
  ds_read_b128 v[148:151], v19 offset:32768
  ds_read_b128 v[192:195], v23 offset:32768
  s_lshl_b32 s79, s79, 15
  s_lshl_b32 s92, s3, 12
  s_waitcnt lgkmcnt(2)
  v_mfma_f32_32x32x16_bf16 v[72:87], v[64:67], v[144:147], v[72:87]
  ds_read_b128 v[188:191], v19 offset:36864
  ds_read_b128 v[196:199], v23 offset:36864
  v_and_b32 v244, 3, v1
  v_and_b32 v245, 2, v3
  v_cvt_pk_bf16_f32 v185, v185, v70
  v_mfma_f32_32x32x16_bf16 v[120:135], v[136:139], v[144:147], v[120:135]
  v_xor_b32 v245, v245, v244
  v_lshlrev_b32 v244, 9, v244
  v_mfma_f32_32x32x16_bf16 v[88:103], v[136:139], v[140:143], v[88:103]
  v_lshl_or_b32 v244, v245, 6, v244
  s_waitcnt vmcnt(9) lgkmcnt(0)
  s_barrier
  v_mfma_f32_32x32x16_bf16 v[40:55], v[148:151], v[192:195], v[40:55]
  ds_read_b128 v[64:67], v16 offset:49152
  ds_read_b128 v[140:143], v20 offset:49152
  v_bfe_u32 v245, v1, 2, 2
  v_lshl_or_b32 v244, v245, 4, v244
  v_dot2c_f32_bf16 v184, s33, v185
  v_mfma_f32_32x32x16_bf16 v[72:87], v[148:151], v[196:199], v[72:87]
  ds_read_b128 v[136:139], v16 offset:53248
  ds_read_b128 v[144:147], v20 offset:53248
  v_and_b32 v245, 1, v3
  v_lshl_or_b32 v240, v245, 3, v244
  v_mfma_f32_32x32x16_bf16 v[120:135], v[188:191], v[196:199], v[120:135]
  s_add_u32 m0, s76, 0
  s_nop 0
  buffer_load_dwordx4 v61, s[20:23], s6 offen offset:0 lds
  v_xor_b32 v241, 64, v240
  v_add_u32 v242, 0x10000, v240
  v_mfma_f32_32x32x16_bf16 v[88:103], v[188:191], v[192:195], v[88:103]
  buffer_load_dwordx4 v61, s[56:59], s6 offen offset:1024 lds
  v_add_u32 v243, 0x10000, v241
  s_waitcnt lgkmcnt(2)
  v_mfma_f32_32x32x16_bf16 v[40:55], v[64:67], v[140:143], v[40:55]
  ds_read_b128 v[148:151], v17 offset:49152
  ds_read_b128 v[192:195], v21 offset:49152
  ds_read_u16_d16_hi v185, v69 offset:49152
  ds_read_u16_d16_hi v70, v69 offset:49154
  s_waitcnt lgkmcnt(4)
  v_mfma_f32_32x32x16_bf16 v[72:87], v[64:67], v[144:147], v[72:87]
  ds_read_b128 v[188:191], v17 offset:53248
  ds_read_b128 v[196:199], v21 offset:53248
  s_add_u32 m0, s76, 2048
  s_nop 0
  buffer_load_dwordx4 v61, s[20:23], s7 offen offset:0 lds
  v_mfma_f32_32x32x16_bf16 v[120:135], v[136:139], v[144:147], v[120:135]
  buffer_load_dwordx4 v61, s[56:59], s7 offen offset:1024 lds
  v_mfma_f32_32x32x16_bf16 v[88:103], v[136:139], v[140:143], v[88:103]
  s_add_u32 m0, s76, 16384
  s_nop 0
  buffer_load_dwordx4 v61, s[20:23], s8 offen offset:0 lds
  s_waitcnt lgkmcnt(4)
  v_mfma_f32_32x32x16_bf16 v[40:55], v[148:151], v[192:195], v[40:55]
  ds_read_b128 v[64:67], v18 offset:49152
  ds_read_b128 v[140:143], v22 offset:49152
  s_waitcnt lgkmcnt(2)
  v_mfma_f32_32x32x16_bf16 v[72:87], v[148:151], v[196:199], v[72:87]
  ds_read_b128 v[136:139], v18 offset:53248
  ds_read_b128 v[144:147], v22 offset:53248
  buffer_load_dwordx4 v61, s[56:59], s8 offen offset:1024 lds
  v_mfma_f32_32x32x16_bf16 v[120:135], v[188:191], v[196:199], v[120:135]
  s_add_u32 m0, s76, 18432
  s_nop 0
  buffer_load_dwordx4 v61, s[20:23], s9 offen offset:0 lds
  v_mfma_f32_32x32x16_bf16 v[88:103], v[188:191], v[192:195], v[88:103]
  buffer_load_dwordx4 v61, s[56:59], s9 offen offset:1024 lds
  v_mul_f32 v185, v185, v182
  v_mul_f32 v70, v70, v183
  s_waitcnt lgkmcnt(2)
  v_mfma_f32_32x32x16_bf16 v[40:55], v[64:67], v[140:143], v[40:55]
  ds_read_b128 v[148:151], v19 offset:49152
  ds_read_b128 v[192:195], v23 offset:49152
  s_waitcnt lgkmcnt(2)
  v_mfma_f32_32x32x16_bf16 v[72:87], v[64:67], v[144:147], v[72:87]
  ds_read_b128 v[188:191], v19 offset:53248
  ds_read_b128 v[196:199], v23 offset:53248
  v_cvt_pk_bf16_f32 v185, v185, v70
  v_mfma_f32_32x32x16_bf16 v[120:135], v[136:139], v[144:147], v[120:135]
  v_mfma_f32_32x32x16_bf16 v[88:103], v[136:139], v[140:143], v[88:103]
  s_waitcnt lgkmcnt(2)
  v_mfma_f32_32x32x16_bf16 v[40:55], v[148:151], v[192:195], v[40:55]
  v_dot2c_f32_bf16 v184, s33, v185
  s_waitcnt lgkmcnt(0)
  v_mfma_f32_32x32x16_bf16 v[72:87], v[148:151], v[196:199], v[72:87]
  v_mfma_f32_32x32x16_bf16 v[120:135], v[188:191], v[196:199], v[120:135]
  v_mfma_f32_32x32x16_bf16 v[88:103], v[188:191], v[192:195], v[88:103]
  s_nop 6
  v_pk_fma_f32 v[250:251], v[226:227], v[40:41], v[42:43] op_sel:[0,0,0] op_sel_hi:[0,1,1]
  s_nop 1
  v_pk_fma_f32 v[244:245], v[226:227], v[72:73], v[74:75] op_sel:[0,0,0] op_sel_hi:[0,1,1]
  v_pk_fma_f32 v[250:251], v[226:227], v[72:73], v[250:251] op_sel:[1,0,0] op_sel_hi:[1,1,1] neg_lo:[1,0,0] neg_hi:[1,0,0]
  v_pk_fma_f32 v[244:245], v[226:227], v[40:41], v[244:245] op_sel:[1,0,0] op_sel_hi:[1,1,1]
  v_pk_fma_f32 v[8:9], v[226:227], v[250:251], v[44:45] op_sel:[0,0,0] op_sel_hi:[0,1,1]
  v_pk_fma_f32 v[10:11], v[226:227], v[244:245], v[76:77] op_sel:[0,0,0] op_sel_hi:[0,1,1]
  v_pk_fma_f32 v[8:9], v[226:227], v[244:245], v[8:9] op_sel:[1,0,0] op_sel_hi:[1,1,1] neg_lo:[1,0,0] neg_hi:[1,0,0]
  v_pk_fma_f32 v[10:11], v[226:227], v[250:251], v[10:11] op_sel:[1,0,0] op_sel_hi:[1,1,1]
  v_pk_fma_f32 v[250:251], v[226:227], v[8:9], v[46:47] op_sel:[0,0,0] op_sel_hi:[0,1,1]
  v_pk_fma_f32 v[244:245], v[226:227], v[10:11], v[78:79] op_sel:[0,0,0] op_sel_hi:[0,1,1]
  v_pk_fma_f32 v[250:251], v[226:227], v[10:11], v[250:251] op_sel:[1,0,0] op_sel_hi:[1,1,1] neg_lo:[1,0,0] neg_hi:[1,0,0]
  v_pk_fma_f32 v[244:245], v[226:227], v[8:9], v[244:245] op_sel:[1,0,0] op_sel_hi:[1,1,1]
  v_pk_fma_f32 v[8:9], v[226:227], v[250:251], v[48:49] op_sel:[0,0,0] op_sel_hi:[0,1,1]
  v_pk_fma_f32 v[10:11], v[226:227], v[244:245], v[80:81] op_sel:[0,0,0] op_sel_hi:[0,1,1]
  v_pk_fma_f32 v[8:9], v[226:227], v[244:245], v[8:9] op_sel:[1,0,0] op_sel_hi:[1,1,1] neg_lo:[1,0,0] neg_hi:[1,0,0]
  v_pk_fma_f32 v[10:11], v[226:227], v[250:251], v[10:11] op_sel:[1,0,0] op_sel_hi:[1,1,1]
  v_pk_fma_f32 v[250:251], v[226:227], v[8:9], v[50:51] op_sel:[0,0,0] op_sel_hi:[0,1,1]
  v_pk_fma_f32 v[244:245], v[226:227], v[10:11], v[82:83] op_sel:[0,0,0] op_sel_hi:[0,1,1]
  v_pk_fma_f32 v[250:251], v[226:227], v[10:11], v[250:251] op_sel:[1,0,0] op_sel_hi:[1,1,1] neg_lo:[1,0,0] neg_hi:[1,0,0]
  v_pk_fma_f32 v[244:245], v[226:227], v[8:9], v[244:245] op_sel:[1,0,0] op_sel_hi:[1,1,1]
  v_pk_fma_f32 v[8:9], v[226:227], v[250:251], v[52:53] op_sel:[0,0,0] op_sel_hi:[0,1,1]
  v_pk_fma_f32 v[10:11], v[226:227], v[244:245], v[84:85] op_sel:[0,0,0] op_sel_hi:[0,1,1]
  v_pk_fma_f32 v[8:9], v[226:227], v[244:245], v[8:9] op_sel:[1,0,0] op_sel_hi:[1,1,1] neg_lo:[1,0,0] neg_hi:[1,0,0]
  v_pk_fma_f32 v[10:11], v[226:227], v[250:251], v[10:11] op_sel:[1,0,0] op_sel_hi:[1,1,1]
  v_pk_fma_f32 v[250:251], v[226:227], v[8:9], v[54:55] op_sel:[0,0,0] op_sel_hi:[0,1,1]
  v_pk_fma_f32 v[244:245], v[226:227], v[10:11], v[86:87] op_sel:[0,0,0] op_sel_hi:[0,1,1]
  v_pk_fma_f32 v[250:251], v[226:227], v[10:11], v[250:251] op_sel:[1,0,0] op_sel_hi:[1,1,1] neg_lo:[1,0,0] neg_hi:[1,0,0]
  v_pk_fma_f32 v[244:245], v[226:227], v[8:9], v[244:245] op_sel:[1,0,0] op_sel_hi:[1,1,1]
  v_pk_fma_f32 v[8:9], v[226:227], v[250:251], v[88:89] op_sel:[0,0,0] op_sel_hi:[0,1,1]
  v_pk_fma_f32 v[10:11], v[226:227], v[244:245], v[120:121] op_sel:[0,0,0] op_sel_hi:[0,1,1]
  v_pk_fma_f32 v[8:9], v[226:227], v[244:245], v[8:9] op_sel:[1,0,0] op_sel_hi:[1,1,1] neg_lo:[1,0,0] neg_hi:[1,0,0]
  v_pk_fma_f32 v[10:11], v[226:227], v[250:251], v[10:11] op_sel:[1,0,0] op_sel_hi:[1,1,1]
  v_pk_fma_f32 v[250:251], v[226:227], v[8:9], v[90:91] op_sel:[0,0,0] op_sel_hi:[0,1,1]
  v_pk_fma_f32 v[244:245], v[226:227], v[10:11], v[122:123] op_sel:[0,0,0] op_sel_hi:[0,1,1]
  v_pk_fma_f32 v[250:251], v[226:227], v[10:11], v[250:251] op_sel:[1,0,0] op_sel_hi:[1,1,1] neg_lo:[1,0,0] neg_hi:[1,0,0]
  v_pk_fma_f32 v[244:245], v[226:227], v[8:9], v[244:245] op_sel:[1,0,0] op_sel_hi:[1,1,1]
  v_pk_fma_f32 v[8:9], v[226:227], v[250:251], v[92:93] op_sel:[0,0,0] op_sel_hi:[0,1,1]
  v_pk_fma_f32 v[10:11], v[226:227], v[244:245], v[124:125] op_sel:[0,0,0] op_sel_hi:[0,1,1]
  v_pk_fma_f32 v[8:9], v[226:227], v[244:245], v[8:9] op_sel:[1,0,0] op_sel_hi:[1,1,1] neg_lo:[1,0,0] neg_hi:[1,0,0]
  v_pk_fma_f32 v[10:11], v[226:227], v[250:251], v[10:11] op_sel:[1,0,0] op_sel_hi:[1,1,1]
  v_pk_fma_f32 v[250:251], v[226:227], v[8:9], v[94:95] op_sel:[0,0,0] op_sel_hi:[0,1,1]
  v_pk_fma_f32 v[244:245], v[226:227], v[10:11], v[126:127] op_sel:[0,0,0] op_sel_hi:[0,1,1]
  v_pk_fma_f32 v[250:251], v[226:227], v[10:11], v[250:251] op_sel:[1,0,0] op_sel_hi:[1,1,1] neg_lo:[1,0,0] neg_hi:[1,0,0]
  v_pk_fma_f32 v[244:245], v[226:227], v[8:9], v[244:245] op_sel:[1,0,0] op_sel_hi:[1,1,1]
  v_pk_fma_f32 v[8:9], v[226:227], v[250:251], v[96:97] op_sel:[0,0,0] op_sel_hi:[0,1,1]
  v_pk_fma_f32 v[10:11], v[226:227], v[244:245], v[128:129] op_sel:[0,0,0] op_sel_hi:[0,1,1]
  v_pk_fma_f32 v[8:9], v[226:227], v[244:245], v[8:9] op_sel:[1,0,0] op_sel_hi:[1,1,1] neg_lo:[1,0,0] neg_hi:[1,0,0]
  v_pk_fma_f32 v[10:11], v[226:227], v[250:251], v[10:11] op_sel:[1,0,0] op_sel_hi:[1,1,1]
  v_pk_fma_f32 v[250:251], v[226:227], v[8:9], v[98:99] op_sel:[0,0,0] op_sel_hi:[0,1,1]
  v_pk_fma_f32 v[244:245], v[226:227], v[10:11], v[130:131] op_sel:[0,0,0] op_sel_hi:[0,1,1]
  v_pk_fma_f32 v[250:251], v[226:227], v[10:11], v[250:251] op_sel:[1,0,0] op_sel_hi:[1,1,1] neg_lo:[1,0,0] neg_hi:[1,0,0]
  v_pk_fma_f32 v[244:245], v[226:227], v[8:9], v[244:245] op_sel:[1,0,0] op_sel_hi:[1,1,1]
  v_pk_fma_f32 v[8:9], v[226:227], v[250:251], v[100:101] op_sel:[0,0,0] op_sel_hi:[0,1,1]
  v_pk_fma_f32 v[10:11], v[226:227], v[244:245], v[132:133] op_sel:[0,0,0] op_sel_hi:[0,1,1]
  v_pk_fma_f32 v[8:9], v[226:227], v[244:245], v[8:9] op_sel:[1,0,0] op_sel_hi:[1,1,1] neg_lo:[1,0,0] neg_hi:[1,0,0]
  v_pk_fma_f32 v[10:11], v[226:227], v[250:251], v[10:11] op_sel:[1,0,0] op_sel_hi:[1,1,1]
  v_pk_fma_f32 v[250:251], v[226:227], v[8:9], v[102:103] op_sel:[0,0,0] op_sel_hi:[0,1,1]
  v_pk_fma_f32 v[244:245], v[226:227], v[10:11], v[134:135] op_sel:[0,0,0] op_sel_hi:[0,1,1]
  v_pk_fma_f32 v[250:251], v[226:227], v[10:11], v[250:251] op_sel:[1,0,0] op_sel_hi:[1,1,1] neg_lo:[1,0,0] neg_hi:[1,0,0]
  v_pk_fma_f32 v[244:245], v[226:227], v[8:9], v[244:245] op_sel:[1,0,0] op_sel_hi:[1,1,1]
  v_fma_f32 v8, v228, v250, v251
  v_fma_f32 v9, v228, v244, v245
  v_fma_f32 v8, -v229, v244, v8
  v_fma_f32 v9, v229, v250, v9
  v_mov_b32 v10, v8
  v_mov_b32 v11, v9
  s_nop 0
  v_permlane32_swap_b32 v8, v10
  v_permlane32_swap_b32 v9, v11
  v_fma_f32 v10, v230, v8, v10
  v_fma_f32 v11, v230, v9, v11
  v_fma_f32 v10, -v231, v9, v10
  v_fma_f32 v11, v231, v8, v11
  ds_write_b64 v60, v[10:11]
  s_waitcnt vmcnt(16)
  v_cmp_ne_u32 vcc, 1, v247
  s_nop 0
  s_cbranch_vccz gated_mix__spectral_gfnet__ssm_conv_s5__prompt_kernel_skip22
  s_mov_b32 s33, 0
gated_mix__spectral_gfnet__ssm_conv_s5__prompt_kernel_poll23:
  s_sleep 16
  buffer_load_dword v247, v6, s[16:19], 0 offen sc1
  s_waitcnt vmcnt(0)
  v_cmp_ne_u32 vcc, 1, v247
  s_nop 0
  s_cbranch_vccz gated_mix__spectral_gfnet__ssm_conv_s5__prompt_kernel_pollout24
  s_add_u32 s33, s33, 1
  s_cmp_lt_u32 s33, 1048576
  s_cbranch_scc1 gated_mix__spectral_gfnet__ssm_conv_s5__prompt_kernel_poll23
gated_mix__spectral_gfnet__ssm_conv_s5__prompt_kernel_pollout24:
gated_mix__spectral_gfnet__ssm_conv_s5__prompt_kernel_skip22:
  s_waitcnt lgkmcnt(0)
  s_barrier
  v_and_b32 v60, 0xfffffbff, v60
  ds_read_b64 v[246:247], v60
  s_cmp_lt_u32 s3, 2
  s_cbranch_scc1 gated_mix__spectral_gfnet__ssm_conv_s5__prompt_kernel_skip25
  s_waitcnt lgkmcnt(0)
  v_fma_f32 v10, v232, v246, v10
  s_waitcnt lgkmcnt(0)
  v_fma_f32 v11, v232, v247, v11
  s_waitcnt lgkmcnt(0)
  v_fma_f32 v10, -v233, v247, v10
  s_waitcnt lgkmcnt(0)
  v_fma_f32 v11, v233, v246, v11
  v_min_u32 v10, -2, v10
  v_min_u32 v11, -2, v11
  s_mov_b32 exec_hi, 0
  buffer_store_dwordx2 v[10:11], v71, s[68:71], 0 offen sc1
  s_mov_b64 exec, -1
gated_mix__spectral_gfnet__ssm_conv_s5__prompt_kernel_skip25:
  v_lshrrev_b32 v5, 5, v1
  v_lshl_add_u32 v71, v5, 12, v71
  v_add_u32 v71, 512, v71
  v_and_b32 v60, 3, v2
  v_lshlrev_b32 v5, 6, v60
  v_lshrrev_b32 v60, 2, v2
  v_lshl_or_b32 v5, v60, 4, v5
  v_lshl_or_b32 v5, v3, 12, v5
  s_mul_i32 s33, s10, 16384
  s_lshl_b32 s43, s3, 8
  s_add_u32 s33, s33, s43
  buffer_load_dwordx4 v[12:15], v5, s[60:63], s33 offen offset:0 sc1
  buffer_load_dwordx4 v[16:19], v5, s[60:63], s33 offen offset:1024 sc1
  buffer_load_dwordx4 v[20:23], v5, s[60:63], s33 offen offset:2048 sc1
  buffer_load_dwordx4 v[64:67], v5, s[60:63], s33 offen offset:3072 sc1
  v_pk_mul_f32 v[138:139], v[236:237], v[40:41] op_sel:[1,0] op_sel_hi:[1,1]
  v_pk_mul_f32 v[40:41], v[236:237], v[40:41] op_sel:[0,0] op_sel_hi:[0,1]
  v_pk_fma_f32 v[40:41], v[236:237], v[72:73], v[40:41] op_sel:[1,0,0] op_sel_hi:[1,1,1] neg_lo:[1,0,0] neg_hi:[1,0,0]
  v_pk_fma_f32 v[72:73], v[236:237], v[72:73], v[138:139] op_sel:[0,0,0] op_sel_hi:[0,1,1]
  v_pk_mul_f32 v[136:137], v[236:237], v[42:43] op_sel:[1,0] op_sel_hi:[1,1]
  v_pk_mul_f32 v[42:43], v[236:237], v[42:43] op_sel:[0,0] op_sel_hi:[0,1]
  v_pk_fma_f32 v[42:43], v[236:237], v[74:75], v[42:43] op_sel:[1,0,0] op_sel_hi:[1,1,1] neg_lo:[1,0,0] neg_hi:[1,0,0]
  v_pk_fma_f32 v[74:75], v[236:237], v[74:75], v[136:137] op_sel:[0,0,0] op_sel_hi:[0,1,1]
  v_pk_mul_f32 v[138:139], v[236:237], v[44:45] op_sel:[1,0] op_sel_hi:[1,1]
  v_pk_mul_f32 v[44:45], v[236:237], v[44:45] op_sel:[0,0] op_sel_hi:[0,1]
  v_pk_fma_f32 v[44:45], v[236:237], v[76:77], v[44:45] op_sel:[1,0,0] op_sel_hi:[1,1,1] neg_lo:[1,0,0] neg_hi:[1,0,0]
  v_pk_fma_f32 v[76:77], v[236:237], v[76:77], v[138:139] op_sel:[0,0,0] op_sel_hi:[0,1,1]
  v_pk_mul_f32 v[136:137], v[236:237], v[46:47] op_sel:[1,0] op_sel_hi:[1,1]
  v_pk_mul_f32 v[46:47], v[236:237], v[46:47] op_sel:[0,0] op_sel_hi:[0,1]
  v_pk_fma_f32 v[46:47], v[236:237], v[78:79], v[46:47] op_sel:[1,0,0] op_sel_hi:[1,1,1] neg_lo:[1,0,0] neg_hi:[1,0,0]
  v_pk_fma_f32 v[78:79], v[236:237], v[78:79], v[136:137] op_sel:[0,0,0] op_sel_hi:[0,1,1]
  v_pk_mul_f32 v[138:139], v[236:237], v[48:49] op_sel:[1,0] op_sel_hi:[1,1]
  v_pk_mul_f32 v[48:49], v[236:237], v[48:49] op_sel:[0,0] op_sel_hi:[0,1]
  v_pk_fma_f32 v[48:49], v[236:237], v[80:81], v[48:49] op_sel:[1,0,0] op_sel_hi:[1,1,1] neg_lo:[1,0,0] neg_hi:[1,0,0]
  v_pk_fma_f32 v[80:81], v[236:237], v[80:81], v[138:139] op_sel:[0,0,0] op_sel_hi:[0,1,1]
  v_pk_mul_f32 v[136:137], v[236:237], v[50:51] op_sel:[1,0] op_sel_hi:[1,1]
  v_pk_mul_f32 v[50:51], v[236:237], v[50:51] op_sel:[0,0] op_sel_hi:[0,1]
  v_pk_fma_f32 v[50:51], v[236:237], v[82:83], v[50:51] op_sel:[1,0,0] op_sel_hi:[1,1,1] neg_lo:[1,0,0] neg_hi:[1,0,0]
  v_pk_fma_f32 v[82:83], v[236:237], v[82:83], v[136:137] op_sel:[0,0,0] op_sel_hi:[0,1,1]
  v_pk_mul_f32 v[138:139], v[236:237], v[52:53] op_sel:[1,0] op_sel_hi:[1,1]
  s_add_u32 m0, s76, 81920
  s_nop 0
  buffer_load_dwordx4 v61, s[20:23], s72 offen offset:0 lds
  v_pk_mul_f32 v[52:53], v[236:237], v[52:53] op_sel:[0,0] op_sel_hi:[0,1]
  v_pk_fma_f32 v[52:53], v[236:237], v[84:85], v[52:53] op_sel:[1,0,0] op_sel_hi:[1,1,1] neg_lo:[1,0,0] neg_hi:[1,0,0]
  v_pk_fma_f32 v[84:85], v[236:237], v[84:85], v[138:139] op_sel:[0,0,0] op_sel_hi:[0,1,1]
  v_pk_mul_f32 v[136:137], v[236:237], v[54:55] op_sel:[1,0] op_sel_hi:[1,1]
  v_pk_mul_f32 v[54:55], v[236:237], v[54:55] op_sel:[0,0] op_sel_hi:[0,1]
  v_pk_fma_f32 v[54:55], v[236:237], v[86:87], v[54:55] op_sel:[1,0,0] op_sel_hi:[1,1,1] neg_lo:[1,0,0] neg_hi:[1,0,0]
  v_pk_fma_f32 v[86:87], v[236:237], v[86:87], v[136:137] op_sel:[0,0,0] op_sel_hi:[0,1,1]
  v_pk_mul_f32 v[138:139], v[236:237], v[88:89] op_sel:[1,0] op_sel_hi:[1,1]
  buffer_load_dwordx4 v61, s[56:59], s72 offen offset:1024 lds
  v_pk_mul_f32 v[88:89], v[236:237], v[88:89] op_sel:[0,0] op_sel_hi:[0,1]
  v_pk_fma_f32 v[88:89], v[236:237], v[120:121], v[88:89] op_sel:[1,0,0] op_sel_hi:[1,1,1] neg_lo:[1,0,0] neg_hi:[1,0,0]
  v_pk_fma_f32 v[120:121], v[236:237], v[120:121], v[138:139] op_sel:[0,0,0] op_sel_hi:[0,1,1]
  v_pk_mul_f32 v[136:137], v[236:237], v[90:91] op_sel:[1,0] op_sel_hi:[1,1]
  v_pk_mul_f32 v[90:91], v[236:237], v[90:91] op_sel:[0,0] op_sel_hi:[0,1]
  v_pk_fma_f32 v[90:91], v[236:237], v[122:123], v[90:91] op_sel:[1,0,0] op_sel_hi:[1,1,1] neg_lo:[1,0,0] neg_hi:[1,0,0]
  v_pk_fma_f32 v[122:123], v[236:237], v[122:123], v[136:137] op_sel:[0,0,0] op_sel_hi:[0,1,1]
  v_pk_mul_f32 v[138:139], v[236:237], v[92:93] op_sel:[1,0] op_sel_hi:[1,1]
  s_add_u32 m0, s76, 83968
  s_nop 0
  buffer_load_dwordx4 v61, s[20:23], s73 offen offset:0 lds
  v_pk_mul_f32 v[92:93], v[236:237], v[92:93] op_sel:[0,0] op_sel_hi:[0,1]
  v_pk_fma_f32 v[92:93], v[236:237], v[124:125], v[92:93] op_sel:[1,0,0] op_sel_hi:[1,1,1] neg_lo:[1,0,0] neg_hi:[1,0,0]
  v_pk_fma_f32 v[124:125], v[236:237], v[124:125], v[138:139] op_sel:[0,0,0] op_sel_hi:[0,1,1]
  v_pk_mul_f32 v[136:137], v[236:237], v[94:95] op_sel:[1,0] op_sel_hi:[1,1]
  v_pk_mul_f32 v[94:95], v[236:237], v[94:95] op_sel:[0,0] op_sel_hi:[0,1]
  v_pk_fma_f32 v[94:95], v[236:237], v[126:127], v[94:95] op_sel:[1,0,0] op_sel_hi:[1,1,1] neg_lo:[1,0,0] neg_hi:[1,0,0]
  v_pk_fma_f32 v[126:127], v[236:237], v[126:127], v[136:137] op_sel:[0,0,0] op_sel_hi:[0,1,1]
  v_pk_mul_f32 v[138:139], v[236:237], v[96:97] op_sel:[1,0] op_sel_hi:[1,1]
  buffer_load_dwordx4 v61, s[56:59], s73 offen offset:1024 lds
  v_pk_mul_f32 v[96:97], v[236:237], v[96:97] op_sel:[0,0] op_sel_hi:[0,1]
  v_pk_fma_f32 v[96:97], v[236:237], v[128:129], v[96:97] op_sel:[1,0,0] op_sel_hi:[1,1,1] neg_lo:[1,0,0] neg_hi:[1,0,0]
  v_pk_fma_f32 v[128:129], v[236:237], v[128:129], v[138:139] op_sel:[0,0,0] op_sel_hi:[0,1,1]
  v_pk_mul_f32 v[136:137], v[236:237], v[98:99] op_sel:[1,0] op_sel_hi:[1,1]
  v_pk_mul_f32 v[98:99], v[236:237], v[98:99] op_sel:[0,0] op_sel_hi:[0,1]
  v_pk_fma_f32 v[98:99], v[236:237], v[130:131], v[98:99] op_sel:[1,0,0] op_sel_hi:[1,1,1] neg_lo:[1,0,0] neg_hi:[1,0,0]
  v_pk_fma_f32 v[130:131], v[236:237], v[130:131], v[136:137] op_sel:[0,0,0] op_sel_hi:[0,1,1]
  v_pk_mul_f32 v[138:139], v[236:237], v[100:101] op_sel:[1,0] op_sel_hi:[1,1]
  s_add_u32 m0, s76, 32768
  s_nop 0
  buffer_load_dwordx4 v61, s[20:23], s74 offen offset:0 lds
  v_pk_mul_f32 v[100:101], v[236:237], v[100:101] op_sel:[0,0] op_sel_hi:[0,1]
  v_pk_fma_f32 v[100:101], v[236:237], v[132:133], v[100:101] op_sel:[1,0,0] op_sel_hi:[1,1,1] neg_lo:[1,0,0] neg_hi:[1,0,0]
  v_pk_fma_f32 v[132:133], v[236:237], v[132:133], v[138:139] op_sel:[0,0,0] op_sel_hi:[0,1,1]
  v_pk_mul_f32 v[136:137], v[236:237], v[102:103] op_sel:[1,0] op_sel_hi:[1,1]
  v_pk_mul_f32 v[102:103], v[236:237], v[102:103] op_sel:[0,0] op_sel_hi:[0,1]
  v_pk_fma_f32 v[102:103], v[236:237], v[134:135], v[102:103] op_sel:[1,0,0] op_sel_hi:[1,1,1] neg_lo:[1,0,0] neg_hi:[1,0,0]
  v_pk_fma_f32 v[134:135], v[236:237], v[134:135], v[136:137] op_sel:[0,0,0] op_sel_hi:[0,1,1]
  v_pk_mul_f32 v[10:11], v[236:237], v[232:233] op_sel:[0,0] op_sel_hi:[0,1]
  buffer_load_dwordx4 v61, s[56:59], s74 offen offset:1024 lds
  v_pk_fma_f32 v[10:11], v[236:237], v[232:233], v[10:11] op_sel:[1,1,0] op_sel_hi:[1,0,1] neg_lo:[1,0,0]
  s_cmp_ge_u32 s3, 2
  s_cbranch_scc1 gated_mix__spectral_gfnet__ssm_conv_s5__prompt_kernel_skip26
  v_mov_b32 v10, v236
  v_mov_b32 v11, v237
  s_waitcnt lgkmcnt(0)
  v_mov_b32 v246, 0
  s_waitcnt lgkmcnt(0)
  v_mov_b32 v247, 0
gated_mix__spectral_gfnet__ssm_conv_s5__prompt_kernel_skip26:
  v_pk_mul_f32 v[140:141], v[230:231], v[10:11] op_sel:[0,0] op_sel_hi:[0,1]
  v_pk_fma_f32 v[140:141], v[230:231], v[10:11], v[140:141] op_sel:[1,1,0] op_sel_hi:[1,0,1] neg_lo:[1,0,0]
  s_waitcnt lgkmcnt(0)
  v_pk_fma_f32 v[8:9], v[230:231], v[246:247], v[8:9] op_sel:[0,0,0] op_sel_hi:[0,1,1]
  v_pk_fma_f32 v[8:9], v[230:231], v[246:247], v[8:9] op_sel:[1,1,0] op_sel_hi:[1,0,1] neg_lo:[1,0,0]
  s_mov_b32 exec_lo, 0
  v_mov_b32 v10, v140
  v_mov_b32 v11, v141
  v_mov_b32 v246, v8
  v_mov_b32 v247, v9
  s_mov_b64 exec, -1
  s_add_u32 m0, s76, 34816
  s_nop 0
  buffer_load_dwordx4 v61, s[20:23], s75 offen offset:0 lds
  v_mov_b32 v251, v244
  v_pk_mul_f32 v[136:137], v[228:229], v[10:11] op_sel:[0,0] op_sel_hi:[0,1]
  v_pk_fma_f32 v[136:137], v[228:229], v[10:11], v[136:137] op_sel:[1,1,0] op_sel_hi:[1,0,1] neg_lo:[1,0,0]
  v_pk_fma_f32 v[250:251], v[228:229], v[246:247], v[250:251] op_sel:[0,0,0] op_sel_hi:[0,1,1]
  v_pk_fma_f32 v[250:251], v[228:229], v[246:247], v[250:251] op_sel:[1,1,0] op_sel_hi:[1,0,1] neg_lo:[1,0,0]
  v_pk_mul_f32 v[138:139], v[236:237], v[250:251] op_sel:[0,0] op_sel_hi:[0,1]
  v_pk_fma_f32 v[138:139], v[236:237], v[250:251], v[138:139] op_sel:[1,1,0] op_sel_hi:[1,0,1] neg_lo:[1,0,0]
  v_pk_mul_f32 v[140:141], v[236:237], v[246:247] op_sel:[0,0] op_sel_hi:[0,1]
  buffer_load_dwordx4 v61, s[56:59], s75 offen offset:1024 lds
  v_pk_fma_f32 v[140:141], v[236:237], v[246:247], v[140:141] op_sel:[1,1,0] op_sel_hi:[1,0,1] neg_lo:[1,0,0]
  buffer_load_dwordx2 v[8:9], v71, s[68:71], 0 offen offset:0 sc1
  buffer_load_dwordx2 v[142:143], v71, s[68:71], 0 offen offset:512 sc1
  buffer_load_dwordx2 v[232:233], v71, s[68:71], 0 offen offset:1024 sc1
  buffer_load_dwordx2 v[250:251], v71, s[68:71], 0 offen offset:1536 sc1
  buffer_load_dwordx2 v[144:145], v71, s[68:71], 0 offen offset:2048 sc1
  buffer_load_dwordx2 v[146:147], v71, s[68:71], 0 offen offset:2560 sc1
  buffer_load_dwordx2 v[148:149], v71, s[68:71], 0 offen offset:3072 sc1
  buffer_load_dwordx2 v[150:151], v71, s[68:71], 0 offen offset:3584 sc1
  s_add_u32 m0, s32, 114688
  s_nop 0
  buffer_load_dwordx4 v216, s[12:15], s29 offen offset:0 lds
  v_mov_b32 v185, v184
  s_lshl_b32 s33, s3, 3
  s_add_u32 s33, s33, 155648
  v_permlane16_swap_b32 v184, v185
  v_add_f32 v184, v184, v185
  s_nop 1
  v_add_f32 v184, v184, v184 row_ror:8 row_mask:0xf bank_mask:0xf
  s_nop 1
  v_add_f32 v184, v184, v184 row_ror:4 row_mask:0xf bank_mask:0xf
  s_nop 1
  v_add_f32 v184, v184, v184 row_ror:2 row_mask:0xf bank_mask:0xf
  buffer_load_dwordx4 v217, s[12:15], s29 offen offset:1024 lds
  s_nop 0
  v_add_f32 v184, v184, v184 row_ror:1 row_mask:0xf bank_mask:0xf
  v_cvt_pk_bf16_f32 v184, v184, v184
  v_and_b32 v184, 0xffff0000, v184
  v_mul_f32 v184, 0xbfb8aa3b, v184
  v_exp_f32 v184, v184
  v_lshrrev_b32 v70, 5, v1
  v_add_f32 v184, 1.0, v184
  s_add_u32 m0, s32, 116736
  s_nop 0
  buffer_load_dwordx4 v218, s[12:15], s29 offen offset:0 lds
  v_rcp_f32 v184, v184
  v_lshl_add_u32 v70, v70, 2, s33
  v_cvt_pk_bf16_f32 v184, v184, v184
  v_and_b32 v184, 0xffff0000, v184
  ds_write_b32 v70, v184
  v_and_b32 v5, 7, v2
  v_lshlrev_b32 v60, 2, v3
  buffer_load_dwordx4 v219, s[12:15], s29 offen offset:1024 lds
  v_xor_b32 v5, v5, v60
  v_lshlrev_b32 v5, 4, v5
  v_lshl_or_b32 v5, v2, 10, v5
  s_lshl_b32 s33, s3, 8
  s_add_u32 s33, s33, 49152
  v_add_u32 v5, s33, v5
  s_waitcnt vmcnt(23)
  v_mov_b32 v152, v12
  s_waitcnt vmcnt(22)
  v_mov_b32 v153, v16
  s_waitcnt vmcnt(21)
  v_mov_b32 v154, v20
  s_waitcnt vmcnt(20)
  v_mov_b32 v155, v64
  v_mov_b32 v156, v13
  v_mov_b32 v157, v17
  v_mov_b32 v158, v21
  v_mov_b32 v159, v65
  v_mfma_f32_16x16x32_bf16 v[160:163], v[152:155], v[104:107], 0
  v_mfma_f32_16x16x32_bf16 v[164:167], v[152:155], v[108:111], 0
  v_mfma_f32_16x16x32_bf16 v[168:171], v[156:159], v[104:107], 0
  v_mfma_f32_16x16x32_bf16 v[172:175], v[156:159], v[108:111], 0
  v_mov_b32 v152, v14
  v_mov_b32 v153, v18
  v_mov_b32 v154, v22
  v_mov_b32 v155, v66
  v_mov_b32 v156, v15
  v_mov_b32 v157, v19
  v_mov_b32 v158, v23
  v_mov_b32 v159, v67
  v_xor_b32 v60, 0, v5
  v_cvt_pk_bf16_f32 v64, v160, v164
  v_cvt_pk_bf16_f32 v65, v161, v165
  v_cvt_pk_bf16_f32 v66, v162, v166
  v_cvt_pk_bf16_f32 v67, v163, v167
  ds_write_b128 v60, v[64:67]
  v_mfma_f32_16x16x32_bf16 v[160:163], v[152:155], v[104:107], 0
  v_mfma_f32_16x16x32_bf16 v[164:167], v[152:155], v[108:111], 0
  v_xor_b32 v60, 16, v5
  v_cvt_pk_bf16_f32 v12, v168, v172
  v_cvt_pk_bf16_f32 v13, v169, v173
  v_cvt_pk_bf16_f32 v14, v170, v174
  v_cvt_pk_bf16_f32 v15, v171, v175
  s_branch gated_mix__spectral_gfnet__ssm_conv_s5__prompt_kernel_isk3
gated_mix__spectral_gfnet__ssm_conv_s5__prompt_kernel_isl3:
  s_branch gated_mix__spectral_gfnet__ssm_conv_s5__prompt_kernel_isl7
gated_mix__spectral_gfnet__ssm_conv_s5__prompt_kernel_isk3:
  ds_write_b128 v60, v[12:15]
  v_mfma_f32_16x16x32_bf16 v[168:171], v[156:159], v[104:107], 0
  v_mfma_f32_16x16x32_bf16 v[172:175], v[156:159], v[108:111], 0
  v_xor_b32 v60, 32, v5
  v_cvt_pk_bf16_f32 v16, v160, v164
  v_cvt_pk_bf16_f32 v17, v161, v165
  v_cvt_pk_bf16_f32 v18, v162, v166
  v_cvt_pk_bf16_f32 v19, v163, v167
  ds_write_b128 v60, v[16:19]
  v_xor_b32 v60, 48, v5
  s_nop 0
  v_cvt_pk_bf16_f32 v20, v168, v172
  v_cvt_pk_bf16_f32 v21, v169, v173
  v_cvt_pk_bf16_f32 v22, v170, v174
  v_cvt_pk_bf16_f32 v23, v171, v175
  ds_write_b128 v60, v[20:23]
  s_waitcnt vmcnt(4)
  v_max_u32 v5, v8, v9
  v_max3_u32 v5, v5, v142, v143
  v_max3_u32 v5, v5, v232, v233
  v_max3_u32 v5, v5, v250, v251
  v_max3_u32 v5, v5, v144, v145
  v_max3_u32 v5, v5, v146, v147
  v_max3_u32 v5, v5, v148, v149
  v_max3_u32 v5, v5, v150, v151
  v_cmp_eq_u32 vcc, -1, v5
  s_nop 0
  s_cbranch_vccz gated_mix__spectral_gfnet__ssm_conv_s5__prompt_kernel_skip27
  s_mov_b32 s33, 0
gated_mix__spectral_gfnet__ssm_conv_s5__prompt_kernel_lb28:
  buffer_load_dwordx2 v[8:9], v71, s[68:71], 0 offen offset:0 sc1
  buffer_load_dwordx2 v[142:143], v71, s[68:71], 0 offen offset:512 sc1
  buffer_load_dwordx2 v[232:233], v71, s[68:71], 0 offen offset:1024 sc1
  buffer_load_dwordx2 v[250:251], v71, s[68:71], 0 offen offset:1536 sc1
  buffer_load_dwordx2 v[144:145], v71, s[68:71], 0 offen offset:2048 sc1
  buffer_load_dwordx2 v[146:147], v71, s[68:71], 0 offen offset:2560 sc1
  buffer_load_dwordx2 v[148:149], v71, s[68:71], 0 offen offset:3072 sc1
  buffer_load_dwordx2 v[150:151], v71, s[68:71], 0 offen offset:3584 sc1
  s_waitcnt vmcnt(0)
  v_max_u32 v5, v8, v9
  v_max3_u32 v5, v5, v142, v143
  v_max3_u32 v5, v5, v232, v233
  v_max3_u32 v5, v5, v250, v251
  v_max3_u32 v5, v5, v144, v145
  v_max3_u32 v5, v5, v146, v147
  v_max3_u32 v5, v5, v148, v149
  v_max3_u32 v5, v5, v150, v151
  v_cmp_eq_u32 vcc, -1, v5
  s_nop 0
  s_cbranch_vccz gated_mix__spectral_gfnet__ssm_conv_s5__prompt_kernel_lbout29
  s_add_u32 s33, s33, 1
  s_cmp_lt_u32 s33, 1048576
  s_cbranch_scc1 gated_mix__spectral_gfnet__ssm_conv_s5__prompt_kernel_lb28
gated_mix__spectral_gfnet__ssm_conv_s5__prompt_kernel_lbout29:
gated_mix__spectral_gfnet__ssm_conv_s5__prompt_kernel_skip27:
  v_pk_fma_f32 v[148:149], v[238:239], v[150:151], v[148:149] op_sel:[0,0,0] op_sel_hi:[0,1,1]
  v_pk_fma_f32 v[148:149], v[238:239], v[150:151], v[148:149] op_sel:[1,1,0] op_sel_hi:[1,0,1] neg_lo:[1,0,0]
  v_pk_fma_f32 v[146:147], v[238:239], v[148:149], v[146:147] op_sel:[0,0,0] op_sel_hi:[0,1,1]
  v_pk_fma_f32 v[146:147], v[238:239], v[148:149], v[146:147] op_sel:[1,1,0] op_sel_hi:[1,0,1] neg_lo:[1,0,0]
  v_pk_fma_f32 v[144:145], v[238:239], v[146:147], v[144:145] op_sel:[0,0,0] op_sel_hi:[0,1,1]
  v_pk_fma_f32 v[144:145], v[238:239], v[146:147], v[144:145] op_sel:[1,1,0] op_sel_hi:[1,0,1] neg_lo:[1,0,0]
  v_pk_fma_f32 v[250:251], v[238:239], v[144:145], v[250:251] op_sel:[0,0,0] op_sel_hi:[0,1,1]
  v_pk_fma_f32 v[250:251], v[238:239], v[144:145], v[250:251] op_sel:[1,1,0] op_sel_hi:[1,0,1] neg_lo:[1,0,0]
  v_pk_fma_f32 v[232:233], v[238:239], v[250:251], v[232:233] op_sel:[0,0,0] op_sel_hi:[0,1,1]
  v_pk_fma_f32 v[232:233], v[238:239], v[250:251], v[232:233] op_sel:[1,1,0] op_sel_hi:[1,0,1] neg_lo:[1,0,0]
  v_pk_fma_f32 v[142:143], v[238:239], v[232:233], v[142:143] op_sel:[0,0,0] op_sel_hi:[0,1,1]
  v_pk_fma_f32 v[142:143], v[238:239], v[232:233], v[142:143] op_sel:[1,1,0] op_sel_hi:[1,0,1] neg_lo:[1,0,0]
  v_pk_fma_f32 v[8:9], v[238:239], v[142:143], v[8:9] op_sel:[0,0,0] op_sel_hi:[0,1,1]
  v_pk_fma_f32 v[8:9], v[238:239], v[142:143], v[8:9] op_sel:[1,1,0] op_sel_hi:[1,0,1] neg_lo:[1,0,0]
  v_mov_b32 v142, v8
  v_mov_b32 v143, v9
  s_nop 0
  v_permlane32_swap_b32 v8, v142
  v_permlane32_swap_b32 v9, v143
  v_pk_fma_f32 v[8:9], v[234:235], v[142:143], v[8:9] op_sel:[0,0,0] op_sel_hi:[0,1,1]
  v_pk_fma_f32 v[8:9], v[234:235], v[142:143], v[8:9] op_sel:[1,1,0] op_sel_hi:[1,0,1] neg_lo:[1,0,0]
  v_pk_fma_f32 v[140:141], v[10:11], v[8:9], v[140:141] op_sel:[0,0,0] op_sel_hi:[0,1,1]
  v_pk_fma_f32 v[140:141], v[10:11], v[8:9], v[140:141] op_sel:[1,1,0] op_sel_hi:[1,0,1] neg_lo:[1,0,0]
  v_pk_fma_f32 v[138:139], v[136:137], v[8:9], v[138:139] op_sel:[0,0,0] op_sel_hi:[0,1,1]
  v_pk_fma_f32 v[138:139], v[136:137], v[8:9], v[138:139] op_sel:[1,1,0] op_sel_hi:[1,0,1] neg_lo:[1,0,0]
  v_swap_b32 v141, v138
  v_pk_fma_f32 v[40:41], v[226:227], v[140:141], v[40:41] op_sel:[0,0,0] op_sel_hi:[0,1,1]
  v_pk_fma_f32 v[72:73], v[226:227], v[138:139], v[72:73] op_sel:[0,0,0] op_sel_hi:[0,1,1]
  v_pk_fma_f32 v[40:41], v[226:227], v[138:139], v[40:41] op_sel:[1,0,0] op_sel_hi:[1,1,1] neg_lo:[1,0,0] neg_hi:[1,0,0]
  v_pk_fma_f32 v[72:73], v[226:227], v[140:141], v[72:73] op_sel:[1,0,0] op_sel_hi:[1,1,1]
  v_cvt_pk_bf16_f32 v12, v40, v41
  v_cvt_pk_bf16_f32 v13, -v72, -v73
  v_pk_fma_f32 v[42:43], v[226:227], v[40:41], v[42:43] op_sel:[0,0,0] op_sel_hi:[0,1,1]
  v_pk_fma_f32 v[74:75], v[226:227], v[72:73], v[74:75] op_sel:[0,0,0] op_sel_hi:[0,1,1]
  v_pk_fma_f32 v[42:43], v[226:227], v[72:73], v[42:43] op_sel:[1,0,0] op_sel_hi:[1,1,1] neg_lo:[1,0,0] neg_hi:[1,0,0]
  v_pk_fma_f32 v[74:75], v[226:227], v[40:41], v[74:75] op_sel:[1,0,0] op_sel_hi:[1,1,1]
  v_cvt_pk_bf16_f32 v14, v42, v43
  v_cvt_pk_bf16_f32 v15, -v74, -v75
  v_pk_fma_f32 v[44:45], v[226:227], v[42:43], v[44:45] op_sel:[0,0,0] op_sel_hi:[0,1,1]
  v_pk_fma_f32 v[76:77], v[226:227], v[74:75], v[76:77] op_sel:[0,0,0] op_sel_hi:[0,1,1]
  v_permlane32_swap_b32 v12, v13
  v_permlane32_swap_b32 v14, v15
  v_pk_fma_f32 v[44:45], v[226:227], v[74:75], v[44:45] op_sel:[1,0,0] op_sel_hi:[1,1,1] neg_lo:[1,0,0] neg_hi:[1,0,0]
  v_pk_fma_f32 v[76:77], v[226:227], v[42:43], v[76:77] op_sel:[1,0,0] op_sel_hi:[1,1,1]
  v_permlane16_swap_b32 v12, v14
  v_permlane16_swap_b32 v13, v15
  buffer_store_dwordx4 v[12:15], v58, s[80:83], s78 offen sc1
  s_add_u32 s78, s78, 1048576
  v_cvt_pk_bf16_f32 v16, v44, v45
  v_cvt_pk_bf16_f32 v17, -v76, -v77
  v_pk_fma_f32 v[46:47], v[226:227], v[44:45], v[46:47] op_sel:[0,0,0] op_sel_hi:[0,1,1]
  v_pk_fma_f32 v[78:79], v[226:227], v[76:77], v[78:79] op_sel:[0,0,0] op_sel_hi:[0,1,1]
  v_pk_fma_f32 v[46:47], v[226:227], v[76:77], v[46:47] op_sel:[1,0,0] op_sel_hi:[1,1,1] neg_lo:[1,0,0] neg_hi:[1,0,0]
  v_pk_fma_f32 v[78:79], v[226:227], v[44:45], v[78:79] op_sel:[1,0,0] op_sel_hi:[1,1,1]
  v_cvt_pk_bf16_f32 v18, v46, v47
  v_cvt_pk_bf16_f32 v19, -v78, -v79
  v_pk_fma_f32 v[48:49], v[226:227], v[46:47], v[48:49] op_sel:[0,0,0] op_sel_hi:[0,1,1]
  v_pk_fma_f32 v[80:81], v[226:227], v[78:79], v[80:81] op_sel:[0,0,0] op_sel_hi:[0,1,1]
  v_permlane32_swap_b32 v16, v17
  v_permlane32_swap_b32 v18, v19
  v_pk_fma_f32 v[48:49], v[226:227], v[78:79], v[48:49] op_sel:[1,0,0] op_sel_hi:[1,1,1] neg_lo:[1,0,0] neg_hi:[1,0,0]
  v_pk_fma_f32 v[80:81], v[226:227], v[46:47], v[80:81] op_sel:[1,0,0] op_sel_hi:[1,1,1]
  v_permlane16_swap_b32 v16, v18
  v_permlane16_swap_b32 v17, v19
  buffer_store_dwordx4 v[16:19], v58, s[80:83], s78 offen sc1
  s_add_u32 s78, s78, 1048576
  v_cvt_pk_bf16_f32 v20, v48, v49
  v_cvt_pk_bf16_f32 v21, -v80, -v81
  v_pk_fma_f32 v[50:51], v[226:227], v[48:49], v[50:51] op_sel:[0,0,0] op_sel_hi:[0,1,1]
  v_pk_fma_f32 v[82:83], v[226:227], v[80:81], v[82:83] op_sel:[0,0,0] op_sel_hi:[0,1,1]
  v_pk_fma_f32 v[50:51], v[226:227], v[80:81], v[50:51] op_sel:[1,0,0] op_sel_hi:[1,1,1] neg_lo:[1,0,0] neg_hi:[1,0,0]
  v_pk_fma_f32 v[82:83], v[226:227], v[48:49], v[82:83] op_sel:[1,0,0] op_sel_hi:[1,1,1]
  v_cvt_pk_bf16_f32 v22, v50, v51
  v_cvt_pk_bf16_f32 v23, -v82, -v83
  v_pk_fma_f32 v[52:53], v[226:227], v[50:51], v[52:53] op_sel:[0,0,0] op_sel_hi:[0,1,1]
  v_pk_fma_f32 v[84:85], v[226:227], v[82:83], v[84:85] op_sel:[0,0,0] op_sel_hi:[0,1,1]
  v_permlane32_swap_b32 v20, v21
  v_permlane32_swap_b32 v22, v23
  v_pk_fma_f32 v[52:53], v[226:227], v[82:83], v[52:53] op_sel:[1,0,0] op_sel_hi:[1,1,1] neg_lo:[1,0,0] neg_hi:[1,0,0]
  v_pk_fma_f32 v[84:85], v[226:227], v[50:51], v[84:85] op_sel:[1,0,0] op_sel_hi:[1,1,1]
  v_permlane16_swap_b32 v20, v22
  v_permlane16_swap_b32 v21, v23
  buffer_store_dwordx4 v[20:23], v58, s[80:83], s78 offen sc1
  s_add_u32 s78, s78, 1048576
  v_cvt_pk_bf16_f32 v12, v52, v53
  v_cvt_pk_bf16_f32 v13, -v84, -v85
  v_pk_fma_f32 v[54:55], v[226:227], v[52:53], v[54:55] op_sel:[0,0,0] op_sel_hi:[0,1,1]
  v_pk_fma_f32 v[86:87], v[226:227], v[84:85], v[86:87] op_sel:[0,0,0] op_sel_hi:[0,1,1]
  v_pk_fma_f32 v[54:55], v[226:227], v[84:85], v[54:55] op_sel:[1,0,0] op_sel_hi:[1,1,1] neg_lo:[1,0,0] neg_hi:[1,0,0]
  v_pk_fma_f32 v[86:87], v[226:227], v[52:53], v[86:87] op_sel:[1,0,0] op_sel_hi:[1,1,1]
  v_cvt_pk_bf16_f32 v14, v54, v55
  v_cvt_pk_bf16_f32 v15, -v86, -v87
  v_pk_fma_f32 v[88:89], v[226:227], v[54:55], v[88:89] op_sel:[0,0,0] op_sel_hi:[0,1,1]
  v_pk_fma_f32 v[120:121], v[226:227], v[86:87], v[120:121] op_sel:[0,0,0] op_sel_hi:[0,1,1]
  v_permlane32_swap_b32 v12, v13
  v_permlane32_swap_b32 v14, v15
  v_pk_fma_f32 v[88:89], v[226:227], v[86:87], v[88:89] op_sel:[1,0,0] op_sel_hi:[1,1,1] neg_lo:[1,0,0] neg_hi:[1,0,0]
  v_pk_fma_f32 v[120:121], v[226:227], v[54:55], v[120:121] op_sel:[1,0,0] op_sel_hi:[1,1,1]
  v_permlane16_swap_b32 v12, v14
  v_permlane16_swap_b32 v13, v15
  buffer_store_dwordx4 v[12:15], v58, s[80:83], s78 offen sc1
  s_add_u32 s78, s78, 1048576
  v_cvt_pk_bf16_f32 v16, v88, v89
  v_cvt_pk_bf16_f32 v17, -v120, -v121
  v_pk_fma_f32 v[90:91], v[226:227], v[88:89], v[90:91] op_sel:[0,0,0] op_sel_hi:[0,1,1]
  v_pk_fma_f32 v[122:123], v[226:227], v[120:121], v[122:123] op_sel:[0,0,0] op_sel_hi:[0,1,1]
  v_pk_fma_f32 v[90:91], v[226:227], v[120:121], v[90:91] op_sel:[1,0,0] op_sel_hi:[1,1,1] neg_lo:[1,0,0] neg_hi:[1,0,0]
  v_pk_fma_f32 v[122:123], v[226:227], v[88:89], v[122:123] op_sel:[1,0,0] op_sel_hi:[1,1,1]
  v_cvt_pk_bf16_f32 v18, v90, v91
  v_cvt_pk_bf16_f32 v19, -v122, -v123
  v_pk_fma_f32 v[92:93], v[226:227], v[90:91], v[92:93] op_sel:[0,0,0] op_sel_hi:[0,1,1]
  v_pk_fma_f32 v[124:125], v[226:227], v[122:123], v[124:125] op_sel:[0,0,0] op_sel_hi:[0,1,1]
  v_permlane32_swap_b32 v16, v17
  v_permlane32_swap_b32 v18, v19
  v_pk_fma_f32 v[92:93], v[226:227], v[122:123], v[92:93] op_sel:[1,0,0] op_sel_hi:[1,1,1] neg_lo:[1,0,0] neg_hi:[1,0,0]
  v_pk_fma_f32 v[124:125], v[226:227], v[90:91], v[124:125] op_sel:[1,0,0] op_sel_hi:[1,1,1]
  v_permlane16_swap_b32 v16, v18
  v_permlane16_swap_b32 v17, v19
  buffer_store_dwordx4 v[16:19], v58, s[80:83], s78 offen sc1
  s_add_u32 s78, s78, 1048576
  v_cvt_pk_bf16_f32 v20, v92, v93
  v_cvt_pk_bf16_f32 v21, -v124, -v125
  v_pk_fma_f32 v[94:95], v[226:227], v[92:93], v[94:95] op_sel:[0,0,0] op_sel_hi:[0,1,1]
  v_pk_fma_f32 v[126:127], v[226:227], v[124:125], v[126:127] op_sel:[0,0,0] op_sel_hi:[0,1,1]
  v_pk_fma_f32 v[94:95], v[226:227], v[124:125], v[94:95] op_sel:[1,0,0] op_sel_hi:[1,1,1] neg_lo:[1,0,0] neg_hi:[1,0,0]
  v_pk_fma_f32 v[126:127], v[226:227], v[92:93], v[126:127] op_sel:[1,0,0] op_sel_hi:[1,1,1]
  v_cvt_pk_bf16_f32 v22, v94, v95
  v_cvt_pk_bf16_f32 v23, -v126, -v127
  v_pk_fma_f32 v[96:97], v[226:227], v[94:95], v[96:97] op_sel:[0,0,0] op_sel_hi:[0,1,1]
  v_pk_fma_f32 v[128:129], v[226:227], v[126:127], v[128:129] op_sel:[0,0,0] op_sel_hi:[0,1,1]
  v_permlane32_swap_b32 v20, v21
  v_permlane32_swap_b32 v22, v23
  v_pk_fma_f32 v[96:97], v[226:227], v[126:127], v[96:97] op_sel:[1,0,0] op_sel_hi:[1,1,1] neg_lo:[1,0,0] neg_hi:[1,0,0]
  v_pk_fma_f32 v[128:129], v[226:227], v[94:95], v[128:129] op_sel:[1,0,0] op_sel_hi:[1,1,1]
  v_permlane16_swap_b32 v20, v22
  v_permlane16_swap_b32 v21, v23
  buffer_store_dwordx4 v[20:23], v58, s[80:83], s78 offen sc1
  s_add_u32 s78, s78, 1048576
  v_cvt_pk_bf16_f32 v12, v96, v97
  v_cvt_pk_bf16_f32 v13, -v128, -v129
  v_pk_fma_f32 v[98:99], v[226:227], v[96:97], v[98:99] op_sel:[0,0,0] op_sel_hi:[0,1,1]
  v_pk_fma_f32 v[130:131], v[226:227], v[128:129], v[130:131] op_sel:[0,0,0] op_sel_hi:[0,1,1]
  v_pk_fma_f32 v[98:99], v[226:227], v[128:129], v[98:99] op_sel:[1,0,0] op_sel_hi:[1,1,1] neg_lo:[1,0,0] neg_hi:[1,0,0]
  v_pk_fma_f32 v[130:131], v[226:227], v[96:97], v[130:131] op_sel:[1,0,0] op_sel_hi:[1,1,1]
  v_cvt_pk_bf16_f32 v14, v98, v99
  v_cvt_pk_bf16_f32 v15, -v130, -v131
  v_pk_fma_f32 v[100:101], v[226:227], v[98:99], v[100:101] op_sel:[0,0,0] op_sel_hi:[0,1,1]
  v_pk_fma_f32 v[132:133], v[226:227], v[130:131], v[132:133] op_sel:[0,0,0] op_sel_hi:[0,1,1]
  v_permlane32_swap_b32 v12, v13
  v_permlane32_swap_b32 v14, v15
  v_pk_fma_f32 v[100:101], v[226:227], v[130:131], v[100:101] op_sel:[1,0,0] op_sel_hi:[1,1,1] neg_lo:[1,0,0] neg_hi:[1,0,0]
  v_pk_fma_f32 v[132:133], v[226:227], v[98:99], v[132:133] op_sel:[1,0,0] op_sel_hi:[1,1,1]
  v_permlane16_swap_b32 v12, v14
  v_permlane16_swap_b32 v13, v15
  buffer_store_dwordx4 v[12:15], v58, s[80:83], s78 offen sc1
  s_add_u32 s78, s78, 1048576
  v_cvt_pk_bf16_f32 v16, v100, v101
  v_cvt_pk_bf16_f32 v17, -v132, -v133
  v_pk_fma_f32 v[102:103], v[226:227], v[100:101], v[102:103] op_sel:[0,0,0] op_sel_hi:[0,1,1]
  v_pk_fma_f32 v[134:135], v[226:227], v[132:133], v[134:135] op_sel:[0,0,0] op_sel_hi:[0,1,1]
  v_pk_fma_f32 v[102:103], v[226:227], v[132:133], v[102:103] op_sel:[1,0,0] op_sel_hi:[1,1,1] neg_lo:[1,0,0] neg_hi:[1,0,0]
  v_pk_fma_f32 v[134:135], v[226:227], v[100:101], v[134:135] op_sel:[1,0,0] op_sel_hi:[1,1,1]
  v_cvt_pk_bf16_f32 v18, v102, v103
  v_cvt_pk_bf16_f32 v19, -v134, -v135
  v_permlane32_swap_b32 v16, v17
  s_nop 0
  v_permlane32_swap_b32 v18, v19
  s_nop 1
  v_permlane16_swap_b32 v16, v18
  v_permlane16_swap_b32 v17, v19
  buffer_store_dwordx4 v[16:19], v58, s[80:83], s78 offen sc1
  s_cmp_lg_u32 s55, 0
  s_cbranch_scc1 gated_mix__spectral_gfnet__ssm_conv_s5__prompt_kernel_skip30
  s_mul_i32 exec_lo, s77, 0x300
  s_or_b32 exec_lo, exec_lo, 0xff
  s_mov_b32 exec_hi, 0
  ds_read_u16_d16_hi v64, v68
  ds_read_u16_d16_hi v65, v68 offset:1024
  s_waitcnt lgkmcnt(1)
  v_add_f32 v64, v64, v248
  s_waitcnt lgkmcnt(0)
  v_sub_f32 v65, v65, v249
  v_mul_f32 v64, 0.5, v64
  v_mul_f32 v65, 0.5, v65
  v_cvt_pk_bf16_f32 v64, v64, v65
  ds_write_b16 v68, v64
  ds_write_b16_d16_hi v68, v64 offset:1024
  s_mov_b64 exec, -1
gated_mix__spectral_gfnet__ssm_conv_s5__prompt_kernel_skip30:
  s_cmp_eq_u32 s77, 0
  s_cbranch_scc1 gated_mix__spectral_gfnet__ssm_conv_s5__prompt_kernel_skip31
  v_add_u32 v61, 147456, v38
  ds_read_u16_d16_hi v64, v61 offset:0
  ds_read_u16_d16_hi v72, v61 offset:1024
  ds_read_u16_d16_hi v65, v61 offset:128
  ds_read_u16_d16_hi v73, v61 offset:1152
  ds_read_u16_d16_hi v66, v61 offset:256
  ds_read_u16_d16_hi v74, v61 offset:1280
  ds_read_u16_d16_hi v67, v61 offset:384
  ds_read_u16_d16_hi v75, v61 offset:1408
gated_mix__spectral_gfnet__ssm_conv_s5__prompt_kernel_skip31:
  ds_read_u16_d16_hi v8, v38 offset:0
  ds_read_u16_d16_hi v12, v38 offset:1024
  ds_read_u16_d16_hi v9, v38 offset:128
  ds_read_u16_d16_hi v13, v38 offset:1152
  ds_read_u16_d16_hi v10, v38 offset:256
  ds_read_u16_d16_hi v14, v38 offset:1280
  ds_read_u16_d16_hi v11, v38 offset:384
  ds_read_u16_d16_hi v15, v38 offset:1408
  ds_read_u16_d16_hi v16, v38 offset:16384
  ds_read_u16_d16_hi v20, v38 offset:17408
  ds_read_u16_d16_hi v17, v38 offset:16512
  ds_read_u16_d16_hi v21, v38 offset:17536
  ds_read_u16_d16_hi v18, v38 offset:16640
  ds_read_u16_d16_hi v22, v38 offset:17664
  ds_read_u16_d16_hi v19, v38 offset:16768
  ds_read_u16_d16_hi v23, v38 offset:17792
  v_add_u32 v61, 81920, v38
  ds_read_u16_d16_hi v40, v61 offset:0
  ds_read_u16_d16_hi v44, v61 offset:1024
  ds_read_u16_d16_hi v41, v61 offset:128
  ds_read_u16_d16_hi v45, v61 offset:1152
  ds_read_u16_d16_hi v42, v61 offset:256
  ds_read_u16_d16_hi v46, v61 offset:1280
  ds_read_u16_d16_hi v43, v61 offset:384
  ds_read_u16_d16_hi v47, v61 offset:1408
  ds_read_u16_d16_hi v48, v38 offset:32768
  ds_read_u16_d16_hi v52, v38 offset:33792
  ds_read_u16_d16_hi v49, v38 offset:32896
  ds_read_u16_d16_hi v53, v38 offset:33920
  ds_read_u16_d16_hi v50, v38 offset:33024
  ds_read_u16_d16_hi v54, v38 offset:34048
  ds_read_u16_d16_hi v51, v38 offset:33152
  ds_read_u16_d16_hi v55, v38 offset:34176
  v_xor_b32 v222, 0x30000, v222
  v_xor_b32 v223, 0x30000, v223
  ds_read_b128 a[0:3], v222 offset:0
  ds_read_b128 a[4:7], v223 offset:0
  ds_read_b128 a[8:11], v222 offset:2048
  ds_read_b128 a[12:15], v223 offset:2048
  v_xor_b32 v222, 0x30000, v222
  v_xor_b32 v223, 0x30000, v223
  ds_read_b128 a[16:19], v222 offset:0
  ds_read_b128 a[20:23], v223 offset:0
  ds_read_b128 a[24:27], v222 offset:2048
  ds_read_b128 a[28:31], v223 offset:2048
  s_waitcnt vmcnt(8)
  ds_read_b128 a[32:35], v222 offset:49152
  ds_read_b128 a[36:39], v223 offset:49152
  ds_read_b128 a[40:43], v222 offset:51200
  ds_read_b128 a[44:47], v223 offset:51200
  s_waitcnt lgkmcnt(12)
  v_pk_mul_f32 v[12:13], v[224:225], v[12:13] op_sel_hi:[0,1]
  v_pk_mul_f32 v[14:15], v[224:225], v[14:15] op_sel_hi:[0,1]
  v_pk_mul_f32 v[20:21], v[224:225], v[20:21] op_sel_hi:[0,1]
  v_pk_mul_f32 v[22:23], v[224:225], v[22:23] op_sel_hi:[0,1]
  v_pk_mul_f32 v[44:45], v[224:225], v[44:45] op_sel_hi:[0,1]
  v_pk_mul_f32 v[46:47], v[224:225], v[46:47] op_sel_hi:[0,1]
  v_pk_mul_f32 v[52:53], v[224:225], v[52:53] op_sel_hi:[0,1]
  v_pk_mul_f32 v[54:55], v[224:225], v[54:55] op_sel_hi:[0,1]
  v_pk_mul_f32 v[72:73], v[224:225], v[72:73] op_sel_hi:[0,1]
  v_pk_mul_f32 v[74:75], v[224:225], v[74:75] op_sel_hi:[0,1]
  s_cmp_lg_u32 s3, 3
  s_cbranch_scc1 gated_mix__spectral_gfnet__ssm_conv_s5__prompt_kernel_skip33
  s_getpc_b64 s[6:7]
gated_mix__spectral_gfnet__ssm_conv_s5__prompt_kernel_pc32:
  s_lshr_b32 s33, s2, 3
  s_mul_i32 s33, s33, 640
  v_min_u32 v38, 4, v1
  v_lshl_add_u32 v38, v38, 7, s33
  v_min_u32 v38, gated_mix__spectral_gfnet__ssm_conv_s5__prompt_kernel_end-gated_mix__spectral_gfnet__ssm_conv_s5__prompt_kernel_pc32, v38
  v_mov_b32 v39, 0
  v_lshl_add_u64 v[38:39], v[38:39], 0, s[6:7]
  global_load_dword v4, v[38:39], off
gated_mix__spectral_gfnet__ssm_conv_s5__prompt_kernel_skip33:
  s_barrier
  s_cmp_lg_u32 s3, 0
  s_cbranch_scc1 gated_mix__spectral_gfnet__ssm_conv_s5__prompt_kernel_skip34
  v_lshlrev_b32 v38, 2, v2
  v_add_u32 v39, 155648, v38
  ds_read_b32 v39, v39
  s_lshl_b32 s33, s39, 11
  s_lshl_b32 s43, s38, 7
  s_add_u32 s33, s33, s43
  s_mov_b64 exec, 0xffff
  s_waitcnt lgkmcnt(0)
  buffer_store_dword v39, v38, s[88:91], s33 offen sc1
  s_mov_b64 exec, -1
gated_mix__spectral_gfnet__ssm_conv_s5__prompt_kernel_skip34:
  s_lshr_b32 s33, s41, 3
  s_lshl2_add_u32 s33, s33, s3
  s_lshl_b32 s33, s33, 12
  v_lshl_add_u32 v5, v1, 7, s33
  s_add_u32 m0, s32, 98304
  s_nop 0
  buffer_load_dwordx4 v216, s[24:27], s29 offen offset:0 lds
  s_and_b32 s33, s3, 1
  s_lshl_b32 s33, s33, 2
  v_xor_b32 v38, s33, v1
  s_lshl_b32 s33, s3, 12
  s_add_u32 s33, s33, 49152
  v_lshl_add_u32 v39, v38, 4, s33
  v_xor_b32 v38, 0, v39
  ds_read_b128 v[68:71], v38 offset:0
  v_xor_b32 v38, 16, v39
  ds_read_b128 v[76:79], v38 offset:1024
  v_xor_b32 v38, 32, v39
  ds_read_b128 v[80:83], v38 offset:2048
  v_xor_b32 v38, 48, v39
  ds_read_b128 v[84:87], v38 offset:3072
  s_waitcnt lgkmcnt(3)
  v_mfma_f32_16x16x32_bf16 v[88:91], v[68:71], v[112:115], 0
  v_mfma_f32_16x16x32_bf16 v[92:95], v[68:71], v[116:119], 0
  buffer_load_dwordx4 v217, s[24:27], s29 offen offset:1024 lds
  s_waitcnt lgkmcnt(2)
  v_mfma_f32_16x16x32_bf16 v[96:99], v[76:79], v[112:115], 0
  v_mfma_f32_16x16x32_bf16 v[100:103], v[76:79], v[116:119], 0
  s_waitcnt lgkmcnt(1)
  v_mfma_f32_16x16x32_bf16 v[104:107], v[80:83], v[112:115], 0
  v_mfma_f32_16x16x32_bf16 v[108:111], v[80:83], v[116:119], 0
  s_waitcnt lgkmcnt(0)
  v_mfma_f32_16x16x32_bf16 v[120:123], v[84:87], v[112:115], 0
  s_add_u32 m0, s32, 100352
  s_nop 0
  buffer_load_dwordx4 v218, s[24:27], s29 offen offset:0 lds
  v_mfma_f32_16x16x32_bf16 v[124:127], v[84:87], v[116:119], 0
  v_pk_mul_f32 v[128:129], v[88:89], v[200:201]
  v_pk_mul_f32 v[130:131], v[92:93], v[200:201]
  v_pk_fma_f32 v[128:129], v[92:93], v[204:205], v[128:129]
  v_pk_fma_f32 v[130:131], v[88:89], v[204:205], v[130:131] neg_lo:[0,1,0] neg_hi:[0,1,0]
  v_cvt_pk_bf16_f32 v68, v128, v130
  v_cvt_pk_bf16_f32 v69, v129, v131
  v_pk_mul_f32 v[128:129], v[90:91], v[202:203]
  v_pk_mul_f32 v[130:131], v[94:95], v[202:203]
  v_pk_fma_f32 v[128:129], v[94:95], v[206:207], v[128:129]
  v_pk_fma_f32 v[130:131], v[90:91], v[206:207], v[130:131] neg_lo:[0,1,0] neg_hi:[0,1,0]
  v_cvt_pk_bf16_f32 v70, v128, v130
  v_cvt_pk_bf16_f32 v71, v129, v131
  v_pk_mul_f32 v[128:129], v[96:97], v[200:201]
  v_pk_mul_f32 v[130:131], v[100:101], v[200:201]
  v_pk_fma_f32 v[128:129], v[100:101], v[204:205], v[128:129]
  v_pk_fma_f32 v[130:131], v[96:97], v[204:205], v[130:131] neg_lo:[0,1,0] neg_hi:[0,1,0]
  buffer_load_dwordx4 v219, s[24:27], s29 offen offset:1024 lds
  s_add_u32 s29, s29, 128
  s_and_b32 s29, s29, 0x3ff
  v_cvt_pk_bf16_f32 v76, v128, v130
  v_cvt_pk_bf16_f32 v77, v129, v131
  v_pk_mul_f32 v[128:129], v[98:99], v[202:203]
  v_pk_mul_f32 v[130:131], v[102:103], v[202:203]
  v_pk_fma_f32 v[128:129], v[102:103], v[206:207], v[128:129]
  v_pk_fma_f32 v[130:131], v[98:99], v[206:207], v[130:131] neg_lo:[0,1,0] neg_hi:[0,1,0]
  v_cvt_pk_bf16_f32 v78, v128, v130
  v_cvt_pk_bf16_f32 v79, v129, v131
  v_mfma_f32_16x16x32_bf16 v[88:91], a[224:227], v[68:71], 0
  v_mfma_f32_16x16x32_bf16 v[92:95], a[228:231], v[68:71], 0
  v_pk_mul_f32 v[128:129], v[104:105], v[200:201]
  v_pk_mul_f32 v[130:131], v[108:109], v[200:201]
  v_pk_fma_f32 v[128:129], v[108:109], v[204:205], v[128:129]
  v_pk_fma_f32 v[130:131], v[104:105], v[204:205], v[130:131] neg_lo:[0,1,0] neg_hi:[0,1,0]
  s_add_u32 m0, s32, 131072
  s_nop 0
  buffer_load_dwordx4 v216, s[12:15], s29 offen offset:0 lds
  v_cvt_pk_bf16_f32 v80, v128, v130
  v_cvt_pk_bf16_f32 v81, v129, v131
  v_pk_mul_f32 v[128:129], v[106:107], v[202:203]
  v_pk_mul_f32 v[130:131], v[110:111], v[202:203]
  v_pk_fma_f32 v[128:129], v[110:111], v[206:207], v[128:129]
  v_pk_fma_f32 v[130:131], v[106:107], v[206:207], v[130:131] neg_lo:[0,1,0] neg_hi:[0,1,0]
  v_cvt_pk_bf16_f32 v82, v128, v130
  v_cvt_pk_bf16_f32 v83, v129, v131
  v_mfma_f32_16x16x32_bf16 v[96:99], a[224:227], v[76:79], 0
  v_mfma_f32_16x16x32_bf16 v[100:103], a[228:231], v[76:79], 0
  v_pk_mul_f32 v[128:129], v[120:121], v[200:201]
  v_pk_mul_f32 v[130:131], v[124:125], v[200:201]
  v_pk_fma_f32 v[128:129], v[124:125], v[204:205], v[128:129]
  v_pk_fma_f32 v[130:131], v[120:121], v[204:205], v[130:131] neg_lo:[0,1,0] neg_hi:[0,1,0]
  buffer_load_dwordx4 v217, s[12:15], s29 offen offset:1024 lds
  v_cvt_pk_bf16_f32 v84, v128, v130
  v_cvt_pk_bf16_f32 v85, v129, v131
  v_pk_mul_f32 v[128:129], v[122:123], v[202:203]
  v_pk_mul_f32 v[130:131], v[126:127], v[202:203]
  v_pk_fma_f32 v[128:129], v[126:127], v[206:207], v[128:129]
  v_pk_fma_f32 v[130:131], v[122:123], v[206:207], v[130:131] neg_lo:[0,1,0] neg_hi:[0,1,0]
  v_cvt_pk_bf16_f32 v86, v128, v130
  v_cvt_pk_bf16_f32 v87, v129, v131
  v_mfma_f32_16x16x32_bf16 v[104:107], a[224:227], v[80:83], 0
  v_mfma_f32_16x16x32_bf16 v[108:111], a[228:231], v[80:83], 0
  v_mfma_f32_16x16x32_bf16 v[120:123], a[224:227], v[84:87], 0
  s_add_u32 m0, s32, 133120
  s_nop 0
  buffer_load_dwordx4 v218, s[12:15], s29 offen offset:0 lds
  v_mfma_f32_16x16x32_bf16 v[124:127], a[228:231], v[84:87], 0
  s_waitcnt vmcnt(7)
  s_barrier
  s_cmp_lg_u32 s3, 0
  s_cbranch_scc1 gated_mix__spectral_gfnet__ssm_conv_s5__prompt_kernel_skip35
  s_mov_b64 exec, 65535
  buffer_store_dword v7, v57, s[16:19], s28 offen sc1
  s_mov_b64 exec, -1
gated_mix__spectral_gfnet__ssm_conv_s5__prompt_kernel_skip35:
  s_cmp_eq_u32 s5, 0
  s_cbranch_scc1 gated_mix__spectral_gfnet__ssm_conv_s5__prompt_kernel_skip36
  v_pk_mul_f32 v[128:129], v[88:89], v[64:65]
  v_pk_mul_f32 v[130:131], v[92:93], v[64:65]
  v_pk_fma_f32 v[128:129], v[92:93], v[72:73], v[128:129] neg_lo:[0,1,0] neg_hi:[0,1,0]
  v_pk_fma_f32 v[130:131], v[88:89], v[72:73], v[130:131]
  v_cvt_pk_bf16_f32 v132, v128, v130
  v_cvt_pk_bf16_f32 v133, v129, v131
  v_pk_mul_f32 v[128:129], v[90:91], v[66:67]
  v_pk_mul_f32 v[130:131], v[94:95], v[66:67]
  v_pk_fma_f32 v[128:129], v[94:95], v[74:75], v[128:129] neg_lo:[0,1,0] neg_hi:[0,1,0]
  v_pk_fma_f32 v[130:131], v[90:91], v[74:75], v[130:131]
  v_cvt_pk_bf16_f32 v134, v128, v130
  v_cvt_pk_bf16_f32 v135, v129, v131
  s_nop 1
  v_mfma_f32_16x16x32_bf16 v[64:67], v[132:135], a[232:235], 0
  v_mfma_f32_16x16x32_bf16 v[72:75], v[132:135], a[236:239], 0
  s_nop 6
  v_pk_mul_f32 v[128:129], v[64:65], v[208:209]
  v_pk_mul_f32 v[130:131], v[72:73], v[208:209]
  v_pk_fma_f32 v[128:129], v[72:73], v[212:213], v[128:129] neg_lo:[0,1,0] neg_hi:[0,1,0]
  v_pk_fma_f32 v[130:131], v[64:65], v[212:213], v[130:131]
  v_cvt_pk_bf16_f32 v132, v128, v130
  v_cvt_pk_bf16_f32 v133, v129, v131
  v_pk_mul_f32 v[128:129], v[66:67], v[210:211]
  v_pk_mul_f32 v[130:131], v[74:75], v[210:211]
  v_pk_fma_f32 v[128:129], v[74:75], v[214:215], v[128:129] neg_lo:[0,1,0] neg_hi:[0,1,0]
  v_pk_fma_f32 v[130:131], v[66:67], v[214:215], v[130:131]
  v_cvt_pk_bf16_f32 v134, v128, v130
  v_cvt_pk_bf16_f32 v135, v129, v131
  s_nop 1
  v_mfma_f32_16x16x32_bf16 v[64:67], a[240:243], v[132:135], 0
  v_mfma_f32_16x16x32_bf16 v[72:75], a[244:247], v[132:135], 0
gated_mix__spectral_gfnet__ssm_conv_s5__prompt_kernel_skip36:
  v_pk_mul_f32 v[128:129], v[88:89], v[8:9]
  v_pk_mul_f32 v[130:131], v[92:93], v[8:9]
  v_pk_fma_f32 v[128:129], v[92:93], v[12:13], v[128:129] neg_lo:[0,1,0] neg_hi:[0,1,0]
  v_pk_fma_f32 v[130:131], v[88:89], v[12:13], v[130:131]
  v_cvt_pk_bf16_f32 v68, v128, v130
  v_cvt_pk_bf16_f32 v69, v129, v131
  v_pk_mul_f32 v[128:129], v[90:91], v[10:11]
  v_pk_mul_f32 v[130:131], v[94:95], v[10:11]
  v_pk_fma_f32 v[128:129], v[94:95], v[14:15], v[128:129] neg_lo:[0,1,0] neg_hi:[0,1,0]
  v_pk_fma_f32 v[130:131], v[90:91], v[14:15], v[130:131]
  v_cvt_pk_bf16_f32 v70, v128, v130
  buffer_load_dwordx4 v219, s[12:15], s29 offen offset:1024 lds
  v_cvt_pk_bf16_f32 v71, v129, v131
  v_pk_mul_f32 v[128:129], v[96:97], v[16:17]
  v_pk_mul_f32 v[130:131], v[100:101], v[16:17]
  v_pk_fma_f32 v[128:129], v[100:101], v[20:21], v[128:129] neg_lo:[0,1,0] neg_hi:[0,1,0]
  v_pk_fma_f32 v[130:131], v[96:97], v[20:21], v[130:131]
  v_cvt_pk_bf16_f32 v76, v128, v130
  v_cvt_pk_bf16_f32 v77, v129, v131
  v_pk_mul_f32 v[128:129], v[98:99], v[18:19]
  v_pk_mul_f32 v[130:131], v[102:103], v[18:19]
  v_pk_fma_f32 v[128:129], v[102:103], v[22:23], v[128:129] neg_lo:[0,1,0] neg_hi:[0,1,0]
  v_pk_fma_f32 v[130:131], v[98:99], v[22:23], v[130:131]
  v_cvt_pk_bf16_f32 v78, v128, v130
  v_cvt_pk_bf16_f32 v79, v129, v131
  v_mfma_f32_16x16x32_bf16 v[88:91], v[68:71], a[232:235], 0
  v_mfma_f32_16x16x32_bf16 v[92:95], v[68:71], a[236:239], 0
  s_add_u32 m0, s32, 65536
  s_nop 0
  buffer_load_dwordx4 v216, s[24:27], s29 offen offset:0 lds
  v_pk_mul_f32 v[128:129], v[104:105], v[40:41]
  v_pk_mul_f32 v[130:131], v[108:109], v[40:41]
  v_pk_fma_f32 v[128:129], v[108:109], v[44:45], v[128:129] neg_lo:[0,1,0] neg_hi:[0,1,0]
  v_pk_fma_f32 v[130:131], v[104:105], v[44:45], v[130:131]
  v_cvt_pk_bf16_f32 v80, v128, v130
  v_cvt_pk_bf16_f32 v81, v129, v131
  v_pk_mul_f32 v[128:129], v[106:107], v[42:43]
  v_pk_mul_f32 v[130:131], v[110:111], v[42:43]
  v_pk_fma_f32 v[128:129], v[110:111], v[46:47], v[128:129] neg_lo:[0,1,0] neg_hi:[0,1,0]
  v_pk_fma_f32 v[130:131], v[106:107], v[46:47], v[130:131]
  v_cvt_pk_bf16_f32 v82, v128, v130
  v_cvt_pk_bf16_f32 v83, v129, v131
  v_mfma_f32_16x16x32_bf16 v[96:99], v[76:79], a[232:235], 0
  v_mfma_f32_16x16x32_bf16 v[100:103], v[76:79], a[236:239], 0
  buffer_load_dwordx4 v217, s[24:27], s29 offen offset:1024 lds
  v_pk_mul_f32 v[128:129], v[120:121], v[48:49]
  v_pk_mul_f32 v[130:131], v[124:125], v[48:49]
  v_pk_fma_f32 v[128:129], v[124:125], v[52:53], v[128:129] neg_lo:[0,1,0] neg_hi:[0,1,0]
  v_pk_fma_f32 v[130:131], v[120:121], v[52:53], v[130:131]
  v_cvt_pk_bf16_f32 v84, v128, v130
  v_cvt_pk_bf16_f32 v85, v129, v131
  v_pk_mul_f32 v[128:129], v[122:123], v[50:51]
  v_pk_mul_f32 v[130:131], v[126:127], v[50:51]
  v_pk_fma_f32 v[128:129], v[126:127], v[54:55], v[128:129] neg_lo:[0,1,0] neg_hi:[0,1,0]
  v_pk_fma_f32 v[130:131], v[122:123], v[54:55], v[130:131]
  v_cvt_pk_bf16_f32 v86, v128, v130
  v_cvt_pk_bf16_f32 v87, v129, v131
  v_mfma_f32_16x16x32_bf16 v[104:107], v[80:83], a[232:235], 0
  v_mfma_f32_16x16x32_bf16 v[108:111], v[80:83], a[236:239], 0
  s_add_u32 m0, s32, 67584
  s_nop 0
  buffer_load_dwordx4 v218, s[24:27], s29 offen offset:0 lds
  v_mfma_f32_16x16x32_bf16 v[120:123], v[84:87], a[232:235], 0
  v_mfma_f32_16x16x32_bf16 v[124:127], v[84:87], a[236:239], 0
  v_pk_mul_f32 v[128:129], v[88:89], v[208:209]
  v_pk_mul_f32 v[130:131], v[92:93], v[208:209]
  v_pk_fma_f32 v[128:129], v[92:93], v[212:213], v[128:129] neg_lo:[0,1,0] neg_hi:[0,1,0]
  v_pk_fma_f32 v[130:131], v[88:89], v[212:213], v[130:131]
  v_cvt_pk_bf16_f32 v68, v128, v130
  v_cvt_pk_bf16_f32 v69, v129, v131
  v_pk_mul_f32 v[128:129], v[90:91], v[210:211]
  v_pk_mul_f32 v[130:131], v[94:95], v[210:211]
  v_pk_fma_f32 v[128:129], v[94:95], v[214:215], v[128:129] neg_lo:[0,1,0] neg_hi:[0,1,0]
  v_pk_fma_f32 v[130:131], v[90:91], v[214:215], v[130:131]
  v_cvt_pk_bf16_f32 v70, v128, v130
  v_cvt_pk_bf16_f32 v71, v129, v131
  buffer_load_dwordx4 v219, s[24:27], s29 offen offset:1024 lds
  s_add_u32 s29, s29, 128
  s_and_b32 s29, s29, 0x3ff
  v_pk_mul_f32 v[128:129], v[96:97], v[208:209]
  v_pk_mul_f32 v[130:131], v[100:101], v[208:209]
  v_pk_fma_f32 v[128:129], v[100:101], v[212:213], v[128:129] neg_lo:[0,1,0] neg_hi:[0,1,0]
  v_pk_fma_f32 v[130:131], v[96:97], v[212:213], v[130:131]
  v_cvt_pk_bf16_f32 v76, v128, v130
  v_cvt_pk_bf16_f32 v77, v129, v131
  v_pk_mul_f32 v[128:129], v[98:99], v[210:211]
  v_pk_mul_f32 v[130:131], v[102:103], v[210:211]
  v_pk_fma_f32 v[128:129], v[102:103], v[214:215], v[128:129] neg_lo:[0,1,0] neg_hi:[0,1,0]
  v_pk_fma_f32 v[130:131], v[98:99], v[214:215], v[130:131]
  v_cvt_pk_bf16_f32 v78, v128, v130
  s_branch gated_mix__spectral_gfnet__ssm_conv_s5__prompt_kernel_isk4
gated_mix__spectral_gfnet__ssm_conv_s5__prompt_kernel_isl4:
  s_branch gated_mix__spectral_gfnet__ssm_conv_s5__prompt_kernel_ret
gated_mix__spectral_gfnet__ssm_conv_s5__prompt_kernel_isk4:
  v_cvt_pk_bf16_f32 v79, v129, v131
  v_mfma_f32_16x16x32_bf16 v[88:91], a[240:243], v[68:71], 0
  v_mfma_f32_16x16x32_bf16 v[92:95], a[244:247], v[68:71], 0
  s_add_u32 m0, s32, 114688
  s_nop 0
  buffer_load_dwordx4 v216, s[12:15], s29 offen offset:0 lds
  v_pk_mul_f32 v[128:129], v[104:105], v[208:209]
  v_pk_mul_f32 v[130:131], v[108:109], v[208:209]
  v_pk_fma_f32 v[128:129], v[108:109], v[212:213], v[128:129] neg_lo:[0,1,0] neg_hi:[0,1,0]
  v_pk_fma_f32 v[130:131], v[104:105], v[212:213], v[130:131]
  v_cvt_pk_bf16_f32 v80, v128, v130
  v_cvt_pk_bf16_f32 v81, v129, v131
  v_pk_mul_f32 v[128:129], v[106:107], v[210:211]
  v_pk_mul_f32 v[130:131], v[110:111], v[210:211]
  v_pk_fma_f32 v[128:129], v[110:111], v[214:215], v[128:129] neg_lo:[0,1,0] neg_hi:[0,1,0]
  v_pk_fma_f32 v[130:131], v[106:107], v[214:215], v[130:131]
  v_cvt_pk_bf16_f32 v82, v128, v130
  v_cvt_pk_bf16_f32 v83, v129, v131
  v_mfma_f32_16x16x32_bf16 v[96:99], a[240:243], v[76:79], 0
  v_mfma_f32_16x16x32_bf16 v[100:103], a[244:247], v[76:79], 0
  buffer_load_dwordx4 v217, s[12:15], s29 offen offset:1024 lds
  v_pk_mul_f32 v[128:129], v[120:121], v[208:209]
  v_pk_mul_f32 v[130:131], v[124:125], v[208:209]
  v_pk_fma_f32 v[128:129], v[124:125], v[212:213], v[128:129] neg_lo:[0,1,0] neg_hi:[0,1,0]
  v_pk_fma_f32 v[130:131], v[120:121], v[212:213], v[130:131]
  v_cvt_pk_bf16_f32 v84, v128, v130
  v_cvt_pk_bf16_f32 v85, v129, v131
  v_pk_mul_f32 v[128:129], v[122:123], v[210:211]
  v_pk_mul_f32 v[130:131], v[126:127], v[210:211]
  v_pk_fma_f32 v[128:129], v[126:127], v[214:215], v[128:129] neg_lo:[0,1,0] neg_hi:[0,1,0]
  v_pk_fma_f32 v[130:131], v[122:123], v[214:215], v[130:131]
  v_cvt_pk_bf16_f32 v86, v128, v130
  v_cvt_pk_bf16_f32 v87, v129, v131
  v_mfma_f32_16x16x32_bf16 v[104:107], a[240:243], v[80:83], 0
  v_mfma_f32_16x16x32_bf16 v[108:111], a[244:247], v[80:83], 0
  s_add_u32 m0, s32, 116736
  s_nop 0
  buffer_load_dwordx4 v218, s[12:15], s29 offen offset:0 lds
  v_mfma_f32_16x16x32_bf16 v[120:123], a[240:243], v[84:87], 0
  v_mfma_f32_16x16x32_bf16 v[124:127], a[244:247], v[84:87], 0
  v_lshlrev_b32 v38, 12, v3
  v_lshl_add_u32 v38, v2, 4, v38
  s_lshl_b32 s33, s3, 8
  s_add_u32 s33, s33, 147456
  v_add_u32 v38, s33, v38
  s_sub_u32 s33, s5, 1
  s_or_b32 s33, s33, s3
  s_cmp_lg_u32 s33, 0
  s_cbranch_scc1 gated_mix__spectral_gfnet__ssm_conv_s5__prompt_kernel_skip37
  v_mov_b32 v92, v72
  v_mov_b32 v93, v73
  v_mov_b32 v94, v74
  v_mov_b32 v95, v75
gated_mix__spectral_gfnet__ssm_conv_s5__prompt_kernel_skip37:
  v_cvt_pk_bf16_f32 v68, v88, v92
  v_cvt_pk_bf16_f32 v69, v96, v100
  v_cvt_pk_bf16_f32 v70, v104, v108
  buffer_load_dwordx4 v219, s[12:15], s29 offen offset:1024 lds
  v_cvt_pk_bf16_f32 v71, v120, v124
  ds_write_b128 v38, v[68:71] offset:0
  v_cvt_pk_bf16_f32 v76, v89, v93
  v_cvt_pk_bf16_f32 v77, v97, v101
  v_cvt_pk_bf16_f32 v78, v105, v109
  v_cvt_pk_bf16_f32 v79, v121, v125
  ds_write_b128 v38, v[76:79] offset:1024
  v_cvt_pk_bf16_f32 v80, v90, v94
  v_cvt_pk_bf16_f32 v81, v98, v102
  v_cvt_pk_bf16_f32 v82, v106, v110
  v_cvt_pk_bf16_f32 v83, v122, v126
  ds_write_b128 v38, v[80:83] offset:2048
  v_cvt_pk_bf16_f32 v84, v91, v95
  v_cvt_pk_bf16_f32 v85, v99, v103
  v_cvt_pk_bf16_f32 v86, v107, v111
  v_cvt_pk_bf16_f32 v87, v123, v127
  ds_write_b128 v38, v[84:87] offset:3072
  s_add_u32 m0, s32, 0
  s_nop 0
  buffer_load_dwordx4 v216, s[24:27], s29 offen offset:0 lds
  buffer_load_dwordx4 v217, s[24:27], s29 offen offset:1024 lds
  s_add_u32 m0, s32, 2048
  s_nop 0
  buffer_load_dwordx4 v218, s[24:27], s29 offen offset:0 lds
  buffer_load_dwordx4 v219, s[24:27], s29 offen offset:1024 lds
  s_add_u32 s29, s29, 128
  s_and_b32 s29, s29, 0x3ff
  s_add_u32 m0, s32, 16384
  s_nop 0
  buffer_load_dwordx4 v216, s[12:15], s29 offen offset:0 lds
  buffer_load_dwordx4 v217, s[12:15], s29 offen offset:1024 lds
  s_add_u32 m0, s32, 18432
  s_nop 0
  buffer_load_dwordx4 v218, s[12:15], s29 offen offset:0 lds
  buffer_load_dwordx4 v219, s[12:15], s29 offen offset:1024 lds
  s_waitcnt lgkmcnt(0)
  s_barrier
  s_lshl_b32 s33, s3, 12
  s_add_u32 s33, s33, 147456
  v_lshl_add_u32 v38, v1, 4, s33
  ds_read_b128 v[8:11], v38 offset:0
  ds_read_b128 v[12:15], v38 offset:1024
  ds_read_b128 v[16:19], v38 offset:2048
  ds_read_b128 v[20:23], v38 offset:3072
  s_mov_b32 s33, 1048576
  v_mul_lo_u32 v38, v3, s33
  v_lshl_add_u32 v38, v2, 2, v38
  s_mul_i32 s43, s3, 65536
  s_lshr_b32 s33, s37, 4
  s_lshl_b32 s33, s33, 12
  s_add_u32 s43, s43, s33
  s_lshl_b32 s33, s36, 10
  s_add_u32 s43, s43, s33
  s_and_b32 s33, s37, 15
  s_lshl_b32 s33, s33, 6
  s_add_u32 s43, s43, s33
  s_waitcnt lgkmcnt(3)
  v_mfma_f32_16x16x32_bf16 v[40:43], a[248:251], v[8:11], 0
  v_mfma_f32_16x16x32_bf16 v[44:47], a[252:255], v[8:11], 0
  s_waitcnt lgkmcnt(2)
  v_mfma_f32_16x16x32_bf16 v[48:51], a[248:251], v[12:15], 0
  v_mfma_f32_16x16x32_bf16 v[52:55], a[252:255], v[12:15], 0
  s_waitcnt lgkmcnt(1)
  v_mfma_f32_16x16x32_bf16 v[64:67], a[248:251], v[16:19], 0
  v_mfma_f32_16x16x32_bf16 v[68:71], a[252:255], v[16:19], 0
  s_waitcnt lgkmcnt(0)
  v_mfma_f32_16x16x32_bf16 v[72:75], a[248:251], v[20:23], 0
  v_mfma_f32_16x16x32_bf16 v[76:79], a[252:255], v[20:23], 0
  v_cvt_pk_bf16_f32 v8, v40, v44
  v_cvt_pk_bf16_f32 v9, v41, v45
  v_cvt_pk_bf16_f32 v10, v42, v46
  v_cvt_pk_bf16_f32 v11, v43, v47
  v_cvt_pk_bf16_f32 v12, v48, v52
  v_cvt_pk_bf16_f32 v13, v49, v53
  v_cvt_pk_bf16_f32 v14, v50, v54
  v_cvt_pk_bf16_f32 v15, v51, v55
  v_cvt_pk_bf16_f32 v16, v64, v68
  v_cvt_pk_bf16_f32 v17, v65, v69
  v_cvt_pk_bf16_f32 v18, v66, v70
  v_cvt_pk_bf16_f32 v19, v67, v71
  v_cvt_pk_bf16_f32 v20, v72, v76
  v_cvt_pk_bf16_f32 v21, v73, v77
  v_cvt_pk_bf16_f32 v22, v74, v78
  v_cvt_pk_bf16_f32 v23, v75, v79
  s_mov_b64 exec, 0xffffffff
  buffer_load_dword v58, v5, s[16:19], s28 offen sc1
  s_mov_b64 exec, -1
  s_waitcnt vmcnt(21)
  ds_read_b128 a[48:51], v222 offset:32768
  ds_read_b128 a[52:55], v223 offset:32768
  ds_read_b128 a[56:59], v222 offset:34816
  ds_read_b128 a[60:63], v223 offset:34816
  v_xor_b32 v222, 0x30000, v222
  v_xor_b32 v223, 0x30000, v223
  s_waitcnt vmcnt(17)
  ds_read_b128 a[64:67], v222 offset:0
  ds_read_b128 a[68:71], v223 offset:0
  ds_read_b128 a[72:75], v222 offset:2048
  ds_read_b128 a[76:79], v223 offset:2048
  v_xor_b32 v222, 0x30000, v222
  v_xor_b32 v223, 0x30000, v223
  s_waitcnt vmcnt(13)
  ds_read_b128 a[80:83], v222 offset:0
  ds_read_b128 a[84:87], v223 offset:0
  ds_read_b128 a[88:91], v222 offset:2048
  ds_read_b128 a[92:95], v223 offset:2048
  s_waitcnt vmcnt(9)
  ds_read_b128 a[96:99], v222 offset:49152
  ds_read_b128 a[100:103], v223 offset:49152
  ds_read_b128 a[104:107], v222 offset:51200
  ds_read_b128 a[108:111], v223 offset:51200
  s_waitcnt vmcnt(5)
  ds_read_b128 a[112:115], v220 offset:0
  ds_read_b128 a[116:119], v221 offset:0
  ds_read_b128 a[120:123], v220 offset:2048
  ds_read_b128 a[124:127], v221 offset:2048
  s_waitcnt vmcnt(1)
  ds_read_b128 a[128:131], v220 offset:16384
  ds_read_b128 a[132:135], v221 offset:16384
  ds_read_b128 a[136:139], v220 offset:18432
  ds_read_b128 a[140:143], v221 offset:18432
  buffer_store_dword v8, v38, s[84:87], s43 offen sc1
  s_add_u32 s43, s43, 262144
  buffer_store_dword v9, v38, s[84:87], s43 offen sc1
  s_add_u32 s43, s43, 262144
  buffer_store_dword v10, v38, s[84:87], s43 offen sc1
  s_add_u32 s43, s43, 262144
  buffer_store_dword v11, v38, s[84:87], s43 offen sc1
  s_sub_u32 s43, s43, 770048
  buffer_store_dword v12, v38, s[84:87], s43 offen sc1
  s_add_u32 s43, s43, 262144
  buffer_store_dword v13, v38, s[84:87], s43 offen sc1
  s_add_u32 s43, s43, 262144
  buffer_store_dword v14, v38, s[84:87], s43 offen sc1
  s_add_u32 s43, s43, 262144
  buffer_store_dword v15, v38, s[84:87], s43 offen sc1
  s_sub_u32 s43, s43, 770048
  buffer_store_dword v16, v38, s[84:87], s43 offen sc1
  s_add_u32 s43, s43, 262144
  buffer_store_dword v17, v38, s[84:87], s43 offen sc1
  s_add_u32 s43, s43, 262144
  buffer_store_dword v18, v38, s[84:87], s43 offen sc1
  s_add_u32 s43, s43, 262144
  buffer_store_dword v19, v38, s[84:87], s43 offen sc1
  s_sub_u32 s43, s43, 770048
  buffer_store_dword v20, v38, s[84:87], s43 offen sc1
  s_add_u32 s43, s43, 262144
  buffer_store_dword v21, v38, s[84:87], s43 offen sc1
  s_add_u32 s43, s43, 262144
  buffer_store_dword v22, v38, s[84:87], s43 offen sc1
  s_add_u32 s43, s43, 262144
  buffer_store_dword v23, v38, s[84:87], s43 offen sc1
  v_mfma_f32_16x16x16_bf16 v[8:11], v[186:187], v[62:63], 0
  v_mfma_f32_16x16x16_bf16 v[12:15], v[24:25], v[62:63], 0
  v_mfma_f32_16x16x16_bf16 v[16:19], v[26:27], v[62:63], 0
  v_mfma_f32_16x16x16_bf16 v[20:23], v[28:29], v[62:63], 0
  v_mfma_f32_16x16x16_bf16 v[64:67], v[30:31], v[62:63], 0
  v_mfma_f32_16x16x16_bf16 v[68:71], v[32:33], v[62:63], 0
  v_mfma_f32_16x16x16_bf16 v[72:75], v[34:35], v[62:63], 0
  v_mfma_f32_16x16x16_bf16 v[76:79], v[36:37], v[62:63], 0
  s_waitcnt vmcnt(16)
  v_cmp_ne_u32 vcc, 1, v58
  s_nop 0
  s_and_b64 vcc, vcc, 0xffffffff
  s_cbranch_vccz gated_mix__spectral_gfnet__ssm_conv_s5__prompt_kernel_skip38
  s_mov_b32 s33, 0
gated_mix__spectral_gfnet__ssm_conv_s5__prompt_kernel_poll39:
  s_sleep 5
  s_mov_b64 exec, 0xffffffff
  buffer_load_dword v58, v5, s[16:19], s28 offen sc1
  s_mov_b64 exec, -1
  s_waitcnt vmcnt(0)
  v_cmp_ne_u32 vcc, 1, v58
  s_nop 0
  s_and_b64 vcc, vcc, 0xffffffff
  s_cbranch_vccz gated_mix__spectral_gfnet__ssm_conv_s5__prompt_kernel_pollout40
  s_add_u32 s33, s33, 1
  s_cmp_lt_u32 s33, 1048576
  s_cbranch_scc1 gated_mix__spectral_gfnet__ssm_conv_s5__prompt_kernel_poll39
gated_mix__spectral_gfnet__ssm_conv_s5__prompt_kernel_pollout40:
gated_mix__spectral_gfnet__ssm_conv_s5__prompt_kernel_skip38:
  s_waitcnt lgkmcnt(0)
  s_barrier
  s_add_u32 m0, s92, 0
  s_nop 0
  buffer_load_dwordx4 v59, s[80:83], s79 offen offset:0 sc1 lds
  buffer_load_dwordx4 v59, s[80:83], s79 offen offset:1024 sc1 lds
  buffer_load_dwordx4 v59, s[80:83], s79 offen offset:2048 sc1 lds
  s_and_b32 s33, s41, 8
  s_lshl_b32 s33, s33, 2
  v_lshrrev_b32 v5, 1, v3
  v_lshl_add_u32 v5, v5, 3, s33
  v_and_b32 v58, 1, v3
  v_lshl_add_u32 v5, v58, 1, v5
  v_cmp_eq_u32 vcc, 0, v5
  v_cvt_f32_u32 v188, v5
  v_bfe_i32 v190, v3, 0, 1
  v_and_b32 v190, 0x80008000, v190
  v_xor_b32 v191, 0x80000000, v190
  s_lshl_b32 s33, s33, 1
  buffer_load_dwordx4 v59, s[80:83], s79 offen offset:3072 sc1 lds
  s_add_u32 s79, s79, 32768
  s_and_b32 s79, s79, 0x3ffff
  s_xor_b32 s33, s33, 64
  v_add_u32 v5, s33, v2
  v_cvt_f32_u32 v5, v5
  v_mul_f32 v5, 0x3c000000, v5
  v_mul_f32 v58, v5, v188
  v_fmamk_f32 v172, v5, 0x0, v58
  v_fmamk_f32 v173, v5, 0x3f800000, v58
  v_fmamk_f32 v174, v5, 0x40800000, v58
  v_fmamk_f32 v175, v5, 0x40a00000, v58
  v_fmamk_f32 v176, v5, 0x41800000, v58
  v_fmamk_f32 v177, v5, 0x41880000, v58
  v_fmamk_f32 v178, v5, 0x41a00000, v58
  s_add_u32 m0, s92, 16384
  s_nop 0
  buffer_load_dwordx4 v59, s[80:83], s79 offen offset:0 sc1 lds
  v_fmamk_f32 v179, v5, 0x41a80000, v58
  v_cos_f32 v180, v172
  v_cos_f32 v181, v173
  v_cos_f32 v182, v174
  v_cos_f32 v183, v175
  v_cos_f32 v184, v176
  v_cos_f32 v185, v177
  buffer_load_dwordx4 v59, s[80:83], s79 offen offset:1024 sc1 lds
  v_cos_f32 v186, v178
  v_cos_f32 v187, v179
  v_sin_f32 v172, v172
  v_sin_f32 v173, v173
  v_sin_f32 v174, v174
  v_sin_f32 v175, v175
  buffer_load_dwordx4 v59, s[80:83], s79 offen offset:2048 sc1 lds
  v_sin_f32 v176, v176
  v_sin_f32 v177, v177
  v_sin_f32 v178, v178
  v_sin_f32 v179, v179
  v_lshlrev_b32 v58, 31, v2
  v_or_b32 v58, 0x3f003f00, v58
  v_cvt_pk_bf16_f32 v24, v180, -v172
  v_cvt_pk_bf16_f32 v25, v181, -v173
  buffer_load_dwordx4 v59, s[80:83], s79 offen offset:3072 sc1 lds
  s_add_u32 s79, s79, 32768
  s_and_b32 s79, s79, 0x3ffff
  v_cvt_pk_bf16_f32 v26, v182, -v174
  v_cvt_pk_bf16_f32 v27, v183, -v175
  v_cvt_pk_bf16_f32 v28, v184, -v176
  v_cvt_pk_bf16_f32 v29, v185, -v177
  v_cvt_pk_bf16_f32 v30, v186, -v178
  v_cvt_pk_bf16_f32 v31, v187, -v179
  v_cndmask_b32 v24, v24, v58, vcc
  v_xor_b32 v60, v190, v24
  v_alignbit_b32 v61, v25, v25, 16
  v_xor_b32 v61, v191, v61
  v_xor_b32 v62, v190, v26
  v_alignbit_b32 v63, v27, v27, 16
  s_add_u32 m0, s32, 98304
  s_nop 0
  buffer_load_dwordx4 v216, s[24:27], s29 offen offset:0 lds
  v_xor_b32 v63, v191, v63
  v_xor_b32 v160, v190, v28
  v_alignbit_b32 v161, v29, v29, 16
  v_xor_b32 v161, v191, v161
  v_xor_b32 v162, v190, v30
  v_alignbit_b32 v163, v31, v31, 16
  v_xor_b32 v163, v191, v163
  v_add_f32 v5, 0x3e000000, v5
  v_mul_f32 v58, v5, v188
  v_fmamk_f32 v172, v5, 0x0, v58
  v_fmamk_f32 v173, v5, 0x3f800000, v58
  v_fmamk_f32 v174, v5, 0x40800000, v58
  buffer_load_dwordx4 v217, s[24:27], s29 offen offset:1024 lds
  v_fmamk_f32 v175, v5, 0x40a00000, v58
  v_fmamk_f32 v176, v5, 0x41800000, v58
  v_fmamk_f32 v177, v5, 0x41880000, v58
  v_fmamk_f32 v178, v5, 0x41a00000, v58
  v_fmamk_f32 v179, v5, 0x41a80000, v58
  v_cos_f32 v180, v172
  v_cos_f32 v181, v173
  v_cos_f32 v182, v174
  v_cos_f32 v183, v175
  s_add_u32 m0, s32, 100352
  s_nop 0
  buffer_load_dwordx4 v218, s[24:27], s29 offen offset:0 lds
  v_cos_f32 v184, v176
  v_cos_f32 v185, v177
  v_cos_f32 v186, v178
  v_cos_f32 v187, v179
  v_sin_f32 v172, v172
  v_sin_f32 v173, v173
  buffer_load_dwordx4 v219, s[24:27], s29 offen offset:1024 lds
  s_add_u32 s29, s29, 128
  s_and_b32 s29, s29, 0x3ff
  v_sin_f32 v174, v174
  v_sin_f32 v175, v175
  v_sin_f32 v176, v176
  v_sin_f32 v177, v177
  v_sin_f32 v178, v178
  v_sin_f32 v179, v179
  v_lshlrev_b32 v58, 31, v2
  v_or_b32 v58, 0x3f003f00, v58
  v_cvt_pk_bf16_f32 v32, v180, -v172
  v_cvt_pk_bf16_f32 v33, v181, -v173
  v_cvt_pk_bf16_f32 v34, v182, -v174
  v_cvt_pk_bf16_f32 v35, v183, -v175
  v_cvt_pk_bf16_f32 v36, v184, -v176
  v_cvt_pk_bf16_f32 v37, v185, -v177
  v_cvt_pk_bf16_f32 v38, v186, -v178
  v_cvt_pk_bf16_f32 v39, v187, -v179
  v_cndmask_b32 v32, v32, v58, vcc
  v_xor_b32 v164, v190, v32
  v_alignbit_b32 v165, v33, v33, 16
  v_xor_b32 v165, v191, v165
  v_xor_b32 v166, v190, v34
  v_alignbit_b32 v167, v35, v35, 16
  v_xor_b32 v167, v191, v167
  v_xor_b32 v168, v190, v36
  v_alignbit_b32 v169, v37, v37, 16
  v_xor_b32 v169, v191, v169
  v_xor_b32 v170, v190, v38
  v_alignbit_b32 v171, v39, v39, 16
  v_xor_b32 v171, v191, v171
  s_waitcnt vmcnt(12)
  s_waitcnt vmcnt(8)
  s_barrier
  ds_read_b64_tr_b16 v[96:97], v240 offset:0
  ds_read_b64_tr_b16 v[98:99], v241 offset:0
  ds_read_b64_tr_b16 v[100:101], v240 offset:2048
  ds_read_b64_tr_b16 v[102:103], v241 offset:2048
  ds_read_b64_tr_b16 v[104:105], v240 offset:4096
  ds_read_b64_tr_b16 v[106:107], v241 offset:4096
  ds_read_b64_tr_b16 v[108:109], v240 offset:6144
  ds_read_b64_tr_b16 v[110:111], v241 offset:6144
  ds_read_b64_tr_b16 v[112:113], v240 offset:256
  ds_read_b64_tr_b16 v[114:115], v241 offset:256
  ds_read_b64_tr_b16 v[116:117], v240 offset:2304
  ds_read_b64_tr_b16 v[118:119], v241 offset:2304
  ds_read_b64_tr_b16 v[120:121], v240 offset:4352
  ds_read_b64_tr_b16 v[122:123], v241 offset:4352
  ds_read_b64_tr_b16 v[124:125], v240 offset:6400
  ds_read_b64_tr_b16 v[126:127], v241 offset:6400
  s_cmp_lg_u32 s3, 0
  s_cbranch_scc1 gated_mix__spectral_gfnet__ssm_conv_s5__prompt_kernel_skip41
  s_mov_b64 exec, 1
  buffer_store_dword v7, v56, s[16:19], s11 offen sc1
  s_mov_b64 exec, -1
gated_mix__spectral_gfnet__ssm_conv_s5__prompt_kernel_skip41:
  s_waitcnt lgkmcnt(0)
  v_mfma_f32_16x16x32_bf16 v[8:11], v[96:99], a[0:3], v[8:11]
  ds_read_b64_tr_b16 v[128:129], v240 offset:8192
  ds_read_b64_tr_b16 v[130:131], v241 offset:8192
  v_mfma_f32_16x16x32_bf16 v[40:43], v[96:99], a[8:11], 0
  ds_read_b64_tr_b16 v[132:133], v240 offset:10240
  ds_read_b64_tr_b16 v[134:135], v241 offset:10240
  v_mfma_f32_16x16x32_bf16 v[44:47], v[100:103], a[8:11], 0
  ds_read_b64_tr_b16 v[136:137], v240 offset:12288
  ds_read_b64_tr_b16 v[138:139], v241 offset:12288
  v_mfma_f32_16x16x32_bf16 v[12:15], v[100:103], a[0:3], v[12:15]
  ds_read_b64_tr_b16 v[140:141], v240 offset:14336
  ds_read_b64_tr_b16 v[142:143], v241 offset:14336
  v_mfma_f32_16x16x32_bf16 v[16:19], v[104:107], a[0:3], v[16:19]
  ds_read_b64_tr_b16 v[144:145], v240 offset:8448
  ds_read_b64_tr_b16 v[146:147], v241 offset:8448
  v_mfma_f32_16x16x32_bf16 v[48:51], v[104:107], a[8:11], 0
  ds_read_b64_tr_b16 v[148:149], v240 offset:10496
  ds_read_b64_tr_b16 v[150:151], v241 offset:10496
  v_mfma_f32_16x16x32_bf16 v[52:55], v[108:111], a[8:11], 0
  ds_read_b64_tr_b16 v[152:153], v240 offset:12544
  ds_read_b64_tr_b16 v[154:155], v241 offset:12544
  v_mfma_f32_16x16x32_bf16 v[20:23], v[108:111], a[0:3], v[20:23]
  ds_read_b64_tr_b16 v[156:157], v240 offset:14592
  ds_read_b64_tr_b16 v[158:159], v241 offset:14592
  v_mfma_f32_16x16x32_bf16 v[8:11], v[112:115], a[4:7], v[8:11]
  s_add_u32 m0, s92, 32768
  s_nop 0
  buffer_load_dwordx4 v59, s[80:83], s79 offen offset:0 sc1 lds
  s_mov_b32 s20, s30
  s_mov_b32 s21, s31
  v_mfma_f32_16x16x32_bf16 v[40:43], v[112:115], a[12:15], v[40:43]
  s_mov_b32 s22, 8388608
  s_mov_b32 s23, 0x20000
  v_mfma_f32_16x16x32_bf16 v[44:47], v[116:119], a[12:15], v[44:47]
  buffer_load_dwordx4 v59, s[80:83], s79 offen offset:1024 sc1 lds
  s_mov_b32 s44, s34
  s_mov_b32 s45, s35
  v_mfma_f32_16x16x32_bf16 v[12:15], v[116:119], a[4:7], v[12:15]
  s_mov_b32 s46, 4194304
  s_mov_b32 s47, 0x20000
  v_mfma_f32_16x16x32_bf16 v[16:19], v[120:123], a[4:7], v[16:19]
  buffer_load_dwordx4 v59, s[80:83], s79 offen offset:2048 sc1 lds
  v_lshlrev_b32 v58, 4, v1
  v_lshrrev_b32 v175, 5, v1
  v_mfma_f32_16x16x32_bf16 v[48:51], v[120:123], a[12:15], v[48:51]
  v_lshlrev_b32 v5, 9, v175
  v_lshlrev_b32 v174, 7, v175
  v_mfma_f32_16x16x32_bf16 v[52:55], v[124:127], a[12:15], v[52:55]
  buffer_load_dwordx4 v59, s[80:83], s79 offen offset:3072 sc1 lds
  s_add_u32 s79, s79, 32768
  s_and_b32 s79, s79, 0x3ffff
  v_bfe_u32 v175, v1, 3, 2
  v_lshl_or_b32 v5, v175, 6, v5
  v_mfma_f32_16x16x32_bf16 v[20:23], v[124:127], a[4:7], v[20:23]
  v_and_b32 v175, 3, v1
  v_lshl_or_b32 v5, v175, 4, v5
  s_waitcnt vmcnt(8) lgkmcnt(0)
  s_barrier
  v_mfma_f32_16x16x32_bf16 v[8:11], v[128:131], a[16:19], v[8:11]
  ds_read_b64_tr_b16 v[96:97], v240 offset:16384
  ds_read_b64_tr_b16 v[98:99], v241 offset:16384
  v_mfma_f32_16x16x32_bf16 v[40:43], v[128:131], a[24:27], v[40:43]
  ds_read_b64_tr_b16 v[100:101], v240 offset:18432
  ds_read_b64_tr_b16 v[102:103], v241 offset:18432
  v_mfma_f32_16x16x32_bf16 v[44:47], v[132:135], a[24:27], v[44:47]
  ds_read_b64_tr_b16 v[104:105], v240 offset:20480
  ds_read_b64_tr_b16 v[106:107], v241 offset:20480
  v_mfma_f32_16x16x32_bf16 v[12:15], v[132:135], a[16:19], v[12:15]
  ds_read_b64_tr_b16 v[108:109], v240 offset:22528
  ds_read_b64_tr_b16 v[110:111], v241 offset:22528
  v_mfma_f32_16x16x32_bf16 v[16:19], v[136:139], a[16:19], v[16:19]
  ds_read_b64_tr_b16 v[112:113], v240 offset:16640
  ds_read_b64_tr_b16 v[114:115], v241 offset:16640
  v_mfma_f32_16x16x32_bf16 v[48:51], v[136:139], a[24:27], v[48:51]
  ds_read_b64_tr_b16 v[116:117], v240 offset:18688
  ds_read_b64_tr_b16 v[118:119], v241 offset:18688
  v_mfma_f32_16x16x32_bf16 v[52:55], v[140:143], a[24:27], v[52:55]
  ds_read_b64_tr_b16 v[120:121], v240 offset:20736
  ds_read_b64_tr_b16 v[122:123], v241 offset:20736
  v_mfma_f32_16x16x32_bf16 v[20:23], v[140:143], a[16:19], v[20:23]
  ds_read_b64_tr_b16 v[124:125], v240 offset:22784
  ds_read_b64_tr_b16 v[126:127], v241 offset:22784
  v_mfma_f32_16x16x32_bf16 v[8:11], v[144:147], a[20:23], v[8:11]
  s_add_u32 m0, s32, 114688
  s_nop 0
  buffer_load_dwordx4 v216, s[12:15], s29 offen offset:0 lds
  v_and_b32 v175, 4, v1
  v_lshl_or_b32 v5, v175, 1, v5
  v_mfma_f32_16x16x32_bf16 v[40:43], v[144:147], a[28:31], v[40:43]
  s_lshl_b32 s8, s3, 12
  s_add_u32 s8, s8, 131072
  v_mfma_f32_16x16x32_bf16 v[44:47], v[148:151], a[28:31], v[44:47]
  buffer_load_dwordx4 v217, s[12:15], s29 offen offset:1024 lds
  v_add_u32 v5, s8, v5
  v_and_or_b32 v174, v1, 16, v174
  v_mfma_f32_16x16x32_bf16 v[12:15], v[148:151], a[20:23], v[12:15]
  s_lshl_b32 s8, s41, 6
  v_lshl_add_u32 v172, v2, 2, s8
  v_mfma_f32_16x16x32_bf16 v[16:19], v[152:155], a[20:23], v[16:19]
  s_add_u32 m0, s32, 116736
  s_nop 0
  buffer_load_dwordx4 v218, s[12:15], s29 offen offset:0 lds
  v_lshl_or_b32 v172, v3, 18, v172
  v_xor_b32 v173, 512, v172
  v_mfma_f32_16x16x32_bf16 v[48:51], v[152:155], a[28:31], v[48:51]
  s_lshr_b32 s8, s41, 3
  s_lshl_b32 s33, s8, 10
  v_mfma_f32_16x16x32_bf16 v[52:55], v[156:159], a[28:31], v[52:55]
  buffer_load_dwordx4 v219, s[12:15], s29 offen offset:1024 lds
  s_add_u32 s33, s33, s40
  s_lshl2_add_u32 s33, s33, s3
  v_mfma_f32_16x16x32_bf16 v[20:23], v[156:159], a[20:23], v[20:23]
  s_lshl_b32 s33, s33, 10
  s_xor_b32 s43, s8, 1
  s_waitcnt lgkmcnt(0)
  v_mfma_f32_16x16x32_bf16 v[8:11], v[96:99], a[32:35], v[8:11]
  ds_read_b64_tr_b16 v[128:129], v240 offset:24576
  ds_read_b64_tr_b16 v[130:131], v241 offset:24576
  v_mfma_f32_16x16x32_bf16 v[40:43], v[96:99], a[40:43], v[40:43]
  ds_read_b64_tr_b16 v[132:133], v240 offset:26624
  ds_read_b64_tr_b16 v[134:135], v241 offset:26624
  v_mfma_f32_16x16x32_bf16 v[44:47], v[100:103], a[40:43], v[44:47]
  ds_read_b64_tr_b16 v[136:137], v240 offset:28672
  ds_read_b64_tr_b16 v[138:139], v241 offset:28672
  v_mfma_f32_16x16x32_bf16 v[12:15], v[100:103], a[32:35], v[12:15]
  ds_read_b64_tr_b16 v[140:141], v240 offset:30720
  ds_read_b64_tr_b16 v[142:143], v241 offset:30720
  v_mfma_f32_16x16x32_bf16 v[16:19], v[104:107], a[32:35], v[16:19]
  ds_read_b64_tr_b16 v[144:145], v240 offset:24832
  ds_read_b64_tr_b16 v[146:147], v241 offset:24832
  v_mfma_f32_16x16x32_bf16 v[48:51], v[104:107], a[40:43], v[48:51]
  ds_read_b64_tr_b16 v[148:149], v240 offset:26880
  ds_read_b64_tr_b16 v[150:151], v241 offset:26880
  v_mfma_f32_16x16x32_bf16 v[52:55], v[108:111], a[40:43], v[52:55]
  ds_read_b64_tr_b16 v[152:153], v240 offset:28928
  ds_read_b64_tr_b16 v[154:155], v241 offset:28928
  v_mfma_f32_16x16x32_bf16 v[20:23], v[108:111], a[32:35], v[20:23]
  ds_read_b64_tr_b16 v[156:157], v240 offset:30976
  ds_read_b64_tr_b16 v[158:159], v241 offset:30976
  v_mfma_f32_16x16x32_bf16 v[8:11], v[112:115], a[36:39], v[8:11]
  s_add_u32 m0, s92, 49152
  s_nop 0
  buffer_load_dwordx4 v59, s[80:83], s79 offen offset:0 sc1 lds
  s_lshl1_add_u32 s43, s40, s43
  s_lshl_b32 s43, s43, 10
  v_mfma_f32_16x16x32_bf16 v[40:43], v[112:115], a[44:47], v[40:43]
  s_lshl4_add_u32 s6, s40, s41
  s_and_b32 s7, s3, 2
  v_mfma_f32_16x16x32_bf16 v[44:47], v[116:119], a[44:47], v[44:47]
  buffer_load_dwordx4 v59, s[80:83], s79 offen offset:1024 sc1 lds
  s_lshl_b32 s7, s7, 2
  s_xor_b32 s7, s7, s6
  v_mfma_f32_16x16x32_bf16 v[12:15], v[116:119], a[36:39], v[12:15]
  s_lshl1_add_u32 s7, s7, s8
  s_and_b32 s8, s3, 1
  v_mfma_f32_16x16x32_bf16 v[16:19], v[120:123], a[36:39], v[16:19]
  buffer_load_dwordx4 v59, s[80:83], s79 offen offset:2048 sc1 lds
  s_lshl1_add_u32 s7, s7, s8
  s_lshl_b32 s7, s7, 12
  v_mfma_f32_16x16x32_bf16 v[48:51], v[120:123], a[44:47], v[48:51]
  s_lshl2_add_u32 s6, s6, s3
  s_lshl_b32 s6, s6, 13
  v_mfma_f32_16x16x32_bf16 v[52:55], v[124:127], a[44:47], v[52:55]
  buffer_load_dwordx4 v59, s[80:83], s79 offen offset:3072 sc1 lds
  s_add_u32 s79, s79, 32768
  s_and_b32 s79, s79, 0x3ffff
  s_lshr_b32 s8, s41, 3
  s_or_b32 s8, s8, s3
  v_mfma_f32_16x16x32_bf16 v[20:23], v[124:127], a[36:39], v[20:23]
  s_and_b32 s8, s8, 1
  s_lshr_b32 s6, s6, 1
  s_waitcnt vmcnt(12)
  ds_read_b128 a[144:147], v222 offset:32768
  ds_read_b128 a[148:151], v223 offset:32768
  ds_read_b128 a[152:155], v222 offset:34816
  ds_read_b128 a[156:159], v223 offset:34816
  s_waitcnt vmcnt(8) lgkmcnt(4)
  s_barrier
  v_mfma_f32_16x16x32_bf16 v[8:11], v[128:131], a[48:51], v[8:11]
  ds_read_b64_tr_b16 v[96:97], v240 offset:32768
  ds_read_b64_tr_b16 v[98:99], v241 offset:32768
  v_mfma_f32_16x16x32_bf16 v[40:43], v[128:131], a[56:59], v[40:43]
  ds_read_b64_tr_b16 v[100:101], v240 offset:34816
  ds_read_b64_tr_b16 v[102:103], v241 offset:34816
  v_mfma_f32_16x16x32_bf16 v[44:47], v[132:135], a[56:59], v[44:47]
  ds_read_b64_tr_b16 v[104:105], v240 offset:36864
  ds_read_b64_tr_b16 v[106:107], v241 offset:36864
  v_mfma_f32_16x16x32_bf16 v[12:15], v[132:135], a[48:51], v[12:15]
  ds_read_b64_tr_b16 v[108:109], v240 offset:38912
  ds_read_b64_tr_b16 v[110:111], v241 offset:38912
  v_mfma_f32_16x16x32_bf16 v[16:19], v[136:139], a[48:51], v[16:19]
  ds_read_b64_tr_b16 v[112:113], v240 offset:33024
  ds_read_b64_tr_b16 v[114:115], v241 offset:33024
  v_mfma_f32_16x16x32_bf16 v[48:51], v[136:139], a[56:59], v[48:51]
  ds_read_b64_tr_b16 v[116:117], v240 offset:35072
  ds_read_b64_tr_b16 v[118:119], v241 offset:35072
  v_mfma_f32_16x16x32_bf16 v[52:55], v[140:143], a[56:59], v[52:55]
  ds_read_b64_tr_b16 v[120:121], v240 offset:37120
  s_branch gated_mix__spectral_gfnet__ssm_conv_s5__prompt_kernel_isk5
gated_mix__spectral_gfnet__ssm_conv_s5__prompt_kernel_isl5:
  s_branch gated_mix__spectral_gfnet__ssm_conv_s5__prompt_kernel_ret
gated_mix__spectral_gfnet__ssm_conv_s5__prompt_kernel_isk5:
  ds_read_b64_tr_b16 v[122:123], v241 offset:37120
  v_mfma_f32_16x16x32_bf16 v[20:23], v[140:143], a[48:51], v[20:23]
  ds_read_b64_tr_b16 v[124:125], v240 offset:39168
  ds_read_b64_tr_b16 v[126:127], v241 offset:39168
  v_mfma_f32_16x16x32_bf16 v[8:11], v[144:147], a[52:55], v[8:11]
  s_add_u32 m0, s32, 147456
  s_nop 0
  buffer_load_dwordx4 v216, s[24:27], s29 offen offset:0 lds
  s_mov_b32 s9, 0x07060302
  v_mfma_f32_16x16x32_bf16 v[40:43], v[144:147], a[60:63], v[40:43]
  v_mfma_f32_16x16x32_bf16 v[44:47], v[148:151], a[60:63], v[44:47]
  buffer_load_dwordx4 v217, s[24:27], s29 offen offset:1024 lds
  v_mfma_f32_16x16x32_bf16 v[12:15], v[148:151], a[52:55], v[12:15]
  v_mfma_f32_16x16x32_bf16 v[16:19], v[152:155], a[52:55], v[16:19]
  s_add_u32 m0, s32, 149504
  s_nop 0
  buffer_load_dwordx4 v218, s[24:27], s29 offen offset:0 lds
  v_mfma_f32_16x16x32_bf16 v[48:51], v[152:155], a[60:63], v[48:51]
  v_mfma_f32_16x16x32_bf16 v[52:55], v[156:159], a[60:63], v[52:55]
  buffer_load_dwordx4 v219, s[24:27], s29 offen offset:1024 lds
  s_add_u32 s29, s29, 128
  s_and_b32 s29, s29, 0x3ff
  v_mfma_f32_16x16x32_bf16 v[20:23], v[156:159], a[52:55], v[20:23]
  s_waitcnt lgkmcnt(0)
  v_mfma_f32_16x16x32_bf16 v[8:11], v[96:99], a[64:67], v[8:11]
  ds_read_b64_tr_b16 v[128:129], v240 offset:40960
  ds_read_b64_tr_b16 v[130:131], v241 offset:40960
  v_mfma_f32_16x16x32_bf16 v[40:43], v[96:99], a[72:75], v[40:43]
  ds_read_b64_tr_b16 v[132:133], v240 offset:43008
  ds_read_b64_tr_b16 v[134:135], v241 offset:43008
  v_mfma_f32_16x16x32_bf16 v[44:47], v[100:103], a[72:75], v[44:47]
  ds_read_b64_tr_b16 v[136:137], v240 offset:45056
  ds_read_b64_tr_b16 v[138:139], v241 offset:45056
  v_mfma_f32_16x16x32_bf16 v[12:15], v[100:103], a[64:67], v[12:15]
  ds_read_b64_tr_b16 v[140:141], v240 offset:47104
  ds_read_b64_tr_b16 v[142:143], v241 offset:47104
  v_mfma_f32_16x16x32_bf16 v[16:19], v[104:107], a[64:67], v[16:19]
  ds_read_b64_tr_b16 v[144:145], v240 offset:41216
  ds_read_b64_tr_b16 v[146:147], v241 offset:41216
  v_mfma_f32_16x16x32_bf16 v[48:51], v[104:107], a[72:75], v[48:51]
  ds_read_b64_tr_b16 v[148:149], v240 offset:43264
  ds_read_b64_tr_b16 v[150:151], v241 offset:43264
  v_mfma_f32_16x16x32_bf16 v[52:55], v[108:111], a[72:75], v[52:55]
  ds_read_b64_tr_b16 v[152:153], v240 offset:45312
  ds_read_b64_tr_b16 v[154:155], v241 offset:45312
  v_mfma_f32_16x16x32_bf16 v[20:23], v[108:111], a[64:67], v[20:23]
  ds_read_b64_tr_b16 v[156:157], v240 offset:47360
  ds_read_b64_tr_b16 v[158:159], v241 offset:47360
  v_mfma_f32_16x16x32_bf16 v[8:11], v[112:115], a[68:71], v[8:11]
  s_add_u32 m0, s92, 65536
  s_nop 0
  buffer_load_dwordx4 v59, s[80:83], s79 offen offset:0 sc1 lds
  v_mfma_f32_16x16x32_bf16 v[40:43], v[112:115], a[76:79], v[40:43]
  v_mfma_f32_16x16x32_bf16 v[44:47], v[116:119], a[76:79], v[44:47]
  buffer_load_dwordx4 v59, s[80:83], s79 offen offset:1024 sc1 lds
  v_mfma_f32_16x16x32_bf16 v[12:15], v[116:119], a[68:71], v[12:15]
  v_mfma_f32_16x16x32_bf16 v[16:19], v[120:123], a[68:71], v[16:19]
  buffer_load_dwordx4 v59, s[80:83], s79 offen offset:2048 sc1 lds
  v_mfma_f32_16x16x32_bf16 v[48:51], v[120:123], a[76:79], v[48:51]
  v_mfma_f32_16x16x32_bf16 v[52:55], v[124:127], a[76:79], v[52:55]
  buffer_load_dwordx4 v59, s[80:83], s79 offen offset:3072 sc1 lds
  s_add_u32 s79, s79, 32768
  s_and_b32 s79, s79, 0x3ffff
  v_mfma_f32_16x16x32_bf16 v[20:23], v[124:127], a[68:71], v[20:23]
  s_waitcnt vmcnt(12)
  ds_read_b128 a[160:163], v222 offset:49152
  ds_read_b128 a[164:167], v223 offset:49152
  ds_read_b128 a[168:171], v222 offset:51200
  ds_read_b128 a[172:175], v223 offset:51200
  s_waitcnt vmcnt(8) lgkmcnt(4)
  s_barrier
  v_mfma_f32_16x16x32_bf16 v[8:11], v[128:131], a[80:83], v[8:11]
  ds_read_b64_tr_b16 v[96:97], v240 offset:49152
  ds_read_b64_tr_b16 v[98:99], v241 offset:49152
  v_mfma_f32_16x16x32_bf16 v[40:43], v[128:131], a[88:91], v[40:43]
  ds_read_b64_tr_b16 v[100:101], v240 offset:51200
  ds_read_b64_tr_b16 v[102:103], v241 offset:51200
  v_mfma_f32_16x16x32_bf16 v[44:47], v[132:135], a[88:91], v[44:47]
  ds_read_b64_tr_b16 v[104:105], v240 offset:53248
  ds_read_b64_tr_b16 v[106:107], v241 offset:53248
  v_mfma_f32_16x16x32_bf16 v[12:15], v[132:135], a[80:83], v[12:15]
  ds_read_b64_tr_b16 v[108:109], v240 offset:55296
  ds_read_b64_tr_b16 v[110:111], v241 offset:55296
  v_mfma_f32_16x16x32_bf16 v[16:19], v[136:139], a[80:83], v[16:19]
  ds_read_b64_tr_b16 v[112:113], v240 offset:49408
  ds_read_b64_tr_b16 v[114:115], v241 offset:49408
  v_mfma_f32_16x16x32_bf16 v[48:51], v[136:139], a[88:91], v[48:51]
  ds_read_b64_tr_b16 v[116:117], v240 offset:51456
  ds_read_b64_tr_b16 v[118:119], v241 offset:51456
  v_mfma_f32_16x16x32_bf16 v[52:55], v[140:143], a[88:91], v[52:55]
  ds_read_b64_tr_b16 v[120:121], v240 offset:53504
  ds_read_b64_tr_b16 v[122:123], v241 offset:53504
  v_mfma_f32_16x16x32_bf16 v[20:23], v[140:143], a[80:83], v[20:23]
  ds_read_b64_tr_b16 v[124:125], v240 offset:55552
  ds_read_b64_tr_b16 v[126:127], v241 offset:55552
  v_mfma_f32_16x16x32_bf16 v[8:11], v[144:147], a[84:87], v[8:11]
  s_add_u32 m0, s32, 98304
  s_nop 0
  buffer_load_dwordx4 v216, s[12:15], s29 offen offset:0 lds
  v_mfma_f32_16x16x32_bf16 v[40:43], v[144:147], a[92:95], v[40:43]
  v_mfma_f32_16x16x32_bf16 v[44:47], v[148:151], a[92:95], v[44:47]
  buffer_load_dwordx4 v217, s[12:15], s29 offen offset:1024 lds
  v_mfma_f32_16x16x32_bf16 v[12:15], v[148:151], a[84:87], v[12:15]
  v_mfma_f32_16x16x32_bf16 v[16:19], v[152:155], a[84:87], v[16:19]
  s_add_u32 m0, s32, 100352
  s_nop 0
  buffer_load_dwordx4 v218, s[12:15], s29 offen offset:0 lds
  v_mfma_f32_16x16x32_bf16 v[48:51], v[152:155], a[92:95], v[48:51]
  v_mfma_f32_16x16x32_bf16 v[52:55], v[156:159], a[92:95], v[52:55]
  buffer_load_dwordx4 v219, s[12:15], s29 offen offset:1024 lds
  v_mfma_f32_16x16x32_bf16 v[20:23], v[156:159], a[84:87], v[20:23]
  s_waitcnt lgkmcnt(0)
  v_mfma_f32_16x16x32_bf16 v[8:11], v[96:99], a[96:99], v[8:11]
  ds_read_b64_tr_b16 v[128:129], v240 offset:57344
  ds_read_b64_tr_b16 v[130:131], v241 offset:57344
  v_mfma_f32_16x16x32_bf16 v[40:43], v[96:99], a[104:107], v[40:43]
  ds_read_b64_tr_b16 v[132:133], v240 offset:59392
  ds_read_b64_tr_b16 v[134:135], v241 offset:59392
  v_mfma_f32_16x16x32_bf16 v[44:47], v[100:103], a[104:107], v[44:47]
  ds_read_b64_tr_b16 v[136:137], v240 offset:61440
  ds_read_b64_tr_b16 v[138:139], v241 offset:61440
  v_mfma_f32_16x16x32_bf16 v[12:15], v[100:103], a[96:99], v[12:15]
  ds_read_b64_tr_b16 v[140:141], v240 offset:63488
  ds_read_b64_tr_b16 v[142:143], v241 offset:63488
  v_mfma_f32_16x16x32_bf16 v[16:19], v[104:107], a[96:99], v[16:19]
  ds_read_b64_tr_b16 v[144:145], v240 offset:57600
  ds_read_b64_tr_b16 v[146:147], v241 offset:57600
  v_mfma_f32_16x16x32_bf16 v[48:51], v[104:107], a[104:107], v[48:51]
  ds_read_b64_tr_b16 v[148:149], v240 offset:59648
  ds_read_b64_tr_b16 v[150:151], v241 offset:59648
  v_mfma_f32_16x16x32_bf16 v[52:55], v[108:111], a[104:107], v[52:55]
  ds_read_b64_tr_b16 v[152:153], v240 offset:61696
  ds_read_b64_tr_b16 v[154:155], v241 offset:61696
  v_mfma_f32_16x16x32_bf16 v[20:23], v[108:111], a[96:99], v[20:23]
  ds_read_b64_tr_b16 v[156:157], v240 offset:63744
  ds_read_b64_tr_b16 v[158:159], v241 offset:63744
  v_mfma_f32_16x16x32_bf16 v[8:11], v[112:115], a[100:103], v[8:11]
  s_add_u32 m0, s92, 81920
  s_nop 0
  buffer_load_dwordx4 v59, s[80:83], s79 offen offset:0 sc1 lds
  v_mfma_f32_16x16x32_bf16 v[40:43], v[112:115], a[108:111], v[40:43]
  v_mfma_f32_16x16x32_bf16 v[44:47], v[116:119], a[108:111], v[44:47]
  buffer_load_dwordx4 v59, s[80:83], s79 offen offset:1024 sc1 lds
  v_mfma_f32_16x16x32_bf16 v[12:15], v[116:119], a[100:103], v[12:15]
  v_mfma_f32_16x16x32_bf16 v[16:19], v[120:123], a[100:103], v[16:19]
  buffer_load_dwordx4 v59, s[80:83], s79 offen offset:2048 sc1 lds
  v_mfma_f32_16x16x32_bf16 v[48:51], v[120:123], a[108:111], v[48:51]
  v_mfma_f32_16x16x32_bf16 v[52:55], v[124:127], a[108:111], v[52:55]
  buffer_load_dwordx4 v59, s[80:83], s79 offen offset:3072 sc1 lds
  s_add_u32 s79, s79, 32768
  s_and_b32 s79, s79, 0x3ffff
  v_mfma_f32_16x16x32_bf16 v[20:23], v[124:127], a[100:103], v[20:23]
  v_xor_b32 v222, 0x30000, v222
  v_xor_b32 v223, 0x30000, v223
  s_waitcnt vmcnt(12)
  ds_read_b128 a[176:179], v222 offset:16384
  ds_read_b128 a[180:183], v223 offset:16384
  ds_read_b128 a[184:187], v222 offset:18432
  ds_read_b128 a[188:191], v223 offset:18432
  s_waitcnt vmcnt(8) lgkmcnt(4)
  s_barrier
  v_mfma_f32_16x16x32_bf16 v[8:11], v[128:131], a[112:115], v[8:11]
  ds_read_b64_tr_b16 v[96:97], v242 offset:0
  ds_read_b64_tr_b16 v[98:99], v243 offset:0
  v_mfma_f32_16x16x32_bf16 v[40:43], v[128:131], a[120:123], v[40:43]
  ds_read_b64_tr_b16 v[100:101], v242 offset:2048
  ds_read_b64_tr_b16 v[102:103], v243 offset:2048
  v_mfma_f32_16x16x32_bf16 v[44:47], v[132:135], a[120:123], v[44:47]
  ds_read_b64_tr_b16 v[104:105], v242 offset:4096
  ds_read_b64_tr_b16 v[106:107], v243 offset:4096
  v_mfma_f32_16x16x32_bf16 v[12:15], v[132:135], a[112:115], v[12:15]
  ds_read_b64_tr_b16 v[108:109], v242 offset:6144
  ds_read_b64_tr_b16 v[110:111], v243 offset:6144
  v_mfma_f32_16x16x32_bf16 v[16:19], v[136:139], a[112:115], v[16:19]
  ds_read_b64_tr_b16 v[112:113], v242 offset:256
  ds_read_b64_tr_b16 v[114:115], v243 offset:256
  v_mfma_f32_16x16x32_bf16 v[48:51], v[136:139], a[120:123], v[48:51]
  ds_read_b64_tr_b16 v[116:117], v242 offset:2304
  ds_read_b64_tr_b16 v[118:119], v243 offset:2304
  v_mfma_f32_16x16x32_bf16 v[52:55], v[140:143], a[120:123], v[52:55]
  ds_read_b64_tr_b16 v[120:121], v242 offset:4352
  ds_read_b64_tr_b16 v[122:123], v243 offset:4352
  v_mfma_f32_16x16x32_bf16 v[20:23], v[140:143], a[112:115], v[20:23]
  ds_read_b64_tr_b16 v[124:125], v242 offset:6400
  ds_read_b64_tr_b16 v[126:127], v243 offset:6400
  v_mfma_f32_16x16x32_bf16 v[8:11], v[144:147], a[116:119], v[8:11]
  s_add_u32 m0, s32, 114688
  s_nop 0
  buffer_load_dwordx4 v216, s[24:27], s29 offen offset:0 lds
  v_mfma_f32_16x16x32_bf16 v[40:43], v[144:147], a[124:127], v[40:43]
  v_mfma_f32_16x16x32_bf16 v[44:47], v[148:151], a[124:127], v[44:47]
  buffer_load_dwordx4 v217, s[24:27], s29 offen offset:1024 lds
  v_mfma_f32_16x16x32_bf16 v[12:15], v[148:151], a[116:119], v[12:15]
  v_mfma_f32_16x16x32_bf16 v[16:19], v[152:155], a[116:119], v[16:19]
  s_add_u32 m0, s32, 116736
  s_nop 0
  buffer_load_dwordx4 v218, s[24:27], s29 offen offset:0 lds
  v_mfma_f32_16x16x32_bf16 v[48:51], v[152:155], a[124:127], v[48:51]
  v_mfma_f32_16x16x32_bf16 v[52:55], v[156:159], a[124:127], v[52:55]
  buffer_load_dwordx4 v219, s[24:27], s29 offen offset:1024 lds
  s_add_u32 s29, s29, 128
  s_and_b32 s29, s29, 0x3ff
  v_mfma_f32_16x16x32_bf16 v[20:23], v[156:159], a[116:119], v[20:23]
  buffer_load_dword v176, v6, s[16:19], s11 offen sc1
  s_waitcnt lgkmcnt(0)
  v_mfma_f32_16x16x32_bf16 v[8:11], v[96:99], a[128:131], v[8:11]
  ds_read_b64_tr_b16 v[128:129], v242 offset:8192
  ds_read_b64_tr_b16 v[130:131], v243 offset:8192
  v_mfma_f32_16x16x32_bf16 v[40:43], v[96:99], a[136:139], v[40:43]
  ds_read_b64_tr_b16 v[132:133], v242 offset:10240
  ds_read_b64_tr_b16 v[134:135], v243 offset:10240
  v_mfma_f32_16x16x32_bf16 v[44:47], v[100:103], a[136:139], v[44:47]
  ds_read_b64_tr_b16 v[136:137], v242 offset:12288
  ds_read_b64_tr_b16 v[138:139], v243 offset:12288
  v_mfma_f32_16x16x32_bf16 v[12:15], v[100:103], a[128:131], v[12:15]
  ds_read_b64_tr_b16 v[140:141], v242 offset:14336
  ds_read_b64_tr_b16 v[142:143], v243 offset:14336
  v_mfma_f32_16x16x32_bf16 v[16:19], v[104:107], a[128:131], v[16:19]
  ds_read_b64_tr_b16 v[144:145], v242 offset:8448
  ds_read_b64_tr_b16 v[146:147], v243 offset:8448
  v_mfma_f32_16x16x32_bf16 v[48:51], v[104:107], a[136:139], v[48:51]
  ds_read_b64_tr_b16 v[148:149], v242 offset:10496
  ds_read_b64_tr_b16 v[150:151], v243 offset:10496
  v_mfma_f32_16x16x32_bf16 v[52:55], v[108:111], a[136:139], v[52:55]
  ds_read_b64_tr_b16 v[152:153], v242 offset:12544
  ds_read_b64_tr_b16 v[154:155], v243 offset:12544
  v_mfma_f32_16x16x32_bf16 v[20:23], v[108:111], a[128:131], v[20:23]
  ds_read_b64_tr_b16 v[156:157], v242 offset:14592
  ds_read_b64_tr_b16 v[158:159], v243 offset:14592
  v_mfma_f32_16x16x32_bf16 v[8:11], v[112:115], a[132:135], v[8:11]
  s_add_u32 m0, s92, 0
  s_nop 0
  buffer_load_dwordx4 v59, s[80:83], s79 offen offset:0 sc1 lds
  v_mfma_f32_16x16x32_bf16 v[40:43], v[112:115], a[140:143], v[40:43]
  v_mfma_f32_16x16x32_bf16 v[44:47], v[116:119], a[140:143], v[44:47]
  buffer_load_dwordx4 v59, s[80:83], s79 offen offset:1024 sc1 lds
  v_mfma_f32_16x16x32_bf16 v[12:15], v[116:119], a[132:135], v[12:15]
  v_mfma_f32_16x16x32_bf16 v[16:19], v[120:123], a[132:135], v[16:19]
  buffer_load_dwordx4 v59, s[80:83], s79 offen offset:2048 sc1 lds
  v_mfma_f32_16x16x32_bf16 v[48:51], v[120:123], a[140:143], v[48:51]
  v_mfma_f32_16x16x32_bf16 v[52:55], v[124:127], a[140:143], v[52:55]
  buffer_load_dwordx4 v59, s[80:83], s79 offen offset:3072 sc1 lds
  s_add_u32 s79, s79, 32768
  s_and_b32 s79, s79, 0x3ffff
  v_mfma_f32_16x16x32_bf16 v[20:23], v[124:127], a[132:135], v[20:23]
  v_xor_b32 v222, 0x30000, v222
  v_xor_b32 v223, 0x30000, v223
  s_waitcnt vmcnt(13)
  ds_read_b128 a[192:195], v222 offset:32768
  ds_read_b128 a[196:199], v223 offset:32768
  ds_read_b128 a[200:203], v222 offset:34816
  ds_read_b128 a[204:207], v223 offset:34816
  s_waitcnt vmcnt(9) lgkmcnt(4)
  s_barrier
  v_mfma_f32_16x16x32_bf16 v[8:11], v[128:131], a[144:147], v[8:11]
  ds_read_b64_tr_b16 v[96:97], v242 offset:16384
  ds_read_b64_tr_b16 v[98:99], v243 offset:16384
  v_mfma_f32_16x16x32_bf16 v[40:43], v[128:131], a[152:155], v[40:43]
  ds_read_b64_tr_b16 v[100:101], v242 offset:18432
  ds_read_b64_tr_b16 v[102:103], v243 offset:18432
  v_mfma_f32_16x16x32_bf16 v[44:47], v[132:135], a[152:155], v[44:47]
  ds_read_b64_tr_b16 v[104:105], v242 offset:20480
  ds_read_b64_tr_b16 v[106:107], v243 offset:20480
  v_mfma_f32_16x16x32_bf16 v[12:15], v[132:135], a[144:147], v[12:15]
  ds_read_b64_tr_b16 v[108:109], v242 offset:22528
  ds_read_b64_tr_b16 v[110:111], v243 offset:22528
  v_mfma_f32_16x16x32_bf16 v[16:19], v[136:139], a[144:147], v[16:19]
  ds_read_b64_tr_b16 v[112:113], v242 offset:16640
  ds_read_b64_tr_b16 v[114:115], v243 offset:16640
  v_mfma_f32_16x16x32_bf16 v[48:51], v[136:139], a[152:155], v[48:51]
  ds_read_b64_tr_b16 v[116:117], v242 offset:18688
  ds_read_b64_tr_b16 v[118:119], v243 offset:18688
  v_mfma_f32_16x16x32_bf16 v[52:55], v[140:143], a[152:155], v[52:55]
  ds_read_b64_tr_b16 v[120:121], v242 offset:20736
  ds_read_b64_tr_b16 v[122:123], v243 offset:20736
  v_mfma_f32_16x16x32_bf16 v[20:23], v[140:143], a[144:147], v[20:23]
  ds_read_b64_tr_b16 v[124:125], v242 offset:22784
  ds_read_b64_tr_b16 v[126:127], v243 offset:22784
  v_mfma_f32_16x16x32_bf16 v[8:11], v[144:147], a[148:151], v[8:11]
  s_add_u32 m0, s32, 147456
  s_nop 0
  buffer_load_dwordx4 v216, s[12:15], s29 offen offset:0 lds
  v_mfma_f32_16x16x32_bf16 v[40:43], v[144:147], a[156:159], v[40:43]
  v_mfma_f32_16x16x32_bf16 v[44:47], v[148:151], a[156:159], v[44:47]
  buffer_load_dwordx4 v217, s[12:15], s29 offen offset:1024 lds
  v_mfma_f32_16x16x32_bf16 v[12:15], v[148:151], a[148:151], v[12:15]
  v_mfma_f32_16x16x32_bf16 v[16:19], v[152:155], a[148:151], v[16:19]
  s_add_u32 m0, s32, 149504
  s_nop 0
  buffer_load_dwordx4 v218, s[12:15], s29 offen offset:0 lds
  v_mfma_f32_16x16x32_bf16 v[48:51], v[152:155], a[156:159], v[48:51]
  v_mfma_f32_16x16x32_bf16 v[52:55], v[156:159], a[156:159], v[52:55]
  buffer_load_dwordx4 v219, s[12:15], s29 offen offset:1024 lds
  v_mfma_f32_16x16x32_bf16 v[20:23], v[156:159], a[148:151], v[20:23]
  s_waitcnt lgkmcnt(0)
  v_mfma_f32_16x16x32_bf16 v[8:11], v[96:99], a[160:163], v[8:11]
  ds_read_b64_tr_b16 v[128:129], v242 offset:24576
  ds_read_b64_tr_b16 v[130:131], v243 offset:24576
  v_mfma_f32_16x16x32_bf16 v[40:43], v[96:99], a[168:171], v[40:43]
  ds_read_b64_tr_b16 v[132:133], v242 offset:26624
  ds_read_b64_tr_b16 v[134:135], v243 offset:26624
  v_mfma_f32_16x16x32_bf16 v[44:47], v[100:103], a[168:171], v[44:47]
  ds_read_b64_tr_b16 v[136:137], v242 offset:28672
  ds_read_b64_tr_b16 v[138:139], v243 offset:28672
  v_mfma_f32_16x16x32_bf16 v[12:15], v[100:103], a[160:163], v[12:15]
  ds_read_b64_tr_b16 v[140:141], v242 offset:30720
  ds_read_b64_tr_b16 v[142:143], v243 offset:30720
  v_mfma_f32_16x16x32_bf16 v[16:19], v[104:107], a[160:163], v[16:19]
  ds_read_b64_tr_b16 v[144:145], v242 offset:24832
  ds_read_b64_tr_b16 v[146:147], v243 offset:24832
  v_mfma_f32_16x16x32_bf16 v[48:51], v[104:107], a[168:171], v[48:51]
  ds_read_b64_tr_b16 v[148:149], v242 offset:26880
  ds_read_b64_tr_b16 v[150:151], v243 offset:26880
  v_mfma_f32_16x16x32_bf16 v[52:55], v[108:111], a[168:171], v[52:55]
  ds_read_b64_tr_b16 v[152:153], v242 offset:28928
  ds_read_b64_tr_b16 v[154:155], v243 offset:28928
  v_mfma_f32_16x16x32_bf16 v[20:23], v[108:111], a[160:163], v[20:23]
  ds_read_b64_tr_b16 v[156:157], v242 offset:30976
  ds_read_b64_tr_b16 v[158:159], v243 offset:30976
  v_mfma_f32_16x16x32_bf16 v[8:11], v[112:115], a[164:167], v[8:11]
  s_add_u32 m0, s92, 16384
  s_nop 0
  buffer_load_dwordx4 v59, s[80:83], s79 offen offset:0 sc1 lds
  v_mfma_f32_16x16x32_bf16 v[40:43], v[112:115], a[172:175], v[40:43]
  v_mfma_f32_16x16x32_bf16 v[44:47], v[116:119], a[172:175], v[44:47]
  buffer_load_dwordx4 v59, s[80:83], s79 offen offset:1024 sc1 lds
  v_mfma_f32_16x16x32_bf16 v[12:15], v[116:119], a[164:167], v[12:15]
  v_mfma_f32_16x16x32_bf16 v[16:19], v[120:123], a[164:167], v[16:19]
  buffer_load_dwordx4 v59, s[80:83], s79 offen offset:2048 sc1 lds
  v_mfma_f32_16x16x32_bf16 v[48:51], v[120:123], a[172:175], v[48:51]
  v_mfma_f32_16x16x32_bf16 v[52:55], v[124:127], a[172:175], v[52:55]
  buffer_load_dwordx4 v59, s[80:83], s79 offen offset:3072 sc1 lds
  s_add_u32 s79, s79, 32768
  s_and_b32 s79, s79, 0x3ffff
  v_xor_b32 v59, 8192, v59
  v_mfma_f32_16x16x32_bf16 v[20:23], v[124:127], a[164:167], v[20:23]
  s_waitcnt vmcnt(13)
  ds_read_b128 a[208:211], v222 offset:49152
  ds_read_b128 a[212:215], v223 offset:49152
  ds_read_b128 a[216:219], v222 offset:51200
  ds_read_b128 a[220:223], v223 offset:51200
  s_waitcnt vmcnt(12)
  v_cmp_ne_u32 vcc, 1, v176
  s_nop 0
  s_cbranch_vccz gated_mix__spectral_gfnet__ssm_conv_s5__prompt_kernel_skip42
  s_mov_b32 s52, 0
gated_mix__spectral_gfnet__ssm_conv_s5__prompt_kernel_poll43:
  s_sleep 16
  buffer_load_dword v176, v6, s[16:19], s11 offen sc1
  s_waitcnt vmcnt(0)
  v_cmp_ne_u32 vcc, 1, v176
  s_nop 0
  s_cbranch_vccz gated_mix__spectral_gfnet__ssm_conv_s5__prompt_kernel_pollout44
  s_add_u32 s52, s52, 1
  s_cmp_lt_u32 s52, 1048576
  s_cbranch_scc1 gated_mix__spectral_gfnet__ssm_conv_s5__prompt_kernel_poll43
gated_mix__spectral_gfnet__ssm_conv_s5__prompt_kernel_pollout44:
gated_mix__spectral_gfnet__ssm_conv_s5__prompt_kernel_skip42:
  s_waitcnt vmcnt(8) lgkmcnt(4)
  s_barrier
  v_mfma_f32_16x16x32_bf16 v[8:11], v[128:131], a[176:179], v[8:11]
  ds_read_b64_tr_b16 v[96:97], v240 offset:0
  ds_read_b64_tr_b16 v[98:99], v241 offset:0
  v_mfma_f32_16x16x32_bf16 v[40:43], v[128:131], a[184:187], v[40:43]
  ds_read_b64_tr_b16 v[100:101], v240 offset:2048
  ds_read_b64_tr_b16 v[102:103], v241 offset:2048
  v_mfma_f32_16x16x32_bf16 v[44:47], v[132:135], a[184:187], v[44:47]
  ds_read_b64_tr_b16 v[104:105], v240 offset:4096
  ds_read_b64_tr_b16 v[106:107], v241 offset:4096
  v_mfma_f32_16x16x32_bf16 v[12:15], v[132:135], a[176:179], v[12:15]
  ds_read_b64_tr_b16 v[108:109], v240 offset:6144
  ds_read_b64_tr_b16 v[110:111], v241 offset:6144
  v_mfma_f32_16x16x32_bf16 v[16:19], v[136:139], a[176:179], v[16:19]
  ds_read_b64_tr_b16 v[112:113], v240 offset:256
  ds_read_b64_tr_b16 v[114:115], v241 offset:256
  v_mfma_f32_16x16x32_bf16 v[48:51], v[136:139], a[184:187], v[48:51]
  ds_read_b64_tr_b16 v[116:117], v240 offset:2304
  ds_read_b64_tr_b16 v[118:119], v241 offset:2304
  v_mfma_f32_16x16x32_bf16 v[52:55], v[140:143], a[184:187], v[52:55]
  ds_read_b64_tr_b16 v[120:121], v240 offset:4352
  ds_read_b64_tr_b16 v[122:123], v241 offset:4352
  v_mfma_f32_16x16x32_bf16 v[20:23], v[140:143], a[176:179], v[20:23]
  ds_read_b64_tr_b16 v[124:125], v240 offset:6400
  ds_read_b64_tr_b16 v[126:127], v241 offset:6400
  v_mfma_f32_16x16x32_bf16 v[8:11], v[144:147], a[180:183], v[8:11]
  s_add_u32 m0, s32, 98304
  s_nop 0
  buffer_load_dwordx4 v216, s[24:27], s29 offen offset:0 lds
  v_mfma_f32_16x16x32_bf16 v[40:43], v[144:147], a[188:191], v[40:43]
  v_mfma_f32_16x16x32_bf16 v[44:47], v[148:151], a[188:191], v[44:47]
  buffer_load_dwordx4 v217, s[24:27], s29 offen offset:1024 lds
  v_mfma_f32_16x16x32_bf16 v[12:15], v[148:151], a[180:183], v[12:15]
  v_mfma_f32_16x16x32_bf16 v[16:19], v[152:155], a[180:183], v[16:19]
  s_add_u32 m0, s32, 100352
  s_nop 0
  buffer_load_dwordx4 v218, s[24:27], s29 offen offset:0 lds
  v_mfma_f32_16x16x32_bf16 v[48:51], v[152:155], a[188:191], v[48:51]
  v_mfma_f32_16x16x32_bf16 v[52:55], v[156:159], a[188:191], v[52:55]
  buffer_load_dwordx4 v219, s[24:27], s29 offen offset:1024 lds
  s_add_u32 s29, s29, 128
  s_and_b32 s29, s29, 0x3ff
  v_mfma_f32_16x16x32_bf16 v[20:23], v[156:159], a[180:183], v[20:23]
  buffer_load_dwordx4 v[176:179], v58, s[84:87], s7 offen offset:0 sc1
  buffer_load_dwordx4 v[180:183], v58, s[84:87], s7 offen offset:1024 sc1
  buffer_load_dwordx4 v[184:187], v58, s[84:87], s7 offen offset:2048 sc1
  buffer_load_dwordx4 v[188:191], v58, s[84:87], s7 offen offset:3072 sc1
  s_waitcnt lgkmcnt(0)
  v_mfma_f32_16x16x32_bf16 v[8:11], v[96:99], a[192:195], v[8:11]
  ds_read_b64_tr_b16 v[128:129], v240 offset:8192
  ds_read_b64_tr_b16 v[130:131], v241 offset:8192
  v_mfma_f32_16x16x32_bf16 v[40:43], v[96:99], a[200:203], v[40:43]
  ds_read_b64_tr_b16 v[132:133], v240 offset:10240
  ds_read_b64_tr_b16 v[134:135], v241 offset:10240
  v_mfma_f32_16x16x32_bf16 v[44:47], v[100:103], a[200:203], v[44:47]
  ds_read_b64_tr_b16 v[136:137], v240 offset:12288
  ds_read_b64_tr_b16 v[138:139], v241 offset:12288
  v_mfma_f32_16x16x32_bf16 v[12:15], v[100:103], a[192:195], v[12:15]
  ds_read_b64_tr_b16 v[140:141], v240 offset:14336
  ds_read_b64_tr_b16 v[142:143], v241 offset:14336
  v_mfma_f32_16x16x32_bf16 v[16:19], v[104:107], a[192:195], v[16:19]
  ds_read_b64_tr_b16 v[144:145], v240 offset:8448
  ds_read_b64_tr_b16 v[146:147], v241 offset:8448
  v_mfma_f32_16x16x32_bf16 v[48:51], v[104:107], a[200:203], v[48:51]
  ds_read_b64_tr_b16 v[148:149], v240 offset:10496
  ds_read_b64_tr_b16 v[150:151], v241 offset:10496
  v_mfma_f32_16x16x32_bf16 v[52:55], v[108:111], a[200:203], v[52:55]
  ds_read_b64_tr_b16 v[152:153], v240 offset:12544
  ds_read_b64_tr_b16 v[154:155], v241 offset:12544
  v_mfma_f32_16x16x32_bf16 v[20:23], v[108:111], a[192:195], v[20:23]
  ds_read_b64_tr_b16 v[156:157], v240 offset:14592
  ds_read_b64_tr_b16 v[158:159], v241 offset:14592
  v_mfma_f32_16x16x32_bf16 v[8:11], v[112:115], a[196:199], v[8:11]
  s_lshr_b32 m0, s3, 1
  s_lshl_b32 m0, m0, 15
  s_add_u32 s79, s79, m0
  s_and_b32 s79, s79, 0x3ffff
  s_and_b32 m0, s3, 1
  s_lshl_b32 m0, m0, 14
  v_and_b32 v59, 0xffffafff, v59
  v_or_b32 v59, m0, v59
  s_add_u32 m0, s92, 32768
  s_nop 0
  buffer_load_dwordx4 v59, s[80:83], s79 offen offset:0 sc1 lds
  v_mfma_f32_16x16x32_bf16 v[40:43], v[112:115], a[204:207], v[40:43]
  v_mfma_f32_16x16x32_bf16 v[44:47], v[116:119], a[204:207], v[44:47]
  buffer_load_dwordx4 v59, s[80:83], s79 offen offset:1024 sc1 lds
  v_mfma_f32_16x16x32_bf16 v[12:15], v[116:119], a[196:199], v[12:15]
  v_mfma_f32_16x16x32_bf16 v[16:19], v[120:123], a[196:199], v[16:19]
  buffer_load_dwordx4 v59, s[80:83], s79 offen offset:2048 sc1 lds
  v_mfma_f32_16x16x32_bf16 v[48:51], v[120:123], a[204:207], v[48:51]
  v_mfma_f32_16x16x32_bf16 v[52:55], v[124:127], a[204:207], v[52:55]
  buffer_load_dwordx4 v59, s[80:83], s79 offen offset:3072 sc1 lds
  s_add_u32 s79, s79, 65536
  s_and_b32 s79, s79, 0x3ffff
  v_mfma_f32_16x16x32_bf16 v[20:23], v[124:127], a[196:199], v[20:23]
  v_xor_b32 v222, 0x30000, v222
  v_xor_b32 v223, 0x30000, v223
  s_waitcnt vmcnt(16)
  ds_read_b128 a[224:227], v222 offset:16384
  ds_read_b128 a[228:231], v223 offset:16384
  ds_read_b128 a[232:235], v222 offset:18432
  ds_read_b128 a[236:239], v223 offset:18432
  s_waitcnt vmcnt(12) lgkmcnt(4)
  s_barrier
  v_mfma_f32_16x16x32_bf16 v[8:11], v[128:131], a[208:211], v[8:11]
  ds_read_b64_tr_b16 v[96:97], v240 offset:16384
  ds_read_b64_tr_b16 v[98:99], v241 offset:16384
  v_mfma_f32_16x16x32_bf16 v[40:43], v[128:131], a[216:219], v[40:43]
  ds_read_b64_tr_b16 v[100:101], v240 offset:18432
  ds_read_b64_tr_b16 v[102:103], v241 offset:18432
  v_mfma_f32_16x16x32_bf16 v[44:47], v[132:135], a[216:219], v[44:47]
  ds_read_b64_tr_b16 v[104:105], v240 offset:20480
  ds_read_b64_tr_b16 v[106:107], v241 offset:20480
  v_mfma_f32_16x16x32_bf16 v[12:15], v[132:135], a[208:211], v[12:15]
  ds_read_b64_tr_b16 v[108:109], v240 offset:22528
  ds_read_b64_tr_b16 v[110:111], v241 offset:22528
  v_mfma_f32_16x16x32_bf16 v[16:19], v[136:139], a[208:211], v[16:19]
  ds_read_b64_tr_b16 v[112:113], v240 offset:16640
  ds_read_b64_tr_b16 v[114:115], v241 offset:16640
  v_mfma_f32_16x16x32_bf16 v[48:51], v[136:139], a[216:219], v[48:51]
  ds_read_b64_tr_b16 v[116:117], v240 offset:18688
  ds_read_b64_tr_b16 v[118:119], v241 offset:18688
  v_mfma_f32_16x16x32_bf16 v[52:55], v[140:143], a[216:219], v[52:55]
  ds_read_b64_tr_b16 v[120:121], v240 offset:20736
  ds_read_b64_tr_b16 v[122:123], v241 offset:20736
  v_mfma_f32_16x16x32_bf16 v[20:23], v[140:143], a[208:211], v[20:23]
  ds_read_b64_tr_b16 v[124:125], v240 offset:22784
  ds_read_b64_tr_b16 v[126:127], v241 offset:22784
  v_mfma_f32_16x16x32_bf16 v[8:11], v[144:147], a[212:215], v[8:11]
  s_add_u32 m0, s92, 49152
  s_nop 0
  buffer_load_dwordx4 v59, s[80:83], s79 offen offset:0 sc1 lds
  s_lshl_b32 s29, s3, 10
  s_add_u32 s29, s29, 131072
  v_lshl_add_u32 v175, v1, 4, s29
  s_waitcnt vmcnt(8)
  v_lshlrev_b32 v192, 16, v176
  v_lshlrev_b32 v193, 16, v177
  s_waitcnt vmcnt(7)
  v_lshlrev_b32 v194, 16, v180
  v_lshlrev_b32 v195, 16, v181
  s_waitcnt vmcnt(6)
  v_lshlrev_b32 v196, 16, v184
  v_lshlrev_b32 v197, 16, v185
  s_waitcnt vmcnt(5)
  v_lshlrev_b32 v198, 16, v188
  v_lshlrev_b32 v199, 16, v189
  v_pk_add_f32 v[200:201], v[192:193], v[196:197]
  v_pk_add_f32 v[204:205], v[192:193], v[196:197] neg_lo:[0,1] neg_hi:[0,1]
  v_pk_add_f32 v[208:209], v[194:195], v[198:199]
  v_pk_add_f32 v[202:203], v[176:177], v[184:185]
  v_pk_add_f32 v[206:207], v[176:177], v[184:185] neg_lo:[0,1] neg_hi:[0,1]
  v_pk_add_f32 v[210:211], v[180:181], v[188:189]
  v_pk_add_f32 v[212:213], v[188:189], v[180:181] neg_lo:[0,1] neg_hi:[0,1]
  v_pk_add_f32 v[214:215], v[194:195], v[198:199] neg_lo:[0,1] neg_hi:[0,1]
  s_cmp_lg_u32 s8, 0
  s_cbranch_scc1 gated_mix__spectral_gfnet__ssm_conv_s5__prompt_kernel_skip45
  s_mov_b64 exec, 15
  v_pk_add_f32 v[208:209], v[194:195], v[194:195]
  v_pk_add_f32 v[210:211], v[198:199], v[198:199]
  v_pk_add_f32 v[212:213], v[180:181], v[180:181] neg_lo:[1,1] neg_hi:[1,1]
  v_pk_add_f32 v[214:215], v[188:189], v[188:189] neg_lo:[1,1] neg_hi:[1,1]
  s_mov_b64 exec, -1
gated_mix__spectral_gfnet__ssm_conv_s5__prompt_kernel_skip45:
  v_pk_add_f32 v[192:193], v[200:201], v[208:209]
  v_pk_add_f32 v[176:177], v[202:203], v[210:211]
  v_cvt_pk_bf16_f32 v216, v192, v193
  v_cvt_pk_bf16_f32 v218, v176, v177
  v_pk_add_f32 v[194:195], v[204:205], v[212:213]
  v_pk_add_f32 v[180:181], v[206:207], v[214:215]
  v_cvt_pk_bf16_f32 v224, v194, v195
  v_cvt_pk_bf16_f32 v226, v180, v181
  v_pk_add_f32 v[196:197], v[200:201], v[208:209] neg_lo:[0,1] neg_hi:[0,1]
  v_pk_add_f32 v[184:185], v[202:203], v[210:211] neg_lo:[0,1] neg_hi:[0,1]
  v_cvt_pk_bf16_f32 v228, v196, v197
  v_cvt_pk_bf16_f32 v230, v184, v185
  v_pk_add_f32 v[198:199], v[204:205], v[212:213] neg_lo:[0,1] neg_hi:[0,1]
  v_pk_add_f32 v[188:189], v[206:207], v[214:215] neg_lo:[0,1] neg_hi:[0,1]
  v_cvt_pk_bf16_f32 v232, v198, v199
  v_cvt_pk_bf16_f32 v234, v188, v189
  v_lshlrev_b32 v192, 16, v178
  v_lshlrev_b32 v193, 16, v179
  v_lshlrev_b32 v194, 16, v182
  v_lshlrev_b32 v195, 16, v183
  v_lshlrev_b32 v196, 16, v186
  v_lshlrev_b32 v197, 16, v187
  v_lshlrev_b32 v198, 16, v190
  v_lshlrev_b32 v199, 16, v191
  v_pk_add_f32 v[200:201], v[192:193], v[196:197]
  v_pk_add_f32 v[204:205], v[192:193], v[196:197] neg_lo:[0,1] neg_hi:[0,1]
  v_pk_add_f32 v[208:209], v[194:195], v[198:199]
  v_pk_add_f32 v[202:203], v[178:179], v[186:187]
  v_pk_add_f32 v[206:207], v[178:179], v[186:187] neg_lo:[0,1] neg_hi:[0,1]
  v_pk_add_f32 v[210:211], v[182:183], v[190:191]
  v_pk_add_f32 v[212:213], v[190:191], v[182:183] neg_lo:[0,1] neg_hi:[0,1]
  s_branch gated_mix__spectral_gfnet__ssm_conv_s5__prompt_kernel_isk6
gated_mix__spectral_gfnet__ssm_conv_s5__prompt_kernel_isl6:
  s_branch gated_mix__spectral_gfnet__ssm_conv_s5__prompt_kernel_ret
gated_mix__spectral_gfnet__ssm_conv_s5__prompt_kernel_isk6:
  v_pk_add_f32 v[214:215], v[194:195], v[198:199] neg_lo:[0,1] neg_hi:[0,1]
  s_cmp_lg_u32 s8, 0
  s_cbranch_scc1 gated_mix__spectral_gfnet__ssm_conv_s5__prompt_kernel_skip46
  s_mov_b64 exec, 15
  v_pk_add_f32 v[208:209], v[194:195], v[194:195]
  v_pk_add_f32 v[210:211], v[198:199], v[198:199]
  v_pk_add_f32 v[212:213], v[182:183], v[182:183] neg_lo:[1,1] neg_hi:[1,1]
  v_pk_add_f32 v[214:215], v[190:191], v[190:191] neg_lo:[1,1] neg_hi:[1,1]
  s_mov_b64 exec, -1
gated_mix__spectral_gfnet__ssm_conv_s5__prompt_kernel_skip46:
  v_pk_add_f32 v[192:193], v[200:201], v[208:209]
  v_pk_add_f32 v[178:179], v[202:203], v[210:211]
  v_cvt_pk_bf16_f32 v217, v192, v193
  v_cvt_pk_bf16_f32 v219, v178, v179
  ds_write_b128 v175, v[216:219] offset:0
  v_pk_add_f32 v[194:195], v[204:205], v[212:213]
  v_pk_add_f32 v[182:183], v[206:207], v[214:215]
  v_cvt_pk_bf16_f32 v225, v194, v195
  v_cvt_pk_bf16_f32 v227, v182, v183
  ds_write_b128 v175, v[224:227] offset:4096
  v_pk_add_f32 v[196:197], v[200:201], v[208:209] neg_lo:[0,1] neg_hi:[0,1]
  v_pk_add_f32 v[186:187], v[202:203], v[210:211] neg_lo:[0,1] neg_hi:[0,1]
  v_cvt_pk_bf16_f32 v229, v196, v197
  v_cvt_pk_bf16_f32 v231, v186, v187
  ds_write_b128 v175, v[228:231] offset:8192
  v_pk_add_f32 v[198:199], v[204:205], v[212:213] neg_lo:[0,1] neg_hi:[0,1]
  v_pk_add_f32 v[190:191], v[206:207], v[214:215] neg_lo:[0,1] neg_hi:[0,1]
  v_cvt_pk_bf16_f32 v233, v198, v199
  v_cvt_pk_bf16_f32 v235, v190, v191
  ds_write_b128 v175, v[232:235] offset:12288
  v_mfma_f32_16x16x32_bf16 v[40:43], v[144:147], a[220:223], v[40:43]
  v_mfma_f32_16x16x32_bf16 v[44:47], v[148:151], a[220:223], v[44:47]
  buffer_load_dwordx4 v59, s[80:83], s79 offen offset:1024 sc1 lds
  v_mfma_f32_16x16x32_bf16 v[12:15], v[148:151], a[212:215], v[12:15]
  v_mfma_f32_16x16x32_bf16 v[16:19], v[152:155], a[212:215], v[16:19]
  buffer_load_dwordx4 v59, s[80:83], s79 offen offset:2048 sc1 lds
  v_mfma_f32_16x16x32_bf16 v[48:51], v[152:155], a[220:223], v[48:51]
  v_mfma_f32_16x16x32_bf16 v[52:55], v[156:159], a[220:223], v[52:55]
  buffer_load_dwordx4 v59, s[80:83], s79 offen offset:3072 sc1 lds
  s_add_u32 s79, s79, 65536
  s_and_b32 s79, s79, 0x3ffff
  v_mfma_f32_16x16x32_bf16 v[20:23], v[156:159], a[212:215], v[20:23]
  s_waitcnt lgkmcnt(4)
  v_mfma_f32_16x16x32_bf16 v[8:11], v[96:99], a[224:227], v[8:11]
  ds_read_b64_tr_b16 v[128:129], v240 offset:24576
  ds_read_b64_tr_b16 v[130:131], v241 offset:24576
  v_mfma_f32_16x16x32_bf16 v[40:43], v[96:99], a[232:235], v[40:43]
  ds_read_b64_tr_b16 v[132:133], v240 offset:26624
  ds_read_b64_tr_b16 v[134:135], v241 offset:26624
  v_mfma_f32_16x16x32_bf16 v[44:47], v[100:103], a[232:235], v[44:47]
  ds_read_b64_tr_b16 v[136:137], v240 offset:28672
  ds_read_b64_tr_b16 v[138:139], v241 offset:28672
  v_mfma_f32_16x16x32_bf16 v[12:15], v[100:103], a[224:227], v[12:15]
  ds_read_b64_tr_b16 v[140:141], v240 offset:30720
  ds_read_b64_tr_b16 v[142:143], v241 offset:30720
  v_mfma_f32_16x16x32_bf16 v[16:19], v[104:107], a[224:227], v[16:19]
  ds_read_b64_tr_b16 v[144:145], v240 offset:24832
  ds_read_b64_tr_b16 v[146:147], v241 offset:24832
  v_mfma_f32_16x16x32_bf16 v[48:51], v[104:107], a[232:235], v[48:51]
  ds_read_b64_tr_b16 v[148:149], v240 offset:26880
  ds_read_b64_tr_b16 v[150:151], v241 offset:26880
  v_mfma_f32_16x16x32_bf16 v[52:55], v[108:111], a[232:235], v[52:55]
  ds_read_b64_tr_b16 v[152:153], v240 offset:28928
  ds_read_b64_tr_b16 v[154:155], v241 offset:28928
  v_mfma_f32_16x16x32_bf16 v[20:23], v[108:111], a[224:227], v[20:23]
  ds_read_b64_tr_b16 v[156:157], v240 offset:30976
  ds_read_b64_tr_b16 v[158:159], v241 offset:30976
  v_mfma_f32_16x16x32_bf16 v[8:11], v[112:115], a[228:231], v[8:11]
  s_add_u32 m0, s92, 65536
  s_nop 0
  buffer_load_dwordx4 v59, s[80:83], s79 offen offset:0 sc1 lds
  v_mfma_f32_16x16x32_bf16 v[40:43], v[112:115], a[236:239], v[40:43]
  v_mfma_f32_16x16x32_bf16 v[44:47], v[116:119], a[236:239], v[44:47]
  buffer_load_dwordx4 v59, s[80:83], s79 offen offset:1024 sc1 lds
  v_mfma_f32_16x16x32_bf16 v[12:15], v[116:119], a[228:231], v[12:15]
  v_mfma_f32_16x16x32_bf16 v[16:19], v[120:123], a[228:231], v[16:19]
  buffer_load_dwordx4 v59, s[80:83], s79 offen offset:2048 sc1 lds
  v_mfma_f32_16x16x32_bf16 v[48:51], v[120:123], a[236:239], v[48:51]
  v_mfma_f32_16x16x32_bf16 v[52:55], v[124:127], a[236:239], v[52:55]
  buffer_load_dwordx4 v59, s[80:83], s79 offen offset:3072 sc1 lds
  s_add_u32 s79, s79, 65536
  s_and_b32 s79, s79, 0x3ffff
  v_mfma_f32_16x16x32_bf16 v[20:23], v[124:127], a[228:231], v[20:23]
  v_xor_b32 v222, 0x30000, v222
  v_xor_b32 v223, 0x30000, v223
  ds_read_b128 a[240:243], v222 offset:32768
  ds_read_b128 a[244:247], v223 offset:32768
  ds_read_b128 a[248:251], v222 offset:34816
  ds_read_b128 a[252:255], v223 offset:34816
  s_waitcnt lgkmcnt(15)
  s_waitcnt vmcnt(8) lgkmcnt(4)
  s_barrier
  s_waitcnt lgkmcnt(3)
  v_mfma_f32_16x16x32_bf16 v[8:11], v[128:131], a[240:243], v[8:11]
  ds_read_b64_tr_b16 v[96:97], v240 offset:32768
  ds_read_b64_tr_b16 v[98:99], v241 offset:32768
  s_waitcnt lgkmcnt(3)
  v_mfma_f32_16x16x32_bf16 v[40:43], v[128:131], a[248:251], v[40:43]
  ds_read_b64_tr_b16 v[100:101], v240 offset:34816
  ds_read_b64_tr_b16 v[102:103], v241 offset:34816
  v_mfma_f32_16x16x32_bf16 v[44:47], v[132:135], a[248:251], v[44:47]
  ds_read_b64_tr_b16 v[104:105], v240 offset:36864
  ds_read_b64_tr_b16 v[106:107], v241 offset:36864
  v_mfma_f32_16x16x32_bf16 v[12:15], v[132:135], a[240:243], v[12:15]
  ds_read_b64_tr_b16 v[108:109], v240 offset:38912
  ds_read_b64_tr_b16 v[110:111], v241 offset:38912
  v_mfma_f32_16x16x32_bf16 v[16:19], v[136:139], a[240:243], v[16:19]
  ds_read_b64_tr_b16 v[112:113], v240 offset:33024
  ds_read_b64_tr_b16 v[114:115], v241 offset:33024
  v_mfma_f32_16x16x32_bf16 v[48:51], v[136:139], a[248:251], v[48:51]
  ds_read_b64_tr_b16 v[116:117], v240 offset:35072
  ds_read_b64_tr_b16 v[118:119], v241 offset:35072
  v_mfma_f32_16x16x32_bf16 v[52:55], v[140:143], a[248:251], v[52:55]
  ds_read_b64_tr_b16 v[120:121], v240 offset:37120
  ds_read_b64_tr_b16 v[122:123], v241 offset:37120
  v_mfma_f32_16x16x32_bf16 v[20:23], v[140:143], a[240:243], v[20:23]
  ds_read_b64_tr_b16 v[124:125], v240 offset:39168
  ds_read_b64_tr_b16 v[126:127], v241 offset:39168
  v_mfma_f32_16x16x32_bf16 v[8:11], v[144:147], a[244:247], v[8:11]
  s_add_u32 m0, s92, 81920
  s_nop 0
  buffer_load_dwordx4 v59, s[80:83], s79 offen offset:0 sc1 lds
  s_waitcnt lgkmcnt(15)
  v_mfma_f32_16x16x32_bf16 v[40:43], v[144:147], a[252:255], v[40:43]
  v_mfma_f32_16x16x32_bf16 v[44:47], v[148:151], a[252:255], v[44:47]
  buffer_load_dwordx4 v59, s[80:83], s79 offen offset:1024 sc1 lds
  v_mfma_f32_16x16x32_bf16 v[12:15], v[148:151], a[244:247], v[12:15]
  v_mfma_f32_16x16x32_bf16 v[16:19], v[152:155], a[244:247], v[16:19]
  buffer_load_dwordx4 v59, s[80:83], s79 offen offset:2048 sc1 lds
  v_mfma_f32_16x16x32_bf16 v[48:51], v[152:155], a[252:255], v[48:51]
  v_mfma_f32_16x16x32_bf16 v[52:55], v[156:159], a[252:255], v[52:55]
  buffer_load_dwordx4 v59, s[80:83], s79 offen offset:3072 sc1 lds
  s_add_u32 s79, s79, 65536
  s_and_b32 s79, s79, 0x3ffff
  v_xor_b32 v59, 4096, v59
  v_mfma_f32_16x16x32_bf16 v[20:23], v[156:159], a[244:247], v[20:23]
  buffer_load_dwordx4 v[224:227], v174, s[88:91], s43 offen offset:0 sc1
  buffer_load_dwordx4 v[228:231], v174, s[88:91], s43 offen offset:256 sc1
  buffer_load_dwordx4 v[232:235], v174, s[88:91], s43 offen offset:512 sc1
  buffer_load_dwordx4 v[236:239], v174, s[88:91], s43 offen offset:768 sc1
  ds_read_b64_tr_b16 v[176:177], v5 offset:0
  ds_read_b64_tr_b16 v[178:179], v5 offset:256
  ds_read_b64_tr_b16 v[180:181], v5 offset:1024
  ds_read_b64_tr_b16 v[182:183], v5 offset:1280
  ds_read_b64_tr_b16 v[184:185], v5 offset:2048
  ds_read_b64_tr_b16 v[186:187], v5 offset:2304
  ds_read_b64_tr_b16 v[188:189], v5 offset:3072
  ds_read_b64_tr_b16 v[190:191], v5 offset:3328
  s_waitcnt lgkmcnt(8)
  v_mfma_f32_16x16x32_bf16 v[64:67], v[96:99], a[0:3], v[64:67]
  ds_read_b64_tr_b16 v[128:129], v240 offset:40960
  ds_read_b64_tr_b16 v[130:131], v241 offset:40960
  v_mfma_f32_16x16x32_bf16 v[80:83], v[96:99], a[8:11], 0
  ds_read_b64_tr_b16 v[132:133], v240 offset:43008
  ds_read_b64_tr_b16 v[134:135], v241 offset:43008
  v_mfma_f32_16x16x32_bf16 v[84:87], v[100:103], a[8:11], 0
  ds_read_b64_tr_b16 v[136:137], v240 offset:45056
  ds_read_b64_tr_b16 v[138:139], v241 offset:45056
  v_mfma_f32_16x16x32_bf16 v[68:71], v[100:103], a[0:3], v[68:71]
  ds_read_b64_tr_b16 v[140:141], v240 offset:47104
  ds_read_b64_tr_b16 v[142:143], v241 offset:47104
  v_mfma_f32_16x16x32_bf16 v[64:67], v[104:107], a[16:19], v[64:67]
  ds_read_b64_tr_b16 v[144:145], v240 offset:41216
  ds_read_b64_tr_b16 v[146:147], v241 offset:41216
  v_mfma_f32_16x16x32_bf16 v[80:83], v[104:107], a[24:27], v[80:83]
  ds_read_b64_tr_b16 v[148:149], v240 offset:43264
  ds_read_b64_tr_b16 v[150:151], v241 offset:43264
  v_mfma_f32_16x16x32_bf16 v[84:87], v[108:111], a[24:27], v[84:87]
  ds_read_b64_tr_b16 v[152:153], v240 offset:45312
  ds_read_b64_tr_b16 v[154:155], v241 offset:45312
  v_mfma_f32_16x16x32_bf16 v[68:71], v[108:111], a[16:19], v[68:71]
  ds_read_b64_tr_b16 v[156:157], v240 offset:47360
  ds_read_b64_tr_b16 v[158:159], v241 offset:47360
  v_mfma_f32_16x16x32_bf16 v[64:67], v[112:115], a[4:7], v[64:67]
  s_add_u32 m0, s92, 0
  s_nop 0
  buffer_load_dwordx4 v59, s[80:83], s79 offen offset:0 sc1 lds
  s_waitcnt lgkmcnt(15)
  v_mfma_f32_16x16x32_bf16 v[192:195], v[24:27], v[176:179], 0
  s_waitcnt lgkmcnt(15)
  v_mfma_f32_16x16x32_bf16 v[208:211], v[24:27], v[184:187], 0
  v_mfma_f32_16x16x32_bf16 v[80:83], v[112:115], a[12:15], v[80:83]
  v_mfma_f32_16x16x32_bf16 v[196:199], v[32:35], v[176:179], 0
  v_mfma_f32_16x16x32_bf16 v[212:215], v[32:35], v[184:187], 0
  v_mfma_f32_16x16x32_bf16 v[84:87], v[116:119], a[12:15], v[84:87]
  buffer_load_dwordx4 v59, s[80:83], s79 offen offset:1024 sc1 lds
  v_mfma_f32_16x16x32_bf16 v[200:203], v[60:63], v[176:179], 0
  v_mfma_f32_16x16x32_bf16 v[216:219], v[60:63], v[184:187], 0
  v_mfma_f32_16x16x32_bf16 v[68:71], v[116:119], a[4:7], v[68:71]
  v_mfma_f32_16x16x32_bf16 v[204:207], v[164:167], v[176:179], 0
  v_mfma_f32_16x16x32_bf16 v[220:223], v[164:167], v[184:187], 0
  v_mfma_f32_16x16x32_bf16 v[64:67], v[120:123], a[20:23], v[64:67]
  buffer_load_dwordx4 v59, s[80:83], s79 offen offset:2048 sc1 lds
  v_mfma_f32_16x16x32_bf16 v[192:195], v[28:31], v[180:183], v[192:195]
  s_waitcnt lgkmcnt(15)
  v_mfma_f32_16x16x32_bf16 v[208:211], v[28:31], v[188:191], v[208:211]
  v_mfma_f32_16x16x32_bf16 v[80:83], v[120:123], a[28:31], v[80:83]
  v_mfma_f32_16x16x32_bf16 v[196:199], v[36:39], v[180:183], v[196:199]
  v_mfma_f32_16x16x32_bf16 v[212:215], v[36:39], v[188:191], v[212:215]
  v_mfma_f32_16x16x32_bf16 v[84:87], v[124:127], a[28:31], v[84:87]
  buffer_load_dwordx4 v59, s[80:83], s79 offen offset:3072 sc1 lds
  s_add_u32 s79, s79, 65536
  s_and_b32 s79, s79, 0x3ffff
  v_mfma_f32_16x16x32_bf16 v[200:203], v[160:163], v[180:183], v[200:203]
  v_mfma_f32_16x16x32_bf16 v[216:219], v[160:163], v[188:191], v[216:219]
  v_mfma_f32_16x16x32_bf16 v[68:71], v[124:127], a[20:23], v[68:71]
  v_mfma_f32_16x16x32_bf16 v[204:207], v[168:171], v[180:183], v[204:207]
  v_mfma_f32_16x16x32_bf16 v[220:223], v[168:171], v[188:191], v[220:223]
  s_waitcnt vmcnt(12) lgkmcnt(0)
  s_barrier
  v_mfma_f32_16x16x32_bf16 v[64:67], v[128:131], a[32:35], v[64:67]
  ds_read_b64_tr_b16 v[96:97], v240 offset:49152
  ds_read_b64_tr_b16 v[98:99], v241 offset:49152
  v_mfma_f32_16x16x32_bf16 v[80:83], v[128:131], a[40:43], v[80:83]
  ds_read_b64_tr_b16 v[100:101], v240 offset:51200
  ds_read_b64_tr_b16 v[102:103], v241 offset:51200
  v_mfma_f32_16x16x32_bf16 v[84:87], v[132:135], a[40:43], v[84:87]
  ds_read_b64_tr_b16 v[104:105], v240 offset:53248
  ds_read_b64_tr_b16 v[106:107], v241 offset:53248
  v_mfma_f32_16x16x32_bf16 v[68:71], v[132:135], a[32:35], v[68:71]
  ds_read_b64_tr_b16 v[108:109], v240 offset:55296
  ds_read_b64_tr_b16 v[110:111], v241 offset:55296
  v_mfma_f32_16x16x32_bf16 v[64:67], v[136:139], a[48:51], v[64:67]
  ds_read_b64_tr_b16 v[112:113], v240 offset:49408
  ds_read_b64_tr_b16 v[114:115], v241 offset:49408
  v_mfma_f32_16x16x32_bf16 v[80:83], v[136:139], a[56:59], v[80:83]
  ds_read_b64_tr_b16 v[116:117], v240 offset:51456
  ds_read_b64_tr_b16 v[118:119], v241 offset:51456
  v_mfma_f32_16x16x32_bf16 v[84:87], v[140:143], a[56:59], v[84:87]
  ds_read_b64_tr_b16 v[120:121], v240 offset:53504
  ds_read_b64_tr_b16 v[122:123], v241 offset:53504
  v_mfma_f32_16x16x32_bf16 v[68:71], v[140:143], a[48:51], v[68:71]
  ds_read_b64_tr_b16 v[124:125], v240 offset:55552
  ds_read_b64_tr_b16 v[126:127], v241 offset:55552
  v_mfma_f32_16x16x32_bf16 v[64:67], v[144:147], a[36:39], v[64:67]
  s_add_u32 m0, s92, 16384
  s_nop 0
  buffer_load_dwordx4 v59, s[80:83], s79 offen offset:0 sc1 lds
  v_xor_b32 v177, 0x80008000, v177
  v_xor_b32 v179, 0x80008000, v179
  v_xor_b32 v181, 0x80008000, v181
  v_xor_b32 v183, 0x80008000, v183
  v_xor_b32 v185, 0x80008000, v185
  v_xor_b32 v187, 0x80008000, v187
  v_xor_b32 v189, 0x80008000, v189
  v_xor_b32 v191, 0x80008000, v191
  v_pk_add_f32 v[192:193], v[192:193], v[8:9] neg_lo:[0,1] neg_hi:[0,1]
  v_pk_add_f32 v[194:195], v[194:195], v[10:11] neg_lo:[0,1] neg_hi:[0,1]
  s_waitcnt vmcnt(8)
  v_pk_fma_f32 v[8:9], v[224:225], v[192:193], v[8:9]
  v_pk_fma_f32 v[10:11], v[226:227], v[194:195], v[10:11]
  v_mfma_f32_16x16x32_bf16 v[80:83], v[144:147], a[44:47], v[80:83]
  v_pk_add_f32 v[208:209], v[208:209], v[40:41] neg_lo:[0,1] neg_hi:[0,1]
  v_pk_add_f32 v[210:211], v[210:211], v[42:43] neg_lo:[0,1] neg_hi:[0,1]
  v_pk_fma_f32 v[40:41], v[224:225], v[208:209], v[40:41]
  v_pk_fma_f32 v[42:43], v[226:227], v[210:211], v[42:43]
  v_or_b32_sdwa v40, v8, v7 dst_sel:WORD_0 dst_unused:UNUSED_PRESERVE src0_sel:WORD_1 src1_sel:WORD_0
  v_or_b32_sdwa v41, v9, v7 dst_sel:WORD_0 dst_unused:UNUSED_PRESERVE src0_sel:WORD_1 src1_sel:WORD_0
  v_or_b32_sdwa v42, v10, v7 dst_sel:WORD_0 dst_unused:UNUSED_PRESERVE src0_sel:WORD_1 src1_sel:WORD_0
  v_or_b32_sdwa v43, v11, v7 dst_sel:WORD_0 dst_unused:UNUSED_PRESERVE src0_sel:WORD_1 src1_sel:WORD_0
  s_nop 0
  buffer_store_dwordx4 v[40:43], v58, s[44:47], s6 offen offset:0 sc1
  v_pk_add_f32 v[196:197], v[196:197], v[12:13] neg_lo:[0,1] neg_hi:[0,1]
  v_pk_add_f32 v[198:199], v[198:199], v[14:15] neg_lo:[0,1] neg_hi:[0,1]
  s_waitcnt vmcnt(8)
  v_pk_fma_f32 v[12:13], v[228:229], v[196:197], v[12:13]
  v_mfma_f32_16x16x32_bf16 v[84:87], v[148:151], a[44:47], v[84:87]
  buffer_load_dwordx4 v59, s[80:83], s79 offen offset:1024 sc1 lds
  v_pk_fma_f32 v[14:15], v[230:231], v[198:199], v[14:15]
  v_pk_add_f32 v[212:213], v[212:213], v[44:45] neg_lo:[0,1] neg_hi:[0,1]
  v_pk_add_f32 v[214:215], v[214:215], v[46:47] neg_lo:[0,1] neg_hi:[0,1]
  v_pk_fma_f32 v[44:45], v[228:229], v[212:213], v[44:45]
  v_pk_fma_f32 v[46:47], v[230:231], v[214:215], v[46:47]
  v_or_b32_sdwa v44, v12, v7 dst_sel:WORD_0 dst_unused:UNUSED_PRESERVE src0_sel:WORD_1 src1_sel:WORD_0
  v_or_b32_sdwa v45, v13, v7 dst_sel:WORD_0 dst_unused:UNUSED_PRESERVE src0_sel:WORD_1 src1_sel:WORD_0
  v_or_b32_sdwa v46, v14, v7 dst_sel:WORD_0 dst_unused:UNUSED_PRESERVE src0_sel:WORD_1 src1_sel:WORD_0
  v_or_b32_sdwa v47, v15, v7 dst_sel:WORD_0 dst_unused:UNUSED_PRESERVE src0_sel:WORD_1 src1_sel:WORD_0
  s_nop 0
  buffer_store_dwordx4 v[44:47], v58, s[44:47], s6 offen offset:1024 sc1
  v_pk_add_f32 v[200:201], v[200:201], v[16:17] neg_lo:[0,1] neg_hi:[0,1]
  v_pk_add_f32 v[202:203], v[202:203], v[18:19] neg_lo:[0,1] neg_hi:[0,1]
  v_mfma_f32_16x16x32_bf16 v[68:71], v[148:151], a[36:39], v[68:71]
  s_waitcnt vmcnt(9)
  v_pk_fma_f32 v[16:17], v[232:233], v[200:201], v[16:17]
  v_pk_fma_f32 v[18:19], v[234:235], v[202:203], v[18:19]
  v_pk_add_f32 v[216:217], v[216:217], v[48:49] neg_lo:[0,1] neg_hi:[0,1]
  v_pk_add_f32 v[218:219], v[218:219], v[50:51] neg_lo:[0,1] neg_hi:[0,1]
  v_pk_fma_f32 v[48:49], v[232:233], v[216:217], v[48:49]
  v_pk_fma_f32 v[50:51], v[234:235], v[218:219], v[50:51]
  v_or_b32_sdwa v48, v16, v7 dst_sel:WORD_0 dst_unused:UNUSED_PRESERVE src0_sel:WORD_1 src1_sel:WORD_0
  v_or_b32_sdwa v49, v17, v7 dst_sel:WORD_0 dst_unused:UNUSED_PRESERVE src0_sel:WORD_1 src1_sel:WORD_0
  v_or_b32_sdwa v50, v18, v7 dst_sel:WORD_0 dst_unused:UNUSED_PRESERVE src0_sel:WORD_1 src1_sel:WORD_0
  v_or_b32_sdwa v51, v19, v7 dst_sel:WORD_0 dst_unused:UNUSED_PRESERVE src0_sel:WORD_1 src1_sel:WORD_0
  s_nop 0
  buffer_store_dwordx4 v[48:51], v58, s[44:47], s6 offen offset:2048 sc1
  v_pk_add_f32 v[204:205], v[204:205], v[20:21] neg_lo:[0,1] neg_hi:[0,1]
  v_mfma_f32_16x16x32_bf16 v[64:67], v[152:155], a[52:55], v[64:67]
  buffer_load_dwordx4 v59, s[80:83], s79 offen offset:2048 sc1 lds
  v_pk_add_f32 v[206:207], v[206:207], v[22:23] neg_lo:[0,1] neg_hi:[0,1]
  s_waitcnt vmcnt(10)
  v_pk_fma_f32 v[20:21], v[236:237], v[204:205], v[20:21]
  v_pk_fma_f32 v[22:23], v[238:239], v[206:207], v[22:23]
  v_pk_add_f32 v[220:221], v[220:221], v[52:53] neg_lo:[0,1] neg_hi:[0,1]
  v_pk_add_f32 v[222:223], v[222:223], v[54:55] neg_lo:[0,1] neg_hi:[0,1]
  v_pk_fma_f32 v[52:53], v[236:237], v[220:221], v[52:53]
  v_pk_fma_f32 v[54:55], v[238:239], v[222:223], v[54:55]
  v_or_b32_sdwa v52, v20, v7 dst_sel:WORD_0 dst_unused:UNUSED_PRESERVE src0_sel:WORD_1 src1_sel:WORD_0
  v_or_b32_sdwa v53, v21, v7 dst_sel:WORD_0 dst_unused:UNUSED_PRESERVE src0_sel:WORD_1 src1_sel:WORD_0
  v_or_b32_sdwa v54, v22, v7 dst_sel:WORD_0 dst_unused:UNUSED_PRESERVE src0_sel:WORD_1 src1_sel:WORD_0
  v_or_b32_sdwa v55, v23, v7 dst_sel:WORD_0 dst_unused:UNUSED_PRESERVE src0_sel:WORD_1 src1_sel:WORD_0
  s_nop 0
  buffer_store_dwordx4 v[52:55], v58, s[44:47], s6 offen offset:3072 sc1
  v_mfma_f32_16x16x32_bf16 v[80:83], v[152:155], a[60:63], v[80:83]
  s_xor_b32 s43, s43, 1024
  s_xor_b32 s6, s6, 131072
  v_mfma_f32_16x16x32_bf16 v[84:87], v[156:159], a[60:63], v[84:87]
  buffer_load_dwordx4 v59, s[80:83], s79 offen offset:3072 sc1 lds
  s_add_u32 s79, s79, 65536
  s_and_b32 s79, s79, 0x3ffff
  v_mfma_f32_16x16x32_bf16 v[68:71], v[156:159], a[52:55], v[68:71]
  s_waitcnt lgkmcnt(0)
  v_mfma_f32_16x16x32_bf16 v[64:67], v[96:99], a[64:67], v[64:67]
  ds_read_b64_tr_b16 v[128:129], v240 offset:57344
  ds_read_b64_tr_b16 v[130:131], v241 offset:57344
  v_mfma_f32_16x16x32_bf16 v[80:83], v[96:99], a[72:75], v[80:83]
  ds_read_b64_tr_b16 v[132:133], v240 offset:59392
  ds_read_b64_tr_b16 v[134:135], v241 offset:59392
  v_mfma_f32_16x16x32_bf16 v[84:87], v[100:103], a[72:75], v[84:87]
  ds_read_b64_tr_b16 v[136:137], v240 offset:61440
  ds_read_b64_tr_b16 v[138:139], v241 offset:61440
  v_mfma_f32_16x16x32_bf16 v[68:71], v[100:103], a[64:67], v[68:71]
  ds_read_b64_tr_b16 v[140:141], v240 offset:63488
  ds_read_b64_tr_b16 v[142:143], v241 offset:63488
  v_mfma_f32_16x16x32_bf16 v[64:67], v[104:107], a[80:83], v[64:67]
  ds_read_b64_tr_b16 v[144:145], v240 offset:57600
  ds_read_b64_tr_b16 v[146:147], v241 offset:57600
  v_mfma_f32_16x16x32_bf16 v[80:83], v[104:107], a[88:91], v[80:83]
  ds_read_b64_tr_b16 v[148:149], v240 offset:59648
  ds_read_b64_tr_b16 v[150:151], v241 offset:59648
  v_mfma_f32_16x16x32_bf16 v[84:87], v[108:111], a[88:91], v[84:87]
  ds_read_b64_tr_b16 v[152:153], v240 offset:61696
  ds_read_b64_tr_b16 v[154:155], v241 offset:61696
  v_mfma_f32_16x16x32_bf16 v[68:71], v[108:111], a[80:83], v[68:71]
  ds_read_b64_tr_b16 v[156:157], v240 offset:63744
  ds_read_b64_tr_b16 v[158:159], v241 offset:63744
  v_mfma_f32_16x16x32_bf16 v[64:67], v[112:115], a[68:71], v[64:67]
  s_add_u32 m0, s92, 32768
  s_nop 0
  buffer_load_dwordx4 v59, s[80:83], s79 offen offset:0 sc1 lds
  v_mfma_f32_16x16x32_bf16 v[80:83], v[112:115], a[76:79], v[80:83]
  v_mfma_f32_16x16x32_bf16 v[84:87], v[116:119], a[76:79], v[84:87]
  buffer_load_dwordx4 v59, s[80:83], s79 offen offset:1024 sc1 lds
  v_mfma_f32_16x16x32_bf16 v[68:71], v[116:119], a[68:71], v[68:71]
  v_mfma_f32_16x16x32_bf16 v[64:67], v[120:123], a[84:87], v[64:67]
  buffer_load_dwordx4 v59, s[80:83], s79 offen offset:2048 sc1 lds
  v_mfma_f32_16x16x32_bf16 v[80:83], v[120:123], a[92:95], v[80:83]
  v_mfma_f32_16x16x32_bf16 v[84:87], v[124:127], a[92:95], v[84:87]
  buffer_load_dwordx4 v59, s[80:83], s79 offen offset:3072 sc1 lds
  s_add_u32 s79, s79, 65536
  s_and_b32 s79, s79, 0x3ffff
  v_mfma_f32_16x16x32_bf16 v[68:71], v[124:127], a[84:87], v[68:71]
  s_waitcnt lgkmcnt(0)
  v_mfma_f32_16x16x32_bf16 v[64:67], v[128:131], a[96:99], v[64:67]
  ds_read_b64_tr_b16 v[96:97], v242 offset:0
  ds_read_b64_tr_b16 v[98:99], v243 offset:0
  v_mfma_f32_16x16x32_bf16 v[80:83], v[128:131], a[104:107], v[80:83]
  ds_read_b64_tr_b16 v[100:101], v242 offset:2048
  ds_read_b64_tr_b16 v[102:103], v243 offset:2048
  v_mfma_f32_16x16x32_bf16 v[84:87], v[132:135], a[104:107], v[84:87]
  ds_read_b64_tr_b16 v[104:105], v242 offset:4096
  ds_read_b64_tr_b16 v[106:107], v243 offset:4096
  v_mfma_f32_16x16x32_bf16 v[68:71], v[132:135], a[96:99], v[68:71]
  ds_read_b64_tr_b16 v[108:109], v242 offset:6144
  ds_read_b64_tr_b16 v[110:111], v243 offset:6144
  v_mfma_f32_16x16x32_bf16 v[64:67], v[136:139], a[112:115], v[64:67]
  ds_read_b64_tr_b16 v[112:113], v242 offset:256
  ds_read_b64_tr_b16 v[114:115], v243 offset:256
  v_mfma_f32_16x16x32_bf16 v[80:83], v[136:139], a[120:123], v[80:83]
  ds_read_b64_tr_b16 v[116:117], v242 offset:2304
  ds_read_b64_tr_b16 v[118:119], v243 offset:2304
  v_mfma_f32_16x16x32_bf16 v[84:87], v[140:143], a[120:123], v[84:87]
  ds_read_b64_tr_b16 v[120:121], v242 offset:4352
  ds_read_b64_tr_b16 v[122:123], v243 offset:4352
  v_mfma_f32_16x16x32_bf16 v[68:71], v[140:143], a[112:115], v[68:71]
  ds_read_b64_tr_b16 v[124:125], v242 offset:6400
  ds_read_b64_tr_b16 v[126:127], v243 offset:6400
  v_mfma_f32_16x16x32_bf16 v[64:67], v[144:147], a[100:103], v[64:67]
  v_mfma_f32_16x16x32_bf16 v[80:83], v[144:147], a[108:111], v[80:83]
  v_mfma_f32_16x16x32_bf16 v[84:87], v[148:151], a[108:111], v[84:87]
  v_mfma_f32_16x16x32_bf16 v[68:71], v[148:151], a[100:103], v[68:71]
  v_mfma_f32_16x16x32_bf16 v[64:67], v[152:155], a[116:119], v[64:67]
  v_mfma_f32_16x16x32_bf16 v[80:83], v[152:155], a[124:127], v[80:83]
  v_mfma_f32_16x16x32_bf16 v[84:87], v[156:159], a[124:127], v[84:87]
  v_mfma_f32_16x16x32_bf16 v[68:71], v[156:159], a[116:119], v[68:71]
  s_waitcnt lgkmcnt(0)
  v_mfma_f32_16x16x32_bf16 v[64:67], v[96:99], a[128:131], v[64:67]
  ds_read_b64_tr_b16 v[128:129], v242 offset:8192
  ds_read_b64_tr_b16 v[130:131], v243 offset:8192
  v_mfma_f32_16x16x32_bf16 v[80:83], v[96:99], a[136:139], v[80:83]
  ds_read_b64_tr_b16 v[132:133], v242 offset:10240
  ds_read_b64_tr_b16 v[134:135], v243 offset:10240
  v_mfma_f32_16x16x32_bf16 v[84:87], v[100:103], a[136:139], v[84:87]
  ds_read_b64_tr_b16 v[136:137], v242 offset:12288
  ds_read_b64_tr_b16 v[138:139], v243 offset:12288
  v_mfma_f32_16x16x32_bf16 v[68:71], v[100:103], a[128:131], v[68:71]
  ds_read_b64_tr_b16 v[140:141], v242 offset:14336
  ds_read_b64_tr_b16 v[142:143], v243 offset:14336
  v_mfma_f32_16x16x32_bf16 v[64:67], v[104:107], a[144:147], v[64:67]
  ds_read_b64_tr_b16 v[144:145], v242 offset:8448
  ds_read_b64_tr_b16 v[146:147], v243 offset:8448
  v_mfma_f32_16x16x32_bf16 v[80:83], v[104:107], a[152:155], v[80:83]
  ds_read_b64_tr_b16 v[148:149], v242 offset:10496
  ds_read_b64_tr_b16 v[150:151], v243 offset:10496
  v_mfma_f32_16x16x32_bf16 v[84:87], v[108:111], a[152:155], v[84:87]
  ds_read_b64_tr_b16 v[152:153], v242 offset:12544
  ds_read_b64_tr_b16 v[154:155], v243 offset:12544
  v_mfma_f32_16x16x32_bf16 v[68:71], v[108:111], a[144:147], v[68:71]
  ds_read_b64_tr_b16 v[156:157], v242 offset:14592
  ds_read_b64_tr_b16 v[158:159], v243 offset:14592
  v_mfma_f32_16x16x32_bf16 v[64:67], v[112:115], a[132:135], v[64:67]
  v_mfma_f32_16x16x32_bf16 v[80:83], v[112:115], a[140:143], v[80:83]
  v_mfma_f32_16x16x32_bf16 v[84:87], v[116:119], a[140:143], v[84:87]
  v_mfma_f32_16x16x32_bf16 v[68:71], v[116:119], a[132:135], v[68:71]
  v_mfma_f32_16x16x32_bf16 v[64:67], v[120:123], a[148:151], v[64:67]
  v_mfma_f32_16x16x32_bf16 v[80:83], v[120:123], a[156:159], v[80:83]
  v_mfma_f32_16x16x32_bf16 v[84:87], v[124:127], a[156:159], v[84:87]
  v_mfma_f32_16x16x32_bf16 v[68:71], v[124:127], a[148:151], v[68:71]
  s_waitcnt vmcnt(12) lgkmcnt(0)
  s_barrier
  v_mfma_f32_16x16x32_bf16 v[64:67], v[128:131], a[160:163], v[64:67]
  ds_read_b64_tr_b16 v[96:97], v242 offset:16384
  ds_read_b64_tr_b16 v[98:99], v243 offset:16384
  v_mfma_f32_16x16x32_bf16 v[80:83], v[128:131], a[168:171], v[80:83]
  ds_read_b64_tr_b16 v[100:101], v242 offset:18432
  ds_read_b64_tr_b16 v[102:103], v243 offset:18432
  v_mfma_f32_16x16x32_bf16 v[84:87], v[132:135], a[168:171], v[84:87]
  ds_read_b64_tr_b16 v[104:105], v242 offset:20480
  ds_read_b64_tr_b16 v[106:107], v243 offset:20480
  v_mfma_f32_16x16x32_bf16 v[68:71], v[132:135], a[160:163], v[68:71]
  ds_read_b64_tr_b16 v[108:109], v242 offset:22528
  ds_read_b64_tr_b16 v[110:111], v243 offset:22528
  v_mfma_f32_16x16x32_bf16 v[64:67], v[136:139], a[176:179], v[64:67]
  ds_read_b64_tr_b16 v[112:113], v242 offset:16640
  ds_read_b64_tr_b16 v[114:115], v243 offset:16640
  v_mfma_f32_16x16x32_bf16 v[80:83], v[136:139], a[184:187], v[80:83]
  ds_read_b64_tr_b16 v[116:117], v242 offset:18688
  ds_read_b64_tr_b16 v[118:119], v243 offset:18688
  v_mfma_f32_16x16x32_bf16 v[84:87], v[140:143], a[184:187], v[84:87]
  ds_read_b64_tr_b16 v[120:121], v242 offset:20736
  ds_read_b64_tr_b16 v[122:123], v243 offset:20736
  v_mfma_f32_16x16x32_bf16 v[68:71], v[140:143], a[176:179], v[68:71]
  ds_read_b64_tr_b16 v[124:125], v242 offset:22784
  ds_read_b64_tr_b16 v[126:127], v243 offset:22784
  v_mfma_f32_16x16x32_bf16 v[64:67], v[144:147], a[164:167], v[64:67]
  s_add_u32 m0, s92, 49152
  s_nop 0
  buffer_load_dwordx4 v59, s[80:83], s79 offen offset:0 sc1 lds
  v_mfma_f32_16x16x32_bf16 v[80:83], v[144:147], a[172:175], v[80:83]
  v_mfma_f32_16x16x32_bf16 v[84:87], v[148:151], a[172:175], v[84:87]
  buffer_load_dwordx4 v59, s[80:83], s79 offen offset:1024 sc1 lds
  v_mfma_f32_16x16x32_bf16 v[68:71], v[148:151], a[164:167], v[68:71]
  v_mfma_f32_16x16x32_bf16 v[64:67], v[152:155], a[180:183], v[64:67]
  buffer_load_dwordx4 v59, s[80:83], s79 offen offset:2048 sc1 lds
  v_mfma_f32_16x16x32_bf16 v[80:83], v[152:155], a[188:191], v[80:83]
  v_mfma_f32_16x16x32_bf16 v[84:87], v[156:159], a[188:191], v[84:87]
  buffer_load_dwordx4 v59, s[80:83], s79 offen offset:3072 sc1 lds
  s_add_u32 s79, s79, 65536
  s_and_b32 s79, s79, 0x3ffff
  v_mfma_f32_16x16x32_bf16 v[68:71], v[156:159], a[180:183], v[68:71]
  s_waitcnt lgkmcnt(0)
  v_mfma_f32_16x16x32_bf16 v[64:67], v[96:99], a[192:195], v[64:67]
  ds_read_b64_tr_b16 v[128:129], v242 offset:24576
  ds_read_b64_tr_b16 v[130:131], v243 offset:24576
  v_mfma_f32_16x16x32_bf16 v[80:83], v[96:99], a[200:203], v[80:83]
  ds_read_b64_tr_b16 v[132:133], v242 offset:26624
  ds_read_b64_tr_b16 v[134:135], v243 offset:26624
  v_mfma_f32_16x16x32_bf16 v[84:87], v[100:103], a[200:203], v[84:87]
  ds_read_b64_tr_b16 v[136:137], v242 offset:28672
  ds_read_b64_tr_b16 v[138:139], v243 offset:28672
  v_mfma_f32_16x16x32_bf16 v[68:71], v[100:103], a[192:195], v[68:71]
  ds_read_b64_tr_b16 v[140:141], v242 offset:30720
  ds_read_b64_tr_b16 v[142:143], v243 offset:30720
  v_mfma_f32_16x16x32_bf16 v[64:67], v[104:107], a[208:211], v[64:67]
  ds_read_b64_tr_b16 v[144:145], v242 offset:24832
  ds_read_b64_tr_b16 v[146:147], v243 offset:24832
  v_mfma_f32_16x16x32_bf16 v[80:83], v[104:107], a[216:219], v[80:83]
  ds_read_b64_tr_b16 v[148:149], v242 offset:26880
  ds_read_b64_tr_b16 v[150:151], v243 offset:26880
  v_mfma_f32_16x16x32_bf16 v[84:87], v[108:111], a[216:219], v[84:87]
  ds_read_b64_tr_b16 v[152:153], v242 offset:28928
  ds_read_b64_tr_b16 v[154:155], v243 offset:28928
  v_mfma_f32_16x16x32_bf16 v[68:71], v[108:111], a[208:211], v[68:71]
  ds_read_b64_tr_b16 v[156:157], v242 offset:30976
  ds_read_b64_tr_b16 v[158:159], v243 offset:30976
  v_mfma_f32_16x16x32_bf16 v[64:67], v[112:115], a[196:199], v[64:67]
  v_mfma_f32_16x16x32_bf16 v[80:83], v[112:115], a[204:207], v[80:83]
  v_mfma_f32_16x16x32_bf16 v[84:87], v[116:119], a[204:207], v[84:87]
  v_mfma_f32_16x16x32_bf16 v[68:71], v[116:119], a[196:199], v[68:71]
  v_mfma_f32_16x16x32_bf16 v[64:67], v[120:123], a[212:215], v[64:67]
  v_mfma_f32_16x16x32_bf16 v[80:83], v[120:123], a[220:223], v[80:83]
  v_mfma_f32_16x16x32_bf16 v[84:87], v[124:127], a[220:223], v[84:87]
  v_mfma_f32_16x16x32_bf16 v[68:71], v[124:127], a[212:215], v[68:71]
  buffer_load_dwordx4 v[224:227], v174, s[88:91], s43 offen offset:0 sc1
  buffer_load_dwordx4 v[228:231], v174, s[88:91], s43 offen offset:256 sc1
  buffer_load_dwordx4 v[232:235], v174, s[88:91], s43 offen offset:512 sc1
  buffer_load_dwordx4 v[236:239], v174, s[88:91], s43 offen offset:768 sc1
  s_waitcnt lgkmcnt(0)
  v_mfma_f32_16x16x32_bf16 v[64:67], v[128:131], a[224:227], v[64:67]
  ds_read_b64_tr_b16 v[96:97], v240 offset:0
  ds_read_b64_tr_b16 v[98:99], v241 offset:0
  v_mfma_f32_16x16x32_bf16 v[80:83], v[128:131], a[232:235], v[80:83]
  ds_read_b64_tr_b16 v[100:101], v240 offset:2048
  ds_read_b64_tr_b16 v[102:103], v241 offset:2048
  v_mfma_f32_16x16x32_bf16 v[84:87], v[132:135], a[232:235], v[84:87]
  ds_read_b64_tr_b16 v[104:105], v240 offset:4096
  ds_read_b64_tr_b16 v[106:107], v241 offset:4096
  v_mfma_f32_16x16x32_bf16 v[68:71], v[132:135], a[224:227], v[68:71]
  ds_read_b64_tr_b16 v[108:109], v240 offset:6144
  ds_read_b64_tr_b16 v[110:111], v241 offset:6144
  v_mfma_f32_16x16x32_bf16 v[64:67], v[136:139], a[240:243], v[64:67]
  ds_read_b64_tr_b16 v[112:113], v240 offset:256
  ds_read_b64_tr_b16 v[114:115], v241 offset:256
  v_mfma_f32_16x16x32_bf16 v[80:83], v[136:139], a[248:251], v[80:83]
  ds_read_b64_tr_b16 v[116:117], v240 offset:2304
  ds_read_b64_tr_b16 v[118:119], v241 offset:2304
  v_mfma_f32_16x16x32_bf16 v[84:87], v[140:143], a[248:251], v[84:87]
  ds_read_b64_tr_b16 v[120:121], v240 offset:4352
  ds_read_b64_tr_b16 v[122:123], v241 offset:4352
  v_mfma_f32_16x16x32_bf16 v[68:71], v[140:143], a[240:243], v[68:71]
  ds_read_b64_tr_b16 v[124:125], v240 offset:6400
  ds_read_b64_tr_b16 v[126:127], v241 offset:6400
  v_mfma_f32_16x16x32_bf16 v[64:67], v[144:147], a[228:231], v[64:67]
  s_branch gated_mix__spectral_gfnet__ssm_conv_s5__prompt_kernel_isk7
gated_mix__spectral_gfnet__ssm_conv_s5__prompt_kernel_isl7:
  s_branch gated_mix__spectral_gfnet__ssm_conv_s5__prompt_kernel_ret
gated_mix__spectral_gfnet__ssm_conv_s5__prompt_kernel_isk7:
  v_mfma_f32_16x16x32_bf16 v[80:83], v[144:147], a[236:239], v[80:83]
  buffer_load_dwordx4 v[40:43], v58, s[44:47], s6 offen offset:0 sc1
  v_mfma_f32_16x16x32_bf16 v[84:87], v[148:151], a[236:239], v[84:87]
  v_mfma_f32_16x16x32_bf16 v[68:71], v[148:151], a[228:231], v[68:71]
  buffer_load_dwordx4 v[44:47], v58, s[44:47], s6 offen offset:1024 sc1
  v_mfma_f32_16x16x32_bf16 v[64:67], v[152:155], a[244:247], v[64:67]
  v_mfma_f32_16x16x32_bf16 v[80:83], v[152:155], a[252:255], v[80:83]
  buffer_load_dwordx4 v[48:51], v58, s[44:47], s6 offen offset:2048 sc1
  v_mfma_f32_16x16x32_bf16 v[84:87], v[156:159], a[252:255], v[84:87]
  v_mfma_f32_16x16x32_bf16 v[68:71], v[156:159], a[244:247], v[68:71]
  buffer_load_dwordx4 v[52:55], v58, s[44:47], s6 offen offset:3072 sc1
  s_waitcnt lgkmcnt(0)
  v_mfma_f32_16x16x32_bf16 v[72:75], v[96:99], a[0:3], v[72:75]
  ds_read_b64_tr_b16 v[128:129], v240 offset:8192
  ds_read_b64_tr_b16 v[130:131], v241 offset:8192
  v_mfma_f32_16x16x32_bf16 v[88:91], v[96:99], a[8:11], 0
  ds_read_b64_tr_b16 v[132:133], v240 offset:10240
  ds_read_b64_tr_b16 v[134:135], v241 offset:10240
  v_mfma_f32_16x16x32_bf16 v[92:95], v[100:103], a[8:11], 0
  ds_read_b64_tr_b16 v[136:137], v240 offset:12288
  ds_read_b64_tr_b16 v[138:139], v241 offset:12288
  v_mfma_f32_16x16x32_bf16 v[76:79], v[100:103], a[0:3], v[76:79]
  ds_read_b64_tr_b16 v[140:141], v240 offset:14336
  ds_read_b64_tr_b16 v[142:143], v241 offset:14336
  v_mfma_f32_16x16x32_bf16 v[72:75], v[104:107], a[16:19], v[72:75]
  ds_read_b64_tr_b16 v[144:145], v240 offset:8448
  ds_read_b64_tr_b16 v[146:147], v241 offset:8448
  v_mfma_f32_16x16x32_bf16 v[88:91], v[104:107], a[24:27], v[88:91]
  ds_read_b64_tr_b16 v[148:149], v240 offset:10496
  ds_read_b64_tr_b16 v[150:151], v241 offset:10496
  v_mfma_f32_16x16x32_bf16 v[92:95], v[108:111], a[24:27], v[92:95]
  ds_read_b64_tr_b16 v[152:153], v240 offset:12544
  ds_read_b64_tr_b16 v[154:155], v241 offset:12544
  v_mfma_f32_16x16x32_bf16 v[76:79], v[108:111], a[16:19], v[76:79]
  ds_read_b64_tr_b16 v[156:157], v240 offset:14592
  ds_read_b64_tr_b16 v[158:159], v241 offset:14592
  v_mfma_f32_16x16x32_bf16 v[72:75], v[112:115], a[4:7], v[72:75]
  v_mfma_f32_16x16x32_bf16 v[192:195], v[24:27], v[176:179], 0
  v_mfma_f32_16x16x32_bf16 v[208:211], v[24:27], v[184:187], 0
  v_mfma_f32_16x16x32_bf16 v[88:91], v[112:115], a[12:15], v[88:91]
  v_mfma_f32_16x16x32_bf16 v[196:199], v[32:35], v[176:179], 0
  v_mfma_f32_16x16x32_bf16 v[212:215], v[32:35], v[184:187], 0
  v_mfma_f32_16x16x32_bf16 v[92:95], v[116:119], a[12:15], v[92:95]
  v_mfma_f32_16x16x32_bf16 v[200:203], v[60:63], v[176:179], 0
  v_mfma_f32_16x16x32_bf16 v[216:219], v[60:63], v[184:187], 0
  v_mfma_f32_16x16x32_bf16 v[76:79], v[116:119], a[4:7], v[76:79]
  v_mfma_f32_16x16x32_bf16 v[204:207], v[164:167], v[176:179], 0
  v_mfma_f32_16x16x32_bf16 v[220:223], v[164:167], v[184:187], 0
  v_mfma_f32_16x16x32_bf16 v[72:75], v[120:123], a[20:23], v[72:75]
  v_mfma_f32_16x16x32_bf16 v[192:195], v[28:31], v[180:183], v[192:195]
  v_mfma_f32_16x16x32_bf16 v[208:211], v[28:31], v[188:191], v[208:211]
  v_mfma_f32_16x16x32_bf16 v[88:91], v[120:123], a[28:31], v[88:91]
  v_mfma_f32_16x16x32_bf16 v[196:199], v[36:39], v[180:183], v[196:199]
  v_mfma_f32_16x16x32_bf16 v[212:215], v[36:39], v[188:191], v[212:215]
  v_mfma_f32_16x16x32_bf16 v[92:95], v[124:127], a[28:31], v[92:95]
  v_mfma_f32_16x16x32_bf16 v[200:203], v[160:163], v[180:183], v[200:203]
  v_mfma_f32_16x16x32_bf16 v[216:219], v[160:163], v[188:191], v[216:219]
  v_mfma_f32_16x16x32_bf16 v[76:79], v[124:127], a[20:23], v[76:79]
  v_mfma_f32_16x16x32_bf16 v[204:207], v[168:171], v[180:183], v[204:207]
  v_mfma_f32_16x16x32_bf16 v[220:223], v[168:171], v[188:191], v[220:223]
  s_waitcnt vmcnt(8) lgkmcnt(0)
  s_barrier
  v_mfma_f32_16x16x32_bf16 v[72:75], v[128:131], a[32:35], v[72:75]
  ds_read_b64_tr_b16 v[96:97], v240 offset:16384
  ds_read_b64_tr_b16 v[98:99], v241 offset:16384
  v_mfma_f32_16x16x32_bf16 v[88:91], v[128:131], a[40:43], v[88:91]
  ds_read_b64_tr_b16 v[100:101], v240 offset:18432
  ds_read_b64_tr_b16 v[102:103], v241 offset:18432
  v_mfma_f32_16x16x32_bf16 v[92:95], v[132:135], a[40:43], v[92:95]
  ds_read_b64_tr_b16 v[104:105], v240 offset:20480
  ds_read_b64_tr_b16 v[106:107], v241 offset:20480
  v_mfma_f32_16x16x32_bf16 v[76:79], v[132:135], a[32:35], v[76:79]
  ds_read_b64_tr_b16 v[108:109], v240 offset:22528
  ds_read_b64_tr_b16 v[110:111], v241 offset:22528
  v_mfma_f32_16x16x32_bf16 v[72:75], v[136:139], a[48:51], v[72:75]
  ds_read_b64_tr_b16 v[112:113], v240 offset:16640
  ds_read_b64_tr_b16 v[114:115], v241 offset:16640
  v_mfma_f32_16x16x32_bf16 v[88:91], v[136:139], a[56:59], v[88:91]
  ds_read_b64_tr_b16 v[116:117], v240 offset:18688
  ds_read_b64_tr_b16 v[118:119], v241 offset:18688
  v_mfma_f32_16x16x32_bf16 v[92:95], v[140:143], a[56:59], v[92:95]
  ds_read_b64_tr_b16 v[120:121], v240 offset:20736
  ds_read_b64_tr_b16 v[122:123], v241 offset:20736
  v_mfma_f32_16x16x32_bf16 v[76:79], v[140:143], a[48:51], v[76:79]
  ds_read_b64_tr_b16 v[124:125], v240 offset:22784
  ds_read_b64_tr_b16 v[126:127], v241 offset:22784
  v_mfma_f32_16x16x32_bf16 v[72:75], v[144:147], a[36:39], v[72:75]
  s_waitcnt vmcnt(0)
  v_and_b32 v8, 1, v40
  v_bitop3_b32 v8, v8, v41, v42 bitop3:0x80
  v_bitop3_b32 v8, v8, v43, v44 bitop3:0x80
  v_bitop3_b32 v8, v8, v45, v46 bitop3:0x80
  v_bitop3_b32 v8, v8, v47, v48 bitop3:0x80
  v_bitop3_b32 v8, v8, v49, v50 bitop3:0x80
  v_bitop3_b32 v8, v8, v51, v52 bitop3:0x80
  v_bitop3_b32 v8, v8, v53, v54 bitop3:0x80
  v_and_b32 v8, v8, v55
  v_cmp_eq_u32 vcc, 0, v8
  s_nop 0
  s_cbranch_vccz gated_mix__spectral_gfnet__ssm_conv_s5__prompt_kernel_skip47
  s_mov_b32 s29, 0
gated_mix__spectral_gfnet__ssm_conv_s5__prompt_kernel_px48:
  s_sleep 2
  buffer_load_dwordx4 v[40:43], v58, s[44:47], s6 offen offset:0 sc1
  buffer_load_dwordx4 v[44:47], v58, s[44:47], s6 offen offset:1024 sc1
  buffer_load_dwordx4 v[48:51], v58, s[44:47], s6 offen offset:2048 sc1
  buffer_load_dwordx4 v[52:55], v58, s[44:47], s6 offen offset:3072 sc1
  s_waitcnt vmcnt(0)
  v_and_b32 v8, 1, v40
  v_bitop3_b32 v8, v8, v41, v42 bitop3:0x80
  v_bitop3_b32 v8, v8, v43, v44 bitop3:0x80
  v_bitop3_b32 v8, v8, v45, v46 bitop3:0x80
  v_bitop3_b32 v8, v8, v47, v48 bitop3:0x80
  v_bitop3_b32 v8, v8, v49, v50 bitop3:0x80
  v_bitop3_b32 v8, v8, v51, v52 bitop3:0x80
  v_bitop3_b32 v8, v8, v53, v54 bitop3:0x80
  v_and_b32 v8, v8, v55
  v_cmp_eq_u32 vcc, 0, v8
  s_nop 0
  s_cbranch_vccz gated_mix__spectral_gfnet__ssm_conv_s5__prompt_kernel_pxout49
  s_add_u32 s29, s29, 1
  s_cmp_lt_u32 s29, 1048576
  s_cbranch_scc1 gated_mix__spectral_gfnet__ssm_conv_s5__prompt_kernel_px48
gated_mix__spectral_gfnet__ssm_conv_s5__prompt_kernel_pxout49:
gated_mix__spectral_gfnet__ssm_conv_s5__prompt_kernel_skip47:
  v_mfma_f32_16x16x32_bf16 v[88:91], v[144:147], a[44:47], v[88:91]
  v_mfma_f32_16x16x32_bf16 v[92:95], v[148:151], a[44:47], v[92:95]
  v_mfma_f32_16x16x32_bf16 v[76:79], v[148:151], a[36:39], v[76:79]
  v_mfma_f32_16x16x32_bf16 v[72:75], v[152:155], a[52:55], v[72:75]
  v_mfma_f32_16x16x32_bf16 v[88:91], v[152:155], a[60:63], v[88:91]
  v_mfma_f32_16x16x32_bf16 v[92:95], v[156:159], a[60:63], v[92:95]
  v_mfma_f32_16x16x32_bf16 v[76:79], v[156:159], a[52:55], v[76:79]
  s_waitcnt lgkmcnt(0)
  v_mfma_f32_16x16x32_bf16 v[72:75], v[96:99], a[64:67], v[72:75]
  ds_read_b64_tr_b16 v[128:129], v240 offset:24576
  ds_read_b64_tr_b16 v[130:131], v241 offset:24576
  v_mfma_f32_16x16x32_bf16 v[88:91], v[96:99], a[72:75], v[88:91]
  ds_read_b64_tr_b16 v[132:133], v240 offset:26624
  ds_read_b64_tr_b16 v[134:135], v241 offset:26624
  v_mfma_f32_16x16x32_bf16 v[92:95], v[100:103], a[72:75], v[92:95]
  ds_read_b64_tr_b16 v[136:137], v240 offset:28672
  ds_read_b64_tr_b16 v[138:139], v241 offset:28672
  v_mfma_f32_16x16x32_bf16 v[76:79], v[100:103], a[64:67], v[76:79]
  ds_read_b64_tr_b16 v[140:141], v240 offset:30720
  ds_read_b64_tr_b16 v[142:143], v241 offset:30720
  v_mfma_f32_16x16x32_bf16 v[72:75], v[104:107], a[80:83], v[72:75]
  ds_read_b64_tr_b16 v[144:145], v240 offset:24832
  ds_read_b64_tr_b16 v[146:147], v241 offset:24832
  v_mfma_f32_16x16x32_bf16 v[88:91], v[104:107], a[88:91], v[88:91]
  ds_read_b64_tr_b16 v[148:149], v240 offset:26880
  ds_read_b64_tr_b16 v[150:151], v241 offset:26880
  v_mfma_f32_16x16x32_bf16 v[92:95], v[108:111], a[88:91], v[92:95]
  ds_read_b64_tr_b16 v[152:153], v240 offset:28928
  ds_read_b64_tr_b16 v[154:155], v241 offset:28928
  v_mfma_f32_16x16x32_bf16 v[76:79], v[108:111], a[80:83], v[76:79]
  ds_read_b64_tr_b16 v[156:157], v240 offset:30976
  ds_read_b64_tr_b16 v[158:159], v241 offset:30976
  v_mfma_f32_16x16x32_bf16 v[72:75], v[112:115], a[68:71], v[72:75]
  v_pk_add_f32 v[192:193], v[192:193], v[64:65] neg_lo:[0,1] neg_hi:[0,1]
  v_pk_add_f32 v[194:195], v[194:195], v[66:67] neg_lo:[0,1] neg_hi:[0,1]
  v_pk_fma_f32 v[64:65], v[224:225], v[192:193], v[64:65]
  v_pk_fma_f32 v[66:67], v[226:227], v[194:195], v[66:67]
  v_pk_add_f32 v[64:65], v[64:65], v[40:41]
  v_pk_add_f32 v[66:67], v[66:67], v[42:43]
  v_pk_add_f32 v[208:209], v[208:209], v[80:81] neg_lo:[0,1] neg_hi:[0,1]
  v_pk_add_f32 v[210:211], v[210:211], v[82:83] neg_lo:[0,1] neg_hi:[0,1]
  v_pk_fma_f32 v[80:81], v[224:225], v[208:209], v[80:81]
  v_pk_fma_f32 v[82:83], v[226:227], v[210:211], v[82:83]
  v_lshlrev_b32 v40, 16, v40
  v_lshlrev_b32 v41, 16, v41
  v_pk_add_f32 v[80:81], v[80:81], v[40:41]
  v_lshlrev_b32 v42, 16, v42
  v_lshlrev_b32 v43, 16, v43
  v_pk_add_f32 v[82:83], v[82:83], v[42:43]
  v_mfma_f32_16x16x32_bf16 v[88:91], v[112:115], a[76:79], v[88:91]
  v_mfma_f32_16x16x32_bf16 v[92:95], v[116:119], a[76:79], v[92:95]
  v_mfma_f32_16x16x32_bf16 v[76:79], v[116:119], a[68:71], v[76:79]
  v_mfma_f32_16x16x32_bf16 v[72:75], v[120:123], a[84:87], v[72:75]
  buffer_store_dword v64, v172, s[20:23], s33 offen sc1
  v_mfma_f32_16x16x32_bf16 v[88:91], v[120:123], a[92:95], v[88:91]
  v_mfma_f32_16x16x32_bf16 v[92:95], v[124:127], a[92:95], v[92:95]
  v_mfma_f32_16x16x32_bf16 v[76:79], v[124:127], a[84:87], v[76:79]
  s_waitcnt lgkmcnt(0)
  v_mfma_f32_16x16x32_bf16 v[72:75], v[128:131], a[96:99], v[72:75]
  ds_read_b64_tr_b16 v[96:97], v240 offset:32768
  ds_read_b64_tr_b16 v[98:99], v241 offset:32768
  buffer_store_dword v80, v173, s[20:23], s33 offen sc1
  v_mfma_f32_16x16x32_bf16 v[88:91], v[128:131], a[104:107], v[88:91]
  ds_read_b64_tr_b16 v[100:101], v240 offset:34816
  ds_read_b64_tr_b16 v[102:103], v241 offset:34816
  s_add_u32 s33, s33, 65536
  v_mfma_f32_16x16x32_bf16 v[92:95], v[132:135], a[104:107], v[92:95]
  ds_read_b64_tr_b16 v[104:105], v240 offset:36864
  ds_read_b64_tr_b16 v[106:107], v241 offset:36864
  v_mfma_f32_16x16x32_bf16 v[76:79], v[132:135], a[96:99], v[76:79]
  ds_read_b64_tr_b16 v[108:109], v240 offset:38912
  ds_read_b64_tr_b16 v[110:111], v241 offset:38912
  v_mfma_f32_16x16x32_bf16 v[72:75], v[136:139], a[112:115], v[72:75]
  ds_read_b64_tr_b16 v[112:113], v240 offset:33024
  ds_read_b64_tr_b16 v[114:115], v241 offset:33024
  buffer_store_dword v65, v172, s[20:23], s33 offen sc1
  v_mfma_f32_16x16x32_bf16 v[88:91], v[136:139], a[120:123], v[88:91]
  ds_read_b64_tr_b16 v[116:117], v240 offset:35072
  ds_read_b64_tr_b16 v[118:119], v241 offset:35072
  v_mfma_f32_16x16x32_bf16 v[92:95], v[140:143], a[120:123], v[92:95]
  ds_read_b64_tr_b16 v[120:121], v240 offset:37120
  ds_read_b64_tr_b16 v[122:123], v241 offset:37120
  v_mfma_f32_16x16x32_bf16 v[76:79], v[140:143], a[112:115], v[76:79]
  ds_read_b64_tr_b16 v[124:125], v240 offset:39168
  ds_read_b64_tr_b16 v[126:127], v241 offset:39168
  v_mfma_f32_16x16x32_bf16 v[72:75], v[144:147], a[100:103], v[72:75]
  buffer_store_dword v81, v173, s[20:23], s33 offen sc1
  v_mfma_f32_16x16x32_bf16 v[88:91], v[144:147], a[108:111], v[88:91]
  s_add_u32 s33, s33, 65536
  v_mfma_f32_16x16x32_bf16 v[92:95], v[148:151], a[108:111], v[92:95]
  v_mfma_f32_16x16x32_bf16 v[76:79], v[148:151], a[100:103], v[76:79]
  v_mfma_f32_16x16x32_bf16 v[72:75], v[152:155], a[116:119], v[72:75]
  buffer_store_dword v66, v172, s[20:23], s33 offen sc1
  v_mfma_f32_16x16x32_bf16 v[88:91], v[152:155], a[124:127], v[88:91]
  v_mfma_f32_16x16x32_bf16 v[92:95], v[156:159], a[124:127], v[92:95]
  v_mfma_f32_16x16x32_bf16 v[76:79], v[156:159], a[116:119], v[76:79]
  s_waitcnt lgkmcnt(0)
  v_mfma_f32_16x16x32_bf16 v[72:75], v[96:99], a[128:131], v[72:75]
  ds_read_b64_tr_b16 v[128:129], v240 offset:40960
  ds_read_b64_tr_b16 v[130:131], v241 offset:40960
  buffer_store_dword v82, v173, s[20:23], s33 offen sc1
  v_mfma_f32_16x16x32_bf16 v[88:91], v[96:99], a[136:139], v[88:91]
  ds_read_b64_tr_b16 v[132:133], v240 offset:43008
  ds_read_b64_tr_b16 v[134:135], v241 offset:43008
  s_add_u32 s33, s33, 65536
  v_mfma_f32_16x16x32_bf16 v[92:95], v[100:103], a[136:139], v[92:95]
  ds_read_b64_tr_b16 v[136:137], v240 offset:45056
  ds_read_b64_tr_b16 v[138:139], v241 offset:45056
  v_mfma_f32_16x16x32_bf16 v[76:79], v[100:103], a[128:131], v[76:79]
  ds_read_b64_tr_b16 v[140:141], v240 offset:47104
  ds_read_b64_tr_b16 v[142:143], v241 offset:47104
  v_mfma_f32_16x16x32_bf16 v[72:75], v[104:107], a[144:147], v[72:75]
  ds_read_b64_tr_b16 v[144:145], v240 offset:41216
  ds_read_b64_tr_b16 v[146:147], v241 offset:41216
  buffer_store_dword v67, v172, s[20:23], s33 offen sc1
  v_mfma_f32_16x16x32_bf16 v[88:91], v[104:107], a[152:155], v[88:91]
  ds_read_b64_tr_b16 v[148:149], v240 offset:43264
  ds_read_b64_tr_b16 v[150:151], v241 offset:43264
  v_mfma_f32_16x16x32_bf16 v[92:95], v[108:111], a[152:155], v[92:95]
  ds_read_b64_tr_b16 v[152:153], v240 offset:45312
  ds_read_b64_tr_b16 v[154:155], v241 offset:45312
  v_mfma_f32_16x16x32_bf16 v[76:79], v[108:111], a[144:147], v[76:79]
  ds_read_b64_tr_b16 v[156:157], v240 offset:47360
  ds_read_b64_tr_b16 v[158:159], v241 offset:47360
  v_mfma_f32_16x16x32_bf16 v[72:75], v[112:115], a[132:135], v[72:75]
  buffer_store_dword v83, v173, s[20:23], s33 offen sc1
  v_mfma_f32_16x16x32_bf16 v[88:91], v[112:115], a[140:143], v[88:91]
  s_add_u32 s33, s33, 851968
  v_pk_add_f32 v[196:197], v[196:197], v[68:69] neg_lo:[0,1] neg_hi:[0,1]
  v_pk_add_f32 v[198:199], v[198:199], v[70:71] neg_lo:[0,1] neg_hi:[0,1]
  v_pk_fma_f32 v[68:69], v[228:229], v[196:197], v[68:69]
  v_pk_fma_f32 v[70:71], v[230:231], v[198:199], v[70:71]
  v_pk_add_f32 v[68:69], v[68:69], v[44:45]
  v_pk_add_f32 v[70:71], v[70:71], v[46:47]
  v_pk_add_f32 v[212:213], v[212:213], v[84:85] neg_lo:[0,1] neg_hi:[0,1]
  v_pk_add_f32 v[214:215], v[214:215], v[86:87] neg_lo:[0,1] neg_hi:[0,1]
  v_pk_fma_f32 v[84:85], v[228:229], v[212:213], v[84:85]
  v_pk_fma_f32 v[86:87], v[230:231], v[214:215], v[86:87]
  v_lshlrev_b32 v44, 16, v44
  v_lshlrev_b32 v45, 16, v45
  v_pk_add_f32 v[84:85], v[84:85], v[44:45]
  v_lshlrev_b32 v46, 16, v46
  v_lshlrev_b32 v47, 16, v47
  v_pk_add_f32 v[86:87], v[86:87], v[46:47]
  v_mfma_f32_16x16x32_bf16 v[92:95], v[116:119], a[140:143], v[92:95]
  v_mfma_f32_16x16x32_bf16 v[76:79], v[116:119], a[132:135], v[76:79]
  v_mfma_f32_16x16x32_bf16 v[72:75], v[120:123], a[148:151], v[72:75]
  buffer_store_dword v68, v172, s[20:23], s33 offen sc1
  v_mfma_f32_16x16x32_bf16 v[88:91], v[120:123], a[156:159], v[88:91]
  v_mfma_f32_16x16x32_bf16 v[92:95], v[124:127], a[156:159], v[92:95]
  v_mfma_f32_16x16x32_bf16 v[76:79], v[124:127], a[148:151], v[76:79]
  s_waitcnt lgkmcnt(0)
  v_mfma_f32_16x16x32_bf16 v[72:75], v[128:131], a[160:163], v[72:75]
  ds_read_b64_tr_b16 v[96:97], v240 offset:49152
  ds_read_b64_tr_b16 v[98:99], v241 offset:49152
  buffer_store_dword v84, v173, s[20:23], s33 offen sc1
  v_mfma_f32_16x16x32_bf16 v[88:91], v[128:131], a[168:171], v[88:91]
  ds_read_b64_tr_b16 v[100:101], v240 offset:51200
  ds_read_b64_tr_b16 v[102:103], v241 offset:51200
  s_add_u32 s33, s33, 65536
  v_mfma_f32_16x16x32_bf16 v[92:95], v[132:135], a[168:171], v[92:95]
  ds_read_b64_tr_b16 v[104:105], v240 offset:53248
  ds_read_b64_tr_b16 v[106:107], v241 offset:53248
  v_mfma_f32_16x16x32_bf16 v[76:79], v[132:135], a[160:163], v[76:79]
  ds_read_b64_tr_b16 v[108:109], v240 offset:55296
  ds_read_b64_tr_b16 v[110:111], v241 offset:55296
  v_mfma_f32_16x16x32_bf16 v[72:75], v[136:139], a[176:179], v[72:75]
  ds_read_b64_tr_b16 v[112:113], v240 offset:49408
  ds_read_b64_tr_b16 v[114:115], v241 offset:49408
  buffer_store_dword v69, v172, s[20:23], s33 offen sc1
  v_mfma_f32_16x16x32_bf16 v[88:91], v[136:139], a[184:187], v[88:91]
  ds_read_b64_tr_b16 v[116:117], v240 offset:51456
  ds_read_b64_tr_b16 v[118:119], v241 offset:51456
  v_mfma_f32_16x16x32_bf16 v[92:95], v[140:143], a[184:187], v[92:95]
  ds_read_b64_tr_b16 v[120:121], v240 offset:53504
  ds_read_b64_tr_b16 v[122:123], v241 offset:53504
  v_mfma_f32_16x16x32_bf16 v[76:79], v[140:143], a[176:179], v[76:79]
  ds_read_b64_tr_b16 v[124:125], v240 offset:55552
  ds_read_b64_tr_b16 v[126:127], v241 offset:55552
  v_mfma_f32_16x16x32_bf16 v[72:75], v[144:147], a[164:167], v[72:75]
  buffer_store_dword v85, v173, s[20:23], s33 offen sc1
  v_mfma_f32_16x16x32_bf16 v[88:91], v[144:147], a[172:175], v[88:91]
  s_add_u32 s33, s33, 65536
  v_mfma_f32_16x16x32_bf16 v[92:95], v[148:151], a[172:175], v[92:95]
  v_mfma_f32_16x16x32_bf16 v[76:79], v[148:151], a[164:167], v[76:79]
  v_mfma_f32_16x16x32_bf16 v[72:75], v[152:155], a[180:183], v[72:75]
  buffer_store_dword v70, v172, s[20:23], s33 offen sc1
  v_mfma_f32_16x16x32_bf16 v[88:91], v[152:155], a[188:191], v[88:91]
  v_mfma_f32_16x16x32_bf16 v[92:95], v[156:159], a[188:191], v[92:95]
  v_mfma_f32_16x16x32_bf16 v[76:79], v[156:159], a[180:183], v[76:79]
  s_waitcnt lgkmcnt(0)
  v_mfma_f32_16x16x32_bf16 v[72:75], v[96:99], a[192:195], v[72:75]
  ds_read_b64_tr_b16 v[128:129], v240 offset:57344
  ds_read_b64_tr_b16 v[130:131], v241 offset:57344
  buffer_store_dword v86, v173, s[20:23], s33 offen sc1
  v_mfma_f32_16x16x32_bf16 v[88:91], v[96:99], a[200:203], v[88:91]
  ds_read_b64_tr_b16 v[132:133], v240 offset:59392
  ds_read_b64_tr_b16 v[134:135], v241 offset:59392
  s_add_u32 s33, s33, 65536
  v_mfma_f32_16x16x32_bf16 v[92:95], v[100:103], a[200:203], v[92:95]
  ds_read_b64_tr_b16 v[136:137], v240 offset:61440
  ds_read_b64_tr_b16 v[138:139], v241 offset:61440
  v_mfma_f32_16x16x32_bf16 v[76:79], v[100:103], a[192:195], v[76:79]
  ds_read_b64_tr_b16 v[140:141], v240 offset:63488
  ds_read_b64_tr_b16 v[142:143], v241 offset:63488
  v_mfma_f32_16x16x32_bf16 v[72:75], v[104:107], a[208:211], v[72:75]
  ds_read_b64_tr_b16 v[144:145], v240 offset:57600
  ds_read_b64_tr_b16 v[146:147], v241 offset:57600
  buffer_store_dword v71, v172, s[20:23], s33 offen sc1
  v_mfma_f32_16x16x32_bf16 v[88:91], v[104:107], a[216:219], v[88:91]
  ds_read_b64_tr_b16 v[148:149], v240 offset:59648
  ds_read_b64_tr_b16 v[150:151], v241 offset:59648
  v_mfma_f32_16x16x32_bf16 v[92:95], v[108:111], a[216:219], v[92:95]
  ds_read_b64_tr_b16 v[152:153], v240 offset:61696
  ds_read_b64_tr_b16 v[154:155], v241 offset:61696
  v_mfma_f32_16x16x32_bf16 v[76:79], v[108:111], a[208:211], v[76:79]
  ds_read_b64_tr_b16 v[156:157], v240 offset:63744
  ds_read_b64_tr_b16 v[158:159], v241 offset:63744
  v_mfma_f32_16x16x32_bf16 v[72:75], v[112:115], a[196:199], v[72:75]
  buffer_store_dword v87, v173, s[20:23], s33 offen sc1
  v_mfma_f32_16x16x32_bf16 v[88:91], v[112:115], a[204:207], v[88:91]
  s_add_u32 s33, s33, 851968
  v_mfma_f32_16x16x32_bf16 v[92:95], v[116:119], a[204:207], v[92:95]
  v_mfma_f32_16x16x32_bf16 v[76:79], v[116:119], a[196:199], v[76:79]
  v_mfma_f32_16x16x32_bf16 v[72:75], v[120:123], a[212:215], v[72:75]
  v_mfma_f32_16x16x32_bf16 v[88:91], v[120:123], a[220:223], v[88:91]
  v_mfma_f32_16x16x32_bf16 v[92:95], v[124:127], a[220:223], v[92:95]
  v_mfma_f32_16x16x32_bf16 v[76:79], v[124:127], a[212:215], v[76:79]
  s_waitcnt lgkmcnt(0)
  v_mfma_f32_16x16x32_bf16 v[72:75], v[128:131], a[224:227], v[72:75]
  v_mfma_f32_16x16x32_bf16 v[88:91], v[128:131], a[232:235], v[88:91]
  v_mfma_f32_16x16x32_bf16 v[92:95], v[132:135], a[232:235], v[92:95]
  v_mfma_f32_16x16x32_bf16 v[76:79], v[132:135], a[224:227], v[76:79]
  v_mfma_f32_16x16x32_bf16 v[72:75], v[136:139], a[240:243], v[72:75]
  v_mfma_f32_16x16x32_bf16 v[88:91], v[136:139], a[248:251], v[88:91]
  v_mfma_f32_16x16x32_bf16 v[92:95], v[140:143], a[248:251], v[92:95]
  v_mfma_f32_16x16x32_bf16 v[76:79], v[140:143], a[240:243], v[76:79]
  v_mfma_f32_16x16x32_bf16 v[72:75], v[144:147], a[228:231], v[72:75]
  v_mfma_f32_16x16x32_bf16 v[88:91], v[144:147], a[236:239], v[88:91]
  v_mfma_f32_16x16x32_bf16 v[92:95], v[148:151], a[236:239], v[92:95]
  v_mfma_f32_16x16x32_bf16 v[76:79], v[148:151], a[228:231], v[76:79]
  v_mfma_f32_16x16x32_bf16 v[72:75], v[152:155], a[244:247], v[72:75]
  v_mfma_f32_16x16x32_bf16 v[88:91], v[152:155], a[252:255], v[88:91]
  v_mfma_f32_16x16x32_bf16 v[92:95], v[156:159], a[252:255], v[92:95]
  v_mfma_f32_16x16x32_bf16 v[76:79], v[156:159], a[244:247], v[76:79]
  s_nop 4
  v_pk_add_f32 v[200:201], v[200:201], v[72:73] neg_lo:[0,1] neg_hi:[0,1]
  v_pk_add_f32 v[202:203], v[202:203], v[74:75] neg_lo:[0,1] neg_hi:[0,1]
  v_pk_fma_f32 v[72:73], v[232:233], v[200:201], v[72:73]
  v_pk_fma_f32 v[74:75], v[234:235], v[202:203], v[74:75]
  v_pk_add_f32 v[72:73], v[72:73], v[48:49]
  v_pk_add_f32 v[74:75], v[74:75], v[50:51]
  v_pk_add_f32 v[216:217], v[216:217], v[88:89] neg_lo:[0,1] neg_hi:[0,1]
  v_pk_add_f32 v[218:219], v[218:219], v[90:91] neg_lo:[0,1] neg_hi:[0,1]
  v_pk_fma_f32 v[88:89], v[232:233], v[216:217], v[88:89]
  v_pk_fma_f32 v[90:91], v[234:235], v[218:219], v[90:91]
  v_lshlrev_b32 v48, 16, v48
  v_lshlrev_b32 v49, 16, v49
  v_pk_add_f32 v[88:89], v[88:89], v[48:49]
  v_lshlrev_b32 v50, 16, v50
  v_lshlrev_b32 v51, 16, v51
  v_pk_add_f32 v[90:91], v[90:91], v[50:51]
  buffer_store_dword v72, v172, s[20:23], s33 offen sc1
  buffer_store_dword v88, v173, s[20:23], s33 offen sc1
  s_add_u32 s33, s33, 65536
  buffer_store_dword v73, v172, s[20:23], s33 offen sc1
  buffer_store_dword v89, v173, s[20:23], s33 offen sc1
  s_add_u32 s33, s33, 65536
  buffer_store_dword v74, v172, s[20:23], s33 offen sc1
  buffer_store_dword v90, v173, s[20:23], s33 offen sc1
  s_add_u32 s33, s33, 65536
  buffer_store_dword v75, v172, s[20:23], s33 offen sc1
  buffer_store_dword v91, v173, s[20:23], s33 offen sc1
  s_add_u32 s33, s33, 851968
  v_pk_add_f32 v[204:205], v[204:205], v[76:77] neg_lo:[0,1] neg_hi:[0,1]
  v_pk_add_f32 v[206:207], v[206:207], v[78:79] neg_lo:[0,1] neg_hi:[0,1]
  v_pk_fma_f32 v[76:77], v[236:237], v[204:205], v[76:77]
  v_pk_fma_f32 v[78:79], v[238:239], v[206:207], v[78:79]
  v_pk_add_f32 v[76:77], v[76:77], v[52:53]
  v_pk_add_f32 v[78:79], v[78:79], v[54:55]
  v_pk_add_f32 v[220:221], v[220:221], v[92:93] neg_lo:[0,1] neg_hi:[0,1]
  v_pk_add_f32 v[222:223], v[222:223], v[94:95] neg_lo:[0,1] neg_hi:[0,1]
  v_pk_fma_f32 v[92:93], v[236:237], v[220:221], v[92:93]
  v_pk_fma_f32 v[94:95], v[238:239], v[222:223], v[94:95]
  v_lshlrev_b32 v52, 16, v52
  v_lshlrev_b32 v53, 16, v53
  v_pk_add_f32 v[92:93], v[92:93], v[52:53]
  v_lshlrev_b32 v54, 16, v54
  v_lshlrev_b32 v55, 16, v55
  v_pk_add_f32 v[94:95], v[94:95], v[54:55]
  buffer_store_dword v76, v172, s[20:23], s33 offen sc1
  buffer_store_dword v92, v173, s[20:23], s33 offen sc1
  s_add_u32 s33, s33, 65536
  buffer_store_dword v77, v172, s[20:23], s33 offen sc1
  buffer_store_dword v93, v173, s[20:23], s33 offen sc1
  s_add_u32 s33, s33, 65536
  buffer_store_dword v78, v172, s[20:23], s33 offen sc1
  buffer_store_dword v94, v173, s[20:23], s33 offen sc1
  s_add_u32 s33, s33, 65536
  buffer_store_dword v79, v172, s[20:23], s33 offen sc1
  buffer_store_dword v95, v173, s[20:23], s33 offen sc1
gated_mix__spectral_gfnet__ssm_conv_s5__prompt_kernel_end:
  s_endpgm
.section .rodata,"a"
.p2align 6
.amdhsa_kernel gated_mix__spectral_gfnet__ssm_conv_s5__prompt_kernel
  .amdhsa_next_free_vgpr 508
  .amdhsa_next_free_sgpr 102
  .amdhsa_accum_offset 252
  .amdhsa_group_segment_fixed_size 0
  .amdhsa_kernarg_size 128
  .amdhsa_user_sgpr_count 2
  .amdhsa_user_sgpr_kernarg_segment_ptr 1
  .amdhsa_system_sgpr_workgroup_id_x 1
  .amdhsa_float_denorm_mode_32 3
.end_amdhsa_kernel
```
